```python
import torch

def _softmax(x, axis=-1):
    return torch.softmax(x, dim=axis)
def _gelu(x):
    return torch.nn.functional.gelu(x, approximate="tanh")
def _silu(x):
    return torch.nn.functional.silu(x)
def _sigmoid(x):
    return torch.sigmoid(x)
def _layernorm(x, axis=-1, eps=1e-5):
    m = x.mean(dim=axis, keepdim=True)
    v = x.var(dim=axis, keepdim=True, unbiased=False)
    return (x - m) / torch.sqrt(v + eps)
def _scatter_add(tgt, idx, src, axis=0):
    return tgt.clone().index_add_(axis, idx, src)
def _segment_sum(src, seg, n):
    out = torch.zeros((n,) + src.shape[1:], dtype=src.dtype)
    return out.index_add_(0, seg, src)
def _pad(x, pw):
    flat = tuple(v for pair in reversed(pw) for v in pair)
    return torch.nn.functional.pad(x, flat)

kernel_name = 'recurrent_scan__mha_block_cached__geglu_ffn__prompt'

def setup_inputs():

    _w = (lambda a: (lambda t: t.to(torch.bfloat16) if t.is_floating_point() else t)(torch.as_tensor(a)))
    def _A_setup():
        B, Sq, D = 1, 2048, 576
        H, Sk, Dh = 32, 2048, 128
        return {
            "x": _w((lambda *s: torch.randn(*s, dtype=torch.bfloat16) * 0.05)(B, Sq, D)),
            "k_cache": _w((lambda *s: torch.randn(*s, dtype=torch.bfloat16) * 0.8)(B, H, Sk, Dh)),
            "v_cache": _w((lambda *s: torch.randn(*s, dtype=torch.bfloat16) * 0.2)(B, H, Sk, Dh)),
            "wq": _w((lambda *s: torch.randn(*s, dtype=torch.bfloat16) * 0.8)(D, H * Dh) * (D ** -0.5)),
            "wo": _w((lambda *s: torch.randn(*s, dtype=torch.bfloat16) * 0.2)(H * Dh, D) * ((H * Dh) ** -0.5)),
        }
    _A_in = _A_setup()

    def _B_setup():
        B, S, D, F = 1, 2048, 576, 4608
        return {
            "x": _w((lambda *s: torch.randn(*s, dtype=torch.bfloat16) * 0.05)(B, S, D)),
            "w_gate": _w((lambda *s: torch.randn(*s, dtype=torch.bfloat16) * 0.1)(D, F)),
            "w_up": _w((lambda *s: torch.randn(*s, dtype=torch.bfloat16) * 0.1)(D, F)),
            "w_down": _w((lambda *s: torch.randn(*s, dtype=torch.bfloat16) * 0.1)(F, D)),
        }
    _B_in = _B_setup()

    return {
        "A_x": _A_in["x"],
        "A_k_cache": _A_in["k_cache"],
        "A_v_cache": _A_in["v_cache"],
        "A_wq": _A_in["wq"],
        "A_wo": _A_in["wo"],
        "B_x": _B_in["x"],
        "B_w_gate": _B_in["w_gate"],
        "B_w_up": _B_in["w_up"],
        "B_w_down": _B_in["w_down"],
    }

def reference(A_x, A_k_cache, A_v_cache, A_wq, A_wo, B_x, B_w_gate, B_w_up, B_w_down):
    def _A_ref(x, k_cache, v_cache, wq, wo):
        B, Sq, D = x.shape
        H, Dh = 32, 128
        q = (lambda x, *d: x.permute(*d))((x @ wq).reshape(B, Sq, H, Dh), 0, 2, 1, 3)
        scores = torch.einsum("bhqd,bhkd->bhqk", q, k_cache) * (Dh ** -0.5)
        p = _softmax(scores, axis=-1)
        o = torch.einsum("bhqk,bhkd->bhqd", p, v_cache)
        return (lambda x, *d: x.permute(*d))(o, 0, 2, 1, 3).reshape(B, Sq, H * Dh) @ wo

    def _B_ref(x, w_gate, w_up, w_down):
        return (_gelu(x @ w_gate) * (x @ w_up)) @ w_down

    x = A_x
    xn = _layernorm(x, axis=-1)
    s = _A_ref(xn, A_k_cache, A_v_cache, A_wq, A_wo)
    g = _silu(_B_ref(xn, B_w_gate, B_w_up, B_w_down))
    return x + s * g
```

```asm
; @launch grid=(256,1,1) block=(256,1,1) lds=163840
.amdgcn_target "amdgcn-amd-amdhsa--gfx950"
.text
.globl recurrent_scan__mha_block_cached__geglu_ffn__prompt_kernel
.p2align 8
.type recurrent_scan__mha_block_cached__geglu_ffn__prompt_kernel,@function
recurrent_scan__mha_block_cached__geglu_ffn__prompt_kernel:
 s_cmp_ge_u32 s2, 0x100
 s_cbranch_scc1 L_end
 s_load_dwordx16 s[80:95], s[0:1], 0
 s_load_dwordx4 s[96:99], s[0:1], 64
 s_load_dwordx4 s[12:15], s[0:1], 80
 s_memrealtime s[60:61]
 v_and_b32 v1, 63, v0
 v_lshrrev_b32 v216, 6, v0
 v_lshrrev_b32 v217, 3, v1
 v_readfirstlane_b32 s3, v216
 s_getpc_b64 s[62:63]
L_pc0:
 s_add_u32 s62, s62, L_pfa-L_pc0
 s_addc_u32 s63, s63, 0
 s_bfe_u32 s18, s2, 0x30003
 s_lshl_b32 s18, s18, 2
 s_add_u32 s18, s18, s3
 s_lshl_b32 s18, s18, 11
 s_add_u32 s62, s62, s18
 s_addc_u32 s63, s63, 0
 v_and_b32 v244, 15, v1
 v_lshlrev_b32 v244, 7, v244
 v_mov_b32 v245, s63
 v_add_co_u32 v244, vcc, s62, v244
 s_nop 1
 v_addc_co_u32 v245, vcc, 0, v245, vcc
 global_load_dword v250, v[244:245], off
L_pfa:
 v_and_b32 v218, 7, v1
 v_mul_u32_u24 v219, 0x480, v217
 v_lshl_add_u32 v219, v218, 4, v219
 s_and_b32 s16, s2, 7
 s_lshl_b32 s16, s16, 2
 s_bfe_u32 s18, s2, 0x20003
 s_add_u32 s16, s16, s18
 s_lshr_b32 s17, s2, 5
 s_lshl_b32 s18, s17, 5
 s_add_u32 s18, s18, s16
 s_mul_i32 s18, s18, 0x2400
 s_mul_i32 s19, s3, 0x180
 s_add_u32 s18, s18, s19
 s_waitcnt lgkmcnt(0)
 s_mov_b32 s4, s80
 s_mov_b32 s5, s81
 s_mov_b32 s6, 0x240000
 s_mov_b32 s7, 0x20000
 s_cmp_eq_u32 s3, 3
 s_cbranch_scc1 L_warm
 buffer_load_dwordx4 v[68:71], v219, s[4:7], s18 offen
 buffer_load_dwordx4 v[72:75], v219, s[4:7], s18 offen offset:128
 buffer_load_dwordx4 v[76:79], v219, s[4:7], s18 offen offset:256
 s_mov_b32 s8, s12
 s_mov_b32 s9, s13
 s_mov_b32 s10, 0x100
 s_mov_b32 s11, 0x20000
 s_or_b32 s62, s2, s3
 s_cbranch_scc1 L_nolead
 s_or_b32 s62, s60, 1
 v_mov_b32 v249, s62
 buffer_store_dword v249, off, s[8:11], 0 sc1
L_nolead:
 s_mov_b32 s36, s14
 s_mov_b32 s37, s15
 s_mov_b32 s38, 0x5390000
 s_mov_b32 s39, 0x20000
 s_cmp_ge_u32 s3, 2
 s_cselect_b32 s92, s94, s92
 s_cselect_b32 s93, s95, s93
 s_mov_b32 s32, s92
 s_mov_b32 s33, s93
 s_mov_b32 s34, 0x510000
 s_mov_b32 s35, 0x20000
 s_lshl_b32 s48, s3, 10
 s_mul_i32 s49, s16, 0x120
 s_and_b32 s18, s16, 1
 s_cmp_eq_u32 s18, 1
 s_cselect_b32 s19, 0, 0x120
 s_add_u32 s50, s49, s19
 s_sub_u32 s50, s50, 32
 s_lshl_b32 s19, s18, 5
 s_add_u32 s49, s49, s19
 s_and_b32 s19, s3, 1
 s_lshl_b32 s19, s19, 4
 v_lshrrev_b32 v220, 2, v1
 v_add_u32 v220, s19, v220
 v_lshrrev_b32 v221, 5, v1
 v_lshlrev_b32 v221, 1, v221
 v_and_b32 v222, 3, v1
 v_xor_b32 v221, v221, v222
 v_lshlrev_b32 v221, 4, v221
 v_mul_u32_u24 v222, 0x2400, v220
 v_add_u32 v4, v222, v221
 v_lshl_add_u32 v5, v220, 13, v221
 s_lshr_b32 s19, s3, 1
 s_lshl_b32 s19, s19, 6
 v_add_u32 v5, s19, v5
 v_lshrrev_b32 v220, 2, v218
 v_lshlrev_b32 v220, 12, v220
 v_and_b32 v221, 3, v218
 v_lshl_add_u32 v220, v221, 8, v220
 v_lshl_add_u32 v220, v217, 4, v220
 s_lshl_b32 s18, s17, 2
 s_lshr_b32 s19, s16, 3
 s_add_u32 s18, s18, s19
 s_mul_i32 s54, s18, 0x12000
 s_bfe_u32 s19, s16, 0x20001
 s_lshl_b32 s19, s19, 10
 s_add_u32 s54, s54, s19
 s_and_b32 s19, s16, 1
 s_lshl_b32 s19, s19, 7
 s_add_u32 s54, s54, s19
 s_mul_i32 s19, s3, 0x6000
 s_add_u32 s54, s54, s19
 v_lshlrev_b32 v221, 5, v217
 v_add_u32 v221, 0x27000, v221
 v_lshl_add_u32 v222, v216, 3, v221
 v_mov_b32 v80, 0
 v_mov_b32 v81, 0
 v_mov_b32 v82, 0
 v_mov_b32 v83, 0
 v_mov_b32 v84, 0x3f803f80
 s_waitcnt vmcnt(2)
 v_dot2_f32_bf16 v80, v68, v84, v80
 v_dot2_f32_bf16 v81, v68, v68, v81
 v_dot2_f32_bf16 v82, v69, v84, v82
 v_dot2_f32_bf16 v83, v69, v69, v83
 v_dot2_f32_bf16 v80, v70, v84, v80
 v_dot2_f32_bf16 v81, v70, v70, v81
 v_dot2_f32_bf16 v82, v71, v84, v82
 v_dot2_f32_bf16 v83, v71, v71, v83
 s_waitcnt vmcnt(1)
 v_dot2_f32_bf16 v80, v72, v84, v80
 v_dot2_f32_bf16 v81, v72, v72, v81
 v_dot2_f32_bf16 v82, v73, v84, v82
 v_dot2_f32_bf16 v83, v73, v73, v83
 v_dot2_f32_bf16 v80, v74, v84, v80
 v_dot2_f32_bf16 v81, v74, v74, v81
 v_dot2_f32_bf16 v82, v75, v84, v82
 v_dot2_f32_bf16 v83, v75, v75, v83
 s_waitcnt vmcnt(0)
 v_dot2_f32_bf16 v80, v76, v84, v80
 v_dot2_f32_bf16 v81, v76, v76, v81
 v_dot2_f32_bf16 v82, v77, v84, v82
 v_dot2_f32_bf16 v83, v77, v77, v83
 v_dot2_f32_bf16 v80, v78, v84, v80
 v_dot2_f32_bf16 v81, v78, v78, v81
 v_dot2_f32_bf16 v82, v79, v84, v82
 v_dot2_f32_bf16 v83, v79, v79, v83
 s_nop 2
 v_add_f32 v80, v80, v82
 v_add_f32 v81, v81, v83
 s_nop 0
 v_add_f32_dpp v80, v80, v80 quad_perm:[1,0,3,2] row_mask:0xf bank_mask:0xf
 v_add_f32_dpp v81, v81, v81 quad_perm:[1,0,3,2] row_mask:0xf bank_mask:0xf
 s_nop 0
 v_add_f32_dpp v80, v80, v80 quad_perm:[2,3,0,1] row_mask:0xf bank_mask:0xf
 v_add_f32_dpp v81, v81, v81 quad_perm:[2,3,0,1] row_mask:0xf bank_mask:0xf
 s_nop 0
 v_add_f32_dpp v80, v80, v80 row_half_mirror row_mask:0xf bank_mask:0xf
 v_add_f32_dpp v81, v81, v81 row_half_mirror row_mask:0xf bank_mask:0xf
 ds_write_b64 v222, v[80:81]
 s_waitcnt lgkmcnt(0)
 s_barrier
 ds_read_b128 v[100:103], v221
 ds_read_b64 v[104:105], v221 offset:16
 buffer_load_dword v253, off, s[8:11], 0 sc1
 s_waitcnt lgkmcnt(1)
 v_add_f32 v80, v100, v102
 v_add_f32 v82, v101, v103
 s_waitcnt lgkmcnt(0)
 v_add_f32 v80, v80, v104
 v_add_f32 v82, v82, v105
 v_mul_f32 v86, 0x3ae38e39, v80
 v_mul_f32 v88, 0x3ae38e39, v82
 v_fma_f32 v88, -v86, v86, v88
 v_max_f32 v88, 0, v88
 v_cvt_pk_bf16_f32 v88, v88, v88
 v_lshlrev_b32 v88, 16, v88
 v_cvt_pk_bf16_f32 v86, v86, v86
 v_lshlrev_b32 v86, 16, v86
 v_add_f32 v88, 0x3727c5ac, v88
 v_cvt_pk_bf16_f32 v88, v88, v88
 v_lshlrev_b32 v88, 16, v88
 v_sqrt_f32 v88, v88
 s_nop 0
 v_cvt_pk_bf16_f32 v88, v88, v88
 v_lshlrev_b32 v88, 16, v88
 v_rcp_f32 v88, v88
 v_lshlrev_b32 v90, 16, v68
 v_and_b32 v91, 0xffff0000, v68
 v_pk_add_f32 v[90:91], v[90:91], v[86:87] op_sel_hi:[1,0] neg_lo:[0,1] neg_hi:[0,1]
 v_cvt_pk_bf16_f32 v68, v90, v91
 v_lshlrev_b32 v90, 16, v68
 v_and_b32 v91, 0xffff0000, v68
 v_pk_mul_f32 v[90:91], v[90:91], v[88:89] op_sel_hi:[1,0]
 v_cvt_pk_bf16_f32 v68, v90, v91
 v_lshlrev_b32 v92, 16, v69
 v_and_b32 v93, 0xffff0000, v69
 v_pk_add_f32 v[92:93], v[92:93], v[86:87] op_sel_hi:[1,0] neg_lo:[0,1] neg_hi:[0,1]
 v_cvt_pk_bf16_f32 v69, v92, v93
 v_lshlrev_b32 v92, 16, v69
 v_and_b32 v93, 0xffff0000, v69
 v_pk_mul_f32 v[92:93], v[92:93], v[88:89] op_sel_hi:[1,0]
 v_cvt_pk_bf16_f32 v69, v92, v93
 v_lshlrev_b32 v94, 16, v70
 v_and_b32 v95, 0xffff0000, v70
 v_pk_add_f32 v[94:95], v[94:95], v[86:87] op_sel_hi:[1,0] neg_lo:[0,1] neg_hi:[0,1]
 v_cvt_pk_bf16_f32 v70, v94, v95
 v_lshlrev_b32 v94, 16, v70
 v_and_b32 v95, 0xffff0000, v70
 v_pk_mul_f32 v[94:95], v[94:95], v[88:89] op_sel_hi:[1,0]
 v_cvt_pk_bf16_f32 v70, v94, v95
 v_lshlrev_b32 v96, 16, v71
 v_and_b32 v97, 0xffff0000, v71
 v_pk_add_f32 v[96:97], v[96:97], v[86:87] op_sel_hi:[1,0] neg_lo:[0,1] neg_hi:[0,1]
 v_cvt_pk_bf16_f32 v71, v96, v97
 v_lshlrev_b32 v96, 16, v71
 v_and_b32 v97, 0xffff0000, v71
 v_pk_mul_f32 v[96:97], v[96:97], v[88:89] op_sel_hi:[1,0]
 v_cvt_pk_bf16_f32 v71, v96, v97
 buffer_store_dwordx4 v[68:71], v220, s[36:39], s54 offen sc1
 s_add_u32 s54, s54, 0x2000
 v_lshlrev_b32 v90, 16, v72
 v_and_b32 v91, 0xffff0000, v72
 v_pk_add_f32 v[90:91], v[90:91], v[86:87] op_sel_hi:[1,0] neg_lo:[0,1] neg_hi:[0,1]
 v_cvt_pk_bf16_f32 v72, v90, v91
 v_lshlrev_b32 v90, 16, v72
 v_and_b32 v91, 0xffff0000, v72
 v_pk_mul_f32 v[90:91], v[90:91], v[88:89] op_sel_hi:[1,0]
 v_cvt_pk_bf16_f32 v72, v90, v91
 v_lshlrev_b32 v92, 16, v73
 v_and_b32 v93, 0xffff0000, v73
 v_pk_add_f32 v[92:93], v[92:93], v[86:87] op_sel_hi:[1,0] neg_lo:[0,1] neg_hi:[0,1]
 v_cvt_pk_bf16_f32 v73, v92, v93
 v_lshlrev_b32 v92, 16, v73
 v_and_b32 v93, 0xffff0000, v73
 v_pk_mul_f32 v[92:93], v[92:93], v[88:89] op_sel_hi:[1,0]
 v_cvt_pk_bf16_f32 v73, v92, v93
 v_lshlrev_b32 v94, 16, v74
 v_and_b32 v95, 0xffff0000, v74
 v_pk_add_f32 v[94:95], v[94:95], v[86:87] op_sel_hi:[1,0] neg_lo:[0,1] neg_hi:[0,1]
 v_cvt_pk_bf16_f32 v74, v94, v95
 v_lshlrev_b32 v94, 16, v74
 v_and_b32 v95, 0xffff0000, v74
 v_pk_mul_f32 v[94:95], v[94:95], v[88:89] op_sel_hi:[1,0]
 v_cvt_pk_bf16_f32 v74, v94, v95
 v_lshlrev_b32 v96, 16, v75
 v_and_b32 v97, 0xffff0000, v75
 v_pk_add_f32 v[96:97], v[96:97], v[86:87] op_sel_hi:[1,0] neg_lo:[0,1] neg_hi:[0,1]
 v_cvt_pk_bf16_f32 v75, v96, v97
 v_lshlrev_b32 v96, 16, v75
 v_and_b32 v97, 0xffff0000, v75
 v_pk_mul_f32 v[96:97], v[96:97], v[88:89] op_sel_hi:[1,0]
 v_cvt_pk_bf16_f32 v75, v96, v97
 buffer_store_dwordx4 v[72:75], v220, s[36:39], s54 offen sc1
 s_add_u32 s54, s54, 0x2000
 v_lshlrev_b32 v90, 16, v76
 v_and_b32 v91, 0xffff0000, v76
 v_pk_add_f32 v[90:91], v[90:91], v[86:87] op_sel_hi:[1,0] neg_lo:[0,1] neg_hi:[0,1]
 v_cvt_pk_bf16_f32 v76, v90, v91
 v_lshlrev_b32 v90, 16, v76
 v_and_b32 v91, 0xffff0000, v76
 v_pk_mul_f32 v[90:91], v[90:91], v[88:89] op_sel_hi:[1,0]
 v_cvt_pk_bf16_f32 v76, v90, v91
 v_lshlrev_b32 v92, 16, v77
 v_and_b32 v93, 0xffff0000, v77
 v_pk_add_f32 v[92:93], v[92:93], v[86:87] op_sel_hi:[1,0] neg_lo:[0,1] neg_hi:[0,1]
 v_cvt_pk_bf16_f32 v77, v92, v93
 v_lshlrev_b32 v92, 16, v77
 v_and_b32 v93, 0xffff0000, v77
 v_pk_mul_f32 v[92:93], v[92:93], v[88:89] op_sel_hi:[1,0]
 v_cvt_pk_bf16_f32 v77, v92, v93
 v_lshlrev_b32 v94, 16, v78
 v_and_b32 v95, 0xffff0000, v78
 v_pk_add_f32 v[94:95], v[94:95], v[86:87] op_sel_hi:[1,0] neg_lo:[0,1] neg_hi:[0,1]
 v_cvt_pk_bf16_f32 v78, v94, v95
 v_lshlrev_b32 v94, 16, v78
 v_and_b32 v95, 0xffff0000, v78
 v_pk_mul_f32 v[94:95], v[94:95], v[88:89] op_sel_hi:[1,0]
 v_cvt_pk_bf16_f32 v78, v94, v95
 v_lshlrev_b32 v96, 16, v79
 v_and_b32 v97, 0xffff0000, v79
 v_pk_add_f32 v[96:97], v[96:97], v[86:87] op_sel_hi:[1,0] neg_lo:[0,1] neg_hi:[0,1]
 v_cvt_pk_bf16_f32 v79, v96, v97
 v_lshlrev_b32 v96, 16, v79
 v_and_b32 v97, 0xffff0000, v79
 v_pk_mul_f32 v[96:97], v[96:97], v[88:89] op_sel_hi:[1,0]
 v_cvt_pk_bf16_f32 v79, v96, v97
 buffer_store_dwordx4 v[76:79], v220, s[36:39], s54 offen sc1
 s_add_u32 m0, s48, 0
 s_add_u32 s53, s49, 0
 buffer_load_dwordx4 v4, s[32:35], s53 offen lds
 s_add_u32 m0, s48, 0x1000
 s_add_u32 s53, s49, 0x48000
 buffer_load_dwordx4 v4, s[32:35], s53 offen lds
 s_add_u32 m0, s48, 0x2000
 s_add_u32 s53, s49, 64
 buffer_load_dwordx4 v4, s[32:35], s53 offen lds
 s_add_u32 m0, s48, 0x3000
 s_add_u32 s53, s49, 0x48040
 buffer_load_dwordx4 v4, s[32:35], s53 offen lds
 s_add_u32 m0, s48, 0x4000
 s_add_u32 s53, s49, 0x90000
 buffer_load_dwordx4 v4, s[32:35], s53 offen lds
 s_add_u32 m0, s48, 0x5000
 s_add_u32 s53, s49, 0xd8000
 buffer_load_dwordx4 v4, s[32:35], s53 offen lds
 s_lshl_b32 s18, s17, 7
 s_lshl_b32 s62, s16, 2
 s_add_u32 s18, s18, s62
 s_add_u32 s18, s18, 0x300000
 s_waitcnt vmcnt(6)
 v_readfirstlane_b32 s59, v253
 s_nop 0
 s_cmp_eq_u32 s59, 0
 s_cbranch_scc1 L_non
L_nond:
 s_barrier
 s_cmp_lg_u32 s3, 0
 s_cbranch_scc1 L_sg1
 s_mov_b64 exec, 1
 buffer_store_dword v253, off, s[36:39], s18 sc1
 s_mov_b64 exec, -1
L_sg1:
L_w3d:
 s_add_u32 m0, s48, 0x6000
 s_add_u32 s53, s49, 0x90040
 buffer_load_dwordx4 v4, s[32:35], s53 offen lds
 s_add_u32 m0, s48, 0x7000
 s_add_u32 s53, s49, 0xd8040
 buffer_load_dwordx4 v4, s[32:35], s53 offen lds
 s_add_u32 m0, s48, 0x8000
 s_add_u32 s53, s49, 0x120000
 buffer_load_dwordx4 v4, s[32:35], s53 offen lds
 s_add_u32 m0, s48, 0x9000
 s_add_u32 s53, s49, 0x168000
 buffer_load_dwordx4 v4, s[32:35], s53 offen lds
 s_add_u32 m0, s48, 0xa000
 s_add_u32 s53, s49, 0x120040
 buffer_load_dwordx4 v4, s[32:35], s53 offen lds
 s_add_u32 m0, s48, 0xb000
 s_add_u32 s53, s49, 0x168040
 buffer_load_dwordx4 v4, s[32:35], s53 offen lds
 s_add_u32 m0, s48, 0xc000
 s_add_u32 s53, s49, 0x1b0000
 buffer_load_dwordx4 v4, s[32:35], s53 offen lds
 s_add_u32 m0, s48, 0xd000
 s_add_u32 s53, s49, 0x1f8000
 buffer_load_dwordx4 v4, s[32:35], s53 offen lds
 s_add_u32 m0, s48, 0xe000
 s_add_u32 s53, s49, 0x1b0040
 buffer_load_dwordx4 v4, s[32:35], s53 offen lds
 s_add_u32 m0, s48, 0xf000
 s_add_u32 s53, s49, 0x1f8040
 buffer_load_dwordx4 v4, s[32:35], s53 offen lds
 s_add_u32 m0, s48, 0x10000
 s_add_u32 s53, s49, 0x240000
 buffer_load_dwordx4 v4, s[32:35], s53 offen lds
 s_add_u32 m0, s48, 0x11000
 s_add_u32 s53, s49, 0x288000
 buffer_load_dwordx4 v4, s[32:35], s53 offen lds
 s_add_u32 m0, s48, 0x12000
 s_add_u32 s53, s49, 0x2d0000
 buffer_load_dwordx4 v4, s[32:35], s53 offen lds
 s_add_u32 m0, s48, 0x13000
 s_add_u32 s53, s49, 0x318000
 buffer_load_dwordx4 v4, s[32:35], s53 offen lds
 s_add_u32 m0, s48, 0x14000
 s_add_u32 s53, s49, 0x360000
 buffer_load_dwordx4 v4, s[32:35], s53 offen lds
 s_add_u32 m0, s48, 0x15000
 s_add_u32 s53, s49, 0x3a8000
 buffer_load_dwordx4 v4, s[32:35], s53 offen lds
 s_mov_b32 s28, s86
 s_mov_b32 s29, s87
 s_mov_b32 s30, 0x480000
 s_mov_b32 s31, 0x20000
 s_lshl_b32 s18, s16, 19
 s_add_u32 s20, s82, s18
 s_addc_u32 s21, s83, 0
 s_mov_b32 s22, 0x80000
 s_mov_b32 s23, 0x20000
 s_add_u32 s24, s84, s18
 s_addc_u32 s25, s85, 0
 s_mov_b32 s26, 0x80000
 s_mov_b32 s27, 0x20000
 s_lshl_b32 s51, s16, 8
 s_lshl_b32 s19, s17, 2
 s_add_u32 s19, s19, s3
 s_mul_i32 s52, s19, 0x12000
 s_mul_i32 s62, s19, 0x110000
 s_add_u32 s62, s62, 0x400000
 s_lshl_b32 s56, s49, 5
 s_add_u32 s56, s56, s62
 s_add_u32 s56, s56, 0x40000
 s_lshl_b32 s57, s50, 5
 s_add_u32 s57, s57, s62
 s_add_u32 s57, s57, 0x40000
 s_and_b32 s18, s16, 1
 s_lshl_b32 s19, s18, 3
 s_add_u32 s57, s57, s19
 s_lshl_b32 s58, s16, 13
 s_add_u32 s58, s58, s62
 s_mov_b32 s69, 0x4e800000
 s_lshl_b32 s65, s3, 12
 s_mov_b32 s67, s65
 s_mov_b32 s64, s65
 s_add_u32 s66, s65, 0x8000
 s_bfe_u32 s70, s16, 0x20002
 s_lshr_b32 s18, s16, 4
 s_lshl_b32 s71, s17, 1
 s_add_u32 s71, s71, s18
 s_and_b32 s72, s16, 3
 s_mul_i32 s73, s72, 0x264000
 s_add_u32 s73, s73, 0x4a00000
 s_lshl_b32 s18, s71, 2
 s_add_u32 s18, s18, s3
 s_cmp_lt_u32 s18, 32
 s_cselect_b32 s88, s96, s88
 s_cselect_b32 s89, s97, s89
 s_cselect_b32 s19, 36, 32
 s_cselect_b32 s62, 0, 0x144000
 s_add_u32 s63, s73, s62
 s_and_b32 s18, s18, 31
 s_mul_i32 s18, s18, s19
 s_lshl_b32 s62, s19, 5
 s_mul_i32 s62, s62, s70
 s_add_u32 s18, s18, s62
 s_mul_i32 s62, s18, 0x120
 s_add_u32 s63, s63, s62
 s_add_u32 s44, s14, s63
 s_addc_u32 s45, s15, 0
 s_mov_b32 s46, 0
 s_mov_b32 s47, 0x20000
 s_mul_i32 s46, s19, 0x120
 s_mul_i32 s18, s18, 0x480
 s_mul_i32 s62, s72, 0x120
 s_add_u32 s18, s18, s62
 s_add_u32 s40, s88, s18
 s_addc_u32 s41, s89, 0
 s_mov_b32 s42, 0
 s_mov_b32 s43, 0x20000
 s_mul_i32 s42, s19, 0x480
 s_sub_u32 s42, s42, 0x360
 s_mov_b32 s12, s98
 s_mov_b32 s13, s99
 v_lshlrev_b32 v2, 4, v1
 v_add_u32 v3, 0x88000, v2
 v_lshrrev_b32 v224, 4, v1
 v_bfe_u32 v225, v1, 2, 2
 v_and_b32 v226, 3, v1
 v_lshl_add_u32 v220, v224, 3, v225
 v_lshlrev_b32 v220, 6, v220
 v_and_b32 v221, 1, v224
 v_lshl_add_u32 v222, v226, 3, v220
 v_lshl_add_u32 v6, v221, 5, v222
 v_xor_b32 v7, 32, v6
 s_and_b32 s19, s16, 1
 s_lshl_b32 s19, s19, 5
 v_xor_b32 v8, s19, v6
 v_lshlrev_b32 v221, 1, v221
 v_xor_b32 v221, v221, v226
 v_lshl_add_u32 v9, v221, 4, v220
 v_add_u32 v10, 0x10000, v6
 v_add_u32 v11, 0x10000, v7
 v_add_u32 v12, 0x10000, v8
 v_add_u32 v13, 0x10000, v9
 v_mov_b32 v223, 0xbdd2d3e8
 v_lshrrev_b32 v216, 4, v1
 v_and_b32 v217, 3, v1
 v_and_b32 v220, 15, v1
 v_xor_b32 v221, v216, v220
 v_lshlrev_b32 v221, 4, v221
 v_lshl_add_u32 v26, v216, 8, v221
 v_xor_b32 v27, 64, v26
 v_xor_b32 v28, 0x80, v26
 v_xor_b32 v29, 0xc0, v26
 v_lshl_add_u32 v221, v220, 8, v221
 v_add_u32 v14, 0x17000, v221
 v_xor_b32 v15, 64, v14
 v_xor_b32 v16, 0x80, v14
 v_xor_b32 v17, 0xc0, v14
 v_lshlrev_b32 v221, 1, v216
 v_xor_b32 v221, v221, v220
 v_lshlrev_b32 v221, 4, v221
 v_lshl_add_u32 v30, v216, 8, v221
 v_xor_b32 v31, 0x80, v30
 v_lshrrev_b32 v221, 2, v1
 v_and_b32 v222, 7, v221
 v_lshlrev_b32 v222, 5, v222
 v_lshl_add_u32 v222, v221, 8, v222
 v_lshl_add_u32 v222, v217, 3, v222
 v_add_u32 v18, 0x1000, v222
 v_xor_b32 v19, 32, v18
 v_xor_b32 v20, 64, v18
 v_xor_b32 v21, 0x60, v18
 v_xor_b32 v22, 0x80, v18
 v_xor_b32 v23, 0xa0, v18
 v_xor_b32 v24, 0xc0, v18
 v_xor_b32 v25, 0xe0, v18
 s_lshl_b32 s18, s17, 7
 s_add_u32 s18, s18, 0x300000
 v_and_b32 v254, 31, v1
 v_lshlrev_b32 v254, 2, v254
 s_mov_b32 s63, 0x100000
L_pl2:
 buffer_load_dword v249, v254, s[36:39], s18 offen sc1
 buffer_load_dword v253, off, s[8:11], 0 sc1
 s_waitcnt vmcnt(0)
 v_readfirstlane_b32 s59, v253
 v_or_b32 v249, 1, v249
 s_nop 0
 v_cmp_ne_u32 vcc, s59, v249
 s_nop 0
 s_cbranch_vccz L_pd2
 s_sleep 1
 s_sub_u32 s63, s63, 1
 s_cbranch_scc0 L_pl2
 s_branch L_pd2
L_warm:
 s_mov_b32 s20, s92
 s_mov_b32 s21, s93
 s_mov_b32 s22, 0x510000
 s_mov_b32 s23, 0x20000
 s_mov_b32 s24, s94
 s_mov_b32 s25, s95
 s_mov_b32 s26, 0x510000
 s_mov_b32 s27, 0x20000
 s_mul_i32 s18, s16, 0x120
 s_and_b32 s18, s18, 0xffffff80
 s_mul_i32 s19, s17, 0x48000
 s_add_u32 s64, s18, s19
 s_add_u32 s65, s64, 0x240000
 s_add_u32 s66, s64, s19
 s_mul_i32 s19, s17, 0x12000
 s_add_u32 s67, s18, s19
 s_add_u32 s67, s67, 0x480000
 v_lshrrev_b32 v100, 1, v1
 v_mul_u32_u24 v100, 0x2400, v100
 v_and_b32 v101, 1, v1
 v_lshl_add_u32 v100, v101, 7, v100
 v_mul_u32_u24 v101, 0x2400, v1
 v_lshrrev_b32 v102, 2, v1
 v_min_u32 v102, 7, v102
 v_mul_u32_u24 v102, 0x2400, v102
 v_and_b32 v218, 3, v1
 v_min_u32 v218, 2, v218
 v_lshl_add_u32 v102, v218, 7, v102
 buffer_load_dword v250, v100, s[20:23], s64 offen offset:0
 buffer_load_dword v250, v100, s[24:27], s64 offen offset:0
 s_mov_b32 s8, s12
 s_mov_b32 s9, s13
 s_mov_b32 s10, 0x100
 s_mov_b32 s11, 0x20000
 s_mov_b32 s36, s14
 s_mov_b32 s37, s15
 s_mov_b32 s38, 0x5390000
 s_mov_b32 s39, 0x20000
 s_cmp_ge_u32 s3, 2
 s_cselect_b32 s92, s94, s92
 s_cselect_b32 s93, s95, s93
 s_mov_b32 s32, s92
 s_mov_b32 s33, s93
 s_mov_b32 s34, 0x510000
 s_mov_b32 s35, 0x20000
 s_lshl_b32 s48, s3, 10
 s_mul_i32 s49, s16, 0x120
 s_and_b32 s18, s16, 1
 s_cmp_eq_u32 s18, 1
 s_cselect_b32 s19, 0, 0x120
 s_add_u32 s50, s49, s19
 s_sub_u32 s50, s50, 32
 s_lshl_b32 s19, s18, 5
 s_add_u32 s49, s49, s19
 s_and_b32 s19, s3, 1
 s_lshl_b32 s19, s19, 4
 v_lshrrev_b32 v220, 2, v1
 v_add_u32 v220, s19, v220
 v_lshrrev_b32 v221, 5, v1
 v_lshlrev_b32 v221, 1, v221
 v_and_b32 v222, 3, v1
 v_xor_b32 v221, v221, v222
 v_lshlrev_b32 v221, 4, v221
 v_mul_u32_u24 v222, 0x2400, v220
 v_add_u32 v4, v222, v221
 v_lshl_add_u32 v5, v220, 13, v221
 s_lshr_b32 s19, s3, 1
 s_lshl_b32 s19, s19, 6
 v_add_u32 v5, s19, v5
 s_barrier
 s_barrier
 buffer_load_dword v250, v100, s[20:23], s65 offen offset:0
 buffer_load_dword v250, v100, s[24:27], s65 offen offset:0
 buffer_load_dword v250, v101, s[20:23], s66 offen offset:256
 buffer_load_dword v250, v101, s[24:27], s66 offen offset:256
 s_add_u32 m0, s48, 0
 s_add_u32 s53, s49, 0
 buffer_load_dwordx4 v4, s[32:35], s53 offen lds
 s_add_u32 m0, s48, 0x1000
 s_add_u32 s53, s49, 0x48000
 buffer_load_dwordx4 v4, s[32:35], s53 offen lds
 s_add_u32 m0, s48, 0x2000
 s_add_u32 s53, s49, 64
 buffer_load_dwordx4 v4, s[32:35], s53 offen lds
 s_add_u32 m0, s48, 0x3000
 s_add_u32 s53, s49, 0x48040
 buffer_load_dwordx4 v4, s[32:35], s53 offen lds
 s_add_u32 m0, s48, 0x4000
 s_add_u32 s53, s49, 0x90000
 buffer_load_dwordx4 v4, s[32:35], s53 offen lds
 s_add_u32 m0, s48, 0x5000
 s_add_u32 s53, s49, 0xd8000
 buffer_load_dwordx4 v4, s[32:35], s53 offen lds
 s_branch L_w3d
L_pd2:
 s_add_u32 s54, s52, 0
 buffer_load_dwordx4 a[0:3], v2, s[36:39], s54 offen sc1
 buffer_load_dwordx4 a[4:7], v2, s[36:39], s54 offen offset:1024 sc1
 buffer_load_dwordx4 a[8:11], v2, s[36:39], s54 offen offset:2048 sc1
 buffer_load_dwordx4 a[12:15], v2, s[36:39], s54 offen offset:3072 sc1
 s_add_u32 s54, s52, 0x1000
 buffer_load_dwordx4 a[16:19], v2, s[36:39], s54 offen sc1
 buffer_load_dwordx4 a[20:23], v2, s[36:39], s54 offen offset:1024 sc1
 buffer_load_dwordx4 a[24:27], v2, s[36:39], s54 offen offset:2048 sc1
 buffer_load_dwordx4 a[28:31], v2, s[36:39], s54 offen offset:3072 sc1
 s_waitcnt lgkmcnt(0)
 s_barrier
 s_add_u32 s54, s52, 0x2000
 buffer_load_dwordx4 a[32:35], v2, s[36:39], s54 offen sc1
 buffer_load_dwordx4 a[36:39], v2, s[36:39], s54 offen offset:1024 sc1
 buffer_load_dwordx4 a[40:43], v2, s[36:39], s54 offen offset:2048 sc1
 buffer_load_dwordx4 a[44:47], v2, s[36:39], s54 offen offset:3072 sc1
 s_add_u32 s54, s52, 0x3000
 buffer_load_dwordx4 a[48:51], v2, s[36:39], s54 offen sc1
 buffer_load_dwordx4 a[52:55], v2, s[36:39], s54 offen offset:1024 sc1
 buffer_load_dwordx4 a[56:59], v2, s[36:39], s54 offen offset:2048 sc1
 buffer_load_dwordx4 a[60:63], v2, s[36:39], s54 offen offset:3072 sc1
 ds_read_b64_tr_b16 a[232:233], v6
 ds_read_b64_tr_b16 a[234:235], v6 offset:256
 ds_read_b64_tr_b16 a[236:237], v6 offset:4096
 ds_read_b64_tr_b16 a[238:239], v6 offset:4352
 ds_read_b64_tr_b16 a[240:241], v7
 ds_read_b64_tr_b16 a[242:243], v7 offset:256
 ds_read_b64_tr_b16 a[244:245], v7 offset:4096
 ds_read_b64_tr_b16 a[246:247], v7 offset:4352
 s_waitcnt lgkmcnt(6)
 s_waitcnt vmcnt(15)
 v_mfma_f32_16x16x32_bf16 v[32:35], a[232:235], a[0:3], 0
 s_waitcnt vmcnt(11) lgkmcnt(4)
 s_add_u32 s54, s52, 0x4000
 ds_read_b64_tr_b16 a[248:249], v6 offset:2048
 ds_read_b64_tr_b16 a[250:251], v6 offset:2304
 v_mfma_f32_16x16x32_bf16 v[32:35], a[236:239], a[16:19], v[32:35]
 buffer_load_dwordx4 a[64:67], v2, s[36:39], s54 offen sc1
 v_mfma_f32_16x16x32_bf16 v[36:39], a[232:235], a[4:7], 0
 s_waitcnt vmcnt(11)
 v_mfma_f32_16x16x32_bf16 v[36:39], a[236:239], a[20:23], v[36:39]
 v_mfma_f32_16x16x32_bf16 v[40:43], a[232:235], a[8:11], 0
 s_waitcnt vmcnt(10)
 ds_read_b64_tr_b16 a[252:253], v6 offset:6144
 ds_read_b64_tr_b16 a[254:255], v6 offset:6400
 v_mfma_f32_16x16x32_bf16 v[40:43], a[236:239], a[24:27], v[40:43]
 v_mfma_f32_16x16x32_bf16 v[44:47], a[232:235], a[12:15], 0
 s_waitcnt vmcnt(9)
 buffer_load_dwordx4 a[68:71], v2, s[36:39], s54 offen offset:1024 sc1
 v_mfma_f32_16x16x32_bf16 v[44:47], a[236:239], a[28:31], v[44:47]
 s_waitcnt lgkmcnt(6)
 v_mfma_f32_16x16x32_bf16 v[48:51], a[240:243], a[0:3], 0
 s_waitcnt lgkmcnt(4)
 ds_read_b64_tr_b16 a[232:233], v7 offset:2048
 ds_read_b64_tr_b16 a[234:235], v7 offset:2304
 v_mfma_f32_16x16x32_bf16 v[48:51], a[244:247], a[16:19], v[48:51]
 v_mfma_f32_16x16x32_bf16 v[52:55], a[240:243], a[4:7], 0
 v_mfma_f32_16x16x32_bf16 v[52:55], a[244:247], a[20:23], v[52:55]
 v_mfma_f32_16x16x32_bf16 v[56:59], a[240:243], a[8:11], 0
 ds_read_b64_tr_b16 a[236:237], v7 offset:6144
 ds_read_b64_tr_b16 a[238:239], v7 offset:6400
 v_mfma_f32_16x16x32_bf16 v[56:59], a[244:247], a[24:27], v[56:59]
 buffer_load_dwordx4 a[72:75], v2, s[36:39], s54 offen offset:2048 sc1
 v_mfma_f32_16x16x32_bf16 v[60:63], a[240:243], a[12:15], 0
 v_mfma_f32_16x16x32_bf16 v[60:63], a[244:247], a[28:31], v[60:63]
 s_waitcnt lgkmcnt(6)
 v_mfma_f32_16x16x32_bf16 v[64:67], a[248:251], a[0:3], 0
 s_waitcnt lgkmcnt(4)
 ds_read_b64_tr_b16 a[240:241], v6 offset:8192
 ds_read_b64_tr_b16 a[242:243], v6 offset:8448
 v_mfma_f32_16x16x32_bf16 v[64:67], a[252:255], a[16:19], v[64:67]
 v_mfma_f32_16x16x32_bf16 v[68:71], a[248:251], a[4:7], 0
 buffer_load_dwordx4 a[76:79], v2, s[36:39], s54 offen offset:3072 sc1
 v_mfma_f32_16x16x32_bf16 v[68:71], a[252:255], a[20:23], v[68:71]
 v_mfma_f32_16x16x32_bf16 v[72:75], a[248:251], a[8:11], 0
 ds_read_b64_tr_b16 a[244:245], v6 offset:12288
 ds_read_b64_tr_b16 a[246:247], v6 offset:12544
 v_mfma_f32_16x16x32_bf16 v[72:75], a[252:255], a[24:27], v[72:75]
 v_mfma_f32_16x16x32_bf16 v[76:79], a[248:251], a[12:15], 0
 v_mfma_f32_16x16x32_bf16 v[76:79], a[252:255], a[28:31], v[76:79]
 s_waitcnt lgkmcnt(4)
 v_mfma_f32_16x16x32_bf16 v[80:83], a[232:235], a[0:3], 0
 s_add_u32 s54, s52, 0x5000
 ds_read_b64_tr_b16 a[248:249], v7 offset:8192
 ds_read_b64_tr_b16 a[250:251], v7 offset:8448
 v_mfma_f32_16x16x32_bf16 v[80:83], a[236:239], a[16:19], v[80:83]
 buffer_load_dwordx4 a[80:83], v2, s[36:39], s54 offen sc1
 v_mfma_f32_16x16x32_bf16 v[84:87], a[232:235], a[4:7], 0
 v_mfma_f32_16x16x32_bf16 v[84:87], a[236:239], a[20:23], v[84:87]
 v_mfma_f32_16x16x32_bf16 v[88:91], a[232:235], a[8:11], 0
 ds_read_b64_tr_b16 a[252:253], v7 offset:12288
 ds_read_b64_tr_b16 a[254:255], v7 offset:12544
 v_mfma_f32_16x16x32_bf16 v[88:91], a[236:239], a[24:27], v[88:91]
 v_mfma_f32_16x16x32_bf16 v[92:95], a[232:235], a[12:15], 0
 buffer_load_dwordx4 a[84:87], v2, s[36:39], s54 offen offset:1024 sc1
 v_mfma_f32_16x16x32_bf16 v[92:95], a[236:239], a[28:31], v[92:95]
 s_waitcnt lgkmcnt(6)
 v_mfma_f32_16x16x32_bf16 v[96:99], a[240:243], a[0:3], 0
 s_waitcnt lgkmcnt(4)
 ds_read_b64_tr_b16 a[232:233], v6 offset:10240
 ds_read_b64_tr_b16 a[234:235], v6 offset:10496
 v_mfma_f32_16x16x32_bf16 v[96:99], a[244:247], a[16:19], v[96:99]
 v_mfma_f32_16x16x32_bf16 v[100:103], a[240:243], a[4:7], 0
 v_mfma_f32_16x16x32_bf16 v[100:103], a[244:247], a[20:23], v[100:103]
 v_mfma_f32_16x16x32_bf16 v[104:107], a[240:243], a[8:11], 0
 ds_read_b64_tr_b16 a[236:237], v6 offset:14336
 ds_read_b64_tr_b16 a[238:239], v6 offset:14592
 v_mfma_f32_16x16x32_bf16 v[104:107], a[244:247], a[24:27], v[104:107]
 buffer_load_dwordx4 a[88:91], v2, s[36:39], s54 offen offset:2048 sc1
 v_mfma_f32_16x16x32_bf16 v[108:111], a[240:243], a[12:15], 0
 v_mfma_f32_16x16x32_bf16 v[108:111], a[244:247], a[28:31], v[108:111]
 s_waitcnt lgkmcnt(6)
 v_mfma_f32_16x16x32_bf16 v[112:115], a[248:251], a[0:3], 0
 s_waitcnt lgkmcnt(4)
 ds_read_b64_tr_b16 a[240:241], v7 offset:10240
 ds_read_b64_tr_b16 a[242:243], v7 offset:10496
 v_mfma_f32_16x16x32_bf16 v[112:115], a[252:255], a[16:19], v[112:115]
 v_mfma_f32_16x16x32_bf16 v[116:119], a[248:251], a[4:7], 0
 buffer_load_dwordx4 a[92:95], v2, s[36:39], s54 offen offset:3072 sc1
 v_mfma_f32_16x16x32_bf16 v[116:119], a[252:255], a[20:23], v[116:119]
 v_mfma_f32_16x16x32_bf16 v[120:123], a[248:251], a[8:11], 0
 ds_read_b64_tr_b16 a[244:245], v7 offset:14336
 ds_read_b64_tr_b16 a[246:247], v7 offset:14592
 v_mfma_f32_16x16x32_bf16 v[120:123], a[252:255], a[24:27], v[120:123]
 v_mfma_f32_16x16x32_bf16 v[124:127], a[248:251], a[12:15], 0
 v_mfma_f32_16x16x32_bf16 v[124:127], a[252:255], a[28:31], v[124:127]
 s_waitcnt lgkmcnt(4)
 v_mfma_f32_16x16x32_bf16 v[128:131], a[232:235], a[0:3], 0
 s_add_u32 s54, s52, 0x6000
 ds_read_b64_tr_b16 a[248:249], v6 offset:16384
 ds_read_b64_tr_b16 a[250:251], v6 offset:16640
 v_mfma_f32_16x16x32_bf16 v[128:131], a[236:239], a[16:19], v[128:131]
 buffer_load_dwordx4 a[96:99], v2, s[36:39], s54 offen sc1
 v_mfma_f32_16x16x32_bf16 v[132:135], a[232:235], a[4:7], 0
 v_mfma_f32_16x16x32_bf16 v[132:135], a[236:239], a[20:23], v[132:135]
 v_mfma_f32_16x16x32_bf16 v[136:139], a[232:235], a[8:11], 0
 ds_read_b64_tr_b16 a[252:253], v6 offset:20480
 ds_read_b64_tr_b16 a[254:255], v6 offset:20736
 v_mfma_f32_16x16x32_bf16 v[136:139], a[236:239], a[24:27], v[136:139]
 v_mfma_f32_16x16x32_bf16 v[140:143], a[232:235], a[12:15], 0
 buffer_load_dwordx4 a[100:103], v2, s[36:39], s54 offen offset:1024 sc1
 v_mfma_f32_16x16x32_bf16 v[140:143], a[236:239], a[28:31], v[140:143]
 s_waitcnt lgkmcnt(6)
 v_mfma_f32_16x16x32_bf16 v[144:147], a[240:243], a[0:3], 0
 s_waitcnt lgkmcnt(4)
 ds_read_b64_tr_b16 a[232:233], v7 offset:16384
 ds_read_b64_tr_b16 a[234:235], v7 offset:16640
 v_mfma_f32_16x16x32_bf16 v[144:147], a[244:247], a[16:19], v[144:147]
 v_mfma_f32_16x16x32_bf16 v[148:151], a[240:243], a[4:7], 0
 v_mfma_f32_16x16x32_bf16 v[148:151], a[244:247], a[20:23], v[148:151]
 v_mfma_f32_16x16x32_bf16 v[152:155], a[240:243], a[8:11], 0
 ds_read_b64_tr_b16 a[236:237], v7 offset:20480
 ds_read_b64_tr_b16 a[238:239], v7 offset:20736
 v_mfma_f32_16x16x32_bf16 v[152:155], a[244:247], a[24:27], v[152:155]
 buffer_load_dwordx4 a[104:107], v2, s[36:39], s54 offen offset:2048 sc1
 v_mfma_f32_16x16x32_bf16 v[156:159], a[240:243], a[12:15], 0
 v_mfma_f32_16x16x32_bf16 v[156:159], a[244:247], a[28:31], v[156:159]
 s_waitcnt vmcnt(18) lgkmcnt(6)
 v_mfma_f32_16x16x32_bf16 v[32:35], a[248:251], a[32:35], v[32:35]
 s_waitcnt vmcnt(14) lgkmcnt(4)
 ds_read_b64_tr_b16 a[240:241], v6 offset:18432
 ds_read_b64_tr_b16 a[242:243], v6 offset:18688
 v_mfma_f32_16x16x32_bf16 v[32:35], a[252:255], a[48:51], v[32:35]
 v_mfma_f32_16x16x32_bf16 v[36:39], a[248:251], a[36:39], v[36:39]
 s_waitcnt vmcnt(13)
 buffer_load_dwordx4 a[108:111], v2, s[36:39], s54 offen offset:3072 sc1
 v_mfma_f32_16x16x32_bf16 v[36:39], a[252:255], a[52:55], v[36:39]
 v_mfma_f32_16x16x32_bf16 v[40:43], a[248:251], a[40:43], v[40:43]
 s_waitcnt vmcnt(13)
 ds_read_b64_tr_b16 a[244:245], v6 offset:22528
 ds_read_b64_tr_b16 a[246:247], v6 offset:22784
 v_mfma_f32_16x16x32_bf16 v[40:43], a[252:255], a[56:59], v[40:43]
 v_mfma_f32_16x16x32_bf16 v[44:47], a[248:251], a[44:47], v[44:47]
 s_waitcnt vmcnt(12)
 v_mfma_f32_16x16x32_bf16 v[44:47], a[252:255], a[60:63], v[44:47]
 s_waitcnt lgkmcnt(4)
 v_mfma_f32_16x16x32_bf16 v[48:51], a[232:235], a[32:35], v[48:51]
 s_add_u32 s54, s52, 0x7000
 ds_read_b64_tr_b16 a[248:249], v7 offset:18432
 ds_read_b64_tr_b16 a[250:251], v7 offset:18688
 v_mfma_f32_16x16x32_bf16 v[48:51], a[236:239], a[48:51], v[48:51]
 buffer_load_dwordx4 a[112:115], v2, s[36:39], s54 offen sc1
 v_mfma_f32_16x16x32_bf16 v[52:55], a[232:235], a[36:39], v[52:55]
 v_mfma_f32_16x16x32_bf16 v[52:55], a[236:239], a[52:55], v[52:55]
 v_mfma_f32_16x16x32_bf16 v[56:59], a[232:235], a[40:43], v[56:59]
 ds_read_b64_tr_b16 a[252:253], v7 offset:22528
 ds_read_b64_tr_b16 a[254:255], v7 offset:22784
 v_mfma_f32_16x16x32_bf16 v[56:59], a[236:239], a[56:59], v[56:59]
 v_mfma_f32_16x16x32_bf16 v[60:63], a[232:235], a[44:47], v[60:63]
 buffer_load_dwordx4 a[116:119], v2, s[36:39], s54 offen offset:1024 sc1
 v_mfma_f32_16x16x32_bf16 v[60:63], a[236:239], a[60:63], v[60:63]
 s_waitcnt lgkmcnt(6)
 v_mfma_f32_16x16x32_bf16 v[64:67], a[240:243], a[32:35], v[64:67]
 s_waitcnt lgkmcnt(4)
 ds_read_b64_tr_b16 a[232:233], v6 offset:24576
 ds_read_b64_tr_b16 a[234:235], v6 offset:24832
 v_mfma_f32_16x16x32_bf16 v[64:67], a[244:247], a[48:51], v[64:67]
 v_mfma_f32_16x16x32_bf16 v[68:71], a[240:243], a[36:39], v[68:71]
 v_mfma_f32_16x16x32_bf16 v[68:71], a[244:247], a[52:55], v[68:71]
 v_mfma_f32_16x16x32_bf16 v[72:75], a[240:243], a[40:43], v[72:75]
 ds_read_b64_tr_b16 a[236:237], v6 offset:28672
 ds_read_b64_tr_b16 a[238:239], v6 offset:28928
 v_mfma_f32_16x16x32_bf16 v[72:75], a[244:247], a[56:59], v[72:75]
 buffer_load_dwordx4 a[120:123], v2, s[36:39], s54 offen offset:2048 sc1
 v_mfma_f32_16x16x32_bf16 v[76:79], a[240:243], a[44:47], v[76:79]
 v_mfma_f32_16x16x32_bf16 v[76:79], a[244:247], a[60:63], v[76:79]
 s_waitcnt lgkmcnt(6)
 v_mfma_f32_16x16x32_bf16 v[80:83], a[248:251], a[32:35], v[80:83]
 s_waitcnt lgkmcnt(4)
 ds_read_b64_tr_b16 a[240:241], v7 offset:24576
 ds_read_b64_tr_b16 a[242:243], v7 offset:24832
 v_mfma_f32_16x16x32_bf16 v[80:83], a[252:255], a[48:51], v[80:83]
 v_mfma_f32_16x16x32_bf16 v[84:87], a[248:251], a[36:39], v[84:87]
 buffer_load_dwordx4 a[124:127], v2, s[36:39], s54 offen offset:3072 sc1
 v_mfma_f32_16x16x32_bf16 v[84:87], a[252:255], a[52:55], v[84:87]
 v_mfma_f32_16x16x32_bf16 v[88:91], a[248:251], a[40:43], v[88:91]
 ds_read_b64_tr_b16 a[244:245], v7 offset:28672
 ds_read_b64_tr_b16 a[246:247], v7 offset:28928
 v_mfma_f32_16x16x32_bf16 v[88:91], a[252:255], a[56:59], v[88:91]
 v_mfma_f32_16x16x32_bf16 v[92:95], a[248:251], a[44:47], v[92:95]
 v_mfma_f32_16x16x32_bf16 v[92:95], a[252:255], a[60:63], v[92:95]
 s_waitcnt lgkmcnt(4)
 v_mfma_f32_16x16x32_bf16 v[96:99], a[232:235], a[32:35], v[96:99]
 s_add_u32 s54, s52, 0x8000
 ds_read_b64_tr_b16 a[248:249], v6 offset:26624
 ds_read_b64_tr_b16 a[250:251], v6 offset:26880
 v_mfma_f32_16x16x32_bf16 v[96:99], a[236:239], a[48:51], v[96:99]
 buffer_load_dwordx4 a[128:131], v2, s[36:39], s54 offen sc1
 v_mfma_f32_16x16x32_bf16 v[100:103], a[232:235], a[36:39], v[100:103]
 v_mfma_f32_16x16x32_bf16 v[100:103], a[236:239], a[52:55], v[100:103]
 v_mfma_f32_16x16x32_bf16 v[104:107], a[232:235], a[40:43], v[104:107]
 ds_read_b64_tr_b16 a[252:253], v6 offset:30720
 ds_read_b64_tr_b16 a[254:255], v6 offset:30976
 v_mfma_f32_16x16x32_bf16 v[104:107], a[236:239], a[56:59], v[104:107]
 v_mfma_f32_16x16x32_bf16 v[108:111], a[232:235], a[44:47], v[108:111]
 buffer_load_dwordx4 a[132:135], v2, s[36:39], s54 offen offset:1024 sc1
 v_mfma_f32_16x16x32_bf16 v[108:111], a[236:239], a[60:63], v[108:111]
 s_waitcnt lgkmcnt(6)
 v_mfma_f32_16x16x32_bf16 v[112:115], a[240:243], a[32:35], v[112:115]
 s_waitcnt lgkmcnt(4)
 ds_read_b64_tr_b16 a[232:233], v7 offset:26624
 ds_read_b64_tr_b16 a[234:235], v7 offset:26880
 v_mfma_f32_16x16x32_bf16 v[112:115], a[244:247], a[48:51], v[112:115]
 v_mfma_f32_16x16x32_bf16 v[116:119], a[240:243], a[36:39], v[116:119]
 v_mfma_f32_16x16x32_bf16 v[116:119], a[244:247], a[52:55], v[116:119]
 v_mfma_f32_16x16x32_bf16 v[120:123], a[240:243], a[40:43], v[120:123]
 ds_read_b64_tr_b16 a[236:237], v7 offset:30720
 ds_read_b64_tr_b16 a[238:239], v7 offset:30976
 v_mfma_f32_16x16x32_bf16 v[120:123], a[244:247], a[56:59], v[120:123]
 buffer_load_dwordx4 a[136:139], v2, s[36:39], s54 offen offset:2048 sc1
 v_mfma_f32_16x16x32_bf16 v[124:127], a[240:243], a[44:47], v[124:127]
 v_mfma_f32_16x16x32_bf16 v[124:127], a[244:247], a[60:63], v[124:127]
 s_waitcnt lgkmcnt(6)
 v_mfma_f32_16x16x32_bf16 v[128:131], a[248:251], a[32:35], v[128:131]
 s_waitcnt lgkmcnt(4)
 ds_read_b64_tr_b16 a[240:241], v6 offset:32768
 ds_read_b64_tr_b16 a[242:243], v6 offset:33024
 v_mfma_f32_16x16x32_bf16 v[128:131], a[252:255], a[48:51], v[128:131]
 v_mfma_f32_16x16x32_bf16 v[132:135], a[248:251], a[36:39], v[132:135]
 buffer_load_dwordx4 a[140:143], v2, s[36:39], s54 offen offset:3072 sc1
 v_mfma_f32_16x16x32_bf16 v[132:135], a[252:255], a[52:55], v[132:135]
 v_mfma_f32_16x16x32_bf16 v[136:139], a[248:251], a[40:43], v[136:139]
 ds_read_b64_tr_b16 a[244:245], v6 offset:36864
 ds_read_b64_tr_b16 a[246:247], v6 offset:37120
 v_mfma_f32_16x16x32_bf16 v[136:139], a[252:255], a[56:59], v[136:139]
 v_mfma_f32_16x16x32_bf16 v[140:143], a[248:251], a[44:47], v[140:143]
 v_mfma_f32_16x16x32_bf16 v[140:143], a[252:255], a[60:63], v[140:143]
 s_waitcnt lgkmcnt(4)
 v_mfma_f32_16x16x32_bf16 v[144:147], a[232:235], a[32:35], v[144:147]
 s_add_u32 s54, s52, 0x9000
 ds_read_b64_tr_b16 a[248:249], v7 offset:32768
 ds_read_b64_tr_b16 a[250:251], v7 offset:33024
 v_mfma_f32_16x16x32_bf16 v[144:147], a[236:239], a[48:51], v[144:147]
 buffer_load_dwordx4 a[144:147], v2, s[36:39], s54 offen sc1
 v_mfma_f32_16x16x32_bf16 v[148:151], a[232:235], a[36:39], v[148:151]
 v_mfma_f32_16x16x32_bf16 v[148:151], a[236:239], a[52:55], v[148:151]
 v_mfma_f32_16x16x32_bf16 v[152:155], a[232:235], a[40:43], v[152:155]
 ds_read_b64_tr_b16 a[252:253], v7 offset:36864
 ds_read_b64_tr_b16 a[254:255], v7 offset:37120
 v_mfma_f32_16x16x32_bf16 v[152:155], a[236:239], a[56:59], v[152:155]
 v_mfma_f32_16x16x32_bf16 v[156:159], a[232:235], a[44:47], v[156:159]
 buffer_load_dwordx4 a[148:151], v2, s[36:39], s54 offen offset:1024 sc1
 v_mfma_f32_16x16x32_bf16 v[156:159], a[236:239], a[60:63], v[156:159]
 s_waitcnt vmcnt(21) lgkmcnt(6)
 v_mfma_f32_16x16x32_bf16 v[32:35], a[240:243], a[64:67], v[32:35]
 s_waitcnt vmcnt(17) lgkmcnt(4)
 ds_read_b64_tr_b16 a[232:233], v6 offset:34816
 ds_read_b64_tr_b16 a[234:235], v6 offset:35072
 v_mfma_f32_16x16x32_bf16 v[32:35], a[244:247], a[80:83], v[32:35]
 v_mfma_f32_16x16x32_bf16 v[36:39], a[240:243], a[68:71], v[36:39]
 s_waitcnt vmcnt(16)
 v_mfma_f32_16x16x32_bf16 v[36:39], a[244:247], a[84:87], v[36:39]
 v_mfma_f32_16x16x32_bf16 v[40:43], a[240:243], a[72:75], v[40:43]
 s_waitcnt vmcnt(15)
 ds_read_b64_tr_b16 a[236:237], v6 offset:38912
 ds_read_b64_tr_b16 a[238:239], v6 offset:39168
 v_mfma_f32_16x16x32_bf16 v[40:43], a[244:247], a[88:91], v[40:43]
 buffer_load_dwordx4 a[152:155], v2, s[36:39], s54 offen offset:2048 sc1
 v_mfma_f32_16x16x32_bf16 v[44:47], a[240:243], a[76:79], v[44:47]
 s_waitcnt vmcnt(15)
 v_mfma_f32_16x16x32_bf16 v[44:47], a[244:247], a[92:95], v[44:47]
 s_waitcnt lgkmcnt(6)
 v_mfma_f32_16x16x32_bf16 v[48:51], a[248:251], a[64:67], v[48:51]
 s_waitcnt lgkmcnt(4)
 ds_read_b64_tr_b16 a[240:241], v7 offset:34816
 ds_read_b64_tr_b16 a[242:243], v7 offset:35072
 v_mfma_f32_16x16x32_bf16 v[48:51], a[252:255], a[80:83], v[48:51]
 v_mfma_f32_16x16x32_bf16 v[52:55], a[248:251], a[68:71], v[52:55]
 buffer_load_dwordx4 a[156:159], v2, s[36:39], s54 offen offset:3072 sc1
 v_mfma_f32_16x16x32_bf16 v[52:55], a[252:255], a[84:87], v[52:55]
 v_mfma_f32_16x16x32_bf16 v[56:59], a[248:251], a[72:75], v[56:59]
 ds_read_b64_tr_b16 a[244:245], v7 offset:38912
 ds_read_b64_tr_b16 a[246:247], v7 offset:39168
 v_mfma_f32_16x16x32_bf16 v[56:59], a[252:255], a[88:91], v[56:59]
 v_mfma_f32_16x16x32_bf16 v[60:63], a[248:251], a[76:79], v[60:63]
 v_mfma_f32_16x16x32_bf16 v[60:63], a[252:255], a[92:95], v[60:63]
 s_waitcnt lgkmcnt(4)
 v_mfma_f32_16x16x32_bf16 v[64:67], a[232:235], a[64:67], v[64:67]
 s_add_u32 s54, s52, 0xa000
 ds_read_b64_tr_b16 a[248:249], v6 offset:40960
 ds_read_b64_tr_b16 a[250:251], v6 offset:41216
 v_mfma_f32_16x16x32_bf16 v[64:67], a[236:239], a[80:83], v[64:67]
 buffer_load_dwordx4 a[160:163], v2, s[36:39], s54 offen sc1
 v_mfma_f32_16x16x32_bf16 v[68:71], a[232:235], a[68:71], v[68:71]
 v_mfma_f32_16x16x32_bf16 v[68:71], a[236:239], a[84:87], v[68:71]
 v_mfma_f32_16x16x32_bf16 v[72:75], a[232:235], a[72:75], v[72:75]
 ds_read_b64_tr_b16 a[252:253], v6 offset:45056
 ds_read_b64_tr_b16 a[254:255], v6 offset:45312
 v_mfma_f32_16x16x32_bf16 v[72:75], a[236:239], a[88:91], v[72:75]
 v_mfma_f32_16x16x32_bf16 v[76:79], a[232:235], a[76:79], v[76:79]
 buffer_load_dwordx4 a[164:167], v2, s[36:39], s54 offen offset:1024 sc1
 v_mfma_f32_16x16x32_bf16 v[76:79], a[236:239], a[92:95], v[76:79]
 s_waitcnt lgkmcnt(6)
 v_mfma_f32_16x16x32_bf16 v[80:83], a[240:243], a[64:67], v[80:83]
 s_waitcnt lgkmcnt(4)
 ds_read_b64_tr_b16 a[232:233], v7 offset:40960
 ds_read_b64_tr_b16 a[234:235], v7 offset:41216
 v_mfma_f32_16x16x32_bf16 v[80:83], a[244:247], a[80:83], v[80:83]
 v_mfma_f32_16x16x32_bf16 v[84:87], a[240:243], a[68:71], v[84:87]
 v_mfma_f32_16x16x32_bf16 v[84:87], a[244:247], a[84:87], v[84:87]
 v_mfma_f32_16x16x32_bf16 v[88:91], a[240:243], a[72:75], v[88:91]
 ds_read_b64_tr_b16 a[236:237], v7 offset:45056
 ds_read_b64_tr_b16 a[238:239], v7 offset:45312
 v_mfma_f32_16x16x32_bf16 v[88:91], a[244:247], a[88:91], v[88:91]
 buffer_load_dwordx4 a[168:171], v2, s[36:39], s54 offen offset:2048 sc1
 v_mfma_f32_16x16x32_bf16 v[92:95], a[240:243], a[76:79], v[92:95]
 v_mfma_f32_16x16x32_bf16 v[92:95], a[244:247], a[92:95], v[92:95]
 s_waitcnt lgkmcnt(6)
 v_mfma_f32_16x16x32_bf16 v[96:99], a[248:251], a[64:67], v[96:99]
 s_waitcnt lgkmcnt(4)
 ds_read_b64_tr_b16 a[240:241], v6 offset:43008
 ds_read_b64_tr_b16 a[242:243], v6 offset:43264
 v_mfma_f32_16x16x32_bf16 v[96:99], a[252:255], a[80:83], v[96:99]
 v_mfma_f32_16x16x32_bf16 v[100:103], a[248:251], a[68:71], v[100:103]
 buffer_load_dwordx4 a[172:175], v2, s[36:39], s54 offen offset:3072 sc1
 v_mfma_f32_16x16x32_bf16 v[100:103], a[252:255], a[84:87], v[100:103]
 v_mfma_f32_16x16x32_bf16 v[104:107], a[248:251], a[72:75], v[104:107]
 ds_read_b64_tr_b16 a[244:245], v6 offset:47104
 ds_read_b64_tr_b16 a[246:247], v6 offset:47360
 v_mfma_f32_16x16x32_bf16 v[104:107], a[252:255], a[88:91], v[104:107]
 v_mfma_f32_16x16x32_bf16 v[108:111], a[248:251], a[76:79], v[108:111]
 v_mfma_f32_16x16x32_bf16 v[108:111], a[252:255], a[92:95], v[108:111]
 s_waitcnt lgkmcnt(4)
 v_mfma_f32_16x16x32_bf16 v[112:115], a[232:235], a[64:67], v[112:115]
 s_add_u32 s54, s52, 0xb000
 ds_read_b64_tr_b16 a[248:249], v7 offset:43008
 ds_read_b64_tr_b16 a[250:251], v7 offset:43264
 v_mfma_f32_16x16x32_bf16 v[112:115], a[236:239], a[80:83], v[112:115]
 buffer_load_dwordx4 a[176:179], v2, s[36:39], s54 offen sc1
 v_mfma_f32_16x16x32_bf16 v[116:119], a[232:235], a[68:71], v[116:119]
 v_mfma_f32_16x16x32_bf16 v[116:119], a[236:239], a[84:87], v[116:119]
 v_mfma_f32_16x16x32_bf16 v[120:123], a[232:235], a[72:75], v[120:123]
 ds_read_b64_tr_b16 a[252:253], v7 offset:47104
 ds_read_b64_tr_b16 a[254:255], v7 offset:47360
 v_mfma_f32_16x16x32_bf16 v[120:123], a[236:239], a[88:91], v[120:123]
 v_mfma_f32_16x16x32_bf16 v[124:127], a[232:235], a[76:79], v[124:127]
 buffer_load_dwordx4 a[180:183], v2, s[36:39], s54 offen offset:1024 sc1
 v_mfma_f32_16x16x32_bf16 v[124:127], a[236:239], a[92:95], v[124:127]
 s_barrier
 s_waitcnt lgkmcnt(6)
 v_mfma_f32_16x16x32_bf16 v[128:131], a[240:243], a[64:67], v[128:131]
 s_waitcnt lgkmcnt(4)
 ds_read_b64_tr_b16 a[232:233], v6 offset:49152
 ds_read_b64_tr_b16 a[234:235], v6 offset:49408
 v_mfma_f32_16x16x32_bf16 v[128:131], a[244:247], a[80:83], v[128:131]
 s_add_u32 m0, s48, 0x16000
 v_mfma_f32_16x16x32_bf16 v[132:135], a[240:243], a[68:71], v[132:135]
 s_add_u32 s53, s49, 0x3f0000
 buffer_load_dwordx4 v4, s[32:35], s53 offen lds
 v_mfma_f32_16x16x32_bf16 v[132:135], a[244:247], a[84:87], v[132:135]
 v_mfma_f32_16x16x32_bf16 v[136:139], a[240:243], a[72:75], v[136:139]
 ds_read_b64_tr_b16 a[236:237], v6 offset:53248
 ds_read_b64_tr_b16 a[238:239], v6 offset:53504
 v_mfma_f32_16x16x32_bf16 v[136:139], a[244:247], a[88:91], v[136:139]
 buffer_load_dwordx4 a[184:187], v2, s[36:39], s54 offen offset:2048 sc1
 v_mfma_f32_16x16x32_bf16 v[140:143], a[240:243], a[76:79], v[140:143]
 v_mfma_f32_16x16x32_bf16 v[140:143], a[244:247], a[92:95], v[140:143]
 s_waitcnt lgkmcnt(6)
 v_mfma_f32_16x16x32_bf16 v[144:147], a[248:251], a[64:67], v[144:147]
 s_waitcnt lgkmcnt(4)
 ds_read_b64_tr_b16 a[240:241], v7 offset:49152
 ds_read_b64_tr_b16 a[242:243], v7 offset:49408
 v_mfma_f32_16x16x32_bf16 v[144:147], a[252:255], a[80:83], v[144:147]
 v_mfma_f32_16x16x32_bf16 v[148:151], a[248:251], a[68:71], v[148:151]
 buffer_load_dwordx4 a[188:191], v2, s[36:39], s54 offen offset:3072 sc1
 v_mfma_f32_16x16x32_bf16 v[148:151], a[252:255], a[84:87], v[148:151]
 v_mfma_f32_16x16x32_bf16 v[152:155], a[248:251], a[72:75], v[152:155]
 ds_read_b64_tr_b16 a[244:245], v7 offset:53248
 ds_read_b64_tr_b16 a[246:247], v7 offset:53504
 v_mfma_f32_16x16x32_bf16 v[152:155], a[252:255], a[88:91], v[152:155]
 v_mfma_f32_16x16x32_bf16 v[156:159], a[248:251], a[76:79], v[156:159]
 v_mfma_f32_16x16x32_bf16 v[156:159], a[252:255], a[92:95], v[156:159]
 s_waitcnt vmcnt(20) lgkmcnt(4)
 v_mfma_f32_16x16x32_bf16 v[32:35], a[232:235], a[96:99], v[32:35]
 s_add_u32 s54, s52, 0xc000
 ds_read_b64_tr_b16 a[248:249], v6 offset:51200
 ds_read_b64_tr_b16 a[250:251], v6 offset:51456
 v_mfma_f32_16x16x32_bf16 v[32:35], a[236:239], a[112:115], v[32:35]
 s_add_u32 m0, s48, 0x17000
 buffer_load_dwordx4 a[192:195], v2, s[36:39], s54 offen sc1
 v_mfma_f32_16x16x32_bf16 v[36:39], a[232:235], a[100:103], v[36:39]
 s_waitcnt vmcnt(20)
 s_add_u32 s53, s49, 0x438000
 buffer_load_dwordx4 v4, s[32:35], s53 offen lds
 v_mfma_f32_16x16x32_bf16 v[36:39], a[236:239], a[116:119], v[36:39]
 v_mfma_f32_16x16x32_bf16 v[40:43], a[232:235], a[104:107], v[40:43]
 s_waitcnt vmcnt(20)
 ds_read_b64_tr_b16 a[252:253], v6 offset:55296
 ds_read_b64_tr_b16 a[254:255], v6 offset:55552
 v_mfma_f32_16x16x32_bf16 v[40:43], a[236:239], a[120:123], v[40:43]
 v_mfma_f32_16x16x32_bf16 v[44:47], a[232:235], a[108:111], v[44:47]
 s_waitcnt vmcnt(19)
 buffer_load_dwordx4 a[196:199], v2, s[36:39], s54 offen offset:1024 sc1
 v_mfma_f32_16x16x32_bf16 v[44:47], a[236:239], a[124:127], v[44:47]
 s_waitcnt lgkmcnt(6)
 v_mfma_f32_16x16x32_bf16 v[48:51], a[240:243], a[96:99], v[48:51]
 s_waitcnt lgkmcnt(4)
 ds_read_b64_tr_b16 a[232:233], v7 offset:51200
 ds_read_b64_tr_b16 a[234:235], v7 offset:51456
 v_mfma_f32_16x16x32_bf16 v[48:51], a[244:247], a[112:115], v[48:51]
 v_mfma_f32_16x16x32_bf16 v[52:55], a[240:243], a[100:103], v[52:55]
 v_mfma_f32_16x16x32_bf16 v[52:55], a[244:247], a[116:119], v[52:55]
 v_mfma_f32_16x16x32_bf16 v[56:59], a[240:243], a[104:107], v[56:59]
 ds_read_b64_tr_b16 a[236:237], v7 offset:55296
 ds_read_b64_tr_b16 a[238:239], v7 offset:55552
 v_mfma_f32_16x16x32_bf16 v[56:59], a[244:247], a[120:123], v[56:59]
 buffer_load_dwordx4 a[200:203], v2, s[36:39], s54 offen offset:2048 sc1
 v_mfma_f32_16x16x32_bf16 v[60:63], a[240:243], a[108:111], v[60:63]
 v_mfma_f32_16x16x32_bf16 v[60:63], a[244:247], a[124:127], v[60:63]
 s_waitcnt lgkmcnt(6)
 v_mfma_f32_16x16x32_bf16 v[64:67], a[248:251], a[96:99], v[64:67]
 s_waitcnt lgkmcnt(4)
 ds_read_b64_tr_b16 a[240:241], v6 offset:57344
 ds_read_b64_tr_b16 a[242:243], v6 offset:57600
 v_mfma_f32_16x16x32_bf16 v[64:67], a[252:255], a[112:115], v[64:67]
 s_add_u32 m0, s48, 0x18000
 v_mfma_f32_16x16x32_bf16 v[68:71], a[248:251], a[100:103], v[68:71]
 s_add_u32 s53, s49, 0x480000
 buffer_load_dwordx4 v4, s[32:35], s53 offen lds
 v_mfma_f32_16x16x32_bf16 v[68:71], a[252:255], a[116:119], v[68:71]
 buffer_load_dwordx4 a[204:207], v2, s[36:39], s54 offen offset:3072 sc1
 v_mfma_f32_16x16x32_bf16 v[72:75], a[248:251], a[104:107], v[72:75]
 ds_read_b64_tr_b16 a[244:245], v6 offset:61440
 ds_read_b64_tr_b16 a[246:247], v6 offset:61696
 v_mfma_f32_16x16x32_bf16 v[72:75], a[252:255], a[120:123], v[72:75]
 v_mfma_f32_16x16x32_bf16 v[76:79], a[248:251], a[108:111], v[76:79]
 v_mfma_f32_16x16x32_bf16 v[76:79], a[252:255], a[124:127], v[76:79]
 s_waitcnt lgkmcnt(4)
 v_mfma_f32_16x16x32_bf16 v[80:83], a[232:235], a[96:99], v[80:83]
 s_add_u32 s54, s52, 0xd000
 ds_read_b64_tr_b16 a[248:249], v7 offset:57344
 ds_read_b64_tr_b16 a[250:251], v7 offset:57600
 v_mfma_f32_16x16x32_bf16 v[80:83], a[236:239], a[112:115], v[80:83]
 buffer_load_dwordx4 a[208:211], v2, s[36:39], s54 offen sc1
 v_mfma_f32_16x16x32_bf16 v[84:87], a[232:235], a[100:103], v[84:87]
 v_mfma_f32_16x16x32_bf16 v[84:87], a[236:239], a[116:119], v[84:87]
 v_mfma_f32_16x16x32_bf16 v[88:91], a[232:235], a[104:107], v[88:91]
 ds_read_b64_tr_b16 a[252:253], v7 offset:61440
 ds_read_b64_tr_b16 a[254:255], v7 offset:61696
 v_mfma_f32_16x16x32_bf16 v[88:91], a[236:239], a[120:123], v[88:91]
 v_mfma_f32_16x16x32_bf16 v[92:95], a[232:235], a[108:111], v[92:95]
 buffer_load_dwordx4 a[212:215], v2, s[36:39], s54 offen offset:1024 sc1
 v_mfma_f32_16x16x32_bf16 v[92:95], a[236:239], a[124:127], v[92:95]
 s_waitcnt lgkmcnt(6)
 v_mfma_f32_16x16x32_bf16 v[96:99], a[240:243], a[96:99], v[96:99]
 s_waitcnt lgkmcnt(4)
 ds_read_b64_tr_b16 a[232:233], v6 offset:59392
 ds_read_b64_tr_b16 a[234:235], v6 offset:59648
 v_mfma_f32_16x16x32_bf16 v[96:99], a[244:247], a[112:115], v[96:99]
 s_add_u32 m0, s48, 0x19000
 v_mfma_f32_16x16x32_bf16 v[100:103], a[240:243], a[100:103], v[100:103]
 s_add_u32 s53, s49, 0x4c8000
 buffer_load_dwordx4 v4, s[32:35], s53 offen lds
 v_mfma_f32_16x16x32_bf16 v[100:103], a[244:247], a[116:119], v[100:103]
 v_mfma_f32_16x16x32_bf16 v[104:107], a[240:243], a[104:107], v[104:107]
 ds_read_b64_tr_b16 a[236:237], v6 offset:63488
 ds_read_b64_tr_b16 a[238:239], v6 offset:63744
 v_mfma_f32_16x16x32_bf16 v[104:107], a[244:247], a[120:123], v[104:107]
 buffer_load_dwordx4 a[216:219], v2, s[36:39], s54 offen offset:2048 sc1
 v_mfma_f32_16x16x32_bf16 v[108:111], a[240:243], a[108:111], v[108:111]
 v_mfma_f32_16x16x32_bf16 v[108:111], a[244:247], a[124:127], v[108:111]
 s_waitcnt lgkmcnt(6)
 v_mfma_f32_16x16x32_bf16 v[112:115], a[248:251], a[96:99], v[112:115]
 s_waitcnt lgkmcnt(4)
 ds_read_b64_tr_b16 a[240:241], v7 offset:59392
 ds_read_b64_tr_b16 a[242:243], v7 offset:59648
 v_mfma_f32_16x16x32_bf16 v[112:115], a[252:255], a[112:115], v[112:115]
 v_mfma_f32_16x16x32_bf16 v[116:119], a[248:251], a[100:103], v[116:119]
 buffer_load_dwordx4 a[220:223], v2, s[36:39], s54 offen offset:3072 sc1
 v_mfma_f32_16x16x32_bf16 v[116:119], a[252:255], a[116:119], v[116:119]
 v_mfma_f32_16x16x32_bf16 v[120:123], a[248:251], a[104:107], v[120:123]
 ds_read_b64_tr_b16 a[244:245], v7 offset:63488
 ds_read_b64_tr_b16 a[246:247], v7 offset:63744
 v_mfma_f32_16x16x32_bf16 v[120:123], a[252:255], a[120:123], v[120:123]
 v_mfma_f32_16x16x32_bf16 v[124:127], a[248:251], a[108:111], v[124:127]
 v_mfma_f32_16x16x32_bf16 v[124:127], a[252:255], a[124:127], v[124:127]
 s_waitcnt lgkmcnt(4)
 v_mfma_f32_16x16x32_bf16 v[128:131], a[232:235], a[96:99], v[128:131]
 s_add_u32 s54, s52, 0xe000
 ds_read_b64_tr_b16 a[248:249], v10
 ds_read_b64_tr_b16 a[250:251], v10 offset:256
 v_mfma_f32_16x16x32_bf16 v[128:131], a[236:239], a[112:115], v[128:131]
 s_add_u32 m0, s48, 0x1a000
 buffer_load_dwordx4 a[224:227], v2, s[36:39], s54 offen sc1
 v_mfma_f32_16x16x32_bf16 v[132:135], a[232:235], a[100:103], v[132:135]
 s_add_u32 s53, s49, 0x240040
 buffer_load_dwordx4 v4, s[32:35], s53 offen lds
 v_mfma_f32_16x16x32_bf16 v[132:135], a[236:239], a[116:119], v[132:135]
 v_mfma_f32_16x16x32_bf16 v[136:139], a[232:235], a[104:107], v[136:139]
 ds_read_b64_tr_b16 a[252:253], v10 offset:4096
 ds_read_b64_tr_b16 a[254:255], v10 offset:4352
 v_mfma_f32_16x16x32_bf16 v[136:139], a[236:239], a[120:123], v[136:139]
 v_mfma_f32_16x16x32_bf16 v[140:143], a[232:235], a[108:111], v[140:143]
 buffer_load_dwordx4 a[228:231], v2, s[36:39], s54 offen offset:1024 sc1
 v_mfma_f32_16x16x32_bf16 v[140:143], a[236:239], a[124:127], v[140:143]
 s_waitcnt lgkmcnt(6)
 v_mfma_f32_16x16x32_bf16 v[144:147], a[240:243], a[96:99], v[144:147]
 s_waitcnt lgkmcnt(4)
 ds_read_b64_tr_b16 a[232:233], v11
 ds_read_b64_tr_b16 a[234:235], v11 offset:256
 v_mfma_f32_16x16x32_bf16 v[144:147], a[244:247], a[112:115], v[144:147]
 v_mfma_f32_16x16x32_bf16 v[148:151], a[240:243], a[100:103], v[148:151]
 v_mfma_f32_16x16x32_bf16 v[148:151], a[244:247], a[116:119], v[148:151]
 v_mfma_f32_16x16x32_bf16 v[152:155], a[240:243], a[104:107], v[152:155]
 ds_read_b64_tr_b16 a[236:237], v11 offset:4096
 ds_read_b64_tr_b16 a[238:239], v11 offset:4352
 v_mfma_f32_16x16x32_bf16 v[152:155], a[244:247], a[120:123], v[152:155]
 buffer_load_dwordx4 v[160:163], v2, s[36:39], s54 offen offset:2048 sc1
 v_mfma_f32_16x16x32_bf16 v[156:159], a[240:243], a[108:111], v[156:159]
 v_mfma_f32_16x16x32_bf16 v[156:159], a[244:247], a[124:127], v[156:159]
 s_waitcnt vmcnt(31) lgkmcnt(6)
 v_mfma_f32_16x16x32_bf16 v[32:35], a[248:251], a[128:131], v[32:35]
 s_waitcnt vmcnt(26) lgkmcnt(4)
 ds_read_b64_tr_b16 a[240:241], v10 offset:2048
 ds_read_b64_tr_b16 a[242:243], v10 offset:2304
 v_mfma_f32_16x16x32_bf16 v[32:35], a[252:255], a[144:147], v[32:35]
 s_add_u32 m0, s48, 0x1b000
 v_mfma_f32_16x16x32_bf16 v[36:39], a[248:251], a[132:135], v[36:39]
 s_add_u32 s53, s49, 0x288040
 buffer_load_dwordx4 v4, s[32:35], s53 offen lds
 v_mfma_f32_16x16x32_bf16 v[36:39], a[252:255], a[148:151], v[36:39]
 buffer_load_dwordx4 v[164:167], v2, s[36:39], s54 offen offset:3072 sc1
 v_mfma_f32_16x16x32_bf16 v[40:43], a[248:251], a[136:139], v[40:43]
 s_waitcnt vmcnt(27)
 ds_read_b64_tr_b16 a[244:245], v10 offset:6144
 ds_read_b64_tr_b16 a[246:247], v10 offset:6400
 v_mfma_f32_16x16x32_bf16 v[40:43], a[252:255], a[152:155], v[40:43]
 v_mfma_f32_16x16x32_bf16 v[44:47], a[248:251], a[140:143], v[44:47]
 s_waitcnt vmcnt(26)
 v_mfma_f32_16x16x32_bf16 v[44:47], a[252:255], a[156:159], v[44:47]
 s_waitcnt lgkmcnt(4)
 v_mfma_f32_16x16x32_bf16 v[48:51], a[232:235], a[128:131], v[48:51]
 s_add_u32 s54, s52, 0xf000
 ds_read_b64_tr_b16 a[248:249], v11 offset:2048
 ds_read_b64_tr_b16 a[250:251], v11 offset:2304
 v_mfma_f32_16x16x32_bf16 v[48:51], a[236:239], a[144:147], v[48:51]
 buffer_load_dwordx4 v[168:171], v2, s[36:39], s54 offen sc1
 v_mfma_f32_16x16x32_bf16 v[52:55], a[232:235], a[132:135], v[52:55]
 v_mfma_f32_16x16x32_bf16 v[52:55], a[236:239], a[148:151], v[52:55]
 v_mfma_f32_16x16x32_bf16 v[56:59], a[232:235], a[136:139], v[56:59]
 ds_read_b64_tr_b16 a[252:253], v11 offset:6144
 ds_read_b64_tr_b16 a[254:255], v11 offset:6400
 v_mfma_f32_16x16x32_bf16 v[56:59], a[236:239], a[152:155], v[56:59]
 v_mfma_f32_16x16x32_bf16 v[60:63], a[232:235], a[140:143], v[60:63]
 buffer_load_dwordx4 v[172:175], v2, s[36:39], s54 offen offset:1024 sc1
 v_mfma_f32_16x16x32_bf16 v[60:63], a[236:239], a[156:159], v[60:63]
 s_waitcnt lgkmcnt(6)
 v_mfma_f32_16x16x32_bf16 v[64:67], a[240:243], a[128:131], v[64:67]
 s_waitcnt lgkmcnt(4)
 ds_read_b64_tr_b16 a[232:233], v10 offset:8192
 ds_read_b64_tr_b16 a[234:235], v10 offset:8448
 v_mfma_f32_16x16x32_bf16 v[64:67], a[244:247], a[144:147], v[64:67]
 s_add_u32 m0, s48, 0x1c000
 v_mfma_f32_16x16x32_bf16 v[68:71], a[240:243], a[132:135], v[68:71]
 s_add_u32 s53, s49, 0x2d0040
 buffer_load_dwordx4 v4, s[32:35], s53 offen lds
 v_mfma_f32_16x16x32_bf16 v[68:71], a[244:247], a[148:151], v[68:71]
 v_mfma_f32_16x16x32_bf16 v[72:75], a[240:243], a[136:139], v[72:75]
 ds_read_b64_tr_b16 a[236:237], v10 offset:12288
 ds_read_b64_tr_b16 a[238:239], v10 offset:12544
 v_mfma_f32_16x16x32_bf16 v[72:75], a[244:247], a[152:155], v[72:75]
 buffer_load_dwordx4 v[176:179], v2, s[36:39], s54 offen offset:2048 sc1
 v_mfma_f32_16x16x32_bf16 v[76:79], a[240:243], a[140:143], v[76:79]
 v_mfma_f32_16x16x32_bf16 v[76:79], a[244:247], a[156:159], v[76:79]
 s_waitcnt lgkmcnt(6)
 v_mfma_f32_16x16x32_bf16 v[80:83], a[248:251], a[128:131], v[80:83]
 s_waitcnt lgkmcnt(4)
 ds_read_b64_tr_b16 a[240:241], v11 offset:8192
 ds_read_b64_tr_b16 a[242:243], v11 offset:8448
 v_mfma_f32_16x16x32_bf16 v[80:83], a[252:255], a[144:147], v[80:83]
 v_mfma_f32_16x16x32_bf16 v[84:87], a[248:251], a[132:135], v[84:87]
 buffer_load_dwordx4 v[180:183], v2, s[36:39], s54 offen offset:3072 sc1
 v_mfma_f32_16x16x32_bf16 v[84:87], a[252:255], a[148:151], v[84:87]
 v_mfma_f32_16x16x32_bf16 v[88:91], a[248:251], a[136:139], v[88:91]
 ds_read_b64_tr_b16 a[244:245], v11 offset:12288
 ds_read_b64_tr_b16 a[246:247], v11 offset:12544
 v_mfma_f32_16x16x32_bf16 v[88:91], a[252:255], a[152:155], v[88:91]
 v_mfma_f32_16x16x32_bf16 v[92:95], a[248:251], a[140:143], v[92:95]
 v_mfma_f32_16x16x32_bf16 v[92:95], a[252:255], a[156:159], v[92:95]
 s_waitcnt vmcnt(26) lgkmcnt(4)
 v_mfma_f32_16x16x32_bf16 v[32:35], a[232:235], a[160:163], v[32:35]
 s_add_u32 s54, s52, 0x10000
 ds_read_b64_tr_b16 a[248:249], v10 offset:10240
 ds_read_b64_tr_b16 a[250:251], v10 offset:10496
 v_mfma_f32_16x16x32_bf16 v[32:35], a[236:239], a[176:179], v[32:35]
 s_add_u32 m0, s48, 0x1d000
 buffer_load_dwordx4 v[184:187], v2, s[36:39], s54 offen sc1
 v_mfma_f32_16x16x32_bf16 v[36:39], a[232:235], a[164:167], v[36:39]
 s_waitcnt vmcnt(26)
 s_add_u32 s53, s49, 0x318040
 buffer_load_dwordx4 v4, s[32:35], s53 offen lds
 v_mfma_f32_16x16x32_bf16 v[36:39], a[236:239], a[180:183], v[36:39]
 v_mfma_f32_16x16x32_bf16 v[40:43], a[232:235], a[168:171], v[40:43]
 s_waitcnt vmcnt(25)
 ds_read_b64_tr_b16 a[252:253], v10 offset:14336
 ds_read_b64_tr_b16 a[254:255], v10 offset:14592
 v_mfma_f32_16x16x32_bf16 v[40:43], a[236:239], a[184:187], v[40:43]
 v_mfma_f32_16x16x32_bf16 v[44:47], a[232:235], a[172:175], v[44:47]
 s_waitcnt vmcnt(24)
 buffer_load_dwordx4 v[188:191], v2, s[36:39], s54 offen offset:1024 sc1
 v_mfma_f32_16x16x32_bf16 v[44:47], a[236:239], a[188:191], v[44:47]
 s_waitcnt lgkmcnt(6)
 v_mfma_f32_16x16x32_bf16 v[48:51], a[240:243], a[160:163], v[48:51]
 s_waitcnt lgkmcnt(4)
 ds_read_b64_tr_b16 a[232:233], v11 offset:10240
 ds_read_b64_tr_b16 a[234:235], v11 offset:10496
 v_mfma_f32_16x16x32_bf16 v[48:51], a[244:247], a[176:179], v[48:51]
 v_mfma_f32_16x16x32_bf16 v[52:55], a[240:243], a[164:167], v[52:55]
 v_mfma_f32_16x16x32_bf16 v[52:55], a[244:247], a[180:183], v[52:55]
 v_mfma_f32_16x16x32_bf16 v[56:59], a[240:243], a[168:171], v[56:59]
 ds_read_b64_tr_b16 a[236:237], v11 offset:14336
 ds_read_b64_tr_b16 a[238:239], v11 offset:14592
 v_mfma_f32_16x16x32_bf16 v[56:59], a[244:247], a[184:187], v[56:59]
 buffer_load_dwordx4 v[192:195], v2, s[36:39], s54 offen offset:2048 sc1
 v_mfma_f32_16x16x32_bf16 v[60:63], a[240:243], a[172:175], v[60:63]
 v_mfma_f32_16x16x32_bf16 v[60:63], a[244:247], a[188:191], v[60:63]
 s_waitcnt lgkmcnt(6)
 v_mfma_f32_16x16x32_bf16 v[64:67], a[248:251], a[160:163], v[64:67]
 s_waitcnt lgkmcnt(4)
 ds_read_b64_tr_b16 a[240:241], v10 offset:16384
 ds_read_b64_tr_b16 a[242:243], v10 offset:16640
 v_mfma_f32_16x16x32_bf16 v[64:67], a[252:255], a[176:179], v[64:67]
 s_add_u32 m0, s48, 0x1e000
 v_mfma_f32_16x16x32_bf16 v[68:71], a[248:251], a[164:167], v[68:71]
 s_add_u32 s53, s49, 0x360040
 buffer_load_dwordx4 v4, s[32:35], s53 offen lds
 v_mfma_f32_16x16x32_bf16 v[68:71], a[252:255], a[180:183], v[68:71]
 buffer_load_dwordx4 v[196:199], v2, s[36:39], s54 offen offset:3072 sc1
 v_mfma_f32_16x16x32_bf16 v[72:75], a[248:251], a[168:171], v[72:75]
 ds_read_b64_tr_b16 a[244:245], v10 offset:20480
 ds_read_b64_tr_b16 a[246:247], v10 offset:20736
 v_mfma_f32_16x16x32_bf16 v[72:75], a[252:255], a[184:187], v[72:75]
 v_mfma_f32_16x16x32_bf16 v[76:79], a[248:251], a[172:175], v[76:79]
 v_mfma_f32_16x16x32_bf16 v[76:79], a[252:255], a[188:191], v[76:79]
 s_waitcnt lgkmcnt(4)
 v_mfma_f32_16x16x32_bf16 v[80:83], a[232:235], a[160:163], v[80:83]
 s_add_u32 s54, s52, 0x11000
 ds_read_b64_tr_b16 a[248:249], v11 offset:16384
 ds_read_b64_tr_b16 a[250:251], v11 offset:16640
 v_mfma_f32_16x16x32_bf16 v[80:83], a[236:239], a[176:179], v[80:83]
 buffer_load_dwordx4 v[200:203], v2, s[36:39], s54 offen sc1
 v_mfma_f32_16x16x32_bf16 v[84:87], a[232:235], a[164:167], v[84:87]
 v_mfma_f32_16x16x32_bf16 v[84:87], a[236:239], a[180:183], v[84:87]
 v_mfma_f32_16x16x32_bf16 v[88:91], a[232:235], a[168:171], v[88:91]
 ds_read_b64_tr_b16 a[252:253], v11 offset:20480
 ds_read_b64_tr_b16 a[254:255], v11 offset:20736
 v_mfma_f32_16x16x32_bf16 v[88:91], a[236:239], a[184:187], v[88:91]
 v_mfma_f32_16x16x32_bf16 v[92:95], a[232:235], a[172:175], v[92:95]
 buffer_load_dwordx4 v[204:207], v2, s[36:39], s54 offen offset:1024 sc1
 v_mfma_f32_16x16x32_bf16 v[92:95], a[236:239], a[188:191], v[92:95]
 s_waitcnt vmcnt(29) lgkmcnt(6)
 v_mfma_f32_16x16x32_bf16 v[32:35], a[240:243], a[192:195], v[32:35]
 s_waitcnt vmcnt(22) lgkmcnt(4)
 ds_read_b64_tr_b16 a[232:233], v10 offset:18432
 ds_read_b64_tr_b16 a[234:235], v10 offset:18688
 v_mfma_f32_16x16x32_bf16 v[32:35], a[244:247], a[208:211], v[32:35]
 s_add_u32 m0, s48, 0x1f000
 v_mfma_f32_16x16x32_bf16 v[36:39], a[240:243], a[196:199], v[36:39]
 s_add_u32 s53, s49, 0x3a8040
 buffer_load_dwordx4 v4, s[32:35], s53 offen lds
 v_mfma_f32_16x16x32_bf16 v[36:39], a[244:247], a[212:215], v[36:39]
 v_mfma_f32_16x16x32_bf16 v[40:43], a[240:243], a[200:203], v[40:43]
 s_waitcnt vmcnt(21)
 ds_read_b64_tr_b16 a[236:237], v10 offset:22528
 ds_read_b64_tr_b16 a[238:239], v10 offset:22784
 v_mfma_f32_16x16x32_bf16 v[40:43], a[244:247], a[216:219], v[40:43]
 buffer_load_dwordx4 v[208:211], v2, s[36:39], s54 offen offset:2048 sc1
 v_mfma_f32_16x16x32_bf16 v[44:47], a[240:243], a[204:207], v[44:47]
 s_waitcnt vmcnt(21)
 v_mfma_f32_16x16x32_bf16 v[44:47], a[244:247], a[220:223], v[44:47]
 s_waitcnt lgkmcnt(6)
 v_mfma_f32_16x16x32_bf16 v[48:51], a[248:251], a[192:195], v[48:51]
 s_waitcnt lgkmcnt(4)
 ds_read_b64_tr_b16 a[240:241], v11 offset:18432
 ds_read_b64_tr_b16 a[242:243], v11 offset:18688
 v_mfma_f32_16x16x32_bf16 v[48:51], a[252:255], a[208:211], v[48:51]
 v_mfma_f32_16x16x32_bf16 v[52:55], a[248:251], a[196:199], v[52:55]
 buffer_load_dwordx4 v[212:215], v2, s[36:39], s54 offen offset:3072 sc1
 v_mfma_f32_16x16x32_bf16 v[52:55], a[252:255], a[212:215], v[52:55]
 v_mfma_f32_16x16x32_bf16 v[56:59], a[248:251], a[200:203], v[56:59]
 ds_read_b64_tr_b16 a[244:245], v11 offset:22528
 ds_read_b64_tr_b16 a[246:247], v11 offset:22784
 v_mfma_f32_16x16x32_bf16 v[56:59], a[252:255], a[216:219], v[56:59]
 v_mfma_f32_16x16x32_bf16 v[60:63], a[248:251], a[204:207], v[60:63]
 s_waitcnt vmcnt(17)
 v_mfma_f32_16x16x32_bf16 v[60:63], a[252:255], a[220:223], v[60:63]
 s_barrier
 s_waitcnt lgkmcnt(6)
 v_mfma_f32_16x16x32_bf16 v[64:67], a[232:235], a[192:195], v[64:67]
 s_waitcnt lgkmcnt(4)
 ds_read_b64_tr_b16 a[248:249], v10 offset:24576
 ds_read_b64_tr_b16 a[250:251], v10 offset:24832
 v_mfma_f32_16x16x32_bf16 v[64:67], a[236:239], a[208:211], v[64:67]
 s_add_u32 m0, s48, 0
 v_mfma_f32_16x16x32_bf16 v[68:71], a[232:235], a[196:199], v[68:71]
 s_add_u32 s53, s49, 0x3f0040
 buffer_load_dwordx4 v4, s[32:35], s53 offen lds
 v_mfma_f32_16x16x32_bf16 v[68:71], a[236:239], a[212:215], v[68:71]
 v_mfma_f32_16x16x32_bf16 v[72:75], a[232:235], a[200:203], v[72:75]
 ds_read_b64_tr_b16 a[252:253], v10 offset:28672
 ds_read_b64_tr_b16 a[254:255], v10 offset:28928
 v_mfma_f32_16x16x32_bf16 v[72:75], a[236:239], a[216:219], v[72:75]
 s_waitcnt lgkmcnt(6)
 v_mfma_f32_16x16x32_bf16 v[76:79], a[232:235], a[204:207], v[76:79]
 s_add_u32 m0, s48, 0x1000
 v_mfma_f32_16x16x32_bf16 v[76:79], a[236:239], a[220:223], v[76:79]
 s_add_u32 s53, s49, 0x438040
 buffer_load_dwordx4 v4, s[32:35], s53 offen lds
 v_mfma_f32_16x16x32_bf16 v[80:83], a[240:243], a[192:195], v[80:83]
 s_waitcnt lgkmcnt(4)
 ds_read_b64_tr_b16 a[232:233], v11 offset:24576
 ds_read_b64_tr_b16 a[234:235], v11 offset:24832
 v_mfma_f32_16x16x32_bf16 v[80:83], a[244:247], a[208:211], v[80:83]
 v_mfma_f32_16x16x32_bf16 v[84:87], a[240:243], a[196:199], v[84:87]
 v_mfma_f32_16x16x32_bf16 v[84:87], a[244:247], a[212:215], v[84:87]
 v_mfma_f32_16x16x32_bf16 v[88:91], a[240:243], a[200:203], v[88:91]
 ds_read_b64_tr_b16 a[236:237], v11 offset:28672
 ds_read_b64_tr_b16 a[238:239], v11 offset:28928
 v_mfma_f32_16x16x32_bf16 v[88:91], a[244:247], a[216:219], v[88:91]
 v_mfma_f32_16x16x32_bf16 v[92:95], a[240:243], a[204:207], v[92:95]
 v_mfma_f32_16x16x32_bf16 v[92:95], a[244:247], a[220:223], v[92:95]
 s_waitcnt lgkmcnt(6)
 v_mfma_f32_16x16x32_bf16 v[32:35], a[248:251], a[224:227], v[32:35]
 s_waitcnt vmcnt(16) lgkmcnt(4)
 ds_read_b64_tr_b16 a[240:241], v10 offset:26624
 ds_read_b64_tr_b16 a[242:243], v10 offset:26880
 v_mfma_f32_16x16x32_bf16 v[32:35], a[252:255], v[168:171], v[32:35]
 s_add_u32 m0, s48, 0x2000
 v_mfma_f32_16x16x32_bf16 v[36:39], a[248:251], a[228:231], v[36:39]
 s_add_u32 s53, s49, 0x480040
 buffer_load_dwordx4 v4, s[32:35], s53 offen lds
 v_mfma_f32_16x16x32_bf16 v[36:39], a[252:255], v[172:175], v[36:39]
 v_mfma_f32_16x16x32_bf16 v[40:43], a[248:251], v[160:163], v[40:43]
 s_waitcnt vmcnt(15)
 ds_read_b64_tr_b16 a[244:245], v10 offset:30720
 ds_read_b64_tr_b16 a[246:247], v10 offset:30976
 v_mfma_f32_16x16x32_bf16 v[40:43], a[252:255], v[176:179], v[40:43]
 s_waitcnt vmcnt(14) lgkmcnt(6)
 v_mfma_f32_16x16x32_bf16 v[44:47], a[248:251], v[164:167], v[44:47]
 s_add_u32 m0, s48, 0x3000
 v_mfma_f32_16x16x32_bf16 v[44:47], a[252:255], v[180:183], v[44:47]
 s_add_u32 s53, s49, 0x4c8040
 buffer_load_dwordx4 v4, s[32:35], s53 offen lds
 v_mfma_f32_16x16x32_bf16 v[48:51], a[232:235], a[224:227], v[48:51]
 s_waitcnt lgkmcnt(4)
 ds_read_b64_tr_b16 a[248:249], v11 offset:26624
 ds_read_b64_tr_b16 a[250:251], v11 offset:26880
 v_mfma_f32_16x16x32_bf16 v[48:51], a[236:239], v[168:171], v[48:51]
 v_mfma_f32_16x16x32_bf16 v[52:55], a[232:235], a[228:231], v[52:55]
 v_mfma_f32_16x16x32_bf16 v[52:55], a[236:239], v[172:175], v[52:55]
 v_mfma_f32_16x16x32_bf16 v[56:59], a[232:235], v[160:163], v[56:59]
 ds_read_b64_tr_b16 a[252:253], v11 offset:30720
 ds_read_b64_tr_b16 a[254:255], v11 offset:30976
 v_mfma_f32_16x16x32_bf16 v[56:59], a[236:239], v[176:179], v[56:59]
 v_mfma_f32_16x16x32_bf16 v[60:63], a[232:235], v[164:167], v[60:63]
 v_mfma_f32_16x16x32_bf16 v[60:63], a[236:239], v[180:183], v[60:63]
 s_waitcnt lgkmcnt(6)
 v_mfma_f32_16x16x32_bf16 v[64:67], a[240:243], a[224:227], v[64:67]
 s_waitcnt lgkmcnt(4)
 ds_read_b64_tr_b16 a[232:233], v10 offset:32768
 ds_read_b64_tr_b16 a[234:235], v10 offset:33024
 v_mfma_f32_16x16x32_bf16 v[64:67], a[244:247], v[168:171], v[64:67]
 s_add_u32 m0, s48, 0x4000
 v_mfma_f32_16x16x32_bf16 v[68:71], a[240:243], a[228:231], v[68:71]
 s_add_u32 s53, s49, 0x80
 buffer_load_dwordx4 v4, s[32:35], s53 offen lds
 v_mfma_f32_16x16x32_bf16 v[68:71], a[244:247], v[172:175], v[68:71]
 v_mfma_f32_16x16x32_bf16 v[72:75], a[240:243], v[160:163], v[72:75]
 ds_read_b64_tr_b16 a[236:237], v10 offset:36864
 ds_read_b64_tr_b16 a[238:239], v10 offset:37120
 v_mfma_f32_16x16x32_bf16 v[72:75], a[244:247], v[176:179], v[72:75]
 s_waitcnt lgkmcnt(6)
 v_mfma_f32_16x16x32_bf16 v[76:79], a[240:243], v[164:167], v[76:79]
 s_add_u32 m0, s48, 0x5000
 v_mfma_f32_16x16x32_bf16 v[76:79], a[244:247], v[180:183], v[76:79]
 s_add_u32 s53, s49, 0x48080
 buffer_load_dwordx4 v4, s[32:35], s53 offen lds
 v_mfma_f32_16x16x32_bf16 v[80:83], a[248:251], a[224:227], v[80:83]
 s_waitcnt lgkmcnt(4)
 ds_read_b64_tr_b16 a[240:241], v11 offset:32768
 ds_read_b64_tr_b16 a[242:243], v11 offset:33024
 v_mfma_f32_16x16x32_bf16 v[80:83], a[252:255], v[168:171], v[80:83]
 v_mfma_f32_16x16x32_bf16 v[84:87], a[248:251], a[228:231], v[84:87]
 v_mfma_f32_16x16x32_bf16 v[84:87], a[252:255], v[172:175], v[84:87]
 v_mfma_f32_16x16x32_bf16 v[88:91], a[248:251], v[160:163], v[88:91]
 ds_read_b64_tr_b16 a[244:245], v11 offset:36864
 ds_read_b64_tr_b16 a[246:247], v11 offset:37120
 v_mfma_f32_16x16x32_bf16 v[88:91], a[252:255], v[176:179], v[88:91]
 v_mfma_f32_16x16x32_bf16 v[92:95], a[248:251], v[164:167], v[92:95]
 v_mfma_f32_16x16x32_bf16 v[92:95], a[252:255], v[180:183], v[92:95]
 s_waitcnt vmcnt(16) lgkmcnt(6)
 v_mfma_f32_16x16x32_bf16 v[32:35], a[232:235], v[184:187], v[32:35]
 s_waitcnt vmcnt(9) lgkmcnt(4)
 ds_read_b64_tr_b16 a[248:249], v10 offset:34816
 ds_read_b64_tr_b16 a[250:251], v10 offset:35072
 v_mfma_f32_16x16x32_bf16 v[32:35], a[236:239], v[200:203], v[32:35]
 s_add_u32 m0, s48, 0x6000
 v_mfma_f32_16x16x32_bf16 v[36:39], a[232:235], v[188:191], v[36:39]
 s_add_u32 s53, s49, 0x90080
 buffer_load_dwordx4 v4, s[32:35], s53 offen lds
 v_mfma_f32_16x16x32_bf16 v[36:39], a[236:239], v[204:207], v[36:39]
 v_mfma_f32_16x16x32_bf16 v[40:43], a[232:235], v[192:195], v[40:43]
 s_waitcnt vmcnt(8)
 ds_read_b64_tr_b16 a[252:253], v10 offset:38912
 ds_read_b64_tr_b16 a[254:255], v10 offset:39168
 v_mfma_f32_16x16x32_bf16 v[40:43], a[236:239], v[208:211], v[40:43]
 s_waitcnt vmcnt(7) lgkmcnt(6)
 v_mfma_f32_16x16x32_bf16 v[44:47], a[232:235], v[196:199], v[44:47]
 s_add_u32 m0, s48, 0x7000
 v_mfma_f32_16x16x32_bf16 v[44:47], a[236:239], v[212:215], v[44:47]
 s_add_u32 s53, s49, 0xd8080
 buffer_load_dwordx4 v4, s[32:35], s53 offen lds
 v_mfma_f32_16x16x32_bf16 v[48:51], a[240:243], v[184:187], v[48:51]
 s_waitcnt lgkmcnt(4)
 ds_read_b64_tr_b16 a[232:233], v11 offset:34816
 ds_read_b64_tr_b16 a[234:235], v11 offset:35072
 v_mfma_f32_16x16x32_bf16 v[48:51], a[244:247], v[200:203], v[48:51]
 v_mfma_f32_16x16x32_bf16 v[52:55], a[240:243], v[188:191], v[52:55]
 v_mfma_f32_16x16x32_bf16 v[52:55], a[244:247], v[204:207], v[52:55]
 v_mfma_f32_16x16x32_bf16 v[56:59], a[240:243], v[192:195], v[56:59]
 ds_read_b64_tr_b16 a[236:237], v11 offset:38912
 ds_read_b64_tr_b16 a[238:239], v11 offset:39168
 v_mfma_f32_16x16x32_bf16 v[56:59], a[244:247], v[208:211], v[56:59]
 v_mfma_f32_16x16x32_bf16 v[60:63], a[240:243], v[196:199], v[60:63]
 v_mfma_f32_16x16x32_bf16 v[60:63], a[244:247], v[212:215], v[60:63]
 s_waitcnt lgkmcnt(6)
 v_mfma_f32_16x16x32_bf16 v[64:67], a[248:251], v[184:187], v[64:67]
 s_waitcnt lgkmcnt(4)
 ds_read_b64_tr_b16 a[240:241], v10 offset:40960
 ds_read_b64_tr_b16 a[242:243], v10 offset:41216
 v_mfma_f32_16x16x32_bf16 v[64:67], a[252:255], v[200:203], v[64:67]
 s_add_u32 m0, s48, 0x8000
 v_mfma_f32_16x16x32_bf16 v[68:71], a[248:251], v[188:191], v[68:71]
 s_add_u32 s53, s49, 0x120080
 buffer_load_dwordx4 v4, s[32:35], s53 offen lds
 v_mfma_f32_16x16x32_bf16 v[68:71], a[252:255], v[204:207], v[68:71]
 v_mfma_f32_16x16x32_bf16 v[72:75], a[248:251], v[192:195], v[72:75]
 ds_read_b64_tr_b16 a[244:245], v10 offset:45056
 ds_read_b64_tr_b16 a[246:247], v10 offset:45312
 v_mfma_f32_16x16x32_bf16 v[72:75], a[252:255], v[208:211], v[72:75]
 s_waitcnt lgkmcnt(6)
 v_mfma_f32_16x16x32_bf16 v[76:79], a[248:251], v[196:199], v[76:79]
 s_add_u32 m0, s48, 0x9000
 v_mfma_f32_16x16x32_bf16 v[76:79], a[252:255], v[212:215], v[76:79]
 s_add_u32 s53, s49, 0x168080
 buffer_load_dwordx4 v4, s[32:35], s53 offen lds
 v_mfma_f32_16x16x32_bf16 v[80:83], a[232:235], v[184:187], v[80:83]
 s_waitcnt lgkmcnt(4)
 ds_read_b64_tr_b16 a[248:249], v11 offset:40960
 ds_read_b64_tr_b16 a[250:251], v11 offset:41216
 v_mfma_f32_16x16x32_bf16 v[80:83], a[236:239], v[200:203], v[80:83]
 v_mfma_f32_16x16x32_bf16 v[84:87], a[232:235], v[188:191], v[84:87]
 v_mfma_f32_16x16x32_bf16 v[84:87], a[236:239], v[204:207], v[84:87]
 v_mfma_f32_16x16x32_bf16 v[88:91], a[232:235], v[192:195], v[88:91]
 ds_read_b64_tr_b16 a[252:253], v11 offset:45056
 ds_read_b64_tr_b16 a[254:255], v11 offset:45312
 v_mfma_f32_16x16x32_bf16 v[88:91], a[236:239], v[208:211], v[88:91]
 v_mfma_f32_16x16x32_bf16 v[92:95], a[232:235], v[196:199], v[92:95]
 v_mfma_f32_16x16x32_bf16 v[92:95], a[236:239], v[212:215], v[92:95]
 s_waitcnt lgkmcnt(6)
 v_mfma_f32_16x16x32_bf16 v[96:99], a[240:243], a[128:131], v[96:99]
 s_waitcnt lgkmcnt(4)
 ds_read_b64_tr_b16 a[232:233], v10 offset:43008
 ds_read_b64_tr_b16 a[234:235], v10 offset:43264
 v_mfma_f32_16x16x32_bf16 v[96:99], a[244:247], a[144:147], v[96:99]
 s_add_u32 m0, s48, 0xa000
 v_mfma_f32_16x16x32_bf16 v[100:103], a[240:243], a[132:135], v[100:103]
 s_add_u32 s53, s49, 0x1b0080
 buffer_load_dwordx4 v4, s[32:35], s53 offen lds
 v_mfma_f32_16x16x32_bf16 v[100:103], a[244:247], a[148:151], v[100:103]
 v_mul_f32 v224, v32, v32
 v_fmaak_f32 v224, v224, v223, 0xc0135761
 v_mfma_f32_16x16x32_bf16 v[104:107], a[240:243], a[136:139], v[104:107]
 ds_read_b64_tr_b16 a[236:237], v10 offset:47104
 ds_read_b64_tr_b16 a[238:239], v10 offset:47360
 v_mfma_f32_16x16x32_bf16 v[104:107], a[244:247], a[152:155], v[104:107]
 s_waitcnt lgkmcnt(6)
 v_mul_f32 v224, v224, v32
 v_mul_f32 v64, v32, v64
 v_mfma_f32_16x16x32_bf16 v[108:111], a[240:243], a[140:143], v[108:111]
 s_add_u32 m0, s48, 0xb000
 v_exp_f32 v224, v224
 v_mfma_f32_16x16x32_bf16 v[108:111], a[244:247], a[156:159], v[108:111]
 s_add_u32 s53, s49, 0x1f8080
 buffer_load_dwordx4 v4, s[32:35], s53 offen lds
 v_mfma_f32_16x16x32_bf16 v[112:115], a[248:251], a[128:131], v[112:115]
 s_waitcnt lgkmcnt(4)
 ds_read_b64_tr_b16 a[240:241], v11 offset:43008
 ds_read_b64_tr_b16 a[242:243], v11 offset:43264
 v_mfma_f32_16x16x32_bf16 v[112:115], a[252:255], a[144:147], v[112:115]
 v_add_f32 v224, 1.0, v224
 v_mul_f32 v225, v33, v33
 v_mfma_f32_16x16x32_bf16 v[116:119], a[248:251], a[132:135], v[116:119]
 v_rcp_f32 v224, v224
 v_mfma_f32_16x16x32_bf16 v[116:119], a[252:255], a[148:151], v[116:119]
 v_mul_f32 v64, v64, v224
 v_fmaak_f32 v225, v225, v223, 0xc0135761
 v_mfma_f32_16x16x32_bf16 v[120:123], a[248:251], a[136:139], v[120:123]
 ds_read_b64_tr_b16 a[244:245], v11 offset:47104
 ds_read_b64_tr_b16 a[246:247], v11 offset:47360
 v_mfma_f32_16x16x32_bf16 v[120:123], a[252:255], a[152:155], v[120:123]
 v_mul_f32 v225, v225, v33
 v_mul_f32 v65, v33, v65
 v_mfma_f32_16x16x32_bf16 v[124:127], a[248:251], a[140:143], v[124:127]
 s_waitcnt vmcnt(6)
 v_exp_f32 v225, v225
 v_mfma_f32_16x16x32_bf16 v[124:127], a[252:255], a[156:159], v[124:127]
 s_barrier
 v_add_f32 v225, 1.0, v225
 v_mul_f32 v226, v34, v34
 s_waitcnt lgkmcnt(6)
 v_mfma_f32_16x16x32_bf16 v[128:131], a[232:235], a[128:131], v[128:131]
 s_waitcnt lgkmcnt(4)
 ds_read_b64_tr_b16 a[248:249], v10 offset:49152
 ds_read_b64_tr_b16 a[250:251], v10 offset:49408
 v_mfma_f32_16x16x32_bf16 v[128:131], a[236:239], a[144:147], v[128:131]
 s_add_u32 m0, s48, 0xc000
 v_rcp_f32 v225, v225
 v_mfma_f32_16x16x32_bf16 v[132:135], a[232:235], a[132:135], v[132:135]
 s_add_u32 s53, s49, 0x240080
 buffer_load_dwordx4 v4, s[32:35], s53 offen lds
 v_mfma_f32_16x16x32_bf16 v[132:135], a[236:239], a[148:151], v[132:135]
 v_mul_f32 v65, v65, v225
 v_cvt_pk_bf16_f32 v240, v64, v65
 v_mfma_f32_16x16x32_bf16 v[136:139], a[232:235], a[136:139], v[136:139]
 ds_read_b64_tr_b16 a[252:253], v10 offset:53248
 ds_read_b64_tr_b16 a[254:255], v10 offset:53504
 v_mfma_f32_16x16x32_bf16 v[136:139], a[236:239], a[152:155], v[136:139]
 s_waitcnt lgkmcnt(6)
 v_fmaak_f32 v226, v226, v223, 0xc0135761
 v_mul_f32 v226, v226, v34
 v_mfma_f32_16x16x32_bf16 v[140:143], a[232:235], a[140:143], v[140:143]
 s_add_u32 m0, s48, 0xd000
 v_exp_f32 v226, v226
 v_mfma_f32_16x16x32_bf16 v[140:143], a[236:239], a[156:159], v[140:143]
 s_add_u32 s53, s49, 0x288080
 buffer_load_dwordx4 v4, s[32:35], s53 offen lds
 v_mfma_f32_16x16x32_bf16 v[144:147], a[240:243], a[128:131], v[144:147]
 s_waitcnt lgkmcnt(4)
 ds_read_b64_tr_b16 a[232:233], v11 offset:49152
 ds_read_b64_tr_b16 a[234:235], v11 offset:49408
 v_mfma_f32_16x16x32_bf16 v[144:147], a[244:247], a[144:147], v[144:147]
 v_mul_f32 v66, v34, v66
 v_add_f32 v226, 1.0, v226
 v_mfma_f32_16x16x32_bf16 v[148:151], a[240:243], a[132:135], v[148:151]
 v_rcp_f32 v226, v226
 v_mfma_f32_16x16x32_bf16 v[148:151], a[244:247], a[148:151], v[148:151]
 v_mul_f32 v66, v66, v226
 v_mul_f32 v227, v35, v35
 v_mfma_f32_16x16x32_bf16 v[152:155], a[240:243], a[136:139], v[152:155]
 ds_read_b64_tr_b16 a[236:237], v11 offset:53248
 ds_read_b64_tr_b16 a[238:239], v11 offset:53504
 v_mfma_f32_16x16x32_bf16 v[152:155], a[244:247], a[152:155], v[152:155]
 v_fmaak_f32 v227, v227, v223, 0xc0135761
 v_mul_f32 v227, v227, v35
 v_mfma_f32_16x16x32_bf16 v[156:159], a[240:243], a[140:143], v[156:159]
 v_exp_f32 v227, v227
 v_mfma_f32_16x16x32_bf16 v[156:159], a[244:247], a[156:159], v[156:159]
 s_waitcnt lgkmcnt(6)
 v_mul_f32 v67, v35, v67
 v_add_f32 v227, 1.0, v227
 v_mfma_f32_16x16x32_bf16 v[96:99], a[248:251], a[160:163], v[96:99]
 s_waitcnt lgkmcnt(4)
 ds_read_b64_tr_b16 a[240:241], v10 offset:51200
 ds_read_b64_tr_b16 a[242:243], v10 offset:51456
 v_mfma_f32_16x16x32_bf16 v[96:99], a[252:255], a[176:179], v[96:99]
 s_add_u32 m0, s48, 0xe000
 v_rcp_f32 v227, v227
 s_nop 0
 v_mul_f32 v67, v67, v227
 v_mfma_f32_16x16x32_bf16 v[100:103], a[248:251], a[164:167], v[100:103]
 s_add_u32 s53, s49, 0x2d0080
 buffer_load_dwordx4 v4, s[32:35], s53 offen lds
 v_cvt_pk_bf16_f32 v241, v66, v67
 v_mfma_f32_16x16x32_bf16 v[100:103], a[252:255], a[180:183], v[100:103]
 v_mul_f32 v228, v48, v48
 v_fmaak_f32 v228, v228, v223, 0xc0135761
 v_mfma_f32_16x16x32_bf16 v[104:107], a[248:251], a[168:171], v[104:107]
 s_add_u32 s55, s56, 0
 ds_read_b64_tr_b16 a[244:245], v10 offset:55296
 ds_read_b64_tr_b16 a[246:247], v10 offset:55552
 v_mul_f32 v228, v228, v48
 v_exp_f32 v228, v228
 v_mfma_f32_16x16x32_bf16 v[104:107], a[252:255], a[184:187], v[104:107]
 s_waitcnt lgkmcnt(6)
 v_mul_f32 v80, v48, v80
 v_add_f32 v228, 1.0, v228
 v_mfma_f32_16x16x32_bf16 v[108:111], a[248:251], a[172:175], v[108:111]
 s_add_u32 m0, s48, 0xf000
 v_rcp_f32 v228, v228
 s_nop 0
 v_mul_f32 v80, v80, v228
 v_mfma_f32_16x16x32_bf16 v[108:111], a[252:255], a[188:191], v[108:111]
 s_add_u32 s53, s49, 0x318080
 v_mul_f32 v229, v49, v49
 v_fmaak_f32 v229, v229, v223, 0xc0135761
 v_mfma_f32_16x16x32_bf16 v[112:115], a[232:235], a[160:163], v[112:115]
 s_waitcnt lgkmcnt(4)
 ds_read_b64_tr_b16 a[248:249], v11 offset:51200
 ds_read_b64_tr_b16 a[250:251], v11 offset:51456
 v_mul_f32 v229, v229, v49
 v_mfma_f32_16x16x32_bf16 v[112:115], a[236:239], a[176:179], v[112:115]
 v_exp_f32 v229, v229
 v_mul_f32 v81, v49, v81
 v_mfma_f32_16x16x32_bf16 v[116:119], a[232:235], a[164:167], v[116:119]
 v_add_f32 v229, 1.0, v229
 v_rcp_f32 v229, v229
 v_mfma_f32_16x16x32_bf16 v[116:119], a[236:239], a[180:183], v[116:119]
 v_mul_f32 v81, v81, v229
 v_cvt_pk_bf16_f32 v242, v80, v81
 v_mfma_f32_16x16x32_bf16 v[120:123], a[232:235], a[168:171], v[120:123]
 ds_read_b64_tr_b16 a[252:253], v11 offset:55296
 ds_read_b64_tr_b16 a[254:255], v11 offset:55552
 v_mul_f32 v230, v50, v50
 v_fmaak_f32 v230, v230, v223, 0xc0135761
 v_mfma_f32_16x16x32_bf16 v[120:123], a[236:239], a[184:187], v[120:123]
 v_mul_f32 v230, v230, v50
 v_mul_f32 v82, v50, v82
 v_mfma_f32_16x16x32_bf16 v[124:127], a[232:235], a[172:175], v[124:127]
 v_exp_f32 v230, v230
 v_mfma_f32_16x16x32_bf16 v[124:127], a[236:239], a[188:191], v[124:127]
 s_waitcnt lgkmcnt(6)
 v_add_f32 v230, 1.0, v230
 v_rcp_f32 v230, v230
 v_mfma_f32_16x16x32_bf16 v[128:131], a[240:243], a[160:163], v[128:131]
 s_waitcnt lgkmcnt(4)
 ds_read_b64_tr_b16 a[232:233], v10 offset:57344
 ds_read_b64_tr_b16 a[234:235], v10 offset:57600
 v_mul_f32 v82, v82, v230
 v_mul_f32 v231, v51, v51
 v_mfma_f32_16x16x32_bf16 v[128:131], a[244:247], a[176:179], v[128:131]
 v_fmaak_f32 v231, v231, v223, 0xc0135761
 v_mul_f32 v231, v231, v51
 v_mfma_f32_16x16x32_bf16 v[132:135], a[240:243], a[164:167], v[132:135]
 v_exp_f32 v231, v231
 v_mfma_f32_16x16x32_bf16 v[132:135], a[244:247], a[180:183], v[132:135]
 v_mul_f32 v83, v51, v83
 v_add_f32 v231, 1.0, v231
 v_mfma_f32_16x16x32_bf16 v[136:139], a[240:243], a[168:171], v[136:139]
 ds_read_b64_tr_b16 a[236:237], v10 offset:61440
 ds_read_b64_tr_b16 a[238:239], v10 offset:61696
 v_rcp_f32 v231, v231
 s_nop 0
 v_mul_f32 v83, v83, v231
 v_mfma_f32_16x16x32_bf16 v[136:139], a[244:247], a[184:187], v[136:139]
 v_cvt_pk_bf16_f32 v243, v82, v83
 v_mul_f32 v232, v36, v36
 v_mfma_f32_16x16x32_bf16 v[140:143], a[240:243], a[172:175], v[140:143]
 buffer_store_dwordx4 v[240:243], v2, s[36:39], s55 offen sc1
 v_mfma_f32_16x16x32_bf16 v[140:143], a[244:247], a[188:191], v[140:143]
 s_waitcnt lgkmcnt(6)
 v_fmaak_f32 v232, v232, v223, 0xc0135761
 v_mul_f32 v232, v232, v36
 v_mfma_f32_16x16x32_bf16 v[144:147], a[248:251], a[160:163], v[144:147]
 s_waitcnt lgkmcnt(4)
 ds_read_b64_tr_b16 a[240:241], v11 offset:57344
 ds_read_b64_tr_b16 a[242:243], v11 offset:57600
 v_exp_f32 v232, v232
 v_mfma_f32_16x16x32_bf16 v[144:147], a[252:255], a[176:179], v[144:147]
 v_mul_f32 v68, v36, v68
 v_add_f32 v232, 1.0, v232
 v_mfma_f32_16x16x32_bf16 v[148:151], a[248:251], a[164:167], v[148:151]
 v_rcp_f32 v232, v232
 s_nop 0
 v_mul_f32 v68, v68, v232
 v_mfma_f32_16x16x32_bf16 v[148:151], a[252:255], a[180:183], v[148:151]
 v_mul_f32 v233, v37, v37
 v_fmaak_f32 v233, v233, v223, 0xc0135761
 v_mfma_f32_16x16x32_bf16 v[152:155], a[248:251], a[168:171], v[152:155]
 ds_read_b64_tr_b16 a[244:245], v11 offset:61440
 ds_read_b64_tr_b16 a[246:247], v11 offset:61696
 v_mul_f32 v233, v233, v37
 v_exp_f32 v233, v233
 v_mfma_f32_16x16x32_bf16 v[152:155], a[252:255], a[184:187], v[152:155]
 v_mul_f32 v69, v37, v69
 v_add_f32 v233, 1.0, v233
 v_mfma_f32_16x16x32_bf16 v[156:159], a[248:251], a[172:175], v[156:159]
 v_rcp_f32 v233, v233
 v_mfma_f32_16x16x32_bf16 v[156:159], a[252:255], a[188:191], v[156:159]
 s_waitcnt lgkmcnt(6)
 v_mul_f32 v69, v69, v233
 v_cvt_pk_bf16_f32 v244, v68, v69
 v_mfma_f32_16x16x32_bf16 v[96:99], a[232:235], a[192:195], v[96:99]
 s_waitcnt lgkmcnt(4)
 ds_read_b64_tr_b16 a[248:249], v10 offset:59392
 ds_read_b64_tr_b16 a[250:251], v10 offset:59648
 v_mul_f32 v234, v38, v38
 v_fmaak_f32 v234, v234, v223, 0xc0135761
 v_mfma_f32_16x16x32_bf16 v[96:99], a[236:239], a[208:211], v[96:99]
 v_mul_f32 v234, v234, v38
 v_exp_f32 v234, v234
 v_mfma_f32_16x16x32_bf16 v[100:103], a[232:235], a[196:199], v[100:103]
 v_mul_f32 v70, v38, v70
 v_add_f32 v234, 1.0, v234
 v_mfma_f32_16x16x32_bf16 v[100:103], a[236:239], a[212:215], v[100:103]
 v_rcp_f32 v234, v234
 v_mfma_f32_16x16x32_bf16 v[104:107], a[232:235], a[200:203], v[104:107]
 ds_read_b64_tr_b16 a[252:253], v10 offset:63488
 ds_read_b64_tr_b16 a[254:255], v10 offset:63744
 v_mul_f32 v70, v70, v234
 v_mul_f32 v235, v39, v39
 v_mfma_f32_16x16x32_bf16 v[104:107], a[236:239], a[216:219], v[104:107]
 v_fmaak_f32 v235, v235, v223, 0xc0135761
 v_mul_f32 v235, v235, v39
 v_mfma_f32_16x16x32_bf16 v[108:111], a[232:235], a[204:207], v[108:111]
 v_exp_f32 v235, v235
 v_mul_f32 v71, v39, v71
 v_mfma_f32_16x16x32_bf16 v[108:111], a[236:239], a[220:223], v[108:111]
 s_waitcnt lgkmcnt(6)
 v_add_f32 v235, 1.0, v235
 v_mul_f32 v236, v52, v52
 v_mfma_f32_16x16x32_bf16 v[112:115], a[240:243], a[192:195], v[112:115]
 s_waitcnt lgkmcnt(4)
 ds_read_b64_tr_b16 a[232:233], v11 offset:59392
 ds_read_b64_tr_b16 a[234:235], v11 offset:59648
 v_rcp_f32 v235, v235
 s_nop 0
 v_mul_f32 v71, v71, v235
 v_mfma_f32_16x16x32_bf16 v[112:115], a[244:247], a[208:211], v[112:115]
 v_cvt_pk_bf16_f32 v245, v70, v71
 v_fmaak_f32 v236, v236, v223, 0xc0135761
 v_mfma_f32_16x16x32_bf16 v[116:119], a[240:243], a[196:199], v[116:119]
 v_mul_f32 v236, v236, v52
 v_mul_f32 v84, v52, v84
 v_mfma_f32_16x16x32_bf16 v[116:119], a[244:247], a[212:215], v[116:119]
 v_exp_f32 v236, v236
 v_mfma_f32_16x16x32_bf16 v[120:123], a[240:243], a[200:203], v[120:123]
 buffer_load_dwordx4 v4, s[32:35], s53 offen lds
 v_add_f32 v236, 1.0, v236
 v_mfma_f32_16x16x32_bf16 v[120:123], a[244:247], a[216:219], v[120:123]
 s_add_u32 m0, s48, 0x10000
 ds_read_b64_tr_b16 a[236:237], v11 offset:63488
 ds_read_b64_tr_b16 a[238:239], v11 offset:63744
 v_rcp_f32 v236, v236
 s_nop 0
 v_mul_f32 v84, v84, v236
 v_mfma_f32_16x16x32_bf16 v[124:127], a[240:243], a[204:207], v[124:127]
 s_add_u32 s53, s49, 0x360080
 buffer_load_dwordx4 v4, s[32:35], s53 offen lds
 v_mul_f32 v237, v53, v53
 v_fmaak_f32 v237, v237, v223, 0xc0135761
 v_mfma_f32_16x16x32_bf16 v[124:127], a[244:247], a[220:223], v[124:127]
 s_waitcnt lgkmcnt(4)
 s_add_u32 m0, s48, 0x11000
 v_mul_f32 v237, v237, v53
 v_exp_f32 v237, v237
 v_mfma_f32_16x16x32_bf16 v[128:131], a[248:251], a[192:195], v[128:131]
 s_add_u32 s53, s49, 0x3a8080
 buffer_load_dwordx4 v4, s[32:35], s53 offen lds
 v_mul_f32 v85, v53, v85
 v_add_f32 v237, 1.0, v237
 v_mfma_f32_16x16x32_bf16 v[128:131], a[252:255], a[208:211], v[128:131]
 s_add_u32 m0, s48, 0x12000
 ds_read_b64_tr_b16 a[240:241], v6
 ds_read_b64_tr_b16 a[242:243], v6 offset:256
 v_rcp_f32 v237, v237
 s_nop 0
 v_mul_f32 v85, v85, v237
 v_mfma_f32_16x16x32_bf16 v[132:135], a[248:251], a[196:199], v[132:135]
 s_add_u32 s53, s49, 0x3f0080
 buffer_load_dwordx4 v4, s[32:35], s53 offen lds
 v_cvt_pk_bf16_f32 v246, v84, v85
 v_mfma_f32_16x16x32_bf16 v[132:135], a[252:255], a[212:215], v[132:135]
 s_add_u32 m0, s48, 0x13000
 v_mul_f32 v238, v54, v54
 v_fmaak_f32 v238, v238, v223, 0xc0135761
 v_mfma_f32_16x16x32_bf16 v[136:139], a[248:251], a[200:203], v[136:139]
 s_add_u32 s53, s49, 0x438080
 ds_read_b64_tr_b16 a[244:245], v6 offset:4096
 ds_read_b64_tr_b16 a[246:247], v6 offset:4352
 v_mul_f32 v238, v238, v54
 v_exp_f32 v238, v238
 v_mfma_f32_16x16x32_bf16 v[136:139], a[252:255], a[216:219], v[136:139]
 v_mul_f32 v86, v54, v86
 v_add_f32 v238, 1.0, v238
 v_mfma_f32_16x16x32_bf16 v[140:143], a[248:251], a[204:207], v[140:143]
 v_rcp_f32 v238, v238
 s_nop 0
 v_mul_f32 v86, v86, v238
 v_mfma_f32_16x16x32_bf16 v[140:143], a[252:255], a[220:223], v[140:143]
 s_waitcnt lgkmcnt(6)
 v_mul_f32 v239, v55, v55
 v_fmaak_f32 v239, v239, v223, 0xc0135761
 v_mfma_f32_16x16x32_bf16 v[144:147], a[232:235], a[192:195], v[144:147]
 s_waitcnt lgkmcnt(4)
 ds_read_b64_tr_b16 a[248:249], v7
 ds_read_b64_tr_b16 a[250:251], v7 offset:256
 v_mul_f32 v239, v239, v55
 v_mfma_f32_16x16x32_bf16 v[144:147], a[236:239], a[208:211], v[144:147]
 v_exp_f32 v239, v239
 v_mul_f32 v87, v55, v87
 v_mfma_f32_16x16x32_bf16 v[148:151], a[232:235], a[196:199], v[148:151]
 v_add_f32 v239, 1.0, v239
 v_rcp_f32 v239, v239
 v_mfma_f32_16x16x32_bf16 v[148:151], a[236:239], a[212:215], v[148:151]
 v_mul_f32 v87, v87, v239
 v_cvt_pk_bf16_f32 v247, v86, v87
 v_mfma_f32_16x16x32_bf16 v[152:155], a[232:235], a[200:203], v[152:155]
 buffer_store_dwordx4 v[244:247], v2, s[36:39], s55 offen offset:1024 sc1
 v_mfma_f32_16x16x32_bf16 v[152:155], a[236:239], a[216:219], v[152:155]
 ds_read_b64_tr_b16 a[252:253], v7 offset:4096
 ds_read_b64_tr_b16 a[254:255], v7 offset:4352
 v_mul_f32 v224, v40, v40
 v_fmaak_f32 v224, v224, v223, 0xc0135761
 v_mfma_f32_16x16x32_bf16 v[156:159], a[232:235], a[204:207], v[156:159]
 v_mul_f32 v224, v224, v40
 v_exp_f32 v224, v224
 v_mfma_f32_16x16x32_bf16 v[156:159], a[236:239], a[220:223], v[156:159]
 s_waitcnt lgkmcnt(6)
 v_mul_f32 v72, v40, v72
 v_add_f32 v224, 1.0, v224
 v_mfma_f32_16x16x32_bf16 v[96:99], a[240:243], a[224:227], v[96:99]
 s_waitcnt lgkmcnt(4)
 ds_read_b64_tr_b16 a[232:233], v6 offset:2048
 ds_read_b64_tr_b16 a[234:235], v6 offset:2304
 v_rcp_f32 v224, v224
 s_nop 0
 v_mul_f32 v72, v72, v224
 v_mfma_f32_16x16x32_bf16 v[96:99], a[244:247], v[168:171], v[96:99]
 v_mul_f32 v225, v41, v41
 v_fmaak_f32 v225, v225, v223, 0xc0135761
 v_mfma_f32_16x16x32_bf16 v[100:103], a[240:243], a[228:231], v[100:103]
 v_mul_f32 v225, v225, v41
 v_mul_f32 v73, v41, v73
 v_mfma_f32_16x16x32_bf16 v[100:103], a[244:247], v[172:175], v[100:103]
 v_exp_f32 v225, v225
 v_mfma_f32_16x16x32_bf16 v[104:107], a[240:243], v[160:163], v[104:107]
 ds_read_b64_tr_b16 a[236:237], v6 offset:6144
 ds_read_b64_tr_b16 a[238:239], v6 offset:6400
 v_add_f32 v225, 1.0, v225
 v_rcp_f32 v225, v225
 v_mfma_f32_16x16x32_bf16 v[104:107], a[244:247], v[176:179], v[104:107]
 v_mul_f32 v73, v73, v225
 v_cvt_pk_bf16_f32 v240, v72, v73
 v_mfma_f32_16x16x32_bf16 v[108:111], a[240:243], v[164:167], v[108:111]
 v_mul_f32 v226, v42, v42
 v_fmaak_f32 v226, v226, v223, 0xc0135761
 v_mfma_f32_16x16x32_bf16 v[108:111], a[244:247], v[180:183], v[108:111]
 s_waitcnt lgkmcnt(6)
 v_mul_f32 v226, v226, v42
 v_mul_f32 v74, v42, v74
 v_mfma_f32_16x16x32_bf16 v[112:115], a[248:251], a[224:227], v[112:115]
 s_waitcnt lgkmcnt(4)
 ds_read_b64_tr_b16 a[240:241], v7 offset:2048
 ds_read_b64_tr_b16 a[242:243], v7 offset:2304
 v_exp_f32 v226, v226
 v_mfma_f32_16x16x32_bf16 v[112:115], a[252:255], v[168:171], v[112:115]
 v_add_f32 v226, 1.0, v226
 v_rcp_f32 v226, v226
 v_mfma_f32_16x16x32_bf16 v[116:119], a[248:251], a[228:231], v[116:119]
 v_mul_f32 v74, v74, v226
 v_mul_f32 v227, v43, v43
 v_mfma_f32_16x16x32_bf16 v[116:119], a[252:255], v[172:175], v[116:119]
 v_fmaak_f32 v227, v227, v223, 0xc0135761
 v_mul_f32 v227, v227, v43
 v_mfma_f32_16x16x32_bf16 v[120:123], a[248:251], v[160:163], v[120:123]
 ds_read_b64_tr_b16 a[244:245], v7 offset:6144
 ds_read_b64_tr_b16 a[246:247], v7 offset:6400
 v_exp_f32 v227, v227
 v_mfma_f32_16x16x32_bf16 v[120:123], a[252:255], v[176:179], v[120:123]
 v_mul_f32 v75, v43, v75
 v_add_f32 v227, 1.0, v227
 v_mfma_f32_16x16x32_bf16 v[124:127], a[248:251], v[164:167], v[124:127]
 v_rcp_f32 v227, v227
 s_nop 0
 v_mul_f32 v75, v75, v227
 v_mfma_f32_16x16x32_bf16 v[124:127], a[252:255], v[180:183], v[124:127]
 s_waitcnt lgkmcnt(6)
 v_cvt_pk_bf16_f32 v241, v74, v75
 v_mul_f32 v228, v56, v56
 v_mfma_f32_16x16x32_bf16 v[128:131], a[232:235], a[224:227], v[128:131]
 s_waitcnt lgkmcnt(4)
 ds_read_b64_tr_b16 a[248:249], v6 offset:8192
 ds_read_b64_tr_b16 a[250:251], v6 offset:8448
 v_fmaak_f32 v228, v228, v223, 0xc0135761
 v_mul_f32 v228, v228, v56
 v_mfma_f32_16x16x32_bf16 v[128:131], a[236:239], v[168:171], v[128:131]
 v_exp_f32 v228, v228
 v_mfma_f32_16x16x32_bf16 v[132:135], a[232:235], a[228:231], v[132:135]
 buffer_load_dwordx4 v4, s[32:35], s53 offen lds
 v_mul_f32 v88, v56, v88
 v_add_f32 v228, 1.0, v228
 v_mfma_f32_16x16x32_bf16 v[132:135], a[236:239], v[172:175], v[132:135]
 s_add_u32 m0, s48, 0x14000
 v_rcp_f32 v228, v228
 s_nop 0
 v_mul_f32 v88, v88, v228
 v_mfma_f32_16x16x32_bf16 v[136:139], a[232:235], v[160:163], v[136:139]
 s_add_u32 s53, s49, 0x480080
 buffer_load_dwordx4 v4, s[32:35], s53 offen lds
 v_mul_f32 v229, v57, v57
 v_fmaak_f32 v229, v229, v223, 0xc0135761
 v_mfma_f32_16x16x32_bf16 v[136:139], a[236:239], v[176:179], v[136:139]
 s_add_u32 m0, s48, 0x15000
 ds_read_b64_tr_b16 a[252:253], v6 offset:12288
 ds_read_b64_tr_b16 a[254:255], v6 offset:12544
 v_mul_f32 v229, v229, v57
 v_exp_f32 v229, v229
 v_mfma_f32_16x16x32_bf16 v[140:143], a[232:235], v[164:167], v[140:143]
 s_add_u32 s53, s49, 0x4c8080
 v_mul_f32 v89, v57, v89
 v_add_f32 v229, 1.0, v229
 v_mfma_f32_16x16x32_bf16 v[140:143], a[236:239], v[180:183], v[140:143]
 s_waitcnt lgkmcnt(6)
 v_rcp_f32 v229, v229
 v_mfma_f32_16x16x32_bf16 v[144:147], a[240:243], a[224:227], v[144:147]
 s_waitcnt lgkmcnt(4)
 ds_read_b64_tr_b16 a[232:233], v7 offset:8192
 ds_read_b64_tr_b16 a[234:235], v7 offset:8448
 v_mul_f32 v89, v89, v229
 v_cvt_pk_bf16_f32 v242, v88, v89
 v_mfma_f32_16x16x32_bf16 v[144:147], a[244:247], v[168:171], v[144:147]
 v_mul_f32 v230, v58, v58
 v_fmaak_f32 v230, v230, v223, 0xc0135761
 v_mfma_f32_16x16x32_bf16 v[148:151], a[240:243], a[228:231], v[148:151]
 v_mul_f32 v230, v230, v58
 v_exp_f32 v230, v230
 v_mfma_f32_16x16x32_bf16 v[148:151], a[244:247], v[172:175], v[148:151]
 v_mul_f32 v90, v58, v90
 v_add_f32 v230, 1.0, v230
 v_mfma_f32_16x16x32_bf16 v[152:155], a[240:243], v[160:163], v[152:155]
 ds_read_b64_tr_b16 a[236:237], v7 offset:12288
 ds_read_b64_tr_b16 a[238:239], v7 offset:12544
 v_rcp_f32 v230, v230
 v_mfma_f32_16x16x32_bf16 v[152:155], a[244:247], v[176:179], v[152:155]
 v_mul_f32 v90, v90, v230
 v_mul_f32 v231, v59, v59
 v_mfma_f32_16x16x32_bf16 v[156:159], a[240:243], v[164:167], v[156:159]
 v_fmaak_f32 v231, v231, v223, 0xc0135761
 v_mul_f32 v231, v231, v59
 v_mfma_f32_16x16x32_bf16 v[156:159], a[244:247], v[180:183], v[156:159]
 s_waitcnt lgkmcnt(6)
 v_exp_f32 v231, v231
 v_mul_f32 v91, v59, v91
 v_mfma_f32_16x16x32_bf16 v[96:99], a[248:251], v[184:187], v[96:99]
 s_waitcnt lgkmcnt(4)
 ds_read_b64_tr_b16 a[240:241], v6 offset:10240
 ds_read_b64_tr_b16 a[242:243], v6 offset:10496
 v_add_f32 v231, 1.0, v231
 v_rcp_f32 v231, v231
 v_mfma_f32_16x16x32_bf16 v[96:99], a[252:255], v[200:203], v[96:99]
 v_mul_f32 v91, v91, v231
 v_cvt_pk_bf16_f32 v243, v90, v91
 v_mfma_f32_16x16x32_bf16 v[100:103], a[248:251], v[188:191], v[100:103]
 buffer_store_dwordx4 v[240:243], v3, s[36:39], s55 offen sc1
 v_mfma_f32_16x16x32_bf16 v[100:103], a[252:255], v[204:207], v[100:103]
 v_mul_f32 v232, v44, v44
 v_fmaak_f32 v232, v232, v223, 0xc0135761
 v_mfma_f32_16x16x32_bf16 v[104:107], a[248:251], v[192:195], v[104:107]
 ds_read_b64_tr_b16 a[244:245], v6 offset:14336
 ds_read_b64_tr_b16 a[246:247], v6 offset:14592
 v_mul_f32 v232, v232, v44
 v_exp_f32 v232, v232
 v_mfma_f32_16x16x32_bf16 v[104:107], a[252:255], v[208:211], v[104:107]
 v_mul_f32 v76, v44, v76
 v_add_f32 v232, 1.0, v232
 v_mfma_f32_16x16x32_bf16 v[108:111], a[248:251], v[196:199], v[108:111]
 v_rcp_f32 v232, v232
 v_mfma_f32_16x16x32_bf16 v[108:111], a[252:255], v[212:215], v[108:111]
 s_waitcnt lgkmcnt(6)
 v_mul_f32 v76, v76, v232
 v_mul_f32 v233, v45, v45
 v_mfma_f32_16x16x32_bf16 v[112:115], a[232:235], v[184:187], v[112:115]
 s_waitcnt lgkmcnt(4)
 ds_read_b64_tr_b16 a[248:249], v7 offset:10240
 ds_read_b64_tr_b16 a[250:251], v7 offset:10496
 v_fmaak_f32 v233, v233, v223, 0xc0135761
 v_mul_f32 v233, v233, v45
 v_mfma_f32_16x16x32_bf16 v[112:115], a[236:239], v[200:203], v[112:115]
 v_exp_f32 v233, v233
 v_mul_f32 v77, v45, v77
 v_mfma_f32_16x16x32_bf16 v[116:119], a[232:235], v[188:191], v[116:119]
 v_add_f32 v233, 1.0, v233
 v_rcp_f32 v233, v233
 v_mfma_f32_16x16x32_bf16 v[116:119], a[236:239], v[204:207], v[116:119]
 v_mul_f32 v77, v77, v233
 v_cvt_pk_bf16_f32 v244, v76, v77
 v_mfma_f32_16x16x32_bf16 v[120:123], a[232:235], v[192:195], v[120:123]
 ds_read_b64_tr_b16 a[252:253], v7 offset:14336
 ds_read_b64_tr_b16 a[254:255], v7 offset:14592
 v_mul_f32 v234, v46, v46
 v_mfma_f32_16x16x32_bf16 v[120:123], a[236:239], v[208:211], v[120:123]
 v_fmaak_f32 v234, v234, v223, 0xc0135761
 v_mul_f32 v234, v234, v46
 v_mfma_f32_16x16x32_bf16 v[124:127], a[232:235], v[196:199], v[124:127]
 v_exp_f32 v234, v234
 v_mul_f32 v78, v46, v78
 v_mfma_f32_16x16x32_bf16 v[124:127], a[236:239], v[212:215], v[124:127]
 s_waitcnt lgkmcnt(6)
 v_add_f32 v234, 1.0, v234
 v_rcp_f32 v234, v234
 v_mfma_f32_16x16x32_bf16 v[128:131], a[240:243], v[184:187], v[128:131]
 s_waitcnt lgkmcnt(4)
 ds_read_b64_tr_b16 a[232:233], v6 offset:16384
 ds_read_b64_tr_b16 a[234:235], v6 offset:16640
 v_mul_f32 v78, v78, v234
 v_mul_f32 v235, v47, v47
 v_mfma_f32_16x16x32_bf16 v[128:131], a[244:247], v[200:203], v[128:131]
 v_fmaak_f32 v235, v235, v223, 0xc0135761
 v_mul_f32 v235, v235, v47
 v_mfma_f32_16x16x32_bf16 v[132:135], a[240:243], v[188:191], v[132:135]
 v_exp_f32 v235, v235
 v_mfma_f32_16x16x32_bf16 v[132:135], a[244:247], v[204:207], v[132:135]
 v_mul_f32 v79, v47, v79
 v_add_f32 v235, 1.0, v235
 v_mfma_f32_16x16x32_bf16 v[136:139], a[240:243], v[192:195], v[136:139]
 ds_read_b64_tr_b16 a[236:237], v6 offset:20480
 ds_read_b64_tr_b16 a[238:239], v6 offset:20736
 v_rcp_f32 v235, v235
 s_nop 0
 v_mul_f32 v79, v79, v235
 v_mfma_f32_16x16x32_bf16 v[136:139], a[244:247], v[208:211], v[136:139]
 v_cvt_pk_bf16_f32 v245, v78, v79
 v_mul_f32 v236, v60, v60
 v_mfma_f32_16x16x32_bf16 v[140:143], a[240:243], v[196:199], v[140:143]
 v_fmaak_f32 v236, v236, v223, 0xc0135761
 v_mul_f32 v236, v236, v60
 v_mfma_f32_16x16x32_bf16 v[140:143], a[244:247], v[212:215], v[140:143]
 s_waitcnt lgkmcnt(6)
 v_exp_f32 v236, v236
 v_mfma_f32_16x16x32_bf16 v[144:147], a[248:251], v[184:187], v[144:147]
 s_waitcnt lgkmcnt(4)
 buffer_load_dwordx4 v4, s[32:35], s53 offen lds
 v_mul_f32 v92, v60, v92
 v_add_f32 v236, 1.0, v236
 v_mfma_f32_16x16x32_bf16 v[144:147], a[252:255], v[200:203], v[144:147]
 s_add_u32 m0, s48, 0x16000
 ds_read_b64_tr_b16 a[240:241], v7 offset:16384
 ds_read_b64_tr_b16 a[242:243], v7 offset:16640
 v_rcp_f32 v236, v236
 s_nop 0
 v_mul_f32 v92, v92, v236
 v_mfma_f32_16x16x32_bf16 v[148:151], a[248:251], v[188:191], v[148:151]
 s_add_u32 s53, s49, 0xc0
 buffer_load_dwordx4 v4, s[32:35], s53 offen lds
 v_mul_f32 v237, v61, v61
 v_fmaak_f32 v237, v237, v223, 0xc0135761
 v_mfma_f32_16x16x32_bf16 v[148:151], a[252:255], v[204:207], v[148:151]
 s_add_u32 m0, s48, 0x17000
 v_mul_f32 v237, v237, v61
 v_mul_f32 v93, v61, v93
 v_mfma_f32_16x16x32_bf16 v[152:155], a[248:251], v[192:195], v[152:155]
 s_add_u32 s53, s49, 0x480c0
 ds_read_b64_tr_b16 a[244:245], v7 offset:20480
 ds_read_b64_tr_b16 a[246:247], v7 offset:20736
 v_exp_f32 v237, v237
 s_nop 0
 v_add_f32 v237, 1.0, v237
 v_rcp_f32 v237, v237
 s_nop 0
 v_mul_f32 v93, v93, v237
 v_cvt_pk_bf16_f32 v246, v92, v93
 v_mul_f32 v238, v62, v62
 v_fmaak_f32 v238, v238, v223, 0xc0135761
 v_mul_f32 v238, v238, v62
 v_exp_f32 v238, v238
 v_mul_f32 v94, v62, v94
 v_add_f32 v238, 1.0, v238
 v_rcp_f32 v238, v238
 s_nop 0
 v_mul_f32 v94, v94, v238
 v_mul_f32 v239, v63, v63
 v_fmaak_f32 v239, v239, v223, 0xc0135761
 v_mul_f32 v239, v239, v63
 v_exp_f32 v239, v239
 v_mul_f32 v95, v63, v95
 v_add_f32 v239, 1.0, v239
 v_rcp_f32 v239, v239
 s_nop 0
 v_mul_f32 v95, v95, v239
 v_cvt_pk_bf16_f32 v247, v94, v95
 v_mfma_f32_16x16x32_bf16 v[152:155], a[252:255], v[208:211], v[152:155]
 buffer_store_dwordx4 v[244:247], v3, s[36:39], s55 offen offset:1024 sc1
 v_mfma_f32_16x16x32_bf16 v[156:159], a[248:251], v[196:199], v[156:159]
 v_mfma_f32_16x16x32_bf16 v[156:159], a[252:255], v[212:215], v[156:159]
 s_waitcnt lgkmcnt(6)
 v_mfma_f32_16x16x32_bf16 v[32:35], a[232:235], a[0:3], 0
 s_waitcnt lgkmcnt(4)
 ds_read_b64_tr_b16 a[248:249], v6 offset:18432
 ds_read_b64_tr_b16 a[250:251], v6 offset:18688
 v_mfma_f32_16x16x32_bf16 v[32:35], a[236:239], a[16:19], v[32:35]
 v_mfma_f32_16x16x32_bf16 v[36:39], a[232:235], a[4:7], 0
 v_mfma_f32_16x16x32_bf16 v[36:39], a[236:239], a[20:23], v[36:39]
 v_mul_f32 v224, v96, v96
 v_fmaak_f32 v224, v224, v223, 0xc0135761
 v_mfma_f32_16x16x32_bf16 v[40:43], a[232:235], a[8:11], 0
 ds_read_b64_tr_b16 a[252:253], v6 offset:22528
 ds_read_b64_tr_b16 a[254:255], v6 offset:22784
 v_mfma_f32_16x16x32_bf16 v[40:43], a[236:239], a[24:27], v[40:43]
 v_mul_f32 v224, v224, v96
 v_mfma_f32_16x16x32_bf16 v[44:47], a[232:235], a[12:15], 0
 v_exp_f32 v224, v224
 v_mfma_f32_16x16x32_bf16 v[44:47], a[236:239], a[28:31], v[44:47]
 s_waitcnt lgkmcnt(6)
 v_mul_f32 v128, v96, v128
 v_add_f32 v224, 1.0, v224
 v_mfma_f32_16x16x32_bf16 v[48:51], a[240:243], a[0:3], 0
 s_waitcnt lgkmcnt(4)
 ds_read_b64_tr_b16 a[232:233], v7 offset:18432
 ds_read_b64_tr_b16 a[234:235], v7 offset:18688
 v_mfma_f32_16x16x32_bf16 v[48:51], a[244:247], a[16:19], v[48:51]
 v_rcp_f32 v224, v224
 v_mfma_f32_16x16x32_bf16 v[52:55], a[240:243], a[4:7], 0
 v_mul_f32 v128, v128, v224
 v_mul_f32 v225, v97, v97
 v_mfma_f32_16x16x32_bf16 v[52:55], a[244:247], a[20:23], v[52:55]
 v_fmaak_f32 v225, v225, v223, 0xc0135761
 v_mfma_f32_16x16x32_bf16 v[56:59], a[240:243], a[8:11], 0
 ds_read_b64_tr_b16 a[236:237], v7 offset:22528
 ds_read_b64_tr_b16 a[238:239], v7 offset:22784
 v_mfma_f32_16x16x32_bf16 v[56:59], a[244:247], a[24:27], v[56:59]
 v_mul_f32 v225, v225, v97
 v_mul_f32 v129, v97, v129
 v_mfma_f32_16x16x32_bf16 v[60:63], a[240:243], a[12:15], 0
 s_waitcnt vmcnt(10)
 v_exp_f32 v225, v225
 v_mfma_f32_16x16x32_bf16 v[60:63], a[244:247], a[28:31], v[60:63]
 s_barrier
 v_add_f32 v225, 1.0, v225
 s_waitcnt lgkmcnt(6)
 v_mfma_f32_16x16x32_bf16 v[64:67], a[248:251], a[0:3], 0
 s_waitcnt lgkmcnt(4)
 ds_read_b64_tr_b16 a[240:241], v6 offset:24576
 ds_read_b64_tr_b16 a[242:243], v6 offset:24832
 v_mfma_f32_16x16x32_bf16 v[64:67], a[252:255], a[16:19], v[64:67]
 v_rcp_f32 v225, v225
 v_mfma_f32_16x16x32_bf16 v[68:71], a[248:251], a[4:7], 0
 v_mul_f32 v129, v129, v225
 v_cvt_pk_bf16_f32 v240, v128, v129
 v_mfma_f32_16x16x32_bf16 v[68:71], a[252:255], a[20:23], v[68:71]
 buffer_load_dwordx4 v4, s[32:35], s53 offen lds
 v_mfma_f32_16x16x32_bf16 v[72:75], a[248:251], a[8:11], 0
 s_add_u32 m0, s48, 0x18000
 ds_read_b64_tr_b16 a[244:245], v6 offset:28672
 ds_read_b64_tr_b16 a[246:247], v6 offset:28928
 v_mfma_f32_16x16x32_bf16 v[72:75], a[252:255], a[24:27], v[72:75]
 s_add_u32 s53, s49, 0x900c0
 buffer_load_dwordx4 v4, s[32:35], s53 offen lds
 v_mfma_f32_16x16x32_bf16 v[76:79], a[248:251], a[12:15], 0
 s_add_u32 m0, s48, 0x19000
 v_mul_f32 v226, v98, v98
 v_fmaak_f32 v226, v226, v223, 0xc0135761
 v_mfma_f32_16x16x32_bf16 v[76:79], a[252:255], a[28:31], v[76:79]
 s_waitcnt lgkmcnt(6)
 s_add_u32 s53, s49, 0xd80c0
 buffer_load_dwordx4 v4, s[32:35], s53 offen lds
 v_mfma_f32_16x16x32_bf16 v[80:83], a[232:235], a[0:3], 0
 s_waitcnt lgkmcnt(4)
 ds_read_b64_tr_b16 a[248:249], v7 offset:24576
 ds_read_b64_tr_b16 a[250:251], v7 offset:24832
 v_mfma_f32_16x16x32_bf16 v[80:83], a[236:239], a[16:19], v[80:83]
 v_mul_f32 v226, v226, v98
 v_mul_f32 v130, v98, v130
 v_mfma_f32_16x16x32_bf16 v[84:87], a[232:235], a[4:7], 0
 v_exp_f32 v226, v226
 v_mfma_f32_16x16x32_bf16 v[84:87], a[236:239], a[20:23], v[84:87]
 v_add_f32 v226, 1.0, v226
 v_mul_f32 v227, v99, v99
 v_mfma_f32_16x16x32_bf16 v[88:91], a[232:235], a[8:11], 0
 ds_read_b64_tr_b16 a[252:253], v7 offset:28672
 ds_read_b64_tr_b16 a[254:255], v7 offset:28928
 v_mfma_f32_16x16x32_bf16 v[88:91], a[236:239], a[24:27], v[88:91]
 v_rcp_f32 v226, v226
 v_mfma_f32_16x16x32_bf16 v[92:95], a[232:235], a[12:15], 0
 v_mul_f32 v130, v130, v226
 v_fmaak_f32 v227, v227, v223, 0xc0135761
 v_mfma_f32_16x16x32_bf16 v[92:95], a[236:239], a[28:31], v[92:95]
 s_waitcnt lgkmcnt(6)
 v_mul_f32 v227, v227, v99
 v_mul_f32 v131, v99, v131
 v_mfma_f32_16x16x32_bf16 v[32:35], a[240:243], a[32:35], v[32:35]
 s_waitcnt lgkmcnt(4)
 ds_read_b64_tr_b16 a[232:233], v6 offset:26624
 ds_read_b64_tr_b16 a[234:235], v6 offset:26880
 v_mfma_f32_16x16x32_bf16 v[32:35], a[244:247], a[48:51], v[32:35]
 s_add_u32 m0, s48, 0x1a000
 v_exp_f32 v227, v227
 v_mfma_f32_16x16x32_bf16 v[36:39], a[240:243], a[36:39], v[36:39]
 s_add_u32 s53, s49, 0x1200c0
 buffer_load_dwordx4 v4, s[32:35], s53 offen lds
 v_mfma_f32_16x16x32_bf16 v[36:39], a[244:247], a[52:55], v[36:39]
 v_add_f32 v227, 1.0, v227
 v_mul_f32 v228, v112, v112
 v_mfma_f32_16x16x32_bf16 v[40:43], a[240:243], a[40:43], v[40:43]
 ds_read_b64_tr_b16 a[236:237], v6 offset:30720
 ds_read_b64_tr_b16 a[238:239], v6 offset:30976
 v_mfma_f32_16x16x32_bf16 v[40:43], a[244:247], a[56:59], v[40:43]
 s_waitcnt lgkmcnt(6)
 v_rcp_f32 v227, v227
 v_mfma_f32_16x16x32_bf16 v[44:47], a[240:243], a[44:47], v[44:47]
 s_lshl_b32 s18, s17, 2
 v_mul_f32 v131, v131, v227
 v_cvt_pk_bf16_f32 v241, v130, v131
 v_mfma_f32_16x16x32_bf16 v[44:47], a[244:247], a[60:63], v[44:47]
 s_add_u32 s18, s18, s3
 v_fmaak_f32 v228, v228, v223, 0xc0135761
 v_mul_f32 v228, v228, v112
 v_mfma_f32_16x16x32_bf16 v[48:51], a[248:251], a[32:35], v[48:51]
 s_waitcnt lgkmcnt(4)
 s_mul_i32 s19, s18, 0x24000
 ds_read_b64_tr_b16 a[240:241], v7 offset:26624
 ds_read_b64_tr_b16 a[242:243], v7 offset:26880
 v_mfma_f32_16x16x32_bf16 v[48:51], a[252:255], a[48:51], v[48:51]
 s_add_u32 s19, s19, s51
 v_exp_f32 v228, v228
 v_mfma_f32_16x16x32_bf16 v[52:55], a[248:251], a[36:39], v[52:55]
 v_mul_f32 v144, v112, v144
 v_lshrrev_b32 v251, 1, v1
 v_mfma_f32_16x16x32_bf16 v[52:55], a[252:255], a[52:55], v[52:55]
 v_min_u32 v251, 17, v251
 v_lshlrev_b32 v251, 13, v251
 v_mfma_f32_16x16x32_bf16 v[56:59], a[248:251], a[40:43], v[56:59]
 ds_read_b64_tr_b16 a[244:245], v7 offset:30720
 ds_read_b64_tr_b16 a[246:247], v7 offset:30976
 v_mfma_f32_16x16x32_bf16 v[56:59], a[252:255], a[56:59], v[56:59]
 v_and_b32 v252, 1, v1
 v_lshl_add_u32 v251, v252, 7, v251
 v_mfma_f32_16x16x32_bf16 v[60:63], a[248:251], a[44:47], v[60:63]
 buffer_load_dword v250, v251, s[28:31], s19 offen
 v_mfma_f32_16x16x32_bf16 v[60:63], a[252:255], a[60:63], v[60:63]
 s_waitcnt lgkmcnt(6)
 v_add_f32 v228, 1.0, v228
 v_mul_f32 v229, v113, v113
 v_mfma_f32_16x16x32_bf16 v[64:67], a[232:235], a[32:35], v[64:67]
 s_waitcnt lgkmcnt(4)
 ds_read_b64_tr_b16 a[248:249], v6 offset:32768
 ds_read_b64_tr_b16 a[250:251], v6 offset:33024
 v_mfma_f32_16x16x32_bf16 v[64:67], a[236:239], a[48:51], v[64:67]
 s_add_u32 m0, s48, 0x1b000
 v_rcp_f32 v228, v228
 v_mfma_f32_16x16x32_bf16 v[68:71], a[232:235], a[36:39], v[68:71]
 s_add_u32 s53, s49, 0x1680c0
 buffer_load_dwordx4 v4, s[32:35], s53 offen lds
 v_mfma_f32_16x16x32_bf16 v[68:71], a[236:239], a[52:55], v[68:71]
 v_mul_f32 v144, v144, v228
 v_fmaak_f32 v229, v229, v223, 0xc0135761
 v_mfma_f32_16x16x32_bf16 v[72:75], a[232:235], a[40:43], v[72:75]
 ds_read_b64_tr_b16 a[252:253], v6 offset:36864
 ds_read_b64_tr_b16 a[254:255], v6 offset:37120
 v_mfma_f32_16x16x32_bf16 v[72:75], a[236:239], a[56:59], v[72:75]
 v_mul_f32 v229, v229, v113
 v_mul_f32 v145, v113, v145
 v_mfma_f32_16x16x32_bf16 v[76:79], a[232:235], a[44:47], v[76:79]
 v_exp_f32 v229, v229
 v_mfma_f32_16x16x32_bf16 v[76:79], a[236:239], a[60:63], v[76:79]
 s_waitcnt lgkmcnt(6)
 v_add_f32 v229, 1.0, v229
 v_mul_f32 v230, v114, v114
 v_mfma_f32_16x16x32_bf16 v[80:83], a[240:243], a[32:35], v[80:83]
 s_waitcnt lgkmcnt(4)
 ds_read_b64_tr_b16 a[232:233], v7 offset:32768
 ds_read_b64_tr_b16 a[234:235], v7 offset:33024
 v_mfma_f32_16x16x32_bf16 v[80:83], a[244:247], a[48:51], v[80:83]
 v_rcp_f32 v229, v229
 v_mfma_f32_16x16x32_bf16 v[84:87], a[240:243], a[36:39], v[84:87]
 v_mul_f32 v145, v145, v229
 v_cvt_pk_bf16_f32 v242, v144, v145
 v_mfma_f32_16x16x32_bf16 v[84:87], a[244:247], a[52:55], v[84:87]
 v_fmaak_f32 v230, v230, v223, 0xc0135761
 v_mul_f32 v230, v230, v114
 v_mfma_f32_16x16x32_bf16 v[88:91], a[240:243], a[40:43], v[88:91]
 ds_read_b64_tr_b16 a[236:237], v7 offset:36864
 ds_read_b64_tr_b16 a[238:239], v7 offset:37120
 v_mfma_f32_16x16x32_bf16 v[88:91], a[244:247], a[56:59], v[88:91]
 v_exp_f32 v230, v230
 v_mfma_f32_16x16x32_bf16 v[92:95], a[240:243], a[44:47], v[92:95]
 v_mul_f32 v146, v114, v146
 v_add_f32 v230, 1.0, v230
 v_mfma_f32_16x16x32_bf16 v[92:95], a[244:247], a[60:63], v[92:95]
 s_waitcnt lgkmcnt(6)
 v_rcp_f32 v230, v230
 v_mfma_f32_16x16x32_bf16 v[32:35], a[248:251], a[64:67], v[32:35]
 s_waitcnt lgkmcnt(4)
 ds_read_b64_tr_b16 a[240:241], v6 offset:34816
 ds_read_b64_tr_b16 a[242:243], v6 offset:35072
 v_mfma_f32_16x16x32_bf16 v[32:35], a[252:255], a[80:83], v[32:35]
 s_add_u32 m0, s48, 0x1c000
 v_mul_f32 v146, v146, v230
 v_mul_f32 v231, v115, v115
 v_mfma_f32_16x16x32_bf16 v[36:39], a[248:251], a[68:71], v[36:39]
 s_add_u32 s53, s49, 0x1b00c0
 buffer_load_dwordx4 v4, s[32:35], s53 offen lds
 v_mfma_f32_16x16x32_bf16 v[36:39], a[252:255], a[84:87], v[36:39]
 s_add_u32 s55, s56, 0x800
 v_fmaak_f32 v231, v231, v223, 0xc0135761
 v_mul_f32 v231, v231, v115
 v_mfma_f32_16x16x32_bf16 v[40:43], a[248:251], a[72:75], v[40:43]
 ds_read_b64_tr_b16 a[244:245], v6 offset:38912
 ds_read_b64_tr_b16 a[246:247], v6 offset:39168
 v_mfma_f32_16x16x32_bf16 v[40:43], a[252:255], a[88:91], v[40:43]
 v_exp_f32 v231, v231
 v_mfma_f32_16x16x32_bf16 v[44:47], a[248:251], a[76:79], v[44:47]
 v_mul_f32 v147, v115, v147
 v_add_f32 v231, 1.0, v231
 v_mfma_f32_16x16x32_bf16 v[44:47], a[252:255], a[92:95], v[44:47]
 s_waitcnt lgkmcnt(6)
 v_rcp_f32 v231, v231
 v_mfma_f32_16x16x32_bf16 v[48:51], a[232:235], a[64:67], v[48:51]
 s_waitcnt lgkmcnt(4)
 ds_read_b64_tr_b16 a[248:249], v7 offset:34816
 ds_read_b64_tr_b16 a[250:251], v7 offset:35072
 v_mfma_f32_16x16x32_bf16 v[48:51], a[236:239], a[80:83], v[48:51]
 v_mul_f32 v147, v147, v231
 v_cvt_pk_bf16_f32 v243, v146, v147
 v_mfma_f32_16x16x32_bf16 v[52:55], a[232:235], a[68:71], v[52:55]
 buffer_store_dwordx4 v[240:243], v2, s[36:39], s55 offen sc1
 v_mfma_f32_16x16x32_bf16 v[52:55], a[236:239], a[84:87], v[52:55]
 v_mul_f32 v232, v100, v100
 v_fmaak_f32 v232, v232, v223, 0xc0135761
 v_mfma_f32_16x16x32_bf16 v[56:59], a[232:235], a[72:75], v[56:59]
 ds_read_b64_tr_b16 a[252:253], v7 offset:38912
 ds_read_b64_tr_b16 a[254:255], v7 offset:39168
 v_mfma_f32_16x16x32_bf16 v[56:59], a[236:239], a[88:91], v[56:59]
 v_mul_f32 v232, v232, v100
 v_mul_f32 v132, v100, v132
 v_mfma_f32_16x16x32_bf16 v[60:63], a[232:235], a[76:79], v[60:63]
 v_exp_f32 v232, v232
 v_mfma_f32_16x16x32_bf16 v[60:63], a[236:239], a[92:95], v[60:63]
 s_waitcnt lgkmcnt(6)
 v_add_f32 v232, 1.0, v232
 v_mul_f32 v233, v101, v101
 v_mfma_f32_16x16x32_bf16 v[64:67], a[240:243], a[64:67], v[64:67]
 s_waitcnt lgkmcnt(4)
 ds_read_b64_tr_b16 a[232:233], v6 offset:40960
 ds_read_b64_tr_b16 a[234:235], v6 offset:41216
 v_mfma_f32_16x16x32_bf16 v[64:67], a[244:247], a[80:83], v[64:67]
 s_add_u32 m0, s48, 0x1d000
 v_rcp_f32 v232, v232
 v_mfma_f32_16x16x32_bf16 v[68:71], a[240:243], a[68:71], v[68:71]
 s_add_u32 s53, s49, 0x1f80c0
 v_mul_f32 v132, v132, v232
 v_fmaak_f32 v233, v233, v223, 0xc0135761
 v_mfma_f32_16x16x32_bf16 v[68:71], a[244:247], a[84:87], v[68:71]
 v_mul_f32 v233, v233, v101
 v_mul_f32 v133, v101, v133
 v_mfma_f32_16x16x32_bf16 v[72:75], a[240:243], a[72:75], v[72:75]
 ds_read_b64_tr_b16 a[236:237], v6 offset:45056
 ds_read_b64_tr_b16 a[238:239], v6 offset:45312
 v_mfma_f32_16x16x32_bf16 v[72:75], a[244:247], a[88:91], v[72:75]
 v_exp_f32 v233, v233
 v_mfma_f32_16x16x32_bf16 v[76:79], a[240:243], a[76:79], v[76:79]
 v_add_f32 v233, 1.0, v233
 v_mul_f32 v234, v102, v102
 v_mfma_f32_16x16x32_bf16 v[76:79], a[244:247], a[92:95], v[76:79]
 s_waitcnt lgkmcnt(6)
 v_rcp_f32 v233, v233
 v_mfma_f32_16x16x32_bf16 v[80:83], a[248:251], a[64:67], v[80:83]
 s_waitcnt lgkmcnt(4)
 ds_read_b64_tr_b16 a[240:241], v7 offset:40960
 ds_read_b64_tr_b16 a[242:243], v7 offset:41216
 v_mfma_f32_16x16x32_bf16 v[80:83], a[252:255], a[80:83], v[80:83]
 v_mul_f32 v133, v133, v233
 v_cvt_pk_bf16_f32 v244, v132, v133
 v_mfma_f32_16x16x32_bf16 v[84:87], a[248:251], a[68:71], v[84:87]
 v_fmaak_f32 v234, v234, v223, 0xc0135761
 v_mul_f32 v234, v234, v102
 v_mfma_f32_16x16x32_bf16 v[84:87], a[252:255], a[84:87], v[84:87]
 v_exp_f32 v234, v234
 v_mfma_f32_16x16x32_bf16 v[88:91], a[248:251], a[72:75], v[88:91]
 ds_read_b64_tr_b16 a[244:245], v7 offset:45056
 ds_read_b64_tr_b16 a[246:247], v7 offset:45312
 v_mfma_f32_16x16x32_bf16 v[88:91], a[252:255], a[88:91], v[88:91]
 v_mul_f32 v134, v102, v134
 v_add_f32 v234, 1.0, v234
 v_mfma_f32_16x16x32_bf16 v[92:95], a[248:251], a[76:79], v[92:95]
 v_rcp_f32 v234, v234
 v_mfma_f32_16x16x32_bf16 v[92:95], a[252:255], a[92:95], v[92:95]
 s_waitcnt lgkmcnt(6)
 v_mul_f32 v134, v134, v234
 v_mul_f32 v235, v103, v103
 v_mfma_f32_16x16x32_bf16 v[32:35], a[232:235], a[96:99], v[32:35]
 s_waitcnt lgkmcnt(4)
 buffer_load_dwordx4 v4, s[32:35], s53 offen lds
 v_mfma_f32_16x16x32_bf16 v[32:35], a[236:239], a[112:115], v[32:35]
 s_add_u32 m0, s48, 0x1e000
 ds_read_b64_tr_b16 a[248:249], v6 offset:43008
 ds_read_b64_tr_b16 a[250:251], v6 offset:43264
 v_mfma_f32_16x16x32_bf16 v[36:39], a[232:235], a[100:103], v[36:39]
 s_add_u32 s53, s49, 0x2400c0
 buffer_load_dwordx4 v4, s[32:35], s53 offen lds
 v_mfma_f32_16x16x32_bf16 v[36:39], a[236:239], a[116:119], v[36:39]
 v_fmaak_f32 v235, v235, v223, 0xc0135761
 v_mul_f32 v235, v235, v103
 v_mfma_f32_16x16x32_bf16 v[40:43], a[232:235], a[104:107], v[40:43]
 ds_read_b64_tr_b16 a[252:253], v6 offset:47104
 ds_read_b64_tr_b16 a[254:255], v6 offset:47360
 v_mfma_f32_16x16x32_bf16 v[40:43], a[236:239], a[120:123], v[40:43]
 v_exp_f32 v235, v235
 v_mfma_f32_16x16x32_bf16 v[44:47], a[232:235], a[108:111], v[44:47]
 v_mul_f32 v135, v103, v135
 v_add_f32 v235, 1.0, v235
 v_mfma_f32_16x16x32_bf16 v[44:47], a[236:239], a[124:127], v[44:47]
 s_waitcnt lgkmcnt(6)
 v_rcp_f32 v235, v235
 v_mfma_f32_16x16x32_bf16 v[48:51], a[240:243], a[96:99], v[48:51]
 s_waitcnt lgkmcnt(4)
 ds_read_b64_tr_b16 a[232:233], v7 offset:43008
 ds_read_b64_tr_b16 a[234:235], v7 offset:43264
 v_mfma_f32_16x16x32_bf16 v[48:51], a[244:247], a[112:115], v[48:51]
 v_mul_f32 v135, v135, v235
 v_cvt_pk_bf16_f32 v245, v134, v135
 v_mfma_f32_16x16x32_bf16 v[52:55], a[240:243], a[100:103], v[52:55]
 v_mul_f32 v236, v116, v116
 v_fmaak_f32 v236, v236, v223, 0xc0135761
 v_mfma_f32_16x16x32_bf16 v[52:55], a[244:247], a[116:119], v[52:55]
 v_mul_f32 v236, v236, v116
 v_mul_f32 v148, v116, v148
 v_mfma_f32_16x16x32_bf16 v[56:59], a[240:243], a[104:107], v[56:59]
 ds_read_b64_tr_b16 a[236:237], v7 offset:47104
 ds_read_b64_tr_b16 a[238:239], v7 offset:47360
 v_mfma_f32_16x16x32_bf16 v[56:59], a[244:247], a[120:123], v[56:59]
 v_exp_f32 v236, v236
 v_mfma_f32_16x16x32_bf16 v[60:63], a[240:243], a[108:111], v[60:63]
 v_add_f32 v236, 1.0, v236
 v_mul_f32 v237, v117, v117
 v_mfma_f32_16x16x32_bf16 v[60:63], a[244:247], a[124:127], v[60:63]
 s_waitcnt lgkmcnt(6)
 v_rcp_f32 v236, v236
 v_mfma_f32_16x16x32_bf16 v[64:67], a[248:251], a[96:99], v[64:67]
 s_waitcnt lgkmcnt(4)
 ds_read_b64_tr_b16 a[240:241], v6 offset:49152
 ds_read_b64_tr_b16 a[242:243], v6 offset:49408
 v_mfma_f32_16x16x32_bf16 v[64:67], a[252:255], a[112:115], v[64:67]
 s_add_u32 m0, s48, 0x1f000
 v_mul_f32 v148, v148, v236
 v_fmaak_f32 v237, v237, v223, 0xc0135761
 v_mfma_f32_16x16x32_bf16 v[68:71], a[248:251], a[100:103], v[68:71]
 s_add_u32 s53, s49, 0x2880c0
 buffer_load_dwordx4 v4, s[32:35], s53 offen lds
 v_mfma_f32_16x16x32_bf16 v[68:71], a[252:255], a[116:119], v[68:71]
 v_mul_f32 v237, v237, v117
 v_mul_f32 v149, v117, v149
 v_mfma_f32_16x16x32_bf16 v[72:75], a[248:251], a[104:107], v[72:75]
 ds_read_b64_tr_b16 a[244:245], v6 offset:53248
 ds_read_b64_tr_b16 a[246:247], v6 offset:53504
 v_mfma_f32_16x16x32_bf16 v[72:75], a[252:255], a[120:123], v[72:75]
 v_exp_f32 v237, v237
 v_mfma_f32_16x16x32_bf16 v[76:79], a[248:251], a[108:111], v[76:79]
 v_add_f32 v237, 1.0, v237
 v_mul_f32 v238, v118, v118
 v_mfma_f32_16x16x32_bf16 v[76:79], a[252:255], a[124:127], v[76:79]
 s_waitcnt lgkmcnt(6)
 v_rcp_f32 v237, v237
 v_mfma_f32_16x16x32_bf16 v[80:83], a[232:235], a[96:99], v[80:83]
 s_waitcnt lgkmcnt(4)
 ds_read_b64_tr_b16 a[248:249], v7 offset:49152
 ds_read_b64_tr_b16 a[250:251], v7 offset:49408
 v_mfma_f32_16x16x32_bf16 v[80:83], a[236:239], a[112:115], v[80:83]
 v_mul_f32 v149, v149, v237
 v_cvt_pk_bf16_f32 v246, v148, v149
 v_mfma_f32_16x16x32_bf16 v[84:87], a[232:235], a[100:103], v[84:87]
 v_fmaak_f32 v238, v238, v223, 0xc0135761
 v_mul_f32 v238, v238, v118
 v_mfma_f32_16x16x32_bf16 v[84:87], a[236:239], a[116:119], v[84:87]
 v_exp_f32 v238, v238
 v_mfma_f32_16x16x32_bf16 v[88:91], a[232:235], a[104:107], v[88:91]
 ds_read_b64_tr_b16 a[252:253], v7 offset:53248
 ds_read_b64_tr_b16 a[254:255], v7 offset:53504
 v_mfma_f32_16x16x32_bf16 v[88:91], a[236:239], a[120:123], v[88:91]
 v_mul_f32 v150, v118, v150
 v_add_f32 v238, 1.0, v238
 v_mfma_f32_16x16x32_bf16 v[92:95], a[232:235], a[108:111], v[92:95]
 v_rcp_f32 v238, v238
 v_mfma_f32_16x16x32_bf16 v[92:95], a[236:239], a[124:127], v[92:95]
 s_waitcnt lgkmcnt(6)
 v_mul_f32 v150, v150, v238
 v_mul_f32 v239, v119, v119
 v_mfma_f32_16x16x32_bf16 v[32:35], a[240:243], a[128:131], v[32:35]
 s_waitcnt lgkmcnt(4)
 ds_read_b64_tr_b16 a[232:233], v6 offset:51200
 ds_read_b64_tr_b16 a[234:235], v6 offset:51456
 v_mfma_f32_16x16x32_bf16 v[32:35], a[244:247], a[144:147], v[32:35]
 s_add_u32 m0, s48, 0
 v_fmaak_f32 v239, v239, v223, 0xc0135761
 v_mul_f32 v239, v239, v119
 v_mfma_f32_16x16x32_bf16 v[36:39], a[240:243], a[132:135], v[36:39]
 s_add_u32 s53, s49, 0x2d00c0
 v_exp_f32 v239, v239
 v_mfma_f32_16x16x32_bf16 v[36:39], a[244:247], a[148:151], v[36:39]
 v_mul_f32 v151, v119, v151
 v_add_f32 v239, 1.0, v239
 v_mfma_f32_16x16x32_bf16 v[40:43], a[240:243], a[136:139], v[40:43]
 ds_read_b64_tr_b16 a[236:237], v6 offset:55296
 ds_read_b64_tr_b16 a[238:239], v6 offset:55552
 v_mfma_f32_16x16x32_bf16 v[40:43], a[244:247], a[152:155], v[40:43]
 v_rcp_f32 v239, v239
 v_mfma_f32_16x16x32_bf16 v[44:47], a[240:243], a[140:143], v[44:47]
 v_mul_f32 v151, v151, v239
 v_cvt_pk_bf16_f32 v247, v150, v151
 v_mfma_f32_16x16x32_bf16 v[44:47], a[244:247], a[156:159], v[44:47]
 s_waitcnt lgkmcnt(6)
 buffer_store_dwordx4 v[244:247], v2, s[36:39], s55 offen offset:1024 sc1
 v_mfma_f32_16x16x32_bf16 v[48:51], a[248:251], a[128:131], v[48:51]
 s_waitcnt lgkmcnt(4)
 ds_read_b64_tr_b16 a[240:241], v7 offset:51200
 ds_read_b64_tr_b16 a[242:243], v7 offset:51456
 v_mfma_f32_16x16x32_bf16 v[48:51], a[252:255], a[144:147], v[48:51]
 v_mul_f32 v224, v104, v104
 v_fmaak_f32 v224, v224, v223, 0xc0135761
 v_mfma_f32_16x16x32_bf16 v[52:55], a[248:251], a[132:135], v[52:55]
 s_add_u32 s19, s19, 0x480000
 v_mul_f32 v224, v224, v104
 v_mul_f32 v136, v104, v136
 v_mfma_f32_16x16x32_bf16 v[52:55], a[252:255], a[148:151], v[52:55]
 v_exp_f32 v224, v224
 v_mfma_f32_16x16x32_bf16 v[56:59], a[248:251], a[136:139], v[56:59]
 ds_read_b64_tr_b16 a[244:245], v7 offset:55296
 ds_read_b64_tr_b16 a[246:247], v7 offset:55552
 v_mfma_f32_16x16x32_bf16 v[56:59], a[252:255], a[152:155], v[56:59]
 v_add_f32 v224, 1.0, v224
 v_mul_f32 v225, v105, v105
 v_mfma_f32_16x16x32_bf16 v[60:63], a[248:251], a[140:143], v[60:63]
 v_rcp_f32 v224, v224
 v_mfma_f32_16x16x32_bf16 v[60:63], a[252:255], a[156:159], v[60:63]
 s_waitcnt lgkmcnt(6)
 v_mul_f32 v136, v136, v224
 v_fmaak_f32 v225, v225, v223, 0xc0135761
 v_mfma_f32_16x16x32_bf16 v[64:67], a[232:235], a[128:131], v[64:67]
 s_waitcnt lgkmcnt(4)
 ds_read_b64_tr_b16 a[248:249], v6 offset:57344
 ds_read_b64_tr_b16 a[250:251], v6 offset:57600
 v_mfma_f32_16x16x32_bf16 v[64:67], a[236:239], a[144:147], v[64:67]
 v_mul_f32 v225, v225, v105
 v_mul_f32 v137, v105, v137
 v_mfma_f32_16x16x32_bf16 v[68:71], a[232:235], a[132:135], v[68:71]
 v_exp_f32 v225, v225
 v_mfma_f32_16x16x32_bf16 v[68:71], a[236:239], a[148:151], v[68:71]
 v_add_f32 v225, 1.0, v225
 v_mul_f32 v226, v106, v106
 v_mfma_f32_16x16x32_bf16 v[72:75], a[232:235], a[136:139], v[72:75]
 ds_read_b64_tr_b16 a[252:253], v6 offset:61440
 ds_read_b64_tr_b16 a[254:255], v6 offset:61696
 v_mfma_f32_16x16x32_bf16 v[72:75], a[236:239], a[152:155], v[72:75]
 v_rcp_f32 v225, v225
 v_mfma_f32_16x16x32_bf16 v[76:79], a[232:235], a[140:143], v[76:79]
 v_mul_f32 v137, v137, v225
 v_cvt_pk_bf16_f32 v240, v136, v137
 v_mfma_f32_16x16x32_bf16 v[76:79], a[236:239], a[156:159], v[76:79]
 s_waitcnt lgkmcnt(6)
 v_fmaak_f32 v226, v226, v223, 0xc0135761
 v_mul_f32 v226, v226, v106
 v_mfma_f32_16x16x32_bf16 v[80:83], a[240:243], a[128:131], v[80:83]
 s_waitcnt lgkmcnt(4)
 ds_read_b64_tr_b16 a[232:233], v7 offset:57344
 ds_read_b64_tr_b16 a[234:235], v7 offset:57600
 v_mfma_f32_16x16x32_bf16 v[80:83], a[244:247], a[144:147], v[80:83]
 v_exp_f32 v226, v226
 v_mfma_f32_16x16x32_bf16 v[84:87], a[240:243], a[132:135], v[84:87]
 v_mul_f32 v138, v106, v138
 v_add_f32 v226, 1.0, v226
 v_mfma_f32_16x16x32_bf16 v[84:87], a[244:247], a[148:151], v[84:87]
 v_rcp_f32 v226, v226
 v_mfma_f32_16x16x32_bf16 v[88:91], a[240:243], a[136:139], v[88:91]
 ds_read_b64_tr_b16 a[236:237], v7 offset:61440
 ds_read_b64_tr_b16 a[238:239], v7 offset:61696
 v_mfma_f32_16x16x32_bf16 v[88:91], a[244:247], a[152:155], v[88:91]
 s_waitcnt lgkmcnt(6)
 buffer_load_dwordx4 v4, s[32:35], s53 offen lds
 v_mfma_f32_16x16x32_bf16 v[92:95], a[240:243], a[140:143], v[92:95]
 s_add_u32 m0, s48, 0x1000
 v_mul_f32 v138, v138, v226
 v_mul_f32 v227, v107, v107
 v_mfma_f32_16x16x32_bf16 v[92:95], a[244:247], a[156:159], v[92:95]
 s_add_u32 s53, s49, 0x3180c0
 buffer_load_dwordx4 v4, s[32:35], s53 offen lds
 v_mfma_f32_16x16x32_bf16 v[32:35], a[248:251], a[160:163], v[32:35]
 s_waitcnt lgkmcnt(4)
 ds_read_b64_tr_b16 a[240:241], v6 offset:59392
 ds_read_b64_tr_b16 a[242:243], v6 offset:59648
 v_mfma_f32_16x16x32_bf16 v[32:35], a[252:255], a[176:179], v[32:35]
 s_add_u32 m0, s48, 0x2000
 v_fmaak_f32 v227, v227, v223, 0xc0135761
 v_mul_f32 v227, v227, v107
 v_mfma_f32_16x16x32_bf16 v[36:39], a[248:251], a[164:167], v[36:39]
 s_add_u32 s53, s49, 0x3600c0
 buffer_load_dwordx4 v4, s[32:35], s53 offen lds
 v_mfma_f32_16x16x32_bf16 v[36:39], a[252:255], a[180:183], v[36:39]
 v_exp_f32 v227, v227
 v_mfma_f32_16x16x32_bf16 v[40:43], a[248:251], a[168:171], v[40:43]
 ds_read_b64_tr_b16 a[244:245], v6 offset:63488
 ds_read_b64_tr_b16 a[246:247], v6 offset:63744
 v_mfma_f32_16x16x32_bf16 v[40:43], a[252:255], a[184:187], v[40:43]
 v_mul_f32 v139, v107, v139
 v_add_f32 v227, 1.0, v227
 v_mfma_f32_16x16x32_bf16 v[44:47], a[248:251], a[172:175], v[44:47]
 v_rcp_f32 v227, v227
 v_mfma_f32_16x16x32_bf16 v[44:47], a[252:255], a[188:191], v[44:47]
 s_waitcnt lgkmcnt(6)
 v_mul_f32 v139, v139, v227
 v_cvt_pk_bf16_f32 v241, v138, v139
 v_mfma_f32_16x16x32_bf16 v[48:51], a[232:235], a[160:163], v[48:51]
 s_waitcnt lgkmcnt(4)
 ds_read_b64_tr_b16 a[248:249], v7 offset:59392
 ds_read_b64_tr_b16 a[250:251], v7 offset:59648
 v_mfma_f32_16x16x32_bf16 v[48:51], a[236:239], a[176:179], v[48:51]
 v_mul_f32 v228, v120, v120
 v_fmaak_f32 v228, v228, v223, 0xc0135761
 v_mfma_f32_16x16x32_bf16 v[52:55], a[232:235], a[164:167], v[52:55]
 v_mul_f32 v228, v228, v120
 v_mul_f32 v152, v120, v152
 v_mfma_f32_16x16x32_bf16 v[52:55], a[236:239], a[180:183], v[52:55]
 v_exp_f32 v228, v228
 v_mfma_f32_16x16x32_bf16 v[56:59], a[232:235], a[168:171], v[56:59]
 ds_read_b64_tr_b16 a[252:253], v7 offset:63488
 ds_read_b64_tr_b16 a[254:255], v7 offset:63744
 v_mfma_f32_16x16x32_bf16 v[56:59], a[236:239], a[184:187], v[56:59]
 v_add_f32 v228, 1.0, v228
 v_mul_f32 v229, v121, v121
 v_mfma_f32_16x16x32_bf16 v[60:63], a[232:235], a[172:175], v[60:63]
 s_waitcnt vmcnt(12)
 v_rcp_f32 v228, v228
 v_mfma_f32_16x16x32_bf16 v[60:63], a[236:239], a[188:191], v[60:63]
 s_barrier
 v_mul_f32 v152, v152, v228
 v_fmaak_f32 v229, v229, v223, 0xc0135761
 s_waitcnt lgkmcnt(6)
 v_mfma_f32_16x16x32_bf16 v[64:67], a[240:243], a[160:163], v[64:67]
 s_waitcnt lgkmcnt(4)
 ds_read_b64_tr_b16 a[232:233], v10
 ds_read_b64_tr_b16 a[234:235], v10 offset:256
 v_mfma_f32_16x16x32_bf16 v[64:67], a[244:247], a[176:179], v[64:67]
 s_add_u32 m0, s48, 0x3000
 v_mul_f32 v229, v229, v121
 v_mul_f32 v153, v121, v153
 v_mfma_f32_16x16x32_bf16 v[68:71], a[240:243], a[164:167], v[68:71]
 s_add_u32 s53, s49, 0x3a80c0
 buffer_load_dwordx4 v4, s[32:35], s53 offen lds
 v_mfma_f32_16x16x32_bf16 v[68:71], a[244:247], a[180:183], v[68:71]
 v_exp_f32 v229, v229
 v_mfma_f32_16x16x32_bf16 v[72:75], a[240:243], a[168:171], v[72:75]
 ds_read_b64_tr_b16 a[236:237], v10 offset:4096
 ds_read_b64_tr_b16 a[238:239], v10 offset:4352
 v_mfma_f32_16x16x32_bf16 v[72:75], a[244:247], a[184:187], v[72:75]
 v_add_f32 v229, 1.0, v229
 v_mul_f32 v230, v122, v122
 v_mfma_f32_16x16x32_bf16 v[76:79], a[240:243], a[172:175], v[76:79]
 v_rcp_f32 v229, v229
 v_mfma_f32_16x16x32_bf16 v[76:79], a[244:247], a[188:191], v[76:79]
 s_waitcnt lgkmcnt(6)
 v_mul_f32 v153, v153, v229
 v_cvt_pk_bf16_f32 v242, v152, v153
 v_mfma_f32_16x16x32_bf16 v[80:83], a[248:251], a[160:163], v[80:83]
 s_waitcnt lgkmcnt(4)
 ds_read_b64_tr_b16 a[240:241], v11
 ds_read_b64_tr_b16 a[242:243], v11 offset:256
 v_mfma_f32_16x16x32_bf16 v[80:83], a[252:255], a[176:179], v[80:83]
 v_fmaak_f32 v230, v230, v223, 0xc0135761
 v_mul_f32 v230, v230, v122
 v_mfma_f32_16x16x32_bf16 v[84:87], a[248:251], a[164:167], v[84:87]
 v_exp_f32 v230, v230
 v_mfma_f32_16x16x32_bf16 v[84:87], a[252:255], a[180:183], v[84:87]
 v_mul_f32 v154, v122, v154
 v_add_f32 v230, 1.0, v230
 v_mfma_f32_16x16x32_bf16 v[88:91], a[248:251], a[168:171], v[88:91]
 ds_read_b64_tr_b16 a[244:245], v11 offset:4096
 ds_read_b64_tr_b16 a[246:247], v11 offset:4352
 v_mfma_f32_16x16x32_bf16 v[88:91], a[252:255], a[184:187], v[88:91]
 v_rcp_f32 v230, v230
 v_mfma_f32_16x16x32_bf16 v[92:95], a[248:251], a[172:175], v[92:95]
 v_mul_f32 v154, v154, v230
 v_mul_f32 v231, v123, v123
 v_mfma_f32_16x16x32_bf16 v[92:95], a[252:255], a[188:191], v[92:95]
 s_waitcnt lgkmcnt(6)
 v_fmaak_f32 v231, v231, v223, 0xc0135761
 v_mul_f32 v231, v231, v123
 v_mfma_f32_16x16x32_bf16 v[32:35], a[232:235], a[192:195], v[32:35]
 s_waitcnt lgkmcnt(4)
 ds_read_b64_tr_b16 a[248:249], v10 offset:2048
 ds_read_b64_tr_b16 a[250:251], v10 offset:2304
 v_mfma_f32_16x16x32_bf16 v[32:35], a[236:239], a[208:211], v[32:35]
 s_add_u32 m0, s48, 0x4000
 v_exp_f32 v231, v231
 v_mfma_f32_16x16x32_bf16 v[36:39], a[232:235], a[196:199], v[36:39]
 s_add_u32 s53, s49, 0x3f00c0
 v_mul_f32 v155, v123, v155
 v_add_f32 v231, 1.0, v231
 v_mfma_f32_16x16x32_bf16 v[36:39], a[236:239], a[212:215], v[36:39]
 v_rcp_f32 v231, v231
 v_mfma_f32_16x16x32_bf16 v[40:43], a[232:235], a[200:203], v[40:43]
 ds_read_b64_tr_b16 a[252:253], v10 offset:6144
 ds_read_b64_tr_b16 a[254:255], v10 offset:6400
 v_mfma_f32_16x16x32_bf16 v[40:43], a[236:239], a[216:219], v[40:43]
 v_mul_f32 v155, v155, v231
 v_cvt_pk_bf16_f32 v243, v154, v155
 v_mfma_f32_16x16x32_bf16 v[44:47], a[232:235], a[204:207], v[44:47]
 buffer_store_dwordx4 v[240:243], v3, s[36:39], s55 offen sc1
 v_mfma_f32_16x16x32_bf16 v[44:47], a[236:239], a[220:223], v[44:47]
 s_waitcnt lgkmcnt(6)
 v_mul_f32 v232, v108, v108
 v_fmaak_f32 v232, v232, v223, 0xc0135761
 v_mfma_f32_16x16x32_bf16 v[48:51], a[240:243], a[192:195], v[48:51]
 s_waitcnt lgkmcnt(4)
 ds_read_b64_tr_b16 a[232:233], v11 offset:2048
 ds_read_b64_tr_b16 a[234:235], v11 offset:2304
 v_mfma_f32_16x16x32_bf16 v[48:51], a[244:247], a[208:211], v[48:51]
 v_mul_f32 v232, v232, v108
 v_mul_f32 v140, v108, v140
 v_mfma_f32_16x16x32_bf16 v[52:55], a[240:243], a[196:199], v[52:55]
 v_exp_f32 v232, v232
 v_mfma_f32_16x16x32_bf16 v[52:55], a[244:247], a[212:215], v[52:55]
 v_add_f32 v232, 1.0, v232
 v_mul_f32 v233, v109, v109
 v_mfma_f32_16x16x32_bf16 v[56:59], a[240:243], a[200:203], v[56:59]
 ds_read_b64_tr_b16 a[236:237], v11 offset:6144
 ds_read_b64_tr_b16 a[238:239], v11 offset:6400
 v_mfma_f32_16x16x32_bf16 v[56:59], a[244:247], a[216:219], v[56:59]
 v_rcp_f32 v232, v232
 v_mfma_f32_16x16x32_bf16 v[60:63], a[240:243], a[204:207], v[60:63]
 v_mul_f32 v140, v140, v232
 v_fmaak_f32 v233, v233, v223, 0xc0135761
 v_mfma_f32_16x16x32_bf16 v[60:63], a[244:247], a[220:223], v[60:63]
 s_waitcnt lgkmcnt(6)
 v_mul_f32 v233, v233, v109
 v_mul_f32 v141, v109, v141
 v_mfma_f32_16x16x32_bf16 v[64:67], a[248:251], a[192:195], v[64:67]
 s_waitcnt lgkmcnt(4)
 ds_read_b64_tr_b16 a[240:241], v10 offset:8192
 ds_read_b64_tr_b16 a[242:243], v10 offset:8448
 v_mfma_f32_16x16x32_bf16 v[64:67], a[252:255], a[208:211], v[64:67]
 v_exp_f32 v233, v233
 v_mfma_f32_16x16x32_bf16 v[68:71], a[248:251], a[196:199], v[68:71]
 v_add_f32 v233, 1.0, v233
 v_mul_f32 v234, v110, v110
 v_mfma_f32_16x16x32_bf16 v[68:71], a[252:255], a[212:215], v[68:71]
 v_rcp_f32 v233, v233
 v_mfma_f32_16x16x32_bf16 v[72:75], a[248:251], a[200:203], v[72:75]
 ds_read_b64_tr_b16 a[244:245], v10 offset:12288
 ds_read_b64_tr_b16 a[246:247], v10 offset:12544
 v_mfma_f32_16x16x32_bf16 v[72:75], a[252:255], a[216:219], v[72:75]
 v_mul_f32 v141, v141, v233
 v_cvt_pk_bf16_f32 v244, v140, v141
 v_mfma_f32_16x16x32_bf16 v[76:79], a[248:251], a[204:207], v[76:79]
 v_fmaak_f32 v234, v234, v223, 0xc0135761
 v_mul_f32 v234, v234, v110
 v_mfma_f32_16x16x32_bf16 v[76:79], a[252:255], a[220:223], v[76:79]
 s_waitcnt lgkmcnt(6)
 v_exp_f32 v234, v234
 v_mfma_f32_16x16x32_bf16 v[80:83], a[232:235], a[192:195], v[80:83]
 s_waitcnt lgkmcnt(4)
 ds_read_b64_tr_b16 a[248:249], v11 offset:8192
 ds_read_b64_tr_b16 a[250:251], v11 offset:8448
 v_mfma_f32_16x16x32_bf16 v[80:83], a[236:239], a[208:211], v[80:83]
 v_mul_f32 v142, v110, v142
 v_add_f32 v234, 1.0, v234
 v_mfma_f32_16x16x32_bf16 v[84:87], a[232:235], a[196:199], v[84:87]
 v_rcp_f32 v234, v234
 v_mfma_f32_16x16x32_bf16 v[84:87], a[236:239], a[212:215], v[84:87]
 v_mul_f32 v142, v142, v234
 v_mul_f32 v235, v111, v111
 v_mfma_f32_16x16x32_bf16 v[88:91], a[232:235], a[200:203], v[88:91]
 buffer_load_dwordx4 v4, s[32:35], s53 offen lds
 v_mfma_f32_16x16x32_bf16 v[88:91], a[236:239], a[216:219], v[88:91]
 s_add_u32 m0, s48, 0x5000
 ds_read_b64_tr_b16 a[252:253], v11 offset:12288
 ds_read_b64_tr_b16 a[254:255], v11 offset:12544
 v_mfma_f32_16x16x32_bf16 v[92:95], a[232:235], a[204:207], v[92:95]
 s_add_u32 s53, s49, 0x4380c0
 buffer_load_dwordx4 v4, s[32:35], s53 offen lds
 v_mfma_f32_16x16x32_bf16 v[92:95], a[236:239], a[220:223], v[92:95]
 s_waitcnt lgkmcnt(6)
 v_fmaak_f32 v235, v235, v223, 0xc0135761
 v_mul_f32 v235, v235, v111
 v_mfma_f32_16x16x32_bf16 v[32:35], a[240:243], a[224:227], v[32:35]
 s_waitcnt lgkmcnt(4)
 ds_read_b64_tr_b16 a[232:233], v10 offset:10240
 ds_read_b64_tr_b16 a[234:235], v10 offset:10496
 v_mfma_f32_16x16x32_bf16 v[32:35], a[244:247], v[168:171], v[32:35]
 s_add_u32 m0, s48, 0x6000
 v_exp_f32 v235, v235
 v_mfma_f32_16x16x32_bf16 v[36:39], a[240:243], a[228:231], v[36:39]
 s_add_u32 s53, s49, 0x4800c0
 buffer_load_dwordx4 v4, s[32:35], s53 offen lds
 v_mfma_f32_16x16x32_bf16 v[36:39], a[244:247], v[172:175], v[36:39]
 v_mul_f32 v143, v111, v143
 v_add_f32 v235, 1.0, v235
 v_mfma_f32_16x16x32_bf16 v[40:43], a[240:243], v[160:163], v[40:43]
 ds_read_b64_tr_b16 a[236:237], v10 offset:14336
 ds_read_b64_tr_b16 a[238:239], v10 offset:14592
 v_mfma_f32_16x16x32_bf16 v[40:43], a[244:247], v[176:179], v[40:43]
 v_rcp_f32 v235, v235
 v_mfma_f32_16x16x32_bf16 v[44:47], a[240:243], v[164:167], v[44:47]
 v_mul_f32 v143, v143, v235
 v_cvt_pk_bf16_f32 v245, v142, v143
 v_mfma_f32_16x16x32_bf16 v[44:47], a[244:247], v[180:183], v[44:47]
 s_waitcnt lgkmcnt(6)
 v_mul_f32 v236, v124, v124
 v_fmaak_f32 v236, v236, v223, 0xc0135761
 v_mfma_f32_16x16x32_bf16 v[48:51], a[248:251], a[224:227], v[48:51]
 s_waitcnt lgkmcnt(4)
 ds_read_b64_tr_b16 a[240:241], v11 offset:10240
 ds_read_b64_tr_b16 a[242:243], v11 offset:10496
 v_mfma_f32_16x16x32_bf16 v[48:51], a[252:255], v[168:171], v[48:51]
 v_mul_f32 v236, v236, v124
 v_mul_f32 v156, v124, v156
 v_mfma_f32_16x16x32_bf16 v[52:55], a[248:251], a[228:231], v[52:55]
 v_exp_f32 v236, v236
 v_mfma_f32_16x16x32_bf16 v[52:55], a[252:255], v[172:175], v[52:55]
 v_add_f32 v236, 1.0, v236
 v_mul_f32 v237, v125, v125
 v_mfma_f32_16x16x32_bf16 v[56:59], a[248:251], v[160:163], v[56:59]
 ds_read_b64_tr_b16 a[244:245], v11 offset:14336
 ds_read_b64_tr_b16 a[246:247], v11 offset:14592
 v_mfma_f32_16x16x32_bf16 v[56:59], a[252:255], v[176:179], v[56:59]
 v_rcp_f32 v236, v236
 v_mfma_f32_16x16x32_bf16 v[60:63], a[248:251], v[164:167], v[60:63]
 v_mul_f32 v156, v156, v236
 v_fmaak_f32 v237, v237, v223, 0xc0135761
 v_mfma_f32_16x16x32_bf16 v[60:63], a[252:255], v[180:183], v[60:63]
 s_waitcnt lgkmcnt(6)
 v_mul_f32 v237, v237, v125
 v_mul_f32 v157, v125, v157
 v_mfma_f32_16x16x32_bf16 v[64:67], a[232:235], a[224:227], v[64:67]
 s_waitcnt lgkmcnt(4)
 ds_read_b64_tr_b16 a[248:249], v10 offset:16384
 ds_read_b64_tr_b16 a[250:251], v10 offset:16640
 v_mfma_f32_16x16x32_bf16 v[64:67], a[236:239], v[168:171], v[64:67]
 s_add_u32 m0, s48, 0x7000
 v_exp_f32 v237, v237
 v_mfma_f32_16x16x32_bf16 v[68:71], a[232:235], a[228:231], v[68:71]
 s_add_u32 s53, s49, 0x4c80c0
 buffer_load_dwordx4 v4, s[32:35], s53 offen lds
 v_mfma_f32_16x16x32_bf16 v[68:71], a[236:239], v[172:175], v[68:71]
 v_add_f32 v237, 1.0, v237
 v_mul_f32 v238, v126, v126
 v_mfma_f32_16x16x32_bf16 v[72:75], a[232:235], v[160:163], v[72:75]
 ds_read_b64_tr_b16 a[252:253], v10 offset:20480
 ds_read_b64_tr_b16 a[254:255], v10 offset:20736
 v_mfma_f32_16x16x32_bf16 v[72:75], a[236:239], v[176:179], v[72:75]
 v_rcp_f32 v237, v237
 v_mfma_f32_16x16x32_bf16 v[76:79], a[232:235], v[164:167], v[76:79]
 v_mul_f32 v157, v157, v237
 v_cvt_pk_bf16_f32 v246, v156, v157
 v_mfma_f32_16x16x32_bf16 v[76:79], a[236:239], v[180:183], v[76:79]
 s_waitcnt lgkmcnt(6)
 v_fmaak_f32 v238, v238, v223, 0xc0135761
 v_mul_f32 v238, v238, v126
 v_mfma_f32_16x16x32_bf16 v[80:83], a[240:243], a[224:227], v[80:83]
 s_waitcnt lgkmcnt(4)
 ds_read_b64_tr_b16 a[232:233], v11 offset:16384
 ds_read_b64_tr_b16 a[234:235], v11 offset:16640
 v_mfma_f32_16x16x32_bf16 v[80:83], a[244:247], v[168:171], v[80:83]
 v_exp_f32 v238, v238
 v_mfma_f32_16x16x32_bf16 v[84:87], a[240:243], a[228:231], v[84:87]
 v_mul_f32 v158, v126, v158
 v_add_f32 v238, 1.0, v238
 v_mfma_f32_16x16x32_bf16 v[84:87], a[244:247], v[172:175], v[84:87]
 v_rcp_f32 v238, v238
 v_mfma_f32_16x16x32_bf16 v[88:91], a[240:243], v[160:163], v[88:91]
 ds_read_b64_tr_b16 a[236:237], v11 offset:20480
 ds_read_b64_tr_b16 a[238:239], v11 offset:20736
 v_mfma_f32_16x16x32_bf16 v[88:91], a[244:247], v[176:179], v[88:91]
 v_mul_f32 v158, v158, v238
 v_mul_f32 v239, v127, v127
 v_mfma_f32_16x16x32_bf16 v[92:95], a[240:243], v[164:167], v[92:95]
 v_fmaak_f32 v239, v239, v223, 0xc0135761
 v_mul_f32 v239, v239, v127
 v_mfma_f32_16x16x32_bf16 v[92:95], a[244:247], v[180:183], v[92:95]
 s_waitcnt lgkmcnt(6)
 v_exp_f32 v239, v239
 v_mfma_f32_16x16x32_bf16 v[32:35], a[248:251], v[184:187], v[32:35]
 s_waitcnt lgkmcnt(4)
 ds_read_b64_tr_b16 a[240:241], v10 offset:18432
 ds_read_b64_tr_b16 a[242:243], v10 offset:18688
 v_mfma_f32_16x16x32_bf16 v[32:35], a[252:255], v[200:203], v[32:35]
 s_add_u32 m0, s48, 0x8000
 v_mul_f32 v159, v127, v159
 v_add_f32 v239, 1.0, v239
 v_mfma_f32_16x16x32_bf16 v[36:39], a[248:251], v[188:191], v[36:39]
 s_add_u32 s53, s51, 0
 v_rcp_f32 v239, v239
 v_mfma_f32_16x16x32_bf16 v[36:39], a[252:255], v[204:207], v[36:39]
 v_mul_f32 v159, v159, v239
 v_cvt_pk_bf16_f32 v247, v158, v159
 v_mfma_f32_16x16x32_bf16 v[40:43], a[248:251], v[192:195], v[40:43]
 buffer_store_dwordx4 v[244:247], v3, s[36:39], s55 offen offset:1024 sc1
 v_mfma_f32_16x16x32_bf16 v[40:43], a[252:255], v[208:211], v[40:43]
 ds_read_b64_tr_b16 a[244:245], v10 offset:22528
 ds_read_b64_tr_b16 a[246:247], v10 offset:22784
 v_mfma_f32_16x16x32_bf16 v[44:47], a[248:251], v[196:199], v[44:47]
 v_mfma_f32_16x16x32_bf16 v[44:47], a[252:255], v[212:215], v[44:47]
 s_waitcnt lgkmcnt(6)
 v_mfma_f32_16x16x32_bf16 v[48:51], a[232:235], v[184:187], v[48:51]
 s_waitcnt lgkmcnt(4)
 ds_read_b64_tr_b16 a[248:249], v11 offset:18432
 ds_read_b64_tr_b16 a[250:251], v11 offset:18688
 v_mfma_f32_16x16x32_bf16 v[48:51], a[236:239], v[200:203], v[48:51]
 v_mfma_f32_16x16x32_bf16 v[52:55], a[232:235], v[188:191], v[52:55]
 v_mfma_f32_16x16x32_bf16 v[52:55], a[236:239], v[204:207], v[52:55]
 v_mfma_f32_16x16x32_bf16 v[56:59], a[232:235], v[192:195], v[56:59]
 ds_read_b64_tr_b16 a[252:253], v11 offset:22528
 ds_read_b64_tr_b16 a[254:255], v11 offset:22784
 v_mfma_f32_16x16x32_bf16 v[56:59], a[236:239], v[208:211], v[56:59]
 v_mfma_f32_16x16x32_bf16 v[60:63], a[232:235], v[196:199], v[60:63]
 v_mfma_f32_16x16x32_bf16 v[60:63], a[236:239], v[212:215], v[60:63]
 s_waitcnt lgkmcnt(6)
 v_mfma_f32_16x16x32_bf16 v[64:67], a[240:243], v[184:187], v[64:67]
 s_waitcnt lgkmcnt(4)
 ds_read_b64_tr_b16 a[232:233], v10 offset:24576
 ds_read_b64_tr_b16 a[234:235], v10 offset:24832
 v_mfma_f32_16x16x32_bf16 v[64:67], a[244:247], v[200:203], v[64:67]
 v_mfma_f32_16x16x32_bf16 v[68:71], a[240:243], v[188:191], v[68:71]
 v_mfma_f32_16x16x32_bf16 v[68:71], a[244:247], v[204:207], v[68:71]
 v_mfma_f32_16x16x32_bf16 v[72:75], a[240:243], v[192:195], v[72:75]
 ds_read_b64_tr_b16 a[236:237], v10 offset:28672
 ds_read_b64_tr_b16 a[238:239], v10 offset:28928
 v_mfma_f32_16x16x32_bf16 v[72:75], a[244:247], v[208:211], v[72:75]
 v_mfma_f32_16x16x32_bf16 v[76:79], a[240:243], v[196:199], v[76:79]
 v_mfma_f32_16x16x32_bf16 v[76:79], a[244:247], v[212:215], v[76:79]
 s_waitcnt lgkmcnt(6)
 v_mfma_f32_16x16x32_bf16 v[80:83], a[248:251], v[184:187], v[80:83]
 s_waitcnt lgkmcnt(4)
 ds_read_b64_tr_b16 a[240:241], v11 offset:24576
 ds_read_b64_tr_b16 a[242:243], v11 offset:24832
 v_mfma_f32_16x16x32_bf16 v[80:83], a[252:255], v[200:203], v[80:83]
 v_mfma_f32_16x16x32_bf16 v[84:87], a[248:251], v[188:191], v[84:87]
 buffer_load_dwordx4 v5, s[28:31], s53 offen lds
 v_mfma_f32_16x16x32_bf16 v[84:87], a[252:255], v[204:207], v[84:87]
 s_add_u32 m0, s48, 0x9000
 v_mfma_f32_16x16x32_bf16 v[88:91], a[248:251], v[192:195], v[88:91]
 s_add_u32 s53, s51, 0x40000
 buffer_load_dwordx4 v5, s[28:31], s53 offen lds
 v_mfma_f32_16x16x32_bf16 v[88:91], a[252:255], v[208:211], v[88:91]
 ds_read_b64_tr_b16 a[244:245], v11 offset:28672
 ds_read_b64_tr_b16 a[246:247], v11 offset:28928
 v_mfma_f32_16x16x32_bf16 v[92:95], a[248:251], v[196:199], v[92:95]
 v_mfma_f32_16x16x32_bf16 v[92:95], a[252:255], v[212:215], v[92:95]
 s_waitcnt lgkmcnt(6)
 v_mfma_f32_16x16x32_bf16 v[96:99], a[232:235], a[0:3], 0
 s_waitcnt lgkmcnt(4)
 ds_read_b64_tr_b16 a[248:249], v10 offset:26624
 ds_read_b64_tr_b16 a[250:251], v10 offset:26880
 v_mfma_f32_16x16x32_bf16 v[96:99], a[236:239], a[16:19], v[96:99]
 s_add_u32 m0, s48, 0xa000
 v_mfma_f32_16x16x32_bf16 v[100:103], a[232:235], a[4:7], 0
 s_add_u32 s53, s51, 0x80000
 buffer_load_dwordx4 v5, s[28:31], s53 offen lds
 v_mfma_f32_16x16x32_bf16 v[100:103], a[236:239], a[20:23], v[100:103]
 v_mul_f32 v224, v32, v32
 v_fmaak_f32 v224, v224, v223, 0xc0135761
 v_mfma_f32_16x16x32_bf16 v[104:107], a[232:235], a[8:11], 0
 ds_read_b64_tr_b16 a[252:253], v10 offset:30720
 ds_read_b64_tr_b16 a[254:255], v10 offset:30976
 v_mfma_f32_16x16x32_bf16 v[104:107], a[236:239], a[24:27], v[104:107]
 v_mul_f32 v224, v224, v32
 v_mfma_f32_16x16x32_bf16 v[108:111], a[232:235], a[12:15], 0
 v_exp_f32 v224, v224
 v_mfma_f32_16x16x32_bf16 v[108:111], a[236:239], a[28:31], v[108:111]
 s_waitcnt lgkmcnt(6)
 v_mul_f32 v64, v32, v64
 v_add_f32 v224, 1.0, v224
 v_mfma_f32_16x16x32_bf16 v[112:115], a[240:243], a[0:3], 0
 s_waitcnt lgkmcnt(4)
 ds_read_b64_tr_b16 a[232:233], v11 offset:26624
 ds_read_b64_tr_b16 a[234:235], v11 offset:26880
 v_mfma_f32_16x16x32_bf16 v[112:115], a[244:247], a[16:19], v[112:115]
 v_rcp_f32 v224, v224
 v_mfma_f32_16x16x32_bf16 v[116:119], a[240:243], a[4:7], 0
 v_mul_f32 v64, v64, v224
 v_mul_f32 v225, v33, v33
 v_mfma_f32_16x16x32_bf16 v[116:119], a[244:247], a[20:23], v[116:119]
 v_fmaak_f32 v225, v225, v223, 0xc0135761
 v_mfma_f32_16x16x32_bf16 v[120:123], a[240:243], a[8:11], 0
 ds_read_b64_tr_b16 a[236:237], v11 offset:30720
 ds_read_b64_tr_b16 a[238:239], v11 offset:30976
 v_mfma_f32_16x16x32_bf16 v[120:123], a[244:247], a[24:27], v[120:123]
 v_mul_f32 v225, v225, v33
 v_mul_f32 v65, v33, v65
 v_mfma_f32_16x16x32_bf16 v[124:127], a[240:243], a[12:15], 0
 v_exp_f32 v225, v225
 v_mfma_f32_16x16x32_bf16 v[124:127], a[244:247], a[28:31], v[124:127]
 s_waitcnt lgkmcnt(6)
 v_add_f32 v225, 1.0, v225
 v_mfma_f32_16x16x32_bf16 v[128:131], a[248:251], a[0:3], 0
 s_waitcnt lgkmcnt(4)
 ds_read_b64_tr_b16 a[240:241], v10 offset:32768
 ds_read_b64_tr_b16 a[242:243], v10 offset:33024
 v_mfma_f32_16x16x32_bf16 v[128:131], a[252:255], a[16:19], v[128:131]
 s_add_u32 m0, s48, 0xb000
 v_rcp_f32 v225, v225
 v_mfma_f32_16x16x32_bf16 v[132:135], a[248:251], a[4:7], 0
 s_add_u32 s53, s51, 0xc0000
 buffer_load_dwordx4 v5, s[28:31], s53 offen lds
 v_mfma_f32_16x16x32_bf16 v[132:135], a[252:255], a[20:23], v[132:135]
 v_mul_f32 v65, v65, v225
 v_cvt_pk_bf16_f32 v240, v64, v65
 v_mfma_f32_16x16x32_bf16 v[136:139], a[248:251], a[8:11], 0
 ds_read_b64_tr_b16 a[244:245], v10 offset:36864
 ds_read_b64_tr_b16 a[246:247], v10 offset:37120
 v_mfma_f32_16x16x32_bf16 v[136:139], a[252:255], a[24:27], v[136:139]
 v_mul_f32 v226, v34, v34
 v_fmaak_f32 v226, v226, v223, 0xc0135761
 v_mfma_f32_16x16x32_bf16 v[140:143], a[248:251], a[12:15], 0
 v_mul_f32 v226, v226, v34
 v_mul_f32 v66, v34, v66
 v_mfma_f32_16x16x32_bf16 v[140:143], a[252:255], a[28:31], v[140:143]
 s_waitcnt lgkmcnt(6)
 v_exp_f32 v226, v226
 v_mfma_f32_16x16x32_bf16 v[144:147], a[232:235], a[0:3], 0
 s_waitcnt lgkmcnt(4)
 ds_read_b64_tr_b16 a[248:249], v11 offset:32768
 ds_read_b64_tr_b16 a[250:251], v11 offset:33024
 v_mfma_f32_16x16x32_bf16 v[144:147], a[236:239], a[16:19], v[144:147]
 v_add_f32 v226, 1.0, v226
 v_mul_f32 v227, v35, v35
 v_mfma_f32_16x16x32_bf16 v[148:151], a[232:235], a[4:7], 0
 v_rcp_f32 v226, v226
 v_mfma_f32_16x16x32_bf16 v[148:151], a[236:239], a[20:23], v[148:151]
 v_mul_f32 v66, v66, v226
 v_fmaak_f32 v227, v227, v223, 0xc0135761
 v_mfma_f32_16x16x32_bf16 v[152:155], a[232:235], a[8:11], 0
 ds_read_b64_tr_b16 a[252:253], v11 offset:36864
 ds_read_b64_tr_b16 a[254:255], v11 offset:37120
 v_mfma_f32_16x16x32_bf16 v[152:155], a[236:239], a[24:27], v[152:155]
 v_mul_f32 v227, v227, v35
 v_mul_f32 v67, v35, v67
 v_mfma_f32_16x16x32_bf16 v[156:159], a[232:235], a[12:15], 0
 v_exp_f32 v227, v227
 v_mfma_f32_16x16x32_bf16 v[156:159], a[236:239], a[28:31], v[156:159]
 s_waitcnt lgkmcnt(6)
 v_add_f32 v227, 1.0, v227
 v_mfma_f32_16x16x32_bf16 v[96:99], a[240:243], a[32:35], v[96:99]
 s_waitcnt lgkmcnt(4)
 ds_read_b64_tr_b16 a[232:233], v10 offset:34816
 ds_read_b64_tr_b16 a[234:235], v10 offset:35072
 v_mfma_f32_16x16x32_bf16 v[96:99], a[244:247], a[48:51], v[96:99]
 s_add_u32 m0, s48, 0xc000
 v_rcp_f32 v227, v227
 v_mfma_f32_16x16x32_bf16 v[100:103], a[240:243], a[36:39], v[100:103]
 s_add_u32 s53, s51, 0x100000
 buffer_load_dwordx4 v5, s[28:31], s53 offen lds
 v_mfma_f32_16x16x32_bf16 v[100:103], a[244:247], a[52:55], v[100:103]
 s_getpc_b64 s[62:63]
L_pcA2:
 s_add_u32 s62, s62, L_pcA2+3072-L_pcA2
 s_addc_u32 s63, s63, 0
 v_mul_f32 v67, v67, v227
 v_cvt_pk_bf16_f32 v241, v66, v67
 v_mfma_f32_16x16x32_bf16 v[104:107], a[240:243], a[40:43], v[104:107]
 s_bfe_u32 s18, s2, 0x10003
 ds_read_b64_tr_b16 a[236:237], v10 offset:38912
 ds_read_b64_tr_b16 a[238:239], v10 offset:39168
 v_mfma_f32_16x16x32_bf16 v[104:107], a[244:247], a[56:59], v[104:107]
 s_lshl_b32 s18, s18, 2
 v_mul_f32 v228, v48, v48
 v_fmaak_f32 v228, v228, v223, 0xc0135761
 v_mfma_f32_16x16x32_bf16 v[108:111], a[240:243], a[44:47], v[108:111]
 s_add_u32 s18, s18, s3
 v_and_b32 v216, 15, v1
 v_lshlrev_b32 v216, 7, v216
 v_mfma_f32_16x16x32_bf16 v[108:111], a[244:247], a[60:63], v[108:111]
 s_waitcnt lgkmcnt(4)
 s_lshl_b32 s18, s18, 11
 v_mul_f32 v228, v228, v48
 v_mul_f32 v80, v48, v80
 v_mfma_f32_16x16x32_bf16 v[112:115], a[248:251], a[32:35], v[112:115]
 s_add_u32 s62, s62, s18
 s_addc_u32 s63, s63, 0
 ds_read_b64_tr_b16 a[240:241], v11 offset:34816
 ds_read_b64_tr_b16 a[242:243], v11 offset:35072
 v_mfma_f32_16x16x32_bf16 v[112:115], a[252:255], a[48:51], v[112:115]
 v_mov_b32 v217, s63
 v_mul_f32 v229, v49, v49
 v_mfma_f32_16x16x32_bf16 v[116:119], a[248:251], a[36:39], v[116:119]
 v_add_co_u32 v216, vcc, s62, v216
 s_nop 1
 v_addc_co_u32 v217, vcc, 0, v217, vcc
 v_mfma_f32_16x16x32_bf16 v[116:119], a[252:255], a[52:55], v[116:119]
 global_load_dword v250, v[216:217], off
 v_mfma_f32_16x16x32_bf16 v[120:123], a[248:251], a[40:43], v[120:123]
 ds_read_b64_tr_b16 a[244:245], v11 offset:38912
 ds_read_b64_tr_b16 a[246:247], v11 offset:39168
 v_mfma_f32_16x16x32_bf16 v[120:123], a[252:255], a[56:59], v[120:123]
 v_exp_f32 v228, v228
 v_mfma_f32_16x16x32_bf16 v[124:127], a[248:251], a[44:47], v[124:127]
 s_waitcnt vmcnt(12)
 v_add_f32 v228, 1.0, v228
 v_fmaak_f32 v229, v229, v223, 0xc0135761
 v_mfma_f32_16x16x32_bf16 v[124:127], a[252:255], a[60:63], v[124:127]
 s_barrier
 v_rcp_f32 v228, v228
 s_waitcnt lgkmcnt(6)
 v_mfma_f32_16x16x32_bf16 v[128:131], a[232:235], a[32:35], v[128:131]
 s_waitcnt lgkmcnt(4)
 ds_read_b64_tr_b16 a[248:249], v10 offset:40960
 ds_read_b64_tr_b16 a[250:251], v10 offset:41216
 v_mfma_f32_16x16x32_bf16 v[128:131], a[236:239], a[48:51], v[128:131]
 s_add_u32 m0, s48, 0xd000
 v_mul_f32 v80, v80, v228
 v_mul_f32 v229, v229, v49
 v_mfma_f32_16x16x32_bf16 v[132:135], a[232:235], a[36:39], v[132:135]
 s_add_u32 s53, s51, 0x140000
 buffer_load_dwordx4 v5, s[28:31], s53 offen lds
 v_mfma_f32_16x16x32_bf16 v[132:135], a[236:239], a[52:55], v[132:135]
 v_exp_f32 v229, v229
 v_mfma_f32_16x16x32_bf16 v[136:139], a[232:235], a[40:43], v[136:139]
 ds_read_b64_tr_b16 a[252:253], v10 offset:45056
 ds_read_b64_tr_b16 a[254:255], v10 offset:45312
 v_mfma_f32_16x16x32_bf16 v[136:139], a[236:239], a[56:59], v[136:139]
 v_mul_f32 v81, v49, v81
 v_add_f32 v229, 1.0, v229
 v_mfma_f32_16x16x32_bf16 v[140:143], a[232:235], a[44:47], v[140:143]
 v_rcp_f32 v229, v229
 v_mfma_f32_16x16x32_bf16 v[140:143], a[236:239], a[60:63], v[140:143]
 s_waitcnt lgkmcnt(6)
 v_mul_f32 v81, v81, v229
 v_cvt_pk_bf16_f32 v242, v80, v81
 v_mfma_f32_16x16x32_bf16 v[144:147], a[240:243], a[32:35], v[144:147]
 s_waitcnt lgkmcnt(4)
 ds_read_b64_tr_b16 a[232:233], v11 offset:40960
 ds_read_b64_tr_b16 a[234:235], v11 offset:41216
 v_mfma_f32_16x16x32_bf16 v[144:147], a[244:247], a[48:51], v[144:147]
 v_mul_f32 v230, v50, v50
 v_fmaak_f32 v230, v230, v223, 0xc0135761
 v_mfma_f32_16x16x32_bf16 v[148:151], a[240:243], a[36:39], v[148:151]
 v_mul_f32 v230, v230, v50
 v_mul_f32 v82, v50, v82
 v_mfma_f32_16x16x32_bf16 v[148:151], a[244:247], a[52:55], v[148:151]
 v_exp_f32 v230, v230
 v_mfma_f32_16x16x32_bf16 v[152:155], a[240:243], a[40:43], v[152:155]
 ds_read_b64_tr_b16 a[236:237], v11 offset:45056
 ds_read_b64_tr_b16 a[238:239], v11 offset:45312
 v_mfma_f32_16x16x32_bf16 v[152:155], a[244:247], a[56:59], v[152:155]
 v_add_f32 v230, 1.0, v230
 v_mul_f32 v231, v51, v51
 v_mfma_f32_16x16x32_bf16 v[156:159], a[240:243], a[44:47], v[156:159]
 v_rcp_f32 v230, v230
 v_mfma_f32_16x16x32_bf16 v[156:159], a[244:247], a[60:63], v[156:159]
 s_waitcnt lgkmcnt(6)
 v_mul_f32 v82, v82, v230
 v_fmaak_f32 v231, v231, v223, 0xc0135761
 v_mfma_f32_16x16x32_bf16 v[96:99], a[248:251], a[64:67], v[96:99]
 s_waitcnt lgkmcnt(4)
 ds_read_b64_tr_b16 a[240:241], v10 offset:43008
 ds_read_b64_tr_b16 a[242:243], v10 offset:43264
 v_mfma_f32_16x16x32_bf16 v[96:99], a[252:255], a[80:83], v[96:99]
 s_add_u32 m0, s48, 0xe000
 v_mul_f32 v231, v231, v51
 v_mul_f32 v83, v51, v83
 v_mfma_f32_16x16x32_bf16 v[100:103], a[248:251], a[68:71], v[100:103]
 s_add_u32 s53, s51, 0x180000
 buffer_load_dwordx4 v5, s[28:31], s53 offen lds
 v_mfma_f32_16x16x32_bf16 v[100:103], a[252:255], a[84:87], v[100:103]
 s_add_u32 s55, s56, 0x1000
 v_exp_f32 v231, v231
 v_mfma_f32_16x16x32_bf16 v[104:107], a[248:251], a[72:75], v[104:107]
 ds_read_b64_tr_b16 a[244:245], v10 offset:47104
 ds_read_b64_tr_b16 a[246:247], v10 offset:47360
 v_mfma_f32_16x16x32_bf16 v[104:107], a[252:255], a[88:91], v[104:107]
 v_add_f32 v231, 1.0, v231
 v_mul_f32 v232, v36, v36
 v_mfma_f32_16x16x32_bf16 v[108:111], a[248:251], a[76:79], v[108:111]
 v_rcp_f32 v231, v231
 v_mfma_f32_16x16x32_bf16 v[108:111], a[252:255], a[92:95], v[108:111]
 s_waitcnt lgkmcnt(6)
 v_mul_f32 v83, v83, v231
 v_cvt_pk_bf16_f32 v243, v82, v83
 v_mfma_f32_16x16x32_bf16 v[112:115], a[232:235], a[64:67], v[112:115]
 s_waitcnt lgkmcnt(4)
 buffer_store_dwordx4 v[240:243], v2, s[36:39], s55 offen sc1
 v_mfma_f32_16x16x32_bf16 v[112:115], a[236:239], a[80:83], v[112:115]
 ds_read_b64_tr_b16 a[248:249], v11 offset:43008
 ds_read_b64_tr_b16 a[250:251], v11 offset:43264
 v_mfma_f32_16x16x32_bf16 v[116:119], a[232:235], a[68:71], v[116:119]
 v_fmaak_f32 v232, v232, v223, 0xc0135761
 v_mul_f32 v232, v232, v36
 v_mfma_f32_16x16x32_bf16 v[116:119], a[236:239], a[84:87], v[116:119]
 v_exp_f32 v232, v232
 v_mfma_f32_16x16x32_bf16 v[120:123], a[232:235], a[72:75], v[120:123]
 ds_read_b64_tr_b16 a[252:253], v11 offset:47104
 ds_read_b64_tr_b16 a[254:255], v11 offset:47360
 v_mfma_f32_16x16x32_bf16 v[120:123], a[236:239], a[88:91], v[120:123]
 v_mul_f32 v68, v36, v68
 v_add_f32 v232, 1.0, v232
 v_mfma_f32_16x16x32_bf16 v[124:127], a[232:235], a[76:79], v[124:127]
 v_rcp_f32 v232, v232
 v_mfma_f32_16x16x32_bf16 v[124:127], a[236:239], a[92:95], v[124:127]
 s_waitcnt lgkmcnt(6)
 v_mul_f32 v68, v68, v232
 v_mul_f32 v233, v37, v37
 v_mfma_f32_16x16x32_bf16 v[128:131], a[240:243], a[64:67], v[128:131]
 s_waitcnt lgkmcnt(4)
 ds_read_b64_tr_b16 a[232:233], v10 offset:49152
 ds_read_b64_tr_b16 a[234:235], v10 offset:49408
 v_mfma_f32_16x16x32_bf16 v[128:131], a[244:247], a[80:83], v[128:131]
 s_add_u32 m0, s48, 0xf000
 v_fmaak_f32 v233, v233, v223, 0xc0135761
 v_mul_f32 v233, v233, v37
 v_mfma_f32_16x16x32_bf16 v[132:135], a[240:243], a[68:71], v[132:135]
 s_add_u32 s53, s51, 0x1c0000
 v_exp_f32 v233, v233
 v_mfma_f32_16x16x32_bf16 v[132:135], a[244:247], a[84:87], v[132:135]
 v_mul_f32 v69, v37, v69
 v_add_f32 v233, 1.0, v233
 v_mfma_f32_16x16x32_bf16 v[136:139], a[240:243], a[72:75], v[136:139]
 ds_read_b64_tr_b16 a[236:237], v10 offset:53248
 ds_read_b64_tr_b16 a[238:239], v10 offset:53504
 v_mfma_f32_16x16x32_bf16 v[136:139], a[244:247], a[88:91], v[136:139]
 v_rcp_f32 v233, v233
 v_mfma_f32_16x16x32_bf16 v[140:143], a[240:243], a[76:79], v[140:143]
 v_mul_f32 v69, v69, v233
 v_cvt_pk_bf16_f32 v244, v68, v69
 v_mfma_f32_16x16x32_bf16 v[140:143], a[244:247], a[92:95], v[140:143]
 s_waitcnt lgkmcnt(6)
 v_mul_f32 v234, v38, v38
 v_fmaak_f32 v234, v234, v223, 0xc0135761
 v_mfma_f32_16x16x32_bf16 v[144:147], a[248:251], a[64:67], v[144:147]
 s_waitcnt lgkmcnt(4)
 ds_read_b64_tr_b16 a[240:241], v11 offset:49152
 ds_read_b64_tr_b16 a[242:243], v11 offset:49408
 v_mfma_f32_16x16x32_bf16 v[144:147], a[252:255], a[80:83], v[144:147]
 v_mul_f32 v234, v234, v38
 v_mul_f32 v70, v38, v70
 v_mfma_f32_16x16x32_bf16 v[148:151], a[248:251], a[68:71], v[148:151]
 v_exp_f32 v234, v234
 v_mfma_f32_16x16x32_bf16 v[148:151], a[252:255], a[84:87], v[148:151]
 v_add_f32 v234, 1.0, v234
 v_mul_f32 v235, v39, v39
 v_mfma_f32_16x16x32_bf16 v[152:155], a[248:251], a[72:75], v[152:155]
 ds_read_b64_tr_b16 a[244:245], v11 offset:53248
 ds_read_b64_tr_b16 a[246:247], v11 offset:53504
 v_mfma_f32_16x16x32_bf16 v[152:155], a[252:255], a[88:91], v[152:155]
 v_rcp_f32 v234, v234
 v_mfma_f32_16x16x32_bf16 v[156:159], a[248:251], a[76:79], v[156:159]
 buffer_load_dwordx4 v5, s[28:31], s53 offen lds
 v_mfma_f32_16x16x32_bf16 v[156:159], a[252:255], a[92:95], v[156:159]
 s_waitcnt lgkmcnt(6)
 v_mul_f32 v70, v70, v234
 v_fmaak_f32 v235, v235, v223, 0xc0135761
 v_mfma_f32_16x16x32_bf16 v[96:99], a[232:235], a[96:99], v[96:99]
 s_waitcnt lgkmcnt(4)
 ds_read_b64_tr_b16 a[248:249], v10 offset:51200
 ds_read_b64_tr_b16 a[250:251], v10 offset:51456
 v_mfma_f32_16x16x32_bf16 v[96:99], a[236:239], a[112:115], v[96:99]
 s_add_u32 m0, s48, 0x10000
 v_mul_f32 v235, v235, v39
 v_mul_f32 v71, v39, v71
 v_mfma_f32_16x16x32_bf16 v[100:103], a[232:235], a[100:103], v[100:103]
 s_add_u32 s53, s51, 0x200000
 buffer_load_dwordx4 v5, s[28:31], s53 offen lds
 v_mfma_f32_16x16x32_bf16 v[100:103], a[236:239], a[116:119], v[100:103]
 v_exp_f32 v235, v235
 v_mfma_f32_16x16x32_bf16 v[104:107], a[232:235], a[104:107], v[104:107]
 ds_read_b64_tr_b16 a[252:253], v10 offset:55296
 ds_read_b64_tr_b16 a[254:255], v10 offset:55552
 v_mfma_f32_16x16x32_bf16 v[104:107], a[236:239], a[120:123], v[104:107]
 v_add_f32 v235, 1.0, v235
 v_mul_f32 v236, v52, v52
 v_mfma_f32_16x16x32_bf16 v[108:111], a[232:235], a[108:111], v[108:111]
 v_rcp_f32 v235, v235
 v_mfma_f32_16x16x32_bf16 v[108:111], a[236:239], a[124:127], v[108:111]
 s_waitcnt lgkmcnt(6)
 v_mul_f32 v71, v71, v235
 v_cvt_pk_bf16_f32 v245, v70, v71
 v_mfma_f32_16x16x32_bf16 v[112:115], a[240:243], a[96:99], v[112:115]
 s_waitcnt lgkmcnt(4)
 ds_read_b64_tr_b16 a[232:233], v11 offset:51200
 ds_read_b64_tr_b16 a[234:235], v11 offset:51456
 v_mfma_f32_16x16x32_bf16 v[112:115], a[244:247], a[112:115], v[112:115]
 v_fmaak_f32 v236, v236, v223, 0xc0135761
 v_mul_f32 v236, v236, v52
 v_mfma_f32_16x16x32_bf16 v[116:119], a[240:243], a[100:103], v[116:119]
 v_exp_f32 v236, v236
 v_mfma_f32_16x16x32_bf16 v[116:119], a[244:247], a[116:119], v[116:119]
 v_mul_f32 v84, v52, v84
 v_add_f32 v236, 1.0, v236
 v_mfma_f32_16x16x32_bf16 v[120:123], a[240:243], a[104:107], v[120:123]
 ds_read_b64_tr_b16 a[236:237], v11 offset:55296
 ds_read_b64_tr_b16 a[238:239], v11 offset:55552
 v_mfma_f32_16x16x32_bf16 v[120:123], a[244:247], a[120:123], v[120:123]
 v_rcp_f32 v236, v236
 v_mfma_f32_16x16x32_bf16 v[124:127], a[240:243], a[108:111], v[124:127]
 v_mul_f32 v84, v84, v236
 v_mul_f32 v237, v53, v53
 v_mfma_f32_16x16x32_bf16 v[124:127], a[244:247], a[124:127], v[124:127]
 s_waitcnt lgkmcnt(6)
 v_fmaak_f32 v237, v237, v223, 0xc0135761
 v_mul_f32 v237, v237, v53
 v_mfma_f32_16x16x32_bf16 v[128:131], a[248:251], a[96:99], v[128:131]
 s_waitcnt lgkmcnt(4)
 ds_read_b64_tr_b16 a[240:241], v10 offset:57344
 ds_read_b64_tr_b16 a[242:243], v10 offset:57600
 v_mfma_f32_16x16x32_bf16 v[128:131], a[252:255], a[112:115], v[128:131]
 s_add_u32 m0, s48, 0x11000
 v_exp_f32 v237, v237
 v_mfma_f32_16x16x32_bf16 v[132:135], a[248:251], a[100:103], v[132:135]
 s_add_u32 s53, s51, 0x240000
 buffer_load_dwordx4 v5, s[28:31], s53 offen lds
 v_mfma_f32_16x16x32_bf16 v[132:135], a[252:255], a[116:119], v[132:135]
 v_mul_f32 v85, v53, v85
 v_add_f32 v237, 1.0, v237
 v_mfma_f32_16x16x32_bf16 v[136:139], a[248:251], a[104:107], v[136:139]
 ds_read_b64_tr_b16 a[244:245], v10 offset:61440
 ds_read_b64_tr_b16 a[246:247], v10 offset:61696
 v_mfma_f32_16x16x32_bf16 v[136:139], a[252:255], a[120:123], v[136:139]
 v_rcp_f32 v237, v237
 v_mfma_f32_16x16x32_bf16 v[140:143], a[248:251], a[108:111], v[140:143]
 v_mul_f32 v85, v85, v237
 v_cvt_pk_bf16_f32 v246, v84, v85
 v_mfma_f32_16x16x32_bf16 v[140:143], a[252:255], a[124:127], v[140:143]
 s_waitcnt lgkmcnt(6)
 v_mul_f32 v238, v54, v54
 v_fmaak_f32 v238, v238, v223, 0xc0135761
 v_mfma_f32_16x16x32_bf16 v[144:147], a[232:235], a[96:99], v[144:147]
 s_waitcnt lgkmcnt(4)
 ds_read_b64_tr_b16 a[248:249], v11 offset:57344
 ds_read_b64_tr_b16 a[250:251], v11 offset:57600
 v_mfma_f32_16x16x32_bf16 v[144:147], a[236:239], a[112:115], v[144:147]
 v_mul_f32 v238, v238, v54
 v_mul_f32 v86, v54, v86
 v_mfma_f32_16x16x32_bf16 v[148:151], a[232:235], a[100:103], v[148:151]
 v_exp_f32 v238, v238
 v_mfma_f32_16x16x32_bf16 v[148:151], a[236:239], a[116:119], v[148:151]
 v_add_f32 v238, 1.0, v238
 v_mul_f32 v239, v55, v55
 v_mfma_f32_16x16x32_bf16 v[152:155], a[232:235], a[104:107], v[152:155]
 ds_read_b64_tr_b16 a[252:253], v11 offset:61440
 ds_read_b64_tr_b16 a[254:255], v11 offset:61696
 v_mfma_f32_16x16x32_bf16 v[152:155], a[236:239], a[120:123], v[152:155]
 v_rcp_f32 v238, v238
 v_mfma_f32_16x16x32_bf16 v[156:159], a[232:235], a[108:111], v[156:159]
 v_mul_f32 v86, v86, v238
 v_fmaak_f32 v239, v239, v223, 0xc0135761
 v_mfma_f32_16x16x32_bf16 v[156:159], a[236:239], a[124:127], v[156:159]
 s_waitcnt lgkmcnt(6)
 v_mul_f32 v239, v239, v55
 v_mul_f32 v87, v55, v87
 v_mfma_f32_16x16x32_bf16 v[96:99], a[240:243], a[128:131], v[96:99]
 s_waitcnt lgkmcnt(4)
 ds_read_b64_tr_b16 a[232:233], v10 offset:59392
 ds_read_b64_tr_b16 a[234:235], v10 offset:59648
 v_mfma_f32_16x16x32_bf16 v[96:99], a[244:247], a[144:147], v[96:99]
 s_add_u32 m0, s48, 0x12000
 v_exp_f32 v239, v239
 v_mfma_f32_16x16x32_bf16 v[100:103], a[240:243], a[132:135], v[100:103]
 s_add_u32 s53, s51, 0x280000
 v_add_f32 v239, 1.0, v239
 v_mul_f32 v224, v40, v40
 v_mfma_f32_16x16x32_bf16 v[100:103], a[244:247], a[148:151], v[100:103]
 v_rcp_f32 v239, v239
 v_mfma_f32_16x16x32_bf16 v[104:107], a[240:243], a[136:139], v[104:107]
 ds_read_b64_tr_b16 a[236:237], v10 offset:63488
 ds_read_b64_tr_b16 a[238:239], v10 offset:63744
 v_mfma_f32_16x16x32_bf16 v[104:107], a[244:247], a[152:155], v[104:107]
 v_mul_f32 v87, v87, v239
 v_cvt_pk_bf16_f32 v247, v86, v87
 v_mfma_f32_16x16x32_bf16 v[108:111], a[240:243], a[140:143], v[108:111]
 buffer_store_dwordx4 v[244:247], v2, s[36:39], s55 offen offset:1024 sc1
 v_mfma_f32_16x16x32_bf16 v[108:111], a[244:247], a[156:159], v[108:111]
 s_waitcnt lgkmcnt(6)
 v_fmaak_f32 v224, v224, v223, 0xc0135761
 v_mul_f32 v224, v224, v40
 v_mfma_f32_16x16x32_bf16 v[112:115], a[248:251], a[128:131], v[112:115]
 s_waitcnt lgkmcnt(4)
 ds_read_b64_tr_b16 a[240:241], v11 offset:59392
 ds_read_b64_tr_b16 a[242:243], v11 offset:59648
 v_mfma_f32_16x16x32_bf16 v[112:115], a[252:255], a[144:147], v[112:115]
 v_exp_f32 v224, v224
 v_mfma_f32_16x16x32_bf16 v[116:119], a[248:251], a[132:135], v[116:119]
 v_mul_f32 v72, v40, v72
 v_add_f32 v224, 1.0, v224
 v_mfma_f32_16x16x32_bf16 v[116:119], a[252:255], a[148:151], v[116:119]
 v_rcp_f32 v224, v224
 v_mfma_f32_16x16x32_bf16 v[120:123], a[248:251], a[136:139], v[120:123]
 ds_read_b64_tr_b16 a[244:245], v11 offset:63488
 ds_read_b64_tr_b16 a[246:247], v11 offset:63744
 v_mfma_f32_16x16x32_bf16 v[120:123], a[252:255], a[152:155], v[120:123]
 v_mul_f32 v72, v72, v224
 v_mul_f32 v225, v41, v41
 v_mfma_f32_16x16x32_bf16 v[124:127], a[248:251], a[140:143], v[124:127]
 v_fmaak_f32 v225, v225, v223, 0xc0135761
 v_mul_f32 v225, v225, v41
 v_mfma_f32_16x16x32_bf16 v[124:127], a[252:255], a[156:159], v[124:127]
 s_waitcnt lgkmcnt(6)
 v_exp_f32 v225, v225
 v_mfma_f32_16x16x32_bf16 v[128:131], a[232:235], a[128:131], v[128:131]
 s_waitcnt lgkmcnt(4)
 ds_read_b64_tr_b16 a[248:249], v6
 ds_read_b64_tr_b16 a[250:251], v6 offset:256
 v_mfma_f32_16x16x32_bf16 v[128:131], a[236:239], a[144:147], v[128:131]
 v_mul_f32 v73, v41, v73
 v_add_f32 v225, 1.0, v225
 v_mfma_f32_16x16x32_bf16 v[132:135], a[232:235], a[132:135], v[132:135]
 v_rcp_f32 v225, v225
 v_mfma_f32_16x16x32_bf16 v[132:135], a[236:239], a[148:151], v[132:135]
 v_mul_f32 v73, v73, v225
 v_cvt_pk_bf16_f32 v240, v72, v73
 v_mfma_f32_16x16x32_bf16 v[136:139], a[232:235], a[136:139], v[136:139]
 ds_read_b64_tr_b16 a[252:253], v6 offset:4096
 ds_read_b64_tr_b16 a[254:255], v6 offset:4352
 v_mfma_f32_16x16x32_bf16 v[136:139], a[236:239], a[152:155], v[136:139]
 v_mul_f32 v226, v42, v42
 v_fmaak_f32 v226, v226, v223, 0xc0135761
 v_mfma_f32_16x16x32_bf16 v[140:143], a[232:235], a[140:143], v[140:143]
 v_mul_f32 v226, v226, v42
 v_mul_f32 v74, v42, v74
 v_mfma_f32_16x16x32_bf16 v[140:143], a[236:239], a[156:159], v[140:143]
 s_waitcnt lgkmcnt(6)
 v_exp_f32 v226, v226
 v_mfma_f32_16x16x32_bf16 v[144:147], a[240:243], a[128:131], v[144:147]
 s_waitcnt lgkmcnt(4)
 ds_read_b64_tr_b16 a[232:233], v7
 ds_read_b64_tr_b16 a[234:235], v7 offset:256
 v_mfma_f32_16x16x32_bf16 v[144:147], a[244:247], a[144:147], v[144:147]
 v_add_f32 v226, 1.0, v226
 v_mul_f32 v227, v43, v43
 v_mfma_f32_16x16x32_bf16 v[148:151], a[240:243], a[132:135], v[148:151]
 v_rcp_f32 v226, v226
 v_mfma_f32_16x16x32_bf16 v[148:151], a[244:247], a[148:151], v[148:151]
 v_mul_f32 v74, v74, v226
 v_fmaak_f32 v227, v227, v223, 0xc0135761
 v_mfma_f32_16x16x32_bf16 v[152:155], a[240:243], a[136:139], v[152:155]
 buffer_load_dwordx4 v5, s[28:31], s53 offen lds
 v_mfma_f32_16x16x32_bf16 v[152:155], a[244:247], a[152:155], v[152:155]
 s_add_u32 m0, s48, 0x13000
 ds_read_b64_tr_b16 a[236:237], v7 offset:4096
 ds_read_b64_tr_b16 a[238:239], v7 offset:4352
 v_mfma_f32_16x16x32_bf16 v[156:159], a[240:243], a[140:143], v[156:159]
 s_add_u32 s53, s51, 0x2c0000
 buffer_load_dwordx4 v5, s[28:31], s53 offen lds
 v_mfma_f32_16x16x32_bf16 v[156:159], a[244:247], a[156:159], v[156:159]
 s_waitcnt lgkmcnt(6)
 v_mul_f32 v227, v227, v43
 v_mul_f32 v75, v43, v75
 v_mfma_f32_16x16x32_bf16 v[96:99], a[248:251], a[160:163], v[96:99]
 s_waitcnt lgkmcnt(4)
 ds_read_b64_tr_b16 a[240:241], v6 offset:2048
 ds_read_b64_tr_b16 a[242:243], v6 offset:2304
 v_mfma_f32_16x16x32_bf16 v[96:99], a[252:255], a[176:179], v[96:99]
 s_add_u32 m0, s48, 0x14000
 v_exp_f32 v227, v227
 v_mfma_f32_16x16x32_bf16 v[100:103], a[248:251], a[164:167], v[100:103]
 s_add_u32 s53, s51, 0x300000
 buffer_load_dwordx4 v5, s[28:31], s53 offen lds
 v_mfma_f32_16x16x32_bf16 v[100:103], a[252:255], a[180:183], v[100:103]
 v_add_f32 v227, 1.0, v227
 v_mul_f32 v228, v56, v56
 v_mfma_f32_16x16x32_bf16 v[104:107], a[248:251], a[168:171], v[104:107]
 ds_read_b64_tr_b16 a[244:245], v6 offset:6144
 ds_read_b64_tr_b16 a[246:247], v6 offset:6400
 v_mfma_f32_16x16x32_bf16 v[104:107], a[252:255], a[184:187], v[104:107]
 v_rcp_f32 v227, v227
 v_mfma_f32_16x16x32_bf16 v[108:111], a[248:251], a[172:175], v[108:111]
 v_mul_f32 v75, v75, v227
 v_cvt_pk_bf16_f32 v241, v74, v75
 v_mfma_f32_16x16x32_bf16 v[108:111], a[252:255], a[188:191], v[108:111]
 s_waitcnt lgkmcnt(6)
 v_fmaak_f32 v228, v228, v223, 0xc0135761
 v_mul_f32 v228, v228, v56
 v_mfma_f32_16x16x32_bf16 v[112:115], a[232:235], a[160:163], v[112:115]
 s_waitcnt lgkmcnt(4)
 ds_read_b64_tr_b16 a[248:249], v7 offset:2048
 ds_read_b64_tr_b16 a[250:251], v7 offset:2304
 v_mfma_f32_16x16x32_bf16 v[112:115], a[236:239], a[176:179], v[112:115]
 v_exp_f32 v228, v228
 v_mfma_f32_16x16x32_bf16 v[116:119], a[232:235], a[164:167], v[116:119]
 v_mul_f32 v88, v56, v88
 v_add_f32 v228, 1.0, v228
 v_mfma_f32_16x16x32_bf16 v[116:119], a[236:239], a[180:183], v[116:119]
 v_rcp_f32 v228, v228
 v_mfma_f32_16x16x32_bf16 v[120:123], a[232:235], a[168:171], v[120:123]
 ds_read_b64_tr_b16 a[252:253], v7 offset:6144
 ds_read_b64_tr_b16 a[254:255], v7 offset:6400
 v_mfma_f32_16x16x32_bf16 v[120:123], a[236:239], a[184:187], v[120:123]
 v_mul_f32 v88, v88, v228
 v_mul_f32 v229, v57, v57
 v_mfma_f32_16x16x32_bf16 v[124:127], a[232:235], a[172:175], v[124:127]
 v_fmaak_f32 v229, v229, v223, 0xc0135761
 v_mul_f32 v229, v229, v57
 v_mfma_f32_16x16x32_bf16 v[124:127], a[236:239], a[188:191], v[124:127]
 s_waitcnt lgkmcnt(6)
 v_exp_f32 v229, v229
 v_mfma_f32_16x16x32_bf16 v[128:131], a[240:243], a[160:163], v[128:131]
 s_waitcnt lgkmcnt(4)
 ds_read_b64_tr_b16 a[232:233], v6 offset:8192
 ds_read_b64_tr_b16 a[234:235], v6 offset:8448
 v_mfma_f32_16x16x32_bf16 v[128:131], a[244:247], a[176:179], v[128:131]
 s_add_u32 m0, s48, 0x15000
 v_mul_f32 v89, v57, v89
 v_add_f32 v229, 1.0, v229
 v_mfma_f32_16x16x32_bf16 v[132:135], a[240:243], a[164:167], v[132:135]
 s_add_u32 s53, s51, 0x340000
 buffer_load_dwordx4 v5, s[28:31], s53 offen lds
 v_mfma_f32_16x16x32_bf16 v[132:135], a[244:247], a[180:183], v[132:135]
 v_rcp_f32 v229, v229
 v_mfma_f32_16x16x32_bf16 v[136:139], a[240:243], a[168:171], v[136:139]
 ds_read_b64_tr_b16 a[236:237], v6 offset:12288
 ds_read_b64_tr_b16 a[238:239], v6 offset:12544
 v_mfma_f32_16x16x32_bf16 v[136:139], a[244:247], a[184:187], v[136:139]
 v_mul_f32 v89, v89, v229
 v_cvt_pk_bf16_f32 v242, v88, v89
 v_mfma_f32_16x16x32_bf16 v[140:143], a[240:243], a[172:175], v[140:143]
 v_mul_f32 v230, v58, v58
 v_fmaak_f32 v230, v230, v223, 0xc0135761
 v_mfma_f32_16x16x32_bf16 v[140:143], a[244:247], a[188:191], v[140:143]
 s_waitcnt lgkmcnt(6)
 v_mul_f32 v230, v230, v58
 v_mul_f32 v90, v58, v90
 v_mfma_f32_16x16x32_bf16 v[144:147], a[248:251], a[160:163], v[144:147]
 s_waitcnt lgkmcnt(4)
 ds_read_b64_tr_b16 a[240:241], v7 offset:8192
 ds_read_b64_tr_b16 a[242:243], v7 offset:8448
 v_mfma_f32_16x16x32_bf16 v[144:147], a[252:255], a[176:179], v[144:147]
 v_exp_f32 v230, v230
 v_mfma_f32_16x16x32_bf16 v[148:151], a[248:251], a[164:167], v[148:151]
 v_add_f32 v230, 1.0, v230
 v_mul_f32 v231, v59, v59
 v_mfma_f32_16x16x32_bf16 v[148:151], a[252:255], a[180:183], v[148:151]
 v_rcp_f32 v230, v230
 v_mfma_f32_16x16x32_bf16 v[152:155], a[248:251], a[168:171], v[152:155]
 ds_read_b64_tr_b16 a[244:245], v7 offset:12288
 ds_read_b64_tr_b16 a[246:247], v7 offset:12544
 v_mfma_f32_16x16x32_bf16 v[152:155], a[252:255], a[184:187], v[152:155]
 v_mul_f32 v90, v90, v230
 v_fmaak_f32 v231, v231, v223, 0xc0135761
 v_mfma_f32_16x16x32_bf16 v[156:159], a[248:251], a[172:175], v[156:159]
 v_mul_f32 v231, v231, v59
 v_mul_f32 v91, v59, v91
 v_mfma_f32_16x16x32_bf16 v[156:159], a[252:255], a[188:191], v[156:159]
 s_waitcnt lgkmcnt(6)
 v_exp_f32 v231, v231
 v_mfma_f32_16x16x32_bf16 v[96:99], a[232:235], a[192:195], v[96:99]
 s_waitcnt lgkmcnt(4)
 ds_read_b64_tr_b16 a[248:249], v6 offset:10240
 ds_read_b64_tr_b16 a[250:251], v6 offset:10496
 v_mfma_f32_16x16x32_bf16 v[96:99], a[236:239], a[208:211], v[96:99]
 s_add_u32 m0, s48, 0x16000
 v_add_f32 v231, 1.0, v231
 v_mul_f32 v232, v44, v44
 v_mfma_f32_16x16x32_bf16 v[100:103], a[232:235], a[196:199], v[100:103]
 s_add_u32 s53, s51, 0x380000
 v_rcp_f32 v231, v231
 v_mfma_f32_16x16x32_bf16 v[100:103], a[236:239], a[212:215], v[100:103]
 v_mul_f32 v91, v91, v231
 v_cvt_pk_bf16_f32 v243, v90, v91
 v_mfma_f32_16x16x32_bf16 v[104:107], a[232:235], a[200:203], v[104:107]
 buffer_store_dwordx4 v[240:243], v3, s[36:39], s55 offen sc1
 v_mfma_f32_16x16x32_bf16 v[104:107], a[236:239], a[216:219], v[104:107]
 ds_read_b64_tr_b16 a[252:253], v6 offset:14336
 ds_read_b64_tr_b16 a[254:255], v6 offset:14592
 v_mfma_f32_16x16x32_bf16 v[108:111], a[232:235], a[204:207], v[108:111]
 v_fmaak_f32 v232, v232, v223, 0xc0135761
 v_mul_f32 v232, v232, v44
 v_mfma_f32_16x16x32_bf16 v[108:111], a[236:239], a[220:223], v[108:111]
 s_waitcnt lgkmcnt(6)
 v_exp_f32 v232, v232
 v_mfma_f32_16x16x32_bf16 v[112:115], a[240:243], a[192:195], v[112:115]
 s_waitcnt lgkmcnt(4)
 ds_read_b64_tr_b16 a[232:233], v7 offset:10240
 ds_read_b64_tr_b16 a[234:235], v7 offset:10496
 v_mfma_f32_16x16x32_bf16 v[112:115], a[244:247], a[208:211], v[112:115]
 v_mul_f32 v76, v44, v76
 v_add_f32 v232, 1.0, v232
 v_mfma_f32_16x16x32_bf16 v[116:119], a[240:243], a[196:199], v[116:119]
 v_rcp_f32 v232, v232
 v_mfma_f32_16x16x32_bf16 v[116:119], a[244:247], a[212:215], v[116:119]
 v_mul_f32 v76, v76, v232
 v_mul_f32 v233, v45, v45
 v_mfma_f32_16x16x32_bf16 v[120:123], a[240:243], a[200:203], v[120:123]
 ds_read_b64_tr_b16 a[236:237], v7 offset:14336
 ds_read_b64_tr_b16 a[238:239], v7 offset:14592
 v_mfma_f32_16x16x32_bf16 v[120:123], a[244:247], a[216:219], v[120:123]
 v_fmaak_f32 v233, v233, v223, 0xc0135761
 v_mul_f32 v233, v233, v45
 v_mfma_f32_16x16x32_bf16 v[124:127], a[240:243], a[204:207], v[124:127]
 s_waitcnt vmcnt(11)
 v_exp_f32 v233, v233
 v_mfma_f32_16x16x32_bf16 v[124:127], a[244:247], a[220:223], v[124:127]
 s_barrier
 v_mul_f32 v77, v45, v77
 v_add_f32 v233, 1.0, v233
 s_waitcnt lgkmcnt(6)
 v_mfma_f32_16x16x32_bf16 v[128:131], a[248:251], a[192:195], v[128:131]
 s_waitcnt lgkmcnt(4)
 ds_read_b64_tr_b16 a[240:241], v6 offset:16384
 ds_read_b64_tr_b16 a[242:243], v6 offset:16640
 v_mfma_f32_16x16x32_bf16 v[128:131], a[252:255], a[208:211], v[128:131]
 v_rcp_f32 v233, v233
 v_mfma_f32_16x16x32_bf16 v[132:135], a[248:251], a[196:199], v[132:135]
 v_mul_f32 v77, v77, v233
 v_cvt_pk_bf16_f32 v244, v76, v77
 v_mfma_f32_16x16x32_bf16 v[132:135], a[252:255], a[212:215], v[132:135]
 v_mul_f32 v234, v46, v46
 v_fmaak_f32 v234, v234, v223, 0xc0135761
 v_mfma_f32_16x16x32_bf16 v[136:139], a[248:251], a[200:203], v[136:139]
 ds_read_b64_tr_b16 a[244:245], v6 offset:20480
 ds_read_b64_tr_b16 a[246:247], v6 offset:20736
 v_mfma_f32_16x16x32_bf16 v[136:139], a[252:255], a[216:219], v[136:139]
 v_mul_f32 v234, v234, v46
 v_mul_f32 v78, v46, v78
 v_mfma_f32_16x16x32_bf16 v[140:143], a[248:251], a[204:207], v[140:143]
 v_exp_f32 v234, v234
 v_mfma_f32_16x16x32_bf16 v[140:143], a[252:255], a[220:223], v[140:143]
 s_waitcnt lgkmcnt(6)
 v_add_f32 v234, 1.0, v234
 v_mul_f32 v235, v47, v47
 v_mfma_f32_16x16x32_bf16 v[144:147], a[232:235], a[192:195], v[144:147]
 s_waitcnt lgkmcnt(4)
 ds_read_b64_tr_b16 a[248:249], v7 offset:16384
 ds_read_b64_tr_b16 a[250:251], v7 offset:16640
 v_mfma_f32_16x16x32_bf16 v[144:147], a[236:239], a[208:211], v[144:147]
 v_rcp_f32 v234, v234
 v_mfma_f32_16x16x32_bf16 v[148:151], a[232:235], a[196:199], v[148:151]
 buffer_load_dwordx4 v5, s[28:31], s53 offen lds
 v_mfma_f32_16x16x32_bf16 v[148:151], a[236:239], a[212:215], v[148:151]
 s_add_u32 m0, s48, 0x17000
 v_mul_f32 v78, v78, v234
 v_fmaak_f32 v235, v235, v223, 0xc0135761
 v_mfma_f32_16x16x32_bf16 v[152:155], a[232:235], a[200:203], v[152:155]
 s_add_u32 s53, s51, 0x3c0000
 buffer_load_dwordx4 v5, s[28:31], s53 offen lds
 v_mfma_f32_16x16x32_bf16 v[152:155], a[236:239], a[216:219], v[152:155]
 ds_read_b64_tr_b16 a[252:253], v7 offset:20480
 ds_read_b64_tr_b16 a[254:255], v7 offset:20736
 v_mfma_f32_16x16x32_bf16 v[156:159], a[232:235], a[204:207], v[156:159]
 v_mul_f32 v235, v235, v47
 v_mul_f32 v79, v47, v79
 v_mfma_f32_16x16x32_bf16 v[156:159], a[236:239], a[220:223], v[156:159]
 s_waitcnt lgkmcnt(6)
 v_exp_f32 v235, v235
 v_mfma_f32_16x16x32_bf16 v[96:99], a[240:243], a[224:227], v[96:99]
 s_waitcnt lgkmcnt(4)
 ds_read_b64_tr_b16 a[232:233], v6 offset:18432
 ds_read_b64_tr_b16 a[234:235], v6 offset:18688
 v_mfma_f32_16x16x32_bf16 v[96:99], a[244:247], v[168:171], v[96:99]
 s_add_u32 m0, s48, 0x18000
 v_add_f32 v235, 1.0, v235
 v_mul_f32 v236, v60, v60
 v_mfma_f32_16x16x32_bf16 v[100:103], a[240:243], a[228:231], v[100:103]
 s_add_u32 s53, s51, 0x400000
 buffer_load_dwordx4 v5, s[28:31], s53 offen lds
 v_mfma_f32_16x16x32_bf16 v[100:103], a[244:247], v[172:175], v[100:103]
 v_rcp_f32 v235, v235
 v_mfma_f32_16x16x32_bf16 v[104:107], a[240:243], v[160:163], v[104:107]
 ds_read_b64_tr_b16 a[236:237], v6 offset:22528
 ds_read_b64_tr_b16 a[238:239], v6 offset:22784
 v_mfma_f32_16x16x32_bf16 v[104:107], a[244:247], v[176:179], v[104:107]
 v_mul_f32 v79, v79, v235
 v_cvt_pk_bf16_f32 v245, v78, v79
 v_mfma_f32_16x16x32_bf16 v[108:111], a[240:243], v[164:167], v[108:111]
 v_fmaak_f32 v236, v236, v223, 0xc0135761
 v_mul_f32 v236, v236, v60
 v_mfma_f32_16x16x32_bf16 v[108:111], a[244:247], v[180:183], v[108:111]
 s_waitcnt lgkmcnt(6)
 v_exp_f32 v236, v236
 v_mfma_f32_16x16x32_bf16 v[112:115], a[248:251], a[224:227], v[112:115]
 s_waitcnt lgkmcnt(4)
 ds_read_b64_tr_b16 a[240:241], v7 offset:18432
 ds_read_b64_tr_b16 a[242:243], v7 offset:18688
 v_mfma_f32_16x16x32_bf16 v[112:115], a[252:255], v[168:171], v[112:115]
 v_mul_f32 v92, v60, v92
 v_add_f32 v236, 1.0, v236
 v_mfma_f32_16x16x32_bf16 v[116:119], a[248:251], a[228:231], v[116:119]
 v_rcp_f32 v236, v236
 v_mfma_f32_16x16x32_bf16 v[116:119], a[252:255], v[172:175], v[116:119]
 v_mul_f32 v92, v92, v236
 v_mul_f32 v237, v61, v61
 v_mfma_f32_16x16x32_bf16 v[120:123], a[248:251], v[160:163], v[120:123]
 ds_read_b64_tr_b16 a[244:245], v7 offset:22528
 ds_read_b64_tr_b16 a[246:247], v7 offset:22784
 v_mfma_f32_16x16x32_bf16 v[120:123], a[252:255], v[176:179], v[120:123]
 v_fmaak_f32 v237, v237, v223, 0xc0135761
 v_mul_f32 v237, v237, v61
 v_mfma_f32_16x16x32_bf16 v[124:127], a[248:251], v[164:167], v[124:127]
 v_exp_f32 v237, v237
 v_mfma_f32_16x16x32_bf16 v[124:127], a[252:255], v[180:183], v[124:127]
 s_waitcnt lgkmcnt(6)
 v_mul_f32 v93, v61, v93
 v_add_f32 v237, 1.0, v237
 v_mfma_f32_16x16x32_bf16 v[128:131], a[232:235], a[224:227], v[128:131]
 s_waitcnt lgkmcnt(4)
 ds_read_b64_tr_b16 a[248:249], v6 offset:24576
 ds_read_b64_tr_b16 a[250:251], v6 offset:24832
 v_mfma_f32_16x16x32_bf16 v[128:131], a[236:239], v[168:171], v[128:131]
 s_add_u32 m0, s48, 0x19000
 v_rcp_f32 v237, v237
 v_mfma_f32_16x16x32_bf16 v[132:135], a[232:235], a[228:231], v[132:135]
 s_add_u32 s53, s51, 0x440000
 buffer_load_dwordx4 v5, s[28:31], s53 offen lds
 v_mfma_f32_16x16x32_bf16 v[132:135], a[236:239], v[172:175], v[132:135]
 v_mul_f32 v93, v93, v237
 v_cvt_pk_bf16_f32 v246, v92, v93
 v_mfma_f32_16x16x32_bf16 v[136:139], a[232:235], v[160:163], v[136:139]
 ds_read_b64_tr_b16 a[252:253], v6 offset:28672
 ds_read_b64_tr_b16 a[254:255], v6 offset:28928
 v_mfma_f32_16x16x32_bf16 v[136:139], a[236:239], v[176:179], v[136:139]
 v_mul_f32 v238, v62, v62
 v_fmaak_f32 v238, v238, v223, 0xc0135761
 v_mfma_f32_16x16x32_bf16 v[140:143], a[232:235], v[164:167], v[140:143]
 v_mul_f32 v238, v238, v62
 v_mul_f32 v94, v62, v94
 v_mfma_f32_16x16x32_bf16 v[140:143], a[236:239], v[180:183], v[140:143]
 s_waitcnt lgkmcnt(6)
 v_exp_f32 v238, v238
 v_mfma_f32_16x16x32_bf16 v[144:147], a[240:243], a[224:227], v[144:147]
 s_waitcnt lgkmcnt(4)
 ds_read_b64_tr_b16 a[232:233], v7 offset:24576
 ds_read_b64_tr_b16 a[234:235], v7 offset:24832
 v_mfma_f32_16x16x32_bf16 v[144:147], a[244:247], v[168:171], v[144:147]
 v_add_f32 v238, 1.0, v238
 v_mul_f32 v239, v63, v63
 v_mfma_f32_16x16x32_bf16 v[148:151], a[240:243], a[228:231], v[148:151]
 v_rcp_f32 v238, v238
 v_mfma_f32_16x16x32_bf16 v[148:151], a[244:247], v[172:175], v[148:151]
 v_mul_f32 v94, v94, v238
 v_fmaak_f32 v239, v239, v223, 0xc0135761
 v_mfma_f32_16x16x32_bf16 v[152:155], a[240:243], v[160:163], v[152:155]
 ds_read_b64_tr_b16 a[236:237], v7 offset:28672
 ds_read_b64_tr_b16 a[238:239], v7 offset:28928
 v_mfma_f32_16x16x32_bf16 v[152:155], a[244:247], v[176:179], v[152:155]
 v_mul_f32 v239, v239, v63
 v_mul_f32 v95, v63, v95
 v_mfma_f32_16x16x32_bf16 v[156:159], a[240:243], v[164:167], v[156:159]
 v_exp_f32 v239, v239
 v_mfma_f32_16x16x32_bf16 v[156:159], a[244:247], v[180:183], v[156:159]
 s_waitcnt lgkmcnt(6)
 v_add_f32 v239, 1.0, v239
 v_mfma_f32_16x16x32_bf16 v[96:99], a[248:251], v[184:187], v[96:99]
 s_waitcnt lgkmcnt(4)
 ds_read_b64_tr_b16 a[240:241], v6 offset:26624
 ds_read_b64_tr_b16 a[242:243], v6 offset:26880
 v_mfma_f32_16x16x32_bf16 v[96:99], a[252:255], v[200:203], v[96:99]
 s_add_u32 m0, s48, 0x1a000
 v_rcp_f32 v239, v239
 v_mfma_f32_16x16x32_bf16 v[100:103], a[248:251], v[188:191], v[100:103]
 s_add_u32 s53, s50, 0
 v_mul_f32 v95, v95, v239
 v_cvt_pk_bf16_f32 v247, v94, v95
 v_mfma_f32_16x16x32_bf16 v[100:103], a[252:255], v[204:207], v[100:103]
 buffer_store_dwordx4 v[244:247], v3, s[36:39], s55 offen offset:1024 sc1
 v_mfma_f32_16x16x32_bf16 v[104:107], a[248:251], v[192:195], v[104:107]
 ds_read_b64_tr_b16 a[244:245], v6 offset:30720
 ds_read_b64_tr_b16 a[246:247], v6 offset:30976
 v_mfma_f32_16x16x32_bf16 v[104:107], a[252:255], v[208:211], v[104:107]
 v_mfma_f32_16x16x32_bf16 v[108:111], a[248:251], v[196:199], v[108:111]
 v_mfma_f32_16x16x32_bf16 v[108:111], a[252:255], v[212:215], v[108:111]
 s_waitcnt lgkmcnt(6)
 v_mfma_f32_16x16x32_bf16 v[112:115], a[232:235], v[184:187], v[112:115]
 s_waitcnt lgkmcnt(4)
 ds_read_b64_tr_b16 a[248:249], v7 offset:26624
 ds_read_b64_tr_b16 a[250:251], v7 offset:26880
 v_mfma_f32_16x16x32_bf16 v[112:115], a[236:239], v[200:203], v[112:115]
 v_mfma_f32_16x16x32_bf16 v[116:119], a[232:235], v[188:191], v[116:119]
 v_mfma_f32_16x16x32_bf16 v[116:119], a[236:239], v[204:207], v[116:119]
 v_mfma_f32_16x16x32_bf16 v[120:123], a[232:235], v[192:195], v[120:123]
 ds_read_b64_tr_b16 a[252:253], v7 offset:30720
 ds_read_b64_tr_b16 a[254:255], v7 offset:30976
 v_mfma_f32_16x16x32_bf16 v[120:123], a[236:239], v[208:211], v[120:123]
 v_mfma_f32_16x16x32_bf16 v[124:127], a[232:235], v[196:199], v[124:127]
 v_mfma_f32_16x16x32_bf16 v[124:127], a[236:239], v[212:215], v[124:127]
 s_waitcnt lgkmcnt(6)
 v_mfma_f32_16x16x32_bf16 v[128:131], a[240:243], v[184:187], v[128:131]
 s_waitcnt lgkmcnt(4)
 ds_read_b64_tr_b16 a[232:233], v9 offset:32768
 ds_read_b64_tr_b16 a[234:235], v9 offset:33024
 v_mfma_f32_16x16x32_bf16 v[128:131], a[244:247], v[200:203], v[128:131]
 v_mfma_f32_16x16x32_bf16 v[132:135], a[240:243], v[188:191], v[132:135]
 v_mfma_f32_16x16x32_bf16 v[132:135], a[244:247], v[204:207], v[132:135]
 v_mfma_f32_16x16x32_bf16 v[136:139], a[240:243], v[192:195], v[136:139]
 ds_read_b64_tr_b16 a[236:237], v9 offset:36864
 ds_read_b64_tr_b16 a[238:239], v9 offset:37120
 v_mfma_f32_16x16x32_bf16 v[136:139], a[244:247], v[208:211], v[136:139]
 v_mfma_f32_16x16x32_bf16 v[140:143], a[240:243], v[196:199], v[140:143]
 v_mfma_f32_16x16x32_bf16 v[140:143], a[244:247], v[212:215], v[140:143]
 s_waitcnt lgkmcnt(6)
 v_mfma_f32_16x16x32_bf16 v[144:147], a[248:251], v[184:187], v[144:147]
 s_waitcnt lgkmcnt(4)
 ds_read_b64_tr_b16 a[240:241], v9 offset:32776
 ds_read_b64_tr_b16 a[242:243], v9 offset:33032
 v_mfma_f32_16x16x32_bf16 v[144:147], a[252:255], v[200:203], v[144:147]
 buffer_load_dwordx4 v4, s[32:35], s53 offen lds
 v_mfma_f32_16x16x32_bf16 v[148:151], a[248:251], v[188:191], v[148:151]
 s_add_u32 m0, s48, 0x1b000
 v_mfma_f32_16x16x32_bf16 v[148:151], a[252:255], v[204:207], v[148:151]
 s_add_u32 s53, s50, 0x48000
 buffer_load_dwordx4 v4, s[32:35], s53 offen lds
 v_mfma_f32_16x16x32_bf16 v[152:155], a[248:251], v[192:195], v[152:155]
 ds_read_b64_tr_b16 a[244:245], v9 offset:36872
 ds_read_b64_tr_b16 a[246:247], v9 offset:37128
 v_mfma_f32_16x16x32_bf16 v[152:155], a[252:255], v[208:211], v[152:155]
 v_mfma_f32_16x16x32_bf16 v[156:159], a[248:251], v[196:199], v[156:159]
 v_mfma_f32_16x16x32_bf16 v[156:159], a[252:255], v[212:215], v[156:159]
 s_waitcnt lgkmcnt(6)
 v_mfma_f32_16x16x32_bf16 v[32:35], a[232:235], a[0:3], 0
 s_waitcnt lgkmcnt(4)
 ds_read_b64_tr_b16 a[248:249], v9 offset:34816
 ds_read_b64_tr_b16 a[250:251], v9 offset:35072
 v_mfma_f32_16x16x32_bf16 v[32:35], a[236:239], a[16:19], v[32:35]
 s_add_u32 m0, s48, 0x1c000
 v_mfma_f32_16x16x32_bf16 v[40:43], a[232:235], a[4:7], 0
 s_add_u32 s53, s50, 0x90000
 buffer_load_dwordx4 v4, s[32:35], s53 offen lds
 v_mfma_f32_16x16x32_bf16 v[40:43], a[236:239], a[20:23], v[40:43]
 v_mul_f32 v224, v96, v96
 v_fmaak_f32 v224, v224, v223, 0xc0135761
 v_mfma_f32_16x16x32_bf16 v[48:51], a[232:235], a[8:11], 0
 ds_read_b64_tr_b16 a[252:253], v9 offset:38912
 ds_read_b64_tr_b16 a[254:255], v9 offset:39168
 v_mfma_f32_16x16x32_bf16 v[48:51], a[236:239], a[24:27], v[48:51]
 v_mul_f32 v224, v224, v96
 v_mfma_f32_16x16x32_bf16 v[56:59], a[232:235], a[12:15], 0
 v_exp_f32 v224, v224
 v_mfma_f32_16x16x32_bf16 v[56:59], a[236:239], a[28:31], v[56:59]
 s_waitcnt lgkmcnt(6)
 v_mul_f32 v128, v96, v128
 v_add_f32 v224, 1.0, v224
 v_mfma_f32_16x16x32_bf16 v[36:39], a[240:243], a[0:3], 0
 s_waitcnt lgkmcnt(4)
 ds_read_b64_tr_b16 a[232:233], v9 offset:34824
 ds_read_b64_tr_b16 a[234:235], v9 offset:35080
 v_mfma_f32_16x16x32_bf16 v[36:39], a[244:247], a[16:19], v[36:39]
 v_rcp_f32 v224, v224
 v_mfma_f32_16x16x32_bf16 v[44:47], a[240:243], a[4:7], 0
 v_mul_f32 v128, v128, v224
 v_mul_f32 v225, v97, v97
 v_mfma_f32_16x16x32_bf16 v[44:47], a[244:247], a[20:23], v[44:47]
 v_fmaak_f32 v225, v225, v223, 0xc0135761
 v_mfma_f32_16x16x32_bf16 v[52:55], a[240:243], a[8:11], 0
 ds_read_b64_tr_b16 a[236:237], v9 offset:38920
 ds_read_b64_tr_b16 a[238:239], v9 offset:39176
 v_mfma_f32_16x16x32_bf16 v[52:55], a[244:247], a[24:27], v[52:55]
 v_mul_f32 v225, v225, v97
 v_mul_f32 v129, v97, v129
 v_mfma_f32_16x16x32_bf16 v[60:63], a[240:243], a[12:15], 0
 v_exp_f32 v225, v225
 v_mfma_f32_16x16x32_bf16 v[60:63], a[244:247], a[28:31], v[60:63]
 s_waitcnt lgkmcnt(6)
 v_add_f32 v225, 1.0, v225
 v_mfma_f32_16x16x32_bf16 v[64:67], a[248:251], a[0:3], 0
 s_waitcnt lgkmcnt(4)
 ds_read_b64_tr_b16 a[240:241], v9 offset:40960
 ds_read_b64_tr_b16 a[242:243], v9 offset:41216
 v_mfma_f32_16x16x32_bf16 v[64:67], a[252:255], a[16:19], v[64:67]
 s_add_u32 m0, s48, 0x1d000
 v_rcp_f32 v225, v225
 v_mfma_f32_16x16x32_bf16 v[72:75], a[248:251], a[4:7], 0
 s_add_u32 s53, s50, 0xd8000
 buffer_load_dwordx4 v4, s[32:35], s53 offen lds
 v_mfma_f32_16x16x32_bf16 v[72:75], a[252:255], a[20:23], v[72:75]
 v_mul_f32 v129, v129, v225
 v_cvt_pk_bf16_f32 v240, v128, v129
 v_mfma_f32_16x16x32_bf16 v[80:83], a[248:251], a[8:11], 0
 ds_read_b64_tr_b16 a[244:245], v9 offset:45056
 ds_read_b64_tr_b16 a[246:247], v9 offset:45312
 v_mfma_f32_16x16x32_bf16 v[80:83], a[252:255], a[24:27], v[80:83]
 v_mul_f32 v226, v98, v98
 v_fmaak_f32 v226, v226, v223, 0xc0135761
 v_mfma_f32_16x16x32_bf16 v[88:91], a[248:251], a[12:15], 0
 v_mul_f32 v226, v226, v98
 v_mul_f32 v130, v98, v130
 v_mfma_f32_16x16x32_bf16 v[88:91], a[252:255], a[28:31], v[88:91]
 s_waitcnt lgkmcnt(6)
 v_exp_f32 v226, v226
 v_mfma_f32_16x16x32_bf16 v[68:71], a[232:235], a[0:3], 0
 s_waitcnt lgkmcnt(4)
 ds_read_b64_tr_b16 a[248:249], v9 offset:40968
 ds_read_b64_tr_b16 a[250:251], v9 offset:41224
 v_mfma_f32_16x16x32_bf16 v[68:71], a[236:239], a[16:19], v[68:71]
 v_add_f32 v226, 1.0, v226
 v_mul_f32 v227, v99, v99
 v_mfma_f32_16x16x32_bf16 v[76:79], a[232:235], a[4:7], 0
 v_rcp_f32 v226, v226
 v_mfma_f32_16x16x32_bf16 v[76:79], a[236:239], a[20:23], v[76:79]
 v_mul_f32 v130, v130, v226
 v_fmaak_f32 v227, v227, v223, 0xc0135761
 v_mfma_f32_16x16x32_bf16 v[84:87], a[232:235], a[8:11], 0
 ds_read_b64_tr_b16 a[252:253], v9 offset:45064
 ds_read_b64_tr_b16 a[254:255], v9 offset:45320
 v_mfma_f32_16x16x32_bf16 v[84:87], a[236:239], a[24:27], v[84:87]
 v_mul_f32 v227, v227, v99
 v_mul_f32 v131, v99, v131
 v_mfma_f32_16x16x32_bf16 v[92:95], a[232:235], a[12:15], 0
 v_exp_f32 v227, v227
 v_mfma_f32_16x16x32_bf16 v[92:95], a[236:239], a[28:31], v[92:95]
 s_waitcnt lgkmcnt(6)
 v_add_f32 v227, 1.0, v227
 v_mfma_f32_16x16x32_bf16 v[32:35], a[240:243], a[32:35], v[32:35]
 s_waitcnt lgkmcnt(4)
 ds_read_b64_tr_b16 a[232:233], v9 offset:43008
 ds_read_b64_tr_b16 a[234:235], v9 offset:43264
 v_mfma_f32_16x16x32_bf16 v[32:35], a[244:247], a[48:51], v[32:35]
 s_add_u32 m0, s48, 0x1e000
 v_rcp_f32 v227, v227
 v_mfma_f32_16x16x32_bf16 v[40:43], a[240:243], a[36:39], v[40:43]
 s_add_u32 s53, s50, 0x120000
 buffer_load_dwordx4 v4, s[32:35], s53 offen lds
 v_mfma_f32_16x16x32_bf16 v[40:43], a[244:247], a[52:55], v[40:43]
 v_mul_f32 v131, v131, v227
 v_cvt_pk_bf16_f32 v241, v130, v131
 v_mfma_f32_16x16x32_bf16 v[48:51], a[240:243], a[40:43], v[48:51]
 ds_read_b64_tr_b16 a[236:237], v9 offset:47104
 ds_read_b64_tr_b16 a[238:239], v9 offset:47360
 v_mfma_f32_16x16x32_bf16 v[48:51], a[244:247], a[56:59], v[48:51]
 v_mul_f32 v228, v112, v112
 v_fmaak_f32 v228, v228, v223, 0xc0135761
 v_mfma_f32_16x16x32_bf16 v[56:59], a[240:243], a[44:47], v[56:59]
 v_mul_f32 v228, v228, v112
 v_mul_f32 v144, v112, v144
 v_mfma_f32_16x16x32_bf16 v[56:59], a[244:247], a[60:63], v[56:59]
 s_waitcnt lgkmcnt(6)
 v_exp_f32 v228, v228
 v_mfma_f32_16x16x32_bf16 v[36:39], a[248:251], a[32:35], v[36:39]
 s_waitcnt lgkmcnt(4)
 ds_read_b64_tr_b16 a[240:241], v9 offset:43016
 ds_read_b64_tr_b16 a[242:243], v9 offset:43272
 v_mfma_f32_16x16x32_bf16 v[36:39], a[252:255], a[48:51], v[36:39]
 v_add_f32 v228, 1.0, v228
 v_mul_f32 v229, v113, v113
 v_mfma_f32_16x16x32_bf16 v[44:47], a[248:251], a[36:39], v[44:47]
 v_rcp_f32 v228, v228
 v_mfma_f32_16x16x32_bf16 v[44:47], a[252:255], a[52:55], v[44:47]
 v_mul_f32 v144, v144, v228
 v_fmaak_f32 v229, v229, v223, 0xc0135761
 v_mfma_f32_16x16x32_bf16 v[52:55], a[248:251], a[40:43], v[52:55]
 ds_read_b64_tr_b16 a[244:245], v9 offset:47112
 ds_read_b64_tr_b16 a[246:247], v9 offset:47368
 v_mfma_f32_16x16x32_bf16 v[52:55], a[252:255], a[56:59], v[52:55]
 v_mul_f32 v229, v229, v113
 v_mul_f32 v145, v113, v145
 v_mfma_f32_16x16x32_bf16 v[60:63], a[248:251], a[44:47], v[60:63]
 v_exp_f32 v229, v229
 v_mfma_f32_16x16x32_bf16 v[60:63], a[252:255], a[60:63], v[60:63]
 s_waitcnt lgkmcnt(6)
 v_add_f32 v229, 1.0, v229
 v_mfma_f32_16x16x32_bf16 v[64:67], a[232:235], a[32:35], v[64:67]
 s_waitcnt lgkmcnt(4)
 ds_read_b64_tr_b16 a[248:249], v9 offset:49152
 ds_read_b64_tr_b16 a[250:251], v9 offset:49408
 v_mfma_f32_16x16x32_bf16 v[64:67], a[236:239], a[48:51], v[64:67]
 s_add_u32 m0, s48, 0x1f000
 v_rcp_f32 v229, v229
 v_mfma_f32_16x16x32_bf16 v[72:75], a[232:235], a[36:39], v[72:75]
 s_add_u32 s53, s50, 0x168000
 buffer_load_dwordx4 v4, s[32:35], s53 offen lds
 v_mfma_f32_16x16x32_bf16 v[72:75], a[236:239], a[52:55], v[72:75]
 v_mul_f32 v145, v145, v229
 v_cvt_pk_bf16_f32 v242, v144, v145
 v_mfma_f32_16x16x32_bf16 v[80:83], a[232:235], a[40:43], v[80:83]
 ds_read_b64_tr_b16 a[252:253], v9 offset:53248
 ds_read_b64_tr_b16 a[254:255], v9 offset:53504
 v_mfma_f32_16x16x32_bf16 v[80:83], a[236:239], a[56:59], v[80:83]
 v_mul_f32 v230, v114, v114
 v_fmaak_f32 v230, v230, v223, 0xc0135761
 v_mfma_f32_16x16x32_bf16 v[88:91], a[232:235], a[44:47], v[88:91]
 v_mul_f32 v230, v230, v114
 v_mul_f32 v146, v114, v146
 v_mfma_f32_16x16x32_bf16 v[88:91], a[236:239], a[60:63], v[88:91]
 s_waitcnt lgkmcnt(6)
 v_exp_f32 v230, v230
 v_mfma_f32_16x16x32_bf16 v[68:71], a[240:243], a[32:35], v[68:71]
 s_waitcnt lgkmcnt(4)
 ds_read_b64_tr_b16 a[232:233], v9 offset:49160
 ds_read_b64_tr_b16 a[234:235], v9 offset:49416
 v_mfma_f32_16x16x32_bf16 v[68:71], a[244:247], a[48:51], v[68:71]
 v_add_f32 v230, 1.0, v230
 v_mul_f32 v231, v115, v115
 v_mfma_f32_16x16x32_bf16 v[76:79], a[240:243], a[36:39], v[76:79]
 v_rcp_f32 v230, v230
 v_mfma_f32_16x16x32_bf16 v[76:79], a[244:247], a[52:55], v[76:79]
 v_mul_f32 v146, v146, v230
 v_fmaak_f32 v231, v231, v223, 0xc0135761
 v_mfma_f32_16x16x32_bf16 v[84:87], a[240:243], a[40:43], v[84:87]
 ds_read_b64_tr_b16 a[236:237], v9 offset:53256
 ds_read_b64_tr_b16 a[238:239], v9 offset:53512
 v_mfma_f32_16x16x32_bf16 v[84:87], a[244:247], a[56:59], v[84:87]
 v_mul_f32 v231, v231, v115
 v_mul_f32 v147, v115, v147
 v_mfma_f32_16x16x32_bf16 v[92:95], a[240:243], a[44:47], v[92:95]
 v_exp_f32 v231, v231
 v_mfma_f32_16x16x32_bf16 v[92:95], a[244:247], a[60:63], v[92:95]
 s_waitcnt lgkmcnt(6)
 v_add_f32 v231, 1.0, v231
 v_mfma_f32_16x16x32_bf16 v[32:35], a[248:251], a[64:67], v[32:35]
 s_waitcnt lgkmcnt(4)
 ds_read_b64_tr_b16 a[240:241], v9 offset:51200
 ds_read_b64_tr_b16 a[242:243], v9 offset:51456
 v_mfma_f32_16x16x32_bf16 v[32:35], a[252:255], a[80:83], v[32:35]
 s_add_u32 m0, s48, 0
 v_rcp_f32 v231, v231
 v_mfma_f32_16x16x32_bf16 v[40:43], a[248:251], a[68:71], v[40:43]
 s_add_u32 s53, s50, 0x1b0000
 buffer_load_dwordx4 v4, s[32:35], s53 offen lds
 v_mfma_f32_16x16x32_bf16 v[40:43], a[252:255], a[84:87], v[40:43]
 s_add_u32 s55, s56, 0x1800
 v_mul_f32 v147, v147, v231
 v_cvt_pk_bf16_f32 v243, v146, v147
 v_mfma_f32_16x16x32_bf16 v[48:51], a[248:251], a[72:75], v[48:51]
 buffer_store_dwordx4 v[240:243], v2, s[36:39], s55 offen sc1
 v_mfma_f32_16x16x32_bf16 v[48:51], a[252:255], a[88:91], v[48:51]
 ds_read_b64_tr_b16 a[244:245], v9 offset:55296
 ds_read_b64_tr_b16 a[246:247], v9 offset:55552
 v_mfma_f32_16x16x32_bf16 v[56:59], a[248:251], a[76:79], v[56:59]
 v_mul_f32 v232, v100, v100
 v_fmaak_f32 v232, v232, v223, 0xc0135761
 v_mfma_f32_16x16x32_bf16 v[56:59], a[252:255], a[92:95], v[56:59]
 s_waitcnt lgkmcnt(6)
 v_mul_f32 v232, v232, v100
 v_mul_f32 v132, v100, v132
 v_mfma_f32_16x16x32_bf16 v[36:39], a[232:235], a[64:67], v[36:39]
 s_waitcnt lgkmcnt(4)
 ds_read_b64_tr_b16 a[248:249], v9 offset:51208
 ds_read_b64_tr_b16 a[250:251], v9 offset:51464
 v_mfma_f32_16x16x32_bf16 v[36:39], a[236:239], a[80:83], v[36:39]
 v_exp_f32 v232, v232
 v_mfma_f32_16x16x32_bf16 v[44:47], a[232:235], a[68:71], v[44:47]
 v_add_f32 v232, 1.0, v232
 v_mul_f32 v233, v101, v101
 v_mfma_f32_16x16x32_bf16 v[44:47], a[236:239], a[84:87], v[44:47]
 v_rcp_f32 v232, v232
 v_mfma_f32_16x16x32_bf16 v[52:55], a[232:235], a[72:75], v[52:55]
 ds_read_b64_tr_b16 a[252:253], v9 offset:55304
 ds_read_b64_tr_b16 a[254:255], v9 offset:55560
 v_mfma_f32_16x16x32_bf16 v[52:55], a[236:239], a[88:91], v[52:55]
 v_mul_f32 v132, v132, v232
 v_fmaak_f32 v233, v233, v223, 0xc0135761
 v_mfma_f32_16x16x32_bf16 v[60:63], a[232:235], a[76:79], v[60:63]
 s_waitcnt vmcnt(11)
 v_mul_f32 v233, v233, v101
 v_mul_f32 v133, v101, v133
 v_mfma_f32_16x16x32_bf16 v[60:63], a[236:239], a[92:95], v[60:63]
 s_barrier
 v_exp_f32 v233, v233
 s_waitcnt lgkmcnt(6)
 v_mfma_f32_16x16x32_bf16 v[64:67], a[240:243], a[64:67], v[64:67]
 s_waitcnt lgkmcnt(4)
 ds_read_b64_tr_b16 a[232:233], v9 offset:57344
 ds_read_b64_tr_b16 a[234:235], v9 offset:57600
 v_mfma_f32_16x16x32_bf16 v[64:67], a[244:247], a[80:83], v[64:67]
 s_add_u32 m0, s48, 0x1000
 v_add_f32 v233, 1.0, v233
 v_mfma_f32_16x16x32_bf16 v[72:75], a[240:243], a[68:71], v[72:75]
 s_add_u32 s53, s50, 0x1f8000
 v_rcp_f32 v233, v233
 v_mfma_f32_16x16x32_bf16 v[72:75], a[244:247], a[84:87], v[72:75]
 v_mul_f32 v133, v133, v233
 v_cvt_pk_bf16_f32 v244, v132, v133
 v_mfma_f32_16x16x32_bf16 v[80:83], a[240:243], a[72:75], v[80:83]
 ds_read_b64_tr_b16 a[236:237], v9 offset:61440
 ds_read_b64_tr_b16 a[238:239], v9 offset:61696
 v_mfma_f32_16x16x32_bf16 v[80:83], a[244:247], a[88:91], v[80:83]
 v_mul_f32 v234, v102, v102
 v_fmaak_f32 v234, v234, v223, 0xc0135761
 v_mfma_f32_16x16x32_bf16 v[88:91], a[240:243], a[76:79], v[88:91]
 v_mul_f32 v234, v234, v102
 v_mul_f32 v134, v102, v134
 v_mfma_f32_16x16x32_bf16 v[88:91], a[244:247], a[92:95], v[88:91]
 s_waitcnt lgkmcnt(6)
 v_exp_f32 v234, v234
 v_mfma_f32_16x16x32_bf16 v[68:71], a[248:251], a[64:67], v[68:71]
 s_waitcnt lgkmcnt(4)
 ds_read_b64_tr_b16 a[240:241], v9 offset:57352
 ds_read_b64_tr_b16 a[242:243], v9 offset:57608
 v_mfma_f32_16x16x32_bf16 v[68:71], a[252:255], a[80:83], v[68:71]
 v_add_f32 v234, 1.0, v234
 v_mul_f32 v235, v103, v103
 v_mfma_f32_16x16x32_bf16 v[76:79], a[248:251], a[68:71], v[76:79]
 buffer_load_dwordx4 v4, s[32:35], s53 offen lds
 v_mfma_f32_16x16x32_bf16 v[76:79], a[252:255], a[84:87], v[76:79]
 v_rcp_f32 v234, v234
 v_mfma_f32_16x16x32_bf16 v[84:87], a[248:251], a[72:75], v[84:87]
 ds_read_b64_tr_b16 a[244:245], v9 offset:61448
 ds_read_b64_tr_b16 a[246:247], v9 offset:61704
 v_mfma_f32_16x16x32_bf16 v[84:87], a[252:255], a[88:91], v[84:87]
 v_mul_f32 v134, v134, v234
 v_fmaak_f32 v235, v235, v223, 0xc0135761
 v_mfma_f32_16x16x32_bf16 v[92:95], a[248:251], a[76:79], v[92:95]
 v_mul_f32 v235, v235, v103
 v_mul_f32 v135, v103, v135
 v_mfma_f32_16x16x32_bf16 v[92:95], a[252:255], a[92:95], v[92:95]
 s_waitcnt lgkmcnt(6)
 v_exp_f32 v235, v235
 v_mfma_f32_16x16x32_bf16 v[32:35], a[232:235], a[96:99], v[32:35]
 s_waitcnt lgkmcnt(4)
 ds_read_b64_tr_b16 a[248:249], v9 offset:59392
 ds_read_b64_tr_b16 a[250:251], v9 offset:59648
 v_mfma_f32_16x16x32_bf16 v[32:35], a[236:239], a[112:115], v[32:35]
 s_add_u32 m0, s48, 0x2000
 v_add_f32 v235, 1.0, v235
 v_mul_f32 v236, v116, v116
 v_mfma_f32_16x16x32_bf16 v[40:43], a[232:235], a[100:103], v[40:43]
 s_add_u32 s53, s50, 0x240000
 buffer_load_dwordx4 v4, s[32:35], s53 offen lds
 v_mfma_f32_16x16x32_bf16 v[40:43], a[236:239], a[116:119], v[40:43]
 v_rcp_f32 v235, v235
 v_mfma_f32_16x16x32_bf16 v[48:51], a[232:235], a[104:107], v[48:51]
 ds_read_b64_tr_b16 a[252:253], v9 offset:63488
 ds_read_b64_tr_b16 a[254:255], v9 offset:63744
 v_mfma_f32_16x16x32_bf16 v[48:51], a[236:239], a[120:123], v[48:51]
 s_waitcnt lgkmcnt(6)
 v_mul_f32 v135, v135, v235
 v_cvt_pk_bf16_f32 v245, v134, v135
 v_mfma_f32_16x16x32_bf16 v[56:59], a[232:235], a[108:111], v[56:59]
 s_lshl_b32 s19, s17, 12
 v_fmaak_f32 v236, v236, v223, 0xc0135761
 v_mul_f32 v236, v236, v116
 v_mfma_f32_16x16x32_bf16 v[56:59], a[236:239], a[124:127], v[56:59]
 s_add_u32 s19, s19, s48
 buffer_load_dword v250, v2, s[20:23], s19 offen
 v_mfma_f32_16x16x32_bf16 v[36:39], a[240:243], a[96:99], v[36:39]
 s_waitcnt lgkmcnt(4)
 ds_read_b64_tr_b16 a[232:233], v9 offset:59400
 ds_read_b64_tr_b16 a[234:235], v9 offset:59656
 v_mfma_f32_16x16x32_bf16 v[36:39], a[244:247], a[112:115], v[36:39]
 v_exp_f32 v236, v236
 v_mfma_f32_16x16x32_bf16 v[44:47], a[240:243], a[100:103], v[44:47]
 v_mul_f32 v148, v116, v148
 v_add_f32 v236, 1.0, v236
 v_mfma_f32_16x16x32_bf16 v[44:47], a[244:247], a[116:119], v[44:47]
 v_rcp_f32 v236, v236
 v_mfma_f32_16x16x32_bf16 v[52:55], a[240:243], a[104:107], v[52:55]
 ds_read_b64_tr_b16 a[236:237], v9 offset:63496
 ds_read_b64_tr_b16 a[238:239], v9 offset:63752
 v_mfma_f32_16x16x32_bf16 v[52:55], a[244:247], a[120:123], v[52:55]
 v_mul_f32 v148, v148, v236
 v_mul_f32 v237, v117, v117
 v_mfma_f32_16x16x32_bf16 v[60:63], a[240:243], a[108:111], v[60:63]
 v_fmaak_f32 v237, v237, v223, 0xc0135761
 v_mul_f32 v237, v237, v117
 v_mfma_f32_16x16x32_bf16 v[60:63], a[244:247], a[124:127], v[60:63]
 s_waitcnt lgkmcnt(6)
 v_exp_f32 v237, v237
 v_mfma_f32_16x16x32_bf16 v[64:67], a[248:251], a[96:99], v[64:67]
 s_waitcnt lgkmcnt(4)
 ds_read_b64_tr_b16 a[240:241], v13
 ds_read_b64_tr_b16 a[242:243], v13 offset:256
 v_mfma_f32_16x16x32_bf16 v[64:67], a[252:255], a[112:115], v[64:67]
 s_add_u32 m0, s48, 0x3000
 v_mul_f32 v149, v117, v149
 v_add_f32 v237, 1.0, v237
 v_mfma_f32_16x16x32_bf16 v[72:75], a[248:251], a[100:103], v[72:75]
 s_add_u32 s53, s50, 0x288000
 buffer_load_dwordx4 v4, s[32:35], s53 offen lds
 v_mfma_f32_16x16x32_bf16 v[72:75], a[252:255], a[116:119], v[72:75]
 v_rcp_f32 v237, v237
 v_mfma_f32_16x16x32_bf16 v[80:83], a[248:251], a[104:107], v[80:83]
 ds_read_b64_tr_b16 a[244:245], v13 offset:4096
 ds_read_b64_tr_b16 a[246:247], v13 offset:4352
 v_mfma_f32_16x16x32_bf16 v[80:83], a[252:255], a[120:123], v[80:83]
 v_mul_f32 v149, v149, v237
 v_cvt_pk_bf16_f32 v246, v148, v149
 v_mfma_f32_16x16x32_bf16 v[88:91], a[248:251], a[108:111], v[88:91]
 v_mul_f32 v238, v118, v118
 v_fmaak_f32 v238, v238, v223, 0xc0135761
 v_mfma_f32_16x16x32_bf16 v[88:91], a[252:255], a[124:127], v[88:91]
 s_waitcnt lgkmcnt(6)
 v_mul_f32 v238, v238, v118
 v_mul_f32 v150, v118, v150
 v_mfma_f32_16x16x32_bf16 v[68:71], a[232:235], a[96:99], v[68:71]
 s_waitcnt lgkmcnt(4)
 ds_read_b64_tr_b16 a[248:249], v13 offset:8
 ds_read_b64_tr_b16 a[250:251], v13 offset:264
 v_mfma_f32_16x16x32_bf16 v[68:71], a[236:239], a[112:115], v[68:71]
 v_exp_f32 v238, v238
 v_mfma_f32_16x16x32_bf16 v[76:79], a[232:235], a[100:103], v[76:79]
 v_add_f32 v238, 1.0, v238
 v_mul_f32 v239, v119, v119
 v_mfma_f32_16x16x32_bf16 v[76:79], a[236:239], a[116:119], v[76:79]
 v_rcp_f32 v238, v238
 v_mfma_f32_16x16x32_bf16 v[84:87], a[232:235], a[104:107], v[84:87]
 ds_read_b64_tr_b16 a[252:253], v13 offset:4104
 ds_read_b64_tr_b16 a[254:255], v13 offset:4360
 v_mfma_f32_16x16x32_bf16 v[84:87], a[236:239], a[120:123], v[84:87]
 v_mul_f32 v150, v150, v238
 v_fmaak_f32 v239, v239, v223, 0xc0135761
 v_mfma_f32_16x16x32_bf16 v[92:95], a[232:235], a[108:111], v[92:95]
 v_mul_f32 v239, v239, v119
 v_mul_f32 v151, v119, v151
 v_mfma_f32_16x16x32_bf16 v[92:95], a[236:239], a[124:127], v[92:95]
 s_waitcnt lgkmcnt(6)
 v_exp_f32 v239, v239
 v_mfma_f32_16x16x32_bf16 v[32:35], a[240:243], a[128:131], v[32:35]
 s_waitcnt lgkmcnt(4)
 ds_read_b64_tr_b16 a[232:233], v13 offset:2048
 ds_read_b64_tr_b16 a[234:235], v13 offset:2304
 v_mfma_f32_16x16x32_bf16 v[32:35], a[244:247], a[144:147], v[32:35]
 s_add_u32 m0, s48, 0x4000
 v_add_f32 v239, 1.0, v239
 v_mul_f32 v224, v104, v104
 v_mfma_f32_16x16x32_bf16 v[40:43], a[240:243], a[132:135], v[40:43]
 s_add_u32 s53, s50, 0x2d0000
 v_rcp_f32 v239, v239
 v_mfma_f32_16x16x32_bf16 v[40:43], a[244:247], a[148:151], v[40:43]
 v_mul_f32 v151, v151, v239
 v_cvt_pk_bf16_f32 v247, v150, v151
 v_mfma_f32_16x16x32_bf16 v[48:51], a[240:243], a[136:139], v[48:51]
 buffer_store_dwordx4 v[244:247], v2, s[36:39], s55 offen offset:1024 sc1
 v_mfma_f32_16x16x32_bf16 v[48:51], a[244:247], a[152:155], v[48:51]
 ds_read_b64_tr_b16 a[236:237], v13 offset:6144
 ds_read_b64_tr_b16 a[238:239], v13 offset:6400
 v_mfma_f32_16x16x32_bf16 v[56:59], a[240:243], a[140:143], v[56:59]
 v_fmaak_f32 v224, v224, v223, 0xc0135761
 v_mul_f32 v224, v224, v104
 v_mfma_f32_16x16x32_bf16 v[56:59], a[244:247], a[156:159], v[56:59]
 s_waitcnt lgkmcnt(6)
 v_exp_f32 v224, v224
 v_mfma_f32_16x16x32_bf16 v[36:39], a[248:251], a[128:131], v[36:39]
 s_waitcnt lgkmcnt(4)
 ds_read_b64_tr_b16 a[240:241], v13 offset:2056
 ds_read_b64_tr_b16 a[242:243], v13 offset:2312
 v_mfma_f32_16x16x32_bf16 v[36:39], a[252:255], a[144:147], v[36:39]
 v_mul_f32 v136, v104, v136
 v_add_f32 v224, 1.0, v224
 v_mfma_f32_16x16x32_bf16 v[44:47], a[248:251], a[132:135], v[44:47]
 v_rcp_f32 v224, v224
 v_mfma_f32_16x16x32_bf16 v[44:47], a[252:255], a[148:151], v[44:47]
 v_mul_f32 v136, v136, v224
 v_mul_f32 v225, v105, v105
 v_mfma_f32_16x16x32_bf16 v[52:55], a[248:251], a[136:139], v[52:55]
 ds_read_b64_tr_b16 a[244:245], v13 offset:6152
 ds_read_b64_tr_b16 a[246:247], v13 offset:6408
 v_mfma_f32_16x16x32_bf16 v[52:55], a[252:255], a[152:155], v[52:55]
 v_fmaak_f32 v225, v225, v223, 0xc0135761
 v_mul_f32 v225, v225, v105
 v_mfma_f32_16x16x32_bf16 v[60:63], a[248:251], a[140:143], v[60:63]
 v_exp_f32 v225, v225
 v_mfma_f32_16x16x32_bf16 v[60:63], a[252:255], a[156:159], v[60:63]
 s_waitcnt lgkmcnt(6)
 v_mul_f32 v137, v105, v137
 v_add_f32 v225, 1.0, v225
 v_mfma_f32_16x16x32_bf16 v[64:67], a[232:235], a[128:131], v[64:67]
 s_waitcnt lgkmcnt(4)
 ds_read_b64_tr_b16 a[248:249], v13 offset:8192
 ds_read_b64_tr_b16 a[250:251], v13 offset:8448
 v_mfma_f32_16x16x32_bf16 v[64:67], a[236:239], a[144:147], v[64:67]
 v_rcp_f32 v225, v225
 v_mfma_f32_16x16x32_bf16 v[72:75], a[232:235], a[132:135], v[72:75]
 v_mul_f32 v137, v137, v225
 v_cvt_pk_bf16_f32 v240, v136, v137
 v_mfma_f32_16x16x32_bf16 v[72:75], a[236:239], a[148:151], v[72:75]
 v_mul_f32 v226, v106, v106
 v_fmaak_f32 v226, v226, v223, 0xc0135761
 v_mfma_f32_16x16x32_bf16 v[80:83], a[232:235], a[136:139], v[80:83]
 ds_read_b64_tr_b16 a[252:253], v13 offset:12288
 ds_read_b64_tr_b16 a[254:255], v13 offset:12544
 v_mfma_f32_16x16x32_bf16 v[80:83], a[236:239], a[152:155], v[80:83]
 v_mul_f32 v226, v226, v106
 v_mul_f32 v138, v106, v138
 v_mfma_f32_16x16x32_bf16 v[88:91], a[232:235], a[140:143], v[88:91]
 v_exp_f32 v226, v226
 v_mfma_f32_16x16x32_bf16 v[88:91], a[236:239], a[156:159], v[88:91]
 s_waitcnt lgkmcnt(6)
 v_add_f32 v226, 1.0, v226
 v_mfma_f32_16x16x32_bf16 v[68:71], a[240:243], a[128:131], v[68:71]
 s_waitcnt lgkmcnt(4)
 ds_read_b64_tr_b16 a[232:233], v13 offset:8200
 ds_read_b64_tr_b16 a[234:235], v13 offset:8456
 v_mfma_f32_16x16x32_bf16 v[68:71], a[244:247], a[144:147], v[68:71]
 v_rcp_f32 v226, v226
 v_mfma_f32_16x16x32_bf16 v[76:79], a[240:243], a[132:135], v[76:79]
 buffer_load_dwordx4 v4, s[32:35], s53 offen lds
 v_mfma_f32_16x16x32_bf16 v[76:79], a[244:247], a[148:151], v[76:79]
 s_add_u32 m0, s48, 0x5000
 buffer_load_dword v250, v2, s[24:27], s19 offen
 v_mfma_f32_16x16x32_bf16 v[84:87], a[240:243], a[136:139], v[84:87]
 s_add_u32 s53, s50, 0x318000
 buffer_load_dwordx4 v4, s[32:35], s53 offen lds
 v_mfma_f32_16x16x32_bf16 v[84:87], a[244:247], a[152:155], v[84:87]
 ds_read_b64_tr_b16 a[236:237], v13 offset:12296
 ds_read_b64_tr_b16 a[238:239], v13 offset:12552
 v_mfma_f32_16x16x32_bf16 v[92:95], a[240:243], a[140:143], v[92:95]
 v_mul_f32 v138, v138, v226
 v_mul_f32 v227, v107, v107
 v_mfma_f32_16x16x32_bf16 v[92:95], a[244:247], a[156:159], v[92:95]
 s_waitcnt lgkmcnt(6)
 v_fmaak_f32 v227, v227, v223, 0xc0135761
 v_mul_f32 v227, v227, v107
 v_mfma_f32_16x16x32_bf16 v[32:35], a[248:251], a[160:163], v[32:35]
 s_waitcnt lgkmcnt(4)
 ds_read_b64_tr_b16 a[240:241], v13 offset:10240
 ds_read_b64_tr_b16 a[242:243], v13 offset:10496
 v_mfma_f32_16x16x32_bf16 v[32:35], a[252:255], a[176:179], v[32:35]
 s_add_u32 m0, s48, 0x6000
 v_exp_f32 v227, v227
 v_mfma_f32_16x16x32_bf16 v[40:43], a[248:251], a[164:167], v[40:43]
 s_add_u32 s53, s50, 0x360000
 buffer_load_dwordx4 v4, s[32:35], s53 offen lds
 v_mfma_f32_16x16x32_bf16 v[40:43], a[252:255], a[180:183], v[40:43]
 v_mul_f32 v139, v107, v139
 v_add_f32 v227, 1.0, v227
 v_mfma_f32_16x16x32_bf16 v[48:51], a[248:251], a[168:171], v[48:51]
 ds_read_b64_tr_b16 a[244:245], v13 offset:14336
 ds_read_b64_tr_b16 a[246:247], v13 offset:14592
 v_mfma_f32_16x16x32_bf16 v[48:51], a[252:255], a[184:187], v[48:51]
 v_rcp_f32 v227, v227
 v_mfma_f32_16x16x32_bf16 v[56:59], a[248:251], a[172:175], v[56:59]
 v_mul_f32 v139, v139, v227
 v_cvt_pk_bf16_f32 v241, v138, v139
 v_mfma_f32_16x16x32_bf16 v[56:59], a[252:255], a[188:191], v[56:59]
 s_waitcnt lgkmcnt(6)
 v_mul_f32 v228, v120, v120
 v_fmaak_f32 v228, v228, v223, 0xc0135761
 v_mfma_f32_16x16x32_bf16 v[36:39], a[232:235], a[160:163], v[36:39]
 s_waitcnt lgkmcnt(4)
 ds_read_b64_tr_b16 a[248:249], v13 offset:10248
 ds_read_b64_tr_b16 a[250:251], v13 offset:10504
 v_mfma_f32_16x16x32_bf16 v[36:39], a[236:239], a[176:179], v[36:39]
 v_mul_f32 v228, v228, v120
 v_mul_f32 v152, v120, v152
 v_mfma_f32_16x16x32_bf16 v[44:47], a[232:235], a[164:167], v[44:47]
 v_exp_f32 v228, v228
 v_mfma_f32_16x16x32_bf16 v[44:47], a[236:239], a[180:183], v[44:47]
 v_add_f32 v228, 1.0, v228
 v_mul_f32 v229, v121, v121
 v_mfma_f32_16x16x32_bf16 v[52:55], a[232:235], a[168:171], v[52:55]
 ds_read_b64_tr_b16 a[252:253], v13 offset:14344
 ds_read_b64_tr_b16 a[254:255], v13 offset:14600
 v_mfma_f32_16x16x32_bf16 v[52:55], a[236:239], a[184:187], v[52:55]
 v_rcp_f32 v228, v228
 v_mfma_f32_16x16x32_bf16 v[60:63], a[232:235], a[172:175], v[60:63]
 v_mul_f32 v152, v152, v228
 v_fmaak_f32 v229, v229, v223, 0xc0135761
 v_mfma_f32_16x16x32_bf16 v[60:63], a[236:239], a[188:191], v[60:63]
 s_waitcnt lgkmcnt(6)
 v_mul_f32 v229, v229, v121
 v_mul_f32 v153, v121, v153
 v_mfma_f32_16x16x32_bf16 v[64:67], a[240:243], a[160:163], v[64:67]
 s_waitcnt lgkmcnt(4)
 ds_read_b64_tr_b16 a[232:233], v13 offset:16384
 ds_read_b64_tr_b16 a[234:235], v13 offset:16640
 v_mfma_f32_16x16x32_bf16 v[64:67], a[244:247], a[176:179], v[64:67]
 s_add_u32 m0, s48, 0x7000
 v_exp_f32 v229, v229
 v_mfma_f32_16x16x32_bf16 v[72:75], a[240:243], a[164:167], v[72:75]
 s_add_u32 s53, s50, 0x3a8000
 buffer_load_dwordx4 v4, s[32:35], s53 offen lds
 v_mfma_f32_16x16x32_bf16 v[72:75], a[244:247], a[180:183], v[72:75]
 v_add_f32 v229, 1.0, v229
 v_mul_f32 v230, v122, v122
 v_mfma_f32_16x16x32_bf16 v[80:83], a[240:243], a[168:171], v[80:83]
 ds_read_b64_tr_b16 a[236:237], v13 offset:20480
 ds_read_b64_tr_b16 a[238:239], v13 offset:20736
 v_mfma_f32_16x16x32_bf16 v[80:83], a[244:247], a[184:187], v[80:83]
 v_rcp_f32 v229, v229
 v_mfma_f32_16x16x32_bf16 v[88:91], a[240:243], a[172:175], v[88:91]
 v_mul_f32 v153, v153, v229
 v_cvt_pk_bf16_f32 v242, v152, v153
 v_mfma_f32_16x16x32_bf16 v[88:91], a[244:247], a[188:191], v[88:91]
 s_waitcnt lgkmcnt(6)
 v_fmaak_f32 v230, v230, v223, 0xc0135761
 v_mul_f32 v230, v230, v122
 v_mfma_f32_16x16x32_bf16 v[68:71], a[248:251], a[160:163], v[68:71]
 s_waitcnt lgkmcnt(4)
 ds_read_b64_tr_b16 a[240:241], v13 offset:16392
 ds_read_b64_tr_b16 a[242:243], v13 offset:16648
 v_mfma_f32_16x16x32_bf16 v[68:71], a[252:255], a[176:179], v[68:71]
 v_exp_f32 v230, v230
 v_mfma_f32_16x16x32_bf16 v[76:79], a[248:251], a[164:167], v[76:79]
 v_mul_f32 v154, v122, v154
 v_add_f32 v230, 1.0, v230
 v_mfma_f32_16x16x32_bf16 v[76:79], a[252:255], a[180:183], v[76:79]
 v_rcp_f32 v230, v230
 v_mfma_f32_16x16x32_bf16 v[84:87], a[248:251], a[168:171], v[84:87]
 ds_read_b64_tr_b16 a[244:245], v13 offset:20488
 ds_read_b64_tr_b16 a[246:247], v13 offset:20744
 v_mfma_f32_16x16x32_bf16 v[84:87], a[252:255], a[184:187], v[84:87]
 v_mul_f32 v154, v154, v230
 v_mul_f32 v231, v123, v123
 v_mfma_f32_16x16x32_bf16 v[92:95], a[248:251], a[172:175], v[92:95]
 v_fmaak_f32 v231, v231, v223, 0xc0135761
 v_mul_f32 v231, v231, v123
 v_mfma_f32_16x16x32_bf16 v[92:95], a[252:255], a[188:191], v[92:95]
 s_waitcnt lgkmcnt(6)
 v_exp_f32 v231, v231
 v_mfma_f32_16x16x32_bf16 v[32:35], a[232:235], a[192:195], v[32:35]
 s_waitcnt lgkmcnt(4)
 ds_read_b64_tr_b16 a[248:249], v13 offset:18432
 ds_read_b64_tr_b16 a[250:251], v13 offset:18688
 v_mfma_f32_16x16x32_bf16 v[32:35], a[236:239], a[208:211], v[32:35]
 s_add_u32 m0, s48, 0x8000
 v_mul_f32 v155, v123, v155
 v_add_f32 v231, 1.0, v231
 v_mfma_f32_16x16x32_bf16 v[40:43], a[232:235], a[196:199], v[40:43]
 s_add_u32 s53, s50, 0x3f0000
 v_rcp_f32 v231, v231
 v_mfma_f32_16x16x32_bf16 v[40:43], a[236:239], a[212:215], v[40:43]
 v_mul_f32 v155, v155, v231
 v_cvt_pk_bf16_f32 v243, v154, v155
 v_mfma_f32_16x16x32_bf16 v[48:51], a[232:235], a[200:203], v[48:51]
 buffer_store_dwordx4 v[240:243], v3, s[36:39], s55 offen sc1
 v_mfma_f32_16x16x32_bf16 v[48:51], a[236:239], a[216:219], v[48:51]
 ds_read_b64_tr_b16 a[252:253], v13 offset:22528
 ds_read_b64_tr_b16 a[254:255], v13 offset:22784
 v_mfma_f32_16x16x32_bf16 v[56:59], a[232:235], a[204:207], v[56:59]
 v_mul_f32 v232, v108, v108
 v_fmaak_f32 v232, v232, v223, 0xc0135761
 v_mfma_f32_16x16x32_bf16 v[56:59], a[236:239], a[220:223], v[56:59]
 s_waitcnt lgkmcnt(6)
 v_mul_f32 v232, v232, v108
 v_mul_f32 v140, v108, v140
 v_mfma_f32_16x16x32_bf16 v[36:39], a[240:243], a[192:195], v[36:39]
 s_waitcnt lgkmcnt(4)
 ds_read_b64_tr_b16 a[232:233], v13 offset:18440
 ds_read_b64_tr_b16 a[234:235], v13 offset:18696
 v_mfma_f32_16x16x32_bf16 v[36:39], a[244:247], a[208:211], v[36:39]
 v_exp_f32 v232, v232
 v_mfma_f32_16x16x32_bf16 v[44:47], a[240:243], a[196:199], v[44:47]
 v_add_f32 v232, 1.0, v232
 v_mul_f32 v233, v109, v109
 v_mfma_f32_16x16x32_bf16 v[44:47], a[244:247], a[212:215], v[44:47]
 v_rcp_f32 v232, v232
 v_mfma_f32_16x16x32_bf16 v[52:55], a[240:243], a[200:203], v[52:55]
 ds_read_b64_tr_b16 a[236:237], v13 offset:22536
 ds_read_b64_tr_b16 a[238:239], v13 offset:22792
 v_mfma_f32_16x16x32_bf16 v[52:55], a[244:247], a[216:219], v[52:55]
 v_mul_f32 v140, v140, v232
 v_fmaak_f32 v233, v233, v223, 0xc0135761
 v_mfma_f32_16x16x32_bf16 v[60:63], a[240:243], a[204:207], v[60:63]
 v_mul_f32 v233, v233, v109
 v_mul_f32 v141, v109, v141
 v_mfma_f32_16x16x32_bf16 v[60:63], a[244:247], a[220:223], v[60:63]
 s_waitcnt lgkmcnt(6)
 v_exp_f32 v233, v233
 v_mfma_f32_16x16x32_bf16 v[64:67], a[248:251], a[192:195], v[64:67]
 s_waitcnt lgkmcnt(4)
 ds_read_b64_tr_b16 a[240:241], v13 offset:24576
 ds_read_b64_tr_b16 a[242:243], v13 offset:24832
 v_mfma_f32_16x16x32_bf16 v[64:67], a[252:255], a[208:211], v[64:67]
 v_add_f32 v233, 1.0, v233
 v_mul_f32 v234, v110, v110
 v_mfma_f32_16x16x32_bf16 v[72:75], a[248:251], a[196:199], v[72:75]
 v_rcp_f32 v233, v233
 v_mfma_f32_16x16x32_bf16 v[72:75], a[252:255], a[212:215], v[72:75]
 v_mul_f32 v141, v141, v233
 v_cvt_pk_bf16_f32 v244, v140, v141
 v_mfma_f32_16x16x32_bf16 v[80:83], a[248:251], a[200:203], v[80:83]
 ds_read_b64_tr_b16 a[244:245], v13 offset:28672
 ds_read_b64_tr_b16 a[246:247], v13 offset:28928
 v_mfma_f32_16x16x32_bf16 v[80:83], a[252:255], a[216:219], v[80:83]
 v_fmaak_f32 v234, v234, v223, 0xc0135761
 v_mul_f32 v234, v234, v110
 v_mfma_f32_16x16x32_bf16 v[88:91], a[248:251], a[204:207], v[88:91]
 v_exp_f32 v234, v234
 v_mfma_f32_16x16x32_bf16 v[88:91], a[252:255], a[220:223], v[88:91]
 s_waitcnt lgkmcnt(6)
 v_mul_f32 v142, v110, v142
 v_add_f32 v234, 1.0, v234
 v_mfma_f32_16x16x32_bf16 v[68:71], a[232:235], a[192:195], v[68:71]
 s_waitcnt lgkmcnt(4)
 ds_read_b64_tr_b16 a[248:249], v13 offset:24584
 ds_read_b64_tr_b16 a[250:251], v13 offset:24840
 v_mfma_f32_16x16x32_bf16 v[68:71], a[236:239], a[208:211], v[68:71]
 v_rcp_f32 v234, v234
 v_mfma_f32_16x16x32_bf16 v[76:79], a[232:235], a[196:199], v[76:79]
 buffer_load_dwordx4 v4, s[32:35], s53 offen lds
 v_mfma_f32_16x16x32_bf16 v[76:79], a[236:239], a[212:215], v[76:79]
 s_add_u32 m0, s48, 0x9000
 v_mul_f32 v142, v142, v234
 v_mul_f32 v235, v111, v111
 v_mfma_f32_16x16x32_bf16 v[84:87], a[232:235], a[200:203], v[84:87]
 s_add_u32 s53, s50, 0x438000
 buffer_load_dwordx4 v4, s[32:35], s53 offen lds
 v_mfma_f32_16x16x32_bf16 v[84:87], a[236:239], a[216:219], v[84:87]
 ds_read_b64_tr_b16 a[252:253], v13 offset:28680
 ds_read_b64_tr_b16 a[254:255], v13 offset:28936
 v_mfma_f32_16x16x32_bf16 v[92:95], a[232:235], a[204:207], v[92:95]
 v_fmaak_f32 v235, v235, v223, 0xc0135761
 v_mul_f32 v235, v235, v111
 v_mfma_f32_16x16x32_bf16 v[92:95], a[236:239], a[220:223], v[92:95]
 s_waitcnt lgkmcnt(6)
 v_exp_f32 v235, v235
 v_mfma_f32_16x16x32_bf16 v[32:35], a[240:243], a[224:227], v[32:35]
 s_waitcnt lgkmcnt(4)
 ds_read_b64_tr_b16 a[232:233], v13 offset:26624
 ds_read_b64_tr_b16 a[234:235], v13 offset:26880
 v_mfma_f32_16x16x32_bf16 v[32:35], a[244:247], v[168:171], v[32:35]
 s_add_u32 m0, s48, 0xa000
 v_mul_f32 v143, v111, v143
 v_add_f32 v235, 1.0, v235
 v_mfma_f32_16x16x32_bf16 v[40:43], a[240:243], a[228:231], v[40:43]
 s_add_u32 s53, s50, 0x480000
 buffer_load_dwordx4 v4, s[32:35], s53 offen lds
 v_mfma_f32_16x16x32_bf16 v[40:43], a[244:247], v[172:175], v[40:43]
 v_rcp_f32 v235, v235
 v_mfma_f32_16x16x32_bf16 v[48:51], a[240:243], v[160:163], v[48:51]
 ds_read_b64_tr_b16 a[236:237], v13 offset:30720
 ds_read_b64_tr_b16 a[238:239], v13 offset:30976
 v_mfma_f32_16x16x32_bf16 v[48:51], a[244:247], v[176:179], v[48:51]
 v_mul_f32 v143, v143, v235
 v_cvt_pk_bf16_f32 v245, v142, v143
 v_mfma_f32_16x16x32_bf16 v[56:59], a[240:243], v[164:167], v[56:59]
 v_mul_f32 v236, v124, v124
 v_fmaak_f32 v236, v236, v223, 0xc0135761
 v_mfma_f32_16x16x32_bf16 v[56:59], a[244:247], v[180:183], v[56:59]
 s_waitcnt lgkmcnt(6)
 v_mul_f32 v236, v236, v124
 v_mul_f32 v156, v124, v156
 v_mfma_f32_16x16x32_bf16 v[36:39], a[248:251], a[224:227], v[36:39]
 s_waitcnt lgkmcnt(4)
 ds_read_b64_tr_b16 a[240:241], v13 offset:26632
 ds_read_b64_tr_b16 a[242:243], v13 offset:26888
 v_mfma_f32_16x16x32_bf16 v[36:39], a[252:255], v[168:171], v[36:39]
 v_exp_f32 v236, v236
 v_mfma_f32_16x16x32_bf16 v[44:47], a[248:251], a[228:231], v[44:47]
 v_add_f32 v236, 1.0, v236
 v_mul_f32 v237, v125, v125
 v_mfma_f32_16x16x32_bf16 v[44:47], a[252:255], v[172:175], v[44:47]
 v_rcp_f32 v236, v236
 v_mfma_f32_16x16x32_bf16 v[52:55], a[248:251], v[160:163], v[52:55]
 ds_read_b64_tr_b16 a[244:245], v13 offset:30728
 ds_read_b64_tr_b16 a[246:247], v13 offset:30984
 v_mfma_f32_16x16x32_bf16 v[52:55], a[252:255], v[176:179], v[52:55]
 v_mul_f32 v156, v156, v236
 v_fmaak_f32 v237, v237, v223, 0xc0135761
 v_mfma_f32_16x16x32_bf16 v[60:63], a[248:251], v[164:167], v[60:63]
 s_waitcnt vmcnt(13)
 v_mul_f32 v237, v237, v125
 v_mul_f32 v157, v125, v157
 v_mfma_f32_16x16x32_bf16 v[60:63], a[252:255], v[180:183], v[60:63]
 s_barrier
 v_exp_f32 v237, v237
 s_waitcnt lgkmcnt(6)
 v_mfma_f32_16x16x32_bf16 v[64:67], a[232:235], a[224:227], v[64:67]
 s_waitcnt lgkmcnt(4)
 ds_read_b64_tr_b16 a[248:249], v13 offset:32768
 ds_read_b64_tr_b16 a[250:251], v13 offset:33024
 v_mfma_f32_16x16x32_bf16 v[64:67], a[236:239], v[168:171], v[64:67]
 s_add_u32 m0, s48, 0xb000
 v_add_f32 v237, 1.0, v237
 v_mul_f32 v238, v126, v126
 v_mfma_f32_16x16x32_bf16 v[72:75], a[232:235], a[228:231], v[72:75]
 s_add_u32 s53, s50, 0x4c8000
 buffer_load_dwordx4 v4, s[32:35], s53 offen lds
 v_mfma_f32_16x16x32_bf16 v[72:75], a[236:239], v[172:175], v[72:75]
 v_rcp_f32 v237, v237
 v_mfma_f32_16x16x32_bf16 v[80:83], a[232:235], v[160:163], v[80:83]
 ds_read_b64_tr_b16 a[252:253], v13 offset:36864
 ds_read_b64_tr_b16 a[254:255], v13 offset:37120
 v_mfma_f32_16x16x32_bf16 v[80:83], a[236:239], v[176:179], v[80:83]
 v_mul_f32 v157, v157, v237
 v_cvt_pk_bf16_f32 v246, v156, v157
 v_mfma_f32_16x16x32_bf16 v[88:91], a[232:235], v[164:167], v[88:91]
 v_fmaak_f32 v238, v238, v223, 0xc0135761
 v_mul_f32 v238, v238, v126
 v_mfma_f32_16x16x32_bf16 v[88:91], a[236:239], v[180:183], v[88:91]
 s_waitcnt lgkmcnt(6)
 v_exp_f32 v238, v238
 v_mfma_f32_16x16x32_bf16 v[68:71], a[240:243], a[224:227], v[68:71]
 s_waitcnt lgkmcnt(4)
 ds_read_b64_tr_b16 a[232:233], v13 offset:32776
 ds_read_b64_tr_b16 a[234:235], v13 offset:33032
 v_mfma_f32_16x16x32_bf16 v[68:71], a[244:247], v[168:171], v[68:71]
 v_mul_f32 v158, v126, v158
 v_add_f32 v238, 1.0, v238
 v_mfma_f32_16x16x32_bf16 v[76:79], a[240:243], a[228:231], v[76:79]
 v_rcp_f32 v238, v238
 v_mfma_f32_16x16x32_bf16 v[76:79], a[244:247], v[172:175], v[76:79]
 v_mul_f32 v158, v158, v238
 v_mul_f32 v239, v127, v127
 v_mfma_f32_16x16x32_bf16 v[84:87], a[240:243], v[160:163], v[84:87]
 ds_read_b64_tr_b16 a[236:237], v13 offset:36872
 ds_read_b64_tr_b16 a[238:239], v13 offset:37128
 v_mfma_f32_16x16x32_bf16 v[84:87], a[244:247], v[176:179], v[84:87]
 v_fmaak_f32 v239, v239, v223, 0xc0135761
 v_mul_f32 v239, v239, v127
 v_mfma_f32_16x16x32_bf16 v[92:95], a[240:243], v[164:167], v[92:95]
 v_exp_f32 v239, v239
 v_mfma_f32_16x16x32_bf16 v[92:95], a[244:247], v[180:183], v[92:95]
 s_waitcnt lgkmcnt(6)
 v_mul_f32 v159, v127, v159
 v_add_f32 v239, 1.0, v239
 v_mfma_f32_16x16x32_bf16 v[32:35], a[248:251], v[184:187], v[32:35]
 s_waitcnt lgkmcnt(4)
 ds_read_b64_tr_b16 a[240:241], v13 offset:34816
 ds_read_b64_tr_b16 a[242:243], v13 offset:35072
 v_mfma_f32_16x16x32_bf16 v[32:35], a[252:255], v[200:203], v[32:35]
 s_add_u32 m0, s48, 0xc000
 v_rcp_f32 v239, v239
 v_mfma_f32_16x16x32_bf16 v[40:43], a[248:251], v[188:191], v[40:43]
 s_add_u32 s53, s51, 0x80
 v_mul_f32 v159, v159, v239
 v_cvt_pk_bf16_f32 v247, v158, v159
 v_mfma_f32_16x16x32_bf16 v[40:43], a[252:255], v[204:207], v[40:43]
 buffer_store_dwordx4 v[244:247], v3, s[36:39], s55 offen offset:1024 sc1
 v_mfma_f32_16x16x32_bf16 v[48:51], a[248:251], v[192:195], v[48:51]
 ds_read_b64_tr_b16 a[244:245], v13 offset:38912
 ds_read_b64_tr_b16 a[246:247], v13 offset:39168
 v_mfma_f32_16x16x32_bf16 v[48:51], a[252:255], v[208:211], v[48:51]
 v_mfma_f32_16x16x32_bf16 v[56:59], a[248:251], v[196:199], v[56:59]
 v_mfma_f32_16x16x32_bf16 v[56:59], a[252:255], v[212:215], v[56:59]
 s_waitcnt lgkmcnt(6)
 v_mfma_f32_16x16x32_bf16 v[36:39], a[232:235], v[184:187], v[36:39]
 s_waitcnt lgkmcnt(4)
 ds_read_b64_tr_b16 a[248:249], v13 offset:34824
 ds_read_b64_tr_b16 a[250:251], v13 offset:35080
 v_mfma_f32_16x16x32_bf16 v[36:39], a[236:239], v[200:203], v[36:39]
 v_mfma_f32_16x16x32_bf16 v[44:47], a[232:235], v[188:191], v[44:47]
 v_mfma_f32_16x16x32_bf16 v[44:47], a[236:239], v[204:207], v[44:47]
 v_mfma_f32_16x16x32_bf16 v[52:55], a[232:235], v[192:195], v[52:55]
 ds_read_b64_tr_b16 a[252:253], v13 offset:38920
 ds_read_b64_tr_b16 a[254:255], v13 offset:39176
 v_mfma_f32_16x16x32_bf16 v[52:55], a[236:239], v[208:211], v[52:55]
 v_mfma_f32_16x16x32_bf16 v[60:63], a[232:235], v[196:199], v[60:63]
 v_mfma_f32_16x16x32_bf16 v[60:63], a[236:239], v[212:215], v[60:63]
 s_waitcnt lgkmcnt(6)
 v_mfma_f32_16x16x32_bf16 v[64:67], a[240:243], v[184:187], v[64:67]
 s_waitcnt lgkmcnt(4)
 ds_read_b64_tr_b16 a[232:233], v12 offset:40960
 ds_read_b64_tr_b16 a[234:235], v12 offset:41216
 v_mfma_f32_16x16x32_bf16 v[64:67], a[244:247], v[200:203], v[64:67]
 v_mfma_f32_16x16x32_bf16 v[72:75], a[240:243], v[188:191], v[72:75]
 v_mfma_f32_16x16x32_bf16 v[72:75], a[244:247], v[204:207], v[72:75]
 v_mfma_f32_16x16x32_bf16 v[80:83], a[240:243], v[192:195], v[80:83]
 ds_read_b64_tr_b16 a[236:237], v12 offset:45056
 ds_read_b64_tr_b16 a[238:239], v12 offset:45312
 v_mfma_f32_16x16x32_bf16 v[80:83], a[244:247], v[208:211], v[80:83]
 v_mfma_f32_16x16x32_bf16 v[88:91], a[240:243], v[196:199], v[88:91]
 v_mfma_f32_16x16x32_bf16 v[88:91], a[244:247], v[212:215], v[88:91]
 s_waitcnt lgkmcnt(6)
 v_mfma_f32_16x16x32_bf16 v[68:71], a[248:251], v[184:187], v[68:71]
 s_waitcnt lgkmcnt(4)
 ds_read_b64_tr_b16 a[240:241], v12 offset:43008
 ds_read_b64_tr_b16 a[242:243], v12 offset:43264
 v_mfma_f32_16x16x32_bf16 v[68:71], a[252:255], v[200:203], v[68:71]
 buffer_load_dwordx4 v5, s[28:31], s53 offen lds
 v_mfma_f32_16x16x32_bf16 v[76:79], a[248:251], v[188:191], v[76:79]
 s_add_u32 m0, s48, 0xd000
 v_mfma_f32_16x16x32_bf16 v[76:79], a[252:255], v[204:207], v[76:79]
 s_add_u32 s53, s51, 0x40080
 buffer_load_dwordx4 v5, s[28:31], s53 offen lds
 v_mfma_f32_16x16x32_bf16 v[84:87], a[248:251], v[192:195], v[84:87]
 ds_read_b64_tr_b16 a[244:245], v12 offset:47104
 ds_read_b64_tr_b16 a[246:247], v12 offset:47360
 v_mfma_f32_16x16x32_bf16 v[84:87], a[252:255], v[208:211], v[84:87]
 v_mfma_f32_16x16x32_bf16 v[92:95], a[248:251], v[196:199], v[92:95]
 v_mfma_f32_16x16x32_bf16 v[92:95], a[252:255], v[212:215], v[92:95]
 s_waitcnt lgkmcnt(6)
 v_mfma_f32_16x16x32_bf16 v[128:131], a[232:235], a[0:3], 0
 s_waitcnt lgkmcnt(4)
 ds_read_b64_tr_b16 a[248:249], v12 offset:49152
 ds_read_b64_tr_b16 a[250:251], v12 offset:49408
 v_mfma_f32_16x16x32_bf16 v[128:131], a[236:239], a[16:19], v[128:131]
 s_add_u32 m0, s48, 0xe000
 v_mfma_f32_16x16x32_bf16 v[132:135], a[232:235], a[4:7], 0
 s_add_u32 s53, s51, 0x80080
 buffer_load_dwordx4 v5, s[28:31], s53 offen lds
 v_mfma_f32_16x16x32_bf16 v[132:135], a[236:239], a[20:23], v[132:135]
 v_mul_f32 v32, 0x3e0293ee, v32
 v_mfma_f32_16x16x32_bf16 v[136:139], a[232:235], a[8:11], 0
 ds_read_b64_tr_b16 a[252:253], v12 offset:53248
 ds_read_b64_tr_b16 a[254:255], v12 offset:53504
 v_mfma_f32_16x16x32_bf16 v[136:139], a[236:239], a[24:27], v[136:139]
 v_mul_f32 v33, 0x3e0293ee, v33
 v_cvt_pk_bf16_f32 v32, v32, v33
 v_mfma_f32_16x16x32_bf16 v[140:143], a[232:235], a[12:15], 0
 v_mul_f32 v34, 0x3e0293ee, v34
 v_mfma_f32_16x16x32_bf16 v[140:143], a[236:239], a[28:31], v[140:143]
 s_waitcnt lgkmcnt(6)
 v_mul_f32 v35, 0x3e0293ee, v35
 v_mfma_f32_16x16x32_bf16 v[144:147], a[240:243], a[0:3], 0
 s_waitcnt lgkmcnt(4)
 ds_read_b64_tr_b16 a[232:233], v12 offset:51200
 ds_read_b64_tr_b16 a[234:235], v12 offset:51456
 v_mfma_f32_16x16x32_bf16 v[144:147], a[244:247], a[16:19], v[144:147]
 s_add_u32 m0, s48, 0xf000
 v_cvt_pk_bf16_f32 v33, v34, v35
 v_mul_f32 v36, 0x3e0293ee, v36
 v_mfma_f32_16x16x32_bf16 v[148:151], a[240:243], a[4:7], 0
 s_add_u32 s53, s51, 0xc0080
 buffer_load_dwordx4 v5, s[28:31], s53 offen lds
 v_mfma_f32_16x16x32_bf16 v[148:151], a[244:247], a[20:23], v[148:151]
 v_mul_f32 v37, 0x3e0293ee, v37
 v_cvt_pk_bf16_f32 v34, v36, v37
 v_mfma_f32_16x16x32_bf16 v[152:155], a[240:243], a[8:11], 0
 ds_read_b64_tr_b16 a[236:237], v12 offset:55296
 ds_read_b64_tr_b16 a[238:239], v12 offset:55552
 v_mfma_f32_16x16x32_bf16 v[152:155], a[244:247], a[24:27], v[152:155]
 v_mul_f32 v38, 0x3e0293ee, v38
 v_mul_f32 v39, 0x3e0293ee, v39
 v_mfma_f32_16x16x32_bf16 v[156:159], a[240:243], a[12:15], 0
 v_cvt_pk_bf16_f32 v35, v38, v39
 v_mfma_f32_16x16x32_bf16 v[156:159], a[244:247], a[28:31], v[156:159]
 s_waitcnt lgkmcnt(6)
 v_mul_f32 v40, 0x3e0293ee, v40
 v_mfma_f32_16x16x32_bf16 v[128:131], a[248:251], a[32:35], v[128:131]
 s_waitcnt lgkmcnt(4)
 ds_read_b64_tr_b16 a[240:241], v12 offset:57344
 ds_read_b64_tr_b16 a[242:243], v12 offset:57600
 v_mfma_f32_16x16x32_bf16 v[128:131], a[252:255], a[48:51], v[128:131]
 s_add_u32 m0, s48, 0x10000
 v_mul_f32 v41, 0x3e0293ee, v41
 v_cvt_pk_bf16_f32 v36, v40, v41
 v_mfma_f32_16x16x32_bf16 v[132:135], a[248:251], a[36:39], v[132:135]
 s_add_u32 s53, s51, 0x100080
 buffer_load_dwordx4 v5, s[28:31], s53 offen lds
 v_mfma_f32_16x16x32_bf16 v[132:135], a[252:255], a[52:55], v[132:135]
 v_mul_f32 v42, 0x3e0293ee, v42
 v_mul_f32 v43, 0x3e0293ee, v43
 v_mfma_f32_16x16x32_bf16 v[136:139], a[248:251], a[40:43], v[136:139]
 ds_read_b64_tr_b16 a[244:245], v12 offset:61440
 ds_read_b64_tr_b16 a[246:247], v12 offset:61696
 v_mfma_f32_16x16x32_bf16 v[136:139], a[252:255], a[56:59], v[136:139]
 v_cvt_pk_bf16_f32 v37, v42, v43
 v_mul_f32 v44, 0x3e0293ee, v44
 v_mfma_f32_16x16x32_bf16 v[140:143], a[248:251], a[44:47], v[140:143]
 v_mul_f32 v45, 0x3e0293ee, v45
 v_mfma_f32_16x16x32_bf16 v[140:143], a[252:255], a[60:63], v[140:143]
 s_waitcnt lgkmcnt(6)
 v_cvt_pk_bf16_f32 v38, v44, v45
 v_mfma_f32_16x16x32_bf16 v[144:147], a[232:235], a[32:35], v[144:147]
 s_waitcnt lgkmcnt(4)
 ds_read_b64_tr_b16 a[248:249], v12 offset:59392
 ds_read_b64_tr_b16 a[250:251], v12 offset:59648
 v_mfma_f32_16x16x32_bf16 v[144:147], a[236:239], a[48:51], v[144:147]
 s_add_u32 m0, s48, 0x11000
 v_mul_f32 v46, 0x3e0293ee, v46
 v_mul_f32 v47, 0x3e0293ee, v47
 v_mfma_f32_16x16x32_bf16 v[148:151], a[232:235], a[36:39], v[148:151]
 s_add_u32 s53, s51, 0x140080
 buffer_load_dwordx4 v5, s[28:31], s53 offen lds
 v_mfma_f32_16x16x32_bf16 v[148:151], a[236:239], a[52:55], v[148:151]
 v_cvt_pk_bf16_f32 v39, v46, v47
 v_mul_f32 v48, 0x3e0293ee, v48
 v_mfma_f32_16x16x32_bf16 v[152:155], a[232:235], a[40:43], v[152:155]
 ds_read_b64_tr_b16 a[252:253], v12 offset:63488
 ds_read_b64_tr_b16 a[254:255], v12 offset:63744
 v_mfma_f32_16x16x32_bf16 v[152:155], a[236:239], a[56:59], v[152:155]
 v_mul_f32 v49, 0x3e0293ee, v49
 v_cvt_pk_bf16_f32 v40, v48, v49
 v_mfma_f32_16x16x32_bf16 v[156:159], a[232:235], a[44:47], v[156:159]
 v_mul_f32 v50, 0x3e0293ee, v50
 v_mfma_f32_16x16x32_bf16 v[156:159], a[236:239], a[60:63], v[156:159]
 s_waitcnt lgkmcnt(6)
 v_mul_f32 v51, 0x3e0293ee, v51
 v_mfma_f32_16x16x32_bf16 v[128:131], a[240:243], a[64:67], v[128:131]
 s_waitcnt lgkmcnt(4)
 ds_read_b64_tr_b16 a[232:233], v8
 ds_read_b64_tr_b16 a[234:235], v8 offset:256
 v_mfma_f32_16x16x32_bf16 v[128:131], a[244:247], a[80:83], v[128:131]
 s_add_u32 m0, s48, 0x12000
 v_cvt_pk_bf16_f32 v41, v50, v51
 v_mul_f32 v52, 0x3e0293ee, v52
 v_mfma_f32_16x16x32_bf16 v[132:135], a[240:243], a[68:71], v[132:135]
 s_add_u32 s53, s51, 0x180080
 buffer_load_dwordx4 v5, s[28:31], s53 offen lds
 v_mfma_f32_16x16x32_bf16 v[132:135], a[244:247], a[84:87], v[132:135]
 s_getpc_b64 s[62:63]
L_pcA1:
 s_add_u32 s62, s62, L_side-2048-L_pcA1
 s_addc_u32 s63, s63, 0
 v_mul_f32 v53, 0x3e0293ee, v53
 v_and_b32 v216, 15, v1
 v_mfma_f32_16x16x32_bf16 v[136:139], a[240:243], a[72:75], v[136:139]
 s_bfe_u32 s18, s2, 0x10003
 ds_read_b64_tr_b16 a[236:237], v8 offset:4096
 ds_read_b64_tr_b16 a[238:239], v8 offset:4352
 v_mfma_f32_16x16x32_bf16 v[136:139], a[244:247], a[88:91], v[136:139]
 s_lshl_b32 s18, s18, 2
 v_lshlrev_b32 v216, 7, v216
 v_cvt_pk_bf16_f32 v42, v52, v53
 v_mfma_f32_16x16x32_bf16 v[140:143], a[240:243], a[76:79], v[140:143]
 s_add_u32 s18, s18, s3
 v_mul_f32 v54, 0x3e0293ee, v54
 v_mul_f32 v55, 0x3e0293ee, v55
 v_mfma_f32_16x16x32_bf16 v[140:143], a[244:247], a[92:95], v[140:143]
 s_waitcnt lgkmcnt(4)
 s_lshl_b32 s18, s18, 11
 v_cvt_pk_bf16_f32 v43, v54, v55
 v_mul_f32 v56, 0x3e0293ee, v56
 v_mfma_f32_16x16x32_bf16 v[144:147], a[248:251], a[64:67], v[144:147]
 s_add_u32 s62, s62, s18
 s_addc_u32 s63, s63, 0
 ds_read_b64_tr_b16 a[240:241], v8 offset:2048
 ds_read_b64_tr_b16 a[242:243], v8 offset:2304
 v_mfma_f32_16x16x32_bf16 v[144:147], a[252:255], a[80:83], v[144:147]
 s_add_u32 m0, s48, 0x13000
 v_mov_b32 v217, s63
 v_mul_f32 v57, 0x3e0293ee, v57
 v_mfma_f32_16x16x32_bf16 v[148:151], a[248:251], a[68:71], v[148:151]
 v_add_co_u32 v216, vcc, s62, v216
 s_nop 1
 v_addc_co_u32 v217, vcc, 0, v217, vcc
 v_mfma_f32_16x16x32_bf16 v[148:151], a[252:255], a[84:87], v[148:151]
 s_add_u32 s53, s51, 0x1c0080
 global_load_dword v250, v[216:217], off
 v_mfma_f32_16x16x32_bf16 v[152:155], a[248:251], a[72:75], v[152:155]
 buffer_load_dwordx4 v5, s[28:31], s53 offen lds
 v_mfma_f32_16x16x32_bf16 v[152:155], a[252:255], a[88:91], v[152:155]
 ds_read_b64_tr_b16 a[244:245], v8 offset:6144
 ds_read_b64_tr_b16 a[246:247], v8 offset:6400
 v_mfma_f32_16x16x32_bf16 v[156:159], a[248:251], a[76:79], v[156:159]
 s_waitcnt vmcnt(10)
 v_cvt_pk_bf16_f32 v44, v56, v57
 v_mul_f32 v58, 0x3e0293ee, v58
 v_mfma_f32_16x16x32_bf16 v[156:159], a[252:255], a[92:95], v[156:159]
 s_barrier
 v_mul_f32 v59, 0x3e0293ee, v59
 v_cvt_pk_bf16_f32 v45, v58, v59
 s_waitcnt lgkmcnt(6)
 v_mfma_f32_16x16x32_bf16 v[128:131], a[232:235], a[96:99], v[128:131]
 s_waitcnt lgkmcnt(4)
 ds_read_b64_tr_b16 a[248:249], v8 offset:8192
 ds_read_b64_tr_b16 a[250:251], v8 offset:8448
 v_mfma_f32_16x16x32_bf16 v[128:131], a[236:239], a[112:115], v[128:131]
 s_add_u32 m0, s48, 0x14000
 v_mul_f32 v60, 0x3e0293ee, v60
 v_mul_f32 v61, 0x3e0293ee, v61
 v_mfma_f32_16x16x32_bf16 v[132:135], a[232:235], a[100:103], v[132:135]
 s_add_u32 s53, s51, 0x200080
 buffer_load_dwordx4 v5, s[28:31], s53 offen lds
 v_mfma_f32_16x16x32_bf16 v[132:135], a[236:239], a[116:119], v[132:135]
 v_cvt_pk_bf16_f32 v46, v60, v61
 v_mul_f32 v62, 0x3e0293ee, v62
 v_mfma_f32_16x16x32_bf16 v[136:139], a[232:235], a[104:107], v[136:139]
 ds_read_b64_tr_b16 a[252:253], v8 offset:12288
 ds_read_b64_tr_b16 a[254:255], v8 offset:12544
 v_mfma_f32_16x16x32_bf16 v[136:139], a[236:239], a[120:123], v[136:139]
 v_mul_f32 v63, 0x3e0293ee, v63
 v_cvt_pk_bf16_f32 v47, v62, v63
 v_mfma_f32_16x16x32_bf16 v[140:143], a[232:235], a[108:111], v[140:143]
 v_mul_f32 v64, 0x3e0293ee, v64
 v_mul_f32 v65, 0x3e0293ee, v65
 v_mfma_f32_16x16x32_bf16 v[140:143], a[236:239], a[124:127], v[140:143]
 s_waitcnt lgkmcnt(6)
 v_cvt_pk_bf16_f32 v48, v64, v65
 v_mul_f32 v66, 0x3e0293ee, v66
 v_mfma_f32_16x16x32_bf16 v[144:147], a[240:243], a[96:99], v[144:147]
 s_waitcnt lgkmcnt(4)
 ds_read_b64_tr_b16 a[232:233], v8 offset:10240
 ds_read_b64_tr_b16 a[234:235], v8 offset:10496
 v_mfma_f32_16x16x32_bf16 v[144:147], a[244:247], a[112:115], v[144:147]
 s_add_u32 m0, s48, 0x15000
 v_mul_f32 v67, 0x3e0293ee, v67
 v_cvt_pk_bf16_f32 v49, v66, v67
 v_mfma_f32_16x16x32_bf16 v[148:151], a[240:243], a[100:103], v[148:151]
 s_add_u32 s53, s51, 0x240080
 buffer_load_dwordx4 v5, s[28:31], s53 offen lds
 v_mfma_f32_16x16x32_bf16 v[148:151], a[244:247], a[116:119], v[148:151]
 v_mul_f32 v68, 0x3e0293ee, v68
 v_mul_f32 v69, 0x3e0293ee, v69
 v_mfma_f32_16x16x32_bf16 v[152:155], a[240:243], a[104:107], v[152:155]
 ds_read_b64_tr_b16 a[236:237], v8 offset:14336
 ds_read_b64_tr_b16 a[238:239], v8 offset:14592
 v_mfma_f32_16x16x32_bf16 v[152:155], a[244:247], a[120:123], v[152:155]
 v_cvt_pk_bf16_f32 v50, v68, v69
 v_mul_f32 v70, 0x3e0293ee, v70
 v_mfma_f32_16x16x32_bf16 v[156:159], a[240:243], a[108:111], v[156:159]
 v_mul_f32 v71, 0x3e0293ee, v71
 v_cvt_pk_bf16_f32 v51, v70, v71
 v_mfma_f32_16x16x32_bf16 v[156:159], a[244:247], a[124:127], v[156:159]
 s_waitcnt lgkmcnt(6)
 v_mul_f32 v72, 0x3e0293ee, v72
 v_mfma_f32_16x16x32_bf16 v[128:131], a[248:251], a[128:131], v[128:131]
 s_waitcnt lgkmcnt(4)
 ds_read_b64_tr_b16 a[240:241], v8 offset:16384
 ds_read_b64_tr_b16 a[242:243], v8 offset:16640
 v_mfma_f32_16x16x32_bf16 v[128:131], a[252:255], a[144:147], v[128:131]
 s_add_u32 m0, s48, 0x16000
 v_mul_f32 v73, 0x3e0293ee, v73
 v_cvt_pk_bf16_f32 v52, v72, v73
 v_mfma_f32_16x16x32_bf16 v[132:135], a[248:251], a[132:135], v[132:135]
 s_add_u32 s53, s51, 0x280080
 buffer_load_dwordx4 v5, s[28:31], s53 offen lds
 v_mfma_f32_16x16x32_bf16 v[132:135], a[252:255], a[148:151], v[132:135]
 v_mul_f32 v74, 0x3e0293ee, v74
 v_mul_f32 v75, 0x3e0293ee, v75
 v_mfma_f32_16x16x32_bf16 v[136:139], a[248:251], a[136:139], v[136:139]
 ds_read_b64_tr_b16 a[244:245], v8 offset:20480
 ds_read_b64_tr_b16 a[246:247], v8 offset:20736
 v_mfma_f32_16x16x32_bf16 v[136:139], a[252:255], a[152:155], v[136:139]
 v_cvt_pk_bf16_f32 v53, v74, v75
 v_mul_f32 v76, 0x3e0293ee, v76
 v_mfma_f32_16x16x32_bf16 v[140:143], a[248:251], a[140:143], v[140:143]
 v_mul_f32 v77, 0x3e0293ee, v77
 v_mfma_f32_16x16x32_bf16 v[140:143], a[252:255], a[156:159], v[140:143]
 s_waitcnt lgkmcnt(6)
 v_cvt_pk_bf16_f32 v54, v76, v77
 v_mfma_f32_16x16x32_bf16 v[144:147], a[232:235], a[128:131], v[144:147]
 s_waitcnt lgkmcnt(4)
 ds_read_b64_tr_b16 a[248:249], v8 offset:18432
 ds_read_b64_tr_b16 a[250:251], v8 offset:18688
 v_mfma_f32_16x16x32_bf16 v[144:147], a[236:239], a[144:147], v[144:147]
 s_add_u32 m0, s48, 0x17000
 v_mul_f32 v78, 0x3e0293ee, v78
 v_mul_f32 v79, 0x3e0293ee, v79
 v_mfma_f32_16x16x32_bf16 v[148:151], a[232:235], a[132:135], v[148:151]
 s_add_u32 s53, s51, 0x2c0080
 buffer_load_dwordx4 v5, s[28:31], s53 offen lds
 v_mfma_f32_16x16x32_bf16 v[148:151], a[236:239], a[148:151], v[148:151]
 v_cvt_pk_bf16_f32 v55, v78, v79
 v_mul_f32 v80, 0x3e0293ee, v80
 v_mfma_f32_16x16x32_bf16 v[152:155], a[232:235], a[136:139], v[152:155]
 ds_read_b64_tr_b16 a[252:253], v8 offset:22528
 ds_read_b64_tr_b16 a[254:255], v8 offset:22784
 v_mfma_f32_16x16x32_bf16 v[152:155], a[236:239], a[152:155], v[152:155]
 v_mul_f32 v81, 0x3e0293ee, v81
 v_cvt_pk_bf16_f32 v56, v80, v81
 v_mfma_f32_16x16x32_bf16 v[156:159], a[232:235], a[140:143], v[156:159]
 v_mul_f32 v82, 0x3e0293ee, v82
 v_mfma_f32_16x16x32_bf16 v[156:159], a[236:239], a[156:159], v[156:159]
 s_waitcnt lgkmcnt(6)
 v_mul_f32 v83, 0x3e0293ee, v83
 v_mfma_f32_16x16x32_bf16 v[128:131], a[240:243], a[160:163], v[128:131]
 s_waitcnt lgkmcnt(4)
 ds_read_b64_tr_b16 a[232:233], v8 offset:24576
 ds_read_b64_tr_b16 a[234:235], v8 offset:24832
 v_mfma_f32_16x16x32_bf16 v[128:131], a[244:247], a[176:179], v[128:131]
 s_add_u32 m0, s48, 0x18000
 v_cvt_pk_bf16_f32 v57, v82, v83
 v_mul_f32 v84, 0x3e0293ee, v84
 v_mfma_f32_16x16x32_bf16 v[132:135], a[240:243], a[164:167], v[132:135]
 s_add_u32 s53, s51, 0x300080
 buffer_load_dwordx4 v5, s[28:31], s53 offen lds
 v_mfma_f32_16x16x32_bf16 v[132:135], a[244:247], a[180:183], v[132:135]
 v_mul_f32 v85, 0x3e0293ee, v85
 v_cvt_pk_bf16_f32 v58, v84, v85
 v_mfma_f32_16x16x32_bf16 v[136:139], a[240:243], a[168:171], v[136:139]
 ds_read_b64_tr_b16 a[236:237], v8 offset:28672
 ds_read_b64_tr_b16 a[238:239], v8 offset:28928
 v_mfma_f32_16x16x32_bf16 v[136:139], a[244:247], a[184:187], v[136:139]
 v_mul_f32 v86, 0x3e0293ee, v86
 v_mul_f32 v87, 0x3e0293ee, v87
 v_mfma_f32_16x16x32_bf16 v[140:143], a[240:243], a[172:175], v[140:143]
 v_cvt_pk_bf16_f32 v59, v86, v87
 v_mfma_f32_16x16x32_bf16 v[140:143], a[244:247], a[188:191], v[140:143]
 s_waitcnt lgkmcnt(6)
 v_mul_f32 v88, 0x3e0293ee, v88
 v_mfma_f32_16x16x32_bf16 v[144:147], a[248:251], a[160:163], v[144:147]
 s_waitcnt lgkmcnt(4)
 ds_read_b64_tr_b16 a[240:241], v8 offset:26624
 ds_read_b64_tr_b16 a[242:243], v8 offset:26880
 v_mfma_f32_16x16x32_bf16 v[144:147], a[252:255], a[176:179], v[144:147]
 s_add_u32 m0, s48, 0x19000
 v_mul_f32 v89, 0x3e0293ee, v89
 v_cvt_pk_bf16_f32 v60, v88, v89
 v_mfma_f32_16x16x32_bf16 v[148:151], a[248:251], a[164:167], v[148:151]
 s_add_u32 s53, s51, 0x340080
 buffer_load_dwordx4 v5, s[28:31], s53 offen lds
 v_mfma_f32_16x16x32_bf16 v[148:151], a[252:255], a[180:183], v[148:151]
 v_mul_f32 v90, 0x3e0293ee, v90
 v_mul_f32 v91, 0x3e0293ee, v91
 v_mfma_f32_16x16x32_bf16 v[152:155], a[248:251], a[168:171], v[152:155]
 ds_read_b64_tr_b16 a[244:245], v8 offset:30720
 ds_read_b64_tr_b16 a[246:247], v8 offset:30976
 v_mfma_f32_16x16x32_bf16 v[152:155], a[252:255], a[184:187], v[152:155]
 v_cvt_pk_bf16_f32 v61, v90, v91
 v_mul_f32 v92, 0x3e0293ee, v92
 v_mfma_f32_16x16x32_bf16 v[156:159], a[248:251], a[172:175], v[156:159]
 v_mul_f32 v93, 0x3e0293ee, v93
 v_mfma_f32_16x16x32_bf16 v[156:159], a[252:255], a[188:191], v[156:159]
 s_waitcnt lgkmcnt(6)
 v_cvt_pk_bf16_f32 v62, v92, v93
 v_mfma_f32_16x16x32_bf16 v[128:131], a[232:235], a[192:195], v[128:131]
 s_waitcnt lgkmcnt(4)
 ds_read_b64_tr_b16 a[248:249], v8 offset:32768
 ds_read_b64_tr_b16 a[250:251], v8 offset:33024
 v_mfma_f32_16x16x32_bf16 v[128:131], a[236:239], a[208:211], v[128:131]
 s_add_u32 m0, s48, 0x1a000
 v_mul_f32 v94, 0x3e0293ee, v94
 v_mul_f32 v95, 0x3e0293ee, v95
 v_mfma_f32_16x16x32_bf16 v[132:135], a[232:235], a[196:199], v[132:135]
 s_add_u32 s53, s51, 0x380080
 buffer_load_dwordx4 v5, s[28:31], s53 offen lds
 v_mfma_f32_16x16x32_bf16 v[132:135], a[236:239], a[212:215], v[132:135]
 v_cvt_pk_bf16_f32 v63, v94, v95
 v_mfma_f32_16x16x32_bf16 v[136:139], a[232:235], a[200:203], v[136:139]
 ds_read_b64_tr_b16 a[252:253], v8 offset:36864
 ds_read_b64_tr_b16 a[254:255], v8 offset:37120
 v_mfma_f32_16x16x32_bf16 v[136:139], a[236:239], a[216:219], v[136:139]
 v_mfma_f32_16x16x32_bf16 v[140:143], a[232:235], a[204:207], v[140:143]
 v_mfma_f32_16x16x32_bf16 v[140:143], a[236:239], a[220:223], v[140:143]
 s_waitcnt lgkmcnt(6)
 v_mfma_f32_16x16x32_bf16 v[144:147], a[240:243], a[192:195], v[144:147]
 s_waitcnt lgkmcnt(4)
 ds_read_b64_tr_b16 a[232:233], v8 offset:34816
 ds_read_b64_tr_b16 a[234:235], v8 offset:35072
 v_mfma_f32_16x16x32_bf16 v[144:147], a[244:247], a[208:211], v[144:147]
 s_add_u32 m0, s48, 0x1b000
 v_mfma_f32_16x16x32_bf16 v[148:151], a[240:243], a[196:199], v[148:151]
 s_add_u32 s53, s51, 0x3c0080
 buffer_load_dwordx4 v5, s[28:31], s53 offen lds
 v_mfma_f32_16x16x32_bf16 v[148:151], a[244:247], a[212:215], v[148:151]
 v_mfma_f32_16x16x32_bf16 v[152:155], a[240:243], a[200:203], v[152:155]
 ds_read_b64_tr_b16 a[236:237], v8 offset:38912
 ds_read_b64_tr_b16 a[238:239], v8 offset:39168
 v_mfma_f32_16x16x32_bf16 v[152:155], a[244:247], a[216:219], v[152:155]
 v_mfma_f32_16x16x32_bf16 v[156:159], a[240:243], a[204:207], v[156:159]
 v_mfma_f32_16x16x32_bf16 v[156:159], a[244:247], a[220:223], v[156:159]
 s_waitcnt lgkmcnt(6)
 v_mfma_f32_16x16x32_bf16 v[128:131], a[248:251], a[224:227], v[128:131]
 s_waitcnt lgkmcnt(4)
 ds_read_b64_tr_b16 a[240:241], v8 offset:40960
 ds_read_b64_tr_b16 a[242:243], v8 offset:41216
 v_mfma_f32_16x16x32_bf16 v[128:131], a[252:255], v[168:171], v[128:131]
 s_add_u32 m0, s48, 0x1c000
 v_mfma_f32_16x16x32_bf16 v[132:135], a[248:251], a[228:231], v[132:135]
 s_add_u32 s53, s51, 0x400080
 buffer_load_dwordx4 v5, s[28:31], s53 offen lds
 v_mfma_f32_16x16x32_bf16 v[132:135], a[252:255], v[172:175], v[132:135]
 v_mfma_f32_16x16x32_bf16 v[136:139], a[248:251], v[160:163], v[136:139]
 ds_read_b64_tr_b16 a[244:245], v8 offset:45056
 ds_read_b64_tr_b16 a[246:247], v8 offset:45312
 v_mfma_f32_16x16x32_bf16 v[136:139], a[252:255], v[176:179], v[136:139]
 v_mfma_f32_16x16x32_bf16 v[140:143], a[248:251], v[164:167], v[140:143]
 v_mfma_f32_16x16x32_bf16 v[140:143], a[252:255], v[180:183], v[140:143]
 s_waitcnt lgkmcnt(6)
 v_mfma_f32_16x16x32_bf16 v[144:147], a[232:235], a[224:227], v[144:147]
 s_waitcnt lgkmcnt(4)
 ds_read_b64_tr_b16 a[248:249], v8 offset:43008
 ds_read_b64_tr_b16 a[250:251], v8 offset:43264
 v_mfma_f32_16x16x32_bf16 v[144:147], a[236:239], v[168:171], v[144:147]
 s_add_u32 m0, s48, 0x1d000
 v_mfma_f32_16x16x32_bf16 v[148:151], a[232:235], a[228:231], v[148:151]
 s_add_u32 s53, s51, 0x440080
 buffer_load_dwordx4 v5, s[28:31], s53 offen lds
 v_mfma_f32_16x16x32_bf16 v[148:151], a[236:239], v[172:175], v[148:151]
 v_mfma_f32_16x16x32_bf16 v[152:155], a[232:235], v[160:163], v[152:155]
 ds_read_b64_tr_b16 a[252:253], v8 offset:47104
 ds_read_b64_tr_b16 a[254:255], v8 offset:47360
 v_mfma_f32_16x16x32_bf16 v[152:155], a[236:239], v[176:179], v[152:155]
 v_mfma_f32_16x16x32_bf16 v[156:159], a[232:235], v[164:167], v[156:159]
 s_waitcnt vmcnt(8)
 v_mfma_f32_16x16x32_bf16 v[156:159], a[236:239], v[180:183], v[156:159]
 s_barrier
 s_waitcnt lgkmcnt(6)
 v_mfma_f32_16x16x32_bf16 v[128:131], a[240:243], v[184:187], v[128:131]
 s_waitcnt lgkmcnt(4)
 ds_read_b64_tr_b16 a[232:233], v9 offset:49152
 ds_read_b64_tr_b16 a[234:235], v9 offset:49408
 v_mfma_f32_16x16x32_bf16 v[128:131], a[244:247], v[200:203], v[128:131]
 v_mfma_f32_16x16x32_bf16 v[132:135], a[240:243], v[188:191], v[132:135]
 v_mfma_f32_16x16x32_bf16 v[132:135], a[244:247], v[204:207], v[132:135]
 v_mfma_f32_16x16x32_bf16 v[136:139], a[240:243], v[192:195], v[136:139]
 ds_read_b64_tr_b16 a[236:237], v9 offset:53248
 ds_read_b64_tr_b16 a[238:239], v9 offset:53504
 v_mfma_f32_16x16x32_bf16 v[136:139], a[244:247], v[208:211], v[136:139]
 v_mfma_f32_16x16x32_bf16 v[140:143], a[240:243], v[196:199], v[140:143]
 v_mfma_f32_16x16x32_bf16 v[140:143], a[244:247], v[212:215], v[140:143]
 s_waitcnt lgkmcnt(4)
 v_mfma_f32_16x16x32_bf16 v[144:147], a[248:251], v[184:187], v[144:147]
 s_add_u32 m0, s66, 0x17000
 ds_read_b64_tr_b16 a[240:241], v9 offset:49160
 ds_read_b64_tr_b16 a[242:243], v9 offset:49416
 v_mfma_f32_16x16x32_bf16 v[144:147], a[252:255], v[200:203], v[144:147]
 buffer_load_dwordx4 v26, s[20:23], s64 offen lds
 v_mfma_f32_16x16x32_bf16 v[148:151], a[248:251], v[188:191], v[148:151]
 v_mfma_f32_16x16x32_bf16 v[148:151], a[252:255], v[204:207], v[148:151]
 v_mfma_f32_16x16x32_bf16 v[152:155], a[248:251], v[192:195], v[152:155]
 ds_read_b64_tr_b16 a[244:245], v9 offset:53256
 ds_read_b64_tr_b16 a[246:247], v9 offset:53512
 v_mfma_f32_16x16x32_bf16 v[152:155], a[252:255], v[208:211], v[152:155]
 buffer_load_dwordx4 v27, s[20:23], s64 offen offset:1024 lds
 v_mfma_f32_16x16x32_bf16 v[156:159], a[248:251], v[196:199], v[156:159]
 v_mfma_f32_16x16x32_bf16 v[156:159], a[252:255], v[212:215], v[156:159]
 s_waitcnt lgkmcnt(6)
 v_mfma_f32_16x16x32_bf16 v[64:67], a[232:235], a[0:3], 0
 s_waitcnt lgkmcnt(4)
 ds_read_b64_tr_b16 a[248:249], v9 offset:51200
 ds_read_b64_tr_b16 a[250:251], v9 offset:51456
 v_mfma_f32_16x16x32_bf16 v[64:67], a[236:239], a[16:19], v[64:67]
 buffer_load_dwordx4 v28, s[20:23], s64 offen offset:2048 lds
 v_mfma_f32_16x16x32_bf16 v[72:75], a[232:235], a[4:7], 0
 v_mfma_f32_16x16x32_bf16 v[72:75], a[236:239], a[20:23], v[72:75]
 v_mul_f32 v224, v128, v128
 v_mfma_f32_16x16x32_bf16 v[80:83], a[232:235], a[8:11], 0
 ds_read_b64_tr_b16 a[252:253], v9 offset:55296
 ds_read_b64_tr_b16 a[254:255], v9 offset:55552
 v_mfma_f32_16x16x32_bf16 v[80:83], a[236:239], a[24:27], v[80:83]
 buffer_load_dwordx4 v29, s[20:23], s64 offen offset:3072 lds
 v_mfma_f32_16x16x32_bf16 v[88:91], a[232:235], a[12:15], 0
 v_fmaak_f32 v224, v224, v223, 0xc0135761
 v_mul_f32 v224, v224, v128
 v_mfma_f32_16x16x32_bf16 v[88:91], a[236:239], a[28:31], v[88:91]
 s_waitcnt lgkmcnt(4)
 v_mfma_f32_16x16x32_bf16 v[68:71], a[240:243], a[0:3], 0
 s_add_u32 s64, s64, 0x4000
 ds_read_b64_tr_b16 a[232:233], v9 offset:51208
 ds_read_b64_tr_b16 a[234:235], v9 offset:51464
 v_mfma_f32_16x16x32_bf16 v[68:71], a[244:247], a[16:19], v[68:71]
 s_add_u32 s66, s66, 0x4000
 v_exp_f32 v224, v224
 v_mfma_f32_16x16x32_bf16 v[76:79], a[240:243], a[4:7], 0
 s_and_b32 s66, s66, 0xffff
 v_mul_f32 v144, v128, v144
 v_mfma_f32_16x16x32_bf16 v[76:79], a[244:247], a[20:23], v[76:79]
 s_add_u32 m0, s66, 0x17000
 v_mfma_f32_16x16x32_bf16 v[84:87], a[240:243], a[8:11], 0
 buffer_load_dwordx4 v26, s[20:23], s64 offen lds
 v_mfma_f32_16x16x32_bf16 v[84:87], a[244:247], a[24:27], v[84:87]
 ds_read_b64_tr_b16 a[236:237], v9 offset:55304
 ds_read_b64_tr_b16 a[238:239], v9 offset:55560
 v_mfma_f32_16x16x32_bf16 v[92:95], a[240:243], a[12:15], 0
 buffer_load_dwordx4 v27, s[20:23], s64 offen offset:1024 lds
 v_mfma_f32_16x16x32_bf16 v[92:95], a[244:247], a[28:31], v[92:95]
 s_waitcnt lgkmcnt(6)
 v_add_f32 v224, 1.0, v224
 v_mfma_f32_16x16x32_bf16 v[96:99], a[248:251], a[0:3], 0
 s_waitcnt lgkmcnt(4)
 ds_read_b64_tr_b16 a[240:241], v9 offset:57344
 ds_read_b64_tr_b16 a[242:243], v9 offset:57600
 v_mfma_f32_16x16x32_bf16 v[96:99], a[252:255], a[16:19], v[96:99]
 buffer_load_dwordx4 v28, s[20:23], s64 offen offset:2048 lds
 v_mfma_f32_16x16x32_bf16 v[104:107], a[248:251], a[4:7], 0
 v_rcp_f32 v224, v224
 v_mfma_f32_16x16x32_bf16 v[104:107], a[252:255], a[20:23], v[104:107]
 v_mul_f32 v144, v144, v224
 v_mul_f32 v225, v129, v129
 v_mfma_f32_16x16x32_bf16 v[112:115], a[248:251], a[8:11], 0
 ds_read_b64_tr_b16 a[244:245], v9 offset:61440
 ds_read_b64_tr_b16 a[246:247], v9 offset:61696
 v_mfma_f32_16x16x32_bf16 v[112:115], a[252:255], a[24:27], v[112:115]
 buffer_load_dwordx4 v29, s[20:23], s64 offen offset:3072 lds
 v_mfma_f32_16x16x32_bf16 v[120:123], a[248:251], a[12:15], 0
 v_fmaak_f32 v225, v225, v223, 0xc0135761
 v_mul_f32 v225, v225, v129
 v_mfma_f32_16x16x32_bf16 v[120:123], a[252:255], a[28:31], v[120:123]
 s_waitcnt lgkmcnt(4)
 v_exp_f32 v225, v225
 v_mfma_f32_16x16x32_bf16 v[100:103], a[232:235], a[0:3], 0
 s_add_u32 s64, s64, 0x4000
 ds_read_b64_tr_b16 a[248:249], v9 offset:57352
 ds_read_b64_tr_b16 a[250:251], v9 offset:57608
 v_mfma_f32_16x16x32_bf16 v[100:103], a[236:239], a[16:19], v[100:103]
 s_add_u32 s66, s66, 0x4000
 v_mul_f32 v145, v129, v145
 v_mfma_f32_16x16x32_bf16 v[108:111], a[232:235], a[4:7], 0
 s_and_b32 s66, s66, 0xffff
 v_add_f32 v225, 1.0, v225
 v_mfma_f32_16x16x32_bf16 v[108:111], a[236:239], a[20:23], v[108:111]
 v_mfma_f32_16x16x32_bf16 v[116:119], a[232:235], a[8:11], 0
 ds_read_b64_tr_b16 a[252:253], v9 offset:61448
 ds_read_b64_tr_b16 a[254:255], v9 offset:61704
 v_mfma_f32_16x16x32_bf16 v[116:119], a[236:239], a[24:27], v[116:119]
 v_rcp_f32 v225, v225
 v_mfma_f32_16x16x32_bf16 v[124:127], a[232:235], a[12:15], 0
 v_mul_f32 v145, v145, v225
 v_mfma_f32_16x16x32_bf16 v[124:127], a[236:239], a[28:31], v[124:127]
 s_waitcnt lgkmcnt(4)
 v_cvt_pk_bf16_f32 v240, v144, v145
 v_mfma_f32_16x16x32_bf16 v[64:67], a[240:243], a[32:35], v[64:67]
 s_add_u32 m0, s67, 0x1000
 ds_read_b64_tr_b16 a[232:233], v9 offset:59392
 ds_read_b64_tr_b16 a[234:235], v9 offset:59648
 v_mfma_f32_16x16x32_bf16 v[64:67], a[244:247], a[48:51], v[64:67]
 buffer_load_dwordx4 v30, s[24:27], s65 offen lds
 v_mfma_f32_16x16x32_bf16 v[72:75], a[240:243], a[36:39], v[72:75]
 v_mul_f32 v226, v130, v130
 v_accvgpr_write_b32 a0, 0
 v_mfma_f32_16x16x32_bf16 v[72:75], a[244:247], a[52:55], v[72:75]
 v_accvgpr_write_b32 a1, 0
 v_fmaak_f32 v226, v226, v223, 0xc0135761
 v_mfma_f32_16x16x32_bf16 v[80:83], a[240:243], a[40:43], v[80:83]
 ds_read_b64_tr_b16 a[236:237], v9 offset:63488
 ds_read_b64_tr_b16 a[238:239], v9 offset:63744
 v_mfma_f32_16x16x32_bf16 v[80:83], a[244:247], a[56:59], v[80:83]
 buffer_load_dwordx4 v31, s[24:27], s65 offen offset:1024 lds
 v_mfma_f32_16x16x32_bf16 v[88:91], a[240:243], a[44:47], v[88:91]
 v_accvgpr_write_b32 a2, 0
 v_accvgpr_write_b32 a3, 0
 v_mfma_f32_16x16x32_bf16 v[88:91], a[244:247], a[60:63], v[88:91]
 s_waitcnt lgkmcnt(6)
 v_mul_f32 v226, v226, v130
 v_accvgpr_write_b32 a4, 0
 v_mfma_f32_16x16x32_bf16 v[68:71], a[248:251], a[32:35], v[68:71]
 s_waitcnt lgkmcnt(4)
 ds_read_b64_tr_b16 a[240:241], v9 offset:59400
 ds_read_b64_tr_b16 a[242:243], v9 offset:59656
 v_mfma_f32_16x16x32_bf16 v[68:71], a[252:255], a[48:51], v[68:71]
 buffer_load_dwordx4 v30, s[24:27], s65 offen offset:2048 lds
 v_mfma_f32_16x16x32_bf16 v[76:79], a[248:251], a[36:39], v[76:79]
 v_accvgpr_write_b32 a5, 0
 v_accvgpr_write_b32 a6, 0
 v_mfma_f32_16x16x32_bf16 v[76:79], a[252:255], a[52:55], v[76:79]
 v_exp_f32 v226, v226
 v_mfma_f32_16x16x32_bf16 v[84:87], a[248:251], a[40:43], v[84:87]
 ds_read_b64_tr_b16 a[244:245], v9 offset:63496
 ds_read_b64_tr_b16 a[246:247], v9 offset:63752
 v_mfma_f32_16x16x32_bf16 v[84:87], a[252:255], a[56:59], v[84:87]
 buffer_load_dwordx4 v31, s[24:27], s65 offen offset:3072 lds
 v_mfma_f32_16x16x32_bf16 v[92:95], a[248:251], a[44:47], v[92:95]
 v_mul_f32 v146, v130, v146
 v_accvgpr_write_b32 a7, 0
 v_mfma_f32_16x16x32_bf16 v[92:95], a[252:255], a[60:63], v[92:95]
 s_waitcnt lgkmcnt(4)
 v_accvgpr_write_b32 a8, 0
 v_add_f32 v226, 1.0, v226
 v_mfma_f32_16x16x32_bf16 v[96:99], a[232:235], a[32:35], v[96:99]
 s_add_u32 s65, s65, 0x4000
 ds_read_b64_tr_b16 a[248:249], v13
 ds_read_b64_tr_b16 a[250:251], v13 offset:256
 v_mfma_f32_16x16x32_bf16 v[96:99], a[236:239], a[48:51], v[96:99]
 s_add_u32 s67, s67, 0x4000
 v_accvgpr_write_b32 a9, 0
 v_accvgpr_write_b32 a10, 0
 v_mfma_f32_16x16x32_bf16 v[104:107], a[232:235], a[36:39], v[104:107]
 s_and_b32 s67, s67, 0xffff
 v_rcp_f32 v226, v226
 v_mfma_f32_16x16x32_bf16 v[104:107], a[236:239], a[52:55], v[104:107]
 v_accvgpr_write_b32 a11, 0
 v_accvgpr_write_b32 a12, 0
 v_mfma_f32_16x16x32_bf16 v[112:115], a[232:235], a[40:43], v[112:115]
 ds_read_b64_tr_b16 a[252:253], v13 offset:4096
 ds_read_b64_tr_b16 a[254:255], v13 offset:4352
 v_mfma_f32_16x16x32_bf16 v[112:115], a[236:239], a[56:59], v[112:115]
 v_mul_f32 v146, v146, v226
 v_accvgpr_write_b32 a13, 0
 v_mfma_f32_16x16x32_bf16 v[120:123], a[232:235], a[44:47], v[120:123]
 v_accvgpr_write_b32 a14, 0
 v_mul_f32 v227, v131, v131
 v_mfma_f32_16x16x32_bf16 v[120:123], a[236:239], a[60:63], v[120:123]
 s_waitcnt lgkmcnt(6)
 v_accvgpr_write_b32 a15, 0
 v_fmaak_f32 v227, v227, v223, 0xc0135761
 v_mfma_f32_16x16x32_bf16 v[100:103], a[240:243], a[32:35], v[100:103]
 s_waitcnt lgkmcnt(4)
 ds_read_b64_tr_b16 a[232:233], v13 offset:8
 ds_read_b64_tr_b16 a[234:235], v13 offset:264
 v_mfma_f32_16x16x32_bf16 v[100:103], a[244:247], a[48:51], v[100:103]
 v_accvgpr_write_b32 a16, 0
 v_accvgpr_write_b32 a17, 0
 v_mfma_f32_16x16x32_bf16 v[108:111], a[240:243], a[36:39], v[108:111]
 v_mul_f32 v227, v227, v131
 v_accvgpr_write_b32 a18, 0
 v_mfma_f32_16x16x32_bf16 v[108:111], a[244:247], a[52:55], v[108:111]
 v_accvgpr_write_b32 a19, 0
 v_accvgpr_write_b32 a20, 0
 v_mfma_f32_16x16x32_bf16 v[116:119], a[240:243], a[40:43], v[116:119]
 ds_read_b64_tr_b16 a[236:237], v13 offset:4104
 ds_read_b64_tr_b16 a[238:239], v13 offset:4360
 v_mfma_f32_16x16x32_bf16 v[116:119], a[244:247], a[56:59], v[116:119]
 v_exp_f32 v227, v227
 v_mfma_f32_16x16x32_bf16 v[124:127], a[240:243], a[44:47], v[124:127]
 v_accvgpr_write_b32 a21, 0
 v_mul_f32 v147, v131, v147
 v_mfma_f32_16x16x32_bf16 v[124:127], a[244:247], a[60:63], v[124:127]
 s_waitcnt lgkmcnt(6)
 v_accvgpr_write_b32 a22, 0
 v_accvgpr_write_b32 a23, 0
 v_mfma_f32_16x16x32_bf16 v[64:67], a[248:251], a[64:67], v[64:67]
 s_waitcnt lgkmcnt(4)
 ds_read_b64_tr_b16 a[240:241], v13 offset:2048
 ds_read_b64_tr_b16 a[242:243], v13 offset:2304
 v_mfma_f32_16x16x32_bf16 v[64:67], a[252:255], a[80:83], v[64:67]
 v_add_f32 v227, 1.0, v227
 v_accvgpr_write_b32 a24, 0
 v_mfma_f32_16x16x32_bf16 v[72:75], a[248:251], a[68:71], v[72:75]
 v_rcp_f32 v227, v227
 v_mfma_f32_16x16x32_bf16 v[72:75], a[252:255], a[84:87], v[72:75]
 v_accvgpr_write_b32 a25, 0
 v_accvgpr_write_b32 a26, 0
 v_mfma_f32_16x16x32_bf16 v[80:83], a[248:251], a[72:75], v[80:83]
 ds_read_b64_tr_b16 a[244:245], v13 offset:6144
 ds_read_b64_tr_b16 a[246:247], v13 offset:6400
 v_mfma_f32_16x16x32_bf16 v[80:83], a[252:255], a[88:91], v[80:83]
 v_mul_f32 v147, v147, v227
 v_accvgpr_write_b32 a27, 0
 v_mfma_f32_16x16x32_bf16 v[88:91], a[248:251], a[76:79], v[88:91]
 v_accvgpr_write_b32 a28, 0
 v_cvt_pk_bf16_f32 v241, v146, v147
 v_mfma_f32_16x16x32_bf16 v[88:91], a[252:255], a[92:95], v[88:91]
 s_waitcnt lgkmcnt(6)
 buffer_store_dwordx2 v[240:241], v2, s[36:39], s57 offen sc1
 v_mfma_f32_16x16x32_bf16 v[68:71], a[232:235], a[64:67], v[68:71]
 s_waitcnt lgkmcnt(4)
 ds_read_b64_tr_b16 a[248:249], v13 offset:2056
 ds_read_b64_tr_b16 a[250:251], v13 offset:2312
 v_mfma_f32_16x16x32_bf16 v[68:71], a[236:239], a[80:83], v[68:71]
 v_accvgpr_write_b32 a29, 0
 v_accvgpr_write_b32 a30, 0
 v_mfma_f32_16x16x32_bf16 v[76:79], a[232:235], a[68:71], v[76:79]
 v_accvgpr_write_b32 a31, 0
 v_accvgpr_write_b32 a32, 0
 v_mfma_f32_16x16x32_bf16 v[76:79], a[236:239], a[84:87], v[76:79]
 v_mul_f32 v228, v132, v132
 v_accvgpr_write_b32 a33, 0
 v_mfma_f32_16x16x32_bf16 v[84:87], a[232:235], a[72:75], v[84:87]
 ds_read_b64_tr_b16 a[252:253], v13 offset:6152
 ds_read_b64_tr_b16 a[254:255], v13 offset:6408
 v_mfma_f32_16x16x32_bf16 v[84:87], a[236:239], a[88:91], v[84:87]
 v_accvgpr_write_b32 a34, 0
 v_fmaak_f32 v228, v228, v223, 0xc0135761
 v_mfma_f32_16x16x32_bf16 v[92:95], a[232:235], a[76:79], v[92:95]
 v_accvgpr_write_b32 a35, 0
 v_mul_f32 v228, v228, v132
 v_mfma_f32_16x16x32_bf16 v[92:95], a[236:239], a[92:95], v[92:95]
 s_waitcnt lgkmcnt(6)
 v_accvgpr_write_b32 a36, 0
 v_accvgpr_write_b32 a37, 0
 v_mfma_f32_16x16x32_bf16 v[96:99], a[240:243], a[64:67], v[96:99]
 s_waitcnt lgkmcnt(4)
 ds_read_b64_tr_b16 a[232:233], v13 offset:8192
 ds_read_b64_tr_b16 a[234:235], v13 offset:8448
 v_mfma_f32_16x16x32_bf16 v[96:99], a[244:247], a[80:83], v[96:99]
 v_exp_f32 v228, v228
 v_mfma_f32_16x16x32_bf16 v[104:107], a[240:243], a[68:71], v[104:107]
 v_accvgpr_write_b32 a38, 0
 v_accvgpr_write_b32 a39, 0
 v_mfma_f32_16x16x32_bf16 v[104:107], a[244:247], a[84:87], v[104:107]
 v_mul_f32 v148, v132, v148
 v_accvgpr_write_b32 a40, 0
 v_mfma_f32_16x16x32_bf16 v[112:115], a[240:243], a[72:75], v[112:115]
 ds_read_b64_tr_b16 a[236:237], v13 offset:12288
 ds_read_b64_tr_b16 a[238:239], v13 offset:12544
 v_mfma_f32_16x16x32_bf16 v[112:115], a[244:247], a[88:91], v[112:115]
 v_accvgpr_write_b32 a41, 0
 v_add_f32 v228, 1.0, v228
 v_mfma_f32_16x16x32_bf16 v[120:123], a[240:243], a[76:79], v[120:123]
 v_accvgpr_write_b32 a42, 0
 v_accvgpr_write_b32 a43, 0
 v_mfma_f32_16x16x32_bf16 v[120:123], a[244:247], a[92:95], v[120:123]
 s_waitcnt lgkmcnt(6)
 v_rcp_f32 v228, v228
 v_mfma_f32_16x16x32_bf16 v[100:103], a[248:251], a[64:67], v[100:103]
 s_waitcnt lgkmcnt(4)
 ds_read_b64_tr_b16 a[240:241], v13 offset:8200
 ds_read_b64_tr_b16 a[242:243], v13 offset:8456
 v_mfma_f32_16x16x32_bf16 v[100:103], a[252:255], a[80:83], v[100:103]
 v_accvgpr_write_b32 a44, 0
 v_mul_f32 v148, v148, v228
 v_mfma_f32_16x16x32_bf16 v[108:111], a[248:251], a[68:71], v[108:111]
 v_accvgpr_write_b32 a45, 0
 v_accvgpr_write_b32 a46, 0
 v_mfma_f32_16x16x32_bf16 v[108:111], a[252:255], a[84:87], v[108:111]
 v_mul_f32 v229, v133, v133
 v_accvgpr_write_b32 a47, 0
 v_mfma_f32_16x16x32_bf16 v[116:119], a[248:251], a[72:75], v[116:119]
 ds_read_b64_tr_b16 a[244:245], v13 offset:12296
 ds_read_b64_tr_b16 a[246:247], v13 offset:12552
 v_mfma_f32_16x16x32_bf16 v[116:119], a[252:255], a[88:91], v[116:119]
 v_accvgpr_write_b32 a48, 0
 v_fmaak_f32 v229, v229, v223, 0xc0135761
 v_mfma_f32_16x16x32_bf16 v[124:127], a[248:251], a[76:79], v[124:127]
 v_accvgpr_write_b32 a49, 0
 v_accvgpr_write_b32 a50, 0
 v_mfma_f32_16x16x32_bf16 v[124:127], a[252:255], a[92:95], v[124:127]
 s_waitcnt lgkmcnt(6)
 v_mul_f32 v229, v229, v133
 v_accvgpr_write_b32 a51, 0
 v_mfma_f32_16x16x32_bf16 v[64:67], a[232:235], a[96:99], v[64:67]
 s_waitcnt lgkmcnt(4)
 ds_read_b64_tr_b16 a[248:249], v13 offset:10240
 ds_read_b64_tr_b16 a[250:251], v13 offset:10496
 v_mfma_f32_16x16x32_bf16 v[64:67], a[236:239], a[112:115], v[64:67]
 v_accvgpr_write_b32 a52, 0
 v_accvgpr_write_b32 a53, 0
 v_mfma_f32_16x16x32_bf16 v[72:75], a[232:235], a[100:103], v[72:75]
 v_exp_f32 v229, v229
 v_mfma_f32_16x16x32_bf16 v[72:75], a[236:239], a[116:119], v[72:75]
 v_mul_f32 v149, v133, v149
 v_accvgpr_write_b32 a54, 0
 v_mfma_f32_16x16x32_bf16 v[80:83], a[232:235], a[104:107], v[80:83]
 ds_read_b64_tr_b16 a[252:253], v13 offset:14336
 ds_read_b64_tr_b16 a[254:255], v13 offset:14592
 v_mfma_f32_16x16x32_bf16 v[80:83], a[236:239], a[120:123], v[80:83]
 v_accvgpr_write_b32 a55, 0
 v_add_f32 v229, 1.0, v229
 v_mfma_f32_16x16x32_bf16 v[88:91], a[232:235], a[108:111], v[88:91]
 v_accvgpr_write_b32 a56, 0
 v_accvgpr_write_b32 a57, 0
 v_mfma_f32_16x16x32_bf16 v[88:91], a[236:239], a[124:127], v[88:91]
 s_waitcnt lgkmcnt(6)
 v_rcp_f32 v229, v229
 v_mfma_f32_16x16x32_bf16 v[68:71], a[240:243], a[96:99], v[68:71]
 s_waitcnt lgkmcnt(4)
 ds_read_b64_tr_b16 a[232:233], v13 offset:10248
 ds_read_b64_tr_b16 a[234:235], v13 offset:10504
 v_mfma_f32_16x16x32_bf16 v[68:71], a[244:247], a[112:115], v[68:71]
 v_accvgpr_write_b32 a58, 0
 v_accvgpr_write_b32 a59, 0
 v_mfma_f32_16x16x32_bf16 v[76:79], a[240:243], a[100:103], v[76:79]
 v_mul_f32 v149, v149, v229
 v_accvgpr_write_b32 a60, 0
 v_mfma_f32_16x16x32_bf16 v[76:79], a[244:247], a[116:119], v[76:79]
 v_accvgpr_write_b32 a61, 0
 v_cvt_pk_bf16_f32 v244, v148, v149
 v_mfma_f32_16x16x32_bf16 v[84:87], a[240:243], a[104:107], v[84:87]
 ds_read_b64_tr_b16 a[236:237], v13 offset:14344
 ds_read_b64_tr_b16 a[238:239], v13 offset:14600
 v_mfma_f32_16x16x32_bf16 v[84:87], a[244:247], a[120:123], v[84:87]
 v_accvgpr_write_b32 a62, 0
 v_mul_f32 v230, v134, v134
 v_mfma_f32_16x16x32_bf16 v[92:95], a[240:243], a[108:111], v[92:95]
 v_accvgpr_write_b32 a63, 0
 v_accvgpr_write_b32 a64, 0
 v_mfma_f32_16x16x32_bf16 v[92:95], a[244:247], a[124:127], v[92:95]
 s_waitcnt lgkmcnt(6)
 v_fmaak_f32 v230, v230, v223, 0xc0135761
 v_accvgpr_write_b32 a65, 0
 v_mfma_f32_16x16x32_bf16 v[96:99], a[248:251], a[96:99], v[96:99]
 s_waitcnt lgkmcnt(4)
 ds_read_b64_tr_b16 a[240:241], v13 offset:16384
 ds_read_b64_tr_b16 a[242:243], v13 offset:16640
 v_mfma_f32_16x16x32_bf16 v[96:99], a[252:255], a[112:115], v[96:99]
 v_accvgpr_write_b32 a66, 0
 v_mul_f32 v230, v230, v134
 v_mfma_f32_16x16x32_bf16 v[104:107], a[248:251], a[100:103], v[104:107]
 v_accvgpr_write_b32 a67, 0
 v_accvgpr_write_b32 a68, 0
 v_mfma_f32_16x16x32_bf16 v[104:107], a[252:255], a[116:119], v[104:107]
 v_exp_f32 v230, v230
 v_mfma_f32_16x16x32_bf16 v[112:115], a[248:251], a[104:107], v[112:115]
 ds_read_b64_tr_b16 a[244:245], v13 offset:20480
 ds_read_b64_tr_b16 a[246:247], v13 offset:20736
 v_mfma_f32_16x16x32_bf16 v[112:115], a[252:255], a[120:123], v[112:115]
 v_accvgpr_write_b32 a69, 0
 v_accvgpr_write_b32 a70, 0
 v_mfma_f32_16x16x32_bf16 v[120:123], a[248:251], a[108:111], v[120:123]
 v_mul_f32 v150, v134, v150
 v_accvgpr_write_b32 a71, 0
 v_mfma_f32_16x16x32_bf16 v[120:123], a[252:255], a[124:127], v[120:123]
 s_waitcnt lgkmcnt(6)
 v_add_f32 v230, 1.0, v230
 v_accvgpr_write_b32 a72, 0
 v_mfma_f32_16x16x32_bf16 v[100:103], a[232:235], a[96:99], v[100:103]
 s_waitcnt lgkmcnt(4)
 ds_read_b64_tr_b16 a[248:249], v13 offset:16392
 ds_read_b64_tr_b16 a[250:251], v13 offset:16648
 v_mfma_f32_16x16x32_bf16 v[100:103], a[236:239], a[112:115], v[100:103]
 v_accvgpr_write_b32 a73, 0
 v_accvgpr_write_b32 a74, 0
 v_mfma_f32_16x16x32_bf16 v[108:111], a[232:235], a[100:103], v[108:111]
 v_rcp_f32 v230, v230
 v_mfma_f32_16x16x32_bf16 v[108:111], a[236:239], a[116:119], v[108:111]
 v_accvgpr_write_b32 a75, 0
 v_mul_f32 v150, v150, v230
 v_mfma_f32_16x16x32_bf16 v[116:119], a[232:235], a[104:107], v[116:119]
 ds_read_b64_tr_b16 a[252:253], v13 offset:20488
 ds_read_b64_tr_b16 a[254:255], v13 offset:20744
 v_mfma_f32_16x16x32_bf16 v[116:119], a[236:239], a[120:123], v[116:119]
 v_accvgpr_write_b32 a76, 0
 v_accvgpr_write_b32 a77, 0
 v_mfma_f32_16x16x32_bf16 v[124:127], a[232:235], a[108:111], v[124:127]
 v_mul_f32 v231, v135, v135
 v_accvgpr_write_b32 a78, 0
 v_mfma_f32_16x16x32_bf16 v[124:127], a[236:239], a[124:127], v[124:127]
 s_waitcnt lgkmcnt(6)
 v_accvgpr_write_b32 a79, 0
 v_fmaak_f32 v231, v231, v223, 0xc0135761
 v_mfma_f32_16x16x32_bf16 v[64:67], a[240:243], a[128:131], v[64:67]
 s_waitcnt lgkmcnt(4)
 ds_read_b64_tr_b16 a[232:233], v13 offset:18432
 ds_read_b64_tr_b16 a[234:235], v13 offset:18688
 v_mfma_f32_16x16x32_bf16 v[64:67], a[244:247], a[144:147], v[64:67]
 v_accvgpr_write_b32 a80, 0
 v_mul_f32 v231, v231, v135
 v_mfma_f32_16x16x32_bf16 v[72:75], a[240:243], a[132:135], v[72:75]
 v_accvgpr_write_b32 a81, 0
 v_accvgpr_write_b32 a82, 0
 v_mfma_f32_16x16x32_bf16 v[72:75], a[244:247], a[148:151], v[72:75]
 v_exp_f32 v231, v231
 v_mfma_f32_16x16x32_bf16 v[80:83], a[240:243], a[136:139], v[80:83]
 ds_read_b64_tr_b16 a[236:237], v13 offset:22528
 ds_read_b64_tr_b16 a[238:239], v13 offset:22784
 v_mfma_f32_16x16x32_bf16 v[80:83], a[244:247], a[152:155], v[80:83]
 v_accvgpr_write_b32 a83, 0
 v_accvgpr_write_b32 a84, 0
 v_mfma_f32_16x16x32_bf16 v[88:91], a[240:243], a[140:143], v[88:91]
 v_mul_f32 v151, v135, v151
 v_accvgpr_write_b32 a85, 0
 v_mfma_f32_16x16x32_bf16 v[88:91], a[244:247], a[156:159], v[88:91]
 s_waitcnt lgkmcnt(6)
 v_accvgpr_write_b32 a86, 0
 v_add_f32 v231, 1.0, v231
 v_mfma_f32_16x16x32_bf16 v[68:71], a[248:251], a[128:131], v[68:71]
 s_waitcnt lgkmcnt(4)
 ds_read_b64_tr_b16 a[240:241], v13 offset:18440
 ds_read_b64_tr_b16 a[242:243], v13 offset:18696
 v_mfma_f32_16x16x32_bf16 v[68:71], a[252:255], a[144:147], v[68:71]
 v_accvgpr_write_b32 a87, 0
 v_accvgpr_write_b32 a88, 0
 v_mfma_f32_16x16x32_bf16 v[76:79], a[248:251], a[132:135], v[76:79]
 v_rcp_f32 v231, v231
 v_mfma_f32_16x16x32_bf16 v[76:79], a[252:255], a[148:151], v[76:79]
 v_accvgpr_write_b32 a89, 0
 v_accvgpr_write_b32 a90, 0
 v_mfma_f32_16x16x32_bf16 v[84:87], a[248:251], a[136:139], v[84:87]
 ds_read_b64_tr_b16 a[244:245], v13 offset:22536
 ds_read_b64_tr_b16 a[246:247], v13 offset:22792
 v_mfma_f32_16x16x32_bf16 v[84:87], a[252:255], a[152:155], v[84:87]
 v_mul_f32 v151, v151, v231
 v_accvgpr_write_b32 a91, 0
 v_mfma_f32_16x16x32_bf16 v[92:95], a[248:251], a[140:143], v[92:95]
 s_waitcnt vmcnt(1)
 v_cvt_pk_bf16_f32 v245, v150, v151
 v_accvgpr_write_b32 a92, 0
 v_mfma_f32_16x16x32_bf16 v[92:95], a[252:255], a[156:159], v[92:95]
 s_barrier
 buffer_store_dwordx2 v[244:245], v2, s[36:39], s57 offen offset:1024 sc1
 s_waitcnt lgkmcnt(6)
 v_mfma_f32_16x16x32_bf16 v[96:99], a[232:235], a[128:131], v[96:99]
 s_waitcnt lgkmcnt(4)
 ds_read_b64_tr_b16 a[248:249], v13 offset:24576
 ds_read_b64_tr_b16 a[250:251], v13 offset:24832
 v_mfma_f32_16x16x32_bf16 v[96:99], a[236:239], a[144:147], v[96:99]
 v_accvgpr_write_b32 a93, 0
 v_accvgpr_write_b32 a94, 0
 v_mfma_f32_16x16x32_bf16 v[104:107], a[232:235], a[132:135], v[104:107]
 v_accvgpr_write_b32 a95, 0
 v_mul_f32 v232, v136, v136
 v_mfma_f32_16x16x32_bf16 v[104:107], a[236:239], a[148:151], v[104:107]
 v_accvgpr_write_b32 a96, 0
 v_accvgpr_write_b32 a97, 0
 v_mfma_f32_16x16x32_bf16 v[112:115], a[232:235], a[136:139], v[112:115]
 ds_read_b64_tr_b16 a[252:253], v13 offset:28672
 ds_read_b64_tr_b16 a[254:255], v13 offset:28928
 v_mfma_f32_16x16x32_bf16 v[112:115], a[236:239], a[152:155], v[112:115]
 v_fmaak_f32 v232, v232, v223, 0xc0135761
 v_accvgpr_write_b32 a98, 0
 v_mfma_f32_16x16x32_bf16 v[120:123], a[232:235], a[140:143], v[120:123]
 v_accvgpr_write_b32 a99, 0
 v_mul_f32 v232, v232, v136
 v_mfma_f32_16x16x32_bf16 v[120:123], a[236:239], a[156:159], v[120:123]
 s_waitcnt lgkmcnt(6)
 v_accvgpr_write_b32 a100, 0
 v_accvgpr_write_b32 a101, 0
 v_mfma_f32_16x16x32_bf16 v[100:103], a[240:243], a[128:131], v[100:103]
 s_waitcnt lgkmcnt(4)
 ds_read_b64_tr_b16 a[232:233], v13 offset:24584
 ds_read_b64_tr_b16 a[234:235], v13 offset:24840
 v_mfma_f32_16x16x32_bf16 v[100:103], a[244:247], a[144:147], v[100:103]
 v_exp_f32 v232, v232
 v_mfma_f32_16x16x32_bf16 v[108:111], a[240:243], a[132:135], v[108:111]
 v_accvgpr_write_b32 a102, 0
 v_mul_f32 v152, v136, v152
 v_mfma_f32_16x16x32_bf16 v[108:111], a[244:247], a[148:151], v[108:111]
 v_accvgpr_write_b32 a103, 0
 v_accvgpr_write_b32 a104, 0
 v_mfma_f32_16x16x32_bf16 v[116:119], a[240:243], a[136:139], v[116:119]
 ds_read_b64_tr_b16 a[236:237], v13 offset:28680
 ds_read_b64_tr_b16 a[238:239], v13 offset:28936
 v_mfma_f32_16x16x32_bf16 v[116:119], a[244:247], a[152:155], v[116:119]
 v_add_f32 v232, 1.0, v232
 v_accvgpr_write_b32 a105, 0
 v_mfma_f32_16x16x32_bf16 v[124:127], a[240:243], a[140:143], v[124:127]
 v_accvgpr_write_b32 a106, 0
 v_accvgpr_write_b32 a107, 0
 v_mfma_f32_16x16x32_bf16 v[124:127], a[244:247], a[156:159], v[124:127]
 s_waitcnt lgkmcnt(6)
 v_rcp_f32 v232, v232
 v_mfma_f32_16x16x32_bf16 v[64:67], a[248:251], a[160:163], v[64:67]
 s_waitcnt lgkmcnt(4)
 ds_read_b64_tr_b16 a[240:241], v13 offset:26624
 ds_read_b64_tr_b16 a[242:243], v13 offset:26880
 v_mfma_f32_16x16x32_bf16 v[64:67], a[252:255], a[176:179], v[64:67]
 v_accvgpr_write_b32 a108, 0
 v_mul_f32 v152, v152, v232
 v_mfma_f32_16x16x32_bf16 v[72:75], a[248:251], a[164:167], v[72:75]
 v_accvgpr_write_b32 a109, 0
 v_mul_f32 v233, v137, v137
 v_mfma_f32_16x16x32_bf16 v[72:75], a[252:255], a[180:183], v[72:75]
 v_accvgpr_write_b32 a110, 0
 v_accvgpr_write_b32 a111, 0
 v_mfma_f32_16x16x32_bf16 v[80:83], a[248:251], a[168:171], v[80:83]
 ds_read_b64_tr_b16 a[244:245], v13 offset:30720
 ds_read_b64_tr_b16 a[246:247], v13 offset:30976
 v_mfma_f32_16x16x32_bf16 v[80:83], a[252:255], a[184:187], v[80:83]
 v_fmaak_f32 v233, v233, v223, 0xc0135761
 v_accvgpr_write_b32 a112, 0
 v_mfma_f32_16x16x32_bf16 v[88:91], a[248:251], a[172:175], v[88:91]
 v_accvgpr_write_b32 a113, 0
 v_mul_f32 v233, v233, v137
 v_mfma_f32_16x16x32_bf16 v[88:91], a[252:255], a[188:191], v[88:91]
 s_waitcnt lgkmcnt(6)
 v_accvgpr_write_b32 a114, 0
 v_accvgpr_write_b32 a115, 0
 v_mfma_f32_16x16x32_bf16 v[68:71], a[232:235], a[160:163], v[68:71]
 s_waitcnt lgkmcnt(4)
 ds_read_b64_tr_b16 a[248:249], v13 offset:26632
 ds_read_b64_tr_b16 a[250:251], v13 offset:26888
 v_mfma_f32_16x16x32_bf16 v[68:71], a[236:239], a[176:179], v[68:71]
 v_exp_f32 v233, v233
 v_mfma_f32_16x16x32_bf16 v[76:79], a[232:235], a[164:167], v[76:79]
 v_accvgpr_write_b32 a116, 0
 v_accvgpr_write_b32 a117, 0
 v_mfma_f32_16x16x32_bf16 v[76:79], a[236:239], a[180:183], v[76:79]
 v_mul_f32 v153, v137, v153
 v_accvgpr_write_b32 a118, 0
 v_mfma_f32_16x16x32_bf16 v[84:87], a[232:235], a[168:171], v[84:87]
 ds_read_b64_tr_b16 a[252:253], v13 offset:30728
 ds_read_b64_tr_b16 a[254:255], v13 offset:30984
 v_mfma_f32_16x16x32_bf16 v[84:87], a[236:239], a[184:187], v[84:87]
 v_add_f32 v233, 1.0, v233
 v_accvgpr_write_b32 a119, 0
 v_mfma_f32_16x16x32_bf16 v[92:95], a[232:235], a[172:175], v[92:95]
 v_accvgpr_write_b32 a120, 0
 v_accvgpr_write_b32 a121, 0
 v_mfma_f32_16x16x32_bf16 v[92:95], a[236:239], a[188:191], v[92:95]
 s_waitcnt lgkmcnt(4)
 v_rcp_f32 v233, v233
 v_mfma_f32_16x16x32_bf16 v[96:99], a[240:243], a[160:163], v[96:99]
 s_add_u32 m0, s67, 0x1000
 ds_read_b64_tr_b16 a[232:233], v13 offset:32768
 ds_read_b64_tr_b16 a[234:235], v13 offset:33024
 v_mfma_f32_16x16x32_bf16 v[96:99], a[244:247], a[176:179], v[96:99]
 buffer_load_dwordx4 v30, s[24:27], s65 offen lds
 v_mfma_f32_16x16x32_bf16 v[104:107], a[240:243], a[164:167], v[104:107]
 v_accvgpr_write_b32 a122, 0
 v_mul_f32 v153, v153, v233
 v_mfma_f32_16x16x32_bf16 v[104:107], a[244:247], a[180:183], v[104:107]
 v_accvgpr_write_b32 a123, 0
 v_accvgpr_write_b32 a124, 0
 v_mfma_f32_16x16x32_bf16 v[112:115], a[240:243], a[168:171], v[112:115]
 ds_read_b64_tr_b16 a[236:237], v13 offset:36864
 ds_read_b64_tr_b16 a[238:239], v13 offset:37120
 v_mfma_f32_16x16x32_bf16 v[112:115], a[244:247], a[184:187], v[112:115]
 buffer_load_dwordx4 v31, s[24:27], s65 offen offset:1024 lds
 v_mfma_f32_16x16x32_bf16 v[120:123], a[240:243], a[172:175], v[120:123]
 v_cvt_pk_bf16_f32 v240, v152, v153
 v_accvgpr_write_b32 a125, 0
 v_mfma_f32_16x16x32_bf16 v[120:123], a[244:247], a[188:191], v[120:123]
 s_waitcnt lgkmcnt(6)
 v_accvgpr_write_b32 a126, 0
 v_mul_f32 v234, v138, v138
 v_mfma_f32_16x16x32_bf16 v[100:103], a[248:251], a[160:163], v[100:103]
 s_waitcnt lgkmcnt(4)
 ds_read_b64_tr_b16 a[240:241], v13 offset:32776
 ds_read_b64_tr_b16 a[242:243], v13 offset:33032
 v_mfma_f32_16x16x32_bf16 v[100:103], a[252:255], a[176:179], v[100:103]
 buffer_load_dwordx4 v30, s[24:27], s65 offen offset:2048 lds
 v_mfma_f32_16x16x32_bf16 v[108:111], a[248:251], a[164:167], v[108:111]
 v_accvgpr_write_b32 a127, 0
 v_fmaak_f32 v234, v234, v223, 0xc0135761
 v_mfma_f32_16x16x32_bf16 v[108:111], a[252:255], a[180:183], v[108:111]
 v_mul_f32 v234, v234, v138
 v_mul_f32 v154, v138, v154
 v_mfma_f32_16x16x32_bf16 v[116:119], a[248:251], a[168:171], v[116:119]
 ds_read_b64_tr_b16 a[244:245], v13 offset:36872
 ds_read_b64_tr_b16 a[246:247], v13 offset:37128
 v_mfma_f32_16x16x32_bf16 v[116:119], a[252:255], a[184:187], v[116:119]
 buffer_load_dwordx4 v31, s[24:27], s65 offen offset:3072 lds
 v_mfma_f32_16x16x32_bf16 v[124:127], a[248:251], a[172:175], v[124:127]
 v_exp_f32 v234, v234
 v_mfma_f32_16x16x32_bf16 v[124:127], a[252:255], a[188:191], v[124:127]
 s_waitcnt lgkmcnt(4)
 v_add_f32 v234, 1.0, v234
 v_mul_f32 v235, v139, v139
 v_mfma_f32_16x16x32_bf16 v[64:67], a[232:235], a[192:195], v[64:67]
 s_add_u32 s65, s65, 0x4000
 ds_read_b64_tr_b16 a[248:249], v13 offset:34816
 ds_read_b64_tr_b16 a[250:251], v13 offset:35072
 v_mfma_f32_16x16x32_bf16 v[64:67], a[236:239], a[208:211], v[64:67]
 s_add_u32 s67, s67, 0x4000
 v_rcp_f32 v234, v234
 v_mfma_f32_16x16x32_bf16 v[72:75], a[232:235], a[196:199], v[72:75]
 s_and_b32 s67, s67, 0xffff
 v_mul_f32 v154, v154, v234
 v_fmaak_f32 v235, v235, v223, 0xc0135761
 v_mfma_f32_16x16x32_bf16 v[72:75], a[236:239], a[212:215], v[72:75]
 v_mul_f32 v235, v235, v139
 v_mul_f32 v155, v139, v155
 v_mfma_f32_16x16x32_bf16 v[80:83], a[232:235], a[200:203], v[80:83]
 ds_read_b64_tr_b16 a[252:253], v13 offset:38912
 ds_read_b64_tr_b16 a[254:255], v13 offset:39168
 v_mfma_f32_16x16x32_bf16 v[80:83], a[236:239], a[216:219], v[80:83]
 v_exp_f32 v235, v235
 v_mfma_f32_16x16x32_bf16 v[88:91], a[232:235], a[204:207], v[88:91]
 v_add_f32 v235, 1.0, v235
 v_mul_f32 v236, v140, v140
 v_mfma_f32_16x16x32_bf16 v[88:91], a[236:239], a[220:223], v[88:91]
 s_waitcnt lgkmcnt(6)
 v_rcp_f32 v235, v235
 v_mfma_f32_16x16x32_bf16 v[68:71], a[240:243], a[192:195], v[68:71]
 s_waitcnt lgkmcnt(4)
 ds_read_b64_tr_b16 a[232:233], v13 offset:34824
 ds_read_b64_tr_b16 a[234:235], v13 offset:35080
 v_mfma_f32_16x16x32_bf16 v[68:71], a[244:247], a[208:211], v[68:71]
 v_mul_f32 v155, v155, v235
 v_cvt_pk_bf16_f32 v241, v154, v155
 v_mfma_f32_16x16x32_bf16 v[76:79], a[240:243], a[196:199], v[76:79]
 buffer_store_dwordx2 v[240:241], v3, s[36:39], s57 offen sc1
 v_mfma_f32_16x16x32_bf16 v[76:79], a[244:247], a[212:215], v[76:79]
 v_fmaak_f32 v236, v236, v223, 0xc0135761
 v_accvgpr_write_b32 a160, v32
 v_mfma_f32_16x16x32_bf16 v[84:87], a[240:243], a[200:203], v[84:87]
 ds_read_b64_tr_b16 a[236:237], v13 offset:38920
 ds_read_b64_tr_b16 a[238:239], v13 offset:39176
 v_mfma_f32_16x16x32_bf16 v[84:87], a[244:247], a[216:219], v[84:87]
 v_mul_f32 v236, v236, v140
 v_accvgpr_write_b32 a161, v33
 v_mfma_f32_16x16x32_bf16 v[92:95], a[240:243], a[204:207], v[92:95]
 v_exp_f32 v236, v236
 v_mfma_f32_16x16x32_bf16 v[92:95], a[244:247], a[220:223], v[92:95]
 s_waitcnt lgkmcnt(6)
 v_accvgpr_write_b32 a162, v34
 v_mul_f32 v156, v140, v156
 v_mfma_f32_16x16x32_bf16 v[96:99], a[248:251], a[192:195], v[96:99]
 s_waitcnt lgkmcnt(4)
 ds_read_b64_tr_b16 a[240:241], v13 offset:40960
 ds_read_b64_tr_b16 a[242:243], v13 offset:41216
 v_mfma_f32_16x16x32_bf16 v[96:99], a[252:255], a[208:211], v[96:99]
 v_accvgpr_write_b32 a163, v35
 v_add_f32 v236, 1.0, v236
 v_mfma_f32_16x16x32_bf16 v[104:107], a[248:251], a[196:199], v[104:107]
 v_accvgpr_write_b32 a164, v36
 v_accvgpr_write_b32 a165, v37
 v_mfma_f32_16x16x32_bf16 v[104:107], a[252:255], a[212:215], v[104:107]
 v_rcp_f32 v236, v236
 v_mfma_f32_16x16x32_bf16 v[112:115], a[248:251], a[200:203], v[112:115]
 ds_read_b64_tr_b16 a[244:245], v13 offset:45056
 ds_read_b64_tr_b16 a[246:247], v13 offset:45312
 v_mfma_f32_16x16x32_bf16 v[112:115], a[252:255], a[216:219], v[112:115]
 v_mul_f32 v156, v156, v236
 v_accvgpr_write_b32 a166, v38
 v_mfma_f32_16x16x32_bf16 v[120:123], a[248:251], a[204:207], v[120:123]
 v_mul_f32 v237, v141, v141
 v_fmaak_f32 v237, v237, v223, 0xc0135761
 v_mfma_f32_16x16x32_bf16 v[120:123], a[252:255], a[220:223], v[120:123]
 s_waitcnt lgkmcnt(6)
 v_accvgpr_write_b32 a167, v39
 v_mul_f32 v237, v237, v141
 v_mfma_f32_16x16x32_bf16 v[100:103], a[232:235], a[192:195], v[100:103]
 s_waitcnt lgkmcnt(4)
 ds_read_b64_tr_b16 a[248:249], v13 offset:40968
 ds_read_b64_tr_b16 a[250:251], v13 offset:41224
 v_mfma_f32_16x16x32_bf16 v[100:103], a[236:239], a[208:211], v[100:103]
 v_accvgpr_write_b32 a168, v40
 v_accvgpr_write_b32 a169, v41
 v_mfma_f32_16x16x32_bf16 v[108:111], a[232:235], a[196:199], v[108:111]
 v_exp_f32 v237, v237
 v_mfma_f32_16x16x32_bf16 v[108:111], a[236:239], a[212:215], v[108:111]
 v_mul_f32 v157, v141, v157
 v_accvgpr_write_b32 a170, v42
 v_mfma_f32_16x16x32_bf16 v[116:119], a[232:235], a[200:203], v[116:119]
 ds_read_b64_tr_b16 a[252:253], v13 offset:45064
 ds_read_b64_tr_b16 a[254:255], v13 offset:45320
 v_mfma_f32_16x16x32_bf16 v[116:119], a[236:239], a[216:219], v[116:119]
 v_add_f32 v237, 1.0, v237
 v_accvgpr_write_b32 a171, v43
 v_mfma_f32_16x16x32_bf16 v[124:127], a[232:235], a[204:207], v[124:127]
 v_rcp_f32 v237, v237
 v_mfma_f32_16x16x32_bf16 v[124:127], a[236:239], a[220:223], v[124:127]
 s_waitcnt lgkmcnt(6)
 v_accvgpr_write_b32 a172, v44
 v_mul_f32 v157, v157, v237
 v_mfma_f32_16x16x32_bf16 v[64:67], a[240:243], a[224:227], v[64:67]
 s_waitcnt lgkmcnt(4)
 ds_read_b64_tr_b16 a[232:233], v13 offset:43008
 ds_read_b64_tr_b16 a[234:235], v13 offset:43264
 v_mfma_f32_16x16x32_bf16 v[64:67], a[244:247], v[168:171], v[64:67]
 v_accvgpr_write_b32 a173, v45
 v_cvt_pk_bf16_f32 v244, v156, v157
 v_mfma_f32_16x16x32_bf16 v[72:75], a[240:243], a[228:231], v[72:75]
 ds_read_b128 a[128:131], v14 offset:32768
 v_accvgpr_write_b32 a174, v46
 v_mfma_f32_16x16x32_bf16 v[72:75], a[244:247], v[172:175], v[72:75]
 v_mul_f32 v238, v142, v142
 v_accvgpr_write_b32 a175, v47
 v_mfma_f32_16x16x32_bf16 v[80:83], a[240:243], v[160:163], v[80:83]
 ds_read_b64_tr_b16 a[236:237], v13 offset:47104
 ds_read_b64_tr_b16 a[238:239], v13 offset:47360
 v_mfma_f32_16x16x32_bf16 v[80:83], a[244:247], v[176:179], v[80:83]
 v_fmaak_f32 v238, v238, v223, 0xc0135761
 v_mul_f32 v238, v238, v142
 v_mfma_f32_16x16x32_bf16 v[88:91], a[240:243], v[164:167], v[88:91]
 ds_read_b128 a[132:135], v15 offset:32768
 v_accvgpr_write_b32 a176, v48
 v_mfma_f32_16x16x32_bf16 v[88:91], a[244:247], v[180:183], v[88:91]
 s_waitcnt lgkmcnt(8)
 v_exp_f32 v238, v238
 v_mfma_f32_16x16x32_bf16 v[68:71], a[248:251], a[224:227], v[68:71]
 s_waitcnt lgkmcnt(6)
 ds_read_b64_tr_b16 a[240:241], v13 offset:43016
 ds_read_b64_tr_b16 a[242:243], v13 offset:43272
 v_mfma_f32_16x16x32_bf16 v[68:71], a[252:255], v[168:171], v[68:71]
 v_accvgpr_write_b32 a177, v49
 v_mul_f32 v158, v142, v158
 v_mfma_f32_16x16x32_bf16 v[76:79], a[248:251], a[228:231], v[76:79]
 ds_read_b128 a[136:139], v16 offset:32768
 v_accvgpr_write_b32 a178, v50
 v_mfma_f32_16x16x32_bf16 v[76:79], a[252:255], v[172:175], v[76:79]
 v_add_f32 v238, 1.0, v238
 v_accvgpr_write_b32 a179, v51
 v_mfma_f32_16x16x32_bf16 v[84:87], a[248:251], v[160:163], v[84:87]
 ds_read_b64_tr_b16 a[244:245], v13 offset:47112
 ds_read_b64_tr_b16 a[246:247], v13 offset:47368
 v_mfma_f32_16x16x32_bf16 v[84:87], a[252:255], v[176:179], v[84:87]
 v_rcp_f32 v238, v238
 v_mfma_f32_16x16x32_bf16 v[92:95], a[248:251], v[164:167], v[92:95]
 ds_read_b128 a[140:143], v17 offset:32768
 v_accvgpr_write_b32 a180, v52
 v_mfma_f32_16x16x32_bf16 v[92:95], a[252:255], v[180:183], v[92:95]
 s_waitcnt lgkmcnt(10)
 v_mul_f32 v158, v158, v238
 v_accvgpr_write_b32 a181, v53
 v_mfma_f32_16x16x32_bf16 v[96:99], a[232:235], a[224:227], v[96:99]
 s_waitcnt lgkmcnt(7)
 ds_read_b64_tr_b16 a[248:249], v13 offset:49152
 ds_read_b64_tr_b16 a[250:251], v13 offset:49408
 v_mfma_f32_16x16x32_bf16 v[96:99], a[236:239], v[168:171], v[96:99]
 v_mul_f32 v239, v143, v143
 v_accvgpr_write_b32 a182, v54
 v_mfma_f32_16x16x32_bf16 v[104:107], a[232:235], a[228:231], v[104:107]
 ds_read_b128 a[144:147], v14 offset:36864
 v_fmaak_f32 v239, v239, v223, 0xc0135761
 v_mfma_f32_16x16x32_bf16 v[104:107], a[236:239], v[172:175], v[104:107]
 v_accvgpr_write_b32 a183, v55
 v_mul_f32 v239, v239, v143
 v_mfma_f32_16x16x32_bf16 v[112:115], a[232:235], v[160:163], v[112:115]
 ds_read_b64_tr_b16 a[252:253], v13 offset:53248
 ds_read_b64_tr_b16 a[254:255], v13 offset:53504
 v_mfma_f32_16x16x32_bf16 v[112:115], a[236:239], v[176:179], v[112:115]
 v_accvgpr_write_b32 a184, v56
 v_accvgpr_write_b32 a185, v57
 v_mfma_f32_16x16x32_bf16 v[120:123], a[232:235], v[164:167], v[120:123]
 ds_read_b128 a[148:151], v15 offset:36864
 v_mul_f32 v159, v143, v159
 v_mfma_f32_16x16x32_bf16 v[120:123], a[236:239], v[180:183], v[120:123]
 s_waitcnt lgkmcnt(10)
 v_exp_f32 v239, v239
 v_mfma_f32_16x16x32_bf16 v[100:103], a[240:243], a[224:227], v[100:103]
 s_waitcnt lgkmcnt(7)
 ds_read_b64_tr_b16 a[232:233], v13 offset:49160
 ds_read_b64_tr_b16 a[234:235], v13 offset:49416
 v_mfma_f32_16x16x32_bf16 v[100:103], a[244:247], v[168:171], v[100:103]
 v_add_f32 v239, 1.0, v239
 v_accvgpr_write_b32 a186, v58
 v_mfma_f32_16x16x32_bf16 v[108:111], a[240:243], a[228:231], v[108:111]
 ds_read_b128 a[152:155], v16 offset:36864
 v_accvgpr_write_b32 a187, v59
 v_mfma_f32_16x16x32_bf16 v[108:111], a[244:247], v[172:175], v[108:111]
 v_rcp_f32 v239, v239
 v_mfma_f32_16x16x32_bf16 v[116:119], a[240:243], v[160:163], v[116:119]
 ds_read_b64_tr_b16 a[236:237], v13 offset:53256
 ds_read_b64_tr_b16 a[238:239], v13 offset:53512
 v_mfma_f32_16x16x32_bf16 v[116:119], a[244:247], v[176:179], v[116:119]
 v_mul_f32 v159, v159, v239
 v_accvgpr_write_b32 a188, v60
 v_mfma_f32_16x16x32_bf16 v[124:127], a[240:243], v[164:167], v[124:127]
 ds_read_b128 a[156:159], v17 offset:36864
 v_cvt_pk_bf16_f32 v245, v158, v159
 v_mfma_f32_16x16x32_bf16 v[124:127], a[244:247], v[180:183], v[124:127]
 s_waitcnt lgkmcnt(10)
 buffer_store_dwordx2 v[244:245], v3, s[36:39], s57 offen offset:1024 sc1
 v_mfma_f32_16x16x32_bf16 v[64:67], a[248:251], v[184:187], v[64:67]
 s_waitcnt lgkmcnt(7)
 ds_read_b64_tr_b16 a[240:241], v13 offset:51200
 ds_read_b64_tr_b16 a[242:243], v13 offset:51456
 v_mfma_f32_16x16x32_bf16 v[64:67], a[252:255], v[200:203], v[64:67]
 v_accvgpr_write_b32 a189, v61
 v_accvgpr_write_b32 a190, v62
 v_mfma_f32_16x16x32_bf16 v[72:75], a[248:251], v[188:191], v[72:75]
 v_accvgpr_write_b32 a191, v63
 v_mfma_f32_16x16x32_bf16 v[72:75], a[252:255], v[204:207], v[72:75]
 v_mfma_f32_16x16x32_bf16 v[80:83], a[248:251], v[192:195], v[80:83]
 ds_read_b64_tr_b16 a[244:245], v13 offset:55296
 ds_read_b64_tr_b16 a[246:247], v13 offset:55552
 v_mfma_f32_16x16x32_bf16 v[80:83], a[252:255], v[208:211], v[80:83]
 v_mfma_f32_16x16x32_bf16 v[88:91], a[248:251], v[196:199], v[88:91]
 v_mfma_f32_16x16x32_bf16 v[88:91], a[252:255], v[212:215], v[88:91]
 s_waitcnt lgkmcnt(8)
 v_mfma_f32_16x16x32_bf16 v[68:71], a[232:235], v[184:187], v[68:71]
 s_waitcnt lgkmcnt(5)
 ds_read_b64_tr_b16 a[248:249], v13 offset:51208
 ds_read_b64_tr_b16 a[250:251], v13 offset:51464
 v_mfma_f32_16x16x32_bf16 v[68:71], a[236:239], v[200:203], v[68:71]
 v_mfma_f32_16x16x32_bf16 v[76:79], a[232:235], v[188:191], v[76:79]
 v_mfma_f32_16x16x32_bf16 v[76:79], a[236:239], v[204:207], v[76:79]
 v_mfma_f32_16x16x32_bf16 v[84:87], a[232:235], v[192:195], v[84:87]
 ds_read_b64_tr_b16 a[252:253], v13 offset:55304
 ds_read_b64_tr_b16 a[254:255], v13 offset:55560
 v_mfma_f32_16x16x32_bf16 v[84:87], a[236:239], v[208:211], v[84:87]
 v_mfma_f32_16x16x32_bf16 v[92:95], a[232:235], v[196:199], v[92:95]
 v_mfma_f32_16x16x32_bf16 v[92:95], a[236:239], v[212:215], v[92:95]
 s_waitcnt lgkmcnt(6)
 v_mfma_f32_16x16x32_bf16 v[96:99], a[240:243], v[184:187], v[96:99]
 s_waitcnt lgkmcnt(4)
 v_mfma_f32_16x16x32_bf16 v[96:99], a[244:247], v[200:203], v[96:99]
 v_mfma_f32_16x16x32_bf16 v[104:107], a[240:243], v[188:191], v[104:107]
 v_mfma_f32_16x16x32_bf16 v[104:107], a[244:247], v[204:207], v[104:107]
 v_mfma_f32_16x16x32_bf16 v[112:115], a[240:243], v[192:195], v[112:115]
 v_mfma_f32_16x16x32_bf16 v[112:115], a[244:247], v[208:211], v[112:115]
 v_mfma_f32_16x16x32_bf16 v[120:123], a[240:243], v[196:199], v[120:123]
 v_mfma_f32_16x16x32_bf16 v[120:123], a[244:247], v[212:215], v[120:123]
 s_waitcnt lgkmcnt(2)
 v_mfma_f32_16x16x32_bf16 v[100:103], a[248:251], v[184:187], v[100:103]
 s_waitcnt lgkmcnt(0)
 v_mfma_f32_16x16x32_bf16 v[100:103], a[252:255], v[200:203], v[100:103]
 v_mfma_f32_16x16x32_bf16 v[108:111], a[248:251], v[188:191], v[108:111]
 v_mfma_f32_16x16x32_bf16 v[108:111], a[252:255], v[204:207], v[108:111]
 v_mfma_f32_16x16x32_bf16 v[116:119], a[248:251], v[192:195], v[116:119]
 v_mfma_f32_16x16x32_bf16 v[116:119], a[252:255], v[208:211], v[116:119]
 v_mfma_f32_16x16x32_bf16 v[124:127], a[248:251], v[196:199], v[124:127]
 v_mfma_f32_16x16x32_bf16 v[124:127], a[252:255], v[212:215], v[124:127]
 v_mfma_f32_16x16x32_bf16 v[128:131], a[128:131], a[160:163], 0
 v_mfma_f32_16x16x32_bf16 v[128:131], a[132:135], a[176:179], v[128:131]
 v_mul_f32 v64, 0x3e0293ee, v64
 v_mul_f32 v65, 0x3e0293ee, v65
 v_mfma_f32_16x16x32_bf16 v[132:135], a[128:131], a[164:167], 0
 v_cvt_pk_bf16_f32 v64, v64, v65
 v_mul_f32 v66, 0x3e0293ee, v66
 v_mfma_f32_16x16x32_bf16 v[132:135], a[132:135], a[180:183], v[132:135]
 v_mul_f32 v67, 0x3e0293ee, v67
 v_cvt_pk_bf16_f32 v65, v66, v67
 v_mfma_f32_16x16x32_bf16 v[136:139], a[128:131], a[168:171], 0
 v_mul_f32 v68, 0x3e0293ee, v68
 v_mul_f32 v69, 0x3e0293ee, v69
 v_mfma_f32_16x16x32_bf16 v[136:139], a[132:135], a[184:187], v[136:139]
 v_cvt_pk_bf16_f32 v66, v68, v69
 v_mul_f32 v70, 0x3e0293ee, v70
 v_mfma_f32_16x16x32_bf16 v[140:143], a[128:131], a[172:175], 0
 v_mul_f32 v71, 0x3e0293ee, v71
 v_cvt_pk_bf16_f32 v67, v70, v71
 v_mfma_f32_16x16x32_bf16 v[140:143], a[132:135], a[188:191], v[140:143]
 v_mul_f32 v72, 0x3e0293ee, v72
 v_mul_f32 v73, 0x3e0293ee, v73
 v_mfma_f32_16x16x32_bf16 v[144:147], a[144:147], a[160:163], 0
 v_cvt_pk_bf16_f32 v68, v72, v73
 v_mul_f32 v74, 0x3e0293ee, v74
 v_mfma_f32_16x16x32_bf16 v[144:147], a[148:151], a[176:179], v[144:147]
 v_mul_f32 v75, 0x3e0293ee, v75
 v_cvt_pk_bf16_f32 v69, v74, v75
 v_mfma_f32_16x16x32_bf16 v[148:151], a[144:147], a[164:167], 0
 v_mul_f32 v76, 0x3e0293ee, v76
 v_mul_f32 v77, 0x3e0293ee, v77
 v_mfma_f32_16x16x32_bf16 v[148:151], a[148:151], a[180:183], v[148:151]
 v_cvt_pk_bf16_f32 v70, v76, v77
 v_mul_f32 v78, 0x3e0293ee, v78
 v_mfma_f32_16x16x32_bf16 v[152:155], a[144:147], a[168:171], 0
 v_mul_f32 v79, 0x3e0293ee, v79
 v_cvt_pk_bf16_f32 v71, v78, v79
 v_mfma_f32_16x16x32_bf16 v[152:155], a[148:151], a[184:187], v[152:155]
 v_mul_f32 v80, 0x3e0293ee, v80
 v_mul_f32 v81, 0x3e0293ee, v81
 v_mfma_f32_16x16x32_bf16 v[156:159], a[144:147], a[172:175], 0
 v_cvt_pk_bf16_f32 v72, v80, v81
 v_mul_f32 v82, 0x3e0293ee, v82
 v_mfma_f32_16x16x32_bf16 v[156:159], a[148:151], a[188:191], v[156:159]
 v_mul_f32 v83, 0x3e0293ee, v83
 v_cvt_pk_bf16_f32 v73, v82, v83
 v_mul_f32 v84, 0x3e0293ee, v84
 v_mul_f32 v85, 0x3e0293ee, v85
 v_cvt_pk_bf16_f32 v74, v84, v85
 v_mul_f32 v86, 0x3e0293ee, v86
 v_mul_f32 v87, 0x3e0293ee, v87
 v_cvt_pk_bf16_f32 v75, v86, v87
 v_mul_f32 v88, 0x3e0293ee, v88
 v_mul_f32 v89, 0x3e0293ee, v89
 v_cvt_pk_bf16_f32 v76, v88, v89
 v_mul_f32 v90, 0x3e0293ee, v90
 v_mul_f32 v91, 0x3e0293ee, v91
 v_cvt_pk_bf16_f32 v77, v90, v91
 v_mul_f32 v92, 0x3e0293ee, v92
 v_mul_f32 v93, 0x3e0293ee, v93
 v_cvt_pk_bf16_f32 v78, v92, v93
 v_mul_f32 v94, 0x3e0293ee, v94
 v_mul_f32 v95, 0x3e0293ee, v95
 v_cvt_pk_bf16_f32 v79, v94, v95
 v_mul_f32 v96, 0x3e0293ee, v96
 v_mul_f32 v97, 0x3e0293ee, v97
 v_cvt_pk_bf16_f32 v80, v96, v97
 v_mul_f32 v98, 0x3e0293ee, v98
 v_mul_f32 v99, 0x3e0293ee, v99
 v_cvt_pk_bf16_f32 v81, v98, v99
 v_mul_f32 v100, 0x3e0293ee, v100
 v_mul_f32 v101, 0x3e0293ee, v101
 v_cvt_pk_bf16_f32 v82, v100, v101
 v_mul_f32 v102, 0x3e0293ee, v102
 v_mul_f32 v103, 0x3e0293ee, v103
 v_cvt_pk_bf16_f32 v83, v102, v103
 v_mul_f32 v104, 0x3e0293ee, v104
 v_mul_f32 v105, 0x3e0293ee, v105
 v_cvt_pk_bf16_f32 v84, v104, v105
 v_mul_f32 v106, 0x3e0293ee, v106
 v_mul_f32 v107, 0x3e0293ee, v107
 v_cvt_pk_bf16_f32 v85, v106, v107
 v_mul_f32 v108, 0x3e0293ee, v108
 v_mul_f32 v109, 0x3e0293ee, v109
 v_cvt_pk_bf16_f32 v86, v108, v109
 v_mul_f32 v110, 0x3e0293ee, v110
 v_mul_f32 v111, 0x3e0293ee, v111
 v_cvt_pk_bf16_f32 v87, v110, v111
 v_mul_f32 v112, 0x3e0293ee, v112
 v_mul_f32 v113, 0x3e0293ee, v113
 v_cvt_pk_bf16_f32 v88, v112, v113
 v_mul_f32 v114, 0x3e0293ee, v114
 v_mul_f32 v115, 0x3e0293ee, v115
 v_cvt_pk_bf16_f32 v89, v114, v115
 v_mul_f32 v116, 0x3e0293ee, v116
 v_mul_f32 v117, 0x3e0293ee, v117
 v_cvt_pk_bf16_f32 v90, v116, v117
 v_mul_f32 v118, 0x3e0293ee, v118
 v_mul_f32 v119, 0x3e0293ee, v119
 v_cvt_pk_bf16_f32 v91, v118, v119
 v_mul_f32 v120, 0x3e0293ee, v120
 v_mul_f32 v121, 0x3e0293ee, v121
 v_cvt_pk_bf16_f32 v92, v120, v121
 v_mul_f32 v122, 0x3e0293ee, v122
 v_mul_f32 v123, 0x3e0293ee, v123
 v_cvt_pk_bf16_f32 v93, v122, v123
 v_mul_f32 v124, 0x3e0293ee, v124
 v_mul_f32 v125, 0x3e0293ee, v125
 v_cvt_pk_bf16_f32 v94, v124, v125
 v_mul_f32 v126, 0x3e0293ee, v126
 v_mul_f32 v127, 0x3e0293ee, v127
 v_cvt_pk_bf16_f32 v95, v126, v127
 v_mfma_f32_16x16x32_bf16 v[128:131], a[136:139], v[64:67], v[128:131]
 s_lshl_b32 s49, s17, 7
 v_and_b32 v224, 3, v1
 v_mov_b32 v225, 0x3f803f80
 v_mfma_f32_16x16x32_bf16 v[128:131], a[140:143], v[80:83], v[128:131]
 s_lshl_b32 s62, s16, 2
 v_cmp_eq_u32 vcc, 0, v224
 v_mov_b32 v232, 0
 v_mfma_f32_16x16x32_bf16 v[132:135], a[136:139], v[68:71], v[132:135]
 s_add_u32 s49, s49, s62
 v_cndmask_b32 v212, 0, v225, vcc
 v_mov_b32 v213, v212
 v_mfma_f32_16x16x32_bf16 v[132:135], a[140:143], v[84:87], v[132:135]
 s_add_u32 s49, s49, 0x300400
 v_mov_b32 v214, v212
 v_mov_b32 v215, v212
 v_mfma_f32_16x16x32_bf16 v[136:139], a[136:139], v[72:75], v[136:139]
 s_lshl_b32 s18, s72, 1
 v_cmp_eq_u32 vcc, 1, v224
 v_mov_b32 v233, 0
 v_mfma_f32_16x16x32_bf16 v[136:139], a[140:143], v[88:91], v[136:139]
 s_lshl_b32 s63, s70, 4
 v_cndmask_b32 v216, 0, v225, vcc
 v_mov_b32 v217, v216
 v_mfma_f32_16x16x32_bf16 v[140:143], a[136:139], v[76:79], v[140:143]
 s_add_u32 s63, s63, s71
 v_mov_b32 v218, v216
 v_mov_b32 v219, v216
 v_mfma_f32_16x16x32_bf16 v[140:143], a[140:143], v[92:95], v[140:143]
 s_lshl_b32 s50, s18, 7
 v_cmp_eq_u32 vcc, 2, v224
 v_mov_b32 v234, 0
 v_mfma_f32_16x16x32_bf16 v[144:147], a[152:155], v[64:67], v[144:147]
 s_lshl_b32 s62, s63, 2
 v_cndmask_b32 v220, 0, v225, vcc
 v_mov_b32 v221, v220
 v_mfma_f32_16x16x32_bf16 v[144:147], a[156:159], v[80:83], v[144:147]
 s_add_u32 s50, s50, s62
 v_mov_b32 v222, v220
 v_mov_b32 v223, v220
 v_mfma_f32_16x16x32_bf16 v[148:151], a[152:155], v[68:71], v[148:151]
 s_add_u32 s50, s50, 0x300c00
 v_cmp_eq_u32 vcc, 3, v224
 v_mov_b32 v235, 0
 v_mfma_f32_16x16x32_bf16 v[148:151], a[156:159], v[84:87], v[148:151]
 s_memrealtime s[0:1]
 v_cndmask_b32 v236, 0, v225, vcc
 v_mov_b32 v237, v236
 v_mfma_f32_16x16x32_bf16 v[152:155], a[152:155], v[72:75], v[152:155]
 s_memtime  s[56:57]
 v_mov_b32 v238, v236
 v_mov_b32 v239, v236
 v_mfma_f32_16x16x32_bf16 v[152:155], a[156:159], v[88:91], v[152:155]
 s_mov_b32 s51, 0
 v_cmp_gt_u32 vcc, 54, v1
 v_mov_b32 v227, 0x40000000
 v_mfma_f32_16x16x32_bf16 v[156:159], a[152:155], v[76:79], v[156:159]
 s_mov_b32 s52, 0xfffff940
 v_cndmask_b32 v5, v227, v2, vcc
 v_mov_b32 v48, 0
 v_mfma_f32_16x16x32_bf16 v[156:159], a[156:159], v[92:95], v[156:159]
 s_mov_b32 s53, 0x2880
 v_mov_b32 v49, 0
 v_mov_b32 v50, 0
 s_mov_b32 s54, 0x360
 s_mov_b32 s19, 0xe38e38f
 v_mul_hi_u32 v226, v1, s19
 v_mul_u32_u24 v226, 0x360, v226
 v_add_u32 v4, v2, v226
 v_cndmask_b32 v4, v227, v4, vcc
 v_mov_b32 v51, 0
 v_mov_b32 v52, 0
 v_mov_b32 v53, 0
 v_mov_b32 v54, 0
 v_mov_b32 v55, 0
 v_mov_b32 v56, 0
 v_mov_b32 v57, 0
 v_mov_b32 v58, 0
 v_mov_b32 v59, 0
 v_mov_b32 v60, 0
 v_mov_b32 v61, 0
 v_mov_b32 v62, 0
 v_mov_b32 v63, 0
 v_max3_f32 v241, v128, v129, v130
 v_max3_f32 v243, v132, v133, v134
 v_max3_f32 v245, v136, v137, v138
 v_max3_f32 v247, v140, v141, v142
 v_max3_f32 v241, v241, v131, v144
 v_max3_f32 v243, v243, v135, v148
 v_max3_f32 v245, v245, v139, v152
 v_max3_f32 v247, v247, v143, v156
 v_max3_f32 v241, v241, v145, v146
 v_max3_f32 v243, v243, v149, v150
 v_max3_f32 v245, v245, v153, v154
 v_max3_f32 v247, v247, v157, v158
 v_max_f32 v241, v241, v147
 v_max_f32 v243, v243, v151
 v_max_f32 v245, v245, v155
 v_max_f32 v247, v247, v159
 v_mov_b32 v242, v241
 v_mov_b32 v244, v243
 v_mov_b32 v246, v245
 v_mov_b32 v248, v247
 v_permlane16_swap_b32 v241, v242
 v_permlane16_swap_b32 v243, v244
 v_permlane16_swap_b32 v245, v246
 v_permlane16_swap_b32 v247, v248
 v_max_f32 v241, v241, v242
 v_max_f32 v243, v243, v244
 v_max_f32 v245, v245, v246
 v_max_f32 v247, v247, v248
 v_mov_b32 v242, v241
 v_mov_b32 v244, v243
 v_mov_b32 v246, v245
 v_mov_b32 v248, v247
 v_permlane32_swap_b32 v241, v242
 v_permlane32_swap_b32 v243, v244
 v_permlane32_swap_b32 v245, v246
 v_permlane32_swap_b32 v247, v248
 v_max_f32 v241, v241, v242
 v_max_f32 v243, v243, v244
 v_max_f32 v245, v245, v246
 v_max_f32 v247, v247, v248
 v_sub_f32 v192, 0, v241
 v_sub_f32 v193, 0, v241
 v_sub_f32 v194, 0, v241
 v_sub_f32 v195, 0, v241
 v_sub_f32 v196, 0, v243
 v_sub_f32 v197, 0, v243
 v_sub_f32 v198, 0, v243
 v_sub_f32 v199, 0, v243
 v_sub_f32 v200, 0, v245
 v_sub_f32 v201, 0, v245
 v_sub_f32 v202, 0, v245
 v_sub_f32 v203, 0, v245
 v_sub_f32 v204, 0, v247
 v_sub_f32 v205, 0, v247
 v_sub_f32 v206, 0, v247
 v_sub_f32 v207, 0, v247
 v_sub_f32 v128, v128, v241
 v_sub_f32 v129, v129, v241
 v_sub_f32 v130, v130, v241
 v_sub_f32 v131, v131, v241
 v_sub_f32 v132, v132, v243
 v_sub_f32 v133, v133, v243
 v_sub_f32 v134, v134, v243
 v_sub_f32 v135, v135, v243
 v_sub_f32 v136, v136, v245
 v_sub_f32 v137, v137, v245
 v_sub_f32 v138, v138, v245
 v_sub_f32 v139, v139, v245
 v_sub_f32 v140, v140, v247
 v_sub_f32 v141, v141, v247
 v_sub_f32 v142, v142, v247
 v_sub_f32 v143, v143, v247
 v_sub_f32 v144, v144, v241
 v_sub_f32 v145, v145, v241
 v_sub_f32 v146, v146, v241
 v_sub_f32 v147, v147, v241
 v_sub_f32 v148, v148, v243
 v_sub_f32 v149, v149, v243
 v_sub_f32 v150, v150, v243
 v_sub_f32 v151, v151, v243
 v_sub_f32 v152, v152, v245
 v_sub_f32 v153, v153, v245
 v_sub_f32 v154, v154, v245
 v_sub_f32 v155, v155, v245
 v_sub_f32 v156, v156, v247
 v_sub_f32 v157, v157, v247
 v_sub_f32 v158, v158, v247
 v_sub_f32 v159, v159, v247
 v_exp_f32 v224, v128
 v_exp_f32 v225, v129
 v_exp_f32 v226, v130
 v_exp_f32 v227, v131
 v_cvt_pk_bf16_f32 v160, v224, v225
 v_cvt_pk_bf16_f32 v161, v226, v227
 v_exp_f32 v228, v132
 v_exp_f32 v229, v133
 s_nop 0
 v_cvt_pk_bf16_f32 v164, v228, v229
 v_exp_f32 v230, v134
 v_exp_f32 v231, v135
 s_nop 0
 v_cvt_pk_bf16_f32 v165, v230, v231
 v_exp_f32 v224, v136
 v_exp_f32 v225, v137
 s_nop 0
 v_cvt_pk_bf16_f32 v168, v224, v225
 v_exp_f32 v226, v138
 v_exp_f32 v227, v139
 s_nop 0
 v_cvt_pk_bf16_f32 v169, v226, v227
 v_exp_f32 v228, v140
 v_exp_f32 v229, v141
 v_exp_f32 v230, v142
 v_exp_f32 v231, v143
 ds_read_b128 a[128:131], v14 offset:40960
 v_cvt_pk_bf16_f32 v172, v228, v229
 v_exp_f32 v224, v144
 v_exp_f32 v225, v145
 ds_read_b128 a[132:135], v15 offset:40960
 v_cvt_pk_bf16_f32 v173, v230, v231
 v_exp_f32 v226, v146
 v_exp_f32 v227, v147
 v_cvt_pk_bf16_f32 v162, v224, v225
 v_cvt_pk_bf16_f32 v163, v226, v227
 v_exp_f32 v228, v148
 ds_read_b128 a[136:139], v16 offset:40960
 v_exp_f32 v229, v149
 v_exp_f32 v230, v150
 ds_read_b128 a[140:143], v17 offset:40960
 v_cvt_pk_bf16_f32 v166, v228, v229
 s_waitcnt vmcnt(0)
 s_barrier
 s_cmp_lg_u32 s3, 0
 s_cbranch_scc1 L_sg3
 s_mov_b64 exec, 1
 buffer_store_dword v253, off, s[36:39], s49 sc1
 s_mov_b64 exec, -1
L_sg3:
 s_add_u32 m0, s66, 0x17000
 s_nop 0
 buffer_load_dwordx4 v26, s[20:23], s64 offen lds
 buffer_load_dwordx4 v27, s[20:23], s64 offen offset:1024 lds
 buffer_load_dwordx4 v28, s[20:23], s64 offen offset:2048 lds
 buffer_load_dwordx4 v29, s[20:23], s64 offen offset:3072 lds
 s_add_u32 s64, s64, 0x4000
 s_add_u32 s66, s66, 0x4000
 s_and_b32 s66, s66, 0xffff
 buffer_load_dword v250, v4, s[40:43], 0 offen
 s_waitcnt lgkmcnt(3)
 s_mov_b32 s68, 7
 s_branch L_enter
 .fill ((128 + 4 - ((. - recurrent_scan__mha_block_cached__geglu_ffn__prompt_kernel + L_loop - L_side) & 127)) & 127) / 4, 4, 0xbf800000
L_side:
 s_cmp_eq_u32 s68, 1
 s_cbranch_scc1 L_side1
 s_lshl_b32 s18, s71, 2
 s_add_u32 s48, s18, s72
 s_lshl_b32 s57, s48, 17
 s_lshl_b32 s19, s3, 13
 s_add_u32 s57, s57, s19
 s_add_u32 s57, s57, 0x2600000
 s_lshl_b32 s48, s48, 7
 s_add_u32 s48, s48, 0x301400
 s_lshl_b32 s18, s70, 15
 s_add_u32 s18, s18, s57
 s_add_u32 s18, s18, 0x800000
 s_add_u32 s44, s14, s18
 s_addc_u32 s45, s15, 0
 s_mov_b32 s46, 0x1c00
 s_mov_b32 s47, 0x20000
 s_mov_b32 s52, 0
 s_mov_b32 s53, 0x1c00
 s_mov_b32 s54, 0x400
 v_mov_b32 v5, v2
 s_cmp_lg_u32 s3, 0
 s_cbranch_scc1 L_loop
 s_mov_b64 exec, 1
 buffer_store_dword v253, off, s[36:39], s50 sc1
 s_memrealtime s[32:33]
 s_memtime  s[8:9]
 s_lshl_b32 s18, s71, 2
 s_add_u32 s18, s18, s72
 s_lshl_b32 s19, s18, 7
 s_lshl_b32 s62, s70, 3
 s_add_u32 s19, s19, s62
 s_add_u32 s19, s19, 0x303400
 s_waitcnt lgkmcnt(0)
 s_sub_u32 s33, s32, s0
 s_sub_u32 s8, s8, s56
 s_sub_u32 s32, s32, s59
 v_cvt_f32_u32 v251, s8
 v_cvt_f32_u32 v252, s33
 v_rcp_f32 v251, v251
 v_mul_f32 v252, 0x4782dc00, v252
 v_mul_f32 v252, v252, v251
 v_cvt_u32_f32 v252, v252
 v_add_u32 v252, s32, v252
 buffer_store_dwordx2 v[252:253], off, s[36:39], s19 sc1
 s_mov_b64 exec, -1
 s_branch L_loop
L_side1:
 s_getpc_b64 s[62:63]
L_pc11:
 s_add_u32 s62, s62, L_peel-L_pc11
 s_addc_u32 s63, s63, 0
 s_bfe_u32 s18, s2, 0x30003
 s_lshl_b32 s18, s18, 2
 s_add_u32 s18, s18, s3
 s_lshl_b32 s18, s18, 11
 s_add_u32 s62, s62, s18
 s_addc_u32 s63, s63, 0
 v_and_b32 v244, 15, v1
 v_lshlrev_b32 v244, 7, v244
 v_mov_b32 v245, s63
 v_add_co_u32 v244, vcc, s62, v244
 s_nop 1
 v_addc_co_u32 v245, vcc, 0, v245, vcc
 global_load_dword v250, v[244:245], off
L_loop:
 v_mfma_f32_16x16x32_bf16 v[128:131], a[128:131], a[160:163], v[192:195]
 s_waitcnt lgkmcnt(2)
 s_and_b32 s67, s67, 0xffff
 v_exp_f32 v230, v118
 v_mfma_f32_16x16x32_bf16 v[128:131], a[132:135], a[176:179], v[128:131]
 s_add_u32 m0, s66, 0x17000
 v_exp_f32 v231, v119
 v_mfma_f32_16x16x32_bf16 v[132:135], a[128:131], a[164:167], v[196:199]
 buffer_load_dwordx4 v26, s[20:23], s64 offen lds
 v_mfma_f32_16x16x32_bf16 v[132:135], a[132:135], a[180:183], v[132:135]
 v_cvt_pk_bf16_f32 v54, v228, v229
 v_cvt_pk_bf16_f32 v55, v230, v231
 v_mfma_f32_16x16x32_bf16 v[136:139], a[128:131], a[168:171], v[200:203]
 ds_read_b128 a[144:147], v14 offset:36864
 v_mfma_f32_16x16x32_bf16 v[136:139], a[132:135], a[184:187], v[136:139]
 v_exp_f32 v224, v120
 v_mfma_f32_16x16x32_bf16 v[140:143], a[128:131], a[172:175], v[204:207]
 v_exp_f32 v225, v121
 v_mfma_f32_16x16x32_bf16 v[140:143], a[132:135], a[188:191], v[140:143]
 s_waitcnt lgkmcnt(2)
 ds_read_b128 a[148:151], v15 offset:36864
 v_cvt_pk_bf16_f32 v58, v224, v225
 v_mfma_f32_16x16x32_bf16 v[128:131], a[136:139], v[64:67], v[128:131]
 s_waitcnt lgkmcnt(2)
 buffer_load_dwordx4 v27, s[20:23], s64 offen offset:1024 lds
 v_mfma_f32_16x16x32_bf16 v[128:131], a[140:143], v[80:83], v[128:131]
 v_exp_f32 v226, v122
 v_mfma_f32_16x16x32_bf16 v[132:135], a[136:139], v[68:71], v[132:135]
 v_exp_f32 v227, v123
 v_mfma_f32_16x16x32_bf16 v[132:135], a[140:143], v[84:87], v[132:135]
 v_exp_f32 v228, v124
 v_mfma_f32_16x16x32_bf16 v[136:139], a[136:139], v[72:75], v[136:139]
 v_exp_f32 v229, v125
 v_mfma_f32_16x16x32_bf16 v[136:139], a[140:143], v[88:91], v[136:139]
 v_cvt_pk_bf16_f32 v59, v226, v227
 v_cvt_pk_bf16_f32 v62, v228, v229
 v_mfma_f32_16x16x32_bf16 v[140:143], a[136:139], v[76:79], v[140:143]
 v_exp_f32 v230, v126
 v_mfma_f32_16x16x32_bf16 v[140:143], a[140:143], v[92:95], v[140:143]
 s_waitcnt lgkmcnt(1)
 v_mfma_f32_16x16x32_bf16 v[144:147], a[144:147], a[160:163], v[192:195]
 s_waitcnt lgkmcnt(0)
 ds_read_b128 a[152:155], v16 offset:36864
 v_mfma_f32_16x16x32_bf16 v[144:147], a[148:151], a[176:179], v[144:147]
 v_exp_f32 v231, v127
 v_mfma_f32_16x16x32_bf16 v[148:151], a[144:147], a[164:167], v[196:199]
 buffer_load_dwordx4 v28, s[20:23], s64 offen offset:2048 lds
 v_mfma_f32_16x16x32_bf16 v[148:151], a[148:151], a[180:183], v[148:151]
 ds_read_b128 a[156:159], v17 offset:36864
 v_cvt_pk_bf16_f32 v63, v230, v231
 v_mfma_f32_16x16x32_bf16 v[152:155], a[144:147], a[168:171], v[200:203]
 v_mfma_f32_16x16x32_bf16 v[152:155], a[148:151], a[184:187], v[152:155]
 v_mfma_f32_16x16x32_bf16 v[156:159], a[144:147], a[172:175], v[204:207]
 ds_read_b64_tr_b16 a[128:129], v22 offset:49152
 ds_read_b64_tr_b16 a[130:131], v22 offset:53248
 v_mfma_f32_16x16x32_bf16 v[156:159], a[148:151], a[188:191], v[156:159]
 v_mfma_f32_16x16x32_bf16 v[208:211], v[212:215], v[48:51], 0
 v_exp_f32 v224, v128
 v_mfma_f32_16x16x32_bf16 v[208:211], v[216:219], v[52:55], v[208:211]
 v_exp_f32 v225, v129
 v_mfma_f32_16x16x32_bf16 v[208:211], v[220:223], v[56:59], v[208:211]
 ds_read_b64_tr_b16 a[132:133], v22 offset:57344
 ds_read_b64_tr_b16 a[134:135], v22 offset:61440
 v_mfma_f32_16x16x32_bf16 v[208:211], v[236:239], v[60:63], v[208:211]
 s_waitcnt lgkmcnt(5)
 v_exp_f32 v226, v130
 v_mfma_f32_16x16x32_bf16 v[144:147], a[152:155], v[64:67], v[144:147]
 s_waitcnt lgkmcnt(4)
 buffer_load_dwordx4 v29, s[20:23], s64 offen offset:3072 lds
 v_mfma_f32_16x16x32_bf16 v[144:147], a[156:159], v[80:83], v[144:147]
 v_exp_f32 v227, v131
 v_mfma_f32_16x16x32_bf16 v[148:151], a[152:155], v[68:71], v[148:151]
 ds_read_b64_tr_b16 a[136:137], v23 offset:49152
 ds_read_b64_tr_b16 a[138:139], v23 offset:53248
 v_mfma_f32_16x16x32_bf16 v[148:151], a[156:159], v[84:87], v[148:151]
 v_cvt_pk_bf16_f32 v160, v224, v225
 v_cvt_pk_bf16_f32 v161, v226, v227
 v_mfma_f32_16x16x32_bf16 v[152:155], a[152:155], v[72:75], v[152:155]
 v_maximum3_f32 v240, v208, v209, v210
 v_maximum3_f32 v240, v240, v211, v211
 v_mfma_f32_16x16x32_bf16 v[152:155], a[156:159], v[88:91], v[152:155]
 v_cmp_nge_f32 vcc, s69, v240
 v_mfma_f32_16x16x32_bf16 v[156:159], a[152:155], v[76:79], v[156:159]
 s_waitcnt lgkmcnt(4)
 ds_read_b64_tr_b16 a[140:141], v23 offset:57344
 ds_read_b64_tr_b16 a[142:143], v23 offset:61440
 v_mfma_f32_16x16x32_bf16 v[156:159], a[156:159], v[92:95], v[156:159]
 s_cbranch_vccnz L_rare7
L_back7:
 v_exp_f32 v228, v132
 v_mfma_f32_16x16x32_bf16 a[64:67], a[128:131], v[32:35], a[64:67]
 s_waitcnt lgkmcnt(4)
 v_exp_f32 v229, v133
 v_mfma_f32_16x16x32_bf16 a[64:67], a[132:135], v[48:51], a[64:67]
 v_cvt_pk_bf16_f32 v164, v228, v229
 v_add_f32 v235, v235, v211
 v_mfma_f32_16x16x32_bf16 a[68:71], a[128:131], v[36:39], a[68:71]
 s_add_u32 s64, s64, 0x4000
 buffer_load_dwordx4 v[10:13], v4, s[40:43], s51 offen
 v_mfma_f32_16x16x32_bf16 a[68:71], a[132:135], v[52:55], a[68:71]
 s_add_u32 s66, s66, 0x4000
 ds_read_b64_tr_b16 a[144:145], v24 offset:49152
 ds_read_b64_tr_b16 a[146:147], v24 offset:53248
 v_mfma_f32_16x16x32_bf16 a[72:75], a[128:131], v[40:43], a[72:75]
 s_and_b32 s66, s66, 0xffff
 v_exp_f32 v230, v134
 v_mfma_f32_16x16x32_bf16 a[72:75], a[132:135], v[56:59], a[72:75]
 v_exp_f32 v231, v135
 v_mfma_f32_16x16x32_bf16 a[76:79], a[128:131], v[44:47], a[76:79]
 ds_read_b64_tr_b16 a[148:149], v24 offset:57344
 ds_read_b64_tr_b16 a[150:151], v24 offset:61440
 v_mfma_f32_16x16x32_bf16 a[76:79], a[132:135], v[60:63], a[76:79]
 s_waitcnt lgkmcnt(6)
 v_cvt_pk_bf16_f32 v165, v230, v231
 v_add_f32 v234, v234, v210
 v_mfma_f32_16x16x32_bf16 a[80:83], a[136:139], v[32:35], a[80:83]
 s_waitcnt lgkmcnt(4)
 v_exp_f32 v224, v136
 v_mfma_f32_16x16x32_bf16 a[80:83], a[140:143], v[48:51], a[80:83]
 v_exp_f32 v225, v137
 v_mfma_f32_16x16x32_bf16 a[84:87], a[136:139], v[36:39], a[84:87]
 ds_read_b64_tr_b16 a[152:153], v25 offset:49152
 ds_read_b64_tr_b16 a[154:155], v25 offset:53248
 v_mfma_f32_16x16x32_bf16 a[84:87], a[140:143], v[52:55], a[84:87]
 v_cvt_pk_bf16_f32 v168, v224, v225
 v_add_f32 v233, v233, v209
 v_mfma_f32_16x16x32_bf16 a[88:91], a[136:139], v[40:43], a[88:91]
 s_add_u32 s51, s51, 0xd80
 v_exp_f32 v226, v138
 v_mfma_f32_16x16x32_bf16 a[88:91], a[140:143], v[56:59], a[88:91]
 v_exp_f32 v227, v139
 v_mfma_f32_16x16x32_bf16 a[92:95], a[136:139], v[44:47], a[92:95]
 ds_read_b64_tr_b16 a[156:157], v25 offset:57344
 ds_read_b64_tr_b16 a[158:159], v25 offset:61440
 v_mfma_f32_16x16x32_bf16 a[92:95], a[140:143], v[60:63], a[92:95]
 s_waitcnt lgkmcnt(6)
 v_cvt_pk_bf16_f32 v169, v226, v227
 v_add_f32 v232, v232, v208
 v_mfma_f32_16x16x32_bf16 a[96:99], a[144:147], v[32:35], a[96:99]
 s_waitcnt lgkmcnt(4)
 v_exp_f32 v228, v140
 v_mfma_f32_16x16x32_bf16 a[96:99], a[148:151], v[48:51], a[96:99]
 v_exp_f32 v229, v141
 v_mfma_f32_16x16x32_bf16 a[100:103], a[144:147], v[36:39], a[100:103]
 s_waitcnt vmcnt(10)
 v_exp_f32 v230, v142
 v_mfma_f32_16x16x32_bf16 a[100:103], a[148:151], v[52:55], a[100:103]
 s_barrier
 v_exp_f32 v231, v143
 v_mfma_f32_16x16x32_bf16 a[104:107], a[144:147], v[40:43], a[104:107]
 ds_read_b128 a[128:131], v14 offset:40960
 v_cvt_pk_bf16_f32 v172, v228, v229
 v_mfma_f32_16x16x32_bf16 a[104:107], a[148:151], v[56:59], a[104:107]
 v_exp_f32 v224, v144
 v_mfma_f32_16x16x32_bf16 a[108:111], a[144:147], v[44:47], a[108:111]
 v_exp_f32 v225, v145
 v_mfma_f32_16x16x32_bf16 a[108:111], a[148:151], v[60:63], a[108:111]
 s_waitcnt lgkmcnt(3)
 ds_read_b128 a[132:135], v15 offset:40960
 v_cvt_pk_bf16_f32 v173, v230, v231
 v_mfma_f32_16x16x32_bf16 a[112:115], a[152:155], v[32:35], a[112:115]
 s_waitcnt lgkmcnt(2)
 v_exp_f32 v226, v146
 v_mfma_f32_16x16x32_bf16 a[112:115], a[156:159], v[48:51], a[112:115]
 v_exp_f32 v227, v147
 v_mfma_f32_16x16x32_bf16 a[116:119], a[152:155], v[36:39], a[116:119]
 v_cvt_pk_bf16_f32 v162, v224, v225
 v_cvt_pk_bf16_f32 v163, v226, v227
 v_mfma_f32_16x16x32_bf16 a[116:119], a[156:159], v[52:55], a[116:119]
 v_exp_f32 v228, v148
 v_mfma_f32_16x16x32_bf16 a[120:123], a[152:155], v[40:43], a[120:123]
 ds_read_b128 a[136:139], v16 offset:40960
 v_mfma_f32_16x16x32_bf16 a[120:123], a[156:159], v[56:59], a[120:123]
 v_exp_f32 v229, v149
 v_mfma_f32_16x16x32_bf16 a[124:127], a[152:155], v[44:47], a[124:127]
 v_exp_f32 v230, v150
 v_mfma_f32_16x16x32_bf16 a[124:127], a[156:159], v[60:63], a[124:127]
 s_waitcnt lgkmcnt(2)
 ds_read_b128 a[140:143], v17 offset:40960
 v_cvt_pk_bf16_f32 v166, v228, v229
L_enter:
 v_mfma_f32_16x16x32_bf16 v[96:99], a[128:131], a[160:163], v[192:195]
 s_waitcnt vmcnt(9) lgkmcnt(2)
 v_exp_f32 v231, v151
 v_mfma_f32_16x16x32_bf16 v[96:99], a[132:135], a[176:179], v[96:99]
 s_cmp_ge_u32 s52, s53
 v_cvt_pk_bf16_f32 v167, v230, v231
 v_mfma_f32_16x16x32_bf16 v[100:103], a[128:131], a[164:167], v[196:199]
 s_cselect_b64 exec, 0, -1
 buffer_store_dwordx4 v[6:9], v5, s[44:47], s52 offen sc1
 s_mov_b64 exec, -1
 v_mfma_f32_16x16x32_bf16 v[100:103], a[132:135], a[180:183], v[100:103]
 s_add_u32 s52, s52, s54
 v_exp_f32 v224, v152
 v_mfma_f32_16x16x32_bf16 v[104:107], a[128:131], a[168:171], v[200:203]
 ds_read_b128 a[144:147], v14 offset:45056
 v_mfma_f32_16x16x32_bf16 v[104:107], a[132:135], a[184:187], v[104:107]
 v_exp_f32 v225, v153
 v_mfma_f32_16x16x32_bf16 v[108:111], a[128:131], a[172:175], v[204:207]
 v_exp_f32 v226, v154
 v_mfma_f32_16x16x32_bf16 v[108:111], a[132:135], a[188:191], v[108:111]
 s_waitcnt lgkmcnt(2)
 ds_read_b128 a[148:151], v15 offset:45056
 v_cvt_pk_bf16_f32 v170, v224, v225
 v_mfma_f32_16x16x32_bf16 v[96:99], a[136:139], v[64:67], v[96:99]
 s_waitcnt lgkmcnt(2)
 v_exp_f32 v227, v155
 v_mfma_f32_16x16x32_bf16 v[96:99], a[140:143], v[80:83], v[96:99]
 v_cvt_pk_bf16_f32 v171, v226, v227
 v_mfma_f32_16x16x32_bf16 v[100:103], a[136:139], v[68:71], v[100:103]
 v_exp_f32 v228, v156
 v_mfma_f32_16x16x32_bf16 v[100:103], a[140:143], v[84:87], v[100:103]
 v_mfma_f32_16x16x32_bf16 v[104:107], a[136:139], v[72:75], v[104:107]
 v_exp_f32 v229, v157
 v_mfma_f32_16x16x32_bf16 v[104:107], a[140:143], v[88:91], v[104:107]
 v_cvt_pk_bf16_f32 v174, v228, v229
 v_mfma_f32_16x16x32_bf16 v[108:111], a[136:139], v[76:79], v[108:111]
 v_exp_f32 v230, v158
 v_mfma_f32_16x16x32_bf16 v[108:111], a[140:143], v[92:95], v[108:111]
 s_waitcnt lgkmcnt(1)
 v_mfma_f32_16x16x32_bf16 v[112:115], a[144:147], a[160:163], v[192:195]
 s_waitcnt lgkmcnt(0)
 ds_read_b128 a[152:155], v16 offset:45056
 v_mfma_f32_16x16x32_bf16 v[112:115], a[148:151], a[176:179], v[112:115]
 v_exp_f32 v231, v159
 v_mfma_f32_16x16x32_bf16 v[116:119], a[144:147], a[164:167], v[196:199]
 v_cvt_pk_bf16_f32 v175, v230, v231
 v_mfma_f32_16x16x32_bf16 v[116:119], a[148:151], a[180:183], v[116:119]
 ds_read_b128 a[156:159], v17 offset:45056
 v_mfma_f32_16x16x32_bf16 v[120:123], a[144:147], a[168:171], v[200:203]
 v_mfma_f32_16x16x32_bf16 v[120:123], a[148:151], a[184:187], v[120:123]
 v_mfma_f32_16x16x32_bf16 v[124:127], a[144:147], a[172:175], v[204:207]
 ds_read_b64_tr_b16 a[128:129], v18 offset:57344
 ds_read_b64_tr_b16 a[130:131], v18 offset:61440
 v_mfma_f32_16x16x32_bf16 v[124:127], a[148:151], a[188:191], v[124:127]
 v_mfma_f32_16x16x32_bf16 v[208:211], v[212:215], v[160:163], 0
 v_exp_f32 v224, v96
 v_mfma_f32_16x16x32_bf16 v[208:211], v[216:219], v[164:167], v[208:211]
 v_exp_f32 v225, v97
 v_mfma_f32_16x16x32_bf16 v[208:211], v[220:223], v[168:171], v[208:211]
 s_add_u32 m0, s67, 0x1000
 ds_read_b64_tr_b16 a[132:133], v18
 ds_read_b64_tr_b16 a[134:135], v18 offset:4096
 v_mfma_f32_16x16x32_bf16 v[208:211], v[236:239], v[172:175], v[208:211]
 s_waitcnt lgkmcnt(5)
 buffer_load_dwordx4 v30, s[24:27], s65 offen lds
 v_mfma_f32_16x16x32_bf16 v[112:115], a[152:155], v[64:67], v[112:115]
 s_waitcnt lgkmcnt(4)
 v_exp_f32 v226, v98
 v_mfma_f32_16x16x32_bf16 v[112:115], a[156:159], v[80:83], v[112:115]
 v_exp_f32 v227, v99
 v_mfma_f32_16x16x32_bf16 v[116:119], a[152:155], v[68:71], v[116:119]
 ds_read_b64_tr_b16 a[136:137], v19 offset:57344
 ds_read_b64_tr_b16 a[138:139], v19 offset:61440
 v_mfma_f32_16x16x32_bf16 v[116:119], a[156:159], v[84:87], v[116:119]
 v_cvt_pk_bf16_f32 v176, v224, v225
 v_cvt_pk_bf16_f32 v177, v226, v227
 v_mfma_f32_16x16x32_bf16 v[120:123], a[152:155], v[72:75], v[120:123]
 v_maximum3_f32 v240, v208, v209, v210
 v_maximum3_f32 v240, v240, v211, v211
 v_mfma_f32_16x16x32_bf16 v[120:123], a[156:159], v[88:91], v[120:123]
 v_cmp_nge_f32 vcc, s69, v240
 v_mfma_f32_16x16x32_bf16 v[124:127], a[152:155], v[76:79], v[124:127]
 s_waitcnt lgkmcnt(4)
 ds_read_b64_tr_b16 a[140:141], v19
 ds_read_b64_tr_b16 a[142:143], v19 offset:4096
 v_mfma_f32_16x16x32_bf16 v[124:127], a[156:159], v[92:95], v[124:127]
 s_cbranch_vccnz L_rare0
L_back0:
 v_exp_f32 v228, v100
 v_mfma_f32_16x16x32_bf16 a[0:3], a[128:131], v[48:51], a[0:3]
 s_waitcnt lgkmcnt(4)
 buffer_load_dwordx4 v31, s[24:27], s65 offen offset:1024 lds
 v_mfma_f32_16x16x32_bf16 a[0:3], a[132:135], v[160:163], a[0:3]
 v_exp_f32 v229, v101
 v_mfma_f32_16x16x32_bf16 a[4:7], a[128:131], v[52:55], a[4:7]
 ds_read_b64_tr_b16 a[144:145], v20 offset:57344
 ds_read_b64_tr_b16 a[146:147], v20 offset:61440
 v_mfma_f32_16x16x32_bf16 a[4:7], a[132:135], v[164:167], a[4:7]
 v_cvt_pk_bf16_f32 v180, v228, v229
 v_add_f32 v235, v235, v211
 v_mfma_f32_16x16x32_bf16 a[8:11], a[128:131], v[56:59], a[8:11]
 v_exp_f32 v230, v102
 v_mfma_f32_16x16x32_bf16 a[8:11], a[132:135], v[168:171], a[8:11]
 v_exp_f32 v231, v103
 v_mfma_f32_16x16x32_bf16 a[12:15], a[128:131], v[60:63], a[12:15]
 ds_read_b64_tr_b16 a[148:149], v20
 ds_read_b64_tr_b16 a[150:151], v20 offset:4096
 v_mfma_f32_16x16x32_bf16 a[12:15], a[132:135], v[172:175], a[12:15]
 s_waitcnt lgkmcnt(6)
 v_cvt_pk_bf16_f32 v181, v230, v231
 v_add_f32 v234, v234, v210
 v_mfma_f32_16x16x32_bf16 a[16:19], a[136:139], v[48:51], a[16:19]
 s_waitcnt lgkmcnt(4)
 v_exp_f32 v224, v104
 v_mfma_f32_16x16x32_bf16 a[16:19], a[140:143], v[160:163], a[16:19]
 v_exp_f32 v225, v105
 v_mfma_f32_16x16x32_bf16 a[20:23], a[136:139], v[52:55], a[20:23]
 ds_read_b64_tr_b16 a[152:153], v21 offset:57344
 ds_read_b64_tr_b16 a[154:155], v21 offset:61440
 v_mfma_f32_16x16x32_bf16 a[20:23], a[140:143], v[164:167], a[20:23]
 buffer_load_dwordx4 v30, s[24:27], s65 offen offset:2048 lds
 v_mfma_f32_16x16x32_bf16 a[24:27], a[136:139], v[56:59], a[24:27]
 v_cvt_pk_bf16_f32 v184, v224, v225
 v_add_f32 v233, v233, v209
 v_mfma_f32_16x16x32_bf16 a[24:27], a[140:143], v[168:171], a[24:27]
 v_exp_f32 v226, v106
 v_mfma_f32_16x16x32_bf16 a[28:31], a[136:139], v[60:63], a[28:31]
 ds_read_b64_tr_b16 a[156:157], v21
 ds_read_b64_tr_b16 a[158:159], v21 offset:4096
 v_mfma_f32_16x16x32_bf16 a[28:31], a[140:143], v[172:175], a[28:31]
 s_waitcnt lgkmcnt(6)
 v_exp_f32 v227, v107
 v_mfma_f32_16x16x32_bf16 a[32:35], a[144:147], v[48:51], a[32:35]
 s_waitcnt lgkmcnt(4)
 v_cvt_pk_bf16_f32 v185, v226, v227
 v_add_f32 v232, v232, v208
 v_mfma_f32_16x16x32_bf16 a[32:35], a[148:151], v[160:163], a[32:35]
 v_exp_f32 v228, v108
 v_mfma_f32_16x16x32_bf16 a[36:39], a[144:147], v[52:55], a[36:39]
 v_exp_f32 v229, v109
 v_mfma_f32_16x16x32_bf16 a[36:39], a[148:151], v[164:167], a[36:39]
 v_exp_f32 v230, v110
 v_mfma_f32_16x16x32_bf16 a[40:43], a[144:147], v[56:59], a[40:43]
 buffer_load_dwordx4 v31, s[24:27], s65 offen offset:3072 lds
 v_mfma_f32_16x16x32_bf16 a[40:43], a[148:151], v[168:171], a[40:43]
 ds_read_b128 a[128:131], v14 offset:49152
 v_cvt_pk_bf16_f32 v188, v228, v229
 v_mfma_f32_16x16x32_bf16 a[44:47], a[144:147], v[60:63], a[44:47]
 v_exp_f32 v231, v111
 v_mfma_f32_16x16x32_bf16 a[44:47], a[148:151], v[172:175], a[44:47]
 s_waitcnt lgkmcnt(3)
 ds_read_b128 a[132:135], v15 offset:49152
 v_cvt_pk_bf16_f32 v189, v230, v231
 v_mfma_f32_16x16x32_bf16 a[48:51], a[152:155], v[48:51], a[48:51]
 s_waitcnt lgkmcnt(2)
 v_exp_f32 v224, v112
 v_mfma_f32_16x16x32_bf16 a[48:51], a[156:159], v[160:163], a[48:51]
 v_exp_f32 v225, v113
 v_mfma_f32_16x16x32_bf16 a[52:55], a[152:155], v[52:55], a[52:55]
 v_exp_f32 v226, v114
 v_mfma_f32_16x16x32_bf16 a[52:55], a[156:159], v[164:167], a[52:55]
 v_exp_f32 v227, v115
 v_mfma_f32_16x16x32_bf16 a[56:59], a[152:155], v[56:59], a[56:59]
 ds_read_b128 a[136:139], v16 offset:49152
 v_cvt_pk_bf16_f32 v178, v224, v225
 v_mfma_f32_16x16x32_bf16 a[56:59], a[156:159], v[168:171], a[56:59]
 s_waitcnt lgkmcnt(2)
 v_exp_f32 v228, v116
 v_mfma_f32_16x16x32_bf16 a[60:63], a[152:155], v[60:63], a[60:63]
 s_add_u32 s65, s65, 0x4000
 v_exp_f32 v229, v117
 v_mfma_f32_16x16x32_bf16 a[60:63], a[156:159], v[172:175], a[60:63]
 s_add_u32 s67, s67, 0x4000
 ds_read_b128 a[140:143], v17 offset:49152
 v_cvt_pk_bf16_f32 v179, v226, v227
 v_mfma_f32_16x16x32_bf16 v[128:131], a[128:131], a[160:163], v[192:195]
 s_waitcnt lgkmcnt(2)
 s_and_b32 s67, s67, 0xffff
 v_exp_f32 v230, v118
 v_mfma_f32_16x16x32_bf16 v[128:131], a[132:135], a[176:179], v[128:131]
 s_add_u32 m0, s66, 0x17000
 v_exp_f32 v231, v119
 v_mfma_f32_16x16x32_bf16 v[132:135], a[128:131], a[164:167], v[196:199]
 buffer_load_dwordx4 v26, s[20:23], s64 offen lds
 v_mfma_f32_16x16x32_bf16 v[132:135], a[132:135], a[180:183], v[132:135]
 v_cvt_pk_bf16_f32 v182, v228, v229
 v_cvt_pk_bf16_f32 v183, v230, v231
 v_mfma_f32_16x16x32_bf16 v[136:139], a[128:131], a[168:171], v[200:203]
 ds_read_b128 a[144:147], v14 offset:53248
 v_mfma_f32_16x16x32_bf16 v[136:139], a[132:135], a[184:187], v[136:139]
 v_exp_f32 v224, v120
 v_mfma_f32_16x16x32_bf16 v[140:143], a[128:131], a[172:175], v[204:207]
 v_exp_f32 v225, v121
 v_mfma_f32_16x16x32_bf16 v[140:143], a[132:135], a[188:191], v[140:143]
 s_waitcnt lgkmcnt(2)
 ds_read_b128 a[148:151], v15 offset:53248
 v_cvt_pk_bf16_f32 v186, v224, v225
 v_mfma_f32_16x16x32_bf16 v[128:131], a[136:139], v[64:67], v[128:131]
 s_waitcnt lgkmcnt(2)
 buffer_load_dwordx4 v27, s[20:23], s64 offen offset:1024 lds
 v_mfma_f32_16x16x32_bf16 v[128:131], a[140:143], v[80:83], v[128:131]
 v_exp_f32 v226, v122
 v_mfma_f32_16x16x32_bf16 v[132:135], a[136:139], v[68:71], v[132:135]
 v_exp_f32 v227, v123
 v_mfma_f32_16x16x32_bf16 v[132:135], a[140:143], v[84:87], v[132:135]
 v_exp_f32 v228, v124
 v_mfma_f32_16x16x32_bf16 v[136:139], a[136:139], v[72:75], v[136:139]
 v_exp_f32 v229, v125
 v_mfma_f32_16x16x32_bf16 v[136:139], a[140:143], v[88:91], v[136:139]
 v_cvt_pk_bf16_f32 v187, v226, v227
 v_cvt_pk_bf16_f32 v190, v228, v229
 v_mfma_f32_16x16x32_bf16 v[140:143], a[136:139], v[76:79], v[140:143]
 v_exp_f32 v230, v126
 v_mfma_f32_16x16x32_bf16 v[140:143], a[140:143], v[92:95], v[140:143]
 s_waitcnt lgkmcnt(1)
 v_mfma_f32_16x16x32_bf16 v[144:147], a[144:147], a[160:163], v[192:195]
 s_waitcnt lgkmcnt(0)
 ds_read_b128 a[152:155], v16 offset:53248
 v_mfma_f32_16x16x32_bf16 v[144:147], a[148:151], a[176:179], v[144:147]
 v_exp_f32 v231, v127
 v_mfma_f32_16x16x32_bf16 v[148:151], a[144:147], a[164:167], v[196:199]
 buffer_load_dwordx4 v28, s[20:23], s64 offen offset:2048 lds
 v_mfma_f32_16x16x32_bf16 v[148:151], a[148:151], a[180:183], v[148:151]
 ds_read_b128 a[156:159], v17 offset:53248
 v_cvt_pk_bf16_f32 v191, v230, v231
 v_mfma_f32_16x16x32_bf16 v[152:155], a[144:147], a[168:171], v[200:203]
 v_mfma_f32_16x16x32_bf16 v[152:155], a[148:151], a[184:187], v[152:155]
 v_mfma_f32_16x16x32_bf16 v[156:159], a[144:147], a[172:175], v[204:207]
 ds_read_b64_tr_b16 a[128:129], v22
 ds_read_b64_tr_b16 a[130:131], v22 offset:4096
 v_mfma_f32_16x16x32_bf16 v[156:159], a[148:151], a[188:191], v[156:159]
 v_mfma_f32_16x16x32_bf16 v[208:211], v[212:215], v[176:179], 0
 v_exp_f32 v224, v128
 v_mfma_f32_16x16x32_bf16 v[208:211], v[216:219], v[180:183], v[208:211]
 v_exp_f32 v225, v129
 v_mfma_f32_16x16x32_bf16 v[208:211], v[220:223], v[184:187], v[208:211]
 ds_read_b64_tr_b16 a[132:133], v22 offset:8192
 ds_read_b64_tr_b16 a[134:135], v22 offset:12288
 v_mfma_f32_16x16x32_bf16 v[208:211], v[236:239], v[188:191], v[208:211]
 s_waitcnt lgkmcnt(5)
 v_exp_f32 v226, v130
 v_mfma_f32_16x16x32_bf16 v[144:147], a[152:155], v[64:67], v[144:147]
 s_waitcnt lgkmcnt(4)
 buffer_load_dwordx4 v29, s[20:23], s64 offen offset:3072 lds
 v_mfma_f32_16x16x32_bf16 v[144:147], a[156:159], v[80:83], v[144:147]
 v_exp_f32 v227, v131
 v_mfma_f32_16x16x32_bf16 v[148:151], a[152:155], v[68:71], v[148:151]
 ds_read_b64_tr_b16 a[136:137], v23
 ds_read_b64_tr_b16 a[138:139], v23 offset:4096
 v_mfma_f32_16x16x32_bf16 v[148:151], a[156:159], v[84:87], v[148:151]
 v_cvt_pk_bf16_f32 v32, v224, v225
 v_cvt_pk_bf16_f32 v33, v226, v227
 v_mfma_f32_16x16x32_bf16 v[152:155], a[152:155], v[72:75], v[152:155]
 v_maximum3_f32 v240, v208, v209, v210
 v_maximum3_f32 v240, v240, v211, v211
 v_mfma_f32_16x16x32_bf16 v[152:155], a[156:159], v[88:91], v[152:155]
 v_cmp_nge_f32 vcc, s69, v240
 v_mfma_f32_16x16x32_bf16 v[156:159], a[152:155], v[76:79], v[156:159]
 s_waitcnt lgkmcnt(4)
 ds_read_b64_tr_b16 a[140:141], v23 offset:8192
 ds_read_b64_tr_b16 a[142:143], v23 offset:12288
 v_mfma_f32_16x16x32_bf16 v[156:159], a[156:159], v[92:95], v[156:159]
 s_cbranch_vccnz L_rare1
L_back1:
 v_exp_f32 v228, v132
 v_mfma_f32_16x16x32_bf16 a[64:67], a[128:131], v[160:163], a[64:67]
 s_waitcnt lgkmcnt(4)
 v_exp_f32 v229, v133
 v_mfma_f32_16x16x32_bf16 a[64:67], a[132:135], v[176:179], a[64:67]
 v_cvt_pk_bf16_f32 v36, v228, v229
 v_add_f32 v235, v235, v211
 v_mfma_f32_16x16x32_bf16 a[68:71], a[128:131], v[164:167], a[68:71]
 s_add_u32 s64, s64, 0x4000
 buffer_load_dwordx4 v[6:9], v4, s[40:43], s51 offen
 v_mfma_f32_16x16x32_bf16 a[68:71], a[132:135], v[180:183], a[68:71]
 s_add_u32 s66, s66, 0x4000
 ds_read_b64_tr_b16 a[144:145], v24
 ds_read_b64_tr_b16 a[146:147], v24 offset:4096
 v_mfma_f32_16x16x32_bf16 a[72:75], a[128:131], v[168:171], a[72:75]
 s_and_b32 s66, s66, 0xffff
 v_exp_f32 v230, v134
 v_mfma_f32_16x16x32_bf16 a[72:75], a[132:135], v[184:187], a[72:75]
 v_exp_f32 v231, v135
 v_mfma_f32_16x16x32_bf16 a[76:79], a[128:131], v[172:175], a[76:79]
 ds_read_b64_tr_b16 a[148:149], v24 offset:8192
 ds_read_b64_tr_b16 a[150:151], v24 offset:12288
 v_mfma_f32_16x16x32_bf16 a[76:79], a[132:135], v[188:191], a[76:79]
 s_waitcnt lgkmcnt(6)
 v_cvt_pk_bf16_f32 v37, v230, v231
 v_add_f32 v234, v234, v210
 v_mfma_f32_16x16x32_bf16 a[80:83], a[136:139], v[160:163], a[80:83]
 s_waitcnt lgkmcnt(4)
 v_exp_f32 v224, v136
 v_mfma_f32_16x16x32_bf16 a[80:83], a[140:143], v[176:179], a[80:83]
 v_exp_f32 v225, v137
 v_mfma_f32_16x16x32_bf16 a[84:87], a[136:139], v[164:167], a[84:87]
 ds_read_b64_tr_b16 a[152:153], v25
 ds_read_b64_tr_b16 a[154:155], v25 offset:4096
 v_mfma_f32_16x16x32_bf16 a[84:87], a[140:143], v[180:183], a[84:87]
 v_cvt_pk_bf16_f32 v40, v224, v225
 v_add_f32 v233, v233, v209
 v_mfma_f32_16x16x32_bf16 a[88:91], a[136:139], v[168:171], a[88:91]
 s_add_u32 s51, s51, 0xd80
 v_exp_f32 v226, v138
 v_mfma_f32_16x16x32_bf16 a[88:91], a[140:143], v[184:187], a[88:91]
 v_exp_f32 v227, v139
 v_mfma_f32_16x16x32_bf16 a[92:95], a[136:139], v[172:175], a[92:95]
 ds_read_b64_tr_b16 a[156:157], v25 offset:8192
 ds_read_b64_tr_b16 a[158:159], v25 offset:12288
 v_mfma_f32_16x16x32_bf16 a[92:95], a[140:143], v[188:191], a[92:95]
 s_waitcnt lgkmcnt(6)
 v_cvt_pk_bf16_f32 v41, v226, v227
 v_add_f32 v232, v232, v208
 v_mfma_f32_16x16x32_bf16 a[96:99], a[144:147], v[160:163], a[96:99]
 s_waitcnt lgkmcnt(4)
 v_exp_f32 v228, v140
 v_mfma_f32_16x16x32_bf16 a[96:99], a[148:151], v[176:179], a[96:99]
 v_exp_f32 v229, v141
 v_mfma_f32_16x16x32_bf16 a[100:103], a[144:147], v[164:167], a[100:103]
 s_waitcnt vmcnt(10)
 v_exp_f32 v230, v142
 v_mfma_f32_16x16x32_bf16 a[100:103], a[148:151], v[180:183], a[100:103]
 s_barrier
 v_exp_f32 v231, v143
 v_mfma_f32_16x16x32_bf16 a[104:107], a[144:147], v[168:171], a[104:107]
 ds_read_b128 a[128:131], v14 offset:57344
 v_cvt_pk_bf16_f32 v44, v228, v229
 v_mfma_f32_16x16x32_bf16 a[104:107], a[148:151], v[184:187], a[104:107]
 v_exp_f32 v224, v144
 v_mfma_f32_16x16x32_bf16 a[108:111], a[144:147], v[172:175], a[108:111]
 v_exp_f32 v225, v145
 v_mfma_f32_16x16x32_bf16 a[108:111], a[148:151], v[188:191], a[108:111]
 s_waitcnt lgkmcnt(3)
 ds_read_b128 a[132:135], v15 offset:57344
 v_cvt_pk_bf16_f32 v45, v230, v231
 v_mfma_f32_16x16x32_bf16 a[112:115], a[152:155], v[160:163], a[112:115]
 s_waitcnt lgkmcnt(2)
 v_exp_f32 v226, v146
 v_mfma_f32_16x16x32_bf16 a[112:115], a[156:159], v[176:179], a[112:115]
 v_exp_f32 v227, v147
 v_mfma_f32_16x16x32_bf16 a[116:119], a[152:155], v[164:167], a[116:119]
 v_cvt_pk_bf16_f32 v34, v224, v225
 v_cvt_pk_bf16_f32 v35, v226, v227
 v_mfma_f32_16x16x32_bf16 a[116:119], a[156:159], v[180:183], a[116:119]
 v_exp_f32 v228, v148
 v_mfma_f32_16x16x32_bf16 a[120:123], a[152:155], v[168:171], a[120:123]
 ds_read_b128 a[136:139], v16 offset:57344
 v_mfma_f32_16x16x32_bf16 a[120:123], a[156:159], v[184:187], a[120:123]
 v_exp_f32 v229, v149
 v_mfma_f32_16x16x32_bf16 a[124:127], a[152:155], v[172:175], a[124:127]
 v_exp_f32 v230, v150
 v_mfma_f32_16x16x32_bf16 a[124:127], a[156:159], v[188:191], a[124:127]
 s_waitcnt lgkmcnt(2)
 ds_read_b128 a[140:143], v17 offset:57344
 v_cvt_pk_bf16_f32 v38, v228, v229
 v_mfma_f32_16x16x32_bf16 v[96:99], a[128:131], a[160:163], v[192:195]
 s_waitcnt vmcnt(9) lgkmcnt(2)
 v_exp_f32 v231, v151
 v_mfma_f32_16x16x32_bf16 v[96:99], a[132:135], a[176:179], v[96:99]
 s_cmp_ge_u32 s52, s53
 v_cvt_pk_bf16_f32 v39, v230, v231
 v_mfma_f32_16x16x32_bf16 v[100:103], a[128:131], a[164:167], v[196:199]
 s_cselect_b64 exec, 0, -1
 buffer_store_dwordx4 v[10:13], v5, s[44:47], s52 offen sc1
 s_mov_b64 exec, -1
 v_mfma_f32_16x16x32_bf16 v[100:103], a[132:135], a[180:183], v[100:103]
 s_add_u32 s52, s52, s54
 v_exp_f32 v224, v152
 v_mfma_f32_16x16x32_bf16 v[104:107], a[128:131], a[168:171], v[200:203]
 ds_read_b128 a[144:147], v14 offset:61440
 v_mfma_f32_16x16x32_bf16 v[104:107], a[132:135], a[184:187], v[104:107]
 v_exp_f32 v225, v153
 v_mfma_f32_16x16x32_bf16 v[108:111], a[128:131], a[172:175], v[204:207]
 v_exp_f32 v226, v154
 v_mfma_f32_16x16x32_bf16 v[108:111], a[132:135], a[188:191], v[108:111]
 s_waitcnt lgkmcnt(2)
 ds_read_b128 a[148:151], v15 offset:61440
 v_cvt_pk_bf16_f32 v42, v224, v225
 v_mfma_f32_16x16x32_bf16 v[96:99], a[136:139], v[64:67], v[96:99]
 s_waitcnt lgkmcnt(2)
 v_exp_f32 v227, v155
 v_mfma_f32_16x16x32_bf16 v[96:99], a[140:143], v[80:83], v[96:99]
 v_cvt_pk_bf16_f32 v43, v226, v227
 v_mfma_f32_16x16x32_bf16 v[100:103], a[136:139], v[68:71], v[100:103]
 v_exp_f32 v228, v156
 v_mfma_f32_16x16x32_bf16 v[100:103], a[140:143], v[84:87], v[100:103]
 v_mfma_f32_16x16x32_bf16 v[104:107], a[136:139], v[72:75], v[104:107]
 v_exp_f32 v229, v157
 v_mfma_f32_16x16x32_bf16 v[104:107], a[140:143], v[88:91], v[104:107]
 v_cvt_pk_bf16_f32 v46, v228, v229
 v_mfma_f32_16x16x32_bf16 v[108:111], a[136:139], v[76:79], v[108:111]
 v_exp_f32 v230, v158
 v_mfma_f32_16x16x32_bf16 v[108:111], a[140:143], v[92:95], v[108:111]
 s_waitcnt lgkmcnt(1)
 v_mfma_f32_16x16x32_bf16 v[112:115], a[144:147], a[160:163], v[192:195]
 s_waitcnt lgkmcnt(0)
 ds_read_b128 a[152:155], v16 offset:61440
 v_mfma_f32_16x16x32_bf16 v[112:115], a[148:151], a[176:179], v[112:115]
 v_exp_f32 v231, v159
 v_mfma_f32_16x16x32_bf16 v[116:119], a[144:147], a[164:167], v[196:199]
 v_cvt_pk_bf16_f32 v47, v230, v231
 v_mfma_f32_16x16x32_bf16 v[116:119], a[148:151], a[180:183], v[116:119]
 ds_read_b128 a[156:159], v17 offset:61440
 v_mfma_f32_16x16x32_bf16 v[120:123], a[144:147], a[168:171], v[200:203]
 v_mfma_f32_16x16x32_bf16 v[120:123], a[148:151], a[184:187], v[120:123]
 v_mfma_f32_16x16x32_bf16 v[124:127], a[144:147], a[172:175], v[204:207]
 ds_read_b64_tr_b16 a[128:129], v18 offset:8192
 ds_read_b64_tr_b16 a[130:131], v18 offset:12288
 v_mfma_f32_16x16x32_bf16 v[124:127], a[148:151], a[188:191], v[124:127]
 v_mfma_f32_16x16x32_bf16 v[208:211], v[212:215], v[32:35], 0
 v_exp_f32 v224, v96
 v_mfma_f32_16x16x32_bf16 v[208:211], v[216:219], v[36:39], v[208:211]
 v_exp_f32 v225, v97
 v_mfma_f32_16x16x32_bf16 v[208:211], v[220:223], v[40:43], v[208:211]
 s_add_u32 m0, s67, 0x1000
 ds_read_b64_tr_b16 a[132:133], v18 offset:16384
 ds_read_b64_tr_b16 a[134:135], v18 offset:20480
 v_mfma_f32_16x16x32_bf16 v[208:211], v[236:239], v[44:47], v[208:211]
 s_waitcnt lgkmcnt(5)
 buffer_load_dwordx4 v30, s[24:27], s65 offen lds
 v_mfma_f32_16x16x32_bf16 v[112:115], a[152:155], v[64:67], v[112:115]
 s_waitcnt lgkmcnt(4)
 v_exp_f32 v226, v98
 v_mfma_f32_16x16x32_bf16 v[112:115], a[156:159], v[80:83], v[112:115]
 v_exp_f32 v227, v99
 v_mfma_f32_16x16x32_bf16 v[116:119], a[152:155], v[68:71], v[116:119]
 ds_read_b64_tr_b16 a[136:137], v19 offset:8192
 ds_read_b64_tr_b16 a[138:139], v19 offset:12288
 v_mfma_f32_16x16x32_bf16 v[116:119], a[156:159], v[84:87], v[116:119]
 v_cvt_pk_bf16_f32 v48, v224, v225
 v_cvt_pk_bf16_f32 v49, v226, v227
 v_mfma_f32_16x16x32_bf16 v[120:123], a[152:155], v[72:75], v[120:123]
 v_maximum3_f32 v240, v208, v209, v210
 v_maximum3_f32 v240, v240, v211, v211
 v_mfma_f32_16x16x32_bf16 v[120:123], a[156:159], v[88:91], v[120:123]
 v_cmp_nge_f32 vcc, s69, v240
 v_mfma_f32_16x16x32_bf16 v[124:127], a[152:155], v[76:79], v[124:127]
 s_waitcnt lgkmcnt(4)
 ds_read_b64_tr_b16 a[140:141], v19 offset:16384
 ds_read_b64_tr_b16 a[142:143], v19 offset:20480
 v_mfma_f32_16x16x32_bf16 v[124:127], a[156:159], v[92:95], v[124:127]
 s_cbranch_vccnz L_rare2
L_back2:
 v_exp_f32 v228, v100
 v_mfma_f32_16x16x32_bf16 a[0:3], a[128:131], v[176:179], a[0:3]
 s_waitcnt lgkmcnt(4)
 buffer_load_dwordx4 v31, s[24:27], s65 offen offset:1024 lds
 v_mfma_f32_16x16x32_bf16 a[0:3], a[132:135], v[32:35], a[0:3]
 v_exp_f32 v229, v101
 v_mfma_f32_16x16x32_bf16 a[4:7], a[128:131], v[180:183], a[4:7]
 ds_read_b64_tr_b16 a[144:145], v20 offset:8192
 ds_read_b64_tr_b16 a[146:147], v20 offset:12288
 v_mfma_f32_16x16x32_bf16 a[4:7], a[132:135], v[36:39], a[4:7]
 v_cvt_pk_bf16_f32 v52, v228, v229
 v_add_f32 v235, v235, v211
 v_mfma_f32_16x16x32_bf16 a[8:11], a[128:131], v[184:187], a[8:11]
 v_exp_f32 v230, v102
 v_mfma_f32_16x16x32_bf16 a[8:11], a[132:135], v[40:43], a[8:11]
 v_exp_f32 v231, v103
 v_mfma_f32_16x16x32_bf16 a[12:15], a[128:131], v[188:191], a[12:15]
 ds_read_b64_tr_b16 a[148:149], v20 offset:16384
 ds_read_b64_tr_b16 a[150:151], v20 offset:20480
 v_mfma_f32_16x16x32_bf16 a[12:15], a[132:135], v[44:47], a[12:15]
 s_waitcnt lgkmcnt(6)
 v_cvt_pk_bf16_f32 v53, v230, v231
 v_add_f32 v234, v234, v210
 v_mfma_f32_16x16x32_bf16 a[16:19], a[136:139], v[176:179], a[16:19]
 s_waitcnt lgkmcnt(4)
 v_exp_f32 v224, v104
 v_mfma_f32_16x16x32_bf16 a[16:19], a[140:143], v[32:35], a[16:19]
 v_exp_f32 v225, v105
 v_mfma_f32_16x16x32_bf16 a[20:23], a[136:139], v[180:183], a[20:23]
 ds_read_b64_tr_b16 a[152:153], v21 offset:8192
 ds_read_b64_tr_b16 a[154:155], v21 offset:12288
 v_mfma_f32_16x16x32_bf16 a[20:23], a[140:143], v[36:39], a[20:23]
 buffer_load_dwordx4 v30, s[24:27], s65 offen offset:2048 lds
 v_mfma_f32_16x16x32_bf16 a[24:27], a[136:139], v[184:187], a[24:27]
 v_cvt_pk_bf16_f32 v56, v224, v225
 v_add_f32 v233, v233, v209
 v_mfma_f32_16x16x32_bf16 a[24:27], a[140:143], v[40:43], a[24:27]
 v_exp_f32 v226, v106
 v_mfma_f32_16x16x32_bf16 a[28:31], a[136:139], v[188:191], a[28:31]
 ds_read_b64_tr_b16 a[156:157], v21 offset:16384
 ds_read_b64_tr_b16 a[158:159], v21 offset:20480
 v_mfma_f32_16x16x32_bf16 a[28:31], a[140:143], v[44:47], a[28:31]
 s_waitcnt lgkmcnt(6)
 v_exp_f32 v227, v107
 v_mfma_f32_16x16x32_bf16 a[32:35], a[144:147], v[176:179], a[32:35]
 s_waitcnt lgkmcnt(4)
 v_cvt_pk_bf16_f32 v57, v226, v227
 v_add_f32 v232, v232, v208
 v_mfma_f32_16x16x32_bf16 a[32:35], a[148:151], v[32:35], a[32:35]
 v_exp_f32 v228, v108
 v_mfma_f32_16x16x32_bf16 a[36:39], a[144:147], v[180:183], a[36:39]
 v_exp_f32 v229, v109
 v_mfma_f32_16x16x32_bf16 a[36:39], a[148:151], v[36:39], a[36:39]
 v_exp_f32 v230, v110
 v_mfma_f32_16x16x32_bf16 a[40:43], a[144:147], v[184:187], a[40:43]
 buffer_load_dwordx4 v31, s[24:27], s65 offen offset:3072 lds
 v_mfma_f32_16x16x32_bf16 a[40:43], a[148:151], v[40:43], a[40:43]
 ds_read_b128 a[128:131], v14
 v_cvt_pk_bf16_f32 v60, v228, v229
 v_mfma_f32_16x16x32_bf16 a[44:47], a[144:147], v[188:191], a[44:47]
 v_exp_f32 v231, v111
 v_mfma_f32_16x16x32_bf16 a[44:47], a[148:151], v[44:47], a[44:47]
 s_waitcnt lgkmcnt(3)
 ds_read_b128 a[132:135], v15
 v_cvt_pk_bf16_f32 v61, v230, v231
 v_mfma_f32_16x16x32_bf16 a[48:51], a[152:155], v[176:179], a[48:51]
 s_waitcnt lgkmcnt(2)
 v_exp_f32 v224, v112
 v_mfma_f32_16x16x32_bf16 a[48:51], a[156:159], v[32:35], a[48:51]
 v_exp_f32 v225, v113
 v_mfma_f32_16x16x32_bf16 a[52:55], a[152:155], v[180:183], a[52:55]
 v_exp_f32 v226, v114
 v_mfma_f32_16x16x32_bf16 a[52:55], a[156:159], v[36:39], a[52:55]
 v_exp_f32 v227, v115
 v_mfma_f32_16x16x32_bf16 a[56:59], a[152:155], v[184:187], a[56:59]
 ds_read_b128 a[136:139], v16
 v_cvt_pk_bf16_f32 v50, v224, v225
 v_mfma_f32_16x16x32_bf16 a[56:59], a[156:159], v[40:43], a[56:59]
 s_waitcnt lgkmcnt(2)
 v_exp_f32 v228, v116
 v_mfma_f32_16x16x32_bf16 a[60:63], a[152:155], v[188:191], a[60:63]
 s_add_u32 s65, s65, 0x4000
 v_exp_f32 v229, v117
 v_mfma_f32_16x16x32_bf16 a[60:63], a[156:159], v[44:47], a[60:63]
 s_add_u32 s67, s67, 0x4000
 ds_read_b128 a[140:143], v17
 v_cvt_pk_bf16_f32 v51, v226, v227
 v_mfma_f32_16x16x32_bf16 v[128:131], a[128:131], a[160:163], v[192:195]
 s_waitcnt lgkmcnt(2)
 s_and_b32 s67, s67, 0xffff
 v_exp_f32 v230, v118
 v_mfma_f32_16x16x32_bf16 v[128:131], a[132:135], a[176:179], v[128:131]
 s_add_u32 m0, s66, 0x17000
 v_exp_f32 v231, v119
 v_mfma_f32_16x16x32_bf16 v[132:135], a[128:131], a[164:167], v[196:199]
 buffer_load_dwordx4 v26, s[20:23], s64 offen lds
 v_mfma_f32_16x16x32_bf16 v[132:135], a[132:135], a[180:183], v[132:135]
 v_cvt_pk_bf16_f32 v54, v228, v229
 v_cvt_pk_bf16_f32 v55, v230, v231
 v_mfma_f32_16x16x32_bf16 v[136:139], a[128:131], a[168:171], v[200:203]
 ds_read_b128 a[144:147], v14 offset:4096
 v_mfma_f32_16x16x32_bf16 v[136:139], a[132:135], a[184:187], v[136:139]
 v_exp_f32 v224, v120
 v_mfma_f32_16x16x32_bf16 v[140:143], a[128:131], a[172:175], v[204:207]
 v_exp_f32 v225, v121
 v_mfma_f32_16x16x32_bf16 v[140:143], a[132:135], a[188:191], v[140:143]
 s_waitcnt lgkmcnt(2)
 ds_read_b128 a[148:151], v15 offset:4096
 v_cvt_pk_bf16_f32 v58, v224, v225
 v_mfma_f32_16x16x32_bf16 v[128:131], a[136:139], v[64:67], v[128:131]
 s_waitcnt lgkmcnt(2)
 buffer_load_dwordx4 v27, s[20:23], s64 offen offset:1024 lds
 v_mfma_f32_16x16x32_bf16 v[128:131], a[140:143], v[80:83], v[128:131]
 v_exp_f32 v226, v122
 v_mfma_f32_16x16x32_bf16 v[132:135], a[136:139], v[68:71], v[132:135]
 v_exp_f32 v227, v123
 v_mfma_f32_16x16x32_bf16 v[132:135], a[140:143], v[84:87], v[132:135]
 v_exp_f32 v228, v124
 v_mfma_f32_16x16x32_bf16 v[136:139], a[136:139], v[72:75], v[136:139]
 v_exp_f32 v229, v125
 v_mfma_f32_16x16x32_bf16 v[136:139], a[140:143], v[88:91], v[136:139]
 v_cvt_pk_bf16_f32 v59, v226, v227
 v_cvt_pk_bf16_f32 v62, v228, v229
 v_mfma_f32_16x16x32_bf16 v[140:143], a[136:139], v[76:79], v[140:143]
 v_exp_f32 v230, v126
 v_mfma_f32_16x16x32_bf16 v[140:143], a[140:143], v[92:95], v[140:143]
 s_waitcnt lgkmcnt(1)
 v_mfma_f32_16x16x32_bf16 v[144:147], a[144:147], a[160:163], v[192:195]
 s_waitcnt lgkmcnt(0)
 ds_read_b128 a[152:155], v16 offset:4096
 v_mfma_f32_16x16x32_bf16 v[144:147], a[148:151], a[176:179], v[144:147]
 v_exp_f32 v231, v127
 v_mfma_f32_16x16x32_bf16 v[148:151], a[144:147], a[164:167], v[196:199]
 buffer_load_dwordx4 v28, s[20:23], s64 offen offset:2048 lds
 v_mfma_f32_16x16x32_bf16 v[148:151], a[148:151], a[180:183], v[148:151]
 ds_read_b128 a[156:159], v17 offset:4096
 v_cvt_pk_bf16_f32 v63, v230, v231
 v_mfma_f32_16x16x32_bf16 v[152:155], a[144:147], a[168:171], v[200:203]
 v_mfma_f32_16x16x32_bf16 v[152:155], a[148:151], a[184:187], v[152:155]
 v_mfma_f32_16x16x32_bf16 v[156:159], a[144:147], a[172:175], v[204:207]
 ds_read_b64_tr_b16 a[128:129], v22 offset:16384
 ds_read_b64_tr_b16 a[130:131], v22 offset:20480
 v_mfma_f32_16x16x32_bf16 v[156:159], a[148:151], a[188:191], v[156:159]
 v_mfma_f32_16x16x32_bf16 v[208:211], v[212:215], v[48:51], 0
 v_exp_f32 v224, v128
 v_mfma_f32_16x16x32_bf16 v[208:211], v[216:219], v[52:55], v[208:211]
 v_exp_f32 v225, v129
 v_mfma_f32_16x16x32_bf16 v[208:211], v[220:223], v[56:59], v[208:211]
 ds_read_b64_tr_b16 a[132:133], v22 offset:24576
 ds_read_b64_tr_b16 a[134:135], v22 offset:28672
 v_mfma_f32_16x16x32_bf16 v[208:211], v[236:239], v[60:63], v[208:211]
 s_waitcnt lgkmcnt(5)
 v_exp_f32 v226, v130
 v_mfma_f32_16x16x32_bf16 v[144:147], a[152:155], v[64:67], v[144:147]
 s_waitcnt lgkmcnt(4)
 buffer_load_dwordx4 v29, s[20:23], s64 offen offset:3072 lds
 v_mfma_f32_16x16x32_bf16 v[144:147], a[156:159], v[80:83], v[144:147]
 v_exp_f32 v227, v131
 v_mfma_f32_16x16x32_bf16 v[148:151], a[152:155], v[68:71], v[148:151]
 ds_read_b64_tr_b16 a[136:137], v23 offset:16384
 ds_read_b64_tr_b16 a[138:139], v23 offset:20480
 v_mfma_f32_16x16x32_bf16 v[148:151], a[156:159], v[84:87], v[148:151]
 v_cvt_pk_bf16_f32 v160, v224, v225
 v_cvt_pk_bf16_f32 v161, v226, v227
 v_mfma_f32_16x16x32_bf16 v[152:155], a[152:155], v[72:75], v[152:155]
 v_maximum3_f32 v240, v208, v209, v210
 v_maximum3_f32 v240, v240, v211, v211
 v_mfma_f32_16x16x32_bf16 v[152:155], a[156:159], v[88:91], v[152:155]
 v_cmp_nge_f32 vcc, s69, v240
 v_mfma_f32_16x16x32_bf16 v[156:159], a[152:155], v[76:79], v[156:159]
 s_waitcnt lgkmcnt(4)
 ds_read_b64_tr_b16 a[140:141], v23 offset:24576
 ds_read_b64_tr_b16 a[142:143], v23 offset:28672
 v_mfma_f32_16x16x32_bf16 v[156:159], a[156:159], v[92:95], v[156:159]
 s_cbranch_vccnz L_rare3
L_back3:
 v_exp_f32 v228, v132
 v_mfma_f32_16x16x32_bf16 a[64:67], a[128:131], v[32:35], a[64:67]
 s_waitcnt lgkmcnt(4)
 v_exp_f32 v229, v133
 v_mfma_f32_16x16x32_bf16 a[64:67], a[132:135], v[48:51], a[64:67]
 v_cvt_pk_bf16_f32 v164, v228, v229
 v_add_f32 v235, v235, v211
 v_mfma_f32_16x16x32_bf16 a[68:71], a[128:131], v[36:39], a[68:71]
 s_add_u32 s64, s64, 0x4000
 buffer_load_dwordx4 v[10:13], v4, s[40:43], s51 offen
 v_mfma_f32_16x16x32_bf16 a[68:71], a[132:135], v[52:55], a[68:71]
 s_add_u32 s66, s66, 0x4000
 ds_read_b64_tr_b16 a[144:145], v24 offset:16384
 ds_read_b64_tr_b16 a[146:147], v24 offset:20480
 v_mfma_f32_16x16x32_bf16 a[72:75], a[128:131], v[40:43], a[72:75]
 s_and_b32 s66, s66, 0xffff
 v_exp_f32 v230, v134
 v_mfma_f32_16x16x32_bf16 a[72:75], a[132:135], v[56:59], a[72:75]
 v_exp_f32 v231, v135
 v_mfma_f32_16x16x32_bf16 a[76:79], a[128:131], v[44:47], a[76:79]
 ds_read_b64_tr_b16 a[148:149], v24 offset:24576
 ds_read_b64_tr_b16 a[150:151], v24 offset:28672
 v_mfma_f32_16x16x32_bf16 a[76:79], a[132:135], v[60:63], a[76:79]
 s_waitcnt lgkmcnt(6)
 v_cvt_pk_bf16_f32 v165, v230, v231
 v_add_f32 v234, v234, v210
 v_mfma_f32_16x16x32_bf16 a[80:83], a[136:139], v[32:35], a[80:83]
 s_waitcnt lgkmcnt(4)
 v_exp_f32 v224, v136
 v_mfma_f32_16x16x32_bf16 a[80:83], a[140:143], v[48:51], a[80:83]
 v_exp_f32 v225, v137
 v_mfma_f32_16x16x32_bf16 a[84:87], a[136:139], v[36:39], a[84:87]
 ds_read_b64_tr_b16 a[152:153], v25 offset:16384
 ds_read_b64_tr_b16 a[154:155], v25 offset:20480
 v_mfma_f32_16x16x32_bf16 a[84:87], a[140:143], v[52:55], a[84:87]
 v_cvt_pk_bf16_f32 v168, v224, v225
 v_add_f32 v233, v233, v209
 v_mfma_f32_16x16x32_bf16 a[88:91], a[136:139], v[40:43], a[88:91]
 s_add_u32 s51, s51, 0xd80
 v_exp_f32 v226, v138
 v_mfma_f32_16x16x32_bf16 a[88:91], a[140:143], v[56:59], a[88:91]
 v_exp_f32 v227, v139
 v_mfma_f32_16x16x32_bf16 a[92:95], a[136:139], v[44:47], a[92:95]
 ds_read_b64_tr_b16 a[156:157], v25 offset:24576
 ds_read_b64_tr_b16 a[158:159], v25 offset:28672
 v_mfma_f32_16x16x32_bf16 a[92:95], a[140:143], v[60:63], a[92:95]
 s_waitcnt lgkmcnt(6)
 v_cvt_pk_bf16_f32 v169, v226, v227
 v_add_f32 v232, v232, v208
 v_mfma_f32_16x16x32_bf16 a[96:99], a[144:147], v[32:35], a[96:99]
 s_waitcnt lgkmcnt(4)
 v_exp_f32 v228, v140
 v_mfma_f32_16x16x32_bf16 a[96:99], a[148:151], v[48:51], a[96:99]
 v_exp_f32 v229, v141
 v_mfma_f32_16x16x32_bf16 a[100:103], a[144:147], v[36:39], a[100:103]
 s_waitcnt vmcnt(10)
 v_exp_f32 v230, v142
 v_mfma_f32_16x16x32_bf16 a[100:103], a[148:151], v[52:55], a[100:103]
 s_barrier
 v_exp_f32 v231, v143
 v_mfma_f32_16x16x32_bf16 a[104:107], a[144:147], v[40:43], a[104:107]
 ds_read_b128 a[128:131], v14 offset:8192
 v_cvt_pk_bf16_f32 v172, v228, v229
 v_mfma_f32_16x16x32_bf16 a[104:107], a[148:151], v[56:59], a[104:107]
 v_exp_f32 v224, v144
 v_mfma_f32_16x16x32_bf16 a[108:111], a[144:147], v[44:47], a[108:111]
 v_exp_f32 v225, v145
 v_mfma_f32_16x16x32_bf16 a[108:111], a[148:151], v[60:63], a[108:111]
 s_waitcnt lgkmcnt(3)
 ds_read_b128 a[132:135], v15 offset:8192
 v_cvt_pk_bf16_f32 v173, v230, v231
 v_mfma_f32_16x16x32_bf16 a[112:115], a[152:155], v[32:35], a[112:115]
 s_waitcnt lgkmcnt(2)
 v_exp_f32 v226, v146
 v_mfma_f32_16x16x32_bf16 a[112:115], a[156:159], v[48:51], a[112:115]
 v_exp_f32 v227, v147
 v_mfma_f32_16x16x32_bf16 a[116:119], a[152:155], v[36:39], a[116:119]
 v_cvt_pk_bf16_f32 v162, v224, v225
 v_cvt_pk_bf16_f32 v163, v226, v227
 v_mfma_f32_16x16x32_bf16 a[116:119], a[156:159], v[52:55], a[116:119]
 v_exp_f32 v228, v148
 v_mfma_f32_16x16x32_bf16 a[120:123], a[152:155], v[40:43], a[120:123]
 ds_read_b128 a[136:139], v16 offset:8192
 v_mfma_f32_16x16x32_bf16 a[120:123], a[156:159], v[56:59], a[120:123]
 v_exp_f32 v229, v149
 v_mfma_f32_16x16x32_bf16 a[124:127], a[152:155], v[44:47], a[124:127]
 v_exp_f32 v230, v150
 v_mfma_f32_16x16x32_bf16 a[124:127], a[156:159], v[60:63], a[124:127]
 s_waitcnt lgkmcnt(2)
 ds_read_b128 a[140:143], v17 offset:8192
 v_cvt_pk_bf16_f32 v166, v228, v229
 v_mfma_f32_16x16x32_bf16 v[96:99], a[128:131], a[160:163], v[192:195]
 s_waitcnt vmcnt(9) lgkmcnt(2)
 v_exp_f32 v231, v151
 v_mfma_f32_16x16x32_bf16 v[96:99], a[132:135], a[176:179], v[96:99]
 s_cmp_ge_u32 s52, s53
 v_cvt_pk_bf16_f32 v167, v230, v231
 v_mfma_f32_16x16x32_bf16 v[100:103], a[128:131], a[164:167], v[196:199]
 s_cselect_b64 exec, 0, -1
 buffer_store_dwordx4 v[6:9], v5, s[44:47], s52 offen sc1
 s_mov_b64 exec, -1
 v_mfma_f32_16x16x32_bf16 v[100:103], a[132:135], a[180:183], v[100:103]
 s_add_u32 s52, s52, s54
 v_exp_f32 v224, v152
 v_mfma_f32_16x16x32_bf16 v[104:107], a[128:131], a[168:171], v[200:203]
 ds_read_b128 a[144:147], v14 offset:12288
 v_mfma_f32_16x16x32_bf16 v[104:107], a[132:135], a[184:187], v[104:107]
 v_exp_f32 v225, v153
 v_mfma_f32_16x16x32_bf16 v[108:111], a[128:131], a[172:175], v[204:207]
 v_exp_f32 v226, v154
 v_mfma_f32_16x16x32_bf16 v[108:111], a[132:135], a[188:191], v[108:111]
 s_waitcnt lgkmcnt(2)
 ds_read_b128 a[148:151], v15 offset:12288
 v_cvt_pk_bf16_f32 v170, v224, v225
 v_mfma_f32_16x16x32_bf16 v[96:99], a[136:139], v[64:67], v[96:99]
 s_waitcnt lgkmcnt(2)
 v_exp_f32 v227, v155
 v_mfma_f32_16x16x32_bf16 v[96:99], a[140:143], v[80:83], v[96:99]
 v_cvt_pk_bf16_f32 v171, v226, v227
 v_mfma_f32_16x16x32_bf16 v[100:103], a[136:139], v[68:71], v[100:103]
 v_exp_f32 v228, v156
 v_mfma_f32_16x16x32_bf16 v[100:103], a[140:143], v[84:87], v[100:103]
 v_mfma_f32_16x16x32_bf16 v[104:107], a[136:139], v[72:75], v[104:107]
 v_exp_f32 v229, v157
 v_mfma_f32_16x16x32_bf16 v[104:107], a[140:143], v[88:91], v[104:107]
 v_cvt_pk_bf16_f32 v174, v228, v229
 v_mfma_f32_16x16x32_bf16 v[108:111], a[136:139], v[76:79], v[108:111]
 v_exp_f32 v230, v158
 v_mfma_f32_16x16x32_bf16 v[108:111], a[140:143], v[92:95], v[108:111]
 s_waitcnt lgkmcnt(1)
 v_mfma_f32_16x16x32_bf16 v[112:115], a[144:147], a[160:163], v[192:195]
 s_waitcnt lgkmcnt(0)
 ds_read_b128 a[152:155], v16 offset:12288
 v_mfma_f32_16x16x32_bf16 v[112:115], a[148:151], a[176:179], v[112:115]
 v_exp_f32 v231, v159
 v_mfma_f32_16x16x32_bf16 v[116:119], a[144:147], a[164:167], v[196:199]
 v_cvt_pk_bf16_f32 v175, v230, v231
 v_mfma_f32_16x16x32_bf16 v[116:119], a[148:151], a[180:183], v[116:119]
 ds_read_b128 a[156:159], v17 offset:12288
 v_mfma_f32_16x16x32_bf16 v[120:123], a[144:147], a[168:171], v[200:203]
 v_mfma_f32_16x16x32_bf16 v[120:123], a[148:151], a[184:187], v[120:123]
 v_mfma_f32_16x16x32_bf16 v[124:127], a[144:147], a[172:175], v[204:207]
 ds_read_b64_tr_b16 a[128:129], v18 offset:24576
 ds_read_b64_tr_b16 a[130:131], v18 offset:28672
 v_mfma_f32_16x16x32_bf16 v[124:127], a[148:151], a[188:191], v[124:127]
 v_mfma_f32_16x16x32_bf16 v[208:211], v[212:215], v[160:163], 0
 v_exp_f32 v224, v96
 v_mfma_f32_16x16x32_bf16 v[208:211], v[216:219], v[164:167], v[208:211]
 v_exp_f32 v225, v97
 v_mfma_f32_16x16x32_bf16 v[208:211], v[220:223], v[168:171], v[208:211]
 s_add_u32 m0, s67, 0x1000
 ds_read_b64_tr_b16 a[132:133], v18 offset:32768
 ds_read_b64_tr_b16 a[134:135], v18 offset:36864
 v_mfma_f32_16x16x32_bf16 v[208:211], v[236:239], v[172:175], v[208:211]
 s_waitcnt lgkmcnt(5)
 buffer_load_dwordx4 v30, s[24:27], s65 offen lds
 v_mfma_f32_16x16x32_bf16 v[112:115], a[152:155], v[64:67], v[112:115]
 s_waitcnt lgkmcnt(4)
 v_exp_f32 v226, v98
 v_mfma_f32_16x16x32_bf16 v[112:115], a[156:159], v[80:83], v[112:115]
 v_exp_f32 v227, v99
 v_mfma_f32_16x16x32_bf16 v[116:119], a[152:155], v[68:71], v[116:119]
 ds_read_b64_tr_b16 a[136:137], v19 offset:24576
 ds_read_b64_tr_b16 a[138:139], v19 offset:28672
 v_mfma_f32_16x16x32_bf16 v[116:119], a[156:159], v[84:87], v[116:119]
 v_cvt_pk_bf16_f32 v176, v224, v225
 v_cvt_pk_bf16_f32 v177, v226, v227
 v_mfma_f32_16x16x32_bf16 v[120:123], a[152:155], v[72:75], v[120:123]
 v_maximum3_f32 v240, v208, v209, v210
 v_maximum3_f32 v240, v240, v211, v211
 v_mfma_f32_16x16x32_bf16 v[120:123], a[156:159], v[88:91], v[120:123]
 v_cmp_nge_f32 vcc, s69, v240
 v_mfma_f32_16x16x32_bf16 v[124:127], a[152:155], v[76:79], v[124:127]
 s_waitcnt lgkmcnt(4)
 ds_read_b64_tr_b16 a[140:141], v19 offset:32768
 ds_read_b64_tr_b16 a[142:143], v19 offset:36864
 v_mfma_f32_16x16x32_bf16 v[124:127], a[156:159], v[92:95], v[124:127]
 s_cbranch_vccnz L_rare4
L_back4:
 v_exp_f32 v228, v100
 v_mfma_f32_16x16x32_bf16 a[0:3], a[128:131], v[48:51], a[0:3]
 s_waitcnt lgkmcnt(4)
 buffer_load_dwordx4 v31, s[24:27], s65 offen offset:1024 lds
 v_mfma_f32_16x16x32_bf16 a[0:3], a[132:135], v[160:163], a[0:3]
 v_exp_f32 v229, v101
 v_mfma_f32_16x16x32_bf16 a[4:7], a[128:131], v[52:55], a[4:7]
 ds_read_b64_tr_b16 a[144:145], v20 offset:24576
 ds_read_b64_tr_b16 a[146:147], v20 offset:28672
 v_mfma_f32_16x16x32_bf16 a[4:7], a[132:135], v[164:167], a[4:7]
 v_cvt_pk_bf16_f32 v180, v228, v229
 v_add_f32 v235, v235, v211
 v_mfma_f32_16x16x32_bf16 a[8:11], a[128:131], v[56:59], a[8:11]
 v_exp_f32 v230, v102
 v_mfma_f32_16x16x32_bf16 a[8:11], a[132:135], v[168:171], a[8:11]
 v_exp_f32 v231, v103
 v_mfma_f32_16x16x32_bf16 a[12:15], a[128:131], v[60:63], a[12:15]
 ds_read_b64_tr_b16 a[148:149], v20 offset:32768
 ds_read_b64_tr_b16 a[150:151], v20 offset:36864
 v_mfma_f32_16x16x32_bf16 a[12:15], a[132:135], v[172:175], a[12:15]
 s_waitcnt lgkmcnt(6)
 v_cvt_pk_bf16_f32 v181, v230, v231
 v_add_f32 v234, v234, v210
 v_mfma_f32_16x16x32_bf16 a[16:19], a[136:139], v[48:51], a[16:19]
 s_waitcnt lgkmcnt(4)
 v_exp_f32 v224, v104
 v_mfma_f32_16x16x32_bf16 a[16:19], a[140:143], v[160:163], a[16:19]
 v_exp_f32 v225, v105
 v_mfma_f32_16x16x32_bf16 a[20:23], a[136:139], v[52:55], a[20:23]
 ds_read_b64_tr_b16 a[152:153], v21 offset:24576
 ds_read_b64_tr_b16 a[154:155], v21 offset:28672
 v_mfma_f32_16x16x32_bf16 a[20:23], a[140:143], v[164:167], a[20:23]
 buffer_load_dwordx4 v30, s[24:27], s65 offen offset:2048 lds
 v_mfma_f32_16x16x32_bf16 a[24:27], a[136:139], v[56:59], a[24:27]
 v_cvt_pk_bf16_f32 v184, v224, v225
 v_add_f32 v233, v233, v209
 v_mfma_f32_16x16x32_bf16 a[24:27], a[140:143], v[168:171], a[24:27]
 v_exp_f32 v226, v106
 v_mfma_f32_16x16x32_bf16 a[28:31], a[136:139], v[60:63], a[28:31]
 ds_read_b64_tr_b16 a[156:157], v21 offset:32768
 ds_read_b64_tr_b16 a[158:159], v21 offset:36864
 v_mfma_f32_16x16x32_bf16 a[28:31], a[140:143], v[172:175], a[28:31]
 s_waitcnt lgkmcnt(6)
 v_exp_f32 v227, v107
 v_mfma_f32_16x16x32_bf16 a[32:35], a[144:147], v[48:51], a[32:35]
 s_waitcnt lgkmcnt(4)
 v_cvt_pk_bf16_f32 v185, v226, v227
 v_add_f32 v232, v232, v208
 v_mfma_f32_16x16x32_bf16 a[32:35], a[148:151], v[160:163], a[32:35]
 v_exp_f32 v228, v108
 v_mfma_f32_16x16x32_bf16 a[36:39], a[144:147], v[52:55], a[36:39]
 v_exp_f32 v229, v109
 v_mfma_f32_16x16x32_bf16 a[36:39], a[148:151], v[164:167], a[36:39]
 v_exp_f32 v230, v110
 v_mfma_f32_16x16x32_bf16 a[40:43], a[144:147], v[56:59], a[40:43]
 buffer_load_dwordx4 v31, s[24:27], s65 offen offset:3072 lds
 v_mfma_f32_16x16x32_bf16 a[40:43], a[148:151], v[168:171], a[40:43]
 ds_read_b128 a[128:131], v14 offset:16384
 v_cvt_pk_bf16_f32 v188, v228, v229
 v_mfma_f32_16x16x32_bf16 a[44:47], a[144:147], v[60:63], a[44:47]
 v_exp_f32 v231, v111
 v_mfma_f32_16x16x32_bf16 a[44:47], a[148:151], v[172:175], a[44:47]
 s_waitcnt lgkmcnt(3)
 ds_read_b128 a[132:135], v15 offset:16384
 v_cvt_pk_bf16_f32 v189, v230, v231
 v_mfma_f32_16x16x32_bf16 a[48:51], a[152:155], v[48:51], a[48:51]
 s_waitcnt lgkmcnt(2)
 v_exp_f32 v224, v112
 v_mfma_f32_16x16x32_bf16 a[48:51], a[156:159], v[160:163], a[48:51]
 v_exp_f32 v225, v113
 v_mfma_f32_16x16x32_bf16 a[52:55], a[152:155], v[52:55], a[52:55]
 v_exp_f32 v226, v114
 v_mfma_f32_16x16x32_bf16 a[52:55], a[156:159], v[164:167], a[52:55]
 v_exp_f32 v227, v115
 v_mfma_f32_16x16x32_bf16 a[56:59], a[152:155], v[56:59], a[56:59]
 ds_read_b128 a[136:139], v16 offset:16384
 v_cvt_pk_bf16_f32 v178, v224, v225
 v_mfma_f32_16x16x32_bf16 a[56:59], a[156:159], v[168:171], a[56:59]
 s_waitcnt lgkmcnt(2)
 v_exp_f32 v228, v116
 v_mfma_f32_16x16x32_bf16 a[60:63], a[152:155], v[60:63], a[60:63]
 s_add_u32 s65, s65, 0x4000
 v_exp_f32 v229, v117
 v_mfma_f32_16x16x32_bf16 a[60:63], a[156:159], v[172:175], a[60:63]
 s_add_u32 s67, s67, 0x4000
 ds_read_b128 a[140:143], v17 offset:16384
 v_cvt_pk_bf16_f32 v179, v226, v227
 v_mfma_f32_16x16x32_bf16 v[128:131], a[128:131], a[160:163], v[192:195]
 s_waitcnt lgkmcnt(2)
 s_and_b32 s67, s67, 0xffff
 v_exp_f32 v230, v118
 v_mfma_f32_16x16x32_bf16 v[128:131], a[132:135], a[176:179], v[128:131]
 s_add_u32 m0, s66, 0x17000
 v_exp_f32 v231, v119
 v_mfma_f32_16x16x32_bf16 v[132:135], a[128:131], a[164:167], v[196:199]
 buffer_load_dwordx4 v26, s[20:23], s64 offen lds
 v_mfma_f32_16x16x32_bf16 v[132:135], a[132:135], a[180:183], v[132:135]
 v_cvt_pk_bf16_f32 v182, v228, v229
 v_cvt_pk_bf16_f32 v183, v230, v231
 v_mfma_f32_16x16x32_bf16 v[136:139], a[128:131], a[168:171], v[200:203]
 ds_read_b128 a[144:147], v14 offset:20480
 v_mfma_f32_16x16x32_bf16 v[136:139], a[132:135], a[184:187], v[136:139]
 v_exp_f32 v224, v120
 v_mfma_f32_16x16x32_bf16 v[140:143], a[128:131], a[172:175], v[204:207]
 v_exp_f32 v225, v121
 v_mfma_f32_16x16x32_bf16 v[140:143], a[132:135], a[188:191], v[140:143]
 s_waitcnt lgkmcnt(2)
 ds_read_b128 a[148:151], v15 offset:20480
 v_cvt_pk_bf16_f32 v186, v224, v225
 v_mfma_f32_16x16x32_bf16 v[128:131], a[136:139], v[64:67], v[128:131]
 s_waitcnt lgkmcnt(2)
 buffer_load_dwordx4 v27, s[20:23], s64 offen offset:1024 lds
 v_mfma_f32_16x16x32_bf16 v[128:131], a[140:143], v[80:83], v[128:131]
 v_exp_f32 v226, v122
 v_mfma_f32_16x16x32_bf16 v[132:135], a[136:139], v[68:71], v[132:135]
 v_exp_f32 v227, v123
 v_mfma_f32_16x16x32_bf16 v[132:135], a[140:143], v[84:87], v[132:135]
 v_exp_f32 v228, v124
 v_mfma_f32_16x16x32_bf16 v[136:139], a[136:139], v[72:75], v[136:139]
 v_exp_f32 v229, v125
 v_mfma_f32_16x16x32_bf16 v[136:139], a[140:143], v[88:91], v[136:139]
 v_cvt_pk_bf16_f32 v187, v226, v227
 v_cvt_pk_bf16_f32 v190, v228, v229
 v_mfma_f32_16x16x32_bf16 v[140:143], a[136:139], v[76:79], v[140:143]
 v_exp_f32 v230, v126
 v_mfma_f32_16x16x32_bf16 v[140:143], a[140:143], v[92:95], v[140:143]
 s_waitcnt lgkmcnt(1)
 v_mfma_f32_16x16x32_bf16 v[144:147], a[144:147], a[160:163], v[192:195]
 s_waitcnt lgkmcnt(0)
 ds_read_b128 a[152:155], v16 offset:20480
 v_mfma_f32_16x16x32_bf16 v[144:147], a[148:151], a[176:179], v[144:147]
 v_exp_f32 v231, v127
 v_mfma_f32_16x16x32_bf16 v[148:151], a[144:147], a[164:167], v[196:199]
 buffer_load_dwordx4 v28, s[20:23], s64 offen offset:2048 lds
 v_mfma_f32_16x16x32_bf16 v[148:151], a[148:151], a[180:183], v[148:151]
 ds_read_b128 a[156:159], v17 offset:20480
 v_cvt_pk_bf16_f32 v191, v230, v231
 v_mfma_f32_16x16x32_bf16 v[152:155], a[144:147], a[168:171], v[200:203]
 v_mfma_f32_16x16x32_bf16 v[152:155], a[148:151], a[184:187], v[152:155]
 v_mfma_f32_16x16x32_bf16 v[156:159], a[144:147], a[172:175], v[204:207]
 ds_read_b64_tr_b16 a[128:129], v22 offset:32768
 ds_read_b64_tr_b16 a[130:131], v22 offset:36864
 v_mfma_f32_16x16x32_bf16 v[156:159], a[148:151], a[188:191], v[156:159]
 v_mfma_f32_16x16x32_bf16 v[208:211], v[212:215], v[176:179], 0
 v_exp_f32 v224, v128
 v_mfma_f32_16x16x32_bf16 v[208:211], v[216:219], v[180:183], v[208:211]
 v_exp_f32 v225, v129
 v_mfma_f32_16x16x32_bf16 v[208:211], v[220:223], v[184:187], v[208:211]
 ds_read_b64_tr_b16 a[132:133], v22 offset:40960
 ds_read_b64_tr_b16 a[134:135], v22 offset:45056
 v_mfma_f32_16x16x32_bf16 v[208:211], v[236:239], v[188:191], v[208:211]
 s_waitcnt lgkmcnt(5)
 v_exp_f32 v226, v130
 v_mfma_f32_16x16x32_bf16 v[144:147], a[152:155], v[64:67], v[144:147]
 s_waitcnt lgkmcnt(4)
 buffer_load_dwordx4 v29, s[20:23], s64 offen offset:3072 lds
 v_mfma_f32_16x16x32_bf16 v[144:147], a[156:159], v[80:83], v[144:147]
 v_exp_f32 v227, v131
 v_mfma_f32_16x16x32_bf16 v[148:151], a[152:155], v[68:71], v[148:151]
 ds_read_b64_tr_b16 a[136:137], v23 offset:32768
 ds_read_b64_tr_b16 a[138:139], v23 offset:36864
 v_mfma_f32_16x16x32_bf16 v[148:151], a[156:159], v[84:87], v[148:151]
 v_cvt_pk_bf16_f32 v32, v224, v225
 v_cvt_pk_bf16_f32 v33, v226, v227
 v_mfma_f32_16x16x32_bf16 v[152:155], a[152:155], v[72:75], v[152:155]
 v_maximum3_f32 v240, v208, v209, v210
 v_maximum3_f32 v240, v240, v211, v211
 v_mfma_f32_16x16x32_bf16 v[152:155], a[156:159], v[88:91], v[152:155]
 v_cmp_nge_f32 vcc, s69, v240
 v_mfma_f32_16x16x32_bf16 v[156:159], a[152:155], v[76:79], v[156:159]
 s_waitcnt lgkmcnt(4)
 ds_read_b64_tr_b16 a[140:141], v23 offset:40960
 ds_read_b64_tr_b16 a[142:143], v23 offset:45056
 v_mfma_f32_16x16x32_bf16 v[156:159], a[156:159], v[92:95], v[156:159]
 s_cbranch_vccnz L_rare5
L_back5:
 v_exp_f32 v228, v132
 v_mfma_f32_16x16x32_bf16 a[64:67], a[128:131], v[160:163], a[64:67]
 s_waitcnt lgkmcnt(4)
 v_exp_f32 v229, v133
 v_mfma_f32_16x16x32_bf16 a[64:67], a[132:135], v[176:179], a[64:67]
 v_cvt_pk_bf16_f32 v36, v228, v229
 v_add_f32 v235, v235, v211
 v_mfma_f32_16x16x32_bf16 a[68:71], a[128:131], v[164:167], a[68:71]
 s_add_u32 s64, s64, 0x4000
 buffer_load_dwordx4 v[6:9], v4, s[40:43], s51 offen
 v_mfma_f32_16x16x32_bf16 a[68:71], a[132:135], v[180:183], a[68:71]
 s_add_u32 s66, s66, 0x4000
 ds_read_b64_tr_b16 a[144:145], v24 offset:32768
 ds_read_b64_tr_b16 a[146:147], v24 offset:36864
 v_mfma_f32_16x16x32_bf16 a[72:75], a[128:131], v[168:171], a[72:75]
 s_and_b32 s66, s66, 0xffff
 v_exp_f32 v230, v134
 v_mfma_f32_16x16x32_bf16 a[72:75], a[132:135], v[184:187], a[72:75]
 v_exp_f32 v231, v135
 v_mfma_f32_16x16x32_bf16 a[76:79], a[128:131], v[172:175], a[76:79]
 ds_read_b64_tr_b16 a[148:149], v24 offset:40960
 ds_read_b64_tr_b16 a[150:151], v24 offset:45056
 v_mfma_f32_16x16x32_bf16 a[76:79], a[132:135], v[188:191], a[76:79]
 s_waitcnt lgkmcnt(6)
 v_cvt_pk_bf16_f32 v37, v230, v231
 v_add_f32 v234, v234, v210
 v_mfma_f32_16x16x32_bf16 a[80:83], a[136:139], v[160:163], a[80:83]
 s_waitcnt lgkmcnt(4)
 v_exp_f32 v224, v136
 v_mfma_f32_16x16x32_bf16 a[80:83], a[140:143], v[176:179], a[80:83]
 v_exp_f32 v225, v137
 v_mfma_f32_16x16x32_bf16 a[84:87], a[136:139], v[164:167], a[84:87]
 ds_read_b64_tr_b16 a[152:153], v25 offset:32768
 ds_read_b64_tr_b16 a[154:155], v25 offset:36864
 v_mfma_f32_16x16x32_bf16 a[84:87], a[140:143], v[180:183], a[84:87]
 v_cvt_pk_bf16_f32 v40, v224, v225
 v_add_f32 v233, v233, v209
 v_mfma_f32_16x16x32_bf16 a[88:91], a[136:139], v[168:171], a[88:91]
 s_add_u32 s51, s51, 0xd80
 v_exp_f32 v226, v138
 v_mfma_f32_16x16x32_bf16 a[88:91], a[140:143], v[184:187], a[88:91]
 v_exp_f32 v227, v139
 v_mfma_f32_16x16x32_bf16 a[92:95], a[136:139], v[172:175], a[92:95]
 ds_read_b64_tr_b16 a[156:157], v25 offset:40960
 ds_read_b64_tr_b16 a[158:159], v25 offset:45056
 v_mfma_f32_16x16x32_bf16 a[92:95], a[140:143], v[188:191], a[92:95]
 s_waitcnt lgkmcnt(6)
 v_cvt_pk_bf16_f32 v41, v226, v227
 v_add_f32 v232, v232, v208
 v_mfma_f32_16x16x32_bf16 a[96:99], a[144:147], v[160:163], a[96:99]
 s_waitcnt lgkmcnt(4)
 v_exp_f32 v228, v140
 v_mfma_f32_16x16x32_bf16 a[96:99], a[148:151], v[176:179], a[96:99]
 v_exp_f32 v229, v141
 v_mfma_f32_16x16x32_bf16 a[100:103], a[144:147], v[164:167], a[100:103]
 s_waitcnt vmcnt(10)
 v_exp_f32 v230, v142
 v_mfma_f32_16x16x32_bf16 a[100:103], a[148:151], v[180:183], a[100:103]
 s_barrier
 v_exp_f32 v231, v143
 v_mfma_f32_16x16x32_bf16 a[104:107], a[144:147], v[168:171], a[104:107]
 ds_read_b128 a[128:131], v14 offset:24576
 v_cvt_pk_bf16_f32 v44, v228, v229
 v_mfma_f32_16x16x32_bf16 a[104:107], a[148:151], v[184:187], a[104:107]
 v_exp_f32 v224, v144
 v_mfma_f32_16x16x32_bf16 a[108:111], a[144:147], v[172:175], a[108:111]
 v_exp_f32 v225, v145
 v_mfma_f32_16x16x32_bf16 a[108:111], a[148:151], v[188:191], a[108:111]
 s_waitcnt lgkmcnt(3)
 ds_read_b128 a[132:135], v15 offset:24576
 v_cvt_pk_bf16_f32 v45, v230, v231
 v_mfma_f32_16x16x32_bf16 a[112:115], a[152:155], v[160:163], a[112:115]
 s_waitcnt lgkmcnt(2)
 v_exp_f32 v226, v146
 v_mfma_f32_16x16x32_bf16 a[112:115], a[156:159], v[176:179], a[112:115]
 v_exp_f32 v227, v147
 v_mfma_f32_16x16x32_bf16 a[116:119], a[152:155], v[164:167], a[116:119]
 v_cvt_pk_bf16_f32 v34, v224, v225
 v_cvt_pk_bf16_f32 v35, v226, v227
 v_mfma_f32_16x16x32_bf16 a[116:119], a[156:159], v[180:183], a[116:119]
 v_exp_f32 v228, v148
 v_mfma_f32_16x16x32_bf16 a[120:123], a[152:155], v[168:171], a[120:123]
 ds_read_b128 a[136:139], v16 offset:24576
 v_mfma_f32_16x16x32_bf16 a[120:123], a[156:159], v[184:187], a[120:123]
 v_exp_f32 v229, v149
 v_mfma_f32_16x16x32_bf16 a[124:127], a[152:155], v[172:175], a[124:127]
 v_exp_f32 v230, v150
 v_mfma_f32_16x16x32_bf16 a[124:127], a[156:159], v[188:191], a[124:127]
 s_waitcnt lgkmcnt(2)
 ds_read_b128 a[140:143], v17 offset:24576
 v_cvt_pk_bf16_f32 v38, v228, v229
 v_mfma_f32_16x16x32_bf16 v[96:99], a[128:131], a[160:163], v[192:195]
 s_waitcnt vmcnt(9) lgkmcnt(2)
 v_exp_f32 v231, v151
 v_mfma_f32_16x16x32_bf16 v[96:99], a[132:135], a[176:179], v[96:99]
 s_cmp_ge_u32 s52, s53
 v_cvt_pk_bf16_f32 v39, v230, v231
 v_mfma_f32_16x16x32_bf16 v[100:103], a[128:131], a[164:167], v[196:199]
 s_cselect_b64 exec, 0, -1
 buffer_store_dwordx4 v[10:13], v5, s[44:47], s52 offen sc1
 s_mov_b64 exec, -1
 v_mfma_f32_16x16x32_bf16 v[100:103], a[132:135], a[180:183], v[100:103]
 s_add_u32 s52, s52, s54
 v_exp_f32 v224, v152
 v_mfma_f32_16x16x32_bf16 v[104:107], a[128:131], a[168:171], v[200:203]
 ds_read_b128 a[144:147], v14 offset:28672
 v_mfma_f32_16x16x32_bf16 v[104:107], a[132:135], a[184:187], v[104:107]
 v_exp_f32 v225, v153
 v_mfma_f32_16x16x32_bf16 v[108:111], a[128:131], a[172:175], v[204:207]
 v_exp_f32 v226, v154
 v_mfma_f32_16x16x32_bf16 v[108:111], a[132:135], a[188:191], v[108:111]
 s_waitcnt lgkmcnt(2)
 ds_read_b128 a[148:151], v15 offset:28672
 v_cvt_pk_bf16_f32 v42, v224, v225
 v_mfma_f32_16x16x32_bf16 v[96:99], a[136:139], v[64:67], v[96:99]
 s_waitcnt lgkmcnt(2)
 v_exp_f32 v227, v155
 v_mfma_f32_16x16x32_bf16 v[96:99], a[140:143], v[80:83], v[96:99]
 v_cvt_pk_bf16_f32 v43, v226, v227
 v_mfma_f32_16x16x32_bf16 v[100:103], a[136:139], v[68:71], v[100:103]
 v_exp_f32 v228, v156
 v_mfma_f32_16x16x32_bf16 v[100:103], a[140:143], v[84:87], v[100:103]
 v_mfma_f32_16x16x32_bf16 v[104:107], a[136:139], v[72:75], v[104:107]
 v_exp_f32 v229, v157
 v_mfma_f32_16x16x32_bf16 v[104:107], a[140:143], v[88:91], v[104:107]
 v_cvt_pk_bf16_f32 v46, v228, v229
 v_mfma_f32_16x16x32_bf16 v[108:111], a[136:139], v[76:79], v[108:111]
 v_exp_f32 v230, v158
 v_mfma_f32_16x16x32_bf16 v[108:111], a[140:143], v[92:95], v[108:111]
 s_waitcnt lgkmcnt(1)
 v_mfma_f32_16x16x32_bf16 v[112:115], a[144:147], a[160:163], v[192:195]
 s_waitcnt lgkmcnt(0)
 ds_read_b128 a[152:155], v16 offset:28672
 v_mfma_f32_16x16x32_bf16 v[112:115], a[148:151], a[176:179], v[112:115]
 v_exp_f32 v231, v159
 v_mfma_f32_16x16x32_bf16 v[116:119], a[144:147], a[164:167], v[196:199]
 v_cvt_pk_bf16_f32 v47, v230, v231
 v_mfma_f32_16x16x32_bf16 v[116:119], a[148:151], a[180:183], v[116:119]
 ds_read_b128 a[156:159], v17 offset:28672
 v_mfma_f32_16x16x32_bf16 v[120:123], a[144:147], a[168:171], v[200:203]
 v_mfma_f32_16x16x32_bf16 v[120:123], a[148:151], a[184:187], v[120:123]
 v_mfma_f32_16x16x32_bf16 v[124:127], a[144:147], a[172:175], v[204:207]
 ds_read_b64_tr_b16 a[128:129], v18 offset:40960
 ds_read_b64_tr_b16 a[130:131], v18 offset:45056
 v_mfma_f32_16x16x32_bf16 v[124:127], a[148:151], a[188:191], v[124:127]
 v_mfma_f32_16x16x32_bf16 v[208:211], v[212:215], v[32:35], 0
 v_exp_f32 v224, v96
 v_mfma_f32_16x16x32_bf16 v[208:211], v[216:219], v[36:39], v[208:211]
 v_exp_f32 v225, v97
 v_mfma_f32_16x16x32_bf16 v[208:211], v[220:223], v[40:43], v[208:211]
 s_add_u32 m0, s67, 0x1000
 ds_read_b64_tr_b16 a[132:133], v18 offset:49152
 ds_read_b64_tr_b16 a[134:135], v18 offset:53248
 v_mfma_f32_16x16x32_bf16 v[208:211], v[236:239], v[44:47], v[208:211]
 s_waitcnt lgkmcnt(5)
 buffer_load_dwordx4 v30, s[24:27], s65 offen lds
 v_mfma_f32_16x16x32_bf16 v[112:115], a[152:155], v[64:67], v[112:115]
 s_waitcnt lgkmcnt(4)
 v_exp_f32 v226, v98
 v_mfma_f32_16x16x32_bf16 v[112:115], a[156:159], v[80:83], v[112:115]
 v_exp_f32 v227, v99
 v_mfma_f32_16x16x32_bf16 v[116:119], a[152:155], v[68:71], v[116:119]
 ds_read_b64_tr_b16 a[136:137], v19 offset:40960
 ds_read_b64_tr_b16 a[138:139], v19 offset:45056
 v_mfma_f32_16x16x32_bf16 v[116:119], a[156:159], v[84:87], v[116:119]
 v_cvt_pk_bf16_f32 v48, v224, v225
 v_cvt_pk_bf16_f32 v49, v226, v227
 v_mfma_f32_16x16x32_bf16 v[120:123], a[152:155], v[72:75], v[120:123]
 v_maximum3_f32 v240, v208, v209, v210
 v_maximum3_f32 v240, v240, v211, v211
 v_mfma_f32_16x16x32_bf16 v[120:123], a[156:159], v[88:91], v[120:123]
 v_cmp_nge_f32 vcc, s69, v240
 v_mfma_f32_16x16x32_bf16 v[124:127], a[152:155], v[76:79], v[124:127]
 s_waitcnt lgkmcnt(4)
 ds_read_b64_tr_b16 a[140:141], v19 offset:49152
 ds_read_b64_tr_b16 a[142:143], v19 offset:53248
 v_mfma_f32_16x16x32_bf16 v[124:127], a[156:159], v[92:95], v[124:127]
 s_cbranch_vccnz L_rare6
L_back6:
 v_exp_f32 v228, v100
 v_mfma_f32_16x16x32_bf16 a[0:3], a[128:131], v[176:179], a[0:3]
 s_waitcnt lgkmcnt(4)
 buffer_load_dwordx4 v31, s[24:27], s65 offen offset:1024 lds
 v_mfma_f32_16x16x32_bf16 a[0:3], a[132:135], v[32:35], a[0:3]
 v_exp_f32 v229, v101
 v_mfma_f32_16x16x32_bf16 a[4:7], a[128:131], v[180:183], a[4:7]
 ds_read_b64_tr_b16 a[144:145], v20 offset:40960
 ds_read_b64_tr_b16 a[146:147], v20 offset:45056
 v_mfma_f32_16x16x32_bf16 a[4:7], a[132:135], v[36:39], a[4:7]
 v_cvt_pk_bf16_f32 v52, v228, v229
 v_add_f32 v235, v235, v211
 v_mfma_f32_16x16x32_bf16 a[8:11], a[128:131], v[184:187], a[8:11]
 v_exp_f32 v230, v102
 v_mfma_f32_16x16x32_bf16 a[8:11], a[132:135], v[40:43], a[8:11]
 v_exp_f32 v231, v103
 v_mfma_f32_16x16x32_bf16 a[12:15], a[128:131], v[188:191], a[12:15]
 ds_read_b64_tr_b16 a[148:149], v20 offset:49152
 ds_read_b64_tr_b16 a[150:151], v20 offset:53248
 v_mfma_f32_16x16x32_bf16 a[12:15], a[132:135], v[44:47], a[12:15]
 s_waitcnt lgkmcnt(6)
 v_cvt_pk_bf16_f32 v53, v230, v231
 v_add_f32 v234, v234, v210
 v_mfma_f32_16x16x32_bf16 a[16:19], a[136:139], v[176:179], a[16:19]
 s_waitcnt lgkmcnt(4)
 v_exp_f32 v224, v104
 v_mfma_f32_16x16x32_bf16 a[16:19], a[140:143], v[32:35], a[16:19]
 v_exp_f32 v225, v105
 v_mfma_f32_16x16x32_bf16 a[20:23], a[136:139], v[180:183], a[20:23]
 ds_read_b64_tr_b16 a[152:153], v21 offset:40960
 ds_read_b64_tr_b16 a[154:155], v21 offset:45056
 v_mfma_f32_16x16x32_bf16 a[20:23], a[140:143], v[36:39], a[20:23]
 buffer_load_dwordx4 v30, s[24:27], s65 offen offset:2048 lds
 v_mfma_f32_16x16x32_bf16 a[24:27], a[136:139], v[184:187], a[24:27]
 v_cvt_pk_bf16_f32 v56, v224, v225
 v_add_f32 v233, v233, v209
 v_mfma_f32_16x16x32_bf16 a[24:27], a[140:143], v[40:43], a[24:27]
 v_exp_f32 v226, v106
 v_mfma_f32_16x16x32_bf16 a[28:31], a[136:139], v[188:191], a[28:31]
 ds_read_b64_tr_b16 a[156:157], v21 offset:49152
 ds_read_b64_tr_b16 a[158:159], v21 offset:53248
 v_mfma_f32_16x16x32_bf16 a[28:31], a[140:143], v[44:47], a[28:31]
 s_waitcnt lgkmcnt(6)
 v_exp_f32 v227, v107
 v_mfma_f32_16x16x32_bf16 a[32:35], a[144:147], v[176:179], a[32:35]
 s_waitcnt lgkmcnt(4)
 v_cvt_pk_bf16_f32 v57, v226, v227
 v_add_f32 v232, v232, v208
 v_mfma_f32_16x16x32_bf16 a[32:35], a[148:151], v[32:35], a[32:35]
 v_exp_f32 v228, v108
 v_mfma_f32_16x16x32_bf16 a[36:39], a[144:147], v[180:183], a[36:39]
 v_exp_f32 v229, v109
 v_mfma_f32_16x16x32_bf16 a[36:39], a[148:151], v[36:39], a[36:39]
 v_exp_f32 v230, v110
 v_mfma_f32_16x16x32_bf16 a[40:43], a[144:147], v[184:187], a[40:43]
 buffer_load_dwordx4 v31, s[24:27], s65 offen offset:3072 lds
 v_mfma_f32_16x16x32_bf16 a[40:43], a[148:151], v[40:43], a[40:43]
 ds_read_b128 a[128:131], v14 offset:32768
 v_cvt_pk_bf16_f32 v60, v228, v229
 v_mfma_f32_16x16x32_bf16 a[44:47], a[144:147], v[188:191], a[44:47]
 v_exp_f32 v231, v111
 v_mfma_f32_16x16x32_bf16 a[44:47], a[148:151], v[44:47], a[44:47]
 s_waitcnt lgkmcnt(3)
 ds_read_b128 a[132:135], v15 offset:32768
 v_cvt_pk_bf16_f32 v61, v230, v231
 v_mfma_f32_16x16x32_bf16 a[48:51], a[152:155], v[176:179], a[48:51]
 s_waitcnt lgkmcnt(2)
 v_exp_f32 v224, v112
 v_mfma_f32_16x16x32_bf16 a[48:51], a[156:159], v[32:35], a[48:51]
 v_exp_f32 v225, v113
 v_mfma_f32_16x16x32_bf16 a[52:55], a[152:155], v[180:183], a[52:55]
 v_exp_f32 v226, v114
 v_mfma_f32_16x16x32_bf16 a[52:55], a[156:159], v[36:39], a[52:55]
 v_exp_f32 v227, v115
 v_mfma_f32_16x16x32_bf16 a[56:59], a[152:155], v[184:187], a[56:59]
 ds_read_b128 a[136:139], v16 offset:32768
 v_cvt_pk_bf16_f32 v50, v224, v225
 v_mfma_f32_16x16x32_bf16 a[56:59], a[156:159], v[40:43], a[56:59]
 s_waitcnt lgkmcnt(2)
 v_exp_f32 v228, v116
 v_mfma_f32_16x16x32_bf16 a[60:63], a[152:155], v[188:191], a[60:63]
 s_add_u32 s65, s65, 0x4000
 v_exp_f32 v229, v117
 v_mfma_f32_16x16x32_bf16 a[60:63], a[156:159], v[44:47], a[60:63]
 s_add_u32 s67, s67, 0x4000
 ds_read_b128 a[140:143], v17 offset:32768
 v_cvt_pk_bf16_f32 v51, v226, v227
 s_sub_u32 s68, s68, 1
 s_lshl_b32 s62, 1, s68
 s_and_b32 s62, s62, 11
 s_cbranch_scc0 L_loop
 s_cmp_lg_u32 s68, 0
 s_cbranch_scc1 L_side
L_peel:
 v_mfma_f32_16x16x32_bf16 v[128:131], a[128:131], a[160:163], v[192:195]
 s_waitcnt lgkmcnt(2)
 s_and_b32 s67, s67, 0xffff
 v_exp_f32 v230, v118
 v_mfma_f32_16x16x32_bf16 v[128:131], a[132:135], a[176:179], v[128:131]
 s_add_u32 m0, s66, 0x17000
 v_exp_f32 v231, v119
 v_mfma_f32_16x16x32_bf16 v[132:135], a[128:131], a[164:167], v[196:199]
 s_lshl_b32 s49, s17, 7
 buffer_load_dwordx4 v26, s[20:23], s64 offen lds
 v_mfma_f32_16x16x32_bf16 v[132:135], a[132:135], a[180:183], v[132:135]
 v_cvt_pk_bf16_f32 v54, v228, v229
 v_cvt_pk_bf16_f32 v55, v230, v231
 v_mfma_f32_16x16x32_bf16 v[136:139], a[128:131], a[168:171], v[200:203]
 s_add_u32 s49, s49, 0x300400
 ds_read_b128 a[144:147], v14 offset:36864
 v_mfma_f32_16x16x32_bf16 v[136:139], a[132:135], a[184:187], v[136:139]
 v_exp_f32 v224, v120
 v_mfma_f32_16x16x32_bf16 v[140:143], a[128:131], a[172:175], v[204:207]
 s_lshl_b32 s18, s72, 1
 v_exp_f32 v225, v121
 v_mfma_f32_16x16x32_bf16 v[140:143], a[132:135], a[188:191], v[140:143]
 s_waitcnt lgkmcnt(1)
 ds_read_b128 a[148:151], v15 offset:36864
 v_cvt_pk_bf16_f32 v58, v224, v225
 v_mfma_f32_16x16x32_bf16 v[128:131], a[136:139], v[64:67], v[128:131]
 s_lshl_b32 s50, s18, 7
 buffer_load_dwordx4 v27, s[20:23], s64 offen offset:1024 lds
 v_mfma_f32_16x16x32_bf16 v[128:131], a[140:143], v[80:83], v[128:131]
 v_exp_f32 v226, v122
 v_mfma_f32_16x16x32_bf16 v[132:135], a[136:139], v[68:71], v[132:135]
 s_add_u32 s50, s50, 0x300c00
 v_exp_f32 v227, v123
 v_mfma_f32_16x16x32_bf16 v[132:135], a[140:143], v[84:87], v[132:135]
 v_exp_f32 v228, v124
 v_mfma_f32_16x16x32_bf16 v[136:139], a[136:139], v[72:75], v[136:139]
 s_lshl_b32 s18, s71, 2
 v_exp_f32 v229, v125
 v_mfma_f32_16x16x32_bf16 v[136:139], a[140:143], v[88:91], v[136:139]
 v_cvt_pk_bf16_f32 v59, v226, v227
 v_cvt_pk_bf16_f32 v62, v228, v229
 v_mfma_f32_16x16x32_bf16 v[140:143], a[136:139], v[76:79], v[140:143]
 s_add_u32 s18, s18, s72
 v_exp_f32 v230, v126
 v_mfma_f32_16x16x32_bf16 v[140:143], a[140:143], v[92:95], v[140:143]
 s_waitcnt lgkmcnt(0)
 v_mfma_f32_16x16x32_bf16 v[144:147], a[144:147], a[160:163], v[192:195]
 s_lshl_b32 s47, s18, 7
 ds_read_b128 a[152:155], v16 offset:36864
 v_mfma_f32_16x16x32_bf16 v[144:147], a[148:151], a[176:179], v[144:147]
 v_exp_f32 v231, v127
 v_mfma_f32_16x16x32_bf16 v[148:151], a[144:147], a[164:167], v[196:199]
 s_add_u32 s47, s47, 0x303400
 buffer_load_dwordx4 v28, s[20:23], s64 offen offset:2048 lds
 v_mfma_f32_16x16x32_bf16 v[148:151], a[148:151], a[180:183], v[148:151]
 ds_read_b128 a[156:159], v17 offset:36864
 v_cvt_pk_bf16_f32 v63, v230, v231
 v_mfma_f32_16x16x32_bf16 v[152:155], a[144:147], a[168:171], v[200:203]
 v_and_b32 v251, 31, v1
 v_mfma_f32_16x16x32_bf16 v[152:155], a[148:151], a[184:187], v[152:155]
 v_mfma_f32_16x16x32_bf16 v[156:159], a[144:147], a[172:175], v[204:207]
 ds_read_b64_tr_b16 a[128:129], v22 offset:49152
 ds_read_b64_tr_b16 a[130:131], v22 offset:53248
 v_mfma_f32_16x16x32_bf16 v[156:159], a[148:151], a[188:191], v[156:159]
 v_lshlrev_b32 v251, 2, v251
 v_mfma_f32_16x16x32_bf16 v[208:211], v[212:215], v[48:51], 0
 buffer_load_dword v251, v251, s[36:39], s49 offen sc1
 v_mfma_f32_16x16x32_bf16 v[208:211], v[216:219], v[52:55], v[208:211]
 v_exp_f32 v224, v128
 v_mfma_f32_16x16x32_bf16 v[208:211], v[220:223], v[56:59], v[208:211]
 ds_read_b64_tr_b16 a[132:133], v22 offset:57344
 ds_read_b64_tr_b16 a[134:135], v22 offset:61440
 v_mfma_f32_16x16x32_bf16 v[208:211], v[236:239], v[60:63], v[208:211]
 s_waitcnt lgkmcnt(5)
 v_exp_f32 v225, v129
 v_mfma_f32_16x16x32_bf16 v[144:147], a[152:155], v[64:67], v[144:147]
 s_waitcnt lgkmcnt(4)
 buffer_load_dwordx4 v29, s[20:23], s64 offen offset:3072 lds
 v_mfma_f32_16x16x32_bf16 v[144:147], a[156:159], v[80:83], v[144:147]
 v_cvt_pk_bf16_f32 v160, v224, v225
 v_and_b32 v252, 63, v1
 v_mfma_f32_16x16x32_bf16 v[148:151], a[152:155], v[68:71], v[148:151]
 ds_read_b64_tr_b16 a[136:137], v23 offset:49152
 ds_read_b64_tr_b16 a[138:139], v23 offset:53248
 v_mfma_f32_16x16x32_bf16 v[148:151], a[156:159], v[84:87], v[148:151]
 v_exp_f32 v226, v130
 v_mfma_f32_16x16x32_bf16 v[152:155], a[152:155], v[72:75], v[152:155]
 v_maximum3_f32 v240, v208, v209, v210
 v_maximum3_f32 v240, v240, v211, v211
 v_mfma_f32_16x16x32_bf16 v[152:155], a[156:159], v[88:91], v[152:155]
 v_cmp_nge_f32 vcc, s69, v240
 v_lshlrev_b32 v252, 2, v252
 v_mfma_f32_16x16x32_bf16 v[156:159], a[152:155], v[76:79], v[156:159]
 s_waitcnt lgkmcnt(4)
 buffer_load_dword v252, v252, s[36:39], s50 offen sc1
 v_mfma_f32_16x16x32_bf16 v[156:159], a[156:159], v[92:95], v[156:159]
 s_cbranch_vccnz L_rarep55
L_backp55:
 ds_read_b64_tr_b16 a[140:141], v23 offset:57344
 ds_read_b64_tr_b16 a[142:143], v23 offset:61440
 v_mfma_f32_16x16x32_bf16 a[64:67], a[128:131], v[32:35], a[64:67]
 s_waitcnt lgkmcnt(4)
 v_exp_f32 v227, v131
 v_mfma_f32_16x16x32_bf16 a[64:67], a[132:135], v[48:51], a[64:67]
 v_cvt_pk_bf16_f32 v161, v226, v227
 v_and_b32 v10, 3, v1
 v_mfma_f32_16x16x32_bf16 a[68:71], a[128:131], v[36:39], a[68:71]
 s_add_u32 s64, s64, 0x4000
 ds_read_b64_tr_b16 a[144:145], v24 offset:49152
 ds_read_b64_tr_b16 a[146:147], v24 offset:53248
 v_mfma_f32_16x16x32_bf16 a[68:71], a[132:135], v[52:55], a[68:71]
 s_add_u32 s66, s66, 0x4000
 v_exp_f32 v228, v132
 v_mfma_f32_16x16x32_bf16 a[72:75], a[128:131], v[40:43], a[72:75]
 s_and_b32 s66, s66, 0xffff
 v_exp_f32 v229, v133
 v_mfma_f32_16x16x32_bf16 a[72:75], a[132:135], v[56:59], a[72:75]
 v_cvt_pk_bf16_f32 v164, v228, v229
 v_lshlrev_b32 v10, 3, v10
 v_mfma_f32_16x16x32_bf16 a[76:79], a[128:131], v[44:47], a[76:79]
 s_waitcnt vmcnt(10)
 buffer_load_dwordx2 v[6:7], v10, s[36:39], s47 offen sc1
 v_mfma_f32_16x16x32_bf16 a[76:79], a[132:135], v[60:63], a[76:79]
 s_waitcnt lgkmcnt(4)
 ds_read_b64_tr_b16 a[148:149], v24 offset:57344
 ds_read_b64_tr_b16 a[150:151], v24 offset:61440
 v_mfma_f32_16x16x32_bf16 a[80:83], a[136:139], v[32:35], a[80:83]
 s_waitcnt lgkmcnt(4)
 v_exp_f32 v230, v134
 v_mfma_f32_16x16x32_bf16 a[80:83], a[140:143], v[48:51], a[80:83]
 v_add_f32 v235, v235, v211
 v_add_f32 v234, v234, v210
 v_mfma_f32_16x16x32_bf16 a[84:87], a[136:139], v[36:39], a[84:87]
 ds_read_b64_tr_b16 a[152:153], v25 offset:49152
 ds_read_b64_tr_b16 a[154:155], v25 offset:53248
 v_mfma_f32_16x16x32_bf16 a[84:87], a[140:143], v[52:55], a[84:87]
 v_exp_f32 v231, v135
 v_mfma_f32_16x16x32_bf16 a[88:91], a[136:139], v[40:43], a[88:91]
 v_cvt_pk_bf16_f32 v165, v230, v231
 v_add_f32 v233, v233, v209
 v_mfma_f32_16x16x32_bf16 a[88:91], a[140:143], v[56:59], a[88:91]
 v_exp_f32 v224, v136
 v_mfma_f32_16x16x32_bf16 a[92:95], a[136:139], v[44:47], a[92:95]
 ds_read_b64_tr_b16 a[156:157], v25 offset:57344
 ds_read_b64_tr_b16 a[158:159], v25 offset:61440
 v_mfma_f32_16x16x32_bf16 a[92:95], a[140:143], v[60:63], a[92:95]
 s_waitcnt lgkmcnt(6)
 v_exp_f32 v225, v137
 v_mfma_f32_16x16x32_bf16 a[96:99], a[144:147], v[32:35], a[96:99]
 s_waitcnt lgkmcnt(4)
 v_cvt_pk_bf16_f32 v168, v224, v225
 v_add_f32 v232, v232, v208
 v_mfma_f32_16x16x32_bf16 a[96:99], a[148:151], v[48:51], a[96:99]
 v_exp_f32 v226, v138
 v_mfma_f32_16x16x32_bf16 a[100:103], a[144:147], v[36:39], a[100:103]
 v_exp_f32 v227, v139
 v_mfma_f32_16x16x32_bf16 a[100:103], a[148:151], v[52:55], a[100:103]
 s_barrier
 v_exp_f32 v228, v140
 v_mfma_f32_16x16x32_bf16 a[104:107], a[144:147], v[40:43], a[104:107]
 ds_read_b128 a[128:131], v14 offset:40960
 v_cvt_pk_bf16_f32 v169, v226, v227
 v_mfma_f32_16x16x32_bf16 a[104:107], a[148:151], v[56:59], a[104:107]
 v_exp_f32 v229, v141
 v_mfma_f32_16x16x32_bf16 a[108:111], a[144:147], v[44:47], a[108:111]
 v_exp_f32 v230, v142
 v_mfma_f32_16x16x32_bf16 a[108:111], a[148:151], v[60:63], a[108:111]
 s_waitcnt lgkmcnt(3)
 ds_read_b128 a[132:135], v15 offset:40960
 v_cvt_pk_bf16_f32 v172, v228, v229
 v_mfma_f32_16x16x32_bf16 a[112:115], a[152:155], v[32:35], a[112:115]
 s_waitcnt lgkmcnt(2)
 v_exp_f32 v231, v143
 v_mfma_f32_16x16x32_bf16 a[112:115], a[156:159], v[48:51], a[112:115]
 v_exp_f32 v224, v144
 v_mfma_f32_16x16x32_bf16 a[116:119], a[152:155], v[36:39], a[116:119]
 v_exp_f32 v225, v145
 v_mfma_f32_16x16x32_bf16 a[116:119], a[156:159], v[52:55], a[116:119]
 v_cvt_pk_bf16_f32 v173, v230, v231
 v_cvt_pk_bf16_f32 v162, v224, v225
 v_mfma_f32_16x16x32_bf16 a[120:123], a[152:155], v[40:43], a[120:123]
 ds_read_b128 a[136:139], v16 offset:40960
 v_mfma_f32_16x16x32_bf16 a[120:123], a[156:159], v[56:59], a[120:123]
 v_exp_f32 v226, v146
 v_mfma_f32_16x16x32_bf16 a[124:127], a[152:155], v[44:47], a[124:127]
 v_exp_f32 v227, v147
 v_mfma_f32_16x16x32_bf16 a[124:127], a[156:159], v[60:63], a[124:127]
 s_waitcnt lgkmcnt(2)
 ds_read_b128 a[140:143], v17 offset:40960
 v_cvt_pk_bf16_f32 v163, v226, v227
 v_mfma_f32_16x16x32_bf16 v[96:99], a[128:131], a[160:163], v[192:195]
 s_waitcnt lgkmcnt(2)
 v_exp_f32 v228, v148
 v_mfma_f32_16x16x32_bf16 v[96:99], a[132:135], a[176:179], v[96:99]
 s_add_u32 m0, s67, 0x1000
 v_exp_f32 v229, v149
 v_mfma_f32_16x16x32_bf16 v[100:103], a[128:131], a[164:167], v[196:199]
 s_mul_i32 s51, s3, 0x2400
 buffer_load_dwordx4 v30, s[24:27], s65 offen lds
 v_mfma_f32_16x16x32_bf16 v[100:103], a[132:135], a[180:183], v[100:103]
 s_add_u32 s52, s73, s51
 v_exp_f32 v230, v150
 v_mfma_f32_16x16x32_bf16 v[104:107], a[128:131], a[168:171], v[200:203]
 s_lshl_b32 s18, s71, 2
 ds_read_b128 a[144:147], v14 offset:45056
 v_cvt_pk_bf16_f32 v166, v228, v229
 v_mfma_f32_16x16x32_bf16 v[104:107], a[132:135], a[184:187], v[104:107]
 s_add_u32 s18, s18, s3
 v_exp_f32 v231, v151
 v_mfma_f32_16x16x32_bf16 v[108:111], a[128:131], a[172:175], v[204:207]
 s_mul_i32 s19, s18, 0x88000
 v_exp_f32 v224, v152
 v_mfma_f32_16x16x32_bf16 v[108:111], a[132:135], a[188:191], v[108:111]
 s_waitcnt lgkmcnt(1)
 s_add_u32 s19, s19, 0x400000
 ds_read_b128 a[148:151], v15 offset:45056
 v_cvt_pk_bf16_f32 v167, v230, v231
 v_mfma_f32_16x16x32_bf16 v[96:99], a[136:139], v[64:67], v[96:99]
 s_add_u32 s28, s14, s19
 v_exp_f32 v225, v153
 v_mfma_f32_16x16x32_bf16 v[96:99], a[140:143], v[80:83], v[96:99]
 s_addc_u32 s29, s15, 0
 v_exp_f32 v226, v154
 v_mfma_f32_16x16x32_bf16 v[100:103], a[136:139], v[68:71], v[100:103]
 s_mov_b32 s30, 0x88000
 v_exp_f32 v227, v155
 v_mfma_f32_16x16x32_bf16 v[100:103], a[140:143], v[84:87], v[100:103]
 s_mov_b32 s31, 0x20000
 v_cvt_pk_bf16_f32 v170, v224, v225
 v_cvt_pk_bf16_f32 v171, v226, v227
 v_mfma_f32_16x16x32_bf16 v[104:107], a[136:139], v[72:75], v[104:107]
 s_and_b32 s54, s70, 1
 v_exp_f32 v228, v156
 v_mfma_f32_16x16x32_bf16 v[104:107], a[140:143], v[88:91], v[104:107]
 s_lshl_b32 s54, s54, 10
 buffer_load_dwordx4 v31, s[24:27], s65 offen offset:1024 lds
 v_mfma_f32_16x16x32_bf16 v[108:111], a[136:139], v[76:79], v[108:111]
 s_lshr_b32 s56, s70, 1
 v_exp_f32 v229, v157
 v_mfma_f32_16x16x32_bf16 v[108:111], a[140:143], v[92:95], v[108:111]
 s_waitcnt lgkmcnt(1)
 v_add_u32 v4, s54, v2
 v_xor_b32 v5, 0x400, v4
 v_mfma_f32_16x16x32_bf16 v[112:115], a[144:147], a[160:163], v[192:195]
 s_waitcnt lgkmcnt(0)
 ds_read_b128 a[152:155], v16 offset:45056
 v_cvt_pk_bf16_f32 v174, v228, v229
 v_mfma_f32_16x16x32_bf16 v[112:115], a[148:151], a[176:179], v[112:115]
 v_exp_f32 v230, v158
 v_mfma_f32_16x16x32_bf16 v[116:119], a[144:147], a[164:167], v[196:199]
 v_exp_f32 v231, v159
 v_mfma_f32_16x16x32_bf16 v[116:119], a[148:151], a[180:183], v[116:119]
 ds_read_b128 a[156:159], v17 offset:45056
 v_cvt_pk_bf16_f32 v175, v230, v231
 v_mfma_f32_16x16x32_bf16 v[120:123], a[144:147], a[168:171], v[200:203]
 v_mfma_f32_16x16x32_bf16 v[120:123], a[148:151], a[184:187], v[120:123]
 v_mfma_f32_16x16x32_bf16 v[124:127], a[144:147], a[172:175], v[204:207]
 ds_read_b64_tr_b16 a[128:129], v18 offset:57344
 ds_read_b64_tr_b16 a[130:131], v18 offset:61440
 v_mfma_f32_16x16x32_bf16 v[124:127], a[148:151], a[188:191], v[124:127]
 v_mfma_f32_16x16x32_bf16 v[208:211], v[212:215], v[160:163], 0
 v_exp_f32 v224, v96
 v_mfma_f32_16x16x32_bf16 v[208:211], v[216:219], v[164:167], v[208:211]
 buffer_load_dwordx4 v30, s[24:27], s65 offen offset:2048 lds
 v_mfma_f32_16x16x32_bf16 v[208:211], v[220:223], v[168:171], v[208:211]
 ds_read_b64_tr_b16 a[132:133], v18
 ds_read_b64_tr_b16 a[134:135], v18 offset:4096
 v_mfma_f32_16x16x32_bf16 v[208:211], v[236:239], v[172:175], v[208:211]
 s_waitcnt lgkmcnt(5)
 v_exp_f32 v225, v97
 v_mfma_f32_16x16x32_bf16 v[112:115], a[152:155], v[64:67], v[112:115]
 s_waitcnt lgkmcnt(4)
 v_exp_f32 v226, v98
 v_mfma_f32_16x16x32_bf16 v[112:115], a[156:159], v[80:83], v[112:115]
 v_exp_f32 v227, v99
 v_mfma_f32_16x16x32_bf16 v[116:119], a[152:155], v[68:71], v[116:119]
 ds_read_b64_tr_b16 a[136:137], v19 offset:57344
 ds_read_b64_tr_b16 a[138:139], v19 offset:61440
 v_mfma_f32_16x16x32_bf16 v[116:119], a[156:159], v[84:87], v[116:119]
 v_cvt_pk_bf16_f32 v176, v224, v225
 v_cvt_pk_bf16_f32 v177, v226, v227
 v_mfma_f32_16x16x32_bf16 v[120:123], a[152:155], v[72:75], v[120:123]
 v_maximum3_f32 v240, v208, v209, v210
 v_maximum3_f32 v240, v240, v211, v211
 v_mfma_f32_16x16x32_bf16 v[120:123], a[156:159], v[88:91], v[120:123]
 v_cmp_nge_f32 vcc, s69, v240
 v_mfma_f32_16x16x32_bf16 v[124:127], a[152:155], v[76:79], v[124:127]
 s_waitcnt lgkmcnt(4)
 ds_read_b64_tr_b16 a[140:141], v19
 ds_read_b64_tr_b16 a[142:143], v19 offset:4096
 v_mfma_f32_16x16x32_bf16 v[124:127], a[156:159], v[92:95], v[124:127]
 s_cbranch_vccnz L_rarep56
L_backp56:
 v_exp_f32 v228, v100
 v_mfma_f32_16x16x32_bf16 a[0:3], a[128:131], v[48:51], a[0:3]
 s_waitcnt lgkmcnt(4)
 v_exp_f32 v229, v101
 v_mfma_f32_16x16x32_bf16 a[0:3], a[132:135], v[160:163], a[0:3]
 buffer_load_dwordx4 v31, s[24:27], s65 offen offset:3072 lds
 v_mfma_f32_16x16x32_bf16 a[4:7], a[128:131], v[52:55], a[4:7]
 ds_read_b64_tr_b16 a[144:145], v20 offset:57344
 ds_read_b64_tr_b16 a[146:147], v20 offset:61440
 v_mfma_f32_16x16x32_bf16 a[4:7], a[132:135], v[164:167], a[4:7]
 v_cvt_pk_bf16_f32 v180, v228, v229
 v_add_f32 v235, v235, v211
 v_mfma_f32_16x16x32_bf16 a[8:11], a[128:131], v[56:59], a[8:11]
 v_exp_f32 v230, v102
 v_mfma_f32_16x16x32_bf16 a[8:11], a[132:135], v[168:171], a[8:11]
 s_waitcnt vmcnt(7)
 v_cmp_ne_u32 vcc, s59, v251
 v_add_f32 v234, v234, v210
 v_mfma_f32_16x16x32_bf16 a[12:15], a[128:131], v[60:63], a[12:15]
 s_cbranch_vccnz L_sl4
L_sb4:
 ds_read_b64_tr_b16 a[148:149], v20
 ds_read_b64_tr_b16 a[150:151], v20 offset:4096
 v_mfma_f32_16x16x32_bf16 a[12:15], a[132:135], v[172:175], a[12:15]
 s_waitcnt lgkmcnt(6)
 v_exp_f32 v231, v103
 v_mfma_f32_16x16x32_bf16 a[16:19], a[136:139], v[48:51], a[16:19]
 s_waitcnt lgkmcnt(4)
 v_cvt_pk_bf16_f32 v181, v230, v231
 v_add_f32 v233, v233, v209
 v_mfma_f32_16x16x32_bf16 a[16:19], a[140:143], v[160:163], a[16:19]
 v_exp_f32 v224, v104
 v_mfma_f32_16x16x32_bf16 a[20:23], a[136:139], v[52:55], a[20:23]
 ds_read_b64_tr_b16 a[152:153], v21 offset:57344
 ds_read_b64_tr_b16 a[154:155], v21 offset:61440
 v_mfma_f32_16x16x32_bf16 a[20:23], a[140:143], v[164:167], a[20:23]
 s_waitcnt vmcnt(5)
 v_cmp_ne_u32 vcc, s59, v252
 v_add_f32 v232, v232, v208
 v_mfma_f32_16x16x32_bf16 a[24:27], a[136:139], v[56:59], a[24:27]
 s_cbranch_vccnz L_sl6
L_sb6:
 v_exp_f32 v225, v105
 v_mfma_f32_16x16x32_bf16 a[24:27], a[140:143], v[168:171], a[24:27]
 s_add_u32 s65, s65, 0x4000
 v_exp_f32 v226, v106
 v_mfma_f32_16x16x32_bf16 a[28:31], a[136:139], v[60:63], a[28:31]
 s_add_u32 s67, s67, 0x4000
 ds_read_b64_tr_b16 a[156:157], v21
 ds_read_b64_tr_b16 a[158:159], v21 offset:4096
 v_mfma_f32_16x16x32_bf16 a[28:31], a[140:143], v[172:175], a[28:31]
 s_waitcnt lgkmcnt(4)
 s_and_b32 s67, s67, 0xffff
 v_exp_f32 v227, v107
 v_mfma_f32_16x16x32_bf16 a[32:35], a[144:147], v[48:51], a[32:35]
 s_add_u32 m0, s66, 0x17000
 v_cvt_pk_bf16_f32 v184, v224, v225
 v_cvt_pk_bf16_f32 v185, v226, v227
 v_mfma_f32_16x16x32_bf16 a[32:35], a[148:151], v[160:163], a[32:35]
 buffer_load_dwordx4 v26, s[20:23], s64 offen lds
 v_mfma_f32_16x16x32_bf16 a[36:39], a[144:147], v[52:55], a[36:39]
 s_waitcnt vmcnt(5)
 v_cmp_ne_u32 vcc, s59, v7
 v_mfma_f32_16x16x32_bf16 a[36:39], a[148:151], v[164:167], a[36:39]
 s_cbranch_vccnz L_tsl
L_tsb:
 v_exp_f32 v228, v108
 v_mfma_f32_16x16x32_bf16 a[40:43], a[144:147], v[56:59], a[40:43]
 ds_read_b128 a[128:131], v14 offset:49152
 v_mfma_f32_16x16x32_bf16 a[40:43], a[148:151], v[168:171], a[40:43]
 v_exp_f32 v229, v109
 v_mfma_f32_16x16x32_bf16 a[44:47], a[144:147], v[60:63], a[44:47]
 v_cvt_pk_bf16_f32 v188, v228, v229
 v_readlane_b32 s32, v6, 0
 v_mfma_f32_16x16x32_bf16 a[44:47], a[148:151], v[172:175], a[44:47]
 s_waitcnt lgkmcnt(3)
 ds_read_b128 a[132:135], v15 offset:49152
 v_mfma_f32_16x16x32_bf16 a[48:51], a[152:155], v[48:51], a[48:51]
 s_waitcnt lgkmcnt(2)
 v_exp_f32 v230, v110
 v_mfma_f32_16x16x32_bf16 a[48:51], a[156:159], v[160:163], a[48:51]
 buffer_load_dwordx4 v27, s[20:23], s64 offen offset:1024 lds
 v_mfma_f32_16x16x32_bf16 a[52:55], a[152:155], v[52:55], a[52:55]
 v_exp_f32 v231, v111
 v_mfma_f32_16x16x32_bf16 a[52:55], a[156:159], v[164:167], a[52:55]
 v_cvt_pk_bf16_f32 v189, v230, v231
 v_readlane_b32 s33, v6, 1
 v_mfma_f32_16x16x32_bf16 a[56:59], a[152:155], v[56:59], a[56:59]
 ds_read_b128 a[136:139], v16 offset:49152
 v_readlane_b32 s34, v6, 2
 v_mfma_f32_16x16x32_bf16 a[56:59], a[156:159], v[168:171], a[56:59]
 v_exp_f32 v224, v112
 v_mfma_f32_16x16x32_bf16 a[60:63], a[152:155], v[60:63], a[60:63]
 s_waitcnt lgkmcnt(2)
 v_exp_f32 v225, v113
 v_mfma_f32_16x16x32_bf16 a[60:63], a[156:159], v[172:175], a[60:63]
 s_add_u32 s18, s32, s33
 ds_read_b128 a[140:143], v17 offset:49152
 v_cvt_pk_bf16_f32 v178, v224, v225
 v_mfma_f32_16x16x32_bf16 v[128:131], a[128:131], a[160:163], v[192:195]
 s_waitcnt lgkmcnt(2)
 v_exp_f32 v226, v114
 v_mfma_f32_16x16x32_bf16 v[128:131], a[132:135], a[176:179], v[128:131]
 v_exp_f32 v227, v115
 v_mfma_f32_16x16x32_bf16 v[132:135], a[128:131], a[164:167], v[196:199]
 v_cvt_pk_bf16_f32 v179, v226, v227
 v_readlane_b32 s35, v6, 3
 v_mfma_f32_16x16x32_bf16 v[132:135], a[132:135], a[180:183], v[132:135]
 s_add_u32 s19, s34, s35
 v_exp_f32 v228, v116
 v_mfma_f32_16x16x32_bf16 v[136:139], a[128:131], a[168:171], v[200:203]
 s_add_u32 s18, s18, s19
 ds_read_b128 a[144:147], v14 offset:53248
 v_mfma_f32_16x16x32_bf16 v[136:139], a[132:135], a[184:187], v[136:139]
 s_lshr_b32 s18, s18, 2
 buffer_load_dwordx4 v28, s[20:23], s64 offen offset:2048 lds
 v_mfma_f32_16x16x32_bf16 v[140:143], a[128:131], a[172:175], v[204:207]
 v_exp_f32 v229, v117
 v_mfma_f32_16x16x32_bf16 v[140:143], a[132:135], a[188:191], v[140:143]
 s_waitcnt lgkmcnt(1)
 ds_read_b128 a[148:151], v15 offset:53248
 v_cvt_pk_bf16_f32 v182, v228, v229
 v_mfma_f32_16x16x32_bf16 v[128:131], a[136:139], v[64:67], v[128:131]
 s_sub_i32 s32, s18, s32
 v_exp_f32 v230, v118
 v_mfma_f32_16x16x32_bf16 v[128:131], a[140:143], v[80:83], v[128:131]
 v_exp_f32 v231, v119
 v_mfma_f32_16x16x32_bf16 v[132:135], a[136:139], v[68:71], v[132:135]
 s_mul_i32 s32, s32, 0x96
 v_exp_f32 v224, v120
 v_mfma_f32_16x16x32_bf16 v[132:135], a[140:143], v[84:87], v[132:135]
 v_exp_f32 v225, v121
 v_mfma_f32_16x16x32_bf16 v[136:139], a[136:139], v[72:75], v[136:139]
 s_ashr_i32 s32, s32, 8
 v_cvt_pk_bf16_f32 v183, v230, v231
 v_cvt_pk_bf16_f32 v186, v224, v225
 v_mfma_f32_16x16x32_bf16 v[136:139], a[140:143], v[88:91], v[136:139]
 v_exp_f32 v226, v122
 v_mfma_f32_16x16x32_bf16 v[140:143], a[136:139], v[76:79], v[140:143]
 s_sub_i32 s33, s18, s33
 v_exp_f32 v227, v123
 v_mfma_f32_16x16x32_bf16 v[140:143], a[140:143], v[92:95], v[140:143]
 s_waitcnt lgkmcnt(1)
 v_exp_f32 v228, v124
 v_mfma_f32_16x16x32_bf16 v[144:147], a[144:147], a[160:163], v[192:195]
 s_waitcnt lgkmcnt(0)
 ds_read_b128 a[152:155], v16 offset:53248
 v_cvt_pk_bf16_f32 v187, v226, v227
 v_mfma_f32_16x16x32_bf16 v[144:147], a[148:151], a[176:179], v[144:147]
 s_mul_i32 s33, s33, 0x96
 buffer_load_dwordx4 v29, s[20:23], s64 offen offset:3072 lds
 v_mfma_f32_16x16x32_bf16 v[148:151], a[144:147], a[164:167], v[196:199]
 v_exp_f32 v229, v125
 v_mfma_f32_16x16x32_bf16 v[148:151], a[148:151], a[180:183], v[148:151]
 s_ashr_i32 s33, s33, 8
 ds_read_b128 a[156:159], v17 offset:53248
 v_cvt_pk_bf16_f32 v190, v228, v229
 v_mfma_f32_16x16x32_bf16 v[152:155], a[144:147], a[168:171], v[200:203]
 v_exp_f32 v230, v126
 v_mfma_f32_16x16x32_bf16 v[152:155], a[148:151], a[184:187], v[152:155]
 s_sub_i32 s34, s18, s34
 v_exp_f32 v231, v127
 v_mfma_f32_16x16x32_bf16 v[156:159], a[144:147], a[172:175], v[204:207]
 ds_read_b64_tr_b16 a[128:129], v22
 ds_read_b64_tr_b16 a[130:131], v22 offset:4096
 v_cvt_pk_bf16_f32 v191, v230, v231
 v_mfma_f32_16x16x32_bf16 v[156:159], a[148:151], a[188:191], v[156:159]
 s_mul_i32 s34, s34, 0x96
 v_mfma_f32_16x16x32_bf16 v[208:211], v[212:215], v[176:179], 0
 v_exp_f32 v224, v128
 v_mfma_f32_16x16x32_bf16 v[208:211], v[216:219], v[180:183], v[208:211]
 v_exp_f32 v225, v129
 v_mfma_f32_16x16x32_bf16 v[208:211], v[220:223], v[184:187], v[208:211]
 s_ashr_i32 s34, s34, 8
 ds_read_b64_tr_b16 a[132:133], v22 offset:8192
 ds_read_b64_tr_b16 a[134:135], v22 offset:12288
 v_mfma_f32_16x16x32_bf16 v[208:211], v[236:239], v[188:191], v[208:211]
 s_waitcnt lgkmcnt(4)
 v_exp_f32 v226, v130
 v_mfma_f32_16x16x32_bf16 v[144:147], a[152:155], v[64:67], v[144:147]
 s_add_i32 s33, s33, s32
 v_cvt_pk_bf16_f32 v32, v224, v225
 v_mfma_f32_16x16x32_bf16 v[144:147], a[156:159], v[80:83], v[144:147]
 s_add_u32 s64, s64, 0x4000
 v_exp_f32 v227, v131
 v_mfma_f32_16x16x32_bf16 v[148:151], a[152:155], v[68:71], v[148:151]
 s_add_u32 s66, s66, 0x4000
 ds_read_b64_tr_b16 a[136:137], v23
 ds_read_b64_tr_b16 a[138:139], v23 offset:4096
 v_mfma_f32_16x16x32_bf16 v[148:151], a[156:159], v[84:87], v[148:151]
 s_and_b32 s66, s66, 0xffff
 v_cvt_pk_bf16_f32 v33, v226, v227
 v_maximum3_f32 v240, v208, v209, v210
 v_mfma_f32_16x16x32_bf16 v[152:155], a[152:155], v[72:75], v[152:155]
 s_add_i32 s34, s34, s33
 v_maximum3_f32 v240, v240, v211, v211
 v_cmp_nge_f32 vcc, s69, v240
 v_mfma_f32_16x16x32_bf16 v[152:155], a[156:159], v[88:91], v[152:155]
 s_add_i32 s32, s32, 0x260
 v_exp_f32 v228, v132
 v_mfma_f32_16x16x32_bf16 v[156:159], a[152:155], v[76:79], v[156:159]
 s_waitcnt lgkmcnt(2)
 ds_read_b64_tr_b16 a[140:141], v23 offset:8192
 ds_read_b64_tr_b16 a[142:143], v23 offset:12288
 v_mfma_f32_16x16x32_bf16 v[156:159], a[156:159], v[92:95], v[156:159]
 s_cbranch_vccnz L_rarep57
L_backp57:
 v_exp_f32 v229, v133
 v_mfma_f32_16x16x32_bf16 a[64:67], a[128:131], v[160:163], a[64:67]
 s_ashr_i32 s32, s32, 6
 v_cvt_pk_bf16_f32 v36, v228, v229
 v_add_f32 v235, v235, v211
 v_mfma_f32_16x16x32_bf16 a[64:67], a[132:135], v[176:179], a[64:67]
 s_add_i32 s33, s33, 0x4a0
 v_exp_f32 v230, v134
 v_mfma_f32_16x16x32_bf16 a[68:71], a[128:131], v[164:167], a[68:71]
 ds_read_b64_tr_b16 a[144:145], v24
 ds_read_b64_tr_b16 a[146:147], v24 offset:4096
 v_mfma_f32_16x16x32_bf16 a[68:71], a[132:135], v[180:183], a[68:71]
 s_ashr_i32 s33, s33, 6
 v_exp_f32 v231, v135
 v_mfma_f32_16x16x32_bf16 a[72:75], a[128:131], v[168:171], a[72:75]
 v_cvt_pk_bf16_f32 v37, v230, v231
 v_add_f32 v234, v234, v210
 v_mfma_f32_16x16x32_bf16 a[72:75], a[132:135], v[184:187], a[72:75]
 s_add_i32 s34, s34, 0x6e0
 v_exp_f32 v224, v136
 v_mfma_f32_16x16x32_bf16 a[76:79], a[128:131], v[172:175], a[76:79]
 ds_read_b64_tr_b16 a[148:149], v24 offset:8192
 ds_read_b64_tr_b16 a[150:151], v24 offset:12288
 v_mfma_f32_16x16x32_bf16 a[76:79], a[132:135], v[188:191], a[76:79]
 s_waitcnt lgkmcnt(4)
 v_exp_f32 v225, v137
 v_mfma_f32_16x16x32_bf16 a[80:83], a[136:139], v[160:163], a[80:83]
 s_ashr_i32 s34, s34, 6
 v_cvt_pk_bf16_f32 v40, v224, v225
 v_add_f32 v233, v233, v209
 v_mfma_f32_16x16x32_bf16 a[80:83], a[140:143], v[176:179], a[80:83]
 v_exp_f32 v226, v138
 v_mfma_f32_16x16x32_bf16 a[84:87], a[136:139], v[164:167], a[84:87]
 s_max_i32 s32, s32, 6
 ds_read_b64_tr_b16 a[152:153], v25
 ds_read_b64_tr_b16 a[154:155], v25 offset:4096
 v_mfma_f32_16x16x32_bf16 a[84:87], a[140:143], v[180:183], a[84:87]
 v_exp_f32 v227, v139
 v_mfma_f32_16x16x32_bf16 a[88:91], a[136:139], v[168:171], a[88:91]
 s_min_i32 s32, s32, 12
 v_cvt_pk_bf16_f32 v41, v226, v227
 v_add_f32 v232, v232, v208
 v_mfma_f32_16x16x32_bf16 a[88:91], a[140:143], v[184:187], a[88:91]
 v_exp_f32 v228, v140
 v_mfma_f32_16x16x32_bf16 a[92:95], a[136:139], v[172:175], a[92:95]
 s_add_i32 s18, s32, 6
 ds_read_b64_tr_b16 a[156:157], v25 offset:8192
 ds_read_b64_tr_b16 a[158:159], v25 offset:12288
 v_mfma_f32_16x16x32_bf16 a[92:95], a[140:143], v[188:191], a[92:95]
 s_waitcnt lgkmcnt(6)
 v_exp_f32 v229, v141
 v_mfma_f32_16x16x32_bf16 a[96:99], a[144:147], v[160:163], a[96:99]
 s_waitcnt lgkmcnt(4)
 v_exp_f32 v230, v142
 v_mfma_f32_16x16x32_bf16 a[96:99], a[148:151], v[176:179], a[96:99]
 s_max_i32 s33, s33, s18
 v_exp_f32 v231, v143
 v_mfma_f32_16x16x32_bf16 a[100:103], a[144:147], v[164:167], a[100:103]
 v_cvt_pk_bf16_f32 v44, v228, v229
 v_cvt_pk_bf16_f32 v45, v230, v231
 v_mfma_f32_16x16x32_bf16 a[100:103], a[148:151], v[180:183], a[100:103]
 s_barrier
 v_exp_f32 v224, v144
 v_mfma_f32_16x16x32_bf16 a[104:107], a[144:147], v[168:171], a[104:107]
 s_add_i32 s18, s18, 6
 ds_read_b128 a[128:131], v14 offset:57344
 v_mfma_f32_16x16x32_bf16 a[104:107], a[148:151], v[184:187], a[104:107]
 s_min_i32 s33, s33, s18
 v_exp_f32 v225, v145
 v_mfma_f32_16x16x32_bf16 a[108:111], a[144:147], v[172:175], a[108:111]
 s_waitcnt lgkmcnt(3)
 v_exp_f32 v226, v146
 v_mfma_f32_16x16x32_bf16 a[108:111], a[148:151], v[188:191], a[108:111]
 s_add_i32 s18, s33, 6
 ds_read_b128 a[132:135], v15 offset:57344
 v_cvt_pk_bf16_f32 v34, v224, v225
 v_mfma_f32_16x16x32_bf16 a[112:115], a[152:155], v[160:163], a[112:115]
 s_waitcnt lgkmcnt(2)
 v_exp_f32 v227, v147
 v_mfma_f32_16x16x32_bf16 a[112:115], a[156:159], v[176:179], a[112:115]
 v_cvt_pk_bf16_f32 v35, v226, v227
 v_mfma_f32_16x16x32_bf16 a[116:119], a[152:155], v[164:167], a[116:119]
 s_max_i32 s34, s34, s18
 v_exp_f32 v228, v148
 v_mfma_f32_16x16x32_bf16 a[116:119], a[156:159], v[180:183], a[116:119]
 v_mfma_f32_16x16x32_bf16 a[120:123], a[152:155], v[168:171], a[120:123]
 s_add_i32 s18, s18, 6
 ds_read_b128 a[136:139], v16 offset:57344
 v_mfma_f32_16x16x32_bf16 a[120:123], a[156:159], v[184:187], a[120:123]
 v_exp_f32 v229, v149
 v_mfma_f32_16x16x32_bf16 a[124:127], a[152:155], v[172:175], a[124:127]
 s_min_i32 s34, s34, s18
 v_exp_f32 v230, v150
 v_mfma_f32_16x16x32_bf16 a[124:127], a[156:159], v[188:191], a[124:127]
 s_waitcnt lgkmcnt(1)
 ds_read_b128 a[140:143], v17 offset:57344
 v_cvt_pk_bf16_f32 v38, v228, v229
 v_mfma_f32_16x16x32_bf16 v[96:99], a[128:131], a[160:163], v[192:195]
 s_max_i32 s34, s34, 24
 v_exp_f32 v231, v151
 v_mfma_f32_16x16x32_bf16 v[96:99], a[132:135], a[176:179], v[96:99]
 s_add_u32 m0, s67, 0x1000
 v_cvt_pk_bf16_f32 v39, v230, v231
 v_mfma_f32_16x16x32_bf16 v[100:103], a[128:131], a[164:167], v[196:199]
 buffer_load_dwordx4 v30, s[24:27], s65 offen lds
 v_mfma_f32_16x16x32_bf16 v[100:103], a[132:135], a[180:183], v[100:103]
 s_min_i32 s34, s34, 30
 v_exp_f32 v224, v152
 v_mfma_f32_16x16x32_bf16 v[104:107], a[128:131], a[168:171], v[200:203]
 ds_read_b128 a[144:147], v14 offset:61440
 v_mfma_f32_16x16x32_bf16 v[104:107], a[132:135], a[184:187], v[104:107]
 s_mov_b32 s35, 36
 v_exp_f32 v225, v153
 v_mfma_f32_16x16x32_bf16 v[108:111], a[128:131], a[172:175], v[204:207]
 s_waitcnt lgkmcnt(2)
 v_exp_f32 v226, v154
 v_mfma_f32_16x16x32_bf16 v[108:111], a[132:135], a[188:191], v[108:111]
 s_mov_b32 s45, 0
 ds_read_b128 a[148:151], v15 offset:61440
 v_cvt_pk_bf16_f32 v42, v224, v225
 v_mfma_f32_16x16x32_bf16 v[96:99], a[136:139], v[64:67], v[96:99]
 s_waitcnt lgkmcnt(2)
 v_exp_f32 v227, v155
 v_mfma_f32_16x16x32_bf16 v[96:99], a[140:143], v[80:83], v[96:99]
 s_mov_b32 s46, s32
 v_cvt_pk_bf16_f32 v43, v226, v227
 v_mfma_f32_16x16x32_bf16 v[100:103], a[136:139], v[68:71], v[100:103]
 v_exp_f32 v228, v156
 v_mfma_f32_16x16x32_bf16 v[100:103], a[140:143], v[84:87], v[100:103]
 v_mfma_f32_16x16x32_bf16 v[104:107], a[136:139], v[72:75], v[104:107]
 s_cmp_eq_u32 s70, 1
 s_cselect_b32 s45, s32, s45
 s_cselect_b32 s46, s33, s46
 v_exp_f32 v229, v157
 v_mfma_f32_16x16x32_bf16 v[104:107], a[140:143], v[88:91], v[104:107]
 buffer_load_dwordx4 v31, s[24:27], s65 offen offset:1024 lds
 v_mfma_f32_16x16x32_bf16 v[108:111], a[136:139], v[76:79], v[108:111]
 s_cmp_eq_u32 s70, 2
 s_cselect_b32 s45, s33, s45
 s_cselect_b32 s46, s34, s46
 v_exp_f32 v230, v158
 v_mfma_f32_16x16x32_bf16 v[108:111], a[140:143], v[92:95], v[108:111]
 s_waitcnt lgkmcnt(0)
 v_cvt_pk_bf16_f32 v46, v228, v229
 v_mfma_f32_16x16x32_bf16 v[112:115], a[144:147], a[160:163], v[192:195]
 s_cmp_eq_u32 s70, 3
 s_cselect_b32 s45, s34, s45
 s_cselect_b32 s46, s35, s46
 ds_read_b128 a[152:155], v16 offset:61440
 v_mfma_f32_16x16x32_bf16 v[112:115], a[148:151], a[176:179], v[112:115]
 v_exp_f32 v231, v159
 v_mfma_f32_16x16x32_bf16 v[116:119], a[144:147], a[164:167], v[196:199]
 s_sub_u32 s46, s46, s45
 v_cvt_pk_bf16_f32 v47, v230, v231
 v_mfma_f32_16x16x32_bf16 v[116:119], a[148:151], a[180:183], v[116:119]
 ds_read_b128 a[156:159], v17 offset:61440
 v_mfma_f32_16x16x32_bf16 v[120:123], a[144:147], a[168:171], v[200:203]
 v_mfma_f32_16x16x32_bf16 v[120:123], a[148:151], a[184:187], v[120:123]
 s_sub_u32 s46, s46, 6
 v_mfma_f32_16x16x32_bf16 v[124:127], a[144:147], a[172:175], v[204:207]
 ds_read_b64_tr_b16 a[128:129], v18 offset:8192
 ds_read_b64_tr_b16 a[130:131], v18 offset:12288
 v_mfma_f32_16x16x32_bf16 v[124:127], a[148:151], a[188:191], v[124:127]
 s_sub_u32 s43, 1, s46
 v_mfma_f32_16x16x32_bf16 v[208:211], v[212:215], v[32:35], 0
 v_exp_f32 v224, v96
 v_mfma_f32_16x16x32_bf16 v[208:211], v[216:219], v[36:39], v[208:211]
 s_and_b32 s43, s43, 3
 buffer_load_dwordx4 v30, s[24:27], s65 offen offset:2048 lds
 v_mfma_f32_16x16x32_bf16 v[208:211], v[220:223], v[40:43], v[208:211]
 s_waitcnt lgkmcnt(3)
 ds_read_b64_tr_b16 a[132:133], v18 offset:16384
 ds_read_b64_tr_b16 a[134:135], v18 offset:20480
 v_mfma_f32_16x16x32_bf16 v[208:211], v[236:239], v[44:47], v[208:211]
 s_add_u32 s68, s46, 3
 v_exp_f32 v225, v97
 v_mfma_f32_16x16x32_bf16 v[112:115], a[152:155], v[64:67], v[112:115]
 s_waitcnt lgkmcnt(4)
 v_exp_f32 v226, v98
 v_mfma_f32_16x16x32_bf16 v[112:115], a[156:159], v[80:83], v[112:115]
 v_exp_f32 v227, v99
 v_mfma_f32_16x16x32_bf16 v[116:119], a[152:155], v[68:71], v[116:119]
 s_lshr_b32 s68, s68, 2
 ds_read_b64_tr_b16 a[136:137], v19 offset:8192
 ds_read_b64_tr_b16 a[138:139], v19 offset:12288
 v_mfma_f32_16x16x32_bf16 v[116:119], a[156:159], v[84:87], v[116:119]
 v_cvt_pk_bf16_f32 v48, v224, v225
 v_cvt_pk_bf16_f32 v49, v226, v227
 v_mfma_f32_16x16x32_bf16 v[120:123], a[152:155], v[72:75], v[120:123]
 s_mul_i32 s18, s45, 0x9000
 v_maximum3_f32 v240, v208, v209, v210
 v_maximum3_f32 v240, v240, v211, v211
 v_mfma_f32_16x16x32_bf16 v[120:123], a[156:159], v[88:91], v[120:123]
 s_waitcnt lgkmcnt(4)
 v_cmp_nge_f32 vcc, s69, v240
 v_mfma_f32_16x16x32_bf16 v[124:127], a[152:155], v[76:79], v[124:127]
 s_add_u32 s52, s52, s18
 ds_read_b64_tr_b16 a[140:141], v19 offset:16384
 ds_read_b64_tr_b16 a[142:143], v19 offset:20480
 v_mfma_f32_16x16x32_bf16 v[124:127], a[156:159], v[92:95], v[124:127]
 s_cbranch_vccnz L_rarep58
L_backp58:
 v_exp_f32 v228, v100
 v_mfma_f32_16x16x32_bf16 a[0:3], a[128:131], v[176:179], a[0:3]
 s_waitcnt lgkmcnt(4)
 s_lshl_b32 s45, s45, 13
 v_exp_f32 v229, v101
 v_mfma_f32_16x16x32_bf16 a[0:3], a[132:135], v[32:35], a[0:3]
 buffer_load_dwordx4 v31, s[24:27], s65 offen offset:3072 lds
 v_mfma_f32_16x16x32_bf16 a[4:7], a[128:131], v[180:183], a[4:7]
 ds_read_b64_tr_b16 a[144:145], v20 offset:8192
 ds_read_b64_tr_b16 a[146:147], v20 offset:12288
 v_mfma_f32_16x16x32_bf16 a[4:7], a[132:135], v[36:39], a[4:7]
 s_add_u32 s45, s45, 0x40000
 v_cvt_pk_bf16_f32 v52, v228, v229
 v_add_f32 v235, v235, v211
 v_mfma_f32_16x16x32_bf16 a[8:11], a[128:131], v[184:187], a[8:11]
 v_exp_f32 v230, v102
 v_mfma_f32_16x16x32_bf16 a[8:11], a[132:135], v[40:43], a[8:11]
 s_sub_u32 s18, 0, s43
 v_exp_f32 v231, v103
 v_mfma_f32_16x16x32_bf16 a[12:15], a[128:131], v[188:191], a[12:15]
 s_waitcnt lgkmcnt(4)
 ds_read_b64_tr_b16 a[148:149], v20 offset:16384
 ds_read_b64_tr_b16 a[150:151], v20 offset:20480
 v_mfma_f32_16x16x32_bf16 a[12:15], a[132:135], v[44:47], a[12:15]
 s_and_b32 s18, s18, 3
 v_cvt_pk_bf16_f32 v53, v230, v231
 v_add_f32 v234, v234, v210
 v_mfma_f32_16x16x32_bf16 a[16:19], a[136:139], v[176:179], a[16:19]
 s_waitcnt lgkmcnt(4)
 v_exp_f32 v224, v104
 v_mfma_f32_16x16x32_bf16 a[16:19], a[140:143], v[32:35], a[16:19]
 s_mov_b32 s8, 0x1f000
 v_exp_f32 v225, v105
 v_mfma_f32_16x16x32_bf16 a[20:23], a[136:139], v[180:183], a[20:23]
 ds_read_b64_tr_b16 a[152:153], v21 offset:8192
 ds_read_b64_tr_b16 a[154:155], v21 offset:12288
 v_mfma_f32_16x16x32_bf16 a[20:23], a[140:143], v[36:39], a[20:23]
 v_cvt_pk_bf16_f32 v56, v224, v225
 v_add_f32 v233, v233, v209
 v_mfma_f32_16x16x32_bf16 a[24:27], a[136:139], v[184:187], a[24:27]
 s_cmp_eq_u32 s18, 1
 s_cselect_b32 s8, 0, s8
 v_exp_f32 v226, v106
 v_mfma_f32_16x16x32_bf16 a[24:27], a[140:143], v[40:43], a[24:27]
 s_add_u32 s65, s65, 0x4000
 v_exp_f32 v227, v107
 v_mfma_f32_16x16x32_bf16 a[28:31], a[136:139], v[188:191], a[28:31]
 s_add_u32 s67, s67, 0x4000
 ds_read_b64_tr_b16 a[156:157], v21 offset:16384
 ds_read_b64_tr_b16 a[158:159], v21 offset:20480
 v_mfma_f32_16x16x32_bf16 a[28:31], a[140:143], v[44:47], a[28:31]
 s_waitcnt lgkmcnt(4)
 s_and_b32 s67, s67, 0xffff
 v_cvt_pk_bf16_f32 v57, v226, v227
 v_add_f32 v232, v232, v208
 v_mfma_f32_16x16x32_bf16 a[32:35], a[144:147], v[176:179], a[32:35]
 s_cmp_eq_u32 s18, 2
 s_cselect_b32 s8, 0x12000, s8
 v_exp_f32 v228, v108
 v_mfma_f32_16x16x32_bf16 a[32:35], a[148:151], v[32:35], a[32:35]
 s_cmp_eq_u32 s18, 3
 s_cselect_b32 s8, 0x9000, s8
 v_exp_f32 v229, v109
 v_mfma_f32_16x16x32_bf16 a[36:39], a[144:147], v[180:183], a[36:39]
 s_sub_u32 s18, 1, s43
 v_exp_f32 v230, v110
 v_mfma_f32_16x16x32_bf16 a[36:39], a[148:151], v[36:39], a[36:39]
 v_exp_f32 v231, v111
 v_mfma_f32_16x16x32_bf16 a[40:43], a[144:147], v[184:187], a[40:43]
 ds_read_b128 a[128:131], v14
 v_cvt_pk_bf16_f32 v60, v228, v229
 v_mfma_f32_16x16x32_bf16 a[40:43], a[148:151], v[40:43], a[40:43]
 s_and_b32 s18, s18, 3
 v_exp_f32 v224, v112
 v_mfma_f32_16x16x32_bf16 a[44:47], a[144:147], v[188:191], a[44:47]
 s_waitcnt lgkmcnt(3)
 v_exp_f32 v225, v113
 v_mfma_f32_16x16x32_bf16 a[44:47], a[148:151], v[44:47], a[44:47]
 s_mov_b32 s9, 0x1f000
 ds_read_b128 a[132:135], v15
 v_cvt_pk_bf16_f32 v61, v230, v231
 v_mfma_f32_16x16x32_bf16 a[48:51], a[152:155], v[176:179], a[48:51]
 s_waitcnt lgkmcnt(2)
 v_exp_f32 v226, v114
 v_mfma_f32_16x16x32_bf16 a[48:51], a[156:159], v[32:35], a[48:51]
 s_cmp_eq_u32 s18, 1
 s_cselect_b32 s9, 0, s9
 v_exp_f32 v227, v115
 v_mfma_f32_16x16x32_bf16 a[52:55], a[152:155], v[180:183], a[52:55]
 v_cvt_pk_bf16_f32 v50, v224, v225
 v_cvt_pk_bf16_f32 v51, v226, v227
 v_mfma_f32_16x16x32_bf16 a[52:55], a[156:159], v[36:39], a[52:55]
 s_cmp_eq_u32 s18, 2
 s_cselect_b32 s9, 0x12000, s9
 v_exp_f32 v228, v116
 v_mfma_f32_16x16x32_bf16 a[56:59], a[152:155], v[184:187], a[56:59]
 ds_read_b128 a[136:139], v16
 v_mfma_f32_16x16x32_bf16 a[56:59], a[156:159], v[40:43], a[56:59]
 v_exp_f32 v229, v117
 v_mfma_f32_16x16x32_bf16 a[60:63], a[152:155], v[188:191], a[60:63]
 s_cmp_eq_u32 s18, 3
 s_cselect_b32 s9, 0x9000, s9
 v_exp_f32 v230, v118
 v_mfma_f32_16x16x32_bf16 a[60:63], a[156:159], v[44:47], a[60:63]
 s_waitcnt lgkmcnt(1)
 ds_read_b128 a[140:143], v17
 v_cvt_pk_bf16_f32 v54, v228, v229
 v_mfma_f32_16x16x32_bf16 v[128:131], a[128:131], a[160:163], v[192:195]
 s_sub_u32 s18, 2, s43
 v_exp_f32 v231, v119
 v_mfma_f32_16x16x32_bf16 v[128:131], a[132:135], a[176:179], v[128:131]
 v_cvt_pk_bf16_f32 v55, v230, v231
 v_mfma_f32_16x16x32_bf16 v[132:135], a[128:131], a[164:167], v[196:199]
 s_and_b32 s18, s18, 3
 v_exp_f32 v224, v120
 v_mfma_f32_16x16x32_bf16 v[132:135], a[132:135], a[180:183], v[132:135]
 v_mfma_f32_16x16x32_bf16 v[136:139], a[128:131], a[168:171], v[200:203]
 s_mov_b32 s10, 0x1f000
 ds_read_b128 a[144:147], v14 offset:4096
 v_mfma_f32_16x16x32_bf16 v[136:139], a[132:135], a[184:187], v[136:139]
 v_exp_f32 v225, v121
 v_mfma_f32_16x16x32_bf16 v[140:143], a[128:131], a[172:175], v[204:207]
 s_waitcnt lgkmcnt(2)
 v_exp_f32 v226, v122
 v_mfma_f32_16x16x32_bf16 v[140:143], a[132:135], a[188:191], v[140:143]
 s_cmp_eq_u32 s18, 1
 s_cselect_b32 s10, 0, s10
 ds_read_b128 a[148:151], v15 offset:4096
 v_cvt_pk_bf16_f32 v58, v224, v225
 v_mfma_f32_16x16x32_bf16 v[128:131], a[136:139], v[64:67], v[128:131]
 s_waitcnt lgkmcnt(2)
 v_exp_f32 v227, v123
 v_mfma_f32_16x16x32_bf16 v[128:131], a[140:143], v[80:83], v[128:131]
 s_cmp_eq_u32 s18, 2
 s_cselect_b32 s10, 0x12000, s10
 v_cvt_pk_bf16_f32 v59, v226, v227
 v_mfma_f32_16x16x32_bf16 v[132:135], a[136:139], v[68:71], v[132:135]
 v_exp_f32 v228, v124
 v_mfma_f32_16x16x32_bf16 v[132:135], a[140:143], v[84:87], v[132:135]
 s_cmp_eq_u32 s18, 3
 s_cselect_b32 s10, 0x9000, s10
 v_mfma_f32_16x16x32_bf16 v[136:139], a[136:139], v[72:75], v[136:139]
 v_exp_f32 v229, v125
 v_mfma_f32_16x16x32_bf16 v[136:139], a[140:143], v[88:91], v[136:139]
 s_sub_u32 s18, 3, s43
 v_cvt_pk_bf16_f32 v62, v228, v229
 v_mfma_f32_16x16x32_bf16 v[140:143], a[136:139], v[76:79], v[140:143]
 v_exp_f32 v230, v126
 v_mfma_f32_16x16x32_bf16 v[140:143], a[140:143], v[92:95], v[140:143]
 s_waitcnt lgkmcnt(0)
 v_mfma_f32_16x16x32_bf16 v[144:147], a[144:147], a[160:163], v[192:195]
 s_and_b32 s18, s18, 3
 ds_read_b128 a[152:155], v16 offset:4096
 v_mfma_f32_16x16x32_bf16 v[144:147], a[148:151], a[176:179], v[144:147]
 v_exp_f32 v231, v127
 v_mfma_f32_16x16x32_bf16 v[148:151], a[144:147], a[164:167], v[196:199]
 s_mov_b32 s11, 0x1f000
 v_cvt_pk_bf16_f32 v63, v230, v231
 v_mfma_f32_16x16x32_bf16 v[148:151], a[148:151], a[180:183], v[148:151]
 ds_read_b128 a[156:159], v17 offset:4096
 v_mfma_f32_16x16x32_bf16 v[152:155], a[144:147], a[168:171], v[200:203]
 s_cmp_eq_u32 s18, 1
 s_cselect_b32 s11, 0, s11
 v_mfma_f32_16x16x32_bf16 v[152:155], a[148:151], a[184:187], v[152:155]
 v_mfma_f32_16x16x32_bf16 v[156:159], a[144:147], a[172:175], v[204:207]
 s_cmp_eq_u32 s18, 2
 s_cselect_b32 s11, 0x12000, s11
 ds_read_b64_tr_b16 a[128:129], v22 offset:16384
 ds_read_b64_tr_b16 a[130:131], v22 offset:20480
 v_mfma_f32_16x16x32_bf16 v[156:159], a[148:151], a[188:191], v[156:159]
 v_mfma_f32_16x16x32_bf16 v[208:211], v[212:215], v[48:51], 0
 v_exp_f32 v224, v128
 v_mfma_f32_16x16x32_bf16 v[208:211], v[216:219], v[52:55], v[208:211]
 s_cmp_eq_u32 s18, 3
 s_cselect_b32 s11, 0x9000, s11
 v_exp_f32 v225, v129
 v_mfma_f32_16x16x32_bf16 v[208:211], v[220:223], v[56:59], v[208:211]
 ds_read_b64_tr_b16 a[132:133], v22 offset:24576
 ds_read_b64_tr_b16 a[134:135], v22 offset:28672
 v_mfma_f32_16x16x32_bf16 v[208:211], v[236:239], v[60:63], v[208:211]
 s_waitcnt lgkmcnt(5)
 v_exp_f32 v226, v130
 v_mfma_f32_16x16x32_bf16 v[144:147], a[152:155], v[64:67], v[144:147]
 s_waitcnt lgkmcnt(4)
 v_cvt_pk_bf16_f32 v160, v224, v225
 v_mfma_f32_16x16x32_bf16 v[144:147], a[156:159], v[80:83], v[144:147]
 v_exp_f32 v227, v131
 v_mfma_f32_16x16x32_bf16 v[148:151], a[152:155], v[68:71], v[148:151]
 ds_read_b64_tr_b16 a[136:137], v23 offset:16384
 ds_read_b64_tr_b16 a[138:139], v23 offset:20480
 v_mfma_f32_16x16x32_bf16 v[148:151], a[156:159], v[84:87], v[148:151]
 v_cvt_pk_bf16_f32 v161, v226, v227
 v_maximum3_f32 v240, v208, v209, v210
 v_mfma_f32_16x16x32_bf16 v[152:155], a[152:155], v[72:75], v[152:155]
 v_maximum3_f32 v240, v240, v211, v211
 v_cmp_nge_f32 vcc, s69, v240
 v_mfma_f32_16x16x32_bf16 v[152:155], a[156:159], v[88:91], v[152:155]
 v_exp_f32 v228, v132
 v_mfma_f32_16x16x32_bf16 v[156:159], a[152:155], v[76:79], v[156:159]
 s_waitcnt lgkmcnt(4)
 ds_read_b64_tr_b16 a[140:141], v23 offset:24576
 ds_read_b64_tr_b16 a[142:143], v23 offset:28672
 v_mfma_f32_16x16x32_bf16 v[156:159], a[156:159], v[92:95], v[156:159]
 s_cbranch_vccnz L_rarep59
L_backp59:
 v_exp_f32 v229, v133
 v_mfma_f32_16x16x32_bf16 a[64:67], a[128:131], v[32:35], a[64:67]
 s_waitcnt lgkmcnt(4)
 v_cvt_pk_bf16_f32 v164, v228, v229
 v_add_f32 v235, v235, v211
 v_mfma_f32_16x16x32_bf16 a[64:67], a[132:135], v[48:51], a[64:67]
 v_exp_f32 v230, v134
 v_mfma_f32_16x16x32_bf16 a[68:71], a[128:131], v[36:39], a[68:71]
 ds_read_b64_tr_b16 a[144:145], v24 offset:16384
 ds_read_b64_tr_b16 a[146:147], v24 offset:20480
 v_mfma_f32_16x16x32_bf16 a[68:71], a[132:135], v[52:55], a[68:71]
 v_exp_f32 v231, v135
 v_mfma_f32_16x16x32_bf16 a[72:75], a[128:131], v[40:43], a[72:75]
 v_cvt_pk_bf16_f32 v165, v230, v231
 v_add_f32 v234, v234, v210
 v_mfma_f32_16x16x32_bf16 a[72:75], a[132:135], v[56:59], a[72:75]
 v_exp_f32 v224, v136
 v_mfma_f32_16x16x32_bf16 a[76:79], a[128:131], v[44:47], a[76:79]
 ds_read_b64_tr_b16 a[148:149], v24 offset:24576
 ds_read_b64_tr_b16 a[150:151], v24 offset:28672
 v_mfma_f32_16x16x32_bf16 a[76:79], a[132:135], v[60:63], a[76:79]
 s_waitcnt lgkmcnt(6)
 v_exp_f32 v225, v137
 v_mfma_f32_16x16x32_bf16 a[80:83], a[136:139], v[32:35], a[80:83]
 s_waitcnt lgkmcnt(4)
 v_cvt_pk_bf16_f32 v168, v224, v225
 v_add_f32 v233, v233, v209
 v_mfma_f32_16x16x32_bf16 a[80:83], a[140:143], v[48:51], a[80:83]
 v_exp_f32 v226, v138
 v_mfma_f32_16x16x32_bf16 a[84:87], a[136:139], v[36:39], a[84:87]
 ds_read_b64_tr_b16 a[152:153], v25 offset:16384
 ds_read_b64_tr_b16 a[154:155], v25 offset:20480
 v_mfma_f32_16x16x32_bf16 a[84:87], a[140:143], v[52:55], a[84:87]
 v_exp_f32 v227, v139
 v_mfma_f32_16x16x32_bf16 a[88:91], a[136:139], v[40:43], a[88:91]
 v_cvt_pk_bf16_f32 v169, v226, v227
 v_add_f32 v232, v232, v208
 v_mfma_f32_16x16x32_bf16 a[88:91], a[140:143], v[56:59], a[88:91]
 v_exp_f32 v228, v140
 v_mfma_f32_16x16x32_bf16 a[92:95], a[136:139], v[44:47], a[92:95]
 ds_read_b64_tr_b16 a[156:157], v25 offset:24576
 ds_read_b64_tr_b16 a[158:159], v25 offset:28672
 v_mfma_f32_16x16x32_bf16 a[92:95], a[140:143], v[60:63], a[92:95]
 s_waitcnt lgkmcnt(6)
 v_exp_f32 v229, v141
 v_mfma_f32_16x16x32_bf16 a[96:99], a[144:147], v[32:35], a[96:99]
 s_waitcnt lgkmcnt(4)
 v_exp_f32 v230, v142
 v_mfma_f32_16x16x32_bf16 a[96:99], a[148:151], v[48:51], a[96:99]
 v_exp_f32 v231, v143
 v_mfma_f32_16x16x32_bf16 a[100:103], a[144:147], v[36:39], a[100:103]
 s_waitcnt vmcnt(4)
 v_cvt_pk_bf16_f32 v172, v228, v229
 v_cvt_pk_bf16_f32 v173, v230, v231
 v_mfma_f32_16x16x32_bf16 a[100:103], a[148:151], v[52:55], a[100:103]
 s_barrier
 v_exp_f32 v224, v144
 v_mfma_f32_16x16x32_bf16 a[104:107], a[144:147], v[40:43], a[104:107]
 ds_read_b128 a[128:131], v14 offset:8192
 v_mfma_f32_16x16x32_bf16 a[104:107], a[148:151], v[56:59], a[104:107]
 s_add_u32 m0, s51, 0x1f000
 v_exp_f32 v225, v145
 v_mfma_f32_16x16x32_bf16 a[108:111], a[144:147], v[44:47], a[108:111]
 s_add_u32 s40, s52, 0
 buffer_load_dwordx4 v2, s[36:39], s40 offen sc1 lds
 v_mfma_f32_16x16x32_bf16 a[108:111], a[148:151], v[60:63], a[108:111]
 s_waitcnt lgkmcnt(3)
 ds_read_b128 a[132:135], v15 offset:8192
 v_cvt_pk_bf16_f32 v162, v224, v225
 v_mfma_f32_16x16x32_bf16 a[112:115], a[152:155], v[32:35], a[112:115]
 s_waitcnt lgkmcnt(2)
 v_exp_f32 v226, v146
 v_mfma_f32_16x16x32_bf16 a[112:115], a[156:159], v[48:51], a[112:115]
 v_exp_f32 v227, v147
 v_mfma_f32_16x16x32_bf16 a[116:119], a[152:155], v[36:39], a[116:119]
 buffer_load_dwordx4 v2, s[36:39], s40 offen offset:1024 sc1 lds
 v_mfma_f32_16x16x32_bf16 a[116:119], a[156:159], v[52:55], a[116:119]
 v_exp_f32 v228, v148
 v_mfma_f32_16x16x32_bf16 a[120:123], a[152:155], v[40:43], a[120:123]
 ds_read_b128 a[136:139], v16 offset:8192
 v_cvt_pk_bf16_f32 v163, v226, v227
 v_mfma_f32_16x16x32_bf16 a[120:123], a[156:159], v[56:59], a[120:123]
 v_exp_f32 v229, v149
 v_mfma_f32_16x16x32_bf16 a[124:127], a[152:155], v[44:47], a[124:127]
 v_exp_f32 v230, v150
 v_mfma_f32_16x16x32_bf16 a[124:127], a[156:159], v[60:63], a[124:127]
 s_waitcnt lgkmcnt(2)
 ds_read_b128 a[140:143], v17 offset:8192
 v_cvt_pk_bf16_f32 v166, v228, v229
 v_mfma_f32_16x16x32_bf16 v[96:99], a[128:131], a[160:163], v[192:195]
 s_waitcnt lgkmcnt(2)
 buffer_load_dwordx4 v2, s[36:39], s40 offen offset:2048 sc1 lds
 v_mfma_f32_16x16x32_bf16 v[96:99], a[132:135], a[176:179], v[96:99]
 v_exp_f32 v231, v151
 v_mfma_f32_16x16x32_bf16 v[100:103], a[128:131], a[164:167], v[196:199]
 v_exp_f32 v224, v152
 v_mfma_f32_16x16x32_bf16 v[100:103], a[132:135], a[180:183], v[100:103]
 v_cvt_pk_bf16_f32 v167, v230, v231
 v_mfma_f32_16x16x32_bf16 v[104:107], a[128:131], a[168:171], v[200:203]
 ds_read_b128 a[144:147], v14 offset:12288
 v_mfma_f32_16x16x32_bf16 v[104:107], a[132:135], a[184:187], v[104:107]
 buffer_load_dwordx4 v2, s[36:39], s40 offen offset:3072 sc1 lds
 v_mfma_f32_16x16x32_bf16 v[108:111], a[128:131], a[172:175], v[204:207]
 v_exp_f32 v225, v153
 v_mfma_f32_16x16x32_bf16 v[108:111], a[132:135], a[188:191], v[108:111]
 s_waitcnt lgkmcnt(2)
 ds_read_b128 a[148:151], v15 offset:12288
 v_cvt_pk_bf16_f32 v170, v224, v225
 v_mfma_f32_16x16x32_bf16 v[96:99], a[136:139], v[64:67], v[96:99]
 s_waitcnt lgkmcnt(2)
 v_exp_f32 v226, v154
 v_mfma_f32_16x16x32_bf16 v[96:99], a[140:143], v[80:83], v[96:99]
 s_add_u32 m0, s51, 0x20000
 v_exp_f32 v227, v155
 v_mfma_f32_16x16x32_bf16 v[100:103], a[136:139], v[68:71], v[100:103]
 s_add_u32 s40, s52, 0x1000
 buffer_load_dwordx4 v2, s[36:39], s40 offen sc1 lds
 v_mfma_f32_16x16x32_bf16 v[100:103], a[140:143], v[84:87], v[100:103]
 v_exp_f32 v228, v156
 v_mfma_f32_16x16x32_bf16 v[104:107], a[136:139], v[72:75], v[104:107]
 v_exp_f32 v229, v157
 v_mfma_f32_16x16x32_bf16 v[104:107], a[140:143], v[88:91], v[104:107]
 v_cvt_pk_bf16_f32 v171, v226, v227
 v_cvt_pk_bf16_f32 v174, v228, v229
 v_mfma_f32_16x16x32_bf16 v[108:111], a[136:139], v[76:79], v[108:111]
 buffer_load_dwordx4 v2, s[36:39], s40 offen offset:1024 sc1 lds
 v_mfma_f32_16x16x32_bf16 v[108:111], a[140:143], v[92:95], v[108:111]
 s_waitcnt lgkmcnt(1)
 v_exp_f32 v230, v158
 v_mfma_f32_16x16x32_bf16 v[112:115], a[144:147], a[160:163], v[192:195]
 s_waitcnt lgkmcnt(0)
 ds_read_b128 a[152:155], v16 offset:12288
 v_mfma_f32_16x16x32_bf16 v[112:115], a[148:151], a[176:179], v[112:115]
 v_exp_f32 v231, v159
 v_mfma_f32_16x16x32_bf16 v[116:119], a[144:147], a[164:167], v[196:199]
 v_cvt_pk_bf16_f32 v175, v230, v231
 v_mfma_f32_16x16x32_bf16 v[116:119], a[148:151], a[180:183], v[116:119]
 ds_read_b128 a[156:159], v17 offset:12288
 v_mfma_f32_16x16x32_bf16 v[120:123], a[144:147], a[168:171], v[200:203]
 buffer_load_dwordx4 v2, s[36:39], s40 offen offset:2048 sc1 lds
 v_mfma_f32_16x16x32_bf16 v[120:123], a[148:151], a[184:187], v[120:123]
 v_mfma_f32_16x16x32_bf16 v[124:127], a[144:147], a[172:175], v[204:207]
 ds_read_b64_tr_b16 a[128:129], v18 offset:24576
 ds_read_b64_tr_b16 a[130:131], v18 offset:28672
 v_mfma_f32_16x16x32_bf16 v[124:127], a[148:151], a[188:191], v[124:127]
 v_mfma_f32_16x16x32_bf16 v[208:211], v[212:215], v[160:163], 0
 buffer_load_dwordx4 v2, s[36:39], s40 offen offset:3072 sc1 lds
 v_mfma_f32_16x16x32_bf16 v[208:211], v[216:219], v[164:167], v[208:211]
 v_exp_f32 v224, v96
 v_mfma_f32_16x16x32_bf16 v[208:211], v[220:223], v[168:171], v[208:211]
 ds_read_b64_tr_b16 a[132:133], v18 offset:32768
 ds_read_b64_tr_b16 a[134:135], v18 offset:36864
 v_mfma_f32_16x16x32_bf16 v[208:211], v[236:239], v[172:175], v[208:211]
 s_waitcnt lgkmcnt(5)
 v_exp_f32 v225, v97
 v_mfma_f32_16x16x32_bf16 v[112:115], a[152:155], v[64:67], v[112:115]
 s_waitcnt lgkmcnt(4)
 v_exp_f32 v226, v98
 v_mfma_f32_16x16x32_bf16 v[112:115], a[156:159], v[80:83], v[112:115]
 s_add_u32 m0, s51, 0x21000
 v_exp_f32 v227, v99
 v_mfma_f32_16x16x32_bf16 v[116:119], a[152:155], v[68:71], v[116:119]
 s_add_u32 s40, s52, 0x2000
 buffer_load_dwordx4 v2, s[36:39], s40 offen sc1 lds
 v_mfma_f32_16x16x32_bf16 v[116:119], a[156:159], v[84:87], v[116:119]
 ds_read_b64_tr_b16 a[136:137], v19 offset:24576
 ds_read_b64_tr_b16 a[138:139], v19 offset:28672
 v_mfma_f32_16x16x32_bf16 v[120:123], a[152:155], v[72:75], v[120:123]
 v_maximum3_f32 v240, v208, v209, v210
 v_maximum3_f32 v240, v240, v211, v211
 v_mfma_f32_16x16x32_bf16 v[120:123], a[156:159], v[88:91], v[120:123]
 s_waitcnt lgkmcnt(4)
 v_cmp_nge_f32 vcc, s69, v240
 v_cvt_pk_bf16_f32 v176, v224, v225
 v_mfma_f32_16x16x32_bf16 v[124:127], a[152:155], v[76:79], v[124:127]
 s_add_u32 s52, s52, 0x9000
 ds_read_b64_tr_b16 a[140:141], v19 offset:32768
 ds_read_b64_tr_b16 a[142:143], v19 offset:36864
 v_mfma_f32_16x16x32_bf16 v[124:127], a[156:159], v[92:95], v[124:127]
 s_sub_u32 s53, 0, s43
 s_cbranch_vccnz L_rarep60
L_backp60:
 v_exp_f32 v228, v100
 v_mfma_f32_16x16x32_bf16 a[0:3], a[128:131], v[48:51], a[0:3]
 s_waitcnt lgkmcnt(4)
 s_and_b32 s53, s53, 3
 v_cvt_pk_bf16_f32 v177, v226, v227
 v_add_f32 v235, v235, v211
 v_mfma_f32_16x16x32_bf16 a[0:3], a[132:135], v[160:163], a[0:3]
 s_lshl_b32 s53, s53, 13
 v_exp_f32 v229, v101
 v_mfma_f32_16x16x32_bf16 a[4:7], a[128:131], v[52:55], a[4:7]
 s_add_u32 s53, s53, s45
 buffer_load_dwordx4 a[192:195], v4, s[28:31], s53 offen sc1
 v_mfma_f32_16x16x32_bf16 a[4:7], a[132:135], v[164:167], a[4:7]
 ds_read_b64_tr_b16 a[144:145], v20 offset:24576
 ds_read_b64_tr_b16 a[146:147], v20 offset:28672
 v_mfma_f32_16x16x32_bf16 a[8:11], a[128:131], v[56:59], a[8:11]
 buffer_load_dwordx4 a[196:199], v5, s[28:31], s53 offen sc1
 v_mfma_f32_16x16x32_bf16 a[8:11], a[132:135], v[168:171], a[8:11]
 v_cvt_pk_bf16_f32 v180, v228, v229
 v_add_f32 v234, v234, v210
 v_mfma_f32_16x16x32_bf16 a[12:15], a[128:131], v[60:63], a[12:15]
 ds_read_b64_tr_b16 a[148:149], v20 offset:32768
 ds_read_b64_tr_b16 a[150:151], v20 offset:36864
 v_mfma_f32_16x16x32_bf16 a[12:15], a[132:135], v[172:175], a[12:15]
 s_waitcnt lgkmcnt(6)
 v_exp_f32 v230, v102
 v_mfma_f32_16x16x32_bf16 a[16:19], a[136:139], v[48:51], a[16:19]
 s_waitcnt lgkmcnt(4)
 buffer_load_dwordx4 a[200:203], v4, s[28:31], s53 offen offset:2048 sc1
 v_mfma_f32_16x16x32_bf16 a[16:19], a[140:143], v[160:163], a[16:19]
 v_exp_f32 v231, v103
 v_mfma_f32_16x16x32_bf16 a[20:23], a[136:139], v[52:55], a[20:23]
 ds_read_b64_tr_b16 a[152:153], v21 offset:24576
 ds_read_b64_tr_b16 a[154:155], v21 offset:28672
 v_mfma_f32_16x16x32_bf16 a[20:23], a[140:143], v[164:167], a[20:23]
 v_cvt_pk_bf16_f32 v181, v230, v231
 v_add_f32 v233, v233, v209
 v_mfma_f32_16x16x32_bf16 a[24:27], a[136:139], v[56:59], a[24:27]
 v_exp_f32 v224, v104
 v_mfma_f32_16x16x32_bf16 a[24:27], a[140:143], v[168:171], a[24:27]
 buffer_load_dwordx4 a[204:207], v5, s[28:31], s53 offen offset:2048 sc1
 v_mfma_f32_16x16x32_bf16 a[28:31], a[136:139], v[60:63], a[28:31]
 ds_read_b64_tr_b16 a[156:157], v21 offset:32768
 ds_read_b64_tr_b16 a[158:159], v21 offset:36864
 v_mfma_f32_16x16x32_bf16 a[28:31], a[140:143], v[172:175], a[28:31]
 s_waitcnt lgkmcnt(6)
 v_exp_f32 v225, v105
 v_mfma_f32_16x16x32_bf16 a[32:35], a[144:147], v[48:51], a[32:35]
 s_waitcnt lgkmcnt(4)
 v_cvt_pk_bf16_f32 v184, v224, v225
 v_add_f32 v232, v232, v208
 v_mfma_f32_16x16x32_bf16 a[32:35], a[148:151], v[160:163], a[32:35]
 v_exp_f32 v226, v106
 v_mfma_f32_16x16x32_bf16 a[36:39], a[144:147], v[52:55], a[36:39]
 s_add_u32 s53, s53, 0x1000
 buffer_load_dwordx4 a[208:211], v4, s[28:31], s53 offen sc1
 v_mfma_f32_16x16x32_bf16 a[36:39], a[148:151], v[164:167], a[36:39]
 v_exp_f32 v227, v107
 v_mfma_f32_16x16x32_bf16 a[40:43], a[144:147], v[56:59], a[40:43]
 ds_read_b128 a[128:131], v14 offset:16384
 v_cvt_pk_bf16_f32 v185, v226, v227
 v_mfma_f32_16x16x32_bf16 a[40:43], a[148:151], v[168:171], a[40:43]
 v_exp_f32 v228, v108
 v_mfma_f32_16x16x32_bf16 a[44:47], a[144:147], v[60:63], a[44:47]
 v_exp_f32 v229, v109
 v_mfma_f32_16x16x32_bf16 a[44:47], a[148:151], v[172:175], a[44:47]
 s_waitcnt lgkmcnt(3)
 ds_read_b128 a[132:135], v15 offset:16384
 v_cvt_pk_bf16_f32 v188, v228, v229
 v_mfma_f32_16x16x32_bf16 a[48:51], a[152:155], v[48:51], a[48:51]
 s_waitcnt lgkmcnt(2)
 buffer_load_dwordx4 a[212:215], v5, s[28:31], s53 offen sc1
 v_mfma_f32_16x16x32_bf16 a[48:51], a[156:159], v[160:163], a[48:51]
 v_exp_f32 v230, v110
 v_mfma_f32_16x16x32_bf16 a[52:55], a[152:155], v[52:55], a[52:55]
 v_exp_f32 v231, v111
 v_mfma_f32_16x16x32_bf16 a[52:55], a[156:159], v[164:167], a[52:55]
 v_exp_f32 v224, v112
 v_mfma_f32_16x16x32_bf16 a[56:59], a[152:155], v[56:59], a[56:59]
 ds_read_b128 a[136:139], v16 offset:16384
 v_cvt_pk_bf16_f32 v189, v230, v231
 v_mfma_f32_16x16x32_bf16 a[56:59], a[156:159], v[168:171], a[56:59]
 buffer_load_dwordx4 a[216:219], v4, s[28:31], s53 offen offset:2048 sc1
 v_mfma_f32_16x16x32_bf16 a[60:63], a[152:155], v[60:63], a[60:63]
 s_barrier
 v_exp_f32 v225, v113
 v_mfma_f32_16x16x32_bf16 a[60:63], a[156:159], v[172:175], a[60:63]
 s_waitcnt lgkmcnt(2)
 ds_read_b128 a[140:143], v17 offset:16384
 v_cvt_pk_bf16_f32 v178, v224, v225
 v_mfma_f32_16x16x32_bf16 v[128:131], a[128:131], a[160:163], v[192:195]
 s_waitcnt lgkmcnt(2)
 v_exp_f32 v226, v114
 v_mfma_f32_16x16x32_bf16 v[128:131], a[132:135], a[176:179], v[128:131]
 buffer_load_dwordx4 a[220:223], v5, s[28:31], s53 offen offset:2048 sc1
 v_mfma_f32_16x16x32_bf16 v[132:135], a[128:131], a[164:167], v[196:199]
 v_exp_f32 v227, v115
 v_mfma_f32_16x16x32_bf16 v[132:135], a[132:135], a[180:183], v[132:135]
 v_exp_f32 v228, v116
 v_mfma_f32_16x16x32_bf16 v[136:139], a[128:131], a[168:171], v[200:203]
 ds_read_b128 a[144:147], v14 offset:20480
 v_cvt_pk_bf16_f32 v179, v226, v227
 v_mfma_f32_16x16x32_bf16 v[136:139], a[132:135], a[184:187], v[136:139]
 s_waitcnt lgkmcnt(2)
 v_exp_f32 v229, v117
 v_mfma_f32_16x16x32_bf16 v[140:143], a[128:131], a[172:175], v[204:207]
 s_add_u32 s53, s53, 0x1000
 v_exp_f32 v230, v118
 v_mfma_f32_16x16x32_bf16 v[140:143], a[132:135], a[188:191], v[140:143]
 s_add_u32 m0, s51, 0
 ds_read_b128 a[148:151], v15 offset:20480
 v_cvt_pk_bf16_f32 v182, v228, v229
 v_mfma_f32_16x16x32_bf16 v[128:131], a[136:139], v[64:67], v[128:131]
 s_waitcnt lgkmcnt(2)
 s_add_u32 s40, s52, 0
 buffer_load_dwordx4 v2, s[36:39], s40 offen sc1 lds
 v_mfma_f32_16x16x32_bf16 v[128:131], a[140:143], v[80:83], v[128:131]
 v_exp_f32 v231, v119
 v_mfma_f32_16x16x32_bf16 v[132:135], a[136:139], v[68:71], v[132:135]
 buffer_load_dwordx4 v2, s[36:39], s40 offen offset:1024 sc1 lds
 v_mfma_f32_16x16x32_bf16 v[132:135], a[140:143], v[84:87], v[132:135]
 v_exp_f32 v224, v120
 v_mfma_f32_16x16x32_bf16 v[136:139], a[136:139], v[72:75], v[136:139]
 v_exp_f32 v225, v121
 v_mfma_f32_16x16x32_bf16 v[136:139], a[140:143], v[88:91], v[136:139]
 v_cvt_pk_bf16_f32 v183, v230, v231
 v_cvt_pk_bf16_f32 v186, v224, v225
 v_mfma_f32_16x16x32_bf16 v[140:143], a[136:139], v[76:79], v[140:143]
 buffer_load_dwordx4 v2, s[36:39], s40 offen offset:2048 sc1 lds
 v_mfma_f32_16x16x32_bf16 v[140:143], a[140:143], v[92:95], v[140:143]
 s_waitcnt lgkmcnt(1)
 v_exp_f32 v226, v122
 v_mfma_f32_16x16x32_bf16 v[144:147], a[144:147], a[160:163], v[192:195]
 s_waitcnt lgkmcnt(0)
 ds_read_b128 a[152:155], v16 offset:20480
 v_mfma_f32_16x16x32_bf16 v[144:147], a[148:151], a[176:179], v[144:147]
 v_exp_f32 v227, v123
 v_mfma_f32_16x16x32_bf16 v[148:151], a[144:147], a[164:167], v[196:199]
 buffer_load_dwordx4 v2, s[36:39], s40 offen offset:3072 sc1 lds
 v_mfma_f32_16x16x32_bf16 v[148:151], a[148:151], a[180:183], v[148:151]
 ds_read_b128 a[156:159], v17 offset:20480
 v_cvt_pk_bf16_f32 v187, v226, v227
 v_mfma_f32_16x16x32_bf16 v[152:155], a[144:147], a[168:171], v[200:203]
 v_exp_f32 v228, v124
 v_mfma_f32_16x16x32_bf16 v[152:155], a[148:151], a[184:187], v[152:155]
 v_exp_f32 v229, v125
 v_mfma_f32_16x16x32_bf16 v[156:159], a[144:147], a[172:175], v[204:207]
 s_add_u32 m0, s51, 0x1000
 ds_read_b64_tr_b16 a[128:129], v22 offset:32768
 ds_read_b64_tr_b16 a[130:131], v22 offset:36864
 v_cvt_pk_bf16_f32 v190, v228, v229
 v_exp_f32 v230, v126
 v_exp_f32 v231, v127
 s_nop 0
 v_cvt_pk_bf16_f32 v191, v230, v231
 v_mfma_f32_16x16x32_bf16 v[156:159], a[148:151], a[188:191], v[156:159]
 s_add_u32 s40, s52, 0x1000
 buffer_load_dwordx4 v2, s[36:39], s40 offen sc1 lds
 v_mfma_f32_16x16x32_bf16 v[208:211], v[212:215], v[176:179], 0
 v_exp_f32 v224, v128
 v_mfma_f32_16x16x32_bf16 v[208:211], v[216:219], v[180:183], v[208:211]
 v_exp_f32 v225, v129
 v_mfma_f32_16x16x32_bf16 v[208:211], v[220:223], v[184:187], v[208:211]
 ds_read_b64_tr_b16 a[132:133], v22 offset:40960
 ds_read_b64_tr_b16 a[134:135], v22 offset:45056
 v_mfma_f32_16x16x32_bf16 v[208:211], v[236:239], v[188:191], v[208:211]
 s_waitcnt lgkmcnt(5)
 buffer_load_dwordx4 v2, s[36:39], s40 offen offset:1024 sc1 lds
 v_mfma_f32_16x16x32_bf16 v[144:147], a[152:155], v[64:67], v[144:147]
 s_waitcnt lgkmcnt(4)
 v_exp_f32 v226, v130
 v_mfma_f32_16x16x32_bf16 v[144:147], a[156:159], v[80:83], v[144:147]
 v_exp_f32 v227, v131
 v_mfma_f32_16x16x32_bf16 v[148:151], a[152:155], v[68:71], v[148:151]
 ds_read_b64_tr_b16 a[136:137], v23 offset:32768
 ds_read_b64_tr_b16 a[138:139], v23 offset:36864
 v_mfma_f32_16x16x32_bf16 v[148:151], a[156:159], v[84:87], v[148:151]
 buffer_load_dwordx4 v2, s[36:39], s40 offen offset:2048 sc1 lds
 v_mfma_f32_16x16x32_bf16 v[152:155], a[152:155], v[72:75], v[152:155]
 v_maximum3_f32 v240, v208, v209, v210
 v_maximum3_f32 v240, v240, v211, v211
 v_mfma_f32_16x16x32_bf16 v[152:155], a[156:159], v[88:91], v[152:155]
 v_cmp_nge_f32 vcc, s69, v240
 v_cvt_pk_bf16_f32 v32, v224, v225
 v_mfma_f32_16x16x32_bf16 v[156:159], a[152:155], v[76:79], v[156:159]
 s_waitcnt lgkmcnt(4)
 ds_read_b64_tr_b16 a[140:141], v23 offset:40960
 ds_read_b64_tr_b16 a[142:143], v23 offset:45056
 v_mfma_f32_16x16x32_bf16 v[156:159], a[156:159], v[92:95], v[156:159]
 s_cbranch_vccnz L_rarep61
L_backp61:
 buffer_load_dwordx4 v2, s[36:39], s40 offen offset:3072 sc1 lds
 v_mfma_f32_16x16x32_bf16 a[64:67], a[128:131], v[160:163], a[64:67]
 s_waitcnt lgkmcnt(4)
 v_cvt_pk_bf16_f32 v33, v226, v227
 v_add_f32 v235, v235, v211
 v_mfma_f32_16x16x32_bf16 a[64:67], a[132:135], v[176:179], a[64:67]
 v_exp_f32 v228, v132
 v_mfma_f32_16x16x32_bf16 a[68:71], a[128:131], v[164:167], a[68:71]
 s_add_u32 m0, s51, 0x2000
 ds_read_b64_tr_b16 a[144:145], v24 offset:32768
 ds_read_b64_tr_b16 a[146:147], v24 offset:36864
 v_mfma_f32_16x16x32_bf16 a[68:71], a[132:135], v[180:183], a[68:71]
 s_add_u32 s40, s52, 0x2000
 buffer_load_dwordx4 v2, s[36:39], s40 offen sc1 lds
 v_mfma_f32_16x16x32_bf16 a[72:75], a[128:131], v[168:171], a[72:75]
 v_exp_f32 v229, v133
 v_mfma_f32_16x16x32_bf16 a[72:75], a[132:135], v[184:187], a[72:75]
 s_waitcnt lgkmcnt(4)
 v_cvt_pk_bf16_f32 v36, v228, v229
 v_add_f32 v234, v234, v210
 v_mfma_f32_16x16x32_bf16 a[76:79], a[128:131], v[172:175], a[76:79]
 s_add_u32 s52, s52, 0x9000
 ds_read_b64_tr_b16 a[148:149], v24 offset:40960
 ds_read_b64_tr_b16 a[150:151], v24 offset:45056
 v_mfma_f32_16x16x32_bf16 a[76:79], a[132:135], v[188:191], a[76:79]
 s_sub_u32 s53, 1, s43
 v_exp_f32 v230, v134
 v_mfma_f32_16x16x32_bf16 a[80:83], a[136:139], v[160:163], a[80:83]
 s_waitcnt lgkmcnt(4)
 s_and_b32 s53, s53, 3
 v_exp_f32 v231, v135
 v_mfma_f32_16x16x32_bf16 a[80:83], a[140:143], v[176:179], a[80:83]
 s_lshl_b32 s53, s53, 13
 v_cvt_pk_bf16_f32 v37, v230, v231
 v_add_f32 v233, v233, v209
 v_mfma_f32_16x16x32_bf16 a[84:87], a[136:139], v[164:167], a[84:87]
 s_add_u32 s53, s53, s45
 buffer_load_dwordx4 a[224:227], v4, s[28:31], s53 offen sc1
 v_mfma_f32_16x16x32_bf16 a[84:87], a[140:143], v[180:183], a[84:87]
 ds_read_b64_tr_b16 a[152:153], v25 offset:32768
 ds_read_b64_tr_b16 a[154:155], v25 offset:36864
 v_mfma_f32_16x16x32_bf16 a[88:91], a[136:139], v[168:171], a[88:91]
 buffer_load_dwordx4 a[228:231], v5, s[28:31], s53 offen sc1
 v_mfma_f32_16x16x32_bf16 a[88:91], a[140:143], v[184:187], a[88:91]
 v_exp_f32 v224, v136
 v_mfma_f32_16x16x32_bf16 a[92:95], a[136:139], v[172:175], a[92:95]
 ds_read_b64_tr_b16 a[156:157], v25 offset:40960
 ds_read_b64_tr_b16 a[158:159], v25 offset:45056
 v_mfma_f32_16x16x32_bf16 a[92:95], a[140:143], v[188:191], a[92:95]
 s_waitcnt lgkmcnt(6)
 buffer_load_dwordx4 a[232:235], v4, s[28:31], s53 offen offset:2048 sc1
 v_mfma_f32_16x16x32_bf16 a[96:99], a[144:147], v[160:163], a[96:99]
 s_waitcnt lgkmcnt(4)
 v_exp_f32 v225, v137
 v_mfma_f32_16x16x32_bf16 a[96:99], a[148:151], v[176:179], a[96:99]
 v_cvt_pk_bf16_f32 v40, v224, v225
 v_add_f32 v232, v232, v208
 v_mfma_f32_16x16x32_bf16 a[100:103], a[144:147], v[164:167], a[100:103]
 s_waitcnt vmcnt(29)
 buffer_load_dwordx4 a[236:239], v5, s[28:31], s53 offen offset:2048 sc1
 v_mfma_f32_16x16x32_bf16 a[100:103], a[148:151], v[180:183], a[100:103]
 s_barrier
 v_exp_f32 v226, v138
 v_mfma_f32_16x16x32_bf16 a[104:107], a[144:147], v[168:171], a[104:107]
 ds_read_b128 a[128:131], v14 offset:24576
 v_mfma_f32_16x16x32_bf16 a[104:107], a[148:151], v[184:187], a[104:107]
 v_exp_f32 v227, v139
 v_mfma_f32_16x16x32_bf16 a[108:111], a[144:147], v[172:175], a[108:111]
 s_add_u32 s53, s53, 0x1000
 buffer_load_dwordx4 a[240:243], v4, s[28:31], s53 offen sc1
 v_mfma_f32_16x16x32_bf16 a[108:111], a[148:151], v[188:191], a[108:111]
 s_waitcnt lgkmcnt(3)
 ds_read_b128 a[132:135], v15 offset:24576
 v_cvt_pk_bf16_f32 v41, v226, v227
 v_mfma_f32_16x16x32_bf16 a[112:115], a[152:155], v[160:163], a[112:115]
 s_waitcnt lgkmcnt(2)
 v_exp_f32 v228, v140
 v_mfma_f32_16x16x32_bf16 a[112:115], a[156:159], v[176:179], a[112:115]
 v_exp_f32 v229, v141
 v_mfma_f32_16x16x32_bf16 a[116:119], a[152:155], v[164:167], a[116:119]
 buffer_load_dwordx4 a[244:247], v5, s[28:31], s53 offen sc1
 v_mfma_f32_16x16x32_bf16 a[116:119], a[156:159], v[180:183], a[116:119]
 v_exp_f32 v230, v142
 v_mfma_f32_16x16x32_bf16 a[120:123], a[152:155], v[168:171], a[120:123]
 ds_read_b128 a[136:139], v16 offset:24576
 v_cvt_pk_bf16_f32 v44, v228, v229
 v_mfma_f32_16x16x32_bf16 a[120:123], a[156:159], v[184:187], a[120:123]
 v_exp_f32 v231, v143
 v_mfma_f32_16x16x32_bf16 a[124:127], a[152:155], v[172:175], a[124:127]
 buffer_load_dwordx4 a[248:251], v4, s[28:31], s53 offen offset:2048 sc1
 v_mfma_f32_16x16x32_bf16 a[124:127], a[156:159], v[188:191], a[124:127]
 s_waitcnt lgkmcnt(2)
 ds_read_b128 a[140:143], v17 offset:24576
 v_cvt_pk_bf16_f32 v45, v230, v231
 v_mfma_f32_16x16x32_bf16 v[96:99], a[128:131], a[160:163], v[192:195]
 s_waitcnt lgkmcnt(2)
 v_exp_f32 v224, v144
 v_mfma_f32_16x16x32_bf16 v[96:99], a[132:135], a[176:179], v[96:99]
 v_exp_f32 v225, v145
 v_mfma_f32_16x16x32_bf16 v[100:103], a[128:131], a[164:167], v[196:199]
 buffer_load_dwordx4 a[252:255], v5, s[28:31], s53 offen offset:2048 sc1
 v_mfma_f32_16x16x32_bf16 v[100:103], a[132:135], a[180:183], v[100:103]
 v_exp_f32 v226, v146
 v_mfma_f32_16x16x32_bf16 v[104:107], a[128:131], a[168:171], v[200:203]
 ds_read_b128 a[144:147], v14 offset:28672
 v_cvt_pk_bf16_f32 v34, v224, v225
 v_mfma_f32_16x16x32_bf16 v[104:107], a[132:135], a[184:187], v[104:107]
 s_waitcnt lgkmcnt(2)
 v_exp_f32 v227, v147
 v_mfma_f32_16x16x32_bf16 v[108:111], a[128:131], a[172:175], v[204:207]
 s_add_u32 s53, s53, 0x1000
 v_exp_f32 v228, v148
 v_mfma_f32_16x16x32_bf16 v[108:111], a[132:135], a[188:191], v[108:111]
 s_add_u32 m0, s51, 0x12000
 ds_read_b128 a[148:151], v15 offset:28672
 v_cvt_pk_bf16_f32 v35, v226, v227
 v_mfma_f32_16x16x32_bf16 v[96:99], a[136:139], v[64:67], v[96:99]
 s_waitcnt lgkmcnt(2)
 s_add_u32 s40, s52, 0
 buffer_load_dwordx4 v2, s[36:39], s40 offen sc1 lds
 v_mfma_f32_16x16x32_bf16 v[96:99], a[140:143], v[80:83], v[96:99]
 v_exp_f32 v229, v149
 v_mfma_f32_16x16x32_bf16 v[100:103], a[136:139], v[68:71], v[100:103]
 buffer_load_dwordx4 v2, s[36:39], s40 offen offset:1024 sc1 lds
 v_mfma_f32_16x16x32_bf16 v[100:103], a[140:143], v[84:87], v[100:103]
 v_exp_f32 v230, v150
 v_mfma_f32_16x16x32_bf16 v[104:107], a[136:139], v[72:75], v[104:107]
 v_exp_f32 v231, v151
 v_mfma_f32_16x16x32_bf16 v[104:107], a[140:143], v[88:91], v[104:107]
 v_cvt_pk_bf16_f32 v38, v228, v229
 v_cvt_pk_bf16_f32 v39, v230, v231
 v_mfma_f32_16x16x32_bf16 v[108:111], a[136:139], v[76:79], v[108:111]
 buffer_load_dwordx4 v2, s[36:39], s40 offen offset:2048 sc1 lds
 v_mfma_f32_16x16x32_bf16 v[108:111], a[140:143], v[92:95], v[108:111]
 s_waitcnt lgkmcnt(1)
 v_exp_f32 v224, v152
 v_mfma_f32_16x16x32_bf16 v[112:115], a[144:147], a[160:163], v[192:195]
 s_waitcnt lgkmcnt(0)
 ds_read_b128 a[152:155], v16 offset:28672
 v_mfma_f32_16x16x32_bf16 v[112:115], a[148:151], a[176:179], v[112:115]
 v_exp_f32 v225, v153
 v_mfma_f32_16x16x32_bf16 v[116:119], a[144:147], a[164:167], v[196:199]
 buffer_load_dwordx4 v2, s[36:39], s40 offen offset:3072 sc1 lds
 v_mfma_f32_16x16x32_bf16 v[116:119], a[148:151], a[180:183], v[116:119]
 ds_read_b128 a[156:159], v17 offset:28672
 v_cvt_pk_bf16_f32 v42, v224, v225
 v_mfma_f32_16x16x32_bf16 v[120:123], a[144:147], a[168:171], v[200:203]
 v_exp_f32 v226, v154
 v_mfma_f32_16x16x32_bf16 v[120:123], a[148:151], a[184:187], v[120:123]
 v_exp_f32 v227, v155
 v_mfma_f32_16x16x32_bf16 v[124:127], a[144:147], a[172:175], v[204:207]
 s_add_u32 m0, s51, 0x13000
 ds_read_b64_tr_b16 a[128:129], v18 offset:40960
 ds_read_b64_tr_b16 a[130:131], v18 offset:45056
 v_cvt_pk_bf16_f32 v43, v226, v227
 v_exp_f32 v228, v156
 v_exp_f32 v229, v157
 s_nop 0
 v_cvt_pk_bf16_f32 v46, v228, v229
 v_exp_f32 v230, v158
 v_exp_f32 v231, v159
 s_nop 0
 v_cvt_pk_bf16_f32 v47, v230, v231
 v_mfma_f32_16x16x32_bf16 v[124:127], a[148:151], a[188:191], v[124:127]
 s_add_u32 s40, s52, 0x1000
 buffer_load_dwordx4 v2, s[36:39], s40 offen sc1 lds
 v_mfma_f32_16x16x32_bf16 v[208:211], v[212:215], v[32:35], 0
 v_exp_f32 v224, v96
 v_mfma_f32_16x16x32_bf16 v[208:211], v[216:219], v[36:39], v[208:211]
 v_exp_f32 v225, v97
 v_mfma_f32_16x16x32_bf16 v[208:211], v[220:223], v[40:43], v[208:211]
 ds_read_b64_tr_b16 a[132:133], v18 offset:49152
 ds_read_b64_tr_b16 a[134:135], v18 offset:53248
 v_mfma_f32_16x16x32_bf16 v[208:211], v[236:239], v[44:47], v[208:211]
 s_waitcnt lgkmcnt(5)
 buffer_load_dwordx4 v2, s[36:39], s40 offen offset:1024 sc1 lds
 v_mfma_f32_16x16x32_bf16 v[112:115], a[152:155], v[64:67], v[112:115]
 s_waitcnt lgkmcnt(4)
 v_exp_f32 v226, v98
 v_mfma_f32_16x16x32_bf16 v[112:115], a[156:159], v[80:83], v[112:115]
 v_exp_f32 v227, v99
 v_mfma_f32_16x16x32_bf16 v[116:119], a[152:155], v[68:71], v[116:119]
 ds_read_b64_tr_b16 a[136:137], v19 offset:40960
 ds_read_b64_tr_b16 a[138:139], v19 offset:45056
 v_mfma_f32_16x16x32_bf16 v[116:119], a[156:159], v[84:87], v[116:119]
 buffer_load_dwordx4 v2, s[36:39], s40 offen offset:2048 sc1 lds
 v_mfma_f32_16x16x32_bf16 v[120:123], a[152:155], v[72:75], v[120:123]
 v_maximum3_f32 v240, v208, v209, v210
 v_maximum3_f32 v240, v240, v211, v211
 v_mfma_f32_16x16x32_bf16 v[120:123], a[156:159], v[88:91], v[120:123]
 v_cmp_nge_f32 vcc, s69, v240
 v_cvt_pk_bf16_f32 v48, v224, v225
 v_mfma_f32_16x16x32_bf16 v[124:127], a[152:155], v[76:79], v[124:127]
 s_waitcnt lgkmcnt(4)
 ds_read_b64_tr_b16 a[140:141], v19 offset:49152
 ds_read_b64_tr_b16 a[142:143], v19 offset:53248
 v_mfma_f32_16x16x32_bf16 v[124:127], a[156:159], v[92:95], v[124:127]
 s_cbranch_vccnz L_rarep62
L_backp62:
 buffer_load_dwordx4 v2, s[36:39], s40 offen offset:3072 sc1 lds
 v_mfma_f32_16x16x32_bf16 a[0:3], a[128:131], v[176:179], a[0:3]
 s_waitcnt lgkmcnt(4)
 v_cvt_pk_bf16_f32 v49, v226, v227
 v_add_f32 v235, v235, v211
 v_mfma_f32_16x16x32_bf16 a[0:3], a[132:135], v[32:35], a[0:3]
 v_exp_f32 v228, v100
 v_mfma_f32_16x16x32_bf16 a[4:7], a[128:131], v[180:183], a[4:7]
 s_add_u32 m0, s51, 0x14000
 ds_read_b64_tr_b16 a[144:145], v20 offset:40960
 ds_read_b64_tr_b16 a[146:147], v20 offset:45056
 v_mfma_f32_16x16x32_bf16 a[4:7], a[132:135], v[36:39], a[4:7]
 s_add_u32 s40, s52, 0x2000
 buffer_load_dwordx4 v2, s[36:39], s40 offen sc1 lds
 v_mfma_f32_16x16x32_bf16 a[8:11], a[128:131], v[184:187], a[8:11]
 v_exp_f32 v229, v101
 v_mfma_f32_16x16x32_bf16 a[8:11], a[132:135], v[40:43], a[8:11]
 s_waitcnt lgkmcnt(4)
 v_cvt_pk_bf16_f32 v52, v228, v229
 v_add_f32 v234, v234, v210
 v_mfma_f32_16x16x32_bf16 a[12:15], a[128:131], v[188:191], a[12:15]
 s_add_u32 s52, s52, 0x9000
 ds_read_b64_tr_b16 a[148:149], v20 offset:49152
 ds_read_b64_tr_b16 a[150:151], v20 offset:53248
 v_mfma_f32_16x16x32_bf16 a[12:15], a[132:135], v[44:47], a[12:15]
 s_sub_u32 s53, 2, s43
 v_exp_f32 v230, v102
 v_mfma_f32_16x16x32_bf16 a[16:19], a[136:139], v[176:179], a[16:19]
 s_waitcnt lgkmcnt(4)
 s_and_b32 s53, s53, 3
 v_exp_f32 v231, v103
 v_mfma_f32_16x16x32_bf16 a[16:19], a[140:143], v[32:35], a[16:19]
 s_lshl_b32 s53, s53, 13
 v_cvt_pk_bf16_f32 v53, v230, v231
 v_add_f32 v233, v233, v209
 v_mfma_f32_16x16x32_bf16 a[20:23], a[136:139], v[180:183], a[20:23]
 s_add_u32 s53, s53, s45
 buffer_load_dwordx4 a[160:163], v4, s[28:31], s53 offen sc1
 v_mfma_f32_16x16x32_bf16 a[20:23], a[140:143], v[36:39], a[20:23]
 ds_read_b64_tr_b16 a[152:153], v21 offset:40960
 ds_read_b64_tr_b16 a[154:155], v21 offset:45056
 v_mfma_f32_16x16x32_bf16 a[24:27], a[136:139], v[184:187], a[24:27]
 buffer_load_dwordx4 a[164:167], v5, s[28:31], s53 offen sc1
 v_mfma_f32_16x16x32_bf16 a[24:27], a[140:143], v[40:43], a[24:27]
 v_exp_f32 v224, v104
 v_mfma_f32_16x16x32_bf16 a[28:31], a[136:139], v[188:191], a[28:31]
 ds_read_b64_tr_b16 a[156:157], v21 offset:49152
 ds_read_b64_tr_b16 a[158:159], v21 offset:53248
 v_mfma_f32_16x16x32_bf16 a[28:31], a[140:143], v[44:47], a[28:31]
 s_waitcnt lgkmcnt(6)
 buffer_load_dwordx4 a[168:171], v4, s[28:31], s53 offen offset:2048 sc1
 v_mfma_f32_16x16x32_bf16 a[32:35], a[144:147], v[176:179], a[32:35]
 s_waitcnt lgkmcnt(4)
 v_exp_f32 v225, v105
 v_mfma_f32_16x16x32_bf16 a[32:35], a[148:151], v[32:35], a[32:35]
 v_cvt_pk_bf16_f32 v56, v224, v225
 v_add_f32 v232, v232, v208
 v_mfma_f32_16x16x32_bf16 a[36:39], a[144:147], v[180:183], a[36:39]
 buffer_load_dwordx4 a[172:175], v5, s[28:31], s53 offen offset:2048 sc1
 v_mfma_f32_16x16x32_bf16 a[36:39], a[148:151], v[36:39], a[36:39]
 v_exp_f32 v226, v106
 v_mfma_f32_16x16x32_bf16 a[40:43], a[144:147], v[184:187], a[40:43]
 v_exp_f32 v227, v107
 v_mfma_f32_16x16x32_bf16 a[40:43], a[148:151], v[40:43], a[40:43]
 v_exp_f32 v228, v108
 v_mfma_f32_16x16x32_bf16 a[44:47], a[144:147], v[188:191], a[44:47]
 s_add_u32 s53, s53, 0x1000
 buffer_load_dwordx4 a[176:179], v4, s[28:31], s53 offen sc1
 v_mfma_f32_16x16x32_bf16 a[44:47], a[148:151], v[44:47], a[44:47]
 s_waitcnt lgkmcnt(2)
 ds_read_b64_tr_b16 a[128:129], v22 offset:49152
 ds_read_b64_tr_b16 a[130:131], v22 offset:53248
 v_mfma_f32_16x16x32_bf16 a[48:51], a[152:155], v[176:179], a[48:51]
 s_waitcnt lgkmcnt(2)
 v_exp_f32 v229, v109
 v_mfma_f32_16x16x32_bf16 a[48:51], a[156:159], v[32:35], a[48:51]
 v_cvt_pk_bf16_f32 v57, v226, v227
 v_cvt_pk_bf16_f32 v60, v228, v229
 v_mfma_f32_16x16x32_bf16 a[52:55], a[152:155], v[180:183], a[52:55]
 buffer_load_dwordx4 a[180:183], v5, s[28:31], s53 offen sc1
 v_mfma_f32_16x16x32_bf16 a[52:55], a[156:159], v[36:39], a[52:55]
 ds_read_b64_tr_b16 a[132:133], v22 offset:57344
 ds_read_b64_tr_b16 a[134:135], v22 offset:61440
 v_mfma_f32_16x16x32_bf16 a[56:59], a[152:155], v[184:187], a[56:59]
 v_exp_f32 v230, v110
 v_mfma_f32_16x16x32_bf16 a[56:59], a[156:159], v[40:43], a[56:59]
 v_exp_f32 v231, v111
 v_mfma_f32_16x16x32_bf16 a[60:63], a[152:155], v[188:191], a[60:63]
 buffer_load_dwordx4 a[184:187], v4, s[28:31], s53 offen offset:2048 sc1
 v_mfma_f32_16x16x32_bf16 a[60:63], a[156:159], v[44:47], a[60:63]
 v_exp_f32 v224, v112
 ds_read_b64_tr_b16 a[136:137], v23 offset:49152
 ds_read_b64_tr_b16 a[138:139], v23 offset:53248
 ds_read_b64_tr_b16 a[140:141], v23 offset:57344
 ds_read_b64_tr_b16 a[142:143], v23 offset:61440
 ds_read_b64_tr_b16 a[144:145], v24 offset:49152
 ds_read_b64_tr_b16 a[146:147], v24 offset:53248
 ds_read_b64_tr_b16 a[148:149], v24 offset:57344
 ds_read_b64_tr_b16 a[150:151], v24 offset:61440
 ds_read_b64_tr_b16 a[152:153], v25 offset:49152
 ds_read_b64_tr_b16 a[154:155], v25 offset:53248
 ds_read_b64_tr_b16 a[156:157], v25 offset:57344
 ds_read_b64_tr_b16 a[158:159], v25 offset:61440
 v_cvt_pk_bf16_f32 v61, v230, v231
 v_exp_f32 v225, v113
 s_nop 0
 v_cvt_pk_bf16_f32 v50, v224, v225
 v_exp_f32 v226, v114
 v_exp_f32 v227, v115
 s_nop 0
 v_cvt_pk_bf16_f32 v51, v226, v227
 v_exp_f32 v228, v116
 v_exp_f32 v229, v117
 s_nop 0
 v_cvt_pk_bf16_f32 v54, v228, v229
 v_exp_f32 v230, v118
 v_exp_f32 v231, v119
 s_nop 0
 v_cvt_pk_bf16_f32 v55, v230, v231
 v_exp_f32 v224, v120
 buffer_load_dwordx4 a[188:191], v5, s[28:31], s53 offen offset:2048 sc1
 v_exp_f32 v225, v121
 s_nop 0
 v_cvt_pk_bf16_f32 v58, v224, v225
 v_exp_f32 v226, v122
 s_add_u32 s53, s53, 0x1000
 v_exp_f32 v227, v123
 s_nop 0
 v_cvt_pk_bf16_f32 v59, v226, v227
 v_exp_f32 v228, v124
 v_exp_f32 v229, v125
 s_nop 0
 v_cvt_pk_bf16_f32 v62, v228, v229
 v_exp_f32 v230, v126
 v_exp_f32 v231, v127
 s_nop 0
 v_cvt_pk_bf16_f32 v63, v230, v231
 v_mfma_f32_16x16x32_bf16 v[208:211], v[212:215], v[48:51], 0
 v_mfma_f32_16x16x32_bf16 v[208:211], v[216:219], v[52:55], v[208:211]
 v_mfma_f32_16x16x32_bf16 v[208:211], v[220:223], v[56:59], v[208:211]
 v_mfma_f32_16x16x32_bf16 v[208:211], v[236:239], v[60:63], v[208:211]
 s_waitcnt lgkmcnt(12)
 s_nop 6
 v_maximum3_f32 v240, v208, v209, v210
 v_maximum3_f32 v240, v240, v211, v211
 v_cmp_nge_f32 vcc, s69, v240
 s_nop 1
 s_cbranch_vccnz L_rare_last
L_back_last:
 v_add_f32 v232, v232, v208
 v_add_f32 v233, v233, v209
 v_add_f32 v234, v234, v210
 v_add_f32 v235, v235, v211
 v_rcp_f32 v232, v232
 v_rcp_f32 v233, v233
 v_rcp_f32 v234, v234
 v_rcp_f32 v235, v235
 v_mfma_f32_16x16x32_bf16 a[64:67], a[128:131], v[32:35], a[64:67]
 s_sub_u32 s53, 3, s43
 v_mfma_f32_16x16x32_bf16 a[64:67], a[132:135], v[48:51], a[64:67]
 s_and_b32 s53, s53, 3
 v_mfma_f32_16x16x32_bf16 a[68:71], a[128:131], v[36:39], a[68:71]
 s_lshl_b32 s53, s53, 13
 v_and_b32 v246, 15, v1
 v_lshlrev_b32 v246, 7, v246
 v_mfma_f32_16x16x32_bf16 a[68:71], a[132:135], v[52:55], a[68:71]
 s_add_u32 s53, s53, s45
 buffer_load_dwordx4 v[128:131], v4, s[28:31], s53 offen sc1
 v_mfma_f32_16x16x32_bf16 a[72:75], a[128:131], v[40:43], a[72:75]
 s_getpc_b64 s[62:63]
L_pcT:
 s_add_u32 s62, s62, L_pcT+2048-L_pcT
 s_addc_u32 s63, s63, 0
 v_mfma_f32_16x16x32_bf16 a[72:75], a[132:135], v[56:59], a[72:75]
 s_bfe_u32 s18, s2, 0x10003
 v_mfma_f32_16x16x32_bf16 a[76:79], a[128:131], v[44:47], a[76:79]
 s_lshl_b32 s18, s18, 2
 v_mfma_f32_16x16x32_bf16 a[76:79], a[132:135], v[60:63], a[76:79]
 s_waitcnt lgkmcnt(8)
 s_add_u32 s18, s18, s3
 v_mfma_f32_16x16x32_bf16 a[80:83], a[136:139], v[32:35], a[80:83]
 s_lshl_b32 s18, s18, 11
 ds_read_b64_tr_b16 a[128:129], v18 offset:57344
 ds_read_b64_tr_b16 a[130:131], v18 offset:61440
 v_mfma_f32_16x16x32_bf16 a[80:83], a[140:143], v[48:51], a[80:83]
 s_add_u32 s62, s62, s18
 s_addc_u32 s63, s63, 0
 v_mov_b32 v247, s63
 v_mfma_f32_16x16x32_bf16 a[84:87], a[136:139], v[36:39], a[84:87]
 v_add_co_u32 v246, vcc, s62, v246
 s_nop 1
 v_addc_co_u32 v247, vcc, 0, v247, vcc
 v_mfma_f32_16x16x32_bf16 a[84:87], a[140:143], v[52:55], a[84:87]
 global_load_dword v250, v[246:247], off
 v_mfma_f32_16x16x32_bf16 a[88:91], a[136:139], v[40:43], a[88:91]
 buffer_load_dwordx4 v[132:135], v5, s[28:31], s53 offen sc1
 v_mfma_f32_16x16x32_bf16 a[88:91], a[140:143], v[56:59], a[88:91]
 buffer_load_dwordx4 v[136:139], v4, s[28:31], s53 offen offset:2048 sc1
 v_mfma_f32_16x16x32_bf16 a[92:95], a[136:139], v[44:47], a[92:95]
 s_waitcnt lgkmcnt(8)
 buffer_load_dwordx4 v[140:143], v5, s[28:31], s53 offen offset:2048 sc1
 v_mfma_f32_16x16x32_bf16 a[92:95], a[140:143], v[60:63], a[92:95]
 s_add_u32 s53, s53, 0x1000
 ds_read_b64_tr_b16 a[132:133], v19 offset:57344
 ds_read_b64_tr_b16 a[134:135], v19 offset:61440
 v_mfma_f32_16x16x32_bf16 a[96:99], a[144:147], v[32:35], a[96:99]
 s_waitcnt lgkmcnt(8)
 buffer_load_dwordx4 v[144:147], v4, s[28:31], s53 offen sc1
 v_mfma_f32_16x16x32_bf16 a[96:99], a[148:151], v[48:51], a[96:99]
 buffer_load_dwordx4 v[148:151], v5, s[28:31], s53 offen sc1
 v_mfma_f32_16x16x32_bf16 a[100:103], a[144:147], v[36:39], a[100:103]
 ds_read_b64_tr_b16 a[136:137], v20 offset:57344
 ds_read_b64_tr_b16 a[138:139], v20 offset:61440
 v_mfma_f32_16x16x32_bf16 a[100:103], a[148:151], v[52:55], a[100:103]
 ds_read_b64_tr_b16 a[140:141], v21 offset:57344
 ds_read_b64_tr_b16 a[142:143], v21 offset:61440
 v_mfma_f32_16x16x32_bf16 a[104:107], a[144:147], v[40:43], a[104:107]
 buffer_load_dwordx4 v[152:155], v4, s[28:31], s53 offen offset:2048 sc1
 v_mfma_f32_16x16x32_bf16 a[104:107], a[148:151], v[56:59], a[104:107]
 buffer_load_dwordx4 v[156:159], v5, s[28:31], s53 offen offset:2048 sc1
 v_mfma_f32_16x16x32_bf16 a[108:111], a[144:147], v[44:47], a[108:111]
 v_accvgpr_read_b32 v160, a64
 v_mul_f32 v160, v160, v232
 v_mfma_f32_16x16x32_bf16 a[108:111], a[148:151], v[60:63], a[108:111]
 s_waitcnt lgkmcnt(8)
 v_accvgpr_read_b32 v161, a65
 v_mul_f32 v161, v161, v232
 v_mfma_f32_16x16x32_bf16 a[112:115], a[152:155], v[32:35], a[112:115]
 s_add_u32 s53, s53, 0x1000
 v_accvgpr_read_b32 v162, a66
 v_mul_f32 v162, v162, v232
 v_mfma_f32_16x16x32_bf16 a[112:115], a[156:159], v[48:51], a[112:115]
 v_accvgpr_read_b32 v163, a67
 v_mul_f32 v163, v163, v232
 v_mfma_f32_16x16x32_bf16 a[116:119], a[152:155], v[36:39], a[116:119]
 v_cvt_pk_bf16_f32 v96, v160, v161
 v_cvt_pk_bf16_f32 v97, v162, v163
 v_mfma_f32_16x16x32_bf16 a[116:119], a[156:159], v[52:55], a[116:119]
 s_waitcnt vmcnt(51)
 v_accvgpr_read_b32 v164, a80
 v_mul_f32 v164, v164, v232
 v_mfma_f32_16x16x32_bf16 a[120:123], a[152:155], v[40:43], a[120:123]
 s_waitcnt lgkmcnt(0)
 v_accvgpr_read_b32 v165, a81
 v_mul_f32 v165, v165, v232
 v_mfma_f32_16x16x32_bf16 a[120:123], a[156:159], v[56:59], a[120:123]
 s_barrier
 v_accvgpr_read_b32 v166, a82
 v_mul_f32 v166, v166, v232
 v_mfma_f32_16x16x32_bf16 a[124:127], a[152:155], v[44:47], a[124:127]
 s_lshl_b32 s18, s56, 7
 v_accvgpr_read_b32 v167, a83
 v_mul_f32 v167, v167, v232
 v_mfma_f32_16x16x32_bf16 a[124:127], a[156:159], v[60:63], a[124:127]
 s_xor_b32 s19, s18, 0x80
 v_cvt_pk_bf16_f32 v98, v164, v165
 v_cvt_pk_bf16_f32 v99, v166, v167
 v_mfma_f32_16x16x32_bf16 a[0:3], a[128:131], v[48:51], a[0:3]
 v_accvgpr_read_b32 v168, a68
 v_mul_f32 v168, v168, v233
 v_mfma_f32_16x16x32_bf16 a[4:7], a[128:131], v[52:55], a[4:7]
 v_accvgpr_read_b32 v169, a69
 v_mul_f32 v169, v169, v233
 v_mfma_f32_16x16x32_bf16 a[8:11], a[128:131], v[56:59], a[8:11]
 v_accvgpr_read_b32 v170, a70
 v_mul_f32 v170, v170, v233
 v_mfma_f32_16x16x32_bf16 a[12:15], a[128:131], v[60:63], a[12:15]
 v_accvgpr_read_b32 v171, a71
 v_mul_f32 v171, v171, v233
 v_mfma_f32_16x16x32_bf16 a[16:19], a[132:135], v[48:51], a[16:19]
 v_cvt_pk_bf16_f32 v100, v168, v169
 v_cvt_pk_bf16_f32 v101, v170, v171
 v_mfma_f32_16x16x32_bf16 a[20:23], a[132:135], v[52:55], a[20:23]
 v_accvgpr_read_b32 v172, a84
 v_mul_f32 v172, v172, v233
 v_mfma_f32_16x16x32_bf16 a[24:27], a[132:135], v[56:59], a[24:27]
 v_accvgpr_read_b32 v173, a85
 v_mul_f32 v173, v173, v233
 v_mfma_f32_16x16x32_bf16 a[28:31], a[132:135], v[60:63], a[28:31]
 v_accvgpr_read_b32 v174, a86
 v_mul_f32 v174, v174, v233
 v_mfma_f32_16x16x32_bf16 a[32:35], a[136:139], v[48:51], a[32:35]
 v_accvgpr_read_b32 v175, a87
 v_mul_f32 v175, v175, v233
 v_mfma_f32_16x16x32_bf16 a[36:39], a[136:139], v[52:55], a[36:39]
 v_cvt_pk_bf16_f32 v102, v172, v173
 v_cvt_pk_bf16_f32 v103, v174, v175
 v_mfma_f32_16x16x32_bf16 a[40:43], a[136:139], v[56:59], a[40:43]
 v_accvgpr_read_b32 v160, a72
 v_mul_f32 v160, v160, v234
 v_mfma_f32_16x16x32_bf16 a[44:47], a[136:139], v[60:63], a[44:47]
 v_accvgpr_read_b32 v161, a73
 v_mul_f32 v161, v161, v234
 v_mfma_f32_16x16x32_bf16 a[48:51], a[140:143], v[48:51], a[48:51]
 v_accvgpr_read_b32 v162, a74
 v_mul_f32 v162, v162, v234
 v_mfma_f32_16x16x32_bf16 a[52:55], a[140:143], v[52:55], a[52:55]
 v_accvgpr_read_b32 v163, a75
 v_mul_f32 v163, v163, v234
 v_mfma_f32_16x16x32_bf16 a[56:59], a[140:143], v[56:59], a[56:59]
 v_cvt_pk_bf16_f32 v104, v160, v161
 v_cvt_pk_bf16_f32 v105, v162, v163
 v_mfma_f32_16x16x32_bf16 a[60:63], a[140:143], v[60:63], a[60:63]
 v_accvgpr_read_b32 v164, a88
 v_mul_f32 v164, v164, v234
 v_accvgpr_read_b32 v165, a89
 v_mul_f32 v165, v165, v234
 v_accvgpr_read_b32 v166, a90
 v_mul_f32 v166, v166, v234
 v_accvgpr_read_b32 v167, a91
 v_mul_f32 v167, v167, v234
 v_cvt_pk_bf16_f32 v106, v164, v165
 v_cvt_pk_bf16_f32 v107, v166, v167
 v_accvgpr_read_b32 v168, a76
 v_mul_f32 v168, v168, v235
 v_accvgpr_read_b32 v169, a77
 v_mul_f32 v169, v169, v235
 v_accvgpr_read_b32 v170, a78
 v_mul_f32 v170, v170, v235
 v_accvgpr_read_b32 v171, a79
 v_mul_f32 v171, v171, v235
 v_cvt_pk_bf16_f32 v108, v168, v169
 v_cvt_pk_bf16_f32 v109, v170, v171
 v_accvgpr_read_b32 v172, a92
 v_mul_f32 v172, v172, v235
 v_accvgpr_read_b32 v173, a93
 v_mul_f32 v173, v173, v235
 v_accvgpr_read_b32 v174, a94
 v_mul_f32 v174, v174, v235
 v_accvgpr_read_b32 v175, a95
 v_mul_f32 v175, v175, v235
 v_cvt_pk_bf16_f32 v110, v172, v173
 v_cvt_pk_bf16_f32 v111, v174, v175
 s_add_u32 s55, s58, 0x1000
 buffer_store_dwordx4 v[96:99], v2, s[36:39], s55 offen sc1
 v_accvgpr_read_b32 v160, a96
 v_mul_f32 v160, v160, v232
 v_accvgpr_read_b32 v161, a97
 v_mul_f32 v161, v161, v232
 v_accvgpr_read_b32 v162, a98
 v_mul_f32 v162, v162, v232
 v_accvgpr_read_b32 v163, a99
 v_mul_f32 v163, v163, v232
 v_cvt_pk_bf16_f32 v112, v160, v161
 v_cvt_pk_bf16_f32 v113, v162, v163
 v_accvgpr_read_b32 v164, a112
 v_mul_f32 v164, v164, v232
 v_accvgpr_read_b32 v165, a113
 v_mul_f32 v165, v165, v232
 v_accvgpr_read_b32 v166, a114
 v_mul_f32 v166, v166, v232
 v_accvgpr_read_b32 v167, a115
 v_mul_f32 v167, v167, v232
 v_cvt_pk_bf16_f32 v114, v164, v165
 v_cvt_pk_bf16_f32 v115, v166, v167
 v_accvgpr_read_b32 v168, a100
 v_mul_f32 v168, v168, v233
 v_accvgpr_read_b32 v169, a101
 v_mul_f32 v169, v169, v233
 v_accvgpr_read_b32 v170, a102
 v_mul_f32 v170, v170, v233
 v_accvgpr_read_b32 v171, a103
 v_mul_f32 v171, v171, v233
 v_cvt_pk_bf16_f32 v116, v168, v169
 v_cvt_pk_bf16_f32 v117, v170, v171
 v_accvgpr_read_b32 v172, a116
 v_mul_f32 v172, v172, v233
 v_accvgpr_read_b32 v173, a117
 v_mul_f32 v173, v173, v233
 v_accvgpr_read_b32 v174, a118
 v_mul_f32 v174, v174, v233
 v_accvgpr_read_b32 v175, a119
 v_mul_f32 v175, v175, v233
 v_cvt_pk_bf16_f32 v118, v172, v173
 v_cvt_pk_bf16_f32 v119, v174, v175
 buffer_store_dwordx4 v[100:103], v2, s[36:39], s55 offen offset:1024 sc1
 v_lshrrev_b32 v243, 2, v1
 v_mul_u32_u24 v243, 0x120, v243
 v_and_b32 v242, 3, v1
 v_lshl_add_u32 v243, v242, 3, v243
 v_add_u32 v241, s18, v243
 v_add_u32 v242, s19, v243
 v_add_u32 v243, 0x100, v243
 v_add_u32 v14, s8, v241
 v_add_u32 v15, s8, v242
 v_add_u32 v16, s8, v243
 v_add_u32 v17, s9, v241
 v_add_u32 v18, s9, v242
 v_add_u32 v19, s9, v243
 v_add_u32 v20, s10, v241
 v_add_u32 v21, s10, v242
 v_add_u32 v22, s10, v243
 v_add_u32 v23, s11, v241
 v_add_u32 v24, s11, v242
 v_add_u32 v25, s11, v243
 s_add_u32 s8, s8, s51
 s_add_u32 s9, s9, s51
 s_add_u32 s10, s10, s51
 s_add_u32 s11, s11, s51
 s_add_u32 s53, s45, 0x8000
 s_add_u32 m0, s51, 0x9000
 s_add_u32 s40, s52, 0
 buffer_load_dwordx4 v2, s[36:39], s40 offen sc1 lds
 v_accvgpr_read_b32 v160, a104
 v_mul_f32 v160, v160, v234
 v_accvgpr_read_b32 v161, a105
 v_mul_f32 v161, v161, v234
 v_accvgpr_read_b32 v162, a106
 v_mul_f32 v162, v162, v234
 v_accvgpr_read_b32 v163, a107
 v_mul_f32 v163, v163, v234
 v_cvt_pk_bf16_f32 v120, v160, v161
 v_cvt_pk_bf16_f32 v121, v162, v163
 v_accvgpr_read_b32 v164, a120
 v_mul_f32 v164, v164, v234
 v_accvgpr_read_b32 v165, a121
 v_mul_f32 v165, v165, v234
 v_accvgpr_read_b32 v166, a122
 v_mul_f32 v166, v166, v234
 v_accvgpr_read_b32 v167, a123
 v_mul_f32 v167, v167, v234
 v_cvt_pk_bf16_f32 v122, v164, v165
 v_cvt_pk_bf16_f32 v123, v166, v167
 buffer_load_dwordx4 v2, s[36:39], s40 offen offset:1024 sc1 lds
 v_accvgpr_read_b32 v168, a108
 v_mul_f32 v168, v168, v235
 v_accvgpr_read_b32 v169, a109
 v_mul_f32 v169, v169, v235
 v_accvgpr_read_b32 v170, a110
 v_mul_f32 v170, v170, v235
 v_accvgpr_read_b32 v171, a111
 v_mul_f32 v171, v171, v235
 v_cvt_pk_bf16_f32 v124, v168, v169
 v_cvt_pk_bf16_f32 v125, v170, v171
 v_accvgpr_read_b32 v172, a124
 v_mul_f32 v172, v172, v235
 v_accvgpr_read_b32 v173, a125
 v_mul_f32 v173, v173, v235
 v_accvgpr_read_b32 v174, a126
 v_mul_f32 v174, v174, v235
 v_accvgpr_read_b32 v175, a127
 v_mul_f32 v175, v175, v235
 v_cvt_pk_bf16_f32 v126, v172, v173
 v_cvt_pk_bf16_f32 v127, v174, v175
 buffer_store_dwordx4 v[104:107], v3, s[36:39], s55 offen sc1
 buffer_load_dwordx4 v2, s[36:39], s40 offen offset:2048 sc1 lds
 buffer_load_dwordx4 v2, s[36:39], s40 offen offset:3072 sc1 lds
 s_add_u32 m0, s51, 0xa000
 s_add_u32 s40, s52, 0x1000
 buffer_load_dwordx4 v2, s[36:39], s40 offen sc1 lds
 buffer_load_dwordx4 v2, s[36:39], s40 offen offset:1024 sc1 lds
 buffer_load_dwordx4 v2, s[36:39], s40 offen offset:2048 sc1 lds
 buffer_load_dwordx4 v2, s[36:39], s40 offen offset:3072 sc1 lds
 s_add_u32 m0, s51, 0xb000
 s_add_u32 s40, s52, 0x2000
 buffer_load_dwordx4 v2, s[36:39], s40 offen sc1 lds
 s_add_u32 s52, s52, 0x9000
 v_accvgpr_read_b32 v160, a0
 v_mul_f32 v160, v160, v232
 v_accvgpr_read_b32 v161, a1
 v_mul_f32 v161, v161, v232
 v_accvgpr_read_b32 v162, a2
 v_mul_f32 v162, v162, v232
 v_accvgpr_read_b32 v163, a3
 v_mul_f32 v163, v163, v232
 v_cvt_pk_bf16_f32 v192, v160, v161
 v_cvt_pk_bf16_f32 v193, v162, v163
 v_accvgpr_read_b32 v164, a16
 v_mul_f32 v164, v164, v232
 v_accvgpr_read_b32 v165, a17
 v_mul_f32 v165, v165, v232
 v_accvgpr_read_b32 v166, a18
 v_mul_f32 v166, v166, v232
 v_accvgpr_read_b32 v167, a19
 v_mul_f32 v167, v167, v232
 v_cvt_pk_bf16_f32 v194, v164, v165
 v_cvt_pk_bf16_f32 v195, v166, v167
 v_accvgpr_read_b32 v168, a4
 v_mul_f32 v168, v168, v233
 v_accvgpr_read_b32 v169, a5
 v_mul_f32 v169, v169, v233
 v_accvgpr_read_b32 v170, a6
 v_mul_f32 v170, v170, v233
 v_accvgpr_read_b32 v171, a7
 v_mul_f32 v171, v171, v233
 v_cvt_pk_bf16_f32 v196, v168, v169
 v_cvt_pk_bf16_f32 v197, v170, v171
 v_accvgpr_read_b32 v172, a20
 v_mul_f32 v172, v172, v233
 v_accvgpr_read_b32 v173, a21
 v_mul_f32 v173, v173, v233
 v_accvgpr_read_b32 v174, a22
 v_mul_f32 v174, v174, v233
 v_accvgpr_read_b32 v175, a23
 v_mul_f32 v175, v175, v233
 v_cvt_pk_bf16_f32 v198, v172, v173
 v_cvt_pk_bf16_f32 v199, v174, v175
 s_waitcnt vmcnt(62)
 buffer_store_dwordx4 v[108:111], v3, s[36:39], s55 offen offset:1024 sc1
 s_cmp_eq_u32 s43, 0
 s_cbranch_scc1 L_P0
 s_cmp_eq_u32 s43, 1
 s_cbranch_scc1 L_P1
 s_cmp_eq_u32 s43, 3
 s_cbranch_scc1 L_P3
L_P2:
 ds_read_b64_tr_b16 v[48:49], v20
 ds_read_b64_tr_b16 v[50:51], v20 offset:4608
 ds_read_b64_tr_b16 v[52:53], v20 offset:9216
 ds_read_b64_tr_b16 v[54:55], v20 offset:13824
 ds_read_b64_tr_b16 v[56:57], v20 offset:32
 ds_read_b64_tr_b16 v[58:59], v20 offset:4640
 ds_read_b64_tr_b16 v[60:61], v20 offset:9248
 ds_read_b64_tr_b16 v[62:63], v20 offset:13856
 ds_read_b64_tr_b16 v[64:65], v20 offset:64
 ds_read_b64_tr_b16 v[66:67], v20 offset:4672
 ds_read_b64_tr_b16 v[68:69], v20 offset:9280
 ds_read_b64_tr_b16 v[70:71], v20 offset:13888
 ds_read_b64_tr_b16 v[72:73], v20 offset:96
 ds_read_b64_tr_b16 v[74:75], v20 offset:4704
 ds_read_b64_tr_b16 v[76:77], v20 offset:9312
 ds_read_b64_tr_b16 v[78:79], v20 offset:13920
 ds_read_b64_tr_b16 v[80:81], v21
 ds_read_b64_tr_b16 v[82:83], v21 offset:4608
 ds_read_b64_tr_b16 v[84:85], v21 offset:9216
 ds_read_b64_tr_b16 v[86:87], v21 offset:13824
 s_waitcnt vmcnt(29) lgkmcnt(15)
 v_mfma_f32_16x16x32_bf16 a[72:75], v[48:51], a[160:163], 0
 s_waitcnt vmcnt(26)
 ds_read_b64_tr_b16 v[88:89], v21 offset:32
 ds_read_b64_tr_b16 v[90:91], v21 offset:4640
 v_mfma_f32_16x16x32_bf16 a[72:75], v[52:55], a[168:171], a[72:75]
 s_add_u32 s55, s58, 0x1800
 buffer_store_dwordx4 v[112:115], v2, s[36:39], s55 offen sc1
 v_mfma_f32_16x16x32_bf16 a[76:79], v[48:51], a[164:167], 0
 s_lshl_b32 s49, s17, 7
 ds_read_b64_tr_b16 v[92:93], v21 offset:9248
 ds_read_b64_tr_b16 v[94:95], v21 offset:13856
 v_mfma_f32_16x16x32_bf16 a[76:79], v[52:55], a[172:175], a[76:79]
 s_waitcnt lgkmcnt(15)
 s_lshl_b32 s62, s16, 2
 v_accvgpr_read_b32 v160, a8
 v_mul_f32 v160, v160, v234
 v_mfma_f32_16x16x32_bf16 a[80:83], v[56:59], a[160:163], 0
 s_add_u32 s49, s49, s62
 ds_read_b64_tr_b16 v[48:49], v21 offset:64
 ds_read_b64_tr_b16 v[50:51], v21 offset:4672
 v_mfma_f32_16x16x32_bf16 a[80:83], v[60:63], a[168:171], a[80:83]
 s_add_u32 s49, s49, 0x300800
 v_accvgpr_read_b32 v161, a9
 v_mul_f32 v161, v161, v234
 v_mfma_f32_16x16x32_bf16 a[84:87], v[56:59], a[164:167], 0
 s_lshl_b32 s50, s17, 7
 ds_read_b64_tr_b16 v[52:53], v21 offset:9280
 ds_read_b64_tr_b16 v[54:55], v21 offset:13888
 v_mfma_f32_16x16x32_bf16 a[84:87], v[60:63], a[172:175], a[84:87]
 s_waitcnt lgkmcnt(15)
 s_lshl_b32 s62, s70, 5
 v_accvgpr_read_b32 v162, a10
 v_mul_f32 v162, v162, v234
 v_mfma_f32_16x16x32_bf16 a[88:91], v[64:67], a[160:163], 0
 s_add_u32 s50, s50, s62
 ds_read_b64_tr_b16 v[56:57], v21 offset:96
 ds_read_b64_tr_b16 v[58:59], v21 offset:4704
 v_mfma_f32_16x16x32_bf16 a[88:91], v[68:71], a[168:171], a[88:91]
 s_add_u32 s50, s50, 0x300800
 v_accvgpr_read_b32 v163, a11
 v_mul_f32 v163, v163, v234
 v_mfma_f32_16x16x32_bf16 a[92:95], v[64:67], a[164:167], 0
 ds_read_b64_tr_b16 v[60:61], v21 offset:9312
 ds_read_b64_tr_b16 v[62:63], v21 offset:13920
 v_mfma_f32_16x16x32_bf16 a[92:95], v[68:71], a[172:175], a[92:95]
 s_waitcnt lgkmcnt(15)
 v_cvt_pk_bf16_f32 v200, v160, v161
 v_cvt_pk_bf16_f32 v201, v162, v163
 v_mfma_f32_16x16x32_bf16 a[96:99], v[72:75], a[160:163], 0
 ds_read_b64_tr_b16 v[64:65], v22
 ds_read_b64_tr_b16 v[66:67], v22 offset:4608
 v_mfma_f32_16x16x32_bf16 a[96:99], v[76:79], a[168:171], a[96:99]
 v_accvgpr_read_b32 v164, a24
 v_mul_f32 v164, v164, v234
 v_mfma_f32_16x16x32_bf16 a[100:103], v[72:75], a[164:167], 0
 ds_read_b64_tr_b16 v[68:69], v22 offset:9216
 ds_read_b64_tr_b16 v[70:71], v22 offset:13824
 v_mfma_f32_16x16x32_bf16 a[100:103], v[76:79], a[172:175], a[100:103]
 s_waitcnt lgkmcnt(15)
 buffer_store_dwordx4 v[116:119], v2, s[36:39], s55 offen offset:1024 sc1
 v_mfma_f32_16x16x32_bf16 a[104:107], v[80:83], a[160:163], 0
 ds_read_b64_tr_b16 v[72:73], v20 offset:18432
 ds_read_b64_tr_b16 v[74:75], v20 offset:23040
 v_mfma_f32_16x16x32_bf16 a[104:107], v[84:87], a[168:171], a[104:107]
 v_accvgpr_read_b32 v165, a25
 v_mul_f32 v165, v165, v234
 v_mfma_f32_16x16x32_bf16 a[108:111], v[80:83], a[164:167], 0
 ds_read_b64_tr_b16 v[76:77], v20 offset:27648
 ds_read_b64_tr_b16 v[78:79], v20 offset:32256
 v_mfma_f32_16x16x32_bf16 a[108:111], v[84:87], a[172:175], a[108:111]
 s_waitcnt lgkmcnt(15)
 v_accvgpr_read_b32 v166, a26
 v_mul_f32 v166, v166, v234
 v_mfma_f32_16x16x32_bf16 a[112:115], v[88:91], a[160:163], 0
 ds_read_b64_tr_b16 v[80:81], v20 offset:18464
 ds_read_b64_tr_b16 v[82:83], v20 offset:23072
 v_mfma_f32_16x16x32_bf16 a[112:115], v[92:95], a[168:171], a[112:115]
 v_accvgpr_read_b32 v167, a27
 v_mul_f32 v167, v167, v234
 v_mfma_f32_16x16x32_bf16 a[116:119], v[88:91], a[164:167], 0
 ds_read_b64_tr_b16 v[84:85], v20 offset:27680
 ds_read_b64_tr_b16 v[86:87], v20 offset:32288
 v_mfma_f32_16x16x32_bf16 a[116:119], v[92:95], a[172:175], a[116:119]
 s_waitcnt lgkmcnt(15)
 v_cvt_pk_bf16_f32 v202, v164, v165
 v_cvt_pk_bf16_f32 v203, v166, v167
 v_mfma_f32_16x16x32_bf16 a[120:123], v[48:51], a[160:163], 0
 ds_read_b64_tr_b16 v[88:89], v20 offset:18496
 ds_read_b64_tr_b16 v[90:91], v20 offset:23104
 v_mfma_f32_16x16x32_bf16 a[120:123], v[52:55], a[168:171], a[120:123]
 v_accvgpr_read_b32 v168, a12
 v_mul_f32 v168, v168, v235
 v_mfma_f32_16x16x32_bf16 a[124:127], v[48:51], a[164:167], 0
 ds_read_b64_tr_b16 v[92:93], v20 offset:27712
 ds_read_b64_tr_b16 v[94:95], v20 offset:32320
 v_mfma_f32_16x16x32_bf16 a[124:127], v[52:55], a[172:175], a[124:127]
 s_waitcnt lgkmcnt(15)
 v_accvgpr_read_b32 v169, a13
 v_mul_f32 v169, v169, v235
 v_mfma_f32_16x16x32_bf16 a[128:131], v[56:59], a[160:163], 0
 ds_read_b64_tr_b16 v[48:49], v20 offset:18528
 ds_read_b64_tr_b16 v[50:51], v20 offset:23136
 v_mfma_f32_16x16x32_bf16 a[128:131], v[60:63], a[168:171], a[128:131]
 buffer_store_dwordx4 v[120:123], v3, s[36:39], s55 offen sc1
 v_mfma_f32_16x16x32_bf16 a[132:135], v[56:59], a[164:167], 0
 ds_read_b64_tr_b16 v[52:53], v20 offset:27744
 ds_read_b64_tr_b16 v[54:55], v20 offset:32352
 v_mfma_f32_16x16x32_bf16 a[132:135], v[60:63], a[172:175], a[132:135]
 s_waitcnt lgkmcnt(15)
 v_accvgpr_read_b32 v170, a14
 v_mul_f32 v170, v170, v235
 v_mfma_f32_16x16x32_bf16 a[136:139], v[64:67], a[160:163], 0
 ds_read_b64_tr_b16 v[56:57], v21 offset:18432
 ds_read_b64_tr_b16 v[58:59], v21 offset:23040
 v_mfma_f32_16x16x32_bf16 a[136:139], v[68:71], a[168:171], a[136:139]
 v_accvgpr_read_b32 v171, a15
 v_mul_f32 v171, v171, v235
 v_mfma_f32_16x16x32_bf16 a[140:143], v[64:67], a[164:167], 0
 ds_read_b64_tr_b16 v[60:61], v21 offset:27648
 ds_read_b64_tr_b16 v[62:63], v21 offset:32256
 v_mfma_f32_16x16x32_bf16 a[140:143], v[68:71], a[172:175], a[140:143]
 s_waitcnt vmcnt(28) lgkmcnt(15)
 v_cvt_pk_bf16_f32 v204, v168, v169
 v_cvt_pk_bf16_f32 v205, v170, v171
 v_mfma_f32_16x16x32_bf16 a[72:75], v[72:75], a[176:179], a[72:75]
 s_waitcnt vmcnt(26)
 ds_read_b64_tr_b16 v[64:65], v21 offset:18464
 ds_read_b64_tr_b16 v[66:67], v21 offset:23072
 v_mfma_f32_16x16x32_bf16 a[72:75], v[76:79], a[184:187], a[72:75]
 v_accvgpr_read_b32 v172, a28
 v_mul_f32 v172, v172, v235
 v_mfma_f32_16x16x32_bf16 a[76:79], v[72:75], a[180:183], a[76:79]
 s_waitcnt vmcnt(25)
 ds_read_b64_tr_b16 v[68:69], v21 offset:27680
 ds_read_b64_tr_b16 v[70:71], v21 offset:32288
 v_mfma_f32_16x16x32_bf16 a[76:79], v[76:79], a[188:191], a[76:79]
 s_waitcnt lgkmcnt(15)
 v_accvgpr_read_b32 v173, a29
 v_mul_f32 v173, v173, v235
 v_mfma_f32_16x16x32_bf16 a[80:83], v[80:83], a[176:179], a[80:83]
 ds_read_b64_tr_b16 v[72:73], v21 offset:18496
 ds_read_b64_tr_b16 v[74:75], v21 offset:23104
 v_mfma_f32_16x16x32_bf16 a[80:83], v[84:87], a[184:187], a[80:83]
 v_accvgpr_read_b32 v174, a30
 v_mul_f32 v174, v174, v235
 v_mfma_f32_16x16x32_bf16 a[84:87], v[80:83], a[180:183], a[84:87]
 ds_read_b64_tr_b16 v[76:77], v21 offset:27712
 ds_read_b64_tr_b16 v[78:79], v21 offset:32320
 v_mfma_f32_16x16x32_bf16 a[84:87], v[84:87], a[188:191], a[84:87]
 s_waitcnt lgkmcnt(15)
 buffer_store_dwordx4 v[124:127], v3, s[36:39], s55 offen offset:1024 sc1
 v_mfma_f32_16x16x32_bf16 a[88:91], v[88:91], a[176:179], a[88:91]
 ds_read_b64_tr_b16 v[80:81], v21 offset:18528
 ds_read_b64_tr_b16 v[82:83], v21 offset:23136
 v_mfma_f32_16x16x32_bf16 a[88:91], v[92:95], a[184:187], a[88:91]
 v_accvgpr_read_b32 v175, a31
 v_mul_f32 v175, v175, v235
 v_mfma_f32_16x16x32_bf16 a[92:95], v[88:91], a[180:183], a[92:95]
 ds_read_b64_tr_b16 v[84:85], v21 offset:27744
 ds_read_b64_tr_b16 v[86:87], v21 offset:32352
 v_mfma_f32_16x16x32_bf16 a[92:95], v[92:95], a[188:191], a[92:95]
 s_waitcnt lgkmcnt(15)
 v_cvt_pk_bf16_f32 v206, v172, v173
 v_cvt_pk_bf16_f32 v207, v174, v175
 v_mfma_f32_16x16x32_bf16 a[96:99], v[48:51], a[176:179], a[96:99]
 ds_read_b64_tr_b16 v[88:89], v22 offset:18432
 ds_read_b64_tr_b16 v[90:91], v22 offset:23040
 v_mfma_f32_16x16x32_bf16 a[96:99], v[52:55], a[184:187], a[96:99]
 v_accvgpr_read_b32 v160, a32
 v_mul_f32 v160, v160, v232
 v_mfma_f32_16x16x32_bf16 a[100:103], v[48:51], a[180:183], a[100:103]
 ds_read_b64_tr_b16 v[92:93], v22 offset:27648
 ds_read_b64_tr_b16 v[94:95], v22 offset:32256
 v_mfma_f32_16x16x32_bf16 a[100:103], v[52:55], a[188:191], a[100:103]
 s_waitcnt lgkmcnt(15)
 v_accvgpr_read_b32 v161, a33
 v_mul_f32 v161, v161, v232
 v_mfma_f32_16x16x32_bf16 a[104:107], v[56:59], a[176:179], a[104:107]
 v_accvgpr_read_b32 v162, a34
 v_mul_f32 v162, v162, v232
 v_mfma_f32_16x16x32_bf16 a[104:107], v[60:63], a[184:187], a[104:107]
 v_accvgpr_read_b32 v163, a35
 v_mul_f32 v163, v163, v232
 v_mfma_f32_16x16x32_bf16 a[108:111], v[56:59], a[180:183], a[108:111]
 v_cvt_pk_bf16_f32 v208, v160, v161
 v_cvt_pk_bf16_f32 v209, v162, v163
 v_mfma_f32_16x16x32_bf16 a[108:111], v[60:63], a[188:191], a[108:111]
 s_waitcnt lgkmcnt(14)
 v_accvgpr_read_b32 v164, a48
 v_mul_f32 v164, v164, v232
 v_mfma_f32_16x16x32_bf16 a[112:115], v[64:67], a[176:179], a[112:115]
 s_waitcnt lgkmcnt(12)
 v_accvgpr_read_b32 v165, a49
 v_mul_f32 v165, v165, v232
 v_mfma_f32_16x16x32_bf16 a[112:115], v[68:71], a[184:187], a[112:115]
 s_waitcnt lgkmcnt(0)
 v_accvgpr_read_b32 v166, a50
 v_mul_f32 v166, v166, v232
 v_mfma_f32_16x16x32_bf16 a[116:119], v[64:67], a[180:183], a[116:119]
 s_add_u32 s55, s58, 0
 buffer_store_dwordx4 v[192:195], v2, s[36:39], s55 offen sc1
 v_mfma_f32_16x16x32_bf16 a[116:119], v[68:71], a[188:191], a[116:119]
 s_barrier
 ds_read_b64_tr_b16 v[48:49], v23
 ds_read_b64_tr_b16 v[50:51], v23 offset:4608
 v_mfma_f32_16x16x32_bf16 a[120:123], v[72:75], a[176:179], a[120:123]
 ds_read_b64_tr_b16 v[52:53], v23 offset:9216
 ds_read_b64_tr_b16 v[54:55], v23 offset:13824
 v_mfma_f32_16x16x32_bf16 a[120:123], v[76:79], a[184:187], a[120:123]
 ds_read_b64_tr_b16 v[56:57], v23 offset:32
 ds_read_b64_tr_b16 v[58:59], v23 offset:4640
 v_mfma_f32_16x16x32_bf16 a[124:127], v[72:75], a[180:183], a[124:127]
 ds_read_b64_tr_b16 v[60:61], v23 offset:9248
 ds_read_b64_tr_b16 v[62:63], v23 offset:13856
 v_mfma_f32_16x16x32_bf16 a[124:127], v[76:79], a[188:191], a[124:127]
 ds_read_b64_tr_b16 v[64:65], v23 offset:64
 ds_read_b64_tr_b16 v[66:67], v23 offset:4672
 v_mfma_f32_16x16x32_bf16 a[128:131], v[80:83], a[176:179], a[128:131]
 ds_read_b64_tr_b16 v[68:69], v23 offset:9280
 ds_read_b64_tr_b16 v[70:71], v23 offset:13888
 v_mfma_f32_16x16x32_bf16 a[128:131], v[84:87], a[184:187], a[128:131]
 ds_read_b64_tr_b16 v[72:73], v23 offset:96
 ds_read_b64_tr_b16 v[74:75], v23 offset:4704
 v_mfma_f32_16x16x32_bf16 a[132:135], v[80:83], a[180:183], a[132:135]
 ds_read_b64_tr_b16 v[76:77], v23 offset:9312
 ds_read_b64_tr_b16 v[78:79], v23 offset:13920
 v_mfma_f32_16x16x32_bf16 a[132:135], v[84:87], a[188:191], a[132:135]
 v_accvgpr_read_b32 v167, a51
 v_mul_f32 v167, v167, v232
 v_mfma_f32_16x16x32_bf16 a[136:139], v[88:91], a[176:179], a[136:139]
 ds_read_b64_tr_b16 v[80:81], v24
 ds_read_b64_tr_b16 v[82:83], v24 offset:4608
 v_mfma_f32_16x16x32_bf16 a[136:139], v[92:95], a[184:187], a[136:139]
 v_cvt_pk_bf16_f32 v210, v164, v165
 v_cvt_pk_bf16_f32 v211, v166, v167
 v_mfma_f32_16x16x32_bf16 a[140:143], v[88:91], a[180:183], a[140:143]
 ds_read_b64_tr_b16 v[84:85], v24 offset:9216
 ds_read_b64_tr_b16 v[86:87], v24 offset:13824
 v_mfma_f32_16x16x32_bf16 a[140:143], v[92:95], a[188:191], a[140:143]
 s_waitcnt vmcnt(26) lgkmcnt(15)
 buffer_store_dwordx4 v[196:199], v2, s[36:39], s55 offen offset:1024 sc1
 v_mfma_f32_16x16x32_bf16 a[72:75], v[48:51], v[128:131], a[72:75]
 s_waitcnt vmcnt(23)
 ds_read_b64_tr_b16 v[88:89], v24 offset:32
 ds_read_b64_tr_b16 v[90:91], v24 offset:4640
 v_mfma_f32_16x16x32_bf16 a[72:75], v[52:55], v[136:139], a[72:75]
 s_add_u32 m0, s10, 0
 v_accvgpr_read_b32 v168, a36
 v_mul_f32 v168, v168, v233
 v_mfma_f32_16x16x32_bf16 a[76:79], v[48:51], v[132:135], a[76:79]
 s_add_u32 s40, s52, 0
 buffer_load_dwordx4 v2, s[36:39], s40 offen sc1 lds
 v_mfma_f32_16x16x32_bf16 a[76:79], v[52:55], v[140:143], a[76:79]
 s_waitcnt lgkmcnt(15)
 ds_read_b64_tr_b16 v[92:93], v24 offset:9248
 ds_read_b64_tr_b16 v[94:95], v24 offset:13856
 v_mfma_f32_16x16x32_bf16 a[80:83], v[56:59], v[128:131], a[80:83]
 s_waitcnt lgkmcnt(15)
 ds_read_b64_tr_b16 v[48:49], v24 offset:64
 ds_read_b64_tr_b16 v[50:51], v24 offset:4672
 v_mfma_f32_16x16x32_bf16 a[80:83], v[60:63], v[136:139], a[80:83]
 buffer_load_dwordx4 a[160:163], v4, s[28:31], s53 offen sc1
 v_mfma_f32_16x16x32_bf16 a[84:87], v[56:59], v[132:135], a[84:87]
 ds_read_b64_tr_b16 v[52:53], v24 offset:9280
 ds_read_b64_tr_b16 v[54:55], v24 offset:13888
 v_mfma_f32_16x16x32_bf16 a[84:87], v[60:63], v[140:143], a[84:87]
 s_waitcnt lgkmcnt(15)
 v_accvgpr_read_b32 v169, a37
 v_mul_f32 v169, v169, v233
 v_mfma_f32_16x16x32_bf16 a[88:91], v[64:67], v[128:131], a[88:91]
 ds_read_b64_tr_b16 v[56:57], v24 offset:96
 ds_read_b64_tr_b16 v[58:59], v24 offset:4704
 v_mfma_f32_16x16x32_bf16 a[88:91], v[68:71], v[136:139], a[88:91]
 buffer_load_dwordx4 v2, s[36:39], s40 offen offset:1024 sc1 lds
 v_mfma_f32_16x16x32_bf16 a[92:95], v[64:67], v[132:135], a[92:95]
 ds_read_b64_tr_b16 v[60:61], v24 offset:9312
 ds_read_b64_tr_b16 v[62:63], v24 offset:13920
 v_mfma_f32_16x16x32_bf16 a[92:95], v[68:71], v[140:143], a[92:95]
 s_waitcnt lgkmcnt(15)
 v_accvgpr_read_b32 v170, a38
 v_mul_f32 v170, v170, v233
 v_mfma_f32_16x16x32_bf16 a[96:99], v[72:75], v[128:131], a[96:99]
 ds_read_b64_tr_b16 v[64:65], v25
 ds_read_b64_tr_b16 v[66:67], v25 offset:4608
 v_mfma_f32_16x16x32_bf16 a[96:99], v[76:79], v[136:139], a[96:99]
 buffer_load_dwordx4 a[164:167], v5, s[28:31], s53 offen sc1
 v_mfma_f32_16x16x32_bf16 a[100:103], v[72:75], v[132:135], a[100:103]
 buffer_store_dwordx4 v[200:203], v3, s[36:39], s55 offen sc1
 v_mfma_f32_16x16x32_bf16 a[100:103], v[76:79], v[140:143], a[100:103]
 s_waitcnt lgkmcnt(15)
 ds_read_b64_tr_b16 v[68:69], v25 offset:9216
 ds_read_b64_tr_b16 v[70:71], v25 offset:13824
 v_mfma_f32_16x16x32_bf16 a[104:107], v[80:83], v[128:131], a[104:107]
 s_waitcnt lgkmcnt(15)
 buffer_load_dwordx4 v2, s[36:39], s40 offen offset:2048 sc1 lds
 v_mfma_f32_16x16x32_bf16 a[104:107], v[84:87], v[136:139], a[104:107]
 ds_read_b64_tr_b16 v[72:73], v23 offset:18432
 ds_read_b64_tr_b16 v[74:75], v23 offset:23040
 v_mfma_f32_16x16x32_bf16 a[108:111], v[80:83], v[132:135], a[108:111]
 ds_read_b64_tr_b16 v[76:77], v23 offset:27648
 ds_read_b64_tr_b16 v[78:79], v23 offset:32256
 v_mfma_f32_16x16x32_bf16 a[108:111], v[84:87], v[140:143], a[108:111]
 s_waitcnt lgkmcnt(15)
 v_accvgpr_read_b32 v171, a39
 v_mul_f32 v171, v171, v233
 v_mfma_f32_16x16x32_bf16 a[112:115], v[88:91], v[128:131], a[112:115]
 ds_read_b64_tr_b16 v[80:81], v23 offset:18464
 ds_read_b64_tr_b16 v[82:83], v23 offset:23072
 v_mfma_f32_16x16x32_bf16 a[112:115], v[92:95], v[136:139], a[112:115]
 buffer_load_dwordx4 a[168:171], v4, s[28:31], s53 offen offset:2048 sc1
 v_mfma_f32_16x16x32_bf16 a[116:119], v[88:91], v[132:135], a[116:119]
 ds_read_b64_tr_b16 v[84:85], v23 offset:27680
 ds_read_b64_tr_b16 v[86:87], v23 offset:32288
 v_cvt_pk_bf16_f32 v212, v168, v169
 v_cvt_pk_bf16_f32 v213, v170, v171
 v_accvgpr_read_b32 v172, a52
 v_mul_f32 v172, v172, v233
 v_accvgpr_read_b32 v173, a53
 v_mul_f32 v173, v173, v233
 v_accvgpr_read_b32 v174, a54
 v_mul_f32 v174, v174, v233
 v_accvgpr_read_b32 v175, a55
 v_mul_f32 v175, v175, v233
 v_cvt_pk_bf16_f32 v214, v172, v173
 v_cvt_pk_bf16_f32 v215, v174, v175
 v_mfma_f32_16x16x32_bf16 a[116:119], v[92:95], v[140:143], a[116:119]
 s_waitcnt lgkmcnt(15)
 buffer_load_dwordx4 v2, s[36:39], s40 offen offset:3072 sc1 lds
 v_mfma_f32_16x16x32_bf16 a[120:123], v[48:51], v[128:131], a[120:123]
 ds_read_b64_tr_b16 v[88:89], v23 offset:18496
 ds_read_b64_tr_b16 v[90:91], v23 offset:23104
 v_mfma_f32_16x16x32_bf16 a[120:123], v[52:55], v[136:139], a[120:123]
 v_accvgpr_read_b32 v160, a40
 v_mul_f32 v160, v160, v234
 v_mfma_f32_16x16x32_bf16 a[124:127], v[48:51], v[132:135], a[124:127]
 ds_read_b64_tr_b16 v[92:93], v23 offset:27712
 ds_read_b64_tr_b16 v[94:95], v23 offset:32320
 v_mfma_f32_16x16x32_bf16 a[124:127], v[52:55], v[140:143], a[124:127]
 s_waitcnt lgkmcnt(15)
 buffer_store_dwordx4 v[204:207], v3, s[36:39], s55 offen offset:1024 sc1
 v_mfma_f32_16x16x32_bf16 a[128:131], v[56:59], v[128:131], a[128:131]
 ds_read_b64_tr_b16 v[48:49], v23 offset:18528
 ds_read_b64_tr_b16 v[50:51], v23 offset:23136
 v_mfma_f32_16x16x32_bf16 a[128:131], v[60:63], v[136:139], a[128:131]
 s_add_u32 m0, s10, 0x1000
 buffer_load_dwordx4 a[172:175], v5, s[28:31], s53 offen offset:2048 sc1
 v_mfma_f32_16x16x32_bf16 a[132:135], v[56:59], v[132:135], a[132:135]
 s_add_u32 s40, s52, 0x1000
 buffer_load_dwordx4 v2, s[36:39], s40 offen sc1 lds
 v_mfma_f32_16x16x32_bf16 a[132:135], v[60:63], v[140:143], a[132:135]
 s_waitcnt lgkmcnt(15)
 ds_read_b64_tr_b16 v[52:53], v23 offset:27744
 ds_read_b64_tr_b16 v[54:55], v23 offset:32352
 v_mfma_f32_16x16x32_bf16 a[136:139], v[64:67], v[128:131], a[136:139]
 s_waitcnt lgkmcnt(15)
 ds_read_b64_tr_b16 v[56:57], v24 offset:18432
 ds_read_b64_tr_b16 v[58:59], v24 offset:23040
 v_mfma_f32_16x16x32_bf16 a[136:139], v[68:71], v[136:139], a[136:139]
 v_accvgpr_read_b32 v161, a41
 v_mul_f32 v161, v161, v234
 v_mfma_f32_16x16x32_bf16 a[140:143], v[64:67], v[132:135], a[140:143]
 ds_read_b64_tr_b16 v[60:61], v24 offset:27648
 ds_read_b64_tr_b16 v[62:63], v24 offset:32256
 v_mfma_f32_16x16x32_bf16 a[140:143], v[68:71], v[140:143], a[140:143]
 s_waitcnt vmcnt(31) lgkmcnt(15)
 v_accvgpr_read_b32 v162, a42
 v_mul_f32 v162, v162, v234
 v_mfma_f32_16x16x32_bf16 a[72:75], v[72:75], v[144:147], a[72:75]
 s_add_u32 s53, s53, 0x1000
 ds_read_b64_tr_b16 v[64:65], v24 offset:18464
 ds_read_b64_tr_b16 v[66:67], v24 offset:23072
 v_mfma_f32_16x16x32_bf16 a[72:75], v[76:79], v[152:155], a[72:75]
 buffer_load_dwordx4 v2, s[36:39], s40 offen offset:1024 sc1 lds
 v_mfma_f32_16x16x32_bf16 a[76:79], v[72:75], v[148:151], a[76:79]
 s_waitcnt vmcnt(31)
 buffer_load_dwordx4 a[176:179], v4, s[28:31], s53 offen sc1
 v_mfma_f32_16x16x32_bf16 a[76:79], v[76:79], v[156:159], a[76:79]
 s_waitcnt lgkmcnt(15)
 ds_read_b64_tr_b16 v[68:69], v24 offset:27680
 ds_read_b64_tr_b16 v[70:71], v24 offset:32288
 v_mfma_f32_16x16x32_bf16 a[80:83], v[80:83], v[144:147], a[80:83]
 s_waitcnt lgkmcnt(15)
 ds_read_b64_tr_b16 v[72:73], v24 offset:18496
 ds_read_b64_tr_b16 v[74:75], v24 offset:23104
 v_mfma_f32_16x16x32_bf16 a[80:83], v[84:87], v[152:155], a[80:83]
 s_add_u32 s55, s58, 0x800
 buffer_store_dwordx4 v[208:211], v2, s[36:39], s55 offen sc1
 v_mfma_f32_16x16x32_bf16 a[84:87], v[80:83], v[148:151], a[84:87]
 ds_read_b64_tr_b16 v[76:77], v24 offset:27712
 ds_read_b64_tr_b16 v[78:79], v24 offset:32320
 v_mfma_f32_16x16x32_bf16 a[84:87], v[84:87], v[156:159], a[84:87]
 s_waitcnt lgkmcnt(15)
 buffer_load_dwordx4 v2, s[36:39], s40 offen offset:2048 sc1 lds
 v_mfma_f32_16x16x32_bf16 a[88:91], v[88:91], v[144:147], a[88:91]
 ds_read_b64_tr_b16 v[80:81], v24 offset:18528
 ds_read_b64_tr_b16 v[82:83], v24 offset:23136
 v_accvgpr_read_b32 v163, a43
 v_mul_f32 v163, v163, v234
 v_cvt_pk_bf16_f32 v216, v160, v161
 v_cvt_pk_bf16_f32 v217, v162, v163
 v_accvgpr_read_b32 v164, a56
 v_mul_f32 v164, v164, v234
 v_accvgpr_read_b32 v165, a57
 v_mul_f32 v165, v165, v234
 v_accvgpr_read_b32 v166, a58
 v_mul_f32 v166, v166, v234
 v_accvgpr_read_b32 v167, a59
 v_mul_f32 v167, v167, v234
 v_cvt_pk_bf16_f32 v218, v164, v165
 v_cvt_pk_bf16_f32 v219, v166, v167
 v_mfma_f32_16x16x32_bf16 a[88:91], v[92:95], v[152:155], a[88:91]
 buffer_load_dwordx4 a[180:183], v5, s[28:31], s53 offen sc1
 v_mfma_f32_16x16x32_bf16 a[92:95], v[88:91], v[148:151], a[92:95]
 ds_read_b64_tr_b16 v[84:85], v24 offset:27744
 ds_read_b64_tr_b16 v[86:87], v24 offset:32352
 v_mfma_f32_16x16x32_bf16 a[92:95], v[92:95], v[156:159], a[92:95]
 s_waitcnt lgkmcnt(15)
 v_accvgpr_read_b32 v168, a44
 v_mul_f32 v168, v168, v235
 v_mfma_f32_16x16x32_bf16 a[96:99], v[48:51], v[144:147], a[96:99]
 ds_read_b64_tr_b16 v[88:89], v25 offset:18432
 ds_read_b64_tr_b16 v[90:91], v25 offset:23040
 v_mfma_f32_16x16x32_bf16 a[96:99], v[52:55], v[152:155], a[96:99]
 v_accvgpr_read_b32 v169, a45
 v_mul_f32 v169, v169, v235
 v_mfma_f32_16x16x32_bf16 a[100:103], v[48:51], v[148:151], a[100:103]
 ds_read_b64_tr_b16 v[92:93], v25 offset:27648
 ds_read_b64_tr_b16 v[94:95], v25 offset:32256
 v_mfma_f32_16x16x32_bf16 a[100:103], v[52:55], v[156:159], a[100:103]
 s_waitcnt lgkmcnt(15)
 buffer_load_dwordx4 v2, s[36:39], s40 offen offset:3072 sc1 lds
 v_mfma_f32_16x16x32_bf16 a[104:107], v[56:59], v[144:147], a[104:107]
 buffer_load_dwordx4 a[184:187], v4, s[28:31], s53 offen offset:2048 sc1
 v_mfma_f32_16x16x32_bf16 a[104:107], v[60:63], v[152:155], a[104:107]
 v_accvgpr_read_b32 v170, a46
 v_mul_f32 v170, v170, v235
 v_mfma_f32_16x16x32_bf16 a[108:111], v[56:59], v[148:151], a[108:111]
 v_accvgpr_read_b32 v171, a47
 v_mul_f32 v171, v171, v235
 v_mfma_f32_16x16x32_bf16 a[108:111], v[60:63], v[156:159], a[108:111]
 s_waitcnt lgkmcnt(14)
 buffer_store_dwordx4 v[212:215], v2, s[36:39], s55 offen offset:1024 sc1
 v_mfma_f32_16x16x32_bf16 a[112:115], v[64:67], v[144:147], a[112:115]
 s_waitcnt lgkmcnt(12)
 v_cvt_pk_bf16_f32 v220, v168, v169
 v_cvt_pk_bf16_f32 v221, v170, v171
 v_mfma_f32_16x16x32_bf16 a[112:115], v[68:71], v[152:155], a[112:115]
 s_waitcnt lgkmcnt(0)
 v_accvgpr_read_b32 v172, a60
 v_mul_f32 v172, v172, v235
 v_mfma_f32_16x16x32_bf16 a[116:119], v[64:67], v[148:151], a[116:119]
 s_add_u32 m0, s10, 0x2000
 v_accvgpr_read_b32 v173, a61
 v_mul_f32 v173, v173, v235
 v_mfma_f32_16x16x32_bf16 a[116:119], v[68:71], v[156:159], a[116:119]
 s_add_u32 s40, s52, 0x2000
 s_barrier
 buffer_load_dwordx4 v2, s[36:39], s40 offen sc1 lds
 v_mfma_f32_16x16x32_bf16 a[120:123], v[72:75], v[144:147], a[120:123]
 ds_read_b64_tr_b16 v[48:49], v14
 ds_read_b64_tr_b16 v[50:51], v14 offset:4608
 v_mfma_f32_16x16x32_bf16 a[120:123], v[76:79], v[152:155], a[120:123]
 ds_read_b64_tr_b16 v[52:53], v14 offset:9216
 ds_read_b64_tr_b16 v[54:55], v14 offset:13824
 v_mfma_f32_16x16x32_bf16 a[124:127], v[72:75], v[148:151], a[124:127]
 buffer_load_dwordx4 a[188:191], v5, s[28:31], s53 offen offset:2048 sc1
 v_mfma_f32_16x16x32_bf16 a[124:127], v[76:79], v[156:159], a[124:127]
 ds_read_b64_tr_b16 v[56:57], v14 offset:32
 ds_read_b64_tr_b16 v[58:59], v14 offset:4640
 v_mfma_f32_16x16x32_bf16 a[128:131], v[80:83], v[144:147], a[128:131]
 s_add_u32 s52, s52, 0x9000
 ds_read_b64_tr_b16 v[60:61], v14 offset:9248
 ds_read_b64_tr_b16 v[62:63], v14 offset:13856
 v_mfma_f32_16x16x32_bf16 a[128:131], v[84:87], v[152:155], a[128:131]
 ds_read_b64_tr_b16 v[64:65], v14 offset:64
 ds_read_b64_tr_b16 v[66:67], v14 offset:4672
 v_mfma_f32_16x16x32_bf16 a[132:135], v[80:83], v[148:151], a[132:135]
 ds_read_b64_tr_b16 v[68:69], v14 offset:9280
 ds_read_b64_tr_b16 v[70:71], v14 offset:13888
 v_accvgpr_read_b32 v174, a62
 v_mul_f32 v174, v174, v235
 v_accvgpr_read_b32 v175, a63
 v_mul_f32 v175, v175, v235
 v_cvt_pk_bf16_f32 v222, v172, v173
 v_cvt_pk_bf16_f32 v223, v174, v175
 v_mfma_f32_16x16x32_bf16 a[132:135], v[84:87], v[156:159], a[132:135]
 ds_read_b64_tr_b16 v[72:73], v14 offset:96
 ds_read_b64_tr_b16 v[74:75], v14 offset:4704
 v_mfma_f32_16x16x32_bf16 a[136:139], v[88:91], v[144:147], a[136:139]
 s_add_u32 s53, s53, 0x1000
 ds_read_b64_tr_b16 v[76:77], v14 offset:9312
 ds_read_b64_tr_b16 v[78:79], v14 offset:13920
 v_mfma_f32_16x16x32_bf16 a[136:139], v[92:95], v[152:155], a[136:139]
 ds_read_b64_tr_b16 v[80:81], v15
 ds_read_b64_tr_b16 v[82:83], v15 offset:4608
 v_mfma_f32_16x16x32_bf16 a[140:143], v[88:91], v[148:151], a[140:143]
 buffer_store_dwordx4 v[216:219], v3, s[36:39], s55 offen sc1
 v_mfma_f32_16x16x32_bf16 a[140:143], v[92:95], v[156:159], a[140:143]
 s_waitcnt lgkmcnt(15)
 ds_read_b64_tr_b16 v[84:85], v15 offset:9216
 ds_read_b64_tr_b16 v[86:87], v15 offset:13824
 v_mfma_f32_16x16x32_bf16 a[72:75], v[48:51], a[192:195], a[72:75]
 s_waitcnt lgkmcnt(15)
 ds_read_b64_tr_b16 v[88:89], v15 offset:32
 ds_read_b64_tr_b16 v[90:91], v15 offset:4640
 v_mfma_f32_16x16x32_bf16 a[72:75], v[52:55], a[200:203], a[72:75]
 s_add_u32 m0, s11, 0
 v_mfma_f32_16x16x32_bf16 a[76:79], v[48:51], a[196:199], a[76:79]
 s_add_u32 s40, s52, 0
 buffer_load_dwordx4 v2, s[36:39], s40 offen sc1 lds
 v_mfma_f32_16x16x32_bf16 a[76:79], v[52:55], a[204:207], a[76:79]
 s_waitcnt lgkmcnt(15)
 ds_read_b64_tr_b16 v[92:93], v15 offset:9248
 ds_read_b64_tr_b16 v[94:95], v15 offset:13856
 v_mfma_f32_16x16x32_bf16 a[80:83], v[56:59], a[192:195], a[80:83]
 s_waitcnt lgkmcnt(15)
 ds_read_b64_tr_b16 v[48:49], v15 offset:64
 ds_read_b64_tr_b16 v[50:51], v15 offset:4672
 v_mfma_f32_16x16x32_bf16 a[80:83], v[60:63], a[200:203], a[80:83]
 buffer_load_dwordx4 v[128:131], v4, s[28:31], s53 offen sc1
 v_mfma_f32_16x16x32_bf16 a[84:87], v[56:59], a[196:199], a[84:87]
 ds_read_b64_tr_b16 v[52:53], v15 offset:9280
 ds_read_b64_tr_b16 v[54:55], v15 offset:13888
 v_mfma_f32_16x16x32_bf16 a[84:87], v[60:63], a[204:207], a[84:87]
 s_waitcnt lgkmcnt(15)
 v_mfma_f32_16x16x32_bf16 a[88:91], v[64:67], a[192:195], a[88:91]
 ds_read_b64_tr_b16 v[56:57], v15 offset:96
 ds_read_b64_tr_b16 v[58:59], v15 offset:4704
 v_mfma_f32_16x16x32_bf16 a[88:91], v[68:71], a[200:203], a[88:91]
 buffer_load_dwordx4 v2, s[36:39], s40 offen offset:1024 sc1 lds
 v_mfma_f32_16x16x32_bf16 a[92:95], v[64:67], a[196:199], a[92:95]
 ds_read_b64_tr_b16 v[60:61], v15 offset:9312
 ds_read_b64_tr_b16 v[62:63], v15 offset:13920
 v_mfma_f32_16x16x32_bf16 a[92:95], v[68:71], a[204:207], a[92:95]
 s_waitcnt lgkmcnt(15)
 buffer_store_dwordx4 v[220:223], v3, s[36:39], s55 offen offset:1024 sc1
 v_mfma_f32_16x16x32_bf16 a[96:99], v[72:75], a[192:195], a[96:99]
 ds_read_b64_tr_b16 v[64:65], v16
 ds_read_b64_tr_b16 v[66:67], v16 offset:4608
 v_mfma_f32_16x16x32_bf16 a[96:99], v[76:79], a[200:203], a[96:99]
 buffer_load_dwordx4 v[132:135], v5, s[28:31], s53 offen sc1
 v_mfma_f32_16x16x32_bf16 a[100:103], v[72:75], a[196:199], a[100:103]
 ds_read_b64_tr_b16 v[68:69], v16 offset:9216
 ds_read_b64_tr_b16 v[70:71], v16 offset:13824
 v_mfma_f32_16x16x32_bf16 a[100:103], v[76:79], a[204:207], a[100:103]
 s_waitcnt lgkmcnt(15)
 buffer_load_dwordx4 v2, s[36:39], s40 offen offset:2048 sc1 lds
 v_mfma_f32_16x16x32_bf16 a[104:107], v[80:83], a[192:195], a[104:107]
 ds_read_b64_tr_b16 v[72:73], v14 offset:18432
 ds_read_b64_tr_b16 v[74:75], v14 offset:23040
 v_mfma_f32_16x16x32_bf16 a[104:107], v[84:87], a[200:203], a[104:107]
 v_mfma_f32_16x16x32_bf16 a[108:111], v[80:83], a[196:199], a[108:111]
 ds_read_b64_tr_b16 v[76:77], v14 offset:27648
 ds_read_b64_tr_b16 v[78:79], v14 offset:32256
 v_mfma_f32_16x16x32_bf16 a[108:111], v[84:87], a[204:207], a[108:111]
 s_waitcnt lgkmcnt(15)
 v_mfma_f32_16x16x32_bf16 a[112:115], v[88:91], a[192:195], a[112:115]
 ds_read_b64_tr_b16 v[80:81], v14 offset:18464
 ds_read_b64_tr_b16 v[82:83], v14 offset:23072
 v_mfma_f32_16x16x32_bf16 a[112:115], v[92:95], a[200:203], a[112:115]
 buffer_load_dwordx4 v[136:139], v4, s[28:31], s53 offen offset:2048 sc1
 v_mfma_f32_16x16x32_bf16 a[116:119], v[88:91], a[196:199], a[116:119]
 ds_read_b64_tr_b16 v[84:85], v14 offset:27680
 ds_read_b64_tr_b16 v[86:87], v14 offset:32288
 v_mfma_f32_16x16x32_bf16 a[116:119], v[92:95], a[204:207], a[116:119]
 s_waitcnt lgkmcnt(15)
 buffer_load_dwordx4 v2, s[36:39], s40 offen offset:3072 sc1 lds
 v_mfma_f32_16x16x32_bf16 a[120:123], v[48:51], a[192:195], a[120:123]
 ds_read_b64_tr_b16 v[88:89], v14 offset:18496
 ds_read_b64_tr_b16 v[90:91], v14 offset:23104
 v_mfma_f32_16x16x32_bf16 a[120:123], v[52:55], a[200:203], a[120:123]
 v_mfma_f32_16x16x32_bf16 a[124:127], v[48:51], a[196:199], a[124:127]
 ds_read_b64_tr_b16 v[92:93], v14 offset:27712
 ds_read_b64_tr_b16 v[94:95], v14 offset:32320
 v_mfma_f32_16x16x32_bf16 a[124:127], v[52:55], a[204:207], a[124:127]
 s_waitcnt lgkmcnt(15)
 v_mfma_f32_16x16x32_bf16 a[128:131], v[56:59], a[192:195], a[128:131]
 ds_read_b64_tr_b16 v[48:49], v14 offset:18528
 ds_read_b64_tr_b16 v[50:51], v14 offset:23136
 v_mfma_f32_16x16x32_bf16 a[128:131], v[60:63], a[200:203], a[128:131]
 s_add_u32 m0, s11, 0x1000
 buffer_load_dwordx4 v[140:143], v5, s[28:31], s53 offen offset:2048 sc1
 v_mfma_f32_16x16x32_bf16 a[132:135], v[56:59], a[196:199], a[132:135]
 s_add_u32 s40, s52, 0x1000
 buffer_load_dwordx4 v2, s[36:39], s40 offen sc1 lds
 v_mfma_f32_16x16x32_bf16 a[132:135], v[60:63], a[204:207], a[132:135]
 s_waitcnt lgkmcnt(15)
 ds_read_b64_tr_b16 v[52:53], v14 offset:27744
 ds_read_b64_tr_b16 v[54:55], v14 offset:32352
 v_mfma_f32_16x16x32_bf16 a[136:139], v[64:67], a[192:195], a[136:139]
 s_waitcnt lgkmcnt(15)
 ds_read_b64_tr_b16 v[56:57], v15 offset:18432
 ds_read_b64_tr_b16 v[58:59], v15 offset:23040
 v_mfma_f32_16x16x32_bf16 a[136:139], v[68:71], a[200:203], a[136:139]
 v_mfma_f32_16x16x32_bf16 a[140:143], v[64:67], a[196:199], a[140:143]
 ds_read_b64_tr_b16 v[60:61], v15 offset:27648
 ds_read_b64_tr_b16 v[62:63], v15 offset:32256
 v_mfma_f32_16x16x32_bf16 a[140:143], v[68:71], a[204:207], a[140:143]
 s_waitcnt lgkmcnt(15)
 v_mfma_f32_16x16x32_bf16 a[72:75], v[72:75], a[208:211], a[72:75]
 s_add_u32 s53, s53, 0x1000
 ds_read_b64_tr_b16 v[64:65], v15 offset:18464
 ds_read_b64_tr_b16 v[66:67], v15 offset:23072
 v_mfma_f32_16x16x32_bf16 a[72:75], v[76:79], a[216:219], a[72:75]
 buffer_load_dwordx4 v2, s[36:39], s40 offen offset:1024 sc1 lds
 v_mfma_f32_16x16x32_bf16 a[76:79], v[72:75], a[212:215], a[76:79]
 buffer_load_dwordx4 v[144:147], v4, s[28:31], s53 offen sc1
 v_mfma_f32_16x16x32_bf16 a[76:79], v[76:79], a[220:223], a[76:79]
 s_waitcnt lgkmcnt(15)
 ds_read_b64_tr_b16 v[68:69], v15 offset:27680
 ds_read_b64_tr_b16 v[70:71], v15 offset:32288
 v_mfma_f32_16x16x32_bf16 a[80:83], v[80:83], a[208:211], a[80:83]
 s_waitcnt lgkmcnt(15)
 ds_read_b64_tr_b16 v[72:73], v15 offset:18496
 ds_read_b64_tr_b16 v[74:75], v15 offset:23104
 v_mfma_f32_16x16x32_bf16 a[80:83], v[84:87], a[216:219], a[80:83]
 v_mfma_f32_16x16x32_bf16 a[84:87], v[80:83], a[212:215], a[84:87]
 ds_read_b64_tr_b16 v[76:77], v15 offset:27712
 ds_read_b64_tr_b16 v[78:79], v15 offset:32320
 v_mfma_f32_16x16x32_bf16 a[84:87], v[84:87], a[220:223], a[84:87]
 s_waitcnt lgkmcnt(15)
 buffer_load_dwordx4 v2, s[36:39], s40 offen offset:2048 sc1 lds
 v_mfma_f32_16x16x32_bf16 a[88:91], v[88:91], a[208:211], a[88:91]
 ds_read_b64_tr_b16 v[80:81], v15 offset:18528
 ds_read_b64_tr_b16 v[82:83], v15 offset:23136
 v_mfma_f32_16x16x32_bf16 a[88:91], v[92:95], a[216:219], a[88:91]
 buffer_load_dwordx4 v[148:151], v5, s[28:31], s53 offen sc1
 v_mfma_f32_16x16x32_bf16 a[92:95], v[88:91], a[212:215], a[92:95]
 ds_read_b64_tr_b16 v[84:85], v15 offset:27744
 ds_read_b64_tr_b16 v[86:87], v15 offset:32352
 v_mfma_f32_16x16x32_bf16 a[92:95], v[92:95], a[220:223], a[92:95]
 s_waitcnt lgkmcnt(15)
 v_mfma_f32_16x16x32_bf16 a[96:99], v[48:51], a[208:211], a[96:99]
 ds_read_b64_tr_b16 v[88:89], v16 offset:18432
 ds_read_b64_tr_b16 v[90:91], v16 offset:23040
 v_mfma_f32_16x16x32_bf16 a[96:99], v[52:55], a[216:219], a[96:99]
 v_mfma_f32_16x16x32_bf16 a[100:103], v[48:51], a[212:215], a[100:103]
 ds_read_b64_tr_b16 v[92:93], v16 offset:27648
 ds_read_b64_tr_b16 v[94:95], v16 offset:32256
 v_mfma_f32_16x16x32_bf16 a[100:103], v[52:55], a[220:223], a[100:103]
 s_waitcnt lgkmcnt(15)
 buffer_load_dwordx4 v2, s[36:39], s40 offen offset:3072 sc1 lds
 v_mfma_f32_16x16x32_bf16 a[104:107], v[56:59], a[208:211], a[104:107]
 buffer_load_dwordx4 v[152:155], v4, s[28:31], s53 offen offset:2048 sc1
 v_mfma_f32_16x16x32_bf16 a[104:107], v[60:63], a[216:219], a[104:107]
 v_mfma_f32_16x16x32_bf16 a[108:111], v[56:59], a[212:215], a[108:111]
 v_mfma_f32_16x16x32_bf16 a[108:111], v[60:63], a[220:223], a[108:111]
 s_waitcnt vmcnt(12) lgkmcnt(14)
 v_mfma_f32_16x16x32_bf16 a[112:115], v[64:67], a[208:211], a[112:115]
 s_waitcnt lgkmcnt(12)
 v_mfma_f32_16x16x32_bf16 a[112:115], v[68:71], a[216:219], a[112:115]
 s_waitcnt lgkmcnt(0)
 v_mfma_f32_16x16x32_bf16 a[116:119], v[64:67], a[212:215], a[116:119]
 s_add_u32 m0, s11, 0x2000
 v_mfma_f32_16x16x32_bf16 a[116:119], v[68:71], a[220:223], a[116:119]
 s_add_u32 s40, s52, 0x2000
 s_barrier
 buffer_load_dwordx4 v2, s[36:39], s40 offen sc1 lds
 v_mfma_f32_16x16x32_bf16 a[120:123], v[72:75], a[208:211], a[120:123]
 s_cmp_lg_u32 s3, 0
 s_cbranch_scc1 L_sgo2
 s_mov_b64 exec, 1
 buffer_store_dword v253, off, s[36:39], s49 sc1
 s_mov_b64 exec, -1
L_sgo2:
 ds_read_b64_tr_b16 v[48:49], v17
 ds_read_b64_tr_b16 v[50:51], v17 offset:4608
 v_mfma_f32_16x16x32_bf16 a[120:123], v[76:79], a[216:219], a[120:123]
 ds_read_b64_tr_b16 v[52:53], v17 offset:9216
 ds_read_b64_tr_b16 v[54:55], v17 offset:13824
 v_mfma_f32_16x16x32_bf16 a[124:127], v[72:75], a[212:215], a[124:127]
 buffer_load_dwordx4 v[156:159], v5, s[28:31], s53 offen offset:2048 sc1
 v_mfma_f32_16x16x32_bf16 a[124:127], v[76:79], a[220:223], a[124:127]
 ds_read_b64_tr_b16 v[56:57], v17 offset:32
 ds_read_b64_tr_b16 v[58:59], v17 offset:4640
 v_mfma_f32_16x16x32_bf16 a[128:131], v[80:83], a[208:211], a[128:131]
 s_add_u32 s52, s52, 0x9000
 ds_read_b64_tr_b16 v[60:61], v17 offset:9248
 ds_read_b64_tr_b16 v[62:63], v17 offset:13856
 v_mfma_f32_16x16x32_bf16 a[128:131], v[84:87], a[216:219], a[128:131]
 ds_read_b64_tr_b16 v[64:65], v17 offset:64
 ds_read_b64_tr_b16 v[66:67], v17 offset:4672
 v_mfma_f32_16x16x32_bf16 a[132:135], v[80:83], a[212:215], a[132:135]
 ds_read_b64_tr_b16 v[68:69], v17 offset:9280
 ds_read_b64_tr_b16 v[70:71], v17 offset:13888
 v_mfma_f32_16x16x32_bf16 a[132:135], v[84:87], a[220:223], a[132:135]
 ds_read_b64_tr_b16 v[72:73], v17 offset:96
 ds_read_b64_tr_b16 v[74:75], v17 offset:4704
 v_mfma_f32_16x16x32_bf16 a[136:139], v[88:91], a[208:211], a[136:139]
 s_add_u32 s53, s53, 0x1000
 ds_read_b64_tr_b16 v[76:77], v17 offset:9312
 ds_read_b64_tr_b16 v[78:79], v17 offset:13920
 v_mfma_f32_16x16x32_bf16 a[136:139], v[92:95], a[216:219], a[136:139]
 ds_read_b64_tr_b16 v[80:81], v18
 ds_read_b64_tr_b16 v[82:83], v18 offset:4608
 v_mfma_f32_16x16x32_bf16 a[140:143], v[88:91], a[212:215], a[140:143]
 ds_read_b64_tr_b16 v[84:85], v18 offset:9216
 ds_read_b64_tr_b16 v[86:87], v18 offset:13824
 v_mfma_f32_16x16x32_bf16 a[140:143], v[92:95], a[220:223], a[140:143]
L_B1:
 s_waitcnt lgkmcnt(15)
 v_mfma_f32_16x16x32_bf16 a[72:75], v[48:51], a[224:227], a[72:75]
 ds_read_b64_tr_b16 v[88:89], v18 offset:32
 ds_read_b64_tr_b16 v[90:91], v18 offset:4640
 v_mfma_f32_16x16x32_bf16 a[72:75], v[52:55], a[232:235], a[72:75]
 s_add_u32 m0, s8, 0
 v_mfma_f32_16x16x32_bf16 a[76:79], v[48:51], a[228:231], a[76:79]
 s_add_u32 s40, s52, 0
 buffer_load_dwordx4 v2, s[36:39], s40 offen sc1 lds
 v_mfma_f32_16x16x32_bf16 a[76:79], v[52:55], a[236:239], a[76:79]
 s_waitcnt lgkmcnt(15)
 ds_read_b64_tr_b16 v[92:93], v18 offset:9248
 ds_read_b64_tr_b16 v[94:95], v18 offset:13856
 v_mfma_f32_16x16x32_bf16 a[80:83], v[56:59], a[224:227], a[80:83]
 s_waitcnt lgkmcnt(15)
 ds_read_b64_tr_b16 v[48:49], v18 offset:64
 ds_read_b64_tr_b16 v[50:51], v18 offset:4672
 v_mfma_f32_16x16x32_bf16 a[80:83], v[60:63], a[232:235], a[80:83]
 buffer_load_dwordx4 a[192:195], v4, s[28:31], s53 offen sc1
 v_mfma_f32_16x16x32_bf16 a[84:87], v[56:59], a[228:231], a[84:87]
 ds_read_b64_tr_b16 v[52:53], v18 offset:9280
 ds_read_b64_tr_b16 v[54:55], v18 offset:13888
 v_mfma_f32_16x16x32_bf16 a[84:87], v[60:63], a[236:239], a[84:87]
 s_waitcnt lgkmcnt(15)
 v_mfma_f32_16x16x32_bf16 a[88:91], v[64:67], a[224:227], a[88:91]
 ds_read_b64_tr_b16 v[56:57], v18 offset:96
 ds_read_b64_tr_b16 v[58:59], v18 offset:4704
 v_mfma_f32_16x16x32_bf16 a[88:91], v[68:71], a[232:235], a[88:91]
 buffer_load_dwordx4 v2, s[36:39], s40 offen offset:1024 sc1 lds
 v_mfma_f32_16x16x32_bf16 a[92:95], v[64:67], a[228:231], a[92:95]
 ds_read_b64_tr_b16 v[60:61], v18 offset:9312
 ds_read_b64_tr_b16 v[62:63], v18 offset:13920
 v_mfma_f32_16x16x32_bf16 a[92:95], v[68:71], a[236:239], a[92:95]
 s_waitcnt lgkmcnt(15)
 v_mfma_f32_16x16x32_bf16 a[96:99], v[72:75], a[224:227], a[96:99]
 ds_read_b64_tr_b16 v[64:65], v19
 ds_read_b64_tr_b16 v[66:67], v19 offset:4608
 v_mfma_f32_16x16x32_bf16 a[96:99], v[76:79], a[232:235], a[96:99]
 buffer_load_dwordx4 a[196:199], v5, s[28:31], s53 offen sc1
 v_mfma_f32_16x16x32_bf16 a[100:103], v[72:75], a[228:231], a[100:103]
 ds_read_b64_tr_b16 v[68:69], v19 offset:9216
 ds_read_b64_tr_b16 v[70:71], v19 offset:13824
 v_mfma_f32_16x16x32_bf16 a[100:103], v[76:79], a[236:239], a[100:103]
 s_waitcnt lgkmcnt(15)
 buffer_load_dwordx4 v2, s[36:39], s40 offen offset:2048 sc1 lds
 v_mfma_f32_16x16x32_bf16 a[104:107], v[80:83], a[224:227], a[104:107]
 ds_read_b64_tr_b16 v[72:73], v17 offset:18432
 ds_read_b64_tr_b16 v[74:75], v17 offset:23040
 v_mfma_f32_16x16x32_bf16 a[104:107], v[84:87], a[232:235], a[104:107]
 v_mfma_f32_16x16x32_bf16 a[108:111], v[80:83], a[228:231], a[108:111]
 ds_read_b64_tr_b16 v[76:77], v17 offset:27648
 ds_read_b64_tr_b16 v[78:79], v17 offset:32256
 v_mfma_f32_16x16x32_bf16 a[108:111], v[84:87], a[236:239], a[108:111]
 s_waitcnt lgkmcnt(15)
 v_mfma_f32_16x16x32_bf16 a[112:115], v[88:91], a[224:227], a[112:115]
 ds_read_b64_tr_b16 v[80:81], v17 offset:18464
 ds_read_b64_tr_b16 v[82:83], v17 offset:23072
 v_mfma_f32_16x16x32_bf16 a[112:115], v[92:95], a[232:235], a[112:115]
 buffer_load_dwordx4 a[200:203], v4, s[28:31], s53 offen offset:2048 sc1
 v_mfma_f32_16x16x32_bf16 a[116:119], v[88:91], a[228:231], a[116:119]
 ds_read_b64_tr_b16 v[84:85], v17 offset:27680
 ds_read_b64_tr_b16 v[86:87], v17 offset:32288
 v_mfma_f32_16x16x32_bf16 a[116:119], v[92:95], a[236:239], a[116:119]
 s_waitcnt lgkmcnt(15)
 buffer_load_dwordx4 v2, s[36:39], s40 offen offset:3072 sc1 lds
 v_mfma_f32_16x16x32_bf16 a[120:123], v[48:51], a[224:227], a[120:123]
 ds_read_b64_tr_b16 v[88:89], v17 offset:18496
 ds_read_b64_tr_b16 v[90:91], v17 offset:23104
 v_mfma_f32_16x16x32_bf16 a[120:123], v[52:55], a[232:235], a[120:123]
 v_mfma_f32_16x16x32_bf16 a[124:127], v[48:51], a[228:231], a[124:127]
 ds_read_b64_tr_b16 v[92:93], v17 offset:27712
 ds_read_b64_tr_b16 v[94:95], v17 offset:32320
 v_mfma_f32_16x16x32_bf16 a[124:127], v[52:55], a[236:239], a[124:127]
 s_waitcnt lgkmcnt(15)
 v_mfma_f32_16x16x32_bf16 a[128:131], v[56:59], a[224:227], a[128:131]
 ds_read_b64_tr_b16 v[48:49], v17 offset:18528
 ds_read_b64_tr_b16 v[50:51], v17 offset:23136
 v_mfma_f32_16x16x32_bf16 a[128:131], v[60:63], a[232:235], a[128:131]
 s_add_u32 m0, s8, 0x1000
 buffer_load_dwordx4 a[204:207], v5, s[28:31], s53 offen offset:2048 sc1
 v_mfma_f32_16x16x32_bf16 a[132:135], v[56:59], a[228:231], a[132:135]
 s_add_u32 s40, s52, 0x1000
 buffer_load_dwordx4 v2, s[36:39], s40 offen sc1 lds
 v_mfma_f32_16x16x32_bf16 a[132:135], v[60:63], a[236:239], a[132:135]
 s_waitcnt lgkmcnt(15)
 ds_read_b64_tr_b16 v[52:53], v17 offset:27744
 ds_read_b64_tr_b16 v[54:55], v17 offset:32352
 v_mfma_f32_16x16x32_bf16 a[136:139], v[64:67], a[224:227], a[136:139]
 s_waitcnt lgkmcnt(15)
 ds_read_b64_tr_b16 v[56:57], v18 offset:18432
 ds_read_b64_tr_b16 v[58:59], v18 offset:23040
 v_mfma_f32_16x16x32_bf16 a[136:139], v[68:71], a[232:235], a[136:139]
 v_mfma_f32_16x16x32_bf16 a[140:143], v[64:67], a[228:231], a[140:143]
 ds_read_b64_tr_b16 v[60:61], v18 offset:27648
 ds_read_b64_tr_b16 v[62:63], v18 offset:32256
 v_mfma_f32_16x16x32_bf16 a[140:143], v[68:71], a[236:239], a[140:143]
 s_waitcnt lgkmcnt(15)
 v_mfma_f32_16x16x32_bf16 a[72:75], v[72:75], a[240:243], a[72:75]
 s_add_u32 s53, s53, 0x1000
 ds_read_b64_tr_b16 v[64:65], v18 offset:18464
 ds_read_b64_tr_b16 v[66:67], v18 offset:23072
 v_mfma_f32_16x16x32_bf16 a[72:75], v[76:79], a[248:251], a[72:75]
 buffer_load_dwordx4 v2, s[36:39], s40 offen offset:1024 sc1 lds
 v_mfma_f32_16x16x32_bf16 a[76:79], v[72:75], a[244:247], a[76:79]
 s_waitcnt vmcnt(44)
 buffer_load_dwordx4 a[208:211], v4, s[28:31], s53 offen sc1
 v_mfma_f32_16x16x32_bf16 a[76:79], v[76:79], a[252:255], a[76:79]
 s_waitcnt lgkmcnt(15)
 ds_read_b64_tr_b16 v[68:69], v18 offset:27680
 ds_read_b64_tr_b16 v[70:71], v18 offset:32288
 v_mfma_f32_16x16x32_bf16 a[80:83], v[80:83], a[240:243], a[80:83]
 s_waitcnt lgkmcnt(15)
 ds_read_b64_tr_b16 v[72:73], v18 offset:18496
 ds_read_b64_tr_b16 v[74:75], v18 offset:23104
 v_mfma_f32_16x16x32_bf16 a[80:83], v[84:87], a[248:251], a[80:83]
 v_mfma_f32_16x16x32_bf16 a[84:87], v[80:83], a[244:247], a[84:87]
 ds_read_b64_tr_b16 v[76:77], v18 offset:27712
 ds_read_b64_tr_b16 v[78:79], v18 offset:32320
 v_mfma_f32_16x16x32_bf16 a[84:87], v[84:87], a[252:255], a[84:87]
 s_waitcnt lgkmcnt(15)
 buffer_load_dwordx4 v2, s[36:39], s40 offen offset:2048 sc1 lds
 v_mfma_f32_16x16x32_bf16 a[88:91], v[88:91], a[240:243], a[88:91]
 ds_read_b64_tr_b16 v[80:81], v18 offset:18528
 ds_read_b64_tr_b16 v[82:83], v18 offset:23136
 v_mfma_f32_16x16x32_bf16 a[88:91], v[92:95], a[248:251], a[88:91]
 buffer_load_dwordx4 a[212:215], v5, s[28:31], s53 offen sc1
 v_mfma_f32_16x16x32_bf16 a[92:95], v[88:91], a[244:247], a[92:95]
 ds_read_b64_tr_b16 v[84:85], v18 offset:27744
 ds_read_b64_tr_b16 v[86:87], v18 offset:32352
 v_mfma_f32_16x16x32_bf16 a[92:95], v[92:95], a[252:255], a[92:95]
 s_waitcnt lgkmcnt(15)
 v_mfma_f32_16x16x32_bf16 a[96:99], v[48:51], a[240:243], a[96:99]
 ds_read_b64_tr_b16 v[88:89], v19 offset:18432
 ds_read_b64_tr_b16 v[90:91], v19 offset:23040
 v_mfma_f32_16x16x32_bf16 a[96:99], v[52:55], a[248:251], a[96:99]
 v_mfma_f32_16x16x32_bf16 a[100:103], v[48:51], a[244:247], a[100:103]
 ds_read_b64_tr_b16 v[92:93], v19 offset:27648
 ds_read_b64_tr_b16 v[94:95], v19 offset:32256
 v_mfma_f32_16x16x32_bf16 a[100:103], v[52:55], a[252:255], a[100:103]
 s_waitcnt lgkmcnt(15)
 buffer_load_dwordx4 v2, s[36:39], s40 offen offset:3072 sc1 lds
 v_mfma_f32_16x16x32_bf16 a[104:107], v[56:59], a[240:243], a[104:107]
 buffer_load_dwordx4 a[216:219], v4, s[28:31], s53 offen offset:2048 sc1
 v_mfma_f32_16x16x32_bf16 a[104:107], v[60:63], a[248:251], a[104:107]
 v_mfma_f32_16x16x32_bf16 a[108:111], v[56:59], a[244:247], a[108:111]
 v_mfma_f32_16x16x32_bf16 a[108:111], v[60:63], a[252:255], a[108:111]
 s_waitcnt lgkmcnt(14)
 v_mfma_f32_16x16x32_bf16 a[112:115], v[64:67], a[240:243], a[112:115]
 s_waitcnt vmcnt(33) lgkmcnt(12)
 v_mfma_f32_16x16x32_bf16 a[112:115], v[68:71], a[248:251], a[112:115]
 s_waitcnt lgkmcnt(0)
 v_mfma_f32_16x16x32_bf16 a[116:119], v[64:67], a[244:247], a[116:119]
 s_add_u32 m0, s8, 0x2000
 v_mfma_f32_16x16x32_bf16 a[116:119], v[68:71], a[252:255], a[116:119]
 s_add_u32 s40, s52, 0x2000
 s_barrier
 buffer_load_dwordx4 v2, s[36:39], s40 offen sc1 lds
 v_mfma_f32_16x16x32_bf16 a[120:123], v[72:75], a[240:243], a[120:123]
 ds_read_b64_tr_b16 v[48:49], v20
 ds_read_b64_tr_b16 v[50:51], v20 offset:4608
 v_mfma_f32_16x16x32_bf16 a[120:123], v[76:79], a[248:251], a[120:123]
 ds_read_b64_tr_b16 v[52:53], v20 offset:9216
 ds_read_b64_tr_b16 v[54:55], v20 offset:13824
 v_mfma_f32_16x16x32_bf16 a[124:127], v[72:75], a[244:247], a[124:127]
 buffer_load_dwordx4 a[220:223], v5, s[28:31], s53 offen offset:2048 sc1
 v_mfma_f32_16x16x32_bf16 a[124:127], v[76:79], a[252:255], a[124:127]
 ds_read_b64_tr_b16 v[56:57], v20 offset:32
 ds_read_b64_tr_b16 v[58:59], v20 offset:4640
 v_mfma_f32_16x16x32_bf16 a[128:131], v[80:83], a[240:243], a[128:131]
 s_add_u32 s52, s52, 0x9000
 ds_read_b64_tr_b16 v[60:61], v20 offset:9248
 ds_read_b64_tr_b16 v[62:63], v20 offset:13856
 v_mfma_f32_16x16x32_bf16 a[128:131], v[84:87], a[248:251], a[128:131]
 ds_read_b64_tr_b16 v[64:65], v20 offset:64
 ds_read_b64_tr_b16 v[66:67], v20 offset:4672
 v_mfma_f32_16x16x32_bf16 a[132:135], v[80:83], a[244:247], a[132:135]
 ds_read_b64_tr_b16 v[68:69], v20 offset:9280
 ds_read_b64_tr_b16 v[70:71], v20 offset:13888
 v_mfma_f32_16x16x32_bf16 a[132:135], v[84:87], a[252:255], a[132:135]
 ds_read_b64_tr_b16 v[72:73], v20 offset:96
 ds_read_b64_tr_b16 v[74:75], v20 offset:4704
 v_mfma_f32_16x16x32_bf16 a[136:139], v[88:91], a[240:243], a[136:139]
 s_add_u32 s53, s53, 0x1000
 ds_read_b64_tr_b16 v[76:77], v20 offset:9312
 ds_read_b64_tr_b16 v[78:79], v20 offset:13920
 v_mfma_f32_16x16x32_bf16 a[136:139], v[92:95], a[248:251], a[136:139]
 ds_read_b64_tr_b16 v[80:81], v21
 ds_read_b64_tr_b16 v[82:83], v21 offset:4608
 v_mfma_f32_16x16x32_bf16 a[140:143], v[88:91], a[244:247], a[140:143]
 ds_read_b64_tr_b16 v[84:85], v21 offset:9216
 ds_read_b64_tr_b16 v[86:87], v21 offset:13824
 v_mfma_f32_16x16x32_bf16 a[140:143], v[92:95], a[252:255], a[140:143]
L_B2:
 s_waitcnt lgkmcnt(15)
 v_mfma_f32_16x16x32_bf16 a[72:75], v[48:51], a[160:163], a[72:75]
 ds_read_b64_tr_b16 v[88:89], v21 offset:32
 ds_read_b64_tr_b16 v[90:91], v21 offset:4640
 v_mfma_f32_16x16x32_bf16 a[72:75], v[52:55], a[168:171], a[72:75]
 s_add_u32 m0, s9, 0
 v_mfma_f32_16x16x32_bf16 a[76:79], v[48:51], a[164:167], a[76:79]
 s_add_u32 s40, s52, 0
 buffer_load_dwordx4 v2, s[36:39], s40 offen sc1 lds
 v_mfma_f32_16x16x32_bf16 a[76:79], v[52:55], a[172:175], a[76:79]
 s_waitcnt lgkmcnt(15)
 ds_read_b64_tr_b16 v[92:93], v21 offset:9248
 ds_read_b64_tr_b16 v[94:95], v21 offset:13856
 v_mfma_f32_16x16x32_bf16 a[80:83], v[56:59], a[160:163], a[80:83]
 s_waitcnt lgkmcnt(15)
 ds_read_b64_tr_b16 v[48:49], v21 offset:64
 ds_read_b64_tr_b16 v[50:51], v21 offset:4672
 v_mfma_f32_16x16x32_bf16 a[80:83], v[60:63], a[168:171], a[80:83]
 buffer_load_dwordx4 a[224:227], v4, s[28:31], s53 offen sc1
 v_mfma_f32_16x16x32_bf16 a[84:87], v[56:59], a[164:167], a[84:87]
 ds_read_b64_tr_b16 v[52:53], v21 offset:9280
 ds_read_b64_tr_b16 v[54:55], v21 offset:13888
 v_mfma_f32_16x16x32_bf16 a[84:87], v[60:63], a[172:175], a[84:87]
 s_waitcnt lgkmcnt(15)
 v_mfma_f32_16x16x32_bf16 a[88:91], v[64:67], a[160:163], a[88:91]
 ds_read_b64_tr_b16 v[56:57], v21 offset:96
 ds_read_b64_tr_b16 v[58:59], v21 offset:4704
 v_mfma_f32_16x16x32_bf16 a[88:91], v[68:71], a[168:171], a[88:91]
 buffer_load_dwordx4 v2, s[36:39], s40 offen offset:1024 sc1 lds
 v_mfma_f32_16x16x32_bf16 a[92:95], v[64:67], a[164:167], a[92:95]
 ds_read_b64_tr_b16 v[60:61], v21 offset:9312
 ds_read_b64_tr_b16 v[62:63], v21 offset:13920
 v_mfma_f32_16x16x32_bf16 a[92:95], v[68:71], a[172:175], a[92:95]
 s_waitcnt lgkmcnt(15)
 v_mfma_f32_16x16x32_bf16 a[96:99], v[72:75], a[160:163], a[96:99]
 ds_read_b64_tr_b16 v[64:65], v22
 ds_read_b64_tr_b16 v[66:67], v22 offset:4608
 v_mfma_f32_16x16x32_bf16 a[96:99], v[76:79], a[168:171], a[96:99]
 buffer_load_dwordx4 a[228:231], v5, s[28:31], s53 offen sc1
 v_mfma_f32_16x16x32_bf16 a[100:103], v[72:75], a[164:167], a[100:103]
 ds_read_b64_tr_b16 v[68:69], v22 offset:9216
 ds_read_b64_tr_b16 v[70:71], v22 offset:13824
 v_mfma_f32_16x16x32_bf16 a[100:103], v[76:79], a[172:175], a[100:103]
 s_waitcnt lgkmcnt(15)
 buffer_load_dwordx4 v2, s[36:39], s40 offen offset:2048 sc1 lds
 v_mfma_f32_16x16x32_bf16 a[104:107], v[80:83], a[160:163], a[104:107]
 ds_read_b64_tr_b16 v[72:73], v20 offset:18432
 ds_read_b64_tr_b16 v[74:75], v20 offset:23040
 v_mfma_f32_16x16x32_bf16 a[104:107], v[84:87], a[168:171], a[104:107]
 v_mfma_f32_16x16x32_bf16 a[108:111], v[80:83], a[164:167], a[108:111]
 ds_read_b64_tr_b16 v[76:77], v20 offset:27648
 ds_read_b64_tr_b16 v[78:79], v20 offset:32256
 v_mfma_f32_16x16x32_bf16 a[108:111], v[84:87], a[172:175], a[108:111]
 s_waitcnt lgkmcnt(15)
 v_mfma_f32_16x16x32_bf16 a[112:115], v[88:91], a[160:163], a[112:115]
 ds_read_b64_tr_b16 v[80:81], v20 offset:18464
 ds_read_b64_tr_b16 v[82:83], v20 offset:23072
 v_mfma_f32_16x16x32_bf16 a[112:115], v[92:95], a[168:171], a[112:115]
 buffer_load_dwordx4 a[232:235], v4, s[28:31], s53 offen offset:2048 sc1
 v_mfma_f32_16x16x32_bf16 a[116:119], v[88:91], a[164:167], a[116:119]
 ds_read_b64_tr_b16 v[84:85], v20 offset:27680
 ds_read_b64_tr_b16 v[86:87], v20 offset:32288
 v_mfma_f32_16x16x32_bf16 a[116:119], v[92:95], a[172:175], a[116:119]
 s_waitcnt lgkmcnt(15)
 buffer_load_dwordx4 v2, s[36:39], s40 offen offset:3072 sc1 lds
 v_mfma_f32_16x16x32_bf16 a[120:123], v[48:51], a[160:163], a[120:123]
 ds_read_b64_tr_b16 v[88:89], v20 offset:18496
 ds_read_b64_tr_b16 v[90:91], v20 offset:23104
 v_mfma_f32_16x16x32_bf16 a[120:123], v[52:55], a[168:171], a[120:123]
 v_mfma_f32_16x16x32_bf16 a[124:127], v[48:51], a[164:167], a[124:127]
 ds_read_b64_tr_b16 v[92:93], v20 offset:27712
 ds_read_b64_tr_b16 v[94:95], v20 offset:32320
 v_mfma_f32_16x16x32_bf16 a[124:127], v[52:55], a[172:175], a[124:127]
 s_waitcnt lgkmcnt(15)
 v_mfma_f32_16x16x32_bf16 a[128:131], v[56:59], a[160:163], a[128:131]
 ds_read_b64_tr_b16 v[48:49], v20 offset:18528
 ds_read_b64_tr_b16 v[50:51], v20 offset:23136
 v_mfma_f32_16x16x32_bf16 a[128:131], v[60:63], a[168:171], a[128:131]
 s_add_u32 m0, s9, 0x1000
 buffer_load_dwordx4 a[236:239], v5, s[28:31], s53 offen offset:2048 sc1
 v_mfma_f32_16x16x32_bf16 a[132:135], v[56:59], a[164:167], a[132:135]
 s_add_u32 s40, s52, 0x1000
 buffer_load_dwordx4 v2, s[36:39], s40 offen sc1 lds
 v_mfma_f32_16x16x32_bf16 a[132:135], v[60:63], a[172:175], a[132:135]
 s_waitcnt lgkmcnt(15)
 ds_read_b64_tr_b16 v[52:53], v20 offset:27744
 ds_read_b64_tr_b16 v[54:55], v20 offset:32352
 v_mfma_f32_16x16x32_bf16 a[136:139], v[64:67], a[160:163], a[136:139]
 s_waitcnt lgkmcnt(15)
 ds_read_b64_tr_b16 v[56:57], v21 offset:18432
 ds_read_b64_tr_b16 v[58:59], v21 offset:23040
 v_mfma_f32_16x16x32_bf16 a[136:139], v[68:71], a[168:171], a[136:139]
 v_mfma_f32_16x16x32_bf16 a[140:143], v[64:67], a[164:167], a[140:143]
 ds_read_b64_tr_b16 v[60:61], v21 offset:27648
 ds_read_b64_tr_b16 v[62:63], v21 offset:32256
 v_mfma_f32_16x16x32_bf16 a[140:143], v[68:71], a[172:175], a[140:143]
 s_waitcnt lgkmcnt(15)
 v_mfma_f32_16x16x32_bf16 a[72:75], v[72:75], a[176:179], a[72:75]
 s_add_u32 s53, s53, 0x1000
 ds_read_b64_tr_b16 v[64:65], v21 offset:18464
 ds_read_b64_tr_b16 v[66:67], v21 offset:23072
 v_mfma_f32_16x16x32_bf16 a[72:75], v[76:79], a[184:187], a[72:75]
 buffer_load_dwordx4 v2, s[36:39], s40 offen offset:1024 sc1 lds
 v_mfma_f32_16x16x32_bf16 a[76:79], v[72:75], a[180:183], a[76:79]
 s_waitcnt vmcnt(44)
 buffer_load_dwordx4 a[240:243], v4, s[28:31], s53 offen sc1
 v_mfma_f32_16x16x32_bf16 a[76:79], v[76:79], a[188:191], a[76:79]
 s_waitcnt lgkmcnt(15)
 ds_read_b64_tr_b16 v[68:69], v21 offset:27680
 ds_read_b64_tr_b16 v[70:71], v21 offset:32288
 v_mfma_f32_16x16x32_bf16 a[80:83], v[80:83], a[176:179], a[80:83]
 s_waitcnt lgkmcnt(15)
 ds_read_b64_tr_b16 v[72:73], v21 offset:18496
 ds_read_b64_tr_b16 v[74:75], v21 offset:23104
 v_mfma_f32_16x16x32_bf16 a[80:83], v[84:87], a[184:187], a[80:83]
 v_mfma_f32_16x16x32_bf16 a[84:87], v[80:83], a[180:183], a[84:87]
 ds_read_b64_tr_b16 v[76:77], v21 offset:27712
 ds_read_b64_tr_b16 v[78:79], v21 offset:32320
 v_mfma_f32_16x16x32_bf16 a[84:87], v[84:87], a[188:191], a[84:87]
 s_waitcnt lgkmcnt(15)
 buffer_load_dwordx4 v2, s[36:39], s40 offen offset:2048 sc1 lds
 v_mfma_f32_16x16x32_bf16 a[88:91], v[88:91], a[176:179], a[88:91]
 ds_read_b64_tr_b16 v[80:81], v21 offset:18528
 ds_read_b64_tr_b16 v[82:83], v21 offset:23136
 v_mfma_f32_16x16x32_bf16 a[88:91], v[92:95], a[184:187], a[88:91]
 buffer_load_dwordx4 a[244:247], v5, s[28:31], s53 offen sc1
 v_mfma_f32_16x16x32_bf16 a[92:95], v[88:91], a[180:183], a[92:95]
 ds_read_b64_tr_b16 v[84:85], v21 offset:27744
 ds_read_b64_tr_b16 v[86:87], v21 offset:32352
 v_mfma_f32_16x16x32_bf16 a[92:95], v[92:95], a[188:191], a[92:95]
 s_waitcnt lgkmcnt(15)
 v_mfma_f32_16x16x32_bf16 a[96:99], v[48:51], a[176:179], a[96:99]
 ds_read_b64_tr_b16 v[88:89], v22 offset:18432
 ds_read_b64_tr_b16 v[90:91], v22 offset:23040
 v_mfma_f32_16x16x32_bf16 a[96:99], v[52:55], a[184:187], a[96:99]
 v_mfma_f32_16x16x32_bf16 a[100:103], v[48:51], a[180:183], a[100:103]
 ds_read_b64_tr_b16 v[92:93], v22 offset:27648
 ds_read_b64_tr_b16 v[94:95], v22 offset:32256
 v_mfma_f32_16x16x32_bf16 a[100:103], v[52:55], a[188:191], a[100:103]
 s_waitcnt lgkmcnt(15)
 buffer_load_dwordx4 v2, s[36:39], s40 offen offset:3072 sc1 lds
 v_mfma_f32_16x16x32_bf16 a[104:107], v[56:59], a[176:179], a[104:107]
 buffer_load_dwordx4 a[248:251], v4, s[28:31], s53 offen offset:2048 sc1
 v_mfma_f32_16x16x32_bf16 a[104:107], v[60:63], a[184:187], a[104:107]
 v_mfma_f32_16x16x32_bf16 a[108:111], v[56:59], a[180:183], a[108:111]
 v_mfma_f32_16x16x32_bf16 a[108:111], v[60:63], a[188:191], a[108:111]
 s_waitcnt lgkmcnt(14)
 v_mfma_f32_16x16x32_bf16 a[112:115], v[64:67], a[176:179], a[112:115]
 s_waitcnt vmcnt(33) lgkmcnt(12)
 v_mfma_f32_16x16x32_bf16 a[112:115], v[68:71], a[184:187], a[112:115]
 s_waitcnt lgkmcnt(0)
 v_mfma_f32_16x16x32_bf16 a[116:119], v[64:67], a[180:183], a[116:119]
 s_add_u32 m0, s9, 0x2000
 v_mfma_f32_16x16x32_bf16 a[116:119], v[68:71], a[188:191], a[116:119]
 s_add_u32 s40, s52, 0x2000
 s_barrier
 buffer_load_dwordx4 v2, s[36:39], s40 offen sc1 lds
 v_mfma_f32_16x16x32_bf16 a[120:123], v[72:75], a[176:179], a[120:123]
 ds_read_b64_tr_b16 v[48:49], v23
 ds_read_b64_tr_b16 v[50:51], v23 offset:4608
 v_mfma_f32_16x16x32_bf16 a[120:123], v[76:79], a[184:187], a[120:123]
 ds_read_b64_tr_b16 v[52:53], v23 offset:9216
 ds_read_b64_tr_b16 v[54:55], v23 offset:13824
 v_mfma_f32_16x16x32_bf16 a[124:127], v[72:75], a[180:183], a[124:127]
 buffer_load_dwordx4 a[252:255], v5, s[28:31], s53 offen offset:2048 sc1
 v_mfma_f32_16x16x32_bf16 a[124:127], v[76:79], a[188:191], a[124:127]
 ds_read_b64_tr_b16 v[56:57], v23 offset:32
 ds_read_b64_tr_b16 v[58:59], v23 offset:4640
 v_mfma_f32_16x16x32_bf16 a[128:131], v[80:83], a[176:179], a[128:131]
 s_add_u32 s52, s52, 0x9000
 ds_read_b64_tr_b16 v[60:61], v23 offset:9248
 ds_read_b64_tr_b16 v[62:63], v23 offset:13856
 v_mfma_f32_16x16x32_bf16 a[128:131], v[84:87], a[184:187], a[128:131]
 ds_read_b64_tr_b16 v[64:65], v23 offset:64
 ds_read_b64_tr_b16 v[66:67], v23 offset:4672
 v_mfma_f32_16x16x32_bf16 a[132:135], v[80:83], a[180:183], a[132:135]
 ds_read_b64_tr_b16 v[68:69], v23 offset:9280
 ds_read_b64_tr_b16 v[70:71], v23 offset:13888
 v_mfma_f32_16x16x32_bf16 a[132:135], v[84:87], a[188:191], a[132:135]
 ds_read_b64_tr_b16 v[72:73], v23 offset:96
 ds_read_b64_tr_b16 v[74:75], v23 offset:4704
 v_mfma_f32_16x16x32_bf16 a[136:139], v[88:91], a[176:179], a[136:139]
 s_add_u32 s53, s53, 0x1000
 ds_read_b64_tr_b16 v[76:77], v23 offset:9312
 ds_read_b64_tr_b16 v[78:79], v23 offset:13920
 v_mfma_f32_16x16x32_bf16 a[136:139], v[92:95], a[184:187], a[136:139]
 ds_read_b64_tr_b16 v[80:81], v24
 ds_read_b64_tr_b16 v[82:83], v24 offset:4608
 v_mfma_f32_16x16x32_bf16 a[140:143], v[88:91], a[180:183], a[140:143]
 ds_read_b64_tr_b16 v[84:85], v24 offset:9216
 ds_read_b64_tr_b16 v[86:87], v24 offset:13824
 v_mfma_f32_16x16x32_bf16 a[140:143], v[92:95], a[188:191], a[140:143]
L_B3:
 s_waitcnt lgkmcnt(15)
 v_mfma_f32_16x16x32_bf16 a[72:75], v[48:51], v[128:131], a[72:75]
 ds_read_b64_tr_b16 v[88:89], v24 offset:32
 ds_read_b64_tr_b16 v[90:91], v24 offset:4640
 v_mfma_f32_16x16x32_bf16 a[72:75], v[52:55], v[136:139], a[72:75]
 s_add_u32 m0, s10, 0
 v_mfma_f32_16x16x32_bf16 a[76:79], v[48:51], v[132:135], a[76:79]
 s_add_u32 s40, s52, 0
 buffer_load_dwordx4 v2, s[36:39], s40 offen sc1 lds
 v_mfma_f32_16x16x32_bf16 a[76:79], v[52:55], v[140:143], a[76:79]
 s_waitcnt lgkmcnt(15)
 ds_read_b64_tr_b16 v[92:93], v24 offset:9248
 ds_read_b64_tr_b16 v[94:95], v24 offset:13856
 v_mfma_f32_16x16x32_bf16 a[80:83], v[56:59], v[128:131], a[80:83]
 s_waitcnt lgkmcnt(15)
 ds_read_b64_tr_b16 v[48:49], v24 offset:64
 ds_read_b64_tr_b16 v[50:51], v24 offset:4672
 v_mfma_f32_16x16x32_bf16 a[80:83], v[60:63], v[136:139], a[80:83]
 buffer_load_dwordx4 a[160:163], v4, s[28:31], s53 offen sc1
 v_mfma_f32_16x16x32_bf16 a[84:87], v[56:59], v[132:135], a[84:87]
 ds_read_b64_tr_b16 v[52:53], v24 offset:9280
 ds_read_b64_tr_b16 v[54:55], v24 offset:13888
 v_mfma_f32_16x16x32_bf16 a[84:87], v[60:63], v[140:143], a[84:87]
 s_waitcnt lgkmcnt(15)
 v_mfma_f32_16x16x32_bf16 a[88:91], v[64:67], v[128:131], a[88:91]
 ds_read_b64_tr_b16 v[56:57], v24 offset:96
 ds_read_b64_tr_b16 v[58:59], v24 offset:4704
 v_mfma_f32_16x16x32_bf16 a[88:91], v[68:71], v[136:139], a[88:91]
 buffer_load_dwordx4 v2, s[36:39], s40 offen offset:1024 sc1 lds
 v_mfma_f32_16x16x32_bf16 a[92:95], v[64:67], v[132:135], a[92:95]
 ds_read_b64_tr_b16 v[60:61], v24 offset:9312
 ds_read_b64_tr_b16 v[62:63], v24 offset:13920
 v_mfma_f32_16x16x32_bf16 a[92:95], v[68:71], v[140:143], a[92:95]
 s_waitcnt lgkmcnt(15)
 v_mfma_f32_16x16x32_bf16 a[96:99], v[72:75], v[128:131], a[96:99]
 ds_read_b64_tr_b16 v[64:65], v25
 ds_read_b64_tr_b16 v[66:67], v25 offset:4608
 v_mfma_f32_16x16x32_bf16 a[96:99], v[76:79], v[136:139], a[96:99]
 buffer_load_dwordx4 a[164:167], v5, s[28:31], s53 offen sc1
 v_mfma_f32_16x16x32_bf16 a[100:103], v[72:75], v[132:135], a[100:103]
 ds_read_b64_tr_b16 v[68:69], v25 offset:9216
 ds_read_b64_tr_b16 v[70:71], v25 offset:13824
 v_mfma_f32_16x16x32_bf16 a[100:103], v[76:79], v[140:143], a[100:103]
 s_waitcnt lgkmcnt(15)
 buffer_load_dwordx4 v2, s[36:39], s40 offen offset:2048 sc1 lds
 v_mfma_f32_16x16x32_bf16 a[104:107], v[80:83], v[128:131], a[104:107]
 ds_read_b64_tr_b16 v[72:73], v23 offset:18432
 ds_read_b64_tr_b16 v[74:75], v23 offset:23040
 v_mfma_f32_16x16x32_bf16 a[104:107], v[84:87], v[136:139], a[104:107]
 v_mfma_f32_16x16x32_bf16 a[108:111], v[80:83], v[132:135], a[108:111]
 ds_read_b64_tr_b16 v[76:77], v23 offset:27648
 ds_read_b64_tr_b16 v[78:79], v23 offset:32256
 v_mfma_f32_16x16x32_bf16 a[108:111], v[84:87], v[140:143], a[108:111]
 s_waitcnt lgkmcnt(15)
 v_mfma_f32_16x16x32_bf16 a[112:115], v[88:91], v[128:131], a[112:115]
 ds_read_b64_tr_b16 v[80:81], v23 offset:18464
 ds_read_b64_tr_b16 v[82:83], v23 offset:23072
 v_mfma_f32_16x16x32_bf16 a[112:115], v[92:95], v[136:139], a[112:115]
 buffer_load_dwordx4 a[168:171], v4, s[28:31], s53 offen offset:2048 sc1
 v_mfma_f32_16x16x32_bf16 a[116:119], v[88:91], v[132:135], a[116:119]
 ds_read_b64_tr_b16 v[84:85], v23 offset:27680
 ds_read_b64_tr_b16 v[86:87], v23 offset:32288
 v_mfma_f32_16x16x32_bf16 a[116:119], v[92:95], v[140:143], a[116:119]
 s_waitcnt lgkmcnt(15)
 buffer_load_dwordx4 v2, s[36:39], s40 offen offset:3072 sc1 lds
 v_mfma_f32_16x16x32_bf16 a[120:123], v[48:51], v[128:131], a[120:123]
 ds_read_b64_tr_b16 v[88:89], v23 offset:18496
 ds_read_b64_tr_b16 v[90:91], v23 offset:23104
 v_mfma_f32_16x16x32_bf16 a[120:123], v[52:55], v[136:139], a[120:123]
 v_mfma_f32_16x16x32_bf16 a[124:127], v[48:51], v[132:135], a[124:127]
 ds_read_b64_tr_b16 v[92:93], v23 offset:27712
 ds_read_b64_tr_b16 v[94:95], v23 offset:32320
 v_mfma_f32_16x16x32_bf16 a[124:127], v[52:55], v[140:143], a[124:127]
 s_waitcnt lgkmcnt(15)
 v_mfma_f32_16x16x32_bf16 a[128:131], v[56:59], v[128:131], a[128:131]
 ds_read_b64_tr_b16 v[48:49], v23 offset:18528
 ds_read_b64_tr_b16 v[50:51], v23 offset:23136
 v_mfma_f32_16x16x32_bf16 a[128:131], v[60:63], v[136:139], a[128:131]
 s_add_u32 m0, s10, 0x1000
 buffer_load_dwordx4 a[172:175], v5, s[28:31], s53 offen offset:2048 sc1
 v_mfma_f32_16x16x32_bf16 a[132:135], v[56:59], v[132:135], a[132:135]
 s_add_u32 s40, s52, 0x1000
 buffer_load_dwordx4 v2, s[36:39], s40 offen sc1 lds
 v_mfma_f32_16x16x32_bf16 a[132:135], v[60:63], v[140:143], a[132:135]
 s_waitcnt lgkmcnt(15)
 ds_read_b64_tr_b16 v[52:53], v23 offset:27744
 ds_read_b64_tr_b16 v[54:55], v23 offset:32352
 v_mfma_f32_16x16x32_bf16 a[136:139], v[64:67], v[128:131], a[136:139]
 s_waitcnt lgkmcnt(15)
 ds_read_b64_tr_b16 v[56:57], v24 offset:18432
 ds_read_b64_tr_b16 v[58:59], v24 offset:23040
 v_mfma_f32_16x16x32_bf16 a[136:139], v[68:71], v[136:139], a[136:139]
 v_mfma_f32_16x16x32_bf16 a[140:143], v[64:67], v[132:135], a[140:143]
 ds_read_b64_tr_b16 v[60:61], v24 offset:27648
 ds_read_b64_tr_b16 v[62:63], v24 offset:32256
 v_mfma_f32_16x16x32_bf16 a[140:143], v[68:71], v[140:143], a[140:143]
 s_waitcnt lgkmcnt(15)
 v_mfma_f32_16x16x32_bf16 a[72:75], v[72:75], v[144:147], a[72:75]
 s_add_u32 s53, s53, 0x1000
 ds_read_b64_tr_b16 v[64:65], v24 offset:18464
 ds_read_b64_tr_b16 v[66:67], v24 offset:23072
 v_mfma_f32_16x16x32_bf16 a[72:75], v[76:79], v[152:155], a[72:75]
 buffer_load_dwordx4 v2, s[36:39], s40 offen offset:1024 sc1 lds
 v_mfma_f32_16x16x32_bf16 a[76:79], v[72:75], v[148:151], a[76:79]
 s_waitcnt vmcnt(44)
 buffer_load_dwordx4 a[176:179], v4, s[28:31], s53 offen sc1
 v_mfma_f32_16x16x32_bf16 a[76:79], v[76:79], v[156:159], a[76:79]
 s_waitcnt lgkmcnt(15)
 ds_read_b64_tr_b16 v[68:69], v24 offset:27680
 ds_read_b64_tr_b16 v[70:71], v24 offset:32288
 v_mfma_f32_16x16x32_bf16 a[80:83], v[80:83], v[144:147], a[80:83]
 s_waitcnt lgkmcnt(15)
 ds_read_b64_tr_b16 v[72:73], v24 offset:18496
 ds_read_b64_tr_b16 v[74:75], v24 offset:23104
 v_mfma_f32_16x16x32_bf16 a[80:83], v[84:87], v[152:155], a[80:83]
 v_mfma_f32_16x16x32_bf16 a[84:87], v[80:83], v[148:151], a[84:87]
 ds_read_b64_tr_b16 v[76:77], v24 offset:27712
 ds_read_b64_tr_b16 v[78:79], v24 offset:32320
 v_mfma_f32_16x16x32_bf16 a[84:87], v[84:87], v[156:159], a[84:87]
 s_waitcnt lgkmcnt(15)
 buffer_load_dwordx4 v2, s[36:39], s40 offen offset:2048 sc1 lds
 v_mfma_f32_16x16x32_bf16 a[88:91], v[88:91], v[144:147], a[88:91]
 ds_read_b64_tr_b16 v[80:81], v24 offset:18528
 ds_read_b64_tr_b16 v[82:83], v24 offset:23136
 v_mfma_f32_16x16x32_bf16 a[88:91], v[92:95], v[152:155], a[88:91]
 buffer_load_dwordx4 a[180:183], v5, s[28:31], s53 offen sc1
 v_mfma_f32_16x16x32_bf16 a[92:95], v[88:91], v[148:151], a[92:95]
 ds_read_b64_tr_b16 v[84:85], v24 offset:27744
 ds_read_b64_tr_b16 v[86:87], v24 offset:32352
 v_mfma_f32_16x16x32_bf16 a[92:95], v[92:95], v[156:159], a[92:95]
 s_waitcnt lgkmcnt(15)
 v_mfma_f32_16x16x32_bf16 a[96:99], v[48:51], v[144:147], a[96:99]
 ds_read_b64_tr_b16 v[88:89], v25 offset:18432
 ds_read_b64_tr_b16 v[90:91], v25 offset:23040
 v_mfma_f32_16x16x32_bf16 a[96:99], v[52:55], v[152:155], a[96:99]
 v_mfma_f32_16x16x32_bf16 a[100:103], v[48:51], v[148:151], a[100:103]
 ds_read_b64_tr_b16 v[92:93], v25 offset:27648
 ds_read_b64_tr_b16 v[94:95], v25 offset:32256
 v_mfma_f32_16x16x32_bf16 a[100:103], v[52:55], v[156:159], a[100:103]
 s_waitcnt lgkmcnt(15)
 buffer_load_dwordx4 v2, s[36:39], s40 offen offset:3072 sc1 lds
 v_mfma_f32_16x16x32_bf16 a[104:107], v[56:59], v[144:147], a[104:107]
 buffer_load_dwordx4 a[184:187], v4, s[28:31], s53 offen offset:2048 sc1
 v_mfma_f32_16x16x32_bf16 a[104:107], v[60:63], v[152:155], a[104:107]
 v_mfma_f32_16x16x32_bf16 a[108:111], v[56:59], v[148:151], a[108:111]
 v_mfma_f32_16x16x32_bf16 a[108:111], v[60:63], v[156:159], a[108:111]
 s_waitcnt lgkmcnt(14)
 v_mfma_f32_16x16x32_bf16 a[112:115], v[64:67], v[144:147], a[112:115]
 s_waitcnt vmcnt(33) lgkmcnt(12)
 v_mfma_f32_16x16x32_bf16 a[112:115], v[68:71], v[152:155], a[112:115]
 s_waitcnt lgkmcnt(0)
 v_mfma_f32_16x16x32_bf16 a[116:119], v[64:67], v[148:151], a[116:119]
 s_add_u32 m0, s10, 0x2000
 v_mfma_f32_16x16x32_bf16 a[116:119], v[68:71], v[156:159], a[116:119]
 s_add_u32 s40, s52, 0x2000
 s_barrier
 buffer_load_dwordx4 v2, s[36:39], s40 offen sc1 lds
 v_mfma_f32_16x16x32_bf16 a[120:123], v[72:75], v[144:147], a[120:123]
 ds_read_b64_tr_b16 v[48:49], v14
 ds_read_b64_tr_b16 v[50:51], v14 offset:4608
 v_mfma_f32_16x16x32_bf16 a[120:123], v[76:79], v[152:155], a[120:123]
 ds_read_b64_tr_b16 v[52:53], v14 offset:9216
 ds_read_b64_tr_b16 v[54:55], v14 offset:13824
 v_mfma_f32_16x16x32_bf16 a[124:127], v[72:75], v[148:151], a[124:127]
 buffer_load_dwordx4 a[188:191], v5, s[28:31], s53 offen offset:2048 sc1
 v_mfma_f32_16x16x32_bf16 a[124:127], v[76:79], v[156:159], a[124:127]
 ds_read_b64_tr_b16 v[56:57], v14 offset:32
 ds_read_b64_tr_b16 v[58:59], v14 offset:4640
 v_mfma_f32_16x16x32_bf16 a[128:131], v[80:83], v[144:147], a[128:131]
 s_add_u32 s52, s52, 0x9000
 ds_read_b64_tr_b16 v[60:61], v14 offset:9248
 ds_read_b64_tr_b16 v[62:63], v14 offset:13856
 v_mfma_f32_16x16x32_bf16 a[128:131], v[84:87], v[152:155], a[128:131]
 ds_read_b64_tr_b16 v[64:65], v14 offset:64
 ds_read_b64_tr_b16 v[66:67], v14 offset:4672
 v_mfma_f32_16x16x32_bf16 a[132:135], v[80:83], v[148:151], a[132:135]
 ds_read_b64_tr_b16 v[68:69], v14 offset:9280
 ds_read_b64_tr_b16 v[70:71], v14 offset:13888
 v_mfma_f32_16x16x32_bf16 a[132:135], v[84:87], v[156:159], a[132:135]
 ds_read_b64_tr_b16 v[72:73], v14 offset:96
 ds_read_b64_tr_b16 v[74:75], v14 offset:4704
 v_mfma_f32_16x16x32_bf16 a[136:139], v[88:91], v[144:147], a[136:139]
 s_add_u32 s53, s53, 0x1000
 ds_read_b64_tr_b16 v[76:77], v14 offset:9312
 ds_read_b64_tr_b16 v[78:79], v14 offset:13920
 v_mfma_f32_16x16x32_bf16 a[136:139], v[92:95], v[152:155], a[136:139]
 ds_read_b64_tr_b16 v[80:81], v15
 ds_read_b64_tr_b16 v[82:83], v15 offset:4608
 v_mfma_f32_16x16x32_bf16 a[140:143], v[88:91], v[148:151], a[140:143]
 ds_read_b64_tr_b16 v[84:85], v15 offset:9216
 ds_read_b64_tr_b16 v[86:87], v15 offset:13824
 v_mfma_f32_16x16x32_bf16 a[140:143], v[92:95], v[156:159], a[140:143]
 s_sub_u32 s68, s68, 1
 s_cmp_lg_u32 s68, 0
 s_cbranch_scc1 L_B0
L_R:
 s_waitcnt lgkmcnt(15)
 v_mfma_f32_16x16x32_bf16 a[72:75], v[48:51], a[192:195], a[72:75]
 ds_read_b64_tr_b16 v[88:89], v15 offset:32
 ds_read_b64_tr_b16 v[90:91], v15 offset:4640
 v_mfma_f32_16x16x32_bf16 a[72:75], v[52:55], a[200:203], a[72:75]
 s_mul_i32 s52, s70, 0x48000
 v_and_b32 v251, 7, v1
 v_lshlrev_b32 v251, 2, v251
 v_mfma_f32_16x16x32_bf16 a[76:79], v[48:51], a[196:199], a[76:79]
 s_add_u32 s52, s52, s73
 buffer_load_dword v251, v251, s[36:39], s50 offen sc1
 v_mfma_f32_16x16x32_bf16 a[76:79], v[52:55], a[204:207], a[76:79]
 s_waitcnt lgkmcnt(14)
 s_add_u32 s52, s52, s51
 ds_read_b64_tr_b16 v[92:93], v15 offset:9248
 ds_read_b64_tr_b16 v[94:95], v15 offset:13856
 v_mfma_f32_16x16x32_bf16 a[80:83], v[56:59], a[192:195], a[80:83]
 s_add_u32 s52, s52, 0x144000
 ds_read_b64_tr_b16 v[48:49], v15 offset:64
 ds_read_b64_tr_b16 v[50:51], v15 offset:4672
 v_mfma_f32_16x16x32_bf16 a[80:83], v[60:63], a[200:203], a[80:83]
 s_add_u32 m0, s11, 0
 v_mfma_f32_16x16x32_bf16 a[84:87], v[56:59], a[196:199], a[84:87]
 s_add_u32 s40, s52, 0
 buffer_load_dwordx4 v2, s[36:39], s40 offen sc1 lds
 v_mfma_f32_16x16x32_bf16 a[84:87], v[60:63], a[204:207], a[84:87]
 s_waitcnt lgkmcnt(15)
 ds_read_b64_tr_b16 v[52:53], v15 offset:9280
 ds_read_b64_tr_b16 v[54:55], v15 offset:13888
 v_mfma_f32_16x16x32_bf16 a[88:91], v[64:67], a[192:195], a[88:91]
 s_waitcnt lgkmcnt(15)
 ds_read_b64_tr_b16 v[56:57], v15 offset:96
 ds_read_b64_tr_b16 v[58:59], v15 offset:4704
 v_mfma_f32_16x16x32_bf16 a[88:91], v[68:71], a[200:203], a[88:91]
 buffer_load_dwordx4 v2, s[36:39], s40 offen offset:1024 sc1 lds
 v_mfma_f32_16x16x32_bf16 a[92:95], v[64:67], a[196:199], a[92:95]
 ds_read_b64_tr_b16 v[60:61], v15 offset:9312
 ds_read_b64_tr_b16 v[62:63], v15 offset:13920
 v_mfma_f32_16x16x32_bf16 a[92:95], v[68:71], a[204:207], a[92:95]
 s_waitcnt lgkmcnt(15)
 v_mfma_f32_16x16x32_bf16 a[96:99], v[72:75], a[192:195], a[96:99]
 ds_read_b64_tr_b16 v[64:65], v16
 ds_read_b64_tr_b16 v[66:67], v16 offset:4608
 v_mfma_f32_16x16x32_bf16 a[96:99], v[76:79], a[200:203], a[96:99]
 v_mfma_f32_16x16x32_bf16 a[100:103], v[72:75], a[196:199], a[100:103]
 ds_read_b64_tr_b16 v[68:69], v16 offset:9216
 ds_read_b64_tr_b16 v[70:71], v16 offset:13824
 v_mfma_f32_16x16x32_bf16 a[100:103], v[76:79], a[204:207], a[100:103]
 s_waitcnt lgkmcnt(15)
 buffer_load_dwordx4 v2, s[36:39], s40 offen offset:2048 sc1 lds
 v_mfma_f32_16x16x32_bf16 a[104:107], v[80:83], a[192:195], a[104:107]
 ds_read_b64_tr_b16 v[72:73], v14 offset:18432
 ds_read_b64_tr_b16 v[74:75], v14 offset:23040
 v_mfma_f32_16x16x32_bf16 a[104:107], v[84:87], a[200:203], a[104:107]
 v_mfma_f32_16x16x32_bf16 a[108:111], v[80:83], a[196:199], a[108:111]
 ds_read_b64_tr_b16 v[76:77], v14 offset:27648
 ds_read_b64_tr_b16 v[78:79], v14 offset:32256
 v_mfma_f32_16x16x32_bf16 a[108:111], v[84:87], a[204:207], a[108:111]
 s_waitcnt lgkmcnt(15)
 v_mfma_f32_16x16x32_bf16 a[112:115], v[88:91], a[192:195], a[112:115]
 ds_read_b64_tr_b16 v[80:81], v14 offset:18464
 ds_read_b64_tr_b16 v[82:83], v14 offset:23072
 v_mfma_f32_16x16x32_bf16 a[112:115], v[92:95], a[200:203], a[112:115]
 v_mfma_f32_16x16x32_bf16 a[116:119], v[88:91], a[196:199], a[116:119]
 ds_read_b64_tr_b16 v[84:85], v14 offset:27680
 ds_read_b64_tr_b16 v[86:87], v14 offset:32288
 v_mfma_f32_16x16x32_bf16 a[116:119], v[92:95], a[204:207], a[116:119]
 s_waitcnt lgkmcnt(15)
 buffer_load_dwordx4 v2, s[36:39], s40 offen offset:3072 sc1 lds
 v_mfma_f32_16x16x32_bf16 a[120:123], v[48:51], a[192:195], a[120:123]
 ds_read_b64_tr_b16 v[88:89], v14 offset:18496
 ds_read_b64_tr_b16 v[90:91], v14 offset:23104
 v_mfma_f32_16x16x32_bf16 a[120:123], v[52:55], a[200:203], a[120:123]
 v_mfma_f32_16x16x32_bf16 a[124:127], v[48:51], a[196:199], a[124:127]
 ds_read_b64_tr_b16 v[92:93], v14 offset:27712
 ds_read_b64_tr_b16 v[94:95], v14 offset:32320
 v_mfma_f32_16x16x32_bf16 a[124:127], v[52:55], a[204:207], a[124:127]
 s_waitcnt lgkmcnt(15)
 v_mfma_f32_16x16x32_bf16 a[128:131], v[56:59], a[192:195], a[128:131]
 ds_read_b64_tr_b16 v[48:49], v14 offset:18528
 ds_read_b64_tr_b16 v[50:51], v14 offset:23136
 v_mfma_f32_16x16x32_bf16 a[128:131], v[60:63], a[200:203], a[128:131]
 s_add_u32 m0, s11, 0x1000
 v_mfma_f32_16x16x32_bf16 a[132:135], v[56:59], a[196:199], a[132:135]
 s_add_u32 s40, s52, 0x1000
 buffer_load_dwordx4 v2, s[36:39], s40 offen sc1 lds
 v_mfma_f32_16x16x32_bf16 a[132:135], v[60:63], a[204:207], a[132:135]
 s_waitcnt lgkmcnt(15)
 ds_read_b64_tr_b16 v[52:53], v14 offset:27744
 ds_read_b64_tr_b16 v[54:55], v14 offset:32352
 v_mfma_f32_16x16x32_bf16 a[136:139], v[64:67], a[192:195], a[136:139]
 s_waitcnt lgkmcnt(15)
 ds_read_b64_tr_b16 v[56:57], v15 offset:18432
 ds_read_b64_tr_b16 v[58:59], v15 offset:23040
 v_mfma_f32_16x16x32_bf16 a[136:139], v[68:71], a[200:203], a[136:139]
 s_waitcnt vmcnt(5) lgkmcnt(15)
 v_cmp_ne_u32 vcc, s59, v251
 v_mfma_f32_16x16x32_bf16 a[140:143], v[64:67], a[196:199], a[140:143]
 s_cbranch_vccnz L_slO
L_sbO:
 ds_read_b64_tr_b16 v[60:61], v15 offset:27648
 ds_read_b64_tr_b16 v[62:63], v15 offset:32256
 v_mfma_f32_16x16x32_bf16 a[140:143], v[68:71], a[204:207], a[140:143]
 s_lshl_b32 s53, s70, 16
 buffer_load_dwordx4 v[128:131], v4, s[28:31], s53 offen sc1
 v_mfma_f32_16x16x32_bf16 a[72:75], v[72:75], a[208:211], a[72:75]
 s_waitcnt lgkmcnt(15)
 buffer_load_dwordx4 v[132:135], v5, s[28:31], s53 offen sc1
 v_mfma_f32_16x16x32_bf16 a[72:75], v[76:79], a[216:219], a[72:75]
 ds_read_b64_tr_b16 v[64:65], v15 offset:18464
 ds_read_b64_tr_b16 v[66:67], v15 offset:23072
 v_mfma_f32_16x16x32_bf16 a[76:79], v[72:75], a[212:215], a[76:79]
 buffer_load_dwordx4 v2, s[36:39], s40 offen offset:1024 sc1 lds
 v_mfma_f32_16x16x32_bf16 a[76:79], v[76:79], a[220:223], a[76:79]
 s_waitcnt lgkmcnt(15)
 ds_read_b64_tr_b16 v[68:69], v15 offset:27680
 ds_read_b64_tr_b16 v[70:71], v15 offset:32288
 v_mfma_f32_16x16x32_bf16 a[80:83], v[80:83], a[208:211], a[80:83]
 s_waitcnt lgkmcnt(15)
 buffer_load_dwordx4 v[136:139], v4, s[28:31], s53 offen offset:2048 sc1
 v_mfma_f32_16x16x32_bf16 a[80:83], v[84:87], a[216:219], a[80:83]
 ds_read_b64_tr_b16 v[72:73], v15 offset:18496
 ds_read_b64_tr_b16 v[74:75], v15 offset:23104
 v_mfma_f32_16x16x32_bf16 a[84:87], v[80:83], a[212:215], a[84:87]
 ds_read_b64_tr_b16 v[76:77], v15 offset:27712
 ds_read_b64_tr_b16 v[78:79], v15 offset:32320
 v_mfma_f32_16x16x32_bf16 a[84:87], v[84:87], a[220:223], a[84:87]
 s_waitcnt lgkmcnt(15)
 buffer_load_dwordx4 v[140:143], v5, s[28:31], s53 offen offset:2048 sc1
 v_mfma_f32_16x16x32_bf16 a[88:91], v[88:91], a[208:211], a[88:91]
 buffer_load_dwordx4 v2, s[36:39], s40 offen offset:2048 sc1 lds
 v_mfma_f32_16x16x32_bf16 a[88:91], v[92:95], a[216:219], a[88:91]
 ds_read_b64_tr_b16 v[80:81], v15 offset:18528
 ds_read_b64_tr_b16 v[82:83], v15 offset:23136
 v_mfma_f32_16x16x32_bf16 a[92:95], v[88:91], a[212:215], a[92:95]
 s_add_u32 s53, s53, 0x1000
 ds_read_b64_tr_b16 v[84:85], v15 offset:27744
 ds_read_b64_tr_b16 v[86:87], v15 offset:32352
 v_mfma_f32_16x16x32_bf16 a[92:95], v[92:95], a[220:223], a[92:95]
 s_waitcnt lgkmcnt(15)
 buffer_load_dwordx4 v[144:147], v4, s[28:31], s53 offen sc1
 v_mfma_f32_16x16x32_bf16 a[96:99], v[48:51], a[208:211], a[96:99]
 ds_read_b64_tr_b16 v[88:89], v16 offset:18432
 ds_read_b64_tr_b16 v[90:91], v16 offset:23040
 v_mfma_f32_16x16x32_bf16 a[96:99], v[52:55], a[216:219], a[96:99]
 v_mfma_f32_16x16x32_bf16 a[100:103], v[48:51], a[212:215], a[100:103]
 ds_read_b64_tr_b16 v[92:93], v16 offset:27648
 ds_read_b64_tr_b16 v[94:95], v16 offset:32256
 v_mfma_f32_16x16x32_bf16 a[100:103], v[52:55], a[220:223], a[100:103]
 s_waitcnt lgkmcnt(15)
 buffer_load_dwordx4 v2, s[36:39], s40 offen offset:3072 sc1 lds
 v_mfma_f32_16x16x32_bf16 a[104:107], v[56:59], a[208:211], a[104:107]
 buffer_load_dwordx4 v[148:151], v5, s[28:31], s53 offen sc1
 v_mfma_f32_16x16x32_bf16 a[104:107], v[60:63], a[216:219], a[104:107]
 v_mfma_f32_16x16x32_bf16 a[108:111], v[56:59], a[212:215], a[108:111]
 buffer_load_dwordx4 v[152:155], v4, s[28:31], s53 offen offset:2048 sc1
 v_mfma_f32_16x16x32_bf16 a[108:111], v[60:63], a[220:223], a[108:111]
 s_waitcnt lgkmcnt(14)
 v_mfma_f32_16x16x32_bf16 a[112:115], v[64:67], a[208:211], a[112:115]
 s_waitcnt lgkmcnt(12)
 v_mfma_f32_16x16x32_bf16 a[112:115], v[68:71], a[216:219], a[112:115]
 s_waitcnt lgkmcnt(0)
 v_mfma_f32_16x16x32_bf16 a[116:119], v[64:67], a[212:215], a[116:119]
 s_add_u32 m0, s11, 0x2000
 v_mfma_f32_16x16x32_bf16 a[116:119], v[68:71], a[220:223], a[116:119]
 s_add_u32 s40, s52, 0x2000
 s_barrier
 buffer_load_dwordx4 v2, s[36:39], s40 offen sc1 lds
 v_mfma_f32_16x16x32_bf16 a[120:123], v[72:75], a[208:211], a[120:123]
 buffer_load_dwordx4 v[156:159], v5, s[28:31], s53 offen offset:2048 sc1
 v_mfma_f32_16x16x32_bf16 a[120:123], v[76:79], a[216:219], a[120:123]
 ds_read_b64_tr_b16 v[48:49], v17
 ds_read_b64_tr_b16 v[50:51], v17 offset:4608
 v_mfma_f32_16x16x32_bf16 a[124:127], v[72:75], a[212:215], a[124:127]
 s_add_u32 s53, s53, 0x1000
 ds_read_b64_tr_b16 v[52:53], v17 offset:9216
 ds_read_b64_tr_b16 v[54:55], v17 offset:13824
 v_mfma_f32_16x16x32_bf16 a[124:127], v[76:79], a[220:223], a[124:127]
 ds_read_b64_tr_b16 v[56:57], v17 offset:32
 ds_read_b64_tr_b16 v[58:59], v17 offset:4640
 v_mfma_f32_16x16x32_bf16 a[128:131], v[80:83], a[208:211], a[128:131]
 s_add_u32 s52, s52, 0x9000
 ds_read_b64_tr_b16 v[60:61], v17 offset:9248
 ds_read_b64_tr_b16 v[62:63], v17 offset:13856
 v_mfma_f32_16x16x32_bf16 a[128:131], v[84:87], a[216:219], a[128:131]
 ds_read_b64_tr_b16 v[64:65], v17 offset:64
 ds_read_b64_tr_b16 v[66:67], v17 offset:4672
 v_mfma_f32_16x16x32_bf16 a[132:135], v[80:83], a[212:215], a[132:135]
 ds_read_b64_tr_b16 v[68:69], v17 offset:9280
 ds_read_b64_tr_b16 v[70:71], v17 offset:13888
 v_mfma_f32_16x16x32_bf16 a[132:135], v[84:87], a[220:223], a[132:135]
 ds_read_b64_tr_b16 v[72:73], v17 offset:96
 ds_read_b64_tr_b16 v[74:75], v17 offset:4704
 v_mfma_f32_16x16x32_bf16 a[136:139], v[88:91], a[208:211], a[136:139]
 ds_read_b64_tr_b16 v[76:77], v17 offset:9312
 ds_read_b64_tr_b16 v[78:79], v17 offset:13920
 v_mfma_f32_16x16x32_bf16 a[136:139], v[92:95], a[216:219], a[136:139]
 ds_read_b64_tr_b16 v[80:81], v18
 ds_read_b64_tr_b16 v[82:83], v18 offset:4608
 v_mfma_f32_16x16x32_bf16 a[140:143], v[88:91], a[212:215], a[140:143]
 ds_read_b64_tr_b16 v[84:85], v18 offset:9216
 ds_read_b64_tr_b16 v[86:87], v18 offset:13824
 v_mfma_f32_16x16x32_bf16 a[140:143], v[92:95], a[220:223], a[140:143]
 s_waitcnt lgkmcnt(15)
 v_mfma_f32_16x16x32_bf16 a[72:75], v[48:51], a[224:227], a[72:75]
 ds_read_b64_tr_b16 v[88:89], v18 offset:32
 ds_read_b64_tr_b16 v[90:91], v18 offset:4640
 v_mfma_f32_16x16x32_bf16 a[72:75], v[52:55], a[232:235], a[72:75]
 s_add_u32 m0, s8, 0
 v_mfma_f32_16x16x32_bf16 a[76:79], v[48:51], a[228:231], a[76:79]
 s_add_u32 s40, s52, 0
 buffer_load_dwordx4 v2, s[36:39], s40 offen sc1 lds
 v_mfma_f32_16x16x32_bf16 a[76:79], v[52:55], a[236:239], a[76:79]
 s_waitcnt lgkmcnt(15)
 ds_read_b64_tr_b16 v[92:93], v18 offset:9248
 ds_read_b64_tr_b16 v[94:95], v18 offset:13856
 v_mfma_f32_16x16x32_bf16 a[80:83], v[56:59], a[224:227], a[80:83]
 s_waitcnt lgkmcnt(15)
 ds_read_b64_tr_b16 v[48:49], v18 offset:64
 ds_read_b64_tr_b16 v[50:51], v18 offset:4672
 v_mfma_f32_16x16x32_bf16 a[80:83], v[60:63], a[232:235], a[80:83]
 buffer_load_dwordx4 a[192:195], v4, s[28:31], s53 offen sc1
 v_mfma_f32_16x16x32_bf16 a[84:87], v[56:59], a[228:231], a[84:87]
 ds_read_b64_tr_b16 v[52:53], v18 offset:9280
 ds_read_b64_tr_b16 v[54:55], v18 offset:13888
 v_mfma_f32_16x16x32_bf16 a[84:87], v[60:63], a[236:239], a[84:87]
 s_waitcnt lgkmcnt(15)
 v_mfma_f32_16x16x32_bf16 a[88:91], v[64:67], a[224:227], a[88:91]
 ds_read_b64_tr_b16 v[56:57], v18 offset:96
 ds_read_b64_tr_b16 v[58:59], v18 offset:4704
 v_mfma_f32_16x16x32_bf16 a[88:91], v[68:71], a[232:235], a[88:91]
 buffer_load_dwordx4 v2, s[36:39], s40 offen offset:1024 sc1 lds
 v_mfma_f32_16x16x32_bf16 a[92:95], v[64:67], a[228:231], a[92:95]
 ds_read_b64_tr_b16 v[60:61], v18 offset:9312
 ds_read_b64_tr_b16 v[62:63], v18 offset:13920
 v_mfma_f32_16x16x32_bf16 a[92:95], v[68:71], a[236:239], a[92:95]
 s_waitcnt lgkmcnt(15)
 v_mfma_f32_16x16x32_bf16 a[96:99], v[72:75], a[224:227], a[96:99]
 ds_read_b64_tr_b16 v[64:65], v19
 ds_read_b64_tr_b16 v[66:67], v19 offset:4608
 v_mfma_f32_16x16x32_bf16 a[96:99], v[76:79], a[232:235], a[96:99]
 buffer_load_dwordx4 a[196:199], v5, s[28:31], s53 offen sc1
 v_mfma_f32_16x16x32_bf16 a[100:103], v[72:75], a[228:231], a[100:103]
 ds_read_b64_tr_b16 v[68:69], v19 offset:9216
 ds_read_b64_tr_b16 v[70:71], v19 offset:13824
 v_mfma_f32_16x16x32_bf16 a[100:103], v[76:79], a[236:239], a[100:103]
 s_waitcnt lgkmcnt(15)
 buffer_load_dwordx4 v2, s[36:39], s40 offen offset:2048 sc1 lds
 v_mfma_f32_16x16x32_bf16 a[104:107], v[80:83], a[224:227], a[104:107]
 ds_read_b64_tr_b16 v[72:73], v17 offset:18432
 ds_read_b64_tr_b16 v[74:75], v17 offset:23040
 v_mfma_f32_16x16x32_bf16 a[104:107], v[84:87], a[232:235], a[104:107]
 v_mfma_f32_16x16x32_bf16 a[108:111], v[80:83], a[228:231], a[108:111]
 ds_read_b64_tr_b16 v[76:77], v17 offset:27648
 ds_read_b64_tr_b16 v[78:79], v17 offset:32256
 v_mfma_f32_16x16x32_bf16 a[108:111], v[84:87], a[236:239], a[108:111]
 s_waitcnt lgkmcnt(15)
 v_mfma_f32_16x16x32_bf16 a[112:115], v[88:91], a[224:227], a[112:115]
 ds_read_b64_tr_b16 v[80:81], v17 offset:18464
 ds_read_b64_tr_b16 v[82:83], v17 offset:23072
 v_mfma_f32_16x16x32_bf16 a[112:115], v[92:95], a[232:235], a[112:115]
 buffer_load_dwordx4 a[200:203], v4, s[28:31], s53 offen offset:2048 sc1
 v_mfma_f32_16x16x32_bf16 a[116:119], v[88:91], a[228:231], a[116:119]
 ds_read_b64_tr_b16 v[84:85], v17 offset:27680
 ds_read_b64_tr_b16 v[86:87], v17 offset:32288
 v_mfma_f32_16x16x32_bf16 a[116:119], v[92:95], a[236:239], a[116:119]
 s_waitcnt lgkmcnt(15)
 buffer_load_dwordx4 v2, s[36:39], s40 offen offset:3072 sc1 lds
 v_mfma_f32_16x16x32_bf16 a[120:123], v[48:51], a[224:227], a[120:123]
 ds_read_b64_tr_b16 v[88:89], v17 offset:18496
 ds_read_b64_tr_b16 v[90:91], v17 offset:23104
 v_mfma_f32_16x16x32_bf16 a[120:123], v[52:55], a[232:235], a[120:123]
 v_mfma_f32_16x16x32_bf16 a[124:127], v[48:51], a[228:231], a[124:127]
 ds_read_b64_tr_b16 v[92:93], v17 offset:27712
 ds_read_b64_tr_b16 v[94:95], v17 offset:32320
 v_mfma_f32_16x16x32_bf16 a[124:127], v[52:55], a[236:239], a[124:127]
 s_waitcnt lgkmcnt(15)
 v_mfma_f32_16x16x32_bf16 a[128:131], v[56:59], a[224:227], a[128:131]
 ds_read_b64_tr_b16 v[48:49], v17 offset:18528
 ds_read_b64_tr_b16 v[50:51], v17 offset:23136
 v_mfma_f32_16x16x32_bf16 a[128:131], v[60:63], a[232:235], a[128:131]
 s_add_u32 m0, s8, 0x1000
 buffer_load_dwordx4 a[204:207], v5, s[28:31], s53 offen offset:2048 sc1
 v_mfma_f32_16x16x32_bf16 a[132:135], v[56:59], a[228:231], a[132:135]
 s_add_u32 s40, s52, 0x1000
 buffer_load_dwordx4 v2, s[36:39], s40 offen sc1 lds
 v_mfma_f32_16x16x32_bf16 a[132:135], v[60:63], a[236:239], a[132:135]
 s_waitcnt lgkmcnt(14)
 s_lshl_b32 s18, s71, 2
 ds_read_b64_tr_b16 v[52:53], v17 offset:27744
 ds_read_b64_tr_b16 v[54:55], v17 offset:32352
 v_mfma_f32_16x16x32_bf16 a[136:139], v[64:67], a[224:227], a[136:139]
 s_add_u32 s18, s18, s3
 ds_read_b64_tr_b16 v[56:57], v18 offset:18432
 ds_read_b64_tr_b16 v[58:59], v18 offset:23040
 v_mfma_f32_16x16x32_bf16 a[136:139], v[68:71], a[232:235], a[136:139]
 s_mov_b32 s32, s12
 v_and_b32 v9, 15, v1
 v_mul_u32_u24 v9, 0x480, v9
 v_mfma_f32_16x16x32_bf16 a[140:143], v[64:67], a[228:231], a[140:143]
 s_mov_b32 s33, s13
 ds_read_b64_tr_b16 v[60:61], v18 offset:27648
 ds_read_b64_tr_b16 v[62:63], v18 offset:32256
 v_mfma_f32_16x16x32_bf16 a[140:143], v[68:71], a[236:239], a[140:143]
 s_waitcnt lgkmcnt(15)
 s_mov_b32 s34, 0x240000
 v_lshrrev_b32 v241, 4, v1
 v_lshl_add_u32 v9, v241, 3, v9
 v_mfma_f32_16x16x32_bf16 a[72:75], v[72:75], a[240:243], a[72:75]
 s_mov_b32 s35, 0x20000
 ds_read_b64_tr_b16 v[64:65], v18 offset:18464
 ds_read_b64_tr_b16 v[66:67], v18 offset:23072
 v_mfma_f32_16x16x32_bf16 a[72:75], v[76:79], a[248:251], a[72:75]
 s_mul_i32 s18, s18, 0x9000
 buffer_load_dwordx4 v2, s[36:39], s40 offen offset:1024 sc1 lds
 v_mfma_f32_16x16x32_bf16 a[76:79], v[72:75], a[244:247], a[76:79]
 s_mul_i32 s19, s54, 18
 ds_read_b64_tr_b16 v[68:69], v18 offset:27680
 ds_read_b64_tr_b16 v[70:71], v18 offset:32288
 v_mfma_f32_16x16x32_bf16 a[76:79], v[76:79], a[252:255], a[76:79]
 s_waitcnt lgkmcnt(15)
 s_add_u32 s18, s18, s19
 v_mfma_f32_16x16x32_bf16 a[80:83], v[80:83], a[240:243], a[80:83]
 s_mul_i32 s19, s72, 0x120
 ds_read_b64_tr_b16 v[72:73], v18 offset:18496
 ds_read_b64_tr_b16 v[74:75], v18 offset:23104
 v_mfma_f32_16x16x32_bf16 a[80:83], v[84:87], a[248:251], a[80:83]
 s_add_u32 s18, s18, s19
 v_add_u32 v9, s18, v9
 v_mfma_f32_16x16x32_bf16 a[84:87], v[80:83], a[244:247], a[84:87]
 s_lshl_b32 s19, s56, 7
 ds_read_b64_tr_b16 v[76:77], v18 offset:27712
 ds_read_b64_tr_b16 v[78:79], v18 offset:32320
 v_mfma_f32_16x16x32_bf16 a[84:87], v[84:87], a[252:255], a[84:87]
 s_waitcnt lgkmcnt(15)
 s_add_u32 s53, s53, 0x1000
 buffer_load_dwordx4 a[208:211], v4, s[28:31], s53 offen sc1
 v_mfma_f32_16x16x32_bf16 a[88:91], v[88:91], a[240:243], a[88:91]
 buffer_load_dwordx4 v2, s[36:39], s40 offen offset:2048 sc1 lds
 v_mfma_f32_16x16x32_bf16 a[88:91], v[92:95], a[248:251], a[88:91]
 ds_read_b64_tr_b16 v[80:81], v18 offset:18528
 ds_read_b64_tr_b16 v[82:83], v18 offset:23136
 v_mfma_f32_16x16x32_bf16 a[92:95], v[88:91], a[244:247], a[92:95]
 buffer_load_dwordx4 a[212:215], v5, s[28:31], s53 offen sc1
 v_mfma_f32_16x16x32_bf16 a[92:95], v[92:95], a[252:255], a[92:95]
 s_waitcnt lgkmcnt(15)
 ds_read_b64_tr_b16 v[84:85], v18 offset:27744
 ds_read_b64_tr_b16 v[86:87], v18 offset:32352
 v_mfma_f32_16x16x32_bf16 a[96:99], v[48:51], a[240:243], a[96:99]
 s_waitcnt lgkmcnt(15)
 ds_read_b64_tr_b16 v[88:89], v19 offset:18432
 ds_read_b64_tr_b16 v[90:91], v19 offset:23040
 v_mfma_f32_16x16x32_bf16 a[96:99], v[52:55], a[248:251], a[96:99]
 v_add_u32 v8, s19, v9
 v_add_u32 v9, 0x100, v9
 v_mfma_f32_16x16x32_bf16 a[100:103], v[48:51], a[244:247], a[100:103]
 ds_read_b64_tr_b16 v[92:93], v19 offset:27648
 ds_read_b64_tr_b16 v[94:95], v19 offset:32256
 v_mfma_f32_16x16x32_bf16 a[100:103], v[52:55], a[252:255], a[100:103]
 s_waitcnt lgkmcnt(15)
 buffer_load_dwordx4 v2, s[36:39], s40 offen offset:3072 sc1 lds
 v_mfma_f32_16x16x32_bf16 a[104:107], v[56:59], a[240:243], a[104:107]
 buffer_load_dwordx4 a[216:219], v4, s[28:31], s53 offen offset:2048 sc1
 v_mfma_f32_16x16x32_bf16 a[104:107], v[60:63], a[248:251], a[104:107]
 v_mfma_f32_16x16x32_bf16 a[108:111], v[56:59], a[244:247], a[108:111]
 v_mfma_f32_16x16x32_bf16 a[108:111], v[60:63], a[252:255], a[108:111]
 s_waitcnt lgkmcnt(14)
 v_mfma_f32_16x16x32_bf16 a[112:115], v[64:67], a[240:243], a[112:115]
 s_waitcnt lgkmcnt(12)
 v_mfma_f32_16x16x32_bf16 a[112:115], v[68:71], a[248:251], a[112:115]
 s_waitcnt lgkmcnt(0)
 v_mfma_f32_16x16x32_bf16 a[116:119], v[64:67], a[244:247], a[116:119]
 s_add_u32 m0, s8, 0x2000
 v_mfma_f32_16x16x32_bf16 a[116:119], v[68:71], a[252:255], a[116:119]
 s_add_u32 s40, s52, 0x2000
 s_barrier
 buffer_load_dwordx4 v2, s[36:39], s40 offen sc1 lds
 v_mfma_f32_16x16x32_bf16 a[120:123], v[72:75], a[240:243], a[120:123]
 ds_read_b64_tr_b16 v[48:49], v20
 ds_read_b64_tr_b16 v[50:51], v20 offset:4608
 v_mfma_f32_16x16x32_bf16 a[120:123], v[76:79], a[248:251], a[120:123]
 ds_read_b64_tr_b16 v[52:53], v20 offset:9216
 ds_read_b64_tr_b16 v[54:55], v20 offset:13824
 v_mfma_f32_16x16x32_bf16 a[124:127], v[72:75], a[244:247], a[124:127]
 buffer_load_dwordx4 a[220:223], v5, s[28:31], s53 offen offset:2048 sc1
 v_mfma_f32_16x16x32_bf16 a[124:127], v[76:79], a[252:255], a[124:127]
 ds_read_b64_tr_b16 v[56:57], v20 offset:32
 ds_read_b64_tr_b16 v[58:59], v20 offset:4640
 v_mfma_f32_16x16x32_bf16 a[128:131], v[80:83], a[240:243], a[128:131]
 s_add_u32 s52, s52, 0x9000
 ds_read_b64_tr_b16 v[60:61], v20 offset:9248
 ds_read_b64_tr_b16 v[62:63], v20 offset:13856
 v_mfma_f32_16x16x32_bf16 a[128:131], v[84:87], a[248:251], a[128:131]
 ds_read_b64_tr_b16 v[64:65], v20 offset:64
 ds_read_b64_tr_b16 v[66:67], v20 offset:4672
 v_mfma_f32_16x16x32_bf16 a[132:135], v[80:83], a[244:247], a[132:135]
 ds_read_b64_tr_b16 v[68:69], v20 offset:9280
 ds_read_b64_tr_b16 v[70:71], v20 offset:13888
 v_mfma_f32_16x16x32_bf16 a[132:135], v[84:87], a[252:255], a[132:135]
 ds_read_b64_tr_b16 v[72:73], v20 offset:96
 ds_read_b64_tr_b16 v[74:75], v20 offset:4704
 v_mfma_f32_16x16x32_bf16 a[136:139], v[88:91], a[240:243], a[136:139]
 s_add_u32 s53, s53, 0x1000
 ds_read_b64_tr_b16 v[76:77], v20 offset:9312
 ds_read_b64_tr_b16 v[78:79], v20 offset:13920
 v_mfma_f32_16x16x32_bf16 a[136:139], v[92:95], a[248:251], a[136:139]
 ds_read_b64_tr_b16 v[80:81], v21
 ds_read_b64_tr_b16 v[82:83], v21 offset:4608
 v_mfma_f32_16x16x32_bf16 a[140:143], v[88:91], a[244:247], a[140:143]
 ds_read_b64_tr_b16 v[84:85], v21 offset:9216
 ds_read_b64_tr_b16 v[86:87], v21 offset:13824
 v_mfma_f32_16x16x32_bf16 a[140:143], v[92:95], a[252:255], a[140:143]
 s_waitcnt lgkmcnt(15)
 v_mfma_f32_16x16x32_bf16 a[72:75], v[48:51], a[160:163], a[72:75]
 ds_read_b64_tr_b16 v[88:89], v21 offset:32
 ds_read_b64_tr_b16 v[90:91], v21 offset:4640
 v_mfma_f32_16x16x32_bf16 a[72:75], v[52:55], a[168:171], a[72:75]
 s_add_u32 m0, s9, 0
 v_mfma_f32_16x16x32_bf16 a[76:79], v[48:51], a[164:167], a[76:79]
 s_add_u32 s40, s52, 0
 buffer_load_dwordx4 v2, s[36:39], s40 offen sc1 lds
 v_mfma_f32_16x16x32_bf16 a[76:79], v[52:55], a[172:175], a[76:79]
 s_waitcnt lgkmcnt(15)
 ds_read_b64_tr_b16 v[92:93], v21 offset:9248
 ds_read_b64_tr_b16 v[94:95], v21 offset:13856
 v_mfma_f32_16x16x32_bf16 a[80:83], v[56:59], a[160:163], a[80:83]
 s_waitcnt lgkmcnt(15)
 ds_read_b64_tr_b16 v[48:49], v21 offset:64
 ds_read_b64_tr_b16 v[50:51], v21 offset:4672
 v_mfma_f32_16x16x32_bf16 a[80:83], v[60:63], a[168:171], a[80:83]
 buffer_load_dwordx4 a[224:227], v4, s[28:31], s53 offen sc1
 v_mfma_f32_16x16x32_bf16 a[84:87], v[56:59], a[164:167], a[84:87]
 ds_read_b64_tr_b16 v[52:53], v21 offset:9280
 ds_read_b64_tr_b16 v[54:55], v21 offset:13888
 v_mfma_f32_16x16x32_bf16 a[84:87], v[60:63], a[172:175], a[84:87]
 s_waitcnt lgkmcnt(15)
 v_mfma_f32_16x16x32_bf16 a[88:91], v[64:67], a[160:163], a[88:91]
 ds_read_b64_tr_b16 v[56:57], v21 offset:96
 ds_read_b64_tr_b16 v[58:59], v21 offset:4704
 v_mfma_f32_16x16x32_bf16 a[88:91], v[68:71], a[168:171], a[88:91]
 s_waitcnt lgkmcnt(15)
 buffer_load_dwordx4 v2, s[36:39], s40 offen offset:1024 sc1 lds
 v_mfma_f32_16x16x32_bf16 a[92:95], v[64:67], a[164:167], a[92:95]
 s_getpc_b64 s[62:63]
L_pcR1:
 s_add_u32 s62, s62, L_pcR1+4096-L_pcR1
 s_addc_u32 s63, s63, 0
 ds_read_b64_tr_b16 v[60:61], v21 offset:9312
 ds_read_b64_tr_b16 v[62:63], v21 offset:13920
 v_mfma_f32_16x16x32_bf16 a[92:95], v[68:71], a[172:175], a[92:95]
 s_bfe_u32 s18, s2, 0x10003
 v_and_b32 v246, 15, v1
 v_lshlrev_b32 v246, 7, v246
 v_mfma_f32_16x16x32_bf16 a[96:99], v[72:75], a[160:163], a[96:99]
 s_waitcnt lgkmcnt(15)
 s_lshl_b32 s18, s18, 2
 ds_read_b64_tr_b16 v[64:65], v22
 ds_read_b64_tr_b16 v[66:67], v22 offset:4608
 v_mfma_f32_16x16x32_bf16 a[96:99], v[76:79], a[168:171], a[96:99]
 s_add_u32 s18, s18, s3
 v_mfma_f32_16x16x32_bf16 a[100:103], v[72:75], a[164:167], a[100:103]
 s_lshl_b32 s18, s18, 11
 ds_read_b64_tr_b16 v[68:69], v22 offset:9216
 ds_read_b64_tr_b16 v[70:71], v22 offset:13824
 v_mfma_f32_16x16x32_bf16 a[100:103], v[76:79], a[172:175], a[100:103]
 s_waitcnt lgkmcnt(15)
 s_add_u32 s62, s62, s18
 s_addc_u32 s63, s63, 0
 v_mov_b32 v247, s63
 v_mfma_f32_16x16x32_bf16 a[104:107], v[80:83], a[160:163], a[104:107]
 v_add_co_u32 v246, vcc, s62, v246
 s_nop 1
 v_addc_co_u32 v247, vcc, 0, v247, vcc
 v_mfma_f32_16x16x32_bf16 a[104:107], v[84:87], a[168:171], a[104:107]
 global_load_dword v250, v[246:247], off
 v_mfma_f32_16x16x32_bf16 a[108:111], v[80:83], a[164:167], a[108:111]
 buffer_load_dwordx4 a[228:231], v5, s[28:31], s53 offen sc1
 v_mfma_f32_16x16x32_bf16 a[108:111], v[84:87], a[172:175], a[108:111]
 s_waitcnt lgkmcnt(14)
 buffer_load_dwordx4 v2, s[36:39], s40 offen offset:2048 sc1 lds
 v_mfma_f32_16x16x32_bf16 a[112:115], v[88:91], a[160:163], a[112:115]
 s_waitcnt lgkmcnt(12)
 ds_read_b64_tr_b16 v[72:73], v20 offset:18432
 ds_read_b64_tr_b16 v[74:75], v20 offset:23040
 v_mfma_f32_16x16x32_bf16 a[112:115], v[92:95], a[168:171], a[112:115]
 ds_read_b64_tr_b16 v[76:77], v20 offset:27648
 ds_read_b64_tr_b16 v[78:79], v20 offset:32256
 v_mfma_f32_16x16x32_bf16 a[116:119], v[88:91], a[164:167], a[116:119]
 ds_read_b64_tr_b16 v[80:81], v20 offset:18464
 ds_read_b64_tr_b16 v[82:83], v20 offset:23072
 v_mfma_f32_16x16x32_bf16 a[116:119], v[92:95], a[172:175], a[116:119]
 s_waitcnt lgkmcnt(15)
 buffer_load_dwordx4 a[232:235], v4, s[28:31], s53 offen offset:2048 sc1
 v_mfma_f32_16x16x32_bf16 a[120:123], v[48:51], a[160:163], a[120:123]
 s_waitcnt lgkmcnt(14)
 ds_read_b64_tr_b16 v[84:85], v20 offset:27680
 ds_read_b64_tr_b16 v[86:87], v20 offset:32288
 v_mfma_f32_16x16x32_bf16 a[120:123], v[52:55], a[168:171], a[120:123]
 buffer_load_dwordx4 v2, s[36:39], s40 offen offset:3072 sc1 lds
 v_mfma_f32_16x16x32_bf16 a[124:127], v[48:51], a[164:167], a[124:127]
 ds_read_b64_tr_b16 v[88:89], v20 offset:18496
 ds_read_b64_tr_b16 v[90:91], v20 offset:23104
 v_mfma_f32_16x16x32_bf16 a[124:127], v[52:55], a[172:175], a[124:127]
 s_waitcnt lgkmcnt(15)
 ds_read_b64_tr_b16 v[92:93], v20 offset:27712
 ds_read_b64_tr_b16 v[94:95], v20 offset:32320
 v_mfma_f32_16x16x32_bf16 a[128:131], v[56:59], a[160:163], a[128:131]
 s_waitcnt lgkmcnt(15)
 ds_read_b64_tr_b16 v[48:49], v20 offset:18528
 ds_read_b64_tr_b16 v[50:51], v20 offset:23136
 v_mfma_f32_16x16x32_bf16 a[128:131], v[60:63], a[168:171], a[128:131]
 s_add_u32 m0, s9, 0x1000
 buffer_load_dwordx4 a[236:239], v5, s[28:31], s53 offen offset:2048 sc1
 v_mfma_f32_16x16x32_bf16 a[132:135], v[56:59], a[164:167], a[132:135]
 s_add_u32 s40, s52, 0x1000
 buffer_load_dwordx4 v2, s[36:39], s40 offen sc1 lds
 v_mfma_f32_16x16x32_bf16 a[132:135], v[60:63], a[172:175], a[132:135]
 s_waitcnt lgkmcnt(15)
 ds_read_b64_tr_b16 v[52:53], v20 offset:27744
 ds_read_b64_tr_b16 v[54:55], v20 offset:32352
 v_mfma_f32_16x16x32_bf16 a[136:139], v[64:67], a[160:163], a[136:139]
 s_waitcnt lgkmcnt(15)
 ds_read_b64_tr_b16 v[56:57], v21 offset:18432
 ds_read_b64_tr_b16 v[58:59], v21 offset:23040
 v_mfma_f32_16x16x32_bf16 a[136:139], v[68:71], a[168:171], a[136:139]
 v_mfma_f32_16x16x32_bf16 a[140:143], v[64:67], a[164:167], a[140:143]
 ds_read_b64_tr_b16 v[60:61], v21 offset:27648
 ds_read_b64_tr_b16 v[62:63], v21 offset:32256
 v_mfma_f32_16x16x32_bf16 a[140:143], v[68:71], a[172:175], a[140:143]
 s_waitcnt lgkmcnt(15)
 v_mfma_f32_16x16x32_bf16 a[72:75], v[72:75], a[176:179], a[72:75]
 s_add_u32 s53, s53, 0x1000
 ds_read_b64_tr_b16 v[64:65], v21 offset:18464
 ds_read_b64_tr_b16 v[66:67], v21 offset:23072
 v_mfma_f32_16x16x32_bf16 a[72:75], v[76:79], a[184:187], a[72:75]
 buffer_load_dwordx4 v2, s[36:39], s40 offen offset:1024 sc1 lds
 v_mfma_f32_16x16x32_bf16 a[76:79], v[72:75], a[180:183], a[76:79]
 buffer_load_dwordx4 a[240:243], v4, s[28:31], s53 offen sc1
 v_mfma_f32_16x16x32_bf16 a[76:79], v[76:79], a[188:191], a[76:79]
 s_waitcnt lgkmcnt(15)
 ds_read_b64_tr_b16 v[68:69], v21 offset:27680
 ds_read_b64_tr_b16 v[70:71], v21 offset:32288
 v_mfma_f32_16x16x32_bf16 a[80:83], v[80:83], a[176:179], a[80:83]
 s_waitcnt lgkmcnt(15)
 ds_read_b64_tr_b16 v[72:73], v21 offset:18496
 ds_read_b64_tr_b16 v[74:75], v21 offset:23104
 v_mfma_f32_16x16x32_bf16 a[80:83], v[84:87], a[184:187], a[80:83]
 v_mfma_f32_16x16x32_bf16 a[84:87], v[80:83], a[180:183], a[84:87]
 ds_read_b64_tr_b16 v[76:77], v21 offset:27712
 ds_read_b64_tr_b16 v[78:79], v21 offset:32320
 v_mfma_f32_16x16x32_bf16 a[84:87], v[84:87], a[188:191], a[84:87]
 s_waitcnt lgkmcnt(15)
 buffer_load_dwordx4 v2, s[36:39], s40 offen offset:2048 sc1 lds
 v_mfma_f32_16x16x32_bf16 a[88:91], v[88:91], a[176:179], a[88:91]
 ds_read_b64_tr_b16 v[80:81], v21 offset:18528
 ds_read_b64_tr_b16 v[82:83], v21 offset:23136
 v_mfma_f32_16x16x32_bf16 a[88:91], v[92:95], a[184:187], a[88:91]
 buffer_load_dwordx4 a[244:247], v5, s[28:31], s53 offen sc1
 v_mfma_f32_16x16x32_bf16 a[92:95], v[88:91], a[180:183], a[92:95]
 ds_read_b64_tr_b16 v[84:85], v21 offset:27744
 ds_read_b64_tr_b16 v[86:87], v21 offset:32352
 v_mfma_f32_16x16x32_bf16 a[92:95], v[92:95], a[188:191], a[92:95]
 s_waitcnt lgkmcnt(15)
 v_mfma_f32_16x16x32_bf16 a[96:99], v[48:51], a[176:179], a[96:99]
 ds_read_b64_tr_b16 v[88:89], v22 offset:18432
 ds_read_b64_tr_b16 v[90:91], v22 offset:23040
 v_mfma_f32_16x16x32_bf16 a[96:99], v[52:55], a[184:187], a[96:99]
 v_mfma_f32_16x16x32_bf16 a[100:103], v[48:51], a[180:183], a[100:103]
 ds_read_b64_tr_b16 v[92:93], v22 offset:27648
 ds_read_b64_tr_b16 v[94:95], v22 offset:32256
 v_mfma_f32_16x16x32_bf16 a[100:103], v[52:55], a[188:191], a[100:103]
 s_waitcnt lgkmcnt(15)
 buffer_load_dwordx4 v2, s[36:39], s40 offen offset:3072 sc1 lds
 v_mfma_f32_16x16x32_bf16 a[104:107], v[56:59], a[176:179], a[104:107]
 buffer_load_dwordx4 a[248:251], v4, s[28:31], s53 offen offset:2048 sc1
 v_mfma_f32_16x16x32_bf16 a[104:107], v[60:63], a[184:187], a[104:107]
 v_mfma_f32_16x16x32_bf16 a[108:111], v[56:59], a[180:183], a[108:111]
 v_mfma_f32_16x16x32_bf16 a[108:111], v[60:63], a[188:191], a[108:111]
 s_waitcnt lgkmcnt(14)
 v_mfma_f32_16x16x32_bf16 a[112:115], v[64:67], a[176:179], a[112:115]
 s_waitcnt vmcnt(34) lgkmcnt(12)
 v_mfma_f32_16x16x32_bf16 a[112:115], v[68:71], a[184:187], a[112:115]
 s_waitcnt lgkmcnt(0)
 v_mfma_f32_16x16x32_bf16 a[116:119], v[64:67], a[180:183], a[116:119]
 s_add_u32 m0, s9, 0x2000
 v_mfma_f32_16x16x32_bf16 a[116:119], v[68:71], a[188:191], a[116:119]
 s_add_u32 s40, s52, 0x2000
 s_barrier
 buffer_load_dwordx4 v2, s[36:39], s40 offen sc1 lds
 v_mfma_f32_16x16x32_bf16 a[120:123], v[72:75], a[176:179], a[120:123]
 ds_read_b64_tr_b16 v[48:49], v23
 ds_read_b64_tr_b16 v[50:51], v23 offset:4608
 v_mfma_f32_16x16x32_bf16 a[120:123], v[76:79], a[184:187], a[120:123]
 ds_read_b64_tr_b16 v[52:53], v23 offset:9216
 ds_read_b64_tr_b16 v[54:55], v23 offset:13824
 v_mfma_f32_16x16x32_bf16 a[124:127], v[72:75], a[180:183], a[124:127]
 buffer_load_dwordx4 a[252:255], v5, s[28:31], s53 offen offset:2048 sc1
 v_mfma_f32_16x16x32_bf16 a[124:127], v[76:79], a[188:191], a[124:127]
 ds_read_b64_tr_b16 v[56:57], v23 offset:32
 ds_read_b64_tr_b16 v[58:59], v23 offset:4640
 v_mfma_f32_16x16x32_bf16 a[128:131], v[80:83], a[176:179], a[128:131]
 s_add_u32 s52, s52, 0x9000
 ds_read_b64_tr_b16 v[60:61], v23 offset:9248
 ds_read_b64_tr_b16 v[62:63], v23 offset:13856
 v_mfma_f32_16x16x32_bf16 a[128:131], v[84:87], a[184:187], a[128:131]
 ds_read_b64_tr_b16 v[64:65], v23 offset:64
 ds_read_b64_tr_b16 v[66:67], v23 offset:4672
 v_mfma_f32_16x16x32_bf16 a[132:135], v[80:83], a[180:183], a[132:135]
 ds_read_b64_tr_b16 v[68:69], v23 offset:9280
 ds_read_b64_tr_b16 v[70:71], v23 offset:13888
 v_mfma_f32_16x16x32_bf16 a[132:135], v[84:87], a[188:191], a[132:135]
 ds_read_b64_tr_b16 v[72:73], v23 offset:96
 ds_read_b64_tr_b16 v[74:75], v23 offset:4704
 v_mfma_f32_16x16x32_bf16 a[136:139], v[88:91], a[176:179], a[136:139]
 s_add_u32 s53, s53, 0x1000
 ds_read_b64_tr_b16 v[76:77], v23 offset:9312
 ds_read_b64_tr_b16 v[78:79], v23 offset:13920
 v_mfma_f32_16x16x32_bf16 a[136:139], v[92:95], a[184:187], a[136:139]
 ds_read_b64_tr_b16 v[80:81], v24
 ds_read_b64_tr_b16 v[82:83], v24 offset:4608
 v_mfma_f32_16x16x32_bf16 a[140:143], v[88:91], a[180:183], a[140:143]
 ds_read_b64_tr_b16 v[84:85], v24 offset:9216
 ds_read_b64_tr_b16 v[86:87], v24 offset:13824
 v_mfma_f32_16x16x32_bf16 a[140:143], v[92:95], a[188:191], a[140:143]
 s_waitcnt lgkmcnt(15)
 v_mfma_f32_16x16x32_bf16 a[0:3], v[48:51], v[128:131], 0
 s_lshl_b32 s44, s70, 2
 ds_read_b64_tr_b16 v[88:89], v24 offset:32
 ds_read_b64_tr_b16 v[90:91], v24 offset:4640
 v_mfma_f32_16x16x32_bf16 a[0:3], v[52:55], v[136:139], a[0:3]
 s_add_u32 s44, s44, s48
 v_mfma_f32_16x16x32_bf16 a[4:7], v[48:51], v[132:135], 0
 s_add_u32 m0, s10, 0
 ds_read_b64_tr_b16 v[92:93], v24 offset:9248
 ds_read_b64_tr_b16 v[94:95], v24 offset:13856
 v_mfma_f32_16x16x32_bf16 a[4:7], v[52:55], v[140:143], a[4:7]
 s_waitcnt lgkmcnt(15)
 s_add_u32 s40, s52, 0
 buffer_load_dwordx4 v2, s[36:39], s40 offen sc1 lds
 v_mfma_f32_16x16x32_bf16 a[8:11], v[56:59], v[128:131], 0
 ds_read_b64_tr_b16 v[48:49], v24 offset:64
 ds_read_b64_tr_b16 v[50:51], v24 offset:4672
 v_mfma_f32_16x16x32_bf16 a[8:11], v[60:63], v[136:139], a[8:11]
 buffer_load_dwordx4 a[160:163], v4, s[28:31], s53 offen sc1
 v_mfma_f32_16x16x32_bf16 a[12:15], v[56:59], v[132:135], 0
 ds_read_b64_tr_b16 v[52:53], v24 offset:9280
 ds_read_b64_tr_b16 v[54:55], v24 offset:13888
 v_mfma_f32_16x16x32_bf16 a[12:15], v[60:63], v[140:143], a[12:15]
 s_waitcnt lgkmcnt(15)
 v_accvgpr_read_b32 v96, a104
 v_accvgpr_read_b32 v97, a105
 v_mfma_f32_16x16x32_bf16 a[16:19], v[64:67], v[128:131], 0
 ds_read_b64_tr_b16 v[56:57], v24 offset:96
 ds_read_b64_tr_b16 v[58:59], v24 offset:4704
 v_mfma_f32_16x16x32_bf16 a[16:19], v[68:71], v[136:139], a[16:19]
 buffer_load_dwordx4 v2, s[36:39], s40 offen offset:1024 sc1 lds
 v_mfma_f32_16x16x32_bf16 a[20:23], v[64:67], v[132:135], 0
 ds_read_b64_tr_b16 v[60:61], v24 offset:9312
 ds_read_b64_tr_b16 v[62:63], v24 offset:13920
 v_mfma_f32_16x16x32_bf16 a[20:23], v[68:71], v[140:143], a[20:23]
 s_waitcnt lgkmcnt(15)
 v_accvgpr_read_b32 v98, a106
 v_accvgpr_read_b32 v99, a107
 v_mfma_f32_16x16x32_bf16 a[24:27], v[72:75], v[128:131], 0
 ds_read_b64_tr_b16 v[64:65], v25
 ds_read_b64_tr_b16 v[66:67], v25 offset:4608
 v_mfma_f32_16x16x32_bf16 a[24:27], v[76:79], v[136:139], a[24:27]
 buffer_load_dwordx4 a[164:167], v5, s[28:31], s53 offen sc1
 v_mfma_f32_16x16x32_bf16 a[28:31], v[72:75], v[132:135], 0
 ds_read_b64_tr_b16 v[68:69], v25 offset:9216
 ds_read_b64_tr_b16 v[70:71], v25 offset:13824
 v_mfma_f32_16x16x32_bf16 a[28:31], v[76:79], v[140:143], a[28:31]
 s_waitcnt lgkmcnt(15)
 buffer_load_dwordx4 v2, s[36:39], s40 offen offset:2048 sc1 lds
 v_mfma_f32_16x16x32_bf16 a[32:35], v[80:83], v[128:131], 0
 ds_read_b64_tr_b16 v[72:73], v23 offset:18432
 ds_read_b64_tr_b16 v[74:75], v23 offset:23040
 v_mfma_f32_16x16x32_bf16 a[32:35], v[84:87], v[136:139], a[32:35]
 v_cvt_pk_bf16_f32 v160, v96, v97
 v_cvt_pk_bf16_f32 v161, v98, v99
 v_mfma_f32_16x16x32_bf16 a[36:39], v[80:83], v[132:135], 0
 ds_read_b64_tr_b16 v[76:77], v23 offset:27648
 ds_read_b64_tr_b16 v[78:79], v23 offset:32256
 v_mfma_f32_16x16x32_bf16 a[36:39], v[84:87], v[140:143], a[36:39]
 s_waitcnt lgkmcnt(15)
 v_accvgpr_read_b32 v100, a112
 v_accvgpr_read_b32 v101, a113
 v_mfma_f32_16x16x32_bf16 a[40:43], v[88:91], v[128:131], 0
 ds_read_b64_tr_b16 v[80:81], v23 offset:18464
 ds_read_b64_tr_b16 v[82:83], v23 offset:23072
 v_mfma_f32_16x16x32_bf16 a[40:43], v[92:95], v[136:139], a[40:43]
 buffer_load_dwordx4 a[168:171], v4, s[28:31], s53 offen offset:2048 sc1
 v_mfma_f32_16x16x32_bf16 a[44:47], v[88:91], v[132:135], 0
 ds_read_b64_tr_b16 v[84:85], v23 offset:27680
 ds_read_b64_tr_b16 v[86:87], v23 offset:32288
 v_mfma_f32_16x16x32_bf16 a[44:47], v[92:95], v[140:143], a[44:47]
 s_waitcnt lgkmcnt(15)
 buffer_load_dwordx4 v2, s[36:39], s40 offen offset:3072 sc1 lds
 v_mfma_f32_16x16x32_bf16 a[48:51], v[48:51], v[128:131], 0
 ds_read_b64_tr_b16 v[88:89], v23 offset:18496
 ds_read_b64_tr_b16 v[90:91], v23 offset:23104
 v_mfma_f32_16x16x32_bf16 a[48:51], v[52:55], v[136:139], a[48:51]
 v_accvgpr_read_b32 v102, a114
 v_accvgpr_read_b32 v103, a115
 v_mfma_f32_16x16x32_bf16 a[52:55], v[48:51], v[132:135], 0
 ds_read_b64_tr_b16 v[92:93], v23 offset:27712
 ds_read_b64_tr_b16 v[94:95], v23 offset:32320
 v_mfma_f32_16x16x32_bf16 a[52:55], v[52:55], v[140:143], a[52:55]
 s_waitcnt lgkmcnt(15)
 v_cvt_pk_bf16_f32 v162, v100, v101
 v_cvt_pk_bf16_f32 v163, v102, v103
 v_mfma_f32_16x16x32_bf16 a[56:59], v[56:59], v[128:131], 0
 ds_read_b64_tr_b16 v[48:49], v23 offset:18528
 ds_read_b64_tr_b16 v[50:51], v23 offset:23136
 v_mfma_f32_16x16x32_bf16 a[56:59], v[60:63], v[136:139], a[56:59]
 s_add_u32 m0, s10, 0x1000
 buffer_load_dwordx4 a[172:175], v5, s[28:31], s53 offen offset:2048 sc1
 v_mfma_f32_16x16x32_bf16 a[60:63], v[56:59], v[132:135], 0
 s_add_u32 s40, s52, 0x1000
 buffer_load_dwordx4 v2, s[36:39], s40 offen sc1 lds
 v_mfma_f32_16x16x32_bf16 a[60:63], v[60:63], v[140:143], a[60:63]
 s_waitcnt lgkmcnt(15)
 ds_read_b64_tr_b16 v[52:53], v23 offset:27744
 ds_read_b64_tr_b16 v[54:55], v23 offset:32352
 v_mfma_f32_16x16x32_bf16 a[64:67], v[64:67], v[128:131], 0
 s_waitcnt lgkmcnt(15)
 ds_read_b64_tr_b16 v[56:57], v24 offset:18432
 ds_read_b64_tr_b16 v[58:59], v24 offset:23040
 v_mfma_f32_16x16x32_bf16 a[64:67], v[68:71], v[136:139], a[64:67]
 v_accvgpr_read_b32 v104, a108
 v_accvgpr_read_b32 v105, a109
 v_mfma_f32_16x16x32_bf16 a[68:71], v[64:67], v[132:135], 0
 ds_read_b64_tr_b16 v[60:61], v24 offset:27648
 ds_read_b64_tr_b16 v[62:63], v24 offset:32256
 v_mfma_f32_16x16x32_bf16 a[68:71], v[68:71], v[140:143], a[68:71]
 s_waitcnt lgkmcnt(15)
 v_accvgpr_read_b32 v106, a110
 v_accvgpr_read_b32 v107, a111
 v_mfma_f32_16x16x32_bf16 a[0:3], v[72:75], v[144:147], a[0:3]
 s_add_u32 s53, s53, 0x1000
 ds_read_b64_tr_b16 v[64:65], v24 offset:18464
 ds_read_b64_tr_b16 v[66:67], v24 offset:23072
 v_mfma_f32_16x16x32_bf16 a[0:3], v[76:79], v[152:155], a[0:3]
 buffer_load_dwordx4 v2, s[36:39], s40 offen offset:1024 sc1 lds
 v_mfma_f32_16x16x32_bf16 a[4:7], v[72:75], v[148:151], a[4:7]
 s_waitcnt vmcnt(45)
 buffer_load_dwordx4 a[176:179], v4, s[28:31], s53 offen sc1
 v_mfma_f32_16x16x32_bf16 a[4:7], v[76:79], v[156:159], a[4:7]
 s_waitcnt lgkmcnt(15)
 ds_read_b64_tr_b16 v[68:69], v24 offset:27680
 ds_read_b64_tr_b16 v[70:71], v24 offset:32288
 v_mfma_f32_16x16x32_bf16 a[8:11], v[80:83], v[144:147], a[8:11]
 s_waitcnt lgkmcnt(15)
 ds_read_b64_tr_b16 v[72:73], v24 offset:18496
 ds_read_b64_tr_b16 v[74:75], v24 offset:23104
 v_mfma_f32_16x16x32_bf16 a[8:11], v[84:87], v[152:155], a[8:11]
 v_cvt_pk_bf16_f32 v164, v104, v105
 v_cvt_pk_bf16_f32 v165, v106, v107
 v_mfma_f32_16x16x32_bf16 a[12:15], v[80:83], v[148:151], a[12:15]
 ds_read_b64_tr_b16 v[76:77], v24 offset:27712
 ds_read_b64_tr_b16 v[78:79], v24 offset:32320
 v_mfma_f32_16x16x32_bf16 a[12:15], v[84:87], v[156:159], a[12:15]
 s_waitcnt lgkmcnt(15)
 buffer_load_dwordx4 v2, s[36:39], s40 offen offset:2048 sc1 lds
 v_mfma_f32_16x16x32_bf16 a[16:19], v[88:91], v[144:147], a[16:19]
 ds_read_b64_tr_b16 v[80:81], v24 offset:18528
 ds_read_b64_tr_b16 v[82:83], v24 offset:23136
 v_mfma_f32_16x16x32_bf16 a[16:19], v[92:95], v[152:155], a[16:19]
 buffer_load_dwordx4 a[180:183], v5, s[28:31], s53 offen sc1
 v_mfma_f32_16x16x32_bf16 a[20:23], v[88:91], v[148:151], a[20:23]
 ds_read_b64_tr_b16 v[84:85], v24 offset:27744
 ds_read_b64_tr_b16 v[86:87], v24 offset:32352
 v_mfma_f32_16x16x32_bf16 a[20:23], v[92:95], v[156:159], a[20:23]
 s_waitcnt lgkmcnt(15)
 v_accvgpr_read_b32 v108, a116
 v_accvgpr_read_b32 v109, a117
 v_mfma_f32_16x16x32_bf16 a[24:27], v[48:51], v[144:147], a[24:27]
 ds_read_b64_tr_b16 v[88:89], v25 offset:18432
 ds_read_b64_tr_b16 v[90:91], v25 offset:23040
 v_mfma_f32_16x16x32_bf16 a[24:27], v[52:55], v[152:155], a[24:27]
 v_accvgpr_read_b32 v110, a118
 v_accvgpr_read_b32 v111, a119
 v_mfma_f32_16x16x32_bf16 a[28:31], v[48:51], v[148:151], a[28:31]
 ds_read_b64_tr_b16 v[92:93], v25 offset:27648
 ds_read_b64_tr_b16 v[94:95], v25 offset:32256
 v_mfma_f32_16x16x32_bf16 a[28:31], v[52:55], v[156:159], a[28:31]
 s_waitcnt lgkmcnt(15)
 buffer_load_dwordx4 v2, s[36:39], s40 offen offset:3072 sc1 lds
 v_mfma_f32_16x16x32_bf16 a[32:35], v[56:59], v[144:147], a[32:35]
 buffer_load_dwordx4 a[184:187], v4, s[28:31], s53 offen offset:2048 sc1
 v_mfma_f32_16x16x32_bf16 a[32:35], v[60:63], v[152:155], a[32:35]
 v_cvt_pk_bf16_f32 v166, v108, v109
 v_cvt_pk_bf16_f32 v167, v110, v111
 v_mfma_f32_16x16x32_bf16 a[36:39], v[56:59], v[148:151], a[36:39]
 v_accvgpr_read_b32 v96, a120
 v_accvgpr_read_b32 v97, a121
 v_mfma_f32_16x16x32_bf16 a[36:39], v[60:63], v[156:159], a[36:39]
 s_waitcnt lgkmcnt(14)
 v_accvgpr_read_b32 v98, a122
 v_accvgpr_read_b32 v99, a123
 v_mfma_f32_16x16x32_bf16 a[40:43], v[64:67], v[144:147], a[40:43]
 s_waitcnt vmcnt(34) lgkmcnt(12)
 v_cvt_pk_bf16_f32 v168, v96, v97
 v_cvt_pk_bf16_f32 v169, v98, v99
 v_mfma_f32_16x16x32_bf16 a[40:43], v[68:71], v[152:155], a[40:43]
 s_waitcnt lgkmcnt(0)
 v_accvgpr_read_b32 v100, a128
 v_accvgpr_read_b32 v101, a129
 v_mfma_f32_16x16x32_bf16 a[44:47], v[64:67], v[148:151], a[44:47]
 s_add_u32 m0, s10, 0x2000
 v_accvgpr_read_b32 v102, a130
 v_accvgpr_read_b32 v103, a131
 v_mfma_f32_16x16x32_bf16 a[44:47], v[68:71], v[156:159], a[44:47]
 s_add_u32 s40, s52, 0x2000
 s_barrier
 buffer_load_dwordx4 v2, s[36:39], s40 offen sc1 lds
 v_mfma_f32_16x16x32_bf16 a[48:51], v[72:75], v[144:147], a[48:51]
 ds_read_b64_tr_b16 v[48:49], v14
 ds_read_b64_tr_b16 v[50:51], v14 offset:4608
 v_mfma_f32_16x16x32_bf16 a[48:51], v[76:79], v[152:155], a[48:51]
 ds_read_b64_tr_b16 v[52:53], v14 offset:9216
 ds_read_b64_tr_b16 v[54:55], v14 offset:13824
 v_mfma_f32_16x16x32_bf16 a[52:55], v[72:75], v[148:151], a[52:55]
 buffer_load_dwordx4 a[188:191], v5, s[28:31], s53 offen offset:2048 sc1
 v_mfma_f32_16x16x32_bf16 a[52:55], v[76:79], v[156:159], a[52:55]
 ds_read_b64_tr_b16 v[56:57], v14 offset:32
 ds_read_b64_tr_b16 v[58:59], v14 offset:4640
 v_mfma_f32_16x16x32_bf16 a[56:59], v[80:83], v[144:147], a[56:59]
 s_add_u32 s52, s52, 0x9000
 ds_read_b64_tr_b16 v[60:61], v14 offset:9248
 ds_read_b64_tr_b16 v[62:63], v14 offset:13856
 v_mfma_f32_16x16x32_bf16 a[56:59], v[84:87], v[152:155], a[56:59]
 ds_read_b64_tr_b16 v[64:65], v14 offset:64
 ds_read_b64_tr_b16 v[66:67], v14 offset:4672
 v_mfma_f32_16x16x32_bf16 a[60:63], v[80:83], v[148:151], a[60:63]
 ds_read_b64_tr_b16 v[68:69], v14 offset:9280
 ds_read_b64_tr_b16 v[70:71], v14 offset:13888
 v_mfma_f32_16x16x32_bf16 a[60:63], v[84:87], v[156:159], a[60:63]
 ds_read_b64_tr_b16 v[72:73], v14 offset:96
 ds_read_b64_tr_b16 v[74:75], v14 offset:4704
 v_mfma_f32_16x16x32_bf16 a[64:67], v[88:91], v[144:147], a[64:67]
 s_add_u32 s53, s53, 0x1000
 ds_read_b64_tr_b16 v[76:77], v14 offset:9312
 ds_read_b64_tr_b16 v[78:79], v14 offset:13920
 v_mfma_f32_16x16x32_bf16 a[64:67], v[92:95], v[152:155], a[64:67]
 s_lshl_b32 s41, s70, 15
 ds_read_b64_tr_b16 v[80:81], v15
 ds_read_b64_tr_b16 v[82:83], v15 offset:4608
 v_mfma_f32_16x16x32_bf16 a[68:71], v[88:91], v[148:151], a[68:71]
 s_add_u32 s41, s41, s57
 ds_read_b64_tr_b16 v[84:85], v15 offset:9216
 ds_read_b64_tr_b16 v[86:87], v15 offset:13824
 v_mfma_f32_16x16x32_bf16 a[68:71], v[92:95], v[156:159], a[68:71]
 s_waitcnt lgkmcnt(15)
 v_cvt_pk_bf16_f32 v170, v100, v101
 v_cvt_pk_bf16_f32 v171, v102, v103
 v_mfma_f32_16x16x32_bf16 a[0:3], v[48:51], a[192:195], a[0:3]
 s_add_u32 s42, s41, 0x1000
 ds_read_b64_tr_b16 v[88:89], v15 offset:32
 ds_read_b64_tr_b16 v[90:91], v15 offset:4640
 v_mfma_f32_16x16x32_bf16 a[0:3], v[52:55], a[200:203], a[0:3]
 s_add_u32 m0, s11, 0
 v_accvgpr_read_b32 v104, a124
 v_accvgpr_read_b32 v105, a125
 v_mfma_f32_16x16x32_bf16 a[4:7], v[48:51], a[196:199], a[4:7]
 s_add_u32 s40, s52, 0
 buffer_load_dwordx4 v2, s[36:39], s40 offen sc1 lds
 v_mfma_f32_16x16x32_bf16 a[4:7], v[52:55], a[204:207], a[4:7]
 s_waitcnt lgkmcnt(15)
 ds_read_b64_tr_b16 v[92:93], v15 offset:9248
 ds_read_b64_tr_b16 v[94:95], v15 offset:13856
 v_mfma_f32_16x16x32_bf16 a[8:11], v[56:59], a[192:195], a[8:11]
 s_waitcnt lgkmcnt(15)
 buffer_store_dwordx4 v[160:163], v2, s[36:39], s41 offen offset:2048 sc1
 v_mfma_f32_16x16x32_bf16 a[8:11], v[60:63], a[200:203], a[8:11]
 ds_read_b64_tr_b16 v[48:49], v15 offset:64
 ds_read_b64_tr_b16 v[50:51], v15 offset:4672
 v_mfma_f32_16x16x32_bf16 a[12:15], v[56:59], a[196:199], a[12:15]
 buffer_load_dwordx4 v[128:131], v4, s[28:31], s53 offen sc1
 v_mfma_f32_16x16x32_bf16 a[12:15], v[60:63], a[204:207], a[12:15]
 s_waitcnt lgkmcnt(15)
 ds_read_b64_tr_b16 v[52:53], v15 offset:9280
 ds_read_b64_tr_b16 v[54:55], v15 offset:13888
 v_mfma_f32_16x16x32_bf16 a[16:19], v[64:67], a[192:195], a[16:19]
 s_waitcnt lgkmcnt(15)
 ds_read_b64_tr_b16 v[56:57], v15 offset:96
 ds_read_b64_tr_b16 v[58:59], v15 offset:4704
 v_mfma_f32_16x16x32_bf16 a[16:19], v[68:71], a[200:203], a[16:19]
 buffer_load_dwordx4 v2, s[36:39], s40 offen offset:1024 sc1 lds
 v_mfma_f32_16x16x32_bf16 a[20:23], v[64:67], a[196:199], a[20:23]
 ds_read_b64_tr_b16 v[60:61], v15 offset:9312
 ds_read_b64_tr_b16 v[62:63], v15 offset:13920
 v_mfma_f32_16x16x32_bf16 a[20:23], v[68:71], a[204:207], a[20:23]
 s_waitcnt lgkmcnt(15)
 v_accvgpr_read_b32 v106, a126
 v_accvgpr_read_b32 v107, a127
 v_mfma_f32_16x16x32_bf16 a[24:27], v[72:75], a[192:195], a[24:27]
 ds_read_b64_tr_b16 v[64:65], v16
 ds_read_b64_tr_b16 v[66:67], v16 offset:4608
 v_mfma_f32_16x16x32_bf16 a[24:27], v[76:79], a[200:203], a[24:27]
 buffer_load_dwordx4 v[132:135], v5, s[28:31], s53 offen sc1
 v_mfma_f32_16x16x32_bf16 a[28:31], v[72:75], a[196:199], a[28:31]
 ds_read_b64_tr_b16 v[68:69], v16 offset:9216
 ds_read_b64_tr_b16 v[70:71], v16 offset:13824
 v_mfma_f32_16x16x32_bf16 a[28:31], v[76:79], a[204:207], a[28:31]
 s_waitcnt lgkmcnt(15)
 buffer_load_dwordx4 v2, s[36:39], s40 offen offset:2048 sc1 lds
 v_mfma_f32_16x16x32_bf16 a[32:35], v[80:83], a[192:195], a[32:35]
 ds_read_b64_tr_b16 v[72:73], v14 offset:18432
 ds_read_b64_tr_b16 v[74:75], v14 offset:23040
 v_mfma_f32_16x16x32_bf16 a[32:35], v[84:87], a[200:203], a[32:35]
 v_cvt_pk_bf16_f32 v172, v104, v105
 v_cvt_pk_bf16_f32 v173, v106, v107
 v_mfma_f32_16x16x32_bf16 a[36:39], v[80:83], a[196:199], a[36:39]
 ds_read_b64_tr_b16 v[76:77], v14 offset:27648
 ds_read_b64_tr_b16 v[78:79], v14 offset:32256
 v_mfma_f32_16x16x32_bf16 a[36:39], v[84:87], a[204:207], a[36:39]
 s_waitcnt lgkmcnt(15)
 v_accvgpr_read_b32 v108, a132
 v_accvgpr_read_b32 v109, a133
 v_mfma_f32_16x16x32_bf16 a[40:43], v[88:91], a[192:195], a[40:43]
 ds_read_b64_tr_b16 v[80:81], v14 offset:18464
 ds_read_b64_tr_b16 v[82:83], v14 offset:23072
 v_mfma_f32_16x16x32_bf16 a[40:43], v[92:95], a[200:203], a[40:43]
 buffer_load_dwordx4 v[136:139], v4, s[28:31], s53 offen offset:2048 sc1
 v_mfma_f32_16x16x32_bf16 a[44:47], v[88:91], a[196:199], a[44:47]
 ds_read_b64_tr_b16 v[84:85], v14 offset:27680
 ds_read_b64_tr_b16 v[86:87], v14 offset:32288
 v_mfma_f32_16x16x32_bf16 a[44:47], v[92:95], a[204:207], a[44:47]
 s_waitcnt lgkmcnt(15)
 buffer_load_dwordx4 v2, s[36:39], s40 offen offset:3072 sc1 lds
 v_mfma_f32_16x16x32_bf16 a[48:51], v[48:51], a[192:195], a[48:51]
 ds_read_b64_tr_b16 v[88:89], v14 offset:18496
 ds_read_b64_tr_b16 v[90:91], v14 offset:23104
 v_mfma_f32_16x16x32_bf16 a[48:51], v[52:55], a[200:203], a[48:51]
 buffer_store_dwordx4 v[164:167], v2, s[36:39], s42 offen sc1
 v_mfma_f32_16x16x32_bf16 a[52:55], v[48:51], a[196:199], a[52:55]
 ds_read_b64_tr_b16 v[92:93], v14 offset:27712
 ds_read_b64_tr_b16 v[94:95], v14 offset:32320
 v_mfma_f32_16x16x32_bf16 a[52:55], v[52:55], a[204:207], a[52:55]
 s_waitcnt lgkmcnt(15)
 v_accvgpr_read_b32 v110, a134
 v_accvgpr_read_b32 v111, a135
 v_mfma_f32_16x16x32_bf16 a[56:59], v[56:59], a[192:195], a[56:59]
 ds_read_b64_tr_b16 v[48:49], v14 offset:18528
 ds_read_b64_tr_b16 v[50:51], v14 offset:23136
 v_mfma_f32_16x16x32_bf16 a[56:59], v[60:63], a[200:203], a[56:59]
 s_add_u32 m0, s11, 0x1000
 buffer_load_dwordx4 v[140:143], v5, s[28:31], s53 offen offset:2048 sc1
 v_mfma_f32_16x16x32_bf16 a[60:63], v[56:59], a[196:199], a[60:63]
 s_add_u32 s40, s52, 0x1000
 buffer_load_dwordx4 v2, s[36:39], s40 offen sc1 lds
 v_mfma_f32_16x16x32_bf16 a[60:63], v[60:63], a[204:207], a[60:63]
 s_waitcnt lgkmcnt(15)
 ds_read_b64_tr_b16 v[52:53], v14 offset:27744
 ds_read_b64_tr_b16 v[54:55], v14 offset:32352
 v_mfma_f32_16x16x32_bf16 a[64:67], v[64:67], a[192:195], a[64:67]
 s_waitcnt lgkmcnt(15)
 ds_read_b64_tr_b16 v[56:57], v15 offset:18432
 ds_read_b64_tr_b16 v[58:59], v15 offset:23040
 v_mfma_f32_16x16x32_bf16 a[64:67], v[68:71], a[200:203], a[64:67]
 v_cvt_pk_bf16_f32 v174, v108, v109
 v_cvt_pk_bf16_f32 v175, v110, v111
 v_mfma_f32_16x16x32_bf16 a[68:71], v[64:67], a[196:199], a[68:71]
 ds_read_b64_tr_b16 v[60:61], v15 offset:27648
 ds_read_b64_tr_b16 v[62:63], v15 offset:32256
 v_mfma_f32_16x16x32_bf16 a[68:71], v[68:71], a[204:207], a[68:71]
 s_waitcnt lgkmcnt(15)
 v_accvgpr_read_b32 v96, a136
 v_accvgpr_read_b32 v97, a137
 v_mfma_f32_16x16x32_bf16 a[0:3], v[72:75], a[208:211], a[0:3]
 s_add_u32 s53, s53, 0x1000
 ds_read_b64_tr_b16 v[64:65], v15 offset:18464
 ds_read_b64_tr_b16 v[66:67], v15 offset:23072
 v_mfma_f32_16x16x32_bf16 a[0:3], v[76:79], a[216:219], a[0:3]
 buffer_load_dwordx4 v2, s[36:39], s40 offen offset:1024 sc1 lds
 v_mfma_f32_16x16x32_bf16 a[4:7], v[72:75], a[212:215], a[4:7]
 s_waitcnt vmcnt(47)
 buffer_load_dwordx4 v[144:147], v4, s[28:31], s53 offen sc1
 v_mfma_f32_16x16x32_bf16 a[4:7], v[76:79], a[220:223], a[4:7]
 s_waitcnt lgkmcnt(15)
 ds_read_b64_tr_b16 v[68:69], v15 offset:27680
 ds_read_b64_tr_b16 v[70:71], v15 offset:32288
 v_mfma_f32_16x16x32_bf16 a[8:11], v[80:83], a[208:211], a[8:11]
 s_waitcnt lgkmcnt(15)
 ds_read_b64_tr_b16 v[72:73], v15 offset:18496
 ds_read_b64_tr_b16 v[74:75], v15 offset:23104
 v_mfma_f32_16x16x32_bf16 a[8:11], v[84:87], a[216:219], a[8:11]
 v_accvgpr_read_b32 v98, a138
 v_accvgpr_read_b32 v99, a139
 v_mfma_f32_16x16x32_bf16 a[12:15], v[80:83], a[212:215], a[12:15]
 ds_read_b64_tr_b16 v[76:77], v15 offset:27712
 ds_read_b64_tr_b16 v[78:79], v15 offset:32320
 v_mfma_f32_16x16x32_bf16 a[12:15], v[84:87], a[220:223], a[12:15]
 s_waitcnt lgkmcnt(15)
 buffer_load_dwordx4 v2, s[36:39], s40 offen offset:2048 sc1 lds
 v_mfma_f32_16x16x32_bf16 a[16:19], v[88:91], a[208:211], a[16:19]
 ds_read_b64_tr_b16 v[80:81], v15 offset:18528
 ds_read_b64_tr_b16 v[82:83], v15 offset:23136
 v_mfma_f32_16x16x32_bf16 a[16:19], v[92:95], a[216:219], a[16:19]
 buffer_load_dwordx4 v[148:151], v5, s[28:31], s53 offen sc1
 v_mfma_f32_16x16x32_bf16 a[20:23], v[88:91], a[212:215], a[20:23]
 ds_read_b64_tr_b16 v[84:85], v15 offset:27744
 ds_read_b64_tr_b16 v[86:87], v15 offset:32352
 v_mfma_f32_16x16x32_bf16 a[20:23], v[92:95], a[220:223], a[20:23]
 s_waitcnt lgkmcnt(15)
 buffer_store_dwordx4 v[168:171], v2, s[36:39], s41 offen offset:3072 sc1
 v_mfma_f32_16x16x32_bf16 a[24:27], v[48:51], a[208:211], a[24:27]
 ds_read_b64_tr_b16 v[88:89], v16 offset:18432
 ds_read_b64_tr_b16 v[90:91], v16 offset:23040
 v_mfma_f32_16x16x32_bf16 a[24:27], v[52:55], a[216:219], a[24:27]
 v_cvt_pk_bf16_f32 v176, v96, v97
 v_cvt_pk_bf16_f32 v177, v98, v99
 v_mfma_f32_16x16x32_bf16 a[28:31], v[48:51], a[212:215], a[28:31]
 ds_read_b64_tr_b16 v[92:93], v16 offset:27648
 ds_read_b64_tr_b16 v[94:95], v16 offset:32256
 v_mfma_f32_16x16x32_bf16 a[28:31], v[52:55], a[220:223], a[28:31]
 s_waitcnt lgkmcnt(15)
 buffer_load_dwordx4 v2, s[36:39], s40 offen offset:3072 sc1 lds
 v_mfma_f32_16x16x32_bf16 a[32:35], v[56:59], a[208:211], a[32:35]
 buffer_load_dwordx4 v[152:155], v4, s[28:31], s53 offen offset:2048 sc1
 v_mfma_f32_16x16x32_bf16 a[32:35], v[60:63], a[216:219], a[32:35]
 v_accvgpr_read_b32 v100, a140
 v_accvgpr_read_b32 v101, a141
 v_mfma_f32_16x16x32_bf16 a[36:39], v[56:59], a[212:215], a[36:39]
 v_accvgpr_read_b32 v102, a142
 v_accvgpr_read_b32 v103, a143
 v_mfma_f32_16x16x32_bf16 a[36:39], v[60:63], a[220:223], a[36:39]
 s_waitcnt lgkmcnt(14)
 v_cvt_pk_bf16_f32 v178, v100, v101
 v_cvt_pk_bf16_f32 v179, v102, v103
 v_mfma_f32_16x16x32_bf16 a[40:43], v[64:67], a[208:211], a[40:43]
 s_waitcnt vmcnt(36) lgkmcnt(12)
 v_accvgpr_read_b32 v104, a76
 v_accvgpr_read_b32 v105, a77
 v_mfma_f32_16x16x32_bf16 a[40:43], v[68:71], a[216:219], a[40:43]
 s_waitcnt lgkmcnt(0)
 v_accvgpr_read_b32 v106, a78
 v_accvgpr_read_b32 v107, a79
 v_mfma_f32_16x16x32_bf16 a[44:47], v[64:67], a[212:215], a[44:47]
 s_add_u32 m0, s11, 0x2000
 v_cvt_pk_bf16_f32 v180, v104, v105
 v_cvt_pk_bf16_f32 v181, v106, v107
 v_mfma_f32_16x16x32_bf16 a[44:47], v[68:71], a[220:223], a[44:47]
 s_add_u32 s40, s52, 0x2000
 s_barrier
 buffer_load_dwordx4 v2, s[36:39], s40 offen sc1 lds
 v_mfma_f32_16x16x32_bf16 a[48:51], v[72:75], a[208:211], a[48:51]
 ds_read_b64_tr_b16 v[48:49], v17
 ds_read_b64_tr_b16 v[50:51], v17 offset:4608
 v_mfma_f32_16x16x32_bf16 a[48:51], v[76:79], a[216:219], a[48:51]
 ds_read_b64_tr_b16 v[52:53], v17 offset:9216
 ds_read_b64_tr_b16 v[54:55], v17 offset:13824
 v_mfma_f32_16x16x32_bf16 a[52:55], v[72:75], a[212:215], a[52:55]
 buffer_load_dwordx4 v[156:159], v5, s[28:31], s53 offen offset:2048 sc1
 v_mfma_f32_16x16x32_bf16 a[52:55], v[76:79], a[220:223], a[52:55]
 ds_read_b64_tr_b16 v[56:57], v17 offset:32
 ds_read_b64_tr_b16 v[58:59], v17 offset:4640
 v_mfma_f32_16x16x32_bf16 a[56:59], v[80:83], a[208:211], a[56:59]
 s_add_u32 s52, s52, 0x9000
 ds_read_b64_tr_b16 v[60:61], v17 offset:9248
 ds_read_b64_tr_b16 v[62:63], v17 offset:13856
 v_mfma_f32_16x16x32_bf16 a[56:59], v[84:87], a[216:219], a[56:59]
 ds_read_b64_tr_b16 v[64:65], v17 offset:64
 ds_read_b64_tr_b16 v[66:67], v17 offset:4672
 v_mfma_f32_16x16x32_bf16 a[60:63], v[80:83], a[212:215], a[60:63]
 ds_read_b64_tr_b16 v[68:69], v17 offset:9280
 ds_read_b64_tr_b16 v[70:71], v17 offset:13888
 v_mfma_f32_16x16x32_bf16 a[60:63], v[84:87], a[220:223], a[60:63]
 ds_read_b64_tr_b16 v[72:73], v17 offset:96
 ds_read_b64_tr_b16 v[74:75], v17 offset:4704
 v_mfma_f32_16x16x32_bf16 a[64:67], v[88:91], a[208:211], a[64:67]
 s_add_u32 s53, s53, 0x1000
 ds_read_b64_tr_b16 v[76:77], v17 offset:9312
 ds_read_b64_tr_b16 v[78:79], v17 offset:13920
 v_mfma_f32_16x16x32_bf16 a[64:67], v[92:95], a[216:219], a[64:67]
 ds_read_b64_tr_b16 v[80:81], v18
 ds_read_b64_tr_b16 v[82:83], v18 offset:4608
 v_mfma_f32_16x16x32_bf16 a[68:71], v[88:91], a[212:215], a[68:71]
 buffer_store_dwordx4 v[172:175], v2, s[36:39], s42 offen offset:1024 sc1
 v_mfma_f32_16x16x32_bf16 a[68:71], v[92:95], a[220:223], a[68:71]
 s_waitcnt lgkmcnt(15)
 ds_read_b64_tr_b16 v[84:85], v18 offset:9216
 ds_read_b64_tr_b16 v[86:87], v18 offset:13824
 v_mfma_f32_16x16x32_bf16 a[0:3], v[48:51], a[224:227], a[0:3]
 s_waitcnt lgkmcnt(15)
 ds_read_b64_tr_b16 v[88:89], v18 offset:32
 ds_read_b64_tr_b16 v[90:91], v18 offset:4640
 v_mfma_f32_16x16x32_bf16 a[0:3], v[52:55], a[232:235], a[0:3]
 s_add_u32 m0, s8, 0
 v_accvgpr_read_b32 v108, a84
 v_accvgpr_read_b32 v109, a85
 v_mfma_f32_16x16x32_bf16 a[4:7], v[48:51], a[228:231], a[4:7]
 s_add_u32 s40, s52, 0
 buffer_load_dwordx4 v2, s[36:39], s40 offen sc1 lds
 v_mfma_f32_16x16x32_bf16 a[4:7], v[52:55], a[236:239], a[4:7]
 s_waitcnt lgkmcnt(15)
 ds_read_b64_tr_b16 v[92:93], v18 offset:9248
 ds_read_b64_tr_b16 v[94:95], v18 offset:13856
 v_mfma_f32_16x16x32_bf16 a[8:11], v[56:59], a[224:227], a[8:11]
 s_waitcnt lgkmcnt(15)
 ds_read_b64_tr_b16 v[48:49], v18 offset:64
 ds_read_b64_tr_b16 v[50:51], v18 offset:4672
 v_mfma_f32_16x16x32_bf16 a[8:11], v[60:63], a[232:235], a[8:11]
 buffer_load_dwordx4 a[192:195], v4, s[28:31], s53 offen sc1
 v_mfma_f32_16x16x32_bf16 a[12:15], v[56:59], a[228:231], a[12:15]
 ds_read_b64_tr_b16 v[52:53], v18 offset:9280
 ds_read_b64_tr_b16 v[54:55], v18 offset:13888
 v_mfma_f32_16x16x32_bf16 a[12:15], v[60:63], a[236:239], a[12:15]
 s_waitcnt lgkmcnt(15)
 v_accvgpr_read_b32 v110, a86
 v_accvgpr_read_b32 v111, a87
 v_mfma_f32_16x16x32_bf16 a[16:19], v[64:67], a[224:227], a[16:19]
 ds_read_b64_tr_b16 v[56:57], v18 offset:96
 ds_read_b64_tr_b16 v[58:59], v18 offset:4704
 v_mfma_f32_16x16x32_bf16 a[16:19], v[68:71], a[232:235], a[16:19]
 buffer_load_dwordx4 v2, s[36:39], s40 offen offset:1024 sc1 lds
 v_mfma_f32_16x16x32_bf16 a[20:23], v[64:67], a[228:231], a[20:23]
 ds_read_b64_tr_b16 v[60:61], v18 offset:9312
 ds_read_b64_tr_b16 v[62:63], v18 offset:13920
 v_mfma_f32_16x16x32_bf16 a[20:23], v[68:71], a[236:239], a[20:23]
 s_waitcnt lgkmcnt(15)
 v_cvt_pk_bf16_f32 v182, v108, v109
 v_cvt_pk_bf16_f32 v183, v110, v111
 v_mfma_f32_16x16x32_bf16 a[24:27], v[72:75], a[224:227], a[24:27]
 ds_read_b64_tr_b16 v[64:65], v19
 ds_read_b64_tr_b16 v[66:67], v19 offset:4608
 v_mfma_f32_16x16x32_bf16 a[24:27], v[76:79], a[232:235], a[24:27]
 buffer_load_dwordx4 a[196:199], v5, s[28:31], s53 offen sc1
 v_mfma_f32_16x16x32_bf16 a[28:31], v[72:75], a[228:231], a[28:31]
 ds_read_b64_tr_b16 v[68:69], v19 offset:9216
 ds_read_b64_tr_b16 v[70:71], v19 offset:13824
 v_mfma_f32_16x16x32_bf16 a[28:31], v[76:79], a[236:239], a[28:31]
 s_waitcnt lgkmcnt(15)
 buffer_load_dwordx4 v2, s[36:39], s40 offen offset:2048 sc1 lds
 v_mfma_f32_16x16x32_bf16 a[32:35], v[80:83], a[224:227], a[32:35]
 ds_read_b64_tr_b16 v[72:73], v17 offset:18432
 ds_read_b64_tr_b16 v[74:75], v17 offset:23040
 v_mfma_f32_16x16x32_bf16 a[32:35], v[84:87], a[232:235], a[32:35]
 v_accvgpr_read_b32 v96, a92
 v_accvgpr_read_b32 v97, a93
 v_mfma_f32_16x16x32_bf16 a[36:39], v[80:83], a[228:231], a[36:39]
 ds_read_b64_tr_b16 v[76:77], v17 offset:27648
 ds_read_b64_tr_b16 v[78:79], v17 offset:32256
 v_mfma_f32_16x16x32_bf16 a[36:39], v[84:87], a[236:239], a[36:39]
 s_waitcnt lgkmcnt(15)
 buffer_store_dwordx4 v[176:179], v2, s[36:39], s42 offen offset:2048 sc1
 v_mfma_f32_16x16x32_bf16 a[40:43], v[88:91], a[224:227], a[40:43]
 ds_read_b64_tr_b16 v[80:81], v17 offset:18464
 ds_read_b64_tr_b16 v[82:83], v17 offset:23072
 v_mfma_f32_16x16x32_bf16 a[40:43], v[92:95], a[232:235], a[40:43]
 buffer_load_dwordx4 a[200:203], v4, s[28:31], s53 offen offset:2048 sc1
 v_mfma_f32_16x16x32_bf16 a[44:47], v[88:91], a[228:231], a[44:47]
 ds_read_b64_tr_b16 v[84:85], v17 offset:27680
 ds_read_b64_tr_b16 v[86:87], v17 offset:32288
 v_mfma_f32_16x16x32_bf16 a[44:47], v[92:95], a[236:239], a[44:47]
 s_waitcnt lgkmcnt(15)
 buffer_load_dwordx4 v2, s[36:39], s40 offen offset:3072 sc1 lds
 v_mfma_f32_16x16x32_bf16 a[48:51], v[48:51], a[224:227], a[48:51]
 ds_read_b64_tr_b16 v[88:89], v17 offset:18496
 ds_read_b64_tr_b16 v[90:91], v17 offset:23104
 v_mfma_f32_16x16x32_bf16 a[48:51], v[52:55], a[232:235], a[48:51]
 v_accvgpr_read_b32 v98, a94
 v_accvgpr_read_b32 v99, a95
 v_mfma_f32_16x16x32_bf16 a[52:55], v[48:51], a[228:231], a[52:55]
 ds_read_b64_tr_b16 v[92:93], v17 offset:27712
 ds_read_b64_tr_b16 v[94:95], v17 offset:32320
 v_mfma_f32_16x16x32_bf16 a[52:55], v[52:55], a[236:239], a[52:55]
 s_waitcnt lgkmcnt(15)
 v_cvt_pk_bf16_f32 v184, v96, v97
 v_cvt_pk_bf16_f32 v185, v98, v99
 v_mfma_f32_16x16x32_bf16 a[56:59], v[56:59], a[224:227], a[56:59]
 ds_read_b64_tr_b16 v[48:49], v17 offset:18528
 ds_read_b64_tr_b16 v[50:51], v17 offset:23136
 v_mfma_f32_16x16x32_bf16 a[56:59], v[60:63], a[232:235], a[56:59]
 s_add_u32 m0, s8, 0x1000
 buffer_load_dwordx4 a[204:207], v5, s[28:31], s53 offen offset:2048 sc1
 v_mfma_f32_16x16x32_bf16 a[60:63], v[56:59], a[228:231], a[60:63]
 s_add_u32 s40, s52, 0x1000
 buffer_load_dwordx4 v2, s[36:39], s40 offen sc1 lds
 v_mfma_f32_16x16x32_bf16 a[60:63], v[60:63], a[236:239], a[60:63]
 s_waitcnt lgkmcnt(15)
 ds_read_b64_tr_b16 v[52:53], v17 offset:27744
 ds_read_b64_tr_b16 v[54:55], v17 offset:32352
 v_mfma_f32_16x16x32_bf16 a[64:67], v[64:67], a[224:227], a[64:67]
 s_waitcnt lgkmcnt(15)
 ds_read_b64_tr_b16 v[56:57], v18 offset:18432
 ds_read_b64_tr_b16 v[58:59], v18 offset:23040
 v_mfma_f32_16x16x32_bf16 a[64:67], v[68:71], a[232:235], a[64:67]
 v_accvgpr_read_b32 v100, a100
 v_accvgpr_read_b32 v101, a101
 v_mfma_f32_16x16x32_bf16 a[68:71], v[64:67], a[228:231], a[68:71]
 ds_read_b64_tr_b16 v[60:61], v18 offset:27648
 ds_read_b64_tr_b16 v[62:63], v18 offset:32256
 v_mfma_f32_16x16x32_bf16 a[68:71], v[68:71], a[236:239], a[68:71]
 s_waitcnt lgkmcnt(15)
 v_accvgpr_read_b32 v102, a102
 v_accvgpr_read_b32 v103, a103
 v_mfma_f32_16x16x32_bf16 a[0:3], v[72:75], a[240:243], a[0:3]
 s_add_u32 s53, s53, 0x1000
 ds_read_b64_tr_b16 v[64:65], v18 offset:18464
 ds_read_b64_tr_b16 v[66:67], v18 offset:23072
 v_mfma_f32_16x16x32_bf16 a[0:3], v[76:79], a[248:251], a[0:3]
 buffer_load_dwordx4 v2, s[36:39], s40 offen offset:1024 sc1 lds
 v_mfma_f32_16x16x32_bf16 a[4:7], v[72:75], a[244:247], a[4:7]
 s_waitcnt vmcnt(49)
 buffer_load_dwordx4 a[208:211], v4, s[28:31], s53 offen sc1
 v_mfma_f32_16x16x32_bf16 a[4:7], v[76:79], a[252:255], a[4:7]
 s_waitcnt lgkmcnt(15)
 ds_read_b64_tr_b16 v[68:69], v18 offset:27680
 ds_read_b64_tr_b16 v[70:71], v18 offset:32288
 v_mfma_f32_16x16x32_bf16 a[8:11], v[80:83], a[240:243], a[8:11]
 s_waitcnt lgkmcnt(15)
 ds_read_b64_tr_b16 v[72:73], v18 offset:18496
 ds_read_b64_tr_b16 v[74:75], v18 offset:23104
 v_mfma_f32_16x16x32_bf16 a[8:11], v[84:87], a[248:251], a[8:11]
 buffer_store_dwordx4 v[180:183], v2, s[36:39], s41 offen sc1
 v_mfma_f32_16x16x32_bf16 a[12:15], v[80:83], a[244:247], a[12:15]
 ds_read_b64_tr_b16 v[76:77], v18 offset:27712
 ds_read_b64_tr_b16 v[78:79], v18 offset:32320
 v_mfma_f32_16x16x32_bf16 a[12:15], v[84:87], a[252:255], a[12:15]
 s_waitcnt lgkmcnt(15)
 buffer_load_dwordx4 v2, s[36:39], s40 offen offset:2048 sc1 lds
 v_mfma_f32_16x16x32_bf16 a[16:19], v[88:91], a[240:243], a[16:19]
 ds_read_b64_tr_b16 v[80:81], v18 offset:18528
 ds_read_b64_tr_b16 v[82:83], v18 offset:23136
 v_mfma_f32_16x16x32_bf16 a[16:19], v[92:95], a[248:251], a[16:19]
 buffer_load_dwordx4 a[212:215], v5, s[28:31], s53 offen sc1
 v_mfma_f32_16x16x32_bf16 a[20:23], v[88:91], a[244:247], a[20:23]
 ds_read_b64_tr_b16 v[84:85], v18 offset:27744
 ds_read_b64_tr_b16 v[86:87], v18 offset:32352
 v_mfma_f32_16x16x32_bf16 a[20:23], v[92:95], a[252:255], a[20:23]
 s_waitcnt lgkmcnt(15)
 v_cvt_pk_bf16_f32 v186, v100, v101
 v_cvt_pk_bf16_f32 v187, v102, v103
 v_mfma_f32_16x16x32_bf16 a[24:27], v[48:51], a[240:243], a[24:27]
 ds_read_b64_tr_b16 v[88:89], v19 offset:18432
 ds_read_b64_tr_b16 v[90:91], v19 offset:23040
 v_mfma_f32_16x16x32_bf16 a[24:27], v[52:55], a[248:251], a[24:27]
 v_mfma_f32_16x16x32_bf16 a[28:31], v[48:51], a[244:247], a[28:31]
 ds_read_b64_tr_b16 v[92:93], v19 offset:27648
 ds_read_b64_tr_b16 v[94:95], v19 offset:32256
 v_mfma_f32_16x16x32_bf16 a[28:31], v[52:55], a[252:255], a[28:31]
 s_waitcnt lgkmcnt(15)
 buffer_load_dwordx4 v2, s[36:39], s40 offen offset:3072 sc1 lds
 v_mfma_f32_16x16x32_bf16 a[32:35], v[56:59], a[240:243], a[32:35]
 buffer_load_dwordx4 a[216:219], v4, s[28:31], s53 offen offset:2048 sc1
 v_mfma_f32_16x16x32_bf16 a[32:35], v[60:63], a[248:251], a[32:35]
 v_mfma_f32_16x16x32_bf16 a[36:39], v[56:59], a[244:247], a[36:39]
 v_mfma_f32_16x16x32_bf16 a[36:39], v[60:63], a[252:255], a[36:39]
 s_waitcnt lgkmcnt(14)
 v_mfma_f32_16x16x32_bf16 a[40:43], v[64:67], a[240:243], a[40:43]
 s_waitcnt vmcnt(39) lgkmcnt(12)
 v_mfma_f32_16x16x32_bf16 a[40:43], v[68:71], a[248:251], a[40:43]
 s_waitcnt lgkmcnt(0)
 v_mfma_f32_16x16x32_bf16 a[44:47], v[64:67], a[244:247], a[44:47]
 s_add_u32 m0, s8, 0x2000
 v_mfma_f32_16x16x32_bf16 a[44:47], v[68:71], a[252:255], a[44:47]
 s_add_u32 s40, s52, 0x2000
 s_barrier
 buffer_load_dwordx4 v2, s[36:39], s40 offen sc1 lds
 v_mfma_f32_16x16x32_bf16 a[48:51], v[72:75], a[240:243], a[48:51]
 ds_read_b64_tr_b16 v[48:49], v20
 ds_read_b64_tr_b16 v[50:51], v20 offset:4608
 v_mfma_f32_16x16x32_bf16 a[48:51], v[76:79], a[248:251], a[48:51]
 ds_read_b64_tr_b16 v[52:53], v20 offset:9216
 ds_read_b64_tr_b16 v[54:55], v20 offset:13824
 v_mfma_f32_16x16x32_bf16 a[52:55], v[72:75], a[244:247], a[52:55]
 buffer_load_dwordx4 a[220:223], v5, s[28:31], s53 offen offset:2048 sc1
 v_mfma_f32_16x16x32_bf16 a[52:55], v[76:79], a[252:255], a[52:55]
 ds_read_b64_tr_b16 v[56:57], v20 offset:32
 ds_read_b64_tr_b16 v[58:59], v20 offset:4640
 v_mfma_f32_16x16x32_bf16 a[56:59], v[80:83], a[240:243], a[56:59]
 s_add_u32 s52, s52, 0x9000
 ds_read_b64_tr_b16 v[60:61], v20 offset:9248
 ds_read_b64_tr_b16 v[62:63], v20 offset:13856
 v_mfma_f32_16x16x32_bf16 a[56:59], v[84:87], a[248:251], a[56:59]
 buffer_store_dwordx4 v[184:187], v2, s[36:39], s41 offen offset:1024 sc1
 v_mfma_f32_16x16x32_bf16 a[60:63], v[80:83], a[244:247], a[60:63]
 ds_read_b64_tr_b16 v[64:65], v20 offset:64
 ds_read_b64_tr_b16 v[66:67], v20 offset:4672
 v_mfma_f32_16x16x32_bf16 a[60:63], v[84:87], a[252:255], a[60:63]
 ds_read_b64_tr_b16 v[68:69], v20 offset:9280
 ds_read_b64_tr_b16 v[70:71], v20 offset:13888
 v_mfma_f32_16x16x32_bf16 a[64:67], v[88:91], a[240:243], a[64:67]
 s_add_u32 s53, s53, 0x1000
 ds_read_b64_tr_b16 v[72:73], v20 offset:96
 ds_read_b64_tr_b16 v[74:75], v20 offset:4704
 v_mfma_f32_16x16x32_bf16 a[64:67], v[92:95], a[248:251], a[64:67]
 ds_read_b64_tr_b16 v[76:77], v20 offset:9312
 ds_read_b64_tr_b16 v[78:79], v20 offset:13920
 v_mfma_f32_16x16x32_bf16 a[68:71], v[88:91], a[244:247], a[68:71]
 ds_read_b64_tr_b16 v[80:81], v21
 ds_read_b64_tr_b16 v[82:83], v21 offset:4608
 v_mfma_f32_16x16x32_bf16 a[68:71], v[92:95], a[252:255], a[68:71]
 s_waitcnt lgkmcnt(15)
 ds_read_b64_tr_b16 v[84:85], v21 offset:9216
 ds_read_b64_tr_b16 v[86:87], v21 offset:13824
 v_mfma_f32_16x16x32_bf16 a[0:3], v[48:51], a[160:163], a[0:3]
 s_waitcnt lgkmcnt(15)
 ds_read_b64_tr_b16 v[88:89], v21 offset:32
 ds_read_b64_tr_b16 v[90:91], v21 offset:4640
 v_mfma_f32_16x16x32_bf16 a[0:3], v[52:55], a[168:171], a[0:3]
 s_add_u32 m0, s9, 0
 v_mfma_f32_16x16x32_bf16 a[4:7], v[48:51], a[164:167], a[4:7]
 s_add_u32 s40, s52, 0
 buffer_load_dwordx4 v2, s[36:39], s40 offen sc1 lds
 v_mfma_f32_16x16x32_bf16 a[4:7], v[52:55], a[172:175], a[4:7]
 s_waitcnt lgkmcnt(15)
 ds_read_b64_tr_b16 v[92:93], v21 offset:9248
 ds_read_b64_tr_b16 v[94:95], v21 offset:13856
 v_mfma_f32_16x16x32_bf16 a[8:11], v[56:59], a[160:163], a[8:11]
 s_waitcnt lgkmcnt(15)
 ds_read_b64_tr_b16 v[48:49], v21 offset:64
 ds_read_b64_tr_b16 v[50:51], v21 offset:4672
 v_mfma_f32_16x16x32_bf16 a[8:11], v[60:63], a[168:171], a[8:11]
 buffer_load_dwordx4 a[224:227], v4, s[28:31], s53 offen sc1
 v_mfma_f32_16x16x32_bf16 a[12:15], v[56:59], a[164:167], a[12:15]
 ds_read_b64_tr_b16 v[52:53], v21 offset:9280
 ds_read_b64_tr_b16 v[54:55], v21 offset:13888
 v_mfma_f32_16x16x32_bf16 a[12:15], v[60:63], a[172:175], a[12:15]
 s_waitcnt lgkmcnt(15)
 v_mfma_f32_16x16x32_bf16 a[16:19], v[64:67], a[160:163], a[16:19]
 ds_read_b64_tr_b16 v[56:57], v21 offset:96
 ds_read_b64_tr_b16 v[58:59], v21 offset:4704
 v_mfma_f32_16x16x32_bf16 a[16:19], v[68:71], a[168:171], a[16:19]
 buffer_load_dwordx4 v2, s[36:39], s40 offen offset:1024 sc1 lds
 v_mfma_f32_16x16x32_bf16 a[20:23], v[64:67], a[164:167], a[20:23]
 ds_read_b64_tr_b16 v[60:61], v21 offset:9312
 ds_read_b64_tr_b16 v[62:63], v21 offset:13920
 v_mfma_f32_16x16x32_bf16 a[20:23], v[68:71], a[172:175], a[20:23]
 s_waitcnt lgkmcnt(15)
 v_mfma_f32_16x16x32_bf16 a[24:27], v[72:75], a[160:163], a[24:27]
 ds_read_b64_tr_b16 v[64:65], v22
 ds_read_b64_tr_b16 v[66:67], v22 offset:4608
 v_mfma_f32_16x16x32_bf16 a[24:27], v[76:79], a[168:171], a[24:27]
 buffer_load_dwordx4 a[228:231], v5, s[28:31], s53 offen sc1
 v_mfma_f32_16x16x32_bf16 a[28:31], v[72:75], a[164:167], a[28:31]
 ds_read_b64_tr_b16 v[68:69], v22 offset:9216
 ds_read_b64_tr_b16 v[70:71], v22 offset:13824
 v_mfma_f32_16x16x32_bf16 a[28:31], v[76:79], a[172:175], a[28:31]
 s_waitcnt lgkmcnt(15)
 buffer_load_dwordx4 v2, s[36:39], s40 offen offset:2048 sc1 lds
 v_mfma_f32_16x16x32_bf16 a[32:35], v[80:83], a[160:163], a[32:35]
 ds_read_b64_tr_b16 v[72:73], v20 offset:18432
 ds_read_b64_tr_b16 v[74:75], v20 offset:23040
 v_mfma_f32_16x16x32_bf16 a[32:35], v[84:87], a[168:171], a[32:35]
 v_mfma_f32_16x16x32_bf16 a[36:39], v[80:83], a[164:167], a[36:39]
 ds_read_b64_tr_b16 v[76:77], v20 offset:27648
 ds_read_b64_tr_b16 v[78:79], v20 offset:32256
 v_mfma_f32_16x16x32_bf16 a[36:39], v[84:87], a[172:175], a[36:39]
 s_waitcnt lgkmcnt(15)
 v_mfma_f32_16x16x32_bf16 a[40:43], v[88:91], a[160:163], a[40:43]
 ds_read_b64_tr_b16 v[80:81], v20 offset:18464
 ds_read_b64_tr_b16 v[82:83], v20 offset:23072
 v_mfma_f32_16x16x32_bf16 a[40:43], v[92:95], a[168:171], a[40:43]
 buffer_load_dwordx4 a[232:235], v4, s[28:31], s53 offen offset:2048 sc1
 v_mfma_f32_16x16x32_bf16 a[44:47], v[88:91], a[164:167], a[44:47]
 ds_read_b64_tr_b16 v[84:85], v20 offset:27680
 ds_read_b64_tr_b16 v[86:87], v20 offset:32288
 v_mfma_f32_16x16x32_bf16 a[44:47], v[92:95], a[172:175], a[44:47]
 s_waitcnt lgkmcnt(15)
 buffer_load_dwordx4 v2, s[36:39], s40 offen offset:3072 sc1 lds
 v_mfma_f32_16x16x32_bf16 a[48:51], v[48:51], a[160:163], a[48:51]
 ds_read_b64_tr_b16 v[88:89], v20 offset:18496
 ds_read_b64_tr_b16 v[90:91], v20 offset:23104
 v_mfma_f32_16x16x32_bf16 a[48:51], v[52:55], a[168:171], a[48:51]
 v_mfma_f32_16x16x32_bf16 a[52:55], v[48:51], a[164:167], a[52:55]
 ds_read_b64_tr_b16 v[92:93], v20 offset:27712
 ds_read_b64_tr_b16 v[94:95], v20 offset:32320
 v_mfma_f32_16x16x32_bf16 a[52:55], v[52:55], a[172:175], a[52:55]
 s_waitcnt lgkmcnt(15)
 v_mfma_f32_16x16x32_bf16 a[56:59], v[56:59], a[160:163], a[56:59]
 ds_read_b64_tr_b16 v[48:49], v20 offset:18528
 ds_read_b64_tr_b16 v[50:51], v20 offset:23136
 v_mfma_f32_16x16x32_bf16 a[56:59], v[60:63], a[168:171], a[56:59]
 s_add_u32 m0, s9, 0x1000
 buffer_load_dwordx4 a[236:239], v5, s[28:31], s53 offen offset:2048 sc1
 v_mfma_f32_16x16x32_bf16 a[60:63], v[56:59], a[164:167], a[60:63]
 s_add_u32 s40, s52, 0x1000
 buffer_load_dwordx4 v2, s[36:39], s40 offen sc1 lds
 v_mfma_f32_16x16x32_bf16 a[60:63], v[60:63], a[172:175], a[60:63]
 s_waitcnt lgkmcnt(15)
 ds_read_b64_tr_b16 v[52:53], v20 offset:27744
 ds_read_b64_tr_b16 v[54:55], v20 offset:32352
 v_mfma_f32_16x16x32_bf16 a[64:67], v[64:67], a[160:163], a[64:67]
 s_waitcnt lgkmcnt(15)
 ds_read_b64_tr_b16 v[56:57], v21 offset:18432
 ds_read_b64_tr_b16 v[58:59], v21 offset:23040
 v_mfma_f32_16x16x32_bf16 a[64:67], v[68:71], a[168:171], a[64:67]
 v_and_b32 v252, 3, v1
 v_lshlrev_b32 v252, 2, v252
 v_mfma_f32_16x16x32_bf16 a[68:71], v[64:67], a[164:167], a[68:71]
 ds_read_b64_tr_b16 v[60:61], v21 offset:27648
 ds_read_b64_tr_b16 v[62:63], v21 offset:32256
 v_mfma_f32_16x16x32_bf16 a[68:71], v[68:71], a[172:175], a[68:71]
 s_waitcnt lgkmcnt(15)
 v_mfma_f32_16x16x32_bf16 a[0:3], v[72:75], a[176:179], a[0:3]
 s_add_u32 s53, s53, 0x1000
 ds_read_b64_tr_b16 v[64:65], v21 offset:18464
 ds_read_b64_tr_b16 v[66:67], v21 offset:23072
 v_mfma_f32_16x16x32_bf16 a[0:3], v[76:79], a[184:187], a[0:3]
 buffer_load_dwordx4 v2, s[36:39], s40 offen offset:1024 sc1 lds
 v_mfma_f32_16x16x32_bf16 a[4:7], v[72:75], a[180:183], a[4:7]
 s_waitcnt vmcnt(51)
 buffer_load_dwordx4 a[240:243], v4, s[28:31], s53 offen sc1
 v_mfma_f32_16x16x32_bf16 a[4:7], v[76:79], a[188:191], a[4:7]
 s_waitcnt lgkmcnt(15)
 ds_read_b64_tr_b16 v[68:69], v21 offset:27680
 ds_read_b64_tr_b16 v[70:71], v21 offset:32288
 v_mfma_f32_16x16x32_bf16 a[8:11], v[80:83], a[176:179], a[8:11]
 s_waitcnt lgkmcnt(15)
 ds_read_b64_tr_b16 v[72:73], v21 offset:18496
 ds_read_b64_tr_b16 v[74:75], v21 offset:23104
 v_mfma_f32_16x16x32_bf16 a[8:11], v[84:87], a[184:187], a[8:11]
 v_mfma_f32_16x16x32_bf16 a[12:15], v[80:83], a[180:183], a[12:15]
 ds_read_b64_tr_b16 v[76:77], v21 offset:27712
 ds_read_b64_tr_b16 v[78:79], v21 offset:32320
 v_mfma_f32_16x16x32_bf16 a[12:15], v[84:87], a[188:191], a[12:15]
 s_waitcnt lgkmcnt(15)
 buffer_load_dwordx4 v2, s[36:39], s40 offen offset:2048 sc1 lds
 v_mfma_f32_16x16x32_bf16 a[16:19], v[88:91], a[176:179], a[16:19]
 ds_read_b64_tr_b16 v[80:81], v21 offset:18528
 ds_read_b64_tr_b16 v[82:83], v21 offset:23136
 v_mfma_f32_16x16x32_bf16 a[16:19], v[92:95], a[184:187], a[16:19]
 buffer_load_dwordx4 a[244:247], v5, s[28:31], s53 offen sc1
 v_mfma_f32_16x16x32_bf16 a[20:23], v[88:91], a[180:183], a[20:23]
 ds_read_b64_tr_b16 v[84:85], v21 offset:27744
 ds_read_b64_tr_b16 v[86:87], v21 offset:32352
 v_mfma_f32_16x16x32_bf16 a[20:23], v[92:95], a[188:191], a[20:23]
 s_waitcnt lgkmcnt(15)
 v_mfma_f32_16x16x32_bf16 a[24:27], v[48:51], a[176:179], a[24:27]
 ds_read_b64_tr_b16 v[88:89], v22 offset:18432
 ds_read_b64_tr_b16 v[90:91], v22 offset:23040
 v_mfma_f32_16x16x32_bf16 a[24:27], v[52:55], a[184:187], a[24:27]
 v_mfma_f32_16x16x32_bf16 a[28:31], v[48:51], a[180:183], a[28:31]
 ds_read_b64_tr_b16 v[92:93], v22 offset:27648
 ds_read_b64_tr_b16 v[94:95], v22 offset:32256
 v_mfma_f32_16x16x32_bf16 a[28:31], v[52:55], a[188:191], a[28:31]
 s_waitcnt lgkmcnt(15)
 buffer_load_dwordx4 v2, s[36:39], s40 offen offset:3072 sc1 lds
 v_mfma_f32_16x16x32_bf16 a[32:35], v[56:59], a[176:179], a[32:35]
 buffer_load_dwordx4 a[248:251], v4, s[28:31], s53 offen offset:2048 sc1
 v_mfma_f32_16x16x32_bf16 a[32:35], v[60:63], a[184:187], a[32:35]
 v_mfma_f32_16x16x32_bf16 a[36:39], v[56:59], a[180:183], a[36:39]
 v_mfma_f32_16x16x32_bf16 a[36:39], v[60:63], a[188:191], a[36:39]
 s_waitcnt vmcnt(15) lgkmcnt(14)
 v_mfma_f32_16x16x32_bf16 a[40:43], v[64:67], a[176:179], a[40:43]
 s_waitcnt lgkmcnt(12)
 v_mfma_f32_16x16x32_bf16 a[40:43], v[68:71], a[184:187], a[40:43]
 s_waitcnt lgkmcnt(0)
 v_mfma_f32_16x16x32_bf16 a[44:47], v[64:67], a[180:183], a[44:47]
 s_add_u32 m0, s9, 0x2000
 v_mfma_f32_16x16x32_bf16 a[44:47], v[68:71], a[188:191], a[44:47]
 s_add_u32 s40, s52, 0x2000
 s_barrier
 buffer_load_dwordx4 v2, s[36:39], s40 offen sc1 lds
 v_mfma_f32_16x16x32_bf16 a[48:51], v[72:75], a[176:179], a[48:51]
 ds_read_b64_tr_b16 v[48:49], v23
 ds_read_b64_tr_b16 v[50:51], v23 offset:4608
 v_mfma_f32_16x16x32_bf16 a[48:51], v[76:79], a[184:187], a[48:51]
 s_cmp_lg_u32 s3, 0
 s_cbranch_scc1 L_sgg
 s_mov_b64 exec, 1
 buffer_store_dword v253, off, s[36:39], s44 sc1
 s_mov_b64 exec, -1
L_sgg:
 ds_read_b64_tr_b16 v[52:53], v23 offset:9216
 ds_read_b64_tr_b16 v[54:55], v23 offset:13824
 v_mfma_f32_16x16x32_bf16 a[52:55], v[72:75], a[180:183], a[52:55]
 buffer_load_dwordx4 a[252:255], v5, s[28:31], s53 offen offset:2048 sc1
 v_mfma_f32_16x16x32_bf16 a[52:55], v[76:79], a[188:191], a[52:55]
 ds_read_b64_tr_b16 v[56:57], v23 offset:32
 ds_read_b64_tr_b16 v[58:59], v23 offset:4640
 v_mfma_f32_16x16x32_bf16 a[56:59], v[80:83], a[176:179], a[56:59]
 s_add_u32 s52, s52, 0x9000
 ds_read_b64_tr_b16 v[60:61], v23 offset:9248
 ds_read_b64_tr_b16 v[62:63], v23 offset:13856
 v_mfma_f32_16x16x32_bf16 a[56:59], v[84:87], a[184:187], a[56:59]
 ds_read_b64_tr_b16 v[64:65], v23 offset:64
 ds_read_b64_tr_b16 v[66:67], v23 offset:4672
 v_mfma_f32_16x16x32_bf16 a[60:63], v[80:83], a[180:183], a[60:63]
 ds_read_b64_tr_b16 v[68:69], v23 offset:9280
 ds_read_b64_tr_b16 v[70:71], v23 offset:13888
 v_mfma_f32_16x16x32_bf16 a[60:63], v[84:87], a[188:191], a[60:63]
 ds_read_b64_tr_b16 v[72:73], v23 offset:96
 ds_read_b64_tr_b16 v[74:75], v23 offset:4704
 v_mfma_f32_16x16x32_bf16 a[64:67], v[88:91], a[176:179], a[64:67]
 s_add_u32 s53, s53, 0x1000
 ds_read_b64_tr_b16 v[76:77], v23 offset:9312
 ds_read_b64_tr_b16 v[78:79], v23 offset:13920
 v_mfma_f32_16x16x32_bf16 a[64:67], v[92:95], a[184:187], a[64:67]
 ds_read_b64_tr_b16 v[80:81], v24
 ds_read_b64_tr_b16 v[82:83], v24 offset:4608
 v_mfma_f32_16x16x32_bf16 a[68:71], v[88:91], a[180:183], a[68:71]
 ds_read_b64_tr_b16 v[84:85], v24 offset:9216
 ds_read_b64_tr_b16 v[86:87], v24 offset:13824
 v_mfma_f32_16x16x32_bf16 a[68:71], v[92:95], a[188:191], a[68:71]
 s_waitcnt lgkmcnt(15)
 v_mfma_f32_16x16x32_bf16 a[0:3], v[48:51], v[128:131], a[0:3]
 ds_read_b64_tr_b16 v[88:89], v24 offset:32
 ds_read_b64_tr_b16 v[90:91], v24 offset:4640
 v_mfma_f32_16x16x32_bf16 a[0:3], v[52:55], v[136:139], a[0:3]
 s_add_u32 m0, s10, 0
 v_mfma_f32_16x16x32_bf16 a[4:7], v[48:51], v[132:135], a[4:7]
 s_add_u32 s40, s52, 0
 buffer_load_dwordx4 v2, s[36:39], s40 offen sc1 lds
 v_mfma_f32_16x16x32_bf16 a[4:7], v[52:55], v[140:143], a[4:7]
 s_waitcnt lgkmcnt(15)
 ds_read_b64_tr_b16 v[92:93], v24 offset:9248
 ds_read_b64_tr_b16 v[94:95], v24 offset:13856
 v_mfma_f32_16x16x32_bf16 a[8:11], v[56:59], v[128:131], a[8:11]
 s_waitcnt lgkmcnt(15)
 ds_read_b64_tr_b16 v[48:49], v24 offset:64
 ds_read_b64_tr_b16 v[50:51], v24 offset:4672
 v_mfma_f32_16x16x32_bf16 a[8:11], v[60:63], v[136:139], a[8:11]
 buffer_load_dwordx4 a[160:163], v4, s[28:31], s53 offen sc1
 v_mfma_f32_16x16x32_bf16 a[12:15], v[56:59], v[132:135], a[12:15]
 ds_read_b64_tr_b16 v[52:53], v24 offset:9280
 ds_read_b64_tr_b16 v[54:55], v24 offset:13888
 v_mfma_f32_16x16x32_bf16 a[12:15], v[60:63], v[140:143], a[12:15]
 s_waitcnt lgkmcnt(15)
 v_mfma_f32_16x16x32_bf16 a[16:19], v[64:67], v[128:131], a[16:19]
 ds_read_b64_tr_b16 v[56:57], v24 offset:96
 ds_read_b64_tr_b16 v[58:59], v24 offset:4704
 v_mfma_f32_16x16x32_bf16 a[16:19], v[68:71], v[136:139], a[16:19]
 s_waitcnt lgkmcnt(15)
 buffer_load_dwordx4 v2, s[36:39], s40 offen offset:1024 sc1 lds
 v_mfma_f32_16x16x32_bf16 a[20:23], v[64:67], v[132:135], a[20:23]
 s_getpc_b64 s[62:63]
L_pcR2:
 s_add_u32 s62, s62, L_pcR2+2048-L_pcR2
 s_addc_u32 s63, s63, 0
 ds_read_b64_tr_b16 v[60:61], v24 offset:9312
 ds_read_b64_tr_b16 v[62:63], v24 offset:13920
 v_mfma_f32_16x16x32_bf16 a[20:23], v[68:71], v[140:143], a[20:23]
 s_bfe_u32 s18, s2, 0x10003
 v_and_b32 v246, 15, v1
 v_lshlrev_b32 v246, 7, v246
 v_mfma_f32_16x16x32_bf16 a[24:27], v[72:75], v[128:131], a[24:27]
 s_waitcnt lgkmcnt(15)
 s_lshl_b32 s18, s18, 2
 ds_read_b64_tr_b16 v[64:65], v25
 ds_read_b64_tr_b16 v[66:67], v25 offset:4608
 v_mfma_f32_16x16x32_bf16 a[24:27], v[76:79], v[136:139], a[24:27]
 s_add_u32 s18, s18, s3
 v_mfma_f32_16x16x32_bf16 a[28:31], v[72:75], v[132:135], a[28:31]
 s_lshl_b32 s18, s18, 11
 ds_read_b64_tr_b16 v[68:69], v25 offset:9216
 ds_read_b64_tr_b16 v[70:71], v25 offset:13824
 v_mfma_f32_16x16x32_bf16 a[28:31], v[76:79], v[140:143], a[28:31]
 s_waitcnt lgkmcnt(15)
 s_add_u32 s62, s62, s18
 s_addc_u32 s63, s63, 0
 v_mov_b32 v247, s63
 v_mfma_f32_16x16x32_bf16 a[32:35], v[80:83], v[128:131], a[32:35]
 v_add_co_u32 v246, vcc, s62, v246
 s_nop 1
 v_addc_co_u32 v247, vcc, 0, v247, vcc
 v_mfma_f32_16x16x32_bf16 a[32:35], v[84:87], v[136:139], a[32:35]
 global_load_dword v250, v[246:247], off
 v_mfma_f32_16x16x32_bf16 a[36:39], v[80:83], v[132:135], a[36:39]
 buffer_load_dwordx4 a[164:167], v5, s[28:31], s53 offen sc1
 v_mfma_f32_16x16x32_bf16 a[36:39], v[84:87], v[140:143], a[36:39]
 s_waitcnt lgkmcnt(14)
 buffer_load_dwordx4 v2, s[36:39], s40 offen offset:2048 sc1 lds
 v_mfma_f32_16x16x32_bf16 a[40:43], v[88:91], v[128:131], a[40:43]
 s_waitcnt lgkmcnt(12)
 ds_read_b64_tr_b16 v[72:73], v23 offset:18432
 ds_read_b64_tr_b16 v[74:75], v23 offset:23040
 v_mfma_f32_16x16x32_bf16 a[40:43], v[92:95], v[136:139], a[40:43]
 ds_read_b64_tr_b16 v[76:77], v23 offset:27648
 ds_read_b64_tr_b16 v[78:79], v23 offset:32256
 v_mfma_f32_16x16x32_bf16 a[44:47], v[88:91], v[132:135], a[44:47]
 ds_read_b64_tr_b16 v[80:81], v23 offset:18464
 ds_read_b64_tr_b16 v[82:83], v23 offset:23072
 v_mfma_f32_16x16x32_bf16 a[44:47], v[92:95], v[140:143], a[44:47]
 s_waitcnt lgkmcnt(15)
 buffer_load_dwordx4 a[168:171], v4, s[28:31], s53 offen offset:2048 sc1
 v_mfma_f32_16x16x32_bf16 a[48:51], v[48:51], v[128:131], a[48:51]
 s_waitcnt lgkmcnt(14)
 ds_read_b64_tr_b16 v[84:85], v23 offset:27680
 ds_read_b64_tr_b16 v[86:87], v23 offset:32288
 v_mfma_f32_16x16x32_bf16 a[48:51], v[52:55], v[136:139], a[48:51]
 buffer_load_dwordx4 v2, s[36:39], s40 offen offset:3072 sc1 lds
 v_mfma_f32_16x16x32_bf16 a[52:55], v[48:51], v[132:135], a[52:55]
 ds_read_b64_tr_b16 v[88:89], v23 offset:18496
 ds_read_b64_tr_b16 v[90:91], v23 offset:23104
 v_mfma_f32_16x16x32_bf16 a[52:55], v[52:55], v[140:143], a[52:55]
 s_waitcnt lgkmcnt(15)
 ds_read_b64_tr_b16 v[92:93], v23 offset:27712
 ds_read_b64_tr_b16 v[94:95], v23 offset:32320
 v_mfma_f32_16x16x32_bf16 a[56:59], v[56:59], v[128:131], a[56:59]
 s_waitcnt lgkmcnt(15)
 ds_read_b64_tr_b16 v[48:49], v23 offset:18528
 ds_read_b64_tr_b16 v[50:51], v23 offset:23136
 v_mfma_f32_16x16x32_bf16 a[56:59], v[60:63], v[136:139], a[56:59]
 s_add_u32 m0, s10, 0x1000
 buffer_load_dwordx4 a[172:175], v5, s[28:31], s53 offen offset:2048 sc1
 v_mfma_f32_16x16x32_bf16 a[60:63], v[56:59], v[132:135], a[60:63]
 s_add_u32 s40, s52, 0x1000
 buffer_load_dwordx4 v2, s[36:39], s40 offen sc1 lds
 v_mfma_f32_16x16x32_bf16 a[60:63], v[60:63], v[140:143], a[60:63]
 s_waitcnt lgkmcnt(15)
 ds_read_b64_tr_b16 v[52:53], v23 offset:27744
 ds_read_b64_tr_b16 v[54:55], v23 offset:32352
 v_mfma_f32_16x16x32_bf16 a[64:67], v[64:67], v[128:131], a[64:67]
 s_waitcnt lgkmcnt(15)
 ds_read_b64_tr_b16 v[56:57], v24 offset:18432
 ds_read_b64_tr_b16 v[58:59], v24 offset:23040
 v_mfma_f32_16x16x32_bf16 a[64:67], v[68:71], v[136:139], a[64:67]
 v_mfma_f32_16x16x32_bf16 a[68:71], v[64:67], v[132:135], a[68:71]
 ds_read_b64_tr_b16 v[60:61], v24 offset:27648
 ds_read_b64_tr_b16 v[62:63], v24 offset:32256
 v_mfma_f32_16x16x32_bf16 a[68:71], v[68:71], v[140:143], a[68:71]
 s_waitcnt lgkmcnt(15)
 v_mfma_f32_16x16x32_bf16 a[0:3], v[72:75], v[144:147], a[0:3]
 s_add_u32 s53, s53, 0x1000
 ds_read_b64_tr_b16 v[64:65], v24 offset:18464
 ds_read_b64_tr_b16 v[66:67], v24 offset:23072
 v_mfma_f32_16x16x32_bf16 a[0:3], v[76:79], v[152:155], a[0:3]
 buffer_load_dwordx4 v2, s[36:39], s40 offen offset:1024 sc1 lds
 v_mfma_f32_16x16x32_bf16 a[4:7], v[72:75], v[148:151], a[4:7]
 buffer_load_dwordx4 a[176:179], v4, s[28:31], s53 offen sc1
 v_mfma_f32_16x16x32_bf16 a[4:7], v[76:79], v[156:159], a[4:7]
 s_waitcnt lgkmcnt(15)
 ds_read_b64_tr_b16 v[68:69], v24 offset:27680
 ds_read_b64_tr_b16 v[70:71], v24 offset:32288
 v_mfma_f32_16x16x32_bf16 a[8:11], v[80:83], v[144:147], a[8:11]
 s_waitcnt lgkmcnt(15)
 ds_read_b64_tr_b16 v[72:73], v24 offset:18496
 ds_read_b64_tr_b16 v[74:75], v24 offset:23104
 v_mfma_f32_16x16x32_bf16 a[8:11], v[84:87], v[152:155], a[8:11]
 v_mfma_f32_16x16x32_bf16 a[12:15], v[80:83], v[148:151], a[12:15]
 ds_read_b64_tr_b16 v[76:77], v24 offset:27712
 ds_read_b64_tr_b16 v[78:79], v24 offset:32320
 v_mfma_f32_16x16x32_bf16 a[12:15], v[84:87], v[156:159], a[12:15]
 s_waitcnt lgkmcnt(15)
 buffer_load_dwordx4 v2, s[36:39], s40 offen offset:2048 sc1 lds
 v_mfma_f32_16x16x32_bf16 a[16:19], v[88:91], v[144:147], a[16:19]
 ds_read_b64_tr_b16 v[80:81], v24 offset:18528
 ds_read_b64_tr_b16 v[82:83], v24 offset:23136
 v_mfma_f32_16x16x32_bf16 a[16:19], v[92:95], v[152:155], a[16:19]
 buffer_load_dwordx4 a[180:183], v5, s[28:31], s53 offen sc1
 v_mfma_f32_16x16x32_bf16 a[20:23], v[88:91], v[148:151], a[20:23]
 ds_read_b64_tr_b16 v[84:85], v24 offset:27744
 ds_read_b64_tr_b16 v[86:87], v24 offset:32352
 v_mfma_f32_16x16x32_bf16 a[20:23], v[92:95], v[156:159], a[20:23]
 s_waitcnt lgkmcnt(15)
 v_mfma_f32_16x16x32_bf16 a[24:27], v[48:51], v[144:147], a[24:27]
 ds_read_b64_tr_b16 v[88:89], v25 offset:18432
 ds_read_b64_tr_b16 v[90:91], v25 offset:23040
 v_mfma_f32_16x16x32_bf16 a[24:27], v[52:55], v[152:155], a[24:27]
 v_mfma_f32_16x16x32_bf16 a[28:31], v[48:51], v[148:151], a[28:31]
 ds_read_b64_tr_b16 v[92:93], v25 offset:27648
 ds_read_b64_tr_b16 v[94:95], v25 offset:32256
 v_mfma_f32_16x16x32_bf16 a[28:31], v[52:55], v[156:159], a[28:31]
 s_waitcnt lgkmcnt(15)
 buffer_load_dwordx4 v2, s[36:39], s40 offen offset:3072 sc1 lds
 v_mfma_f32_16x16x32_bf16 a[32:35], v[56:59], v[144:147], a[32:35]
 buffer_load_dwordx4 a[184:187], v4, s[28:31], s53 offen offset:2048 sc1
 v_mfma_f32_16x16x32_bf16 a[32:35], v[60:63], v[152:155], a[32:35]
 v_mfma_f32_16x16x32_bf16 a[36:39], v[56:59], v[148:151], a[36:39]
 v_mfma_f32_16x16x32_bf16 a[36:39], v[60:63], v[156:159], a[36:39]
 s_waitcnt lgkmcnt(14)
 v_mfma_f32_16x16x32_bf16 a[40:43], v[64:67], v[144:147], a[40:43]
 s_waitcnt lgkmcnt(12)
 v_mfma_f32_16x16x32_bf16 a[40:43], v[68:71], v[152:155], a[40:43]
 s_waitcnt lgkmcnt(0)
 v_mfma_f32_16x16x32_bf16 a[44:47], v[64:67], v[148:151], a[44:47]
 s_add_u32 m0, s10, 0x2000
 v_mfma_f32_16x16x32_bf16 a[44:47], v[68:71], v[156:159], a[44:47]
 s_add_u32 s40, s52, 0x2000
 s_barrier
 buffer_load_dwordx4 v2, s[36:39], s40 offen sc1 lds
 v_mfma_f32_16x16x32_bf16 a[48:51], v[72:75], v[144:147], a[48:51]
 ds_read_b64_tr_b16 v[48:49], v14
 ds_read_b64_tr_b16 v[50:51], v14 offset:4608
 v_mfma_f32_16x16x32_bf16 a[48:51], v[76:79], v[152:155], a[48:51]
 ds_read_b64_tr_b16 v[52:53], v14 offset:9216
 ds_read_b64_tr_b16 v[54:55], v14 offset:13824
 v_mfma_f32_16x16x32_bf16 a[52:55], v[72:75], v[148:151], a[52:55]
 buffer_load_dwordx4 a[188:191], v5, s[28:31], s53 offen offset:2048 sc1
 v_mfma_f32_16x16x32_bf16 a[52:55], v[76:79], v[156:159], a[52:55]
 ds_read_b64_tr_b16 v[56:57], v14 offset:32
 ds_read_b64_tr_b16 v[58:59], v14 offset:4640
 v_mfma_f32_16x16x32_bf16 a[56:59], v[80:83], v[144:147], a[56:59]
 s_add_u32 s52, s52, 0x9000
 ds_read_b64_tr_b16 v[60:61], v14 offset:9248
 ds_read_b64_tr_b16 v[62:63], v14 offset:13856
 v_mfma_f32_16x16x32_bf16 a[56:59], v[84:87], v[152:155], a[56:59]
 ds_read_b64_tr_b16 v[64:65], v14 offset:64
 ds_read_b64_tr_b16 v[66:67], v14 offset:4672
 v_mfma_f32_16x16x32_bf16 a[60:63], v[80:83], v[148:151], a[60:63]
 ds_read_b64_tr_b16 v[68:69], v14 offset:9280
 ds_read_b64_tr_b16 v[70:71], v14 offset:13888
 v_mfma_f32_16x16x32_bf16 a[60:63], v[84:87], v[156:159], a[60:63]
 ds_read_b64_tr_b16 v[72:73], v14 offset:96
 ds_read_b64_tr_b16 v[74:75], v14 offset:4704
 v_mfma_f32_16x16x32_bf16 a[64:67], v[88:91], v[144:147], a[64:67]
 s_add_u32 s53, s53, 0x1000
 ds_read_b64_tr_b16 v[76:77], v14 offset:9312
 ds_read_b64_tr_b16 v[78:79], v14 offset:13920
 v_mfma_f32_16x16x32_bf16 a[64:67], v[92:95], v[152:155], a[64:67]
 buffer_load_dwordx2 v[220:221], v8, s[4:7], 0 offen
 v_mfma_f32_16x16x32_bf16 a[68:71], v[88:91], v[148:151], a[68:71]
 buffer_load_dword v252, v252, s[36:39], s48 offen sc1
 v_mfma_f32_16x16x32_bf16 a[68:71], v[92:95], v[156:159], a[68:71]
 s_waitcnt lgkmcnt(14)
 ds_read_b64_tr_b16 v[80:81], v15
 ds_read_b64_tr_b16 v[82:83], v15 offset:4608
 v_mfma_f32_16x16x32_bf16 a[0:3], v[48:51], a[192:195], a[0:3]
 s_waitcnt lgkmcnt(14)
 buffer_load_dwordx2 v[222:223], v8, s[4:7], 0 offen offset:32
 v_mfma_f32_16x16x32_bf16 a[0:3], v[52:55], a[200:203], a[0:3]
 ds_read_b64_tr_b16 v[84:85], v15 offset:9216
 ds_read_b64_tr_b16 v[86:87], v15 offset:13824
 v_mfma_f32_16x16x32_bf16 a[4:7], v[48:51], a[196:199], a[4:7]
 ds_read_b64_tr_b16 v[88:89], v15 offset:32
 ds_read_b64_tr_b16 v[90:91], v15 offset:4640
 v_mfma_f32_16x16x32_bf16 a[4:7], v[52:55], a[204:207], a[4:7]
 s_waitcnt lgkmcnt(15)
 buffer_load_dwordx2 v[224:225], v8, s[4:7], 0 offen offset:64
 v_mfma_f32_16x16x32_bf16 a[8:11], v[56:59], a[192:195], a[8:11]
 s_waitcnt lgkmcnt(14)
 ds_read_b64_tr_b16 v[92:93], v15 offset:9248
 ds_read_b64_tr_b16 v[94:95], v15 offset:13856
 v_mfma_f32_16x16x32_bf16 a[8:11], v[60:63], a[200:203], a[8:11]
 buffer_load_dwordx2 v[226:227], v8, s[4:7], 0 offen offset:96
 v_mfma_f32_16x16x32_bf16 a[12:15], v[56:59], a[196:199], a[12:15]
 ds_read_b64_tr_b16 v[48:49], v15 offset:64
 ds_read_b64_tr_b16 v[50:51], v15 offset:4672
 v_mfma_f32_16x16x32_bf16 a[12:15], v[60:63], a[204:207], a[12:15]
 s_waitcnt lgkmcnt(15)
 ds_read_b64_tr_b16 v[52:53], v15 offset:9280
 ds_read_b64_tr_b16 v[54:55], v15 offset:13888
 v_mfma_f32_16x16x32_bf16 a[16:19], v[64:67], a[192:195], a[16:19]
 s_waitcnt lgkmcnt(15)
 buffer_load_dwordx2 v[228:229], v9, s[4:7], 0 offen
 v_mfma_f32_16x16x32_bf16 a[16:19], v[68:71], a[200:203], a[16:19]
 ds_read_b64_tr_b16 v[56:57], v15 offset:96
 ds_read_b64_tr_b16 v[58:59], v15 offset:4704
 v_mfma_f32_16x16x32_bf16 a[20:23], v[64:67], a[196:199], a[20:23]
 ds_read_b64_tr_b16 v[60:61], v15 offset:9312
 ds_read_b64_tr_b16 v[62:63], v15 offset:13920
 v_mfma_f32_16x16x32_bf16 a[20:23], v[68:71], a[204:207], a[20:23]
 s_waitcnt lgkmcnt(15)
 v_mfma_f32_16x16x32_bf16 a[24:27], v[72:75], a[192:195], a[24:27]
 ds_read_b64_tr_b16 v[64:65], v16
 ds_read_b64_tr_b16 v[66:67], v16 offset:4608
 v_mfma_f32_16x16x32_bf16 a[24:27], v[76:79], a[200:203], a[24:27]
 v_mfma_f32_16x16x32_bf16 a[28:31], v[72:75], a[196:199], a[28:31]
 ds_read_b64_tr_b16 v[68:69], v16 offset:9216
 ds_read_b64_tr_b16 v[70:71], v16 offset:13824
 v_mfma_f32_16x16x32_bf16 a[28:31], v[76:79], a[204:207], a[28:31]
 s_waitcnt lgkmcnt(15)
 v_mfma_f32_16x16x32_bf16 a[32:35], v[80:83], a[192:195], a[32:35]
 ds_read_b64_tr_b16 v[72:73], v14 offset:18432
 ds_read_b64_tr_b16 v[74:75], v14 offset:23040
 v_mfma_f32_16x16x32_bf16 a[32:35], v[84:87], a[200:203], a[32:35]
 v_mfma_f32_16x16x32_bf16 a[36:39], v[80:83], a[196:199], a[36:39]
 ds_read_b64_tr_b16 v[76:77], v14 offset:27648
 ds_read_b64_tr_b16 v[78:79], v14 offset:32256
 v_mfma_f32_16x16x32_bf16 a[36:39], v[84:87], a[204:207], a[36:39]
 s_waitcnt lgkmcnt(15)
 v_mfma_f32_16x16x32_bf16 a[40:43], v[88:91], a[192:195], a[40:43]
 ds_read_b64_tr_b16 v[80:81], v14 offset:18464
 ds_read_b64_tr_b16 v[82:83], v14 offset:23072
 v_mfma_f32_16x16x32_bf16 a[40:43], v[92:95], a[200:203], a[40:43]
 v_mfma_f32_16x16x32_bf16 a[44:47], v[88:91], a[196:199], a[44:47]
 ds_read_b64_tr_b16 v[84:85], v14 offset:27680
 ds_read_b64_tr_b16 v[86:87], v14 offset:32288
 v_mfma_f32_16x16x32_bf16 a[44:47], v[92:95], a[204:207], a[44:47]
 s_waitcnt lgkmcnt(15)
 v_mfma_f32_16x16x32_bf16 a[48:51], v[48:51], a[192:195], a[48:51]
 ds_read_b64_tr_b16 v[88:89], v14 offset:18496
 ds_read_b64_tr_b16 v[90:91], v14 offset:23104
 v_mfma_f32_16x16x32_bf16 a[48:51], v[52:55], a[200:203], a[48:51]
 v_mfma_f32_16x16x32_bf16 a[52:55], v[48:51], a[196:199], a[52:55]
 ds_read_b64_tr_b16 v[92:93], v14 offset:27712
 ds_read_b64_tr_b16 v[94:95], v14 offset:32320
 v_mfma_f32_16x16x32_bf16 a[52:55], v[52:55], a[204:207], a[52:55]
 s_waitcnt lgkmcnt(15)
 v_mfma_f32_16x16x32_bf16 a[56:59], v[56:59], a[192:195], a[56:59]
 ds_read_b64_tr_b16 v[48:49], v14 offset:18528
 ds_read_b64_tr_b16 v[50:51], v14 offset:23136
 v_mfma_f32_16x16x32_bf16 a[56:59], v[60:63], a[200:203], a[56:59]
 v_mfma_f32_16x16x32_bf16 a[60:63], v[56:59], a[196:199], a[60:63]
 ds_read_b64_tr_b16 v[52:53], v14 offset:27744
 ds_read_b64_tr_b16 v[54:55], v14 offset:32352
 v_mfma_f32_16x16x32_bf16 a[60:63], v[60:63], a[204:207], a[60:63]
 s_waitcnt lgkmcnt(15)
 v_mfma_f32_16x16x32_bf16 a[64:67], v[64:67], a[192:195], a[64:67]
 ds_read_b64_tr_b16 v[56:57], v15 offset:18432
 ds_read_b64_tr_b16 v[58:59], v15 offset:23040
 v_mfma_f32_16x16x32_bf16 a[64:67], v[68:71], a[200:203], a[64:67]
 s_waitcnt lgkmcnt(15)
 v_mfma_f32_16x16x32_bf16 a[68:71], v[64:67], a[196:199], a[68:71]
 s_xor_b32 s19, s70, 1
 ds_read_b64_tr_b16 v[60:61], v15 offset:27648
 ds_read_b64_tr_b16 v[62:63], v15 offset:32256
 v_mfma_f32_16x16x32_bf16 a[68:71], v[68:71], a[204:207], a[68:71]
 s_lshl_b32 s19, s19, 15
 s_waitcnt vmcnt(4)
 v_cmp_ne_u32 s[46:47], v252, v253
 v_mfma_f32_16x16x32_bf16 a[0:3], v[72:75], a[208:211], a[0:3]
 s_waitcnt lgkmcnt(15)
 s_nop 0
 ds_read_b64_tr_b16 v[64:65], v15 offset:18464
 ds_read_b64_tr_b16 v[66:67], v15 offset:23072
 v_mfma_f32_16x16x32_bf16 a[0:3], v[76:79], a[216:219], a[0:3]
 s_add_u32 s19, s19, s57
 v_mfma_f32_16x16x32_bf16 a[4:7], v[72:75], a[212:215], a[4:7]
 s_add_u32 s18, s19, 0x1800
 ds_read_b64_tr_b16 v[68:69], v15 offset:27680
 ds_read_b64_tr_b16 v[70:71], v15 offset:32288
 v_mfma_f32_16x16x32_bf16 a[4:7], v[76:79], a[220:223], a[4:7]
 s_waitcnt lgkmcnt(15)
 s_add_u32 s19, s19, 0
 buffer_load_dwordx4 v[160:163], v2, s[36:39], s19 offen sc1
 v_mfma_f32_16x16x32_bf16 a[8:11], v[80:83], a[208:211], a[8:11]
 buffer_load_dwordx4 v[164:167], v2, s[36:39], s19 offen offset:1024 sc1
 v_mfma_f32_16x16x32_bf16 a[8:11], v[84:87], a[216:219], a[8:11]
 s_xor_b32 s19, s70, 2
 buffer_load_dwordx2 v[168:169], v2, s[36:39], s18 offen offset:8 sc1
 v_mfma_f32_16x16x32_bf16 a[12:15], v[80:83], a[212:215], a[12:15]
 s_lshl_b32 s19, s19, 15
 ds_read_b64_tr_b16 v[72:73], v15 offset:18496
 ds_read_b64_tr_b16 v[74:75], v15 offset:23104
 v_mfma_f32_16x16x32_bf16 a[12:15], v[84:87], a[220:223], a[12:15]
 s_waitcnt lgkmcnt(14)
 s_add_u32 s19, s19, s57
 ds_read_b64_tr_b16 v[76:77], v15 offset:27712
 ds_read_b64_tr_b16 v[78:79], v15 offset:32320
 v_mfma_f32_16x16x32_bf16 a[16:19], v[88:91], a[208:211], a[16:19]
 s_add_u32 s18, s19, 0x1800
 ds_read_b64_tr_b16 v[80:81], v15 offset:18528
 ds_read_b64_tr_b16 v[82:83], v15 offset:23136
 v_mfma_f32_16x16x32_bf16 a[16:19], v[92:95], a[216:219], a[16:19]
 s_add_u32 s19, s19, 0x800
 buffer_load_dwordx4 v[170:173], v2, s[36:39], s19 offen sc1
 v_mfma_f32_16x16x32_bf16 a[20:23], v[88:91], a[212:215], a[20:23]
 s_waitcnt lgkmcnt(14)
 buffer_load_dwordx4 v[174:177], v2, s[36:39], s19 offen offset:1024 sc1
 v_mfma_f32_16x16x32_bf16 a[20:23], v[92:95], a[220:223], a[20:23]
 s_xor_b32 s19, s70, 3
 buffer_load_dwordx2 v[178:179], v2, s[36:39], s18 offen sc1
 v_mfma_f32_16x16x32_bf16 a[24:27], v[48:51], a[208:211], a[24:27]
 s_lshl_b32 s19, s19, 15
 ds_read_b64_tr_b16 v[84:85], v15 offset:27744
 ds_read_b64_tr_b16 v[86:87], v15 offset:32352
 v_mfma_f32_16x16x32_bf16 a[24:27], v[52:55], a[216:219], a[24:27]
 s_add_u32 s19, s19, s57
 ds_read_b64_tr_b16 v[88:89], v16 offset:18432
 ds_read_b64_tr_b16 v[90:91], v16 offset:23040
 v_mfma_f32_16x16x32_bf16 a[28:31], v[48:51], a[212:215], a[28:31]
 s_add_u32 s18, s19, 0x1800
 ds_read_b64_tr_b16 v[92:93], v16 offset:27648
 ds_read_b64_tr_b16 v[94:95], v16 offset:32256
 v_mfma_f32_16x16x32_bf16 a[28:31], v[52:55], a[220:223], a[28:31]
 s_waitcnt lgkmcnt(15)
 s_add_u32 s19, s19, 0x1000
 buffer_load_dwordx4 v[180:183], v2, s[36:39], s19 offen sc1
 v_mfma_f32_16x16x32_bf16 a[32:35], v[56:59], a[208:211], a[32:35]
 buffer_load_dwordx4 v[184:187], v2, s[36:39], s19 offen offset:1024 sc1
 v_mfma_f32_16x16x32_bf16 a[32:35], v[60:63], a[216:219], a[32:35]
 buffer_load_dwordx2 v[188:189], v2, s[36:39], s18 offen offset:8 sc1
 v_mfma_f32_16x16x32_bf16 a[36:39], v[56:59], a[212:215], a[36:39]
 v_mfma_f32_16x16x32_bf16 a[36:39], v[60:63], a[220:223], a[36:39]
 s_waitcnt lgkmcnt(14)
 v_mfma_f32_16x16x32_bf16 a[40:43], v[64:67], a[208:211], a[40:43]
 s_waitcnt lgkmcnt(12)
 v_mfma_f32_16x16x32_bf16 a[40:43], v[68:71], a[216:219], a[40:43]
 s_waitcnt lgkmcnt(0)
 v_mfma_f32_16x16x32_bf16 a[44:47], v[64:67], a[212:215], a[44:47]
 s_barrier
 v_mfma_f32_16x16x32_bf16 a[44:47], v[68:71], a[220:223], a[44:47]
 ds_read_b64_tr_b16 v[48:49], v18
 ds_read_b64_tr_b16 v[50:51], v18 offset:4608
 v_mfma_f32_16x16x32_bf16 a[48:51], v[72:75], a[208:211], a[48:51]
 ds_read_b64_tr_b16 v[52:53], v18 offset:9216
 ds_read_b64_tr_b16 v[54:55], v18 offset:13824
 v_mfma_f32_16x16x32_bf16 a[48:51], v[76:79], a[216:219], a[48:51]
 ds_read_b64_tr_b16 v[56:57], v18 offset:18432
 ds_read_b64_tr_b16 v[58:59], v18 offset:23040
 v_mfma_f32_16x16x32_bf16 a[52:55], v[72:75], a[212:215], a[52:55]
 ds_read_b64_tr_b16 v[60:61], v18 offset:27648
 ds_read_b64_tr_b16 v[62:63], v18 offset:32256
 v_mfma_f32_16x16x32_bf16 a[52:55], v[76:79], a[220:223], a[52:55]
 ds_read_b64_tr_b16 v[64:65], v21
 ds_read_b64_tr_b16 v[66:67], v21 offset:4608
 v_mfma_f32_16x16x32_bf16 a[56:59], v[80:83], a[208:211], a[56:59]
 ds_read_b64_tr_b16 v[68:69], v21 offset:9216
 ds_read_b64_tr_b16 v[70:71], v21 offset:13824
 v_mfma_f32_16x16x32_bf16 a[56:59], v[84:87], a[216:219], a[56:59]
 ds_read_b64_tr_b16 v[72:73], v21 offset:18432
 ds_read_b64_tr_b16 v[74:75], v21 offset:23040
 v_mfma_f32_16x16x32_bf16 a[60:63], v[80:83], a[212:215], a[60:63]
 ds_read_b64_tr_b16 v[76:77], v21 offset:27648
 ds_read_b64_tr_b16 v[78:79], v21 offset:32256
 v_mfma_f32_16x16x32_bf16 a[60:63], v[84:87], a[220:223], a[60:63]
 v_mfma_f32_16x16x32_bf16 a[64:67], v[88:91], a[208:211], a[64:67]
 ds_read_b64_tr_b16 v[80:81], v18 offset:32
 ds_read_b64_tr_b16 v[82:83], v18 offset:4640
 v_mfma_f32_16x16x32_bf16 a[64:67], v[92:95], a[216:219], a[64:67]
 v_mfma_f32_16x16x32_bf16 a[68:71], v[88:91], a[212:215], a[68:71]
 ds_read_b64_tr_b16 v[84:85], v18 offset:9248
 ds_read_b64_tr_b16 v[86:87], v18 offset:13856
 v_mfma_f32_16x16x32_bf16 a[68:71], v[92:95], a[220:223], a[68:71]
 s_waitcnt lgkmcnt(15)
 v_mfma_f32_16x16x32_bf16 a[32:35], v[48:51], a[224:227], a[32:35]
 ds_read_b64_tr_b16 v[88:89], v18 offset:18464
 ds_read_b64_tr_b16 v[90:91], v18 offset:23072
 v_mfma_f32_16x16x32_bf16 a[32:35], v[52:55], a[232:235], a[32:35]
 v_mfma_f32_16x16x32_bf16 a[36:39], v[48:51], a[228:231], a[36:39]
 ds_read_b64_tr_b16 v[92:93], v18 offset:27680
 ds_read_b64_tr_b16 v[94:95], v18 offset:32288
 v_mfma_f32_16x16x32_bf16 a[36:39], v[52:55], a[236:239], a[36:39]
 s_waitcnt lgkmcnt(15)
 v_mfma_f32_16x16x32_bf16 a[32:35], v[56:59], a[240:243], a[32:35]
 ds_read_b64_tr_b16 v[48:49], v21 offset:32
 ds_read_b64_tr_b16 v[50:51], v21 offset:4640
 v_mfma_f32_16x16x32_bf16 a[32:35], v[60:63], a[248:251], a[32:35]
 v_mfma_f32_16x16x32_bf16 a[36:39], v[56:59], a[244:247], a[36:39]
 ds_read_b64_tr_b16 v[52:53], v21 offset:9248
 ds_read_b64_tr_b16 v[54:55], v21 offset:13856
 v_mfma_f32_16x16x32_bf16 a[36:39], v[60:63], a[252:255], a[36:39]
 s_waitcnt lgkmcnt(15)
 v_mfma_f32_16x16x32_bf16 a[32:35], v[64:67], a[160:163], a[32:35]
 ds_read_b64_tr_b16 v[56:57], v21 offset:18464
 ds_read_b64_tr_b16 v[58:59], v21 offset:23072
 v_mfma_f32_16x16x32_bf16 a[32:35], v[68:71], a[168:171], a[32:35]
 v_mfma_f32_16x16x32_bf16 a[36:39], v[64:67], a[164:167], a[36:39]
 ds_read_b64_tr_b16 v[60:61], v21 offset:27680
 ds_read_b64_tr_b16 v[62:63], v21 offset:32288
 v_mfma_f32_16x16x32_bf16 a[36:39], v[68:71], a[172:175], a[36:39]
 s_waitcnt lgkmcnt(15)
 v_mfma_f32_16x16x32_bf16 a[32:35], v[72:75], a[176:179], a[32:35]
 ds_read_b64_tr_b16 v[64:65], v18 offset:64
 ds_read_b64_tr_b16 v[66:67], v18 offset:4672
 v_mfma_f32_16x16x32_bf16 a[32:35], v[76:79], a[184:187], a[32:35]
 v_mfma_f32_16x16x32_bf16 a[36:39], v[72:75], a[180:183], a[36:39]
 ds_read_b64_tr_b16 v[68:69], v18 offset:9280
 ds_read_b64_tr_b16 v[70:71], v18 offset:13888
 v_mfma_f32_16x16x32_bf16 a[36:39], v[76:79], a[188:191], a[36:39]
 s_waitcnt lgkmcnt(15)
 v_mfma_f32_16x16x32_bf16 a[40:43], v[80:83], a[224:227], a[40:43]
 ds_read_b64_tr_b16 v[72:73], v18 offset:18496
 ds_read_b64_tr_b16 v[74:75], v18 offset:23104
 v_mfma_f32_16x16x32_bf16 a[40:43], v[84:87], a[232:235], a[40:43]
 v_mfma_f32_16x16x32_bf16 a[44:47], v[80:83], a[228:231], a[44:47]
 ds_read_b64_tr_b16 v[76:77], v18 offset:27712
 ds_read_b64_tr_b16 v[78:79], v18 offset:32320
 v_mfma_f32_16x16x32_bf16 a[44:47], v[84:87], a[236:239], a[44:47]
 s_waitcnt lgkmcnt(15)
 v_mfma_f32_16x16x32_bf16 a[40:43], v[88:91], a[240:243], a[40:43]
 ds_read_b64_tr_b16 v[80:81], v21 offset:64
 ds_read_b64_tr_b16 v[82:83], v21 offset:4672
 v_mfma_f32_16x16x32_bf16 a[40:43], v[92:95], a[248:251], a[40:43]
 v_mfma_f32_16x16x32_bf16 a[44:47], v[88:91], a[244:247], a[44:47]
 ds_read_b64_tr_b16 v[84:85], v21 offset:9280
 ds_read_b64_tr_b16 v[86:87], v21 offset:13888
 v_mfma_f32_16x16x32_bf16 a[44:47], v[92:95], a[252:255], a[44:47]
 s_waitcnt lgkmcnt(15)
 v_mfma_f32_16x16x32_bf16 a[40:43], v[48:51], a[160:163], a[40:43]
 ds_read_b64_tr_b16 v[88:89], v21 offset:18496
 ds_read_b64_tr_b16 v[90:91], v21 offset:23104
 v_mfma_f32_16x16x32_bf16 a[40:43], v[52:55], a[168:171], a[40:43]
 v_mfma_f32_16x16x32_bf16 a[44:47], v[48:51], a[164:167], a[44:47]
 ds_read_b64_tr_b16 v[92:93], v21 offset:27712
 ds_read_b64_tr_b16 v[94:95], v21 offset:32320
 v_mfma_f32_16x16x32_bf16 a[44:47], v[52:55], a[172:175], a[44:47]
 s_waitcnt lgkmcnt(15)
 v_mfma_f32_16x16x32_bf16 a[40:43], v[56:59], a[176:179], a[40:43]
 ds_read_b64_tr_b16 v[48:49], v18 offset:96
 ds_read_b64_tr_b16 v[50:51], v18 offset:4704
 v_mfma_f32_16x16x32_bf16 a[40:43], v[60:63], a[184:187], a[40:43]
 v_mfma_f32_16x16x32_bf16 a[44:47], v[56:59], a[180:183], a[44:47]
 s_waitcnt lgkmcnt(14)
 ds_read_b64_tr_b16 v[52:53], v18 offset:9312
 ds_read_b64_tr_b16 v[54:55], v18 offset:13920
 v_mfma_f32_16x16x32_bf16 a[44:47], v[60:63], a[188:191], a[44:47]
 s_lshl_b32 s41, s70, 15
 v_mfma_f32_16x16x32_bf16 a[48:51], v[64:67], a[224:227], a[48:51]
 s_add_u32 s41, s41, s57
 ds_read_b64_tr_b16 v[56:57], v18 offset:18528
 ds_read_b64_tr_b16 v[58:59], v18 offset:23136
 v_mfma_f32_16x16x32_bf16 a[48:51], v[68:71], a[232:235], a[48:51]
 s_add_u32 s41, s41, 0x800000
 v_mfma_f32_16x16x32_bf16 a[52:55], v[64:67], a[228:231], a[52:55]
 s_add_u32 s42, s41, 0x1000
 ds_read_b64_tr_b16 v[60:61], v18 offset:27744
 ds_read_b64_tr_b16 v[62:63], v18 offset:32352
 v_mfma_f32_16x16x32_bf16 a[52:55], v[68:71], a[236:239], a[52:55]
 s_waitcnt lgkmcnt(15)
 v_mfma_f32_16x16x32_bf16 a[48:51], v[72:75], a[240:243], a[48:51]
 ds_read_b64_tr_b16 v[64:65], v21 offset:96
 ds_read_b64_tr_b16 v[66:67], v21 offset:4704
 v_mfma_f32_16x16x32_bf16 a[48:51], v[76:79], a[248:251], a[48:51]
 v_accvgpr_read_b32 v96, a32
 v_accvgpr_read_b32 v97, a33
 v_mfma_f32_16x16x32_bf16 a[52:55], v[72:75], a[244:247], a[52:55]
 ds_read_b64_tr_b16 v[68:69], v21 offset:9312
 ds_read_b64_tr_b16 v[70:71], v21 offset:13920
 v_mfma_f32_16x16x32_bf16 a[52:55], v[76:79], a[252:255], a[52:55]
 s_waitcnt lgkmcnt(15)
 v_accvgpr_read_b32 v98, a34
 v_accvgpr_read_b32 v99, a35
 v_mfma_f32_16x16x32_bf16 a[48:51], v[80:83], a[160:163], a[48:51]
 ds_read_b64_tr_b16 v[72:73], v21 offset:18528
 ds_read_b64_tr_b16 v[74:75], v21 offset:23136
 v_mfma_f32_16x16x32_bf16 a[48:51], v[84:87], a[168:171], a[48:51]
 v_cvt_pk_bf16_f32 v112, v96, v97
 v_cvt_pk_bf16_f32 v113, v98, v99
 v_mfma_f32_16x16x32_bf16 a[52:55], v[80:83], a[164:167], a[52:55]
 ds_read_b64_tr_b16 v[76:77], v21 offset:27744
 ds_read_b64_tr_b16 v[78:79], v21 offset:32352
 v_mfma_f32_16x16x32_bf16 a[52:55], v[84:87], a[172:175], a[52:55]
 s_waitcnt lgkmcnt(15)
 v_accvgpr_read_b32 v100, a40
 v_accvgpr_read_b32 v101, a41
 v_mfma_f32_16x16x32_bf16 a[48:51], v[88:91], a[176:179], a[48:51]
 ds_read_b64_tr_b16 v[80:81], v19
 ds_read_b64_tr_b16 v[82:83], v19 offset:4608
 v_mfma_f32_16x16x32_bf16 a[48:51], v[92:95], a[184:187], a[48:51]
 v_accvgpr_read_b32 v102, a42
 v_accvgpr_read_b32 v103, a43
 v_mfma_f32_16x16x32_bf16 a[52:55], v[88:91], a[180:183], a[52:55]
 ds_read_b64_tr_b16 v[84:85], v19 offset:9216
 ds_read_b64_tr_b16 v[86:87], v19 offset:13824
 v_mfma_f32_16x16x32_bf16 a[52:55], v[92:95], a[188:191], a[52:55]
 s_waitcnt lgkmcnt(15)
 v_cvt_pk_bf16_f32 v114, v100, v101
 v_cvt_pk_bf16_f32 v115, v102, v103
 v_mfma_f32_16x16x32_bf16 a[56:59], v[48:51], a[224:227], a[56:59]
 ds_read_b64_tr_b16 v[88:89], v19 offset:18432
 ds_read_b64_tr_b16 v[90:91], v19 offset:23040
 v_mfma_f32_16x16x32_bf16 a[56:59], v[52:55], a[232:235], a[56:59]
 v_max_u32 v112, 1, v112
 v_max_u32 v113, 1, v113
 v_mfma_f32_16x16x32_bf16 a[60:63], v[48:51], a[228:231], a[60:63]
 ds_read_b64_tr_b16 v[92:93], v19 offset:27648
 ds_read_b64_tr_b16 v[94:95], v19 offset:32256
 v_mfma_f32_16x16x32_bf16 a[60:63], v[52:55], a[236:239], a[60:63]
 s_waitcnt lgkmcnt(15)
 v_max_u32 v114, 1, v114
 v_max_u32 v115, 1, v115
 v_mfma_f32_16x16x32_bf16 a[56:59], v[56:59], a[240:243], a[56:59]
 buffer_store_dwordx4 v[112:115], v2, s[36:39], s41 offen offset:2048 sc1
 v_mfma_f32_16x16x32_bf16 a[56:59], v[60:63], a[248:251], a[56:59]
 ds_read_b64_tr_b16 v[48:49], v22
 ds_read_b64_tr_b16 v[50:51], v22 offset:4608
 v_mfma_f32_16x16x32_bf16 a[60:63], v[56:59], a[244:247], a[60:63]
 ds_read_b64_tr_b16 v[52:53], v22 offset:9216
 ds_read_b64_tr_b16 v[54:55], v22 offset:13824
 v_mfma_f32_16x16x32_bf16 a[60:63], v[60:63], a[252:255], a[60:63]
 s_waitcnt lgkmcnt(15)
 v_accvgpr_read_b32 v104, a36
 v_accvgpr_read_b32 v105, a37
 v_mfma_f32_16x16x32_bf16 a[56:59], v[64:67], a[160:163], a[56:59]
 ds_read_b64_tr_b16 v[56:57], v22 offset:18432
 ds_read_b64_tr_b16 v[58:59], v22 offset:23040
 v_mfma_f32_16x16x32_bf16 a[56:59], v[68:71], a[168:171], a[56:59]
 v_accvgpr_read_b32 v106, a38
 v_accvgpr_read_b32 v107, a39
 v_mfma_f32_16x16x32_bf16 a[60:63], v[64:67], a[164:167], a[60:63]
 ds_read_b64_tr_b16 v[60:61], v22 offset:27648
 ds_read_b64_tr_b16 v[62:63], v22 offset:32256
 v_mfma_f32_16x16x32_bf16 a[60:63], v[68:71], a[172:175], a[60:63]
 s_waitcnt lgkmcnt(15)
 v_cvt_pk_bf16_f32 v116, v104, v105
 v_cvt_pk_bf16_f32 v117, v106, v107
 v_mfma_f32_16x16x32_bf16 a[56:59], v[72:75], a[176:179], a[56:59]
 ds_read_b64_tr_b16 v[64:65], v17
 ds_read_b64_tr_b16 v[66:67], v17 offset:4608
 v_mfma_f32_16x16x32_bf16 a[56:59], v[76:79], a[184:187], a[56:59]
 v_accvgpr_read_b32 v108, a44
 v_accvgpr_read_b32 v109, a45
 v_mfma_f32_16x16x32_bf16 a[60:63], v[72:75], a[180:183], a[60:63]
 ds_read_b64_tr_b16 v[68:69], v17 offset:9216
 ds_read_b64_tr_b16 v[70:71], v17 offset:13824
 v_mfma_f32_16x16x32_bf16 a[60:63], v[76:79], a[188:191], a[60:63]
 s_waitcnt lgkmcnt(15)
 v_accvgpr_read_b32 v110, a46
 v_accvgpr_read_b32 v111, a47
 v_mfma_f32_16x16x32_bf16 a[64:67], v[80:83], a[224:227], a[64:67]
 ds_read_b64_tr_b16 v[72:73], v17 offset:18432
 ds_read_b64_tr_b16 v[74:75], v17 offset:23040
 v_mfma_f32_16x16x32_bf16 a[64:67], v[84:87], a[232:235], a[64:67]
 v_cvt_pk_bf16_f32 v118, v108, v109
 v_cvt_pk_bf16_f32 v119, v110, v111
 v_mfma_f32_16x16x32_bf16 a[68:71], v[80:83], a[228:231], a[68:71]
 ds_read_b64_tr_b16 v[76:77], v17 offset:27648
 ds_read_b64_tr_b16 v[78:79], v17 offset:32256
 v_mfma_f32_16x16x32_bf16 a[68:71], v[84:87], a[236:239], a[68:71]
 s_waitcnt lgkmcnt(15)
 v_max_u32 v116, 1, v116
 v_max_u32 v117, 1, v117
 v_mfma_f32_16x16x32_bf16 a[64:67], v[88:91], a[240:243], a[64:67]
 ds_read_b64_tr_b16 v[80:81], v20
 ds_read_b64_tr_b16 v[82:83], v20 offset:4608
 v_mfma_f32_16x16x32_bf16 a[64:67], v[92:95], a[248:251], a[64:67]
 v_max_u32 v118, 1, v118
 v_max_u32 v119, 1, v119
 v_mfma_f32_16x16x32_bf16 a[68:71], v[88:91], a[244:247], a[68:71]
 buffer_store_dwordx4 v[116:119], v2, s[36:39], s42 offen sc1
 v_mfma_f32_16x16x32_bf16 a[68:71], v[92:95], a[252:255], a[68:71]
 s_waitcnt lgkmcnt(15)
 ds_read_b64_tr_b16 v[84:85], v20 offset:9216
 ds_read_b64_tr_b16 v[86:87], v20 offset:13824
 v_mfma_f32_16x16x32_bf16 a[64:67], v[48:51], a[160:163], a[64:67]
 s_waitcnt lgkmcnt(15)
 ds_read_b64_tr_b16 v[88:89], v20 offset:18432
 ds_read_b64_tr_b16 v[90:91], v20 offset:23040
 v_mfma_f32_16x16x32_bf16 a[64:67], v[52:55], a[168:171], a[64:67]
 v_accvgpr_read_b32 v96, a48
 v_accvgpr_read_b32 v97, a49
 v_mfma_f32_16x16x32_bf16 a[68:71], v[48:51], a[164:167], a[68:71]
 ds_read_b64_tr_b16 v[92:93], v20 offset:27648
 ds_read_b64_tr_b16 v[94:95], v20 offset:32256
 v_mfma_f32_16x16x32_bf16 a[68:71], v[52:55], a[172:175], a[68:71]
 s_waitcnt lgkmcnt(15)
 v_accvgpr_read_b32 v98, a50
 v_accvgpr_read_b32 v99, a51
 v_mfma_f32_16x16x32_bf16 a[64:67], v[56:59], a[176:179], a[64:67]
 ds_read_b64_tr_b16 v[48:49], v17 offset:32
 ds_read_b64_tr_b16 v[50:51], v17 offset:4640
 v_mfma_f32_16x16x32_bf16 a[64:67], v[60:63], a[184:187], a[64:67]
 v_cvt_pk_bf16_f32 v120, v96, v97
 v_cvt_pk_bf16_f32 v121, v98, v99
 v_mfma_f32_16x16x32_bf16 a[68:71], v[56:59], a[180:183], a[68:71]
 ds_read_b64_tr_b16 v[52:53], v17 offset:9248
 ds_read_b64_tr_b16 v[54:55], v17 offset:13856
 v_mfma_f32_16x16x32_bf16 a[68:71], v[60:63], a[188:191], a[68:71]
 s_waitcnt lgkmcnt(15)
 v_accvgpr_read_b32 v100, a56
 v_accvgpr_read_b32 v101, a57
 v_mfma_f32_16x16x32_bf16 a[0:3], v[64:67], a[224:227], a[0:3]
 ds_read_b64_tr_b16 v[56:57], v17 offset:18464
 ds_read_b64_tr_b16 v[58:59], v17 offset:23072
 v_mfma_f32_16x16x32_bf16 a[0:3], v[68:71], a[232:235], a[0:3]
 v_accvgpr_read_b32 v102, a58
 v_accvgpr_read_b32 v103, a59
 v_mfma_f32_16x16x32_bf16 a[4:7], v[64:67], a[228:231], a[4:7]
 ds_read_b64_tr_b16 v[60:61], v17 offset:27680
 ds_read_b64_tr_b16 v[62:63], v17 offset:32288
 v_mfma_f32_16x16x32_bf16 a[4:7], v[68:71], a[236:239], a[4:7]
 s_waitcnt lgkmcnt(15)
 v_cvt_pk_bf16_f32 v122, v100, v101
 v_cvt_pk_bf16_f32 v123, v102, v103
 v_mfma_f32_16x16x32_bf16 a[0:3], v[72:75], a[240:243], a[0:3]
 ds_read_b64_tr_b16 v[64:65], v20 offset:32
 ds_read_b64_tr_b16 v[66:67], v20 offset:4640
 v_mfma_f32_16x16x32_bf16 a[0:3], v[76:79], a[248:251], a[0:3]
 v_max_u32 v120, 1, v120
 v_max_u32 v121, 1, v121
 v_mfma_f32_16x16x32_bf16 a[4:7], v[72:75], a[244:247], a[4:7]
 ds_read_b64_tr_b16 v[68:69], v20 offset:9248
 ds_read_b64_tr_b16 v[70:71], v20 offset:13856
 v_mfma_f32_16x16x32_bf16 a[4:7], v[76:79], a[252:255], a[4:7]
 s_waitcnt lgkmcnt(15)
 v_max_u32 v122, 1, v122
 v_max_u32 v123, 1, v123
 v_mfma_f32_16x16x32_bf16 a[0:3], v[80:83], a[160:163], a[0:3]
 buffer_store_dwordx4 v[120:123], v2, s[36:39], s41 offen offset:3072 sc1
 v_mfma_f32_16x16x32_bf16 a[0:3], v[84:87], a[168:171], a[0:3]
 ds_read_b64_tr_b16 v[72:73], v20 offset:18464
 ds_read_b64_tr_b16 v[74:75], v20 offset:23072
 v_mfma_f32_16x16x32_bf16 a[4:7], v[80:83], a[164:167], a[4:7]
 ds_read_b64_tr_b16 v[76:77], v20 offset:27680
 ds_read_b64_tr_b16 v[78:79], v20 offset:32288
 v_mfma_f32_16x16x32_bf16 a[4:7], v[84:87], a[172:175], a[4:7]
 s_waitcnt lgkmcnt(15)
 v_accvgpr_read_b32 v104, a52
 v_accvgpr_read_b32 v105, a53
 v_mfma_f32_16x16x32_bf16 a[0:3], v[88:91], a[176:179], a[0:3]
 ds_read_b64_tr_b16 v[80:81], v17 offset:64
 ds_read_b64_tr_b16 v[82:83], v17 offset:4672
 v_mfma_f32_16x16x32_bf16 a[0:3], v[92:95], a[184:187], a[0:3]
 v_accvgpr_read_b32 v106, a54
 v_accvgpr_read_b32 v107, a55
 v_mfma_f32_16x16x32_bf16 a[4:7], v[88:91], a[180:183], a[4:7]
 ds_read_b64_tr_b16 v[84:85], v17 offset:9280
 ds_read_b64_tr_b16 v[86:87], v17 offset:13888
 v_mfma_f32_16x16x32_bf16 a[4:7], v[92:95], a[188:191], a[4:7]
 s_waitcnt lgkmcnt(15)
 v_cvt_pk_bf16_f32 v124, v104, v105
 v_cvt_pk_bf16_f32 v125, v106, v107
 v_mfma_f32_16x16x32_bf16 a[8:11], v[48:51], a[224:227], a[8:11]
 ds_read_b64_tr_b16 v[88:89], v17 offset:18496
 ds_read_b64_tr_b16 v[90:91], v17 offset:23104
 v_mfma_f32_16x16x32_bf16 a[8:11], v[52:55], a[232:235], a[8:11]
 v_accvgpr_read_b32 v108, a60
 v_accvgpr_read_b32 v109, a61
 v_mfma_f32_16x16x32_bf16 a[12:15], v[48:51], a[228:231], a[12:15]
 ds_read_b64_tr_b16 v[92:93], v17 offset:27712
 ds_read_b64_tr_b16 v[94:95], v17 offset:32320
 v_mfma_f32_16x16x32_bf16 a[12:15], v[52:55], a[236:239], a[12:15]
 s_waitcnt lgkmcnt(15)
 v_accvgpr_read_b32 v110, a62
 v_accvgpr_read_b32 v111, a63
 v_mfma_f32_16x16x32_bf16 a[8:11], v[56:59], a[240:243], a[8:11]
 ds_read_b64_tr_b16 v[48:49], v20 offset:64
 ds_read_b64_tr_b16 v[50:51], v20 offset:4672
 v_mfma_f32_16x16x32_bf16 a[8:11], v[60:63], a[248:251], a[8:11]
 v_cvt_pk_bf16_f32 v126, v108, v109
 v_cvt_pk_bf16_f32 v127, v110, v111
 v_mfma_f32_16x16x32_bf16 a[12:15], v[56:59], a[244:247], a[12:15]
 ds_read_b64_tr_b16 v[52:53], v20 offset:9280
 ds_read_b64_tr_b16 v[54:55], v20 offset:13888
 v_mfma_f32_16x16x32_bf16 a[12:15], v[60:63], a[252:255], a[12:15]
 s_waitcnt lgkmcnt(15)
 v_max_u32 v124, 1, v124
 v_max_u32 v125, 1, v125
 v_mfma_f32_16x16x32_bf16 a[8:11], v[64:67], a[160:163], a[8:11]
 ds_read_b64_tr_b16 v[56:57], v20 offset:18496
 ds_read_b64_tr_b16 v[58:59], v20 offset:23104
 v_mfma_f32_16x16x32_bf16 a[8:11], v[68:71], a[168:171], a[8:11]
 v_max_u32 v126, 1, v126
 v_max_u32 v127, 1, v127
 v_mfma_f32_16x16x32_bf16 a[12:15], v[64:67], a[164:167], a[12:15]
 buffer_store_dwordx4 v[124:127], v2, s[36:39], s42 offen offset:1024 sc1
 v_mfma_f32_16x16x32_bf16 a[12:15], v[68:71], a[172:175], a[12:15]
 s_waitcnt lgkmcnt(15)
 ds_read_b64_tr_b16 v[60:61], v20 offset:27712
 ds_read_b64_tr_b16 v[62:63], v20 offset:32320
 v_mfma_f32_16x16x32_bf16 a[8:11], v[72:75], a[176:179], a[8:11]
 s_waitcnt lgkmcnt(15)
 ds_read_b64_tr_b16 v[64:65], v17 offset:96
 ds_read_b64_tr_b16 v[66:67], v17 offset:4704
 v_mfma_f32_16x16x32_bf16 a[8:11], v[76:79], a[184:187], a[8:11]
 v_accvgpr_read_b32 v96, a64
 v_accvgpr_read_b32 v97, a65
 v_mfma_f32_16x16x32_bf16 a[12:15], v[72:75], a[180:183], a[12:15]
 ds_read_b64_tr_b16 v[68:69], v17 offset:9312
 ds_read_b64_tr_b16 v[70:71], v17 offset:13920
 v_mfma_f32_16x16x32_bf16 a[12:15], v[76:79], a[188:191], a[12:15]
 s_waitcnt lgkmcnt(15)
 v_accvgpr_read_b32 v98, a66
 v_accvgpr_read_b32 v99, a67
 v_mfma_f32_16x16x32_bf16 a[16:19], v[80:83], a[224:227], a[16:19]
 ds_read_b64_tr_b16 v[72:73], v17 offset:18528
 ds_read_b64_tr_b16 v[74:75], v17 offset:23136
 v_mfma_f32_16x16x32_bf16 a[16:19], v[84:87], a[232:235], a[16:19]
 v_cvt_pk_bf16_f32 v112, v96, v97
 v_cvt_pk_bf16_f32 v113, v98, v99
 v_mfma_f32_16x16x32_bf16 a[20:23], v[80:83], a[228:231], a[20:23]
 ds_read_b64_tr_b16 v[76:77], v17 offset:27744
 ds_read_b64_tr_b16 v[78:79], v17 offset:32352
 v_mfma_f32_16x16x32_bf16 a[20:23], v[84:87], a[236:239], a[20:23]
 s_waitcnt lgkmcnt(15)
 v_accvgpr_read_b32 v100, a68
 v_accvgpr_read_b32 v101, a69
 v_mfma_f32_16x16x32_bf16 a[16:19], v[88:91], a[240:243], a[16:19]
 ds_read_b64_tr_b16 v[80:81], v20 offset:96
 ds_read_b64_tr_b16 v[82:83], v20 offset:4704
 v_mfma_f32_16x16x32_bf16 a[16:19], v[92:95], a[248:251], a[16:19]
 v_accvgpr_read_b32 v102, a70
 v_accvgpr_read_b32 v103, a71
 v_mfma_f32_16x16x32_bf16 a[20:23], v[88:91], a[244:247], a[20:23]
 ds_read_b64_tr_b16 v[84:85], v20 offset:9312
 ds_read_b64_tr_b16 v[86:87], v20 offset:13920
 v_mfma_f32_16x16x32_bf16 a[20:23], v[92:95], a[252:255], a[20:23]
 s_waitcnt lgkmcnt(15)
 v_cvt_pk_bf16_f32 v114, v100, v101
 v_cvt_pk_bf16_f32 v115, v102, v103
 v_mfma_f32_16x16x32_bf16 a[16:19], v[48:51], a[160:163], a[16:19]
 ds_read_b64_tr_b16 v[88:89], v20 offset:18528
 ds_read_b64_tr_b16 v[90:91], v20 offset:23136
 v_mfma_f32_16x16x32_bf16 a[16:19], v[52:55], a[168:171], a[16:19]
 v_max_u32 v112, 1, v112
 v_max_u32 v113, 1, v113
 v_mfma_f32_16x16x32_bf16 a[20:23], v[48:51], a[164:167], a[20:23]
 ds_read_b64_tr_b16 v[92:93], v20 offset:27744
 ds_read_b64_tr_b16 v[94:95], v20 offset:32352
 v_mfma_f32_16x16x32_bf16 a[20:23], v[52:55], a[172:175], a[20:23]
 s_waitcnt lgkmcnt(15)
 v_max_u32 v114, 1, v114
 v_max_u32 v115, 1, v115
 v_mfma_f32_16x16x32_bf16 a[16:19], v[56:59], a[176:179], a[16:19]
 buffer_store_dwordx4 v[112:115], v2, s[36:39], s42 offen offset:2048 sc1
 v_mfma_f32_16x16x32_bf16 a[16:19], v[60:63], a[184:187], a[16:19]
 v_accvgpr_read_b32 v104, a4
 v_accvgpr_read_b32 v105, a5
 v_mfma_f32_16x16x32_bf16 a[20:23], v[56:59], a[180:183], a[20:23]
 v_accvgpr_read_b32 v106, a6
 v_accvgpr_read_b32 v107, a7
 v_mfma_f32_16x16x32_bf16 a[20:23], v[60:63], a[188:191], a[20:23]
 s_waitcnt lgkmcnt(14)
 v_cvt_pk_bf16_f32 v116, v104, v105
 v_cvt_pk_bf16_f32 v117, v106, v107
 v_mfma_f32_16x16x32_bf16 a[24:27], v[64:67], a[224:227], a[24:27]
 s_waitcnt lgkmcnt(12)
 v_accvgpr_read_b32 v108, a12
 v_accvgpr_read_b32 v109, a13
 v_mfma_f32_16x16x32_bf16 a[24:27], v[68:71], a[232:235], a[24:27]
 v_accvgpr_read_b32 v110, a14
 v_accvgpr_read_b32 v111, a15
 v_mfma_f32_16x16x32_bf16 a[28:31], v[64:67], a[228:231], a[28:31]
 v_cvt_pk_bf16_f32 v118, v108, v109
 v_cvt_pk_bf16_f32 v119, v110, v111
 v_mfma_f32_16x16x32_bf16 a[28:31], v[68:71], a[236:239], a[28:31]
 s_waitcnt lgkmcnt(10)
 v_max_u32 v116, 1, v116
 v_max_u32 v117, 1, v117
 v_mfma_f32_16x16x32_bf16 a[24:27], v[72:75], a[240:243], a[24:27]
 s_waitcnt lgkmcnt(8)
 v_max_u32 v118, 1, v118
 v_max_u32 v119, 1, v119
 v_mfma_f32_16x16x32_bf16 a[24:27], v[76:79], a[248:251], a[24:27]
 buffer_store_dwordx4 v[116:119], v2, s[36:39], s41 offen sc1
 v_mfma_f32_16x16x32_bf16 a[28:31], v[72:75], a[244:247], a[28:31]
 v_mfma_f32_16x16x32_bf16 a[28:31], v[76:79], a[252:255], a[28:31]
 s_waitcnt lgkmcnt(6)
 v_mfma_f32_16x16x32_bf16 a[24:27], v[80:83], a[160:163], a[24:27]
 s_waitcnt lgkmcnt(4)
 v_mfma_f32_16x16x32_bf16 a[24:27], v[84:87], a[168:171], a[24:27]
 v_mfma_f32_16x16x32_bf16 a[28:31], v[80:83], a[164:167], a[28:31]
 v_mfma_f32_16x16x32_bf16 a[28:31], v[84:87], a[172:175], a[28:31]
 s_waitcnt lgkmcnt(2)
 v_mfma_f32_16x16x32_bf16 a[24:27], v[88:91], a[176:179], a[24:27]
 s_waitcnt lgkmcnt(0)
 v_mfma_f32_16x16x32_bf16 a[24:27], v[92:95], a[184:187], a[24:27]
 v_mfma_f32_16x16x32_bf16 a[28:31], v[88:91], a[180:183], a[28:31]
 v_mfma_f32_16x16x32_bf16 a[28:31], v[92:95], a[188:191], a[28:31]
 v_accvgpr_read_b32 v96, a20
 v_accvgpr_read_b32 v97, a21
 v_accvgpr_read_b32 v98, a22
 v_accvgpr_read_b32 v99, a23
 v_cvt_pk_bf16_f32 v120, v96, v97
 v_cvt_pk_bf16_f32 v121, v98, v99
 s_nop 1
 v_accvgpr_read_b32 v100, a28
 v_accvgpr_read_b32 v101, a29
 v_accvgpr_read_b32 v102, a30
 v_accvgpr_read_b32 v103, a31
 v_cvt_pk_bf16_f32 v122, v100, v101
 v_cvt_pk_bf16_f32 v123, v102, v103
 v_max_u32 v120, 1, v120
 v_max_u32 v121, 1, v121
 v_max_u32 v122, 1, v122
 v_max_u32 v123, 1, v123
 buffer_store_dwordx4 v[120:123], v2, s[36:39], s41 offen offset:1024 sc1
 s_cmp_lg_u64 s[46:47], 0
 s_cbranch_scc1 L_fre
L_frb:
 v_accvgpr_read_b32 v32, a72
 v_accvgpr_read_b32 v52, a0
 v_lshlrev_b32 v140, 16, v220
 v_accvgpr_read_b32 v33, a73
 v_accvgpr_read_b32 v53, a1
 v_and_b32 v141, 0xffff0000, v220
 v_accvgpr_read_b32 v34, a74
 v_accvgpr_read_b32 v54, a2
 v_lshlrev_b32 v142, 16, v221
 v_accvgpr_read_b32 v35, a75
 v_accvgpr_read_b32 v55, a3
 v_and_b32 v143, 0xffff0000, v221
 v_accvgpr_read_b32 v36, a80
 v_accvgpr_read_b32 v56, a8
 s_waitcnt vmcnt(19)
 v_lshlrev_b32 v144, 16, v222
 v_accvgpr_read_b32 v37, a81
 v_accvgpr_read_b32 v57, a9
 v_and_b32 v145, 0xffff0000, v222
 v_accvgpr_read_b32 v38, a82
 v_accvgpr_read_b32 v58, a10
 v_lshlrev_b32 v146, 16, v223
 v_accvgpr_read_b32 v39, a83
 v_accvgpr_read_b32 v59, a11
 v_and_b32 v147, 0xffff0000, v223
 v_accvgpr_read_b32 v40, a88
 v_accvgpr_read_b32 v60, a16
 s_waitcnt vmcnt(18)
 v_lshlrev_b32 v148, 16, v224
 v_accvgpr_read_b32 v41, a89
 v_accvgpr_read_b32 v61, a17
 v_and_b32 v149, 0xffff0000, v224
 v_accvgpr_read_b32 v42, a90
 v_accvgpr_read_b32 v62, a18
 v_lshlrev_b32 v150, 16, v225
 v_accvgpr_read_b32 v43, a91
 v_accvgpr_read_b32 v63, a19
 v_and_b32 v151, 0xffff0000, v225
 v_accvgpr_read_b32 v44, a96
 v_accvgpr_read_b32 v64, a24
 s_waitcnt vmcnt(17)
 v_lshlrev_b32 v152, 16, v226
 v_accvgpr_read_b32 v45, a97
 v_accvgpr_read_b32 v65, a25
 v_and_b32 v153, 0xffff0000, v226
 v_accvgpr_read_b32 v46, a98
 v_accvgpr_read_b32 v66, a26
 v_lshlrev_b32 v154, 16, v227
 v_accvgpr_read_b32 v47, a99
 v_accvgpr_read_b32 v67, a27
 v_and_b32 v155, 0xffff0000, v227
 v_accvgpr_read_b32 v48, a136
 v_accvgpr_read_b32 v68, a64
 s_waitcnt vmcnt(16)
 v_lshlrev_b32 v156, 16, v228
 v_accvgpr_read_b32 v49, a137
 v_accvgpr_read_b32 v69, a65
 v_and_b32 v157, 0xffff0000, v228
 v_accvgpr_read_b32 v50, a138
 v_accvgpr_read_b32 v70, a66
 v_lshlrev_b32 v158, 16, v229
 v_accvgpr_read_b32 v51, a139
 v_accvgpr_read_b32 v71, a67
 v_and_b32 v159, 0xffff0000, v229
 s_waitcnt vmcnt(15)
 v_lshlrev_b32 v72, 16, v160
 v_and_b32 v73, 0xffff0000, v160
 v_pk_add_f32 v[32:33], v[32:33], v[72:73]
 v_lshlrev_b32 v74, 16, v161
 v_and_b32 v75, 0xffff0000, v161
 v_pk_add_f32 v[34:35], v[34:35], v[74:75]
 v_lshlrev_b32 v76, 16, v162
 v_and_b32 v77, 0xffff0000, v162
 v_pk_add_f32 v[36:37], v[36:37], v[76:77]
 v_lshlrev_b32 v78, 16, v163
 v_and_b32 v79, 0xffff0000, v163
 v_pk_add_f32 v[38:39], v[38:39], v[78:79]
 s_waitcnt vmcnt(14)
 v_lshlrev_b32 v72, 16, v164
 v_and_b32 v73, 0xffff0000, v164
 v_pk_add_f32 v[40:41], v[40:41], v[72:73]
 v_lshlrev_b32 v74, 16, v165
 v_and_b32 v75, 0xffff0000, v165
 v_pk_add_f32 v[42:43], v[42:43], v[74:75]
 v_lshlrev_b32 v76, 16, v166
 v_and_b32 v77, 0xffff0000, v166
 v_pk_add_f32 v[44:45], v[44:45], v[76:77]
 v_lshlrev_b32 v78, 16, v167
 v_and_b32 v79, 0xffff0000, v167
 v_pk_add_f32 v[46:47], v[46:47], v[78:79]
 s_waitcnt vmcnt(13)
 v_lshlrev_b32 v72, 16, v168
 v_and_b32 v73, 0xffff0000, v168
 v_pk_add_f32 v[48:49], v[48:49], v[72:73]
 v_lshlrev_b32 v74, 16, v169
 v_and_b32 v75, 0xffff0000, v169
 v_pk_add_f32 v[50:51], v[50:51], v[74:75]
 s_waitcnt vmcnt(12)
 v_lshlrev_b32 v76, 16, v170
 v_and_b32 v77, 0xffff0000, v170
 v_pk_add_f32 v[32:33], v[32:33], v[76:77]
 v_lshlrev_b32 v78, 16, v171
 v_and_b32 v79, 0xffff0000, v171
 v_pk_add_f32 v[34:35], v[34:35], v[78:79]
 v_lshlrev_b32 v72, 16, v172
 v_and_b32 v73, 0xffff0000, v172
 v_pk_add_f32 v[36:37], v[36:37], v[72:73]
 v_lshlrev_b32 v74, 16, v173
 v_and_b32 v75, 0xffff0000, v173
 v_pk_add_f32 v[38:39], v[38:39], v[74:75]
 s_waitcnt vmcnt(11)
 v_lshlrev_b32 v76, 16, v174
 v_and_b32 v77, 0xffff0000, v174
 v_pk_add_f32 v[40:41], v[40:41], v[76:77]
 v_lshlrev_b32 v78, 16, v175
 v_and_b32 v79, 0xffff0000, v175
 v_pk_add_f32 v[42:43], v[42:43], v[78:79]
 v_lshlrev_b32 v72, 16, v176
 v_and_b32 v73, 0xffff0000, v176
 v_pk_add_f32 v[44:45], v[44:45], v[72:73]
 v_lshlrev_b32 v74, 16, v177
 v_and_b32 v75, 0xffff0000, v177
 v_pk_add_f32 v[46:47], v[46:47], v[74:75]
 s_waitcnt vmcnt(10)
 v_lshlrev_b32 v76, 16, v178
 v_and_b32 v77, 0xffff0000, v178
 v_pk_add_f32 v[48:49], v[48:49], v[76:77]
 v_lshlrev_b32 v78, 16, v179
 v_and_b32 v79, 0xffff0000, v179
 v_pk_add_f32 v[50:51], v[50:51], v[78:79]
 s_waitcnt vmcnt(9)
 v_lshlrev_b32 v72, 16, v180
 v_and_b32 v73, 0xffff0000, v180
 v_pk_add_f32 v[32:33], v[32:33], v[72:73]
 v_lshlrev_b32 v74, 16, v181
 v_and_b32 v75, 0xffff0000, v181
 v_pk_add_f32 v[34:35], v[34:35], v[74:75]
 v_lshlrev_b32 v76, 16, v182
 v_and_b32 v77, 0xffff0000, v182
 v_pk_add_f32 v[36:37], v[36:37], v[76:77]
 v_lshlrev_b32 v78, 16, v183
 v_and_b32 v79, 0xffff0000, v183
 v_pk_add_f32 v[38:39], v[38:39], v[78:79]
 s_waitcnt vmcnt(8)
 v_lshlrev_b32 v72, 16, v184
 v_and_b32 v73, 0xffff0000, v184
 v_pk_add_f32 v[40:41], v[40:41], v[72:73]
 v_lshlrev_b32 v74, 16, v185
 v_and_b32 v75, 0xffff0000, v185
 v_pk_add_f32 v[42:43], v[42:43], v[74:75]
 v_lshlrev_b32 v76, 16, v186
 v_and_b32 v77, 0xffff0000, v186
 v_pk_add_f32 v[44:45], v[44:45], v[76:77]
 v_lshlrev_b32 v78, 16, v187
 v_and_b32 v79, 0xffff0000, v187
 v_pk_add_f32 v[46:47], v[46:47], v[78:79]
 s_waitcnt vmcnt(7)
 v_lshlrev_b32 v72, 16, v188
 v_and_b32 v73, 0xffff0000, v188
 v_pk_add_f32 v[48:49], v[48:49], v[72:73]
 v_lshlrev_b32 v74, 16, v189
 v_and_b32 v75, 0xffff0000, v189
 v_pk_add_f32 v[50:51], v[50:51], v[74:75]
 s_xor_b32 s19, s70, 1
 s_lshl_b32 s19, s19, 15
 s_add_u32 s19, s19, s57
 s_add_u32 s18, s19, 0x801800
 s_add_u32 s19, s19, 0x800000
 buffer_load_dwordx4 v[190:193], v2, s[36:39], s19 offen sc1
 buffer_load_dwordx4 v[194:197], v2, s[36:39], s19 offen offset:1024 sc1
 buffer_load_dwordx2 v[198:199], v2, s[36:39], s18 offen offset:8 sc1
 s_xor_b32 s19, s70, 2
 s_lshl_b32 s19, s19, 15
 s_add_u32 s19, s19, s57
 s_add_u32 s18, s19, 0x801800
 s_add_u32 s19, s19, 0x800800
 buffer_load_dwordx4 v[200:203], v2, s[36:39], s19 offen sc1
 buffer_load_dwordx4 v[204:207], v2, s[36:39], s19 offen offset:1024 sc1
 buffer_load_dwordx2 v[208:209], v2, s[36:39], s18 offen sc1
 s_xor_b32 s19, s70, 3
 s_lshl_b32 s19, s19, 15
 s_add_u32 s19, s19, s57
 s_add_u32 s18, s19, 0x801800
 s_add_u32 s19, s19, 0x801000
 buffer_load_dwordx4 v[210:213], v2, s[36:39], s19 offen sc1
 buffer_load_dwordx4 v[214:217], v2, s[36:39], s19 offen offset:1024 sc1
 buffer_load_dwordx2 v[218:219], v2, s[36:39], s18 offen offset:8 sc1
 v_mul_f32 v80, 0xbfb8aa3b, v32
 v_mul_f32 v81, 0xbfb8aa3b, v33
 v_mul_f32 v82, 0xbfb8aa3b, v34
 v_mul_f32 v83, 0xbfb8aa3b, v35
 v_mul_f32 v84, 0xbfb8aa3b, v36
 v_mul_f32 v85, 0xbfb8aa3b, v37
 v_mul_f32 v86, 0xbfb8aa3b, v38
 v_mul_f32 v87, 0xbfb8aa3b, v39
 v_mul_f32 v88, 0xbfb8aa3b, v40
 v_mul_f32 v89, 0xbfb8aa3b, v41
 v_mul_f32 v90, 0xbfb8aa3b, v42
 v_mul_f32 v91, 0xbfb8aa3b, v43
 v_mul_f32 v92, 0xbfb8aa3b, v44
 v_mul_f32 v93, 0xbfb8aa3b, v45
 v_mul_f32 v94, 0xbfb8aa3b, v46
 v_mul_f32 v95, 0xbfb8aa3b, v47
 v_mul_f32 v96, 0xbfb8aa3b, v48
 v_mul_f32 v97, 0xbfb8aa3b, v49
 v_mul_f32 v98, 0xbfb8aa3b, v50
 v_mul_f32 v99, 0xbfb8aa3b, v51
 v_exp_f32 v80, v80
 v_exp_f32 v81, v81
 v_exp_f32 v82, v82
 v_exp_f32 v83, v83
 v_exp_f32 v84, v84
 v_exp_f32 v85, v85
 v_exp_f32 v86, v86
 v_exp_f32 v87, v87
 v_exp_f32 v88, v88
 v_exp_f32 v89, v89
 v_exp_f32 v90, v90
 v_exp_f32 v91, v91
 v_exp_f32 v92, v92
 v_exp_f32 v93, v93
 v_exp_f32 v94, v94
 v_exp_f32 v95, v95
 v_exp_f32 v96, v96
 v_exp_f32 v97, v97
 v_exp_f32 v98, v98
 v_exp_f32 v99, v99
 v_add_f32 v80, 1.0, v80
 v_add_f32 v81, 1.0, v81
 v_add_f32 v82, 1.0, v82
 v_add_f32 v83, 1.0, v83
 v_add_f32 v84, 1.0, v84
 v_add_f32 v85, 1.0, v85
 v_add_f32 v86, 1.0, v86
 v_add_f32 v87, 1.0, v87
 v_add_f32 v88, 1.0, v88
 v_add_f32 v89, 1.0, v89
 v_add_f32 v90, 1.0, v90
 v_add_f32 v91, 1.0, v91
 v_add_f32 v92, 1.0, v92
 v_add_f32 v93, 1.0, v93
 v_add_f32 v94, 1.0, v94
 v_add_f32 v95, 1.0, v95
 v_add_f32 v96, 1.0, v96
 v_add_f32 v97, 1.0, v97
 v_add_f32 v98, 1.0, v98
 v_add_f32 v99, 1.0, v99
 v_rcp_f32 v80, v80
 v_rcp_f32 v81, v81
 v_rcp_f32 v82, v82
 v_rcp_f32 v83, v83
 v_rcp_f32 v84, v84
 v_rcp_f32 v85, v85
 v_rcp_f32 v86, v86
 v_rcp_f32 v87, v87
 v_rcp_f32 v88, v88
 v_rcp_f32 v89, v89
 v_rcp_f32 v90, v90
 v_rcp_f32 v91, v91
 v_rcp_f32 v92, v92
 v_rcp_f32 v93, v93
 v_rcp_f32 v94, v94
 v_rcp_f32 v95, v95
 v_rcp_f32 v96, v96
 v_rcp_f32 v97, v97
 v_rcp_f32 v98, v98
 v_rcp_f32 v99, v99
 v_pk_mul_f32 v[32:33], v[32:33], v[80:81]
 v_pk_mul_f32 v[34:35], v[34:35], v[82:83]
 v_pk_mul_f32 v[36:37], v[36:37], v[84:85]
 v_pk_mul_f32 v[38:39], v[38:39], v[86:87]
 v_pk_mul_f32 v[40:41], v[40:41], v[88:89]
 v_pk_mul_f32 v[42:43], v[42:43], v[90:91]
 v_pk_mul_f32 v[44:45], v[44:45], v[92:93]
 v_pk_mul_f32 v[46:47], v[46:47], v[94:95]
 v_pk_mul_f32 v[48:49], v[48:49], v[96:97]
 v_pk_mul_f32 v[50:51], v[50:51], v[98:99]
 s_mov_b32 s63, 0x100000
 s_waitcnt vmcnt(0)
 v_min3_u32 v249, v190, v191, v192
 v_min3_u32 v249, v249, v193, v194
 v_min3_u32 v249, v249, v195, v196
 v_min3_u32 v249, v249, v197, v198
 v_min3_u32 v249, v249, v199, v200
 v_min3_u32 v249, v249, v201, v202
 v_min3_u32 v249, v249, v203, v204
 v_min3_u32 v249, v249, v205, v206
 v_min3_u32 v249, v249, v207, v208
 v_min3_u32 v249, v249, v209, v210
 v_min3_u32 v249, v249, v211, v212
 v_min3_u32 v249, v249, v213, v214
 v_min3_u32 v249, v249, v215, v216
 v_min3_u32 v249, v249, v217, v218
 v_min_u32 v249, v249, v219
 v_cmp_eq_u32 vcc, 0, v249
 s_nop 1
 s_cbranch_vccnz L_sretry
L_sok:
 v_lshlrev_b32 v72, 16, v190
 v_and_b32 v73, 0xffff0000, v190
 v_pk_add_f32 v[52:53], v[52:53], v[72:73]
 v_lshlrev_b32 v74, 16, v191
 v_and_b32 v75, 0xffff0000, v191
 v_pk_add_f32 v[54:55], v[54:55], v[74:75]
 v_lshlrev_b32 v76, 16, v192
 v_and_b32 v77, 0xffff0000, v192
 v_pk_add_f32 v[56:57], v[56:57], v[76:77]
 v_lshlrev_b32 v78, 16, v193
 v_and_b32 v79, 0xffff0000, v193
 v_pk_add_f32 v[58:59], v[58:59], v[78:79]
 v_lshlrev_b32 v72, 16, v194
 v_and_b32 v73, 0xffff0000, v194
 v_pk_add_f32 v[60:61], v[60:61], v[72:73]
 v_lshlrev_b32 v74, 16, v195
 v_and_b32 v75, 0xffff0000, v195
 v_pk_add_f32 v[62:63], v[62:63], v[74:75]
 v_lshlrev_b32 v76, 16, v196
 v_and_b32 v77, 0xffff0000, v196
 v_pk_add_f32 v[64:65], v[64:65], v[76:77]
 v_lshlrev_b32 v78, 16, v197
 v_and_b32 v79, 0xffff0000, v197
 v_pk_add_f32 v[66:67], v[66:67], v[78:79]
 v_lshlrev_b32 v72, 16, v198
 v_and_b32 v73, 0xffff0000, v198
 v_pk_add_f32 v[68:69], v[68:69], v[72:73]
 v_lshlrev_b32 v74, 16, v199
 v_and_b32 v75, 0xffff0000, v199
 v_pk_add_f32 v[70:71], v[70:71], v[74:75]
 v_lshlrev_b32 v76, 16, v200
 v_and_b32 v77, 0xffff0000, v200
 v_pk_add_f32 v[52:53], v[52:53], v[76:77]
 v_lshlrev_b32 v78, 16, v201
 v_and_b32 v79, 0xffff0000, v201
 v_pk_add_f32 v[54:55], v[54:55], v[78:79]
 v_lshlrev_b32 v72, 16, v202
 v_and_b32 v73, 0xffff0000, v202
 v_pk_add_f32 v[56:57], v[56:57], v[72:73]
 v_lshlrev_b32 v74, 16, v203
 v_and_b32 v75, 0xffff0000, v203
 v_pk_add_f32 v[58:59], v[58:59], v[74:75]
 v_lshlrev_b32 v76, 16, v204
 v_and_b32 v77, 0xffff0000, v204
 v_pk_add_f32 v[60:61], v[60:61], v[76:77]
 v_lshlrev_b32 v78, 16, v205
 v_and_b32 v79, 0xffff0000, v205
 v_pk_add_f32 v[62:63], v[62:63], v[78:79]
 v_lshlrev_b32 v72, 16, v206
 v_and_b32 v73, 0xffff0000, v206
 v_pk_add_f32 v[64:65], v[64:65], v[72:73]
 v_lshlrev_b32 v74, 16, v207
 v_and_b32 v75, 0xffff0000, v207
 v_pk_add_f32 v[66:67], v[66:67], v[74:75]
 v_lshlrev_b32 v76, 16, v208
 v_and_b32 v77, 0xffff0000, v208
 v_pk_add_f32 v[68:69], v[68:69], v[76:77]
 v_lshlrev_b32 v78, 16, v209
 v_and_b32 v79, 0xffff0000, v209
 v_pk_add_f32 v[70:71], v[70:71], v[78:79]
 v_lshlrev_b32 v72, 16, v210
 v_and_b32 v73, 0xffff0000, v210
 v_pk_add_f32 v[52:53], v[52:53], v[72:73]
 v_lshlrev_b32 v74, 16, v211
 v_and_b32 v75, 0xffff0000, v211
 v_pk_add_f32 v[54:55], v[54:55], v[74:75]
 v_lshlrev_b32 v76, 16, v212
 v_and_b32 v77, 0xffff0000, v212
 v_pk_add_f32 v[56:57], v[56:57], v[76:77]
 v_lshlrev_b32 v78, 16, v213
 v_and_b32 v79, 0xffff0000, v213
 v_pk_add_f32 v[58:59], v[58:59], v[78:79]
 v_lshlrev_b32 v72, 16, v214
 v_and_b32 v73, 0xffff0000, v214
 v_pk_add_f32 v[60:61], v[60:61], v[72:73]
 v_lshlrev_b32 v74, 16, v215
 v_and_b32 v75, 0xffff0000, v215
 v_pk_add_f32 v[62:63], v[62:63], v[74:75]
 v_lshlrev_b32 v76, 16, v216
 v_and_b32 v77, 0xffff0000, v216
 v_pk_add_f32 v[64:65], v[64:65], v[76:77]
 v_lshlrev_b32 v78, 16, v217
 v_and_b32 v79, 0xffff0000, v217
 v_pk_add_f32 v[66:67], v[66:67], v[78:79]
 v_lshlrev_b32 v72, 16, v218
 v_and_b32 v73, 0xffff0000, v218
 v_pk_add_f32 v[68:69], v[68:69], v[72:73]
 v_lshlrev_b32 v74, 16, v219
 v_and_b32 v75, 0xffff0000, v219
 v_pk_add_f32 v[70:71], v[70:71], v[74:75]
 v_pk_fma_f32 v[140:141], v[52:53], v[32:33], v[140:141]
 v_pk_fma_f32 v[142:143], v[54:55], v[34:35], v[142:143]
 v_cvt_pk_bf16_f32 v220, v140, v141
 v_cvt_pk_bf16_f32 v221, v142, v143
 buffer_store_dwordx2 v[220:221], v8, s[32:35], 0 offen
 v_pk_fma_f32 v[144:145], v[56:57], v[36:37], v[144:145]
 v_pk_fma_f32 v[146:147], v[58:59], v[38:39], v[146:147]
 v_cvt_pk_bf16_f32 v222, v144, v145
 v_cvt_pk_bf16_f32 v223, v146, v147
 buffer_store_dwordx2 v[222:223], v8, s[32:35], 0 offen offset:32
 v_pk_fma_f32 v[148:149], v[60:61], v[40:41], v[148:149]
 v_pk_fma_f32 v[150:151], v[62:63], v[42:43], v[150:151]
 v_cvt_pk_bf16_f32 v224, v148, v149
 v_cvt_pk_bf16_f32 v225, v150, v151
 buffer_store_dwordx2 v[224:225], v8, s[32:35], 0 offen offset:64
 v_pk_fma_f32 v[152:153], v[64:65], v[44:45], v[152:153]
 v_pk_fma_f32 v[154:155], v[66:67], v[46:47], v[154:155]
 v_cvt_pk_bf16_f32 v226, v152, v153
 v_cvt_pk_bf16_f32 v227, v154, v155
 buffer_store_dwordx2 v[226:227], v8, s[32:35], 0 offen offset:96
 v_pk_fma_f32 v[156:157], v[68:69], v[48:49], v[156:157]
 v_pk_fma_f32 v[158:159], v[70:71], v[50:51], v[158:159]
 v_cvt_pk_bf16_f32 v228, v156, v157
 v_cvt_pk_bf16_f32 v229, v158, v159
 s_lshl_b32 s18, s56, 30
 buffer_store_dwordx2 v[228:229], v9, s[32:35], s18 offen
L_end:
 s_endpgm
L_sretry:
 s_xor_b32 s19, s70, 1
 s_lshl_b32 s19, s19, 15
 s_add_u32 s19, s19, s57
 s_add_u32 s45, s19, 0x800400
 s_xor_b32 s19, s70, 2
 s_lshl_b32 s19, s19, 15
 s_add_u32 s19, s19, s57
 s_add_u32 s46, s19, 0x801800
 s_xor_b32 s19, s70, 3
 s_lshl_b32 s19, s19, 15
 s_add_u32 s19, s19, s57
 s_add_u32 s47, s19, 0x801800
L_slight:
 buffer_load_dword v73, off, s[36:39], s45 offset:1020 sc1
 buffer_load_dword v74, off, s[36:39], s46 offset:1020 sc1
 buffer_load_dword v75, off, s[36:39], s47 offset:1020 sc1
 s_waitcnt vmcnt(0)
 v_min3_u32 v249, v73, v74, v75
 v_cmp_eq_u32 vcc, 0, v249
 s_sub_u32 s63, s63, 1
 s_cbranch_scc1 L_sok
 s_cbranch_vccnz L_slight
 s_xor_b32 s19, s70, 1
 s_lshl_b32 s19, s19, 15
 s_add_u32 s19, s19, s57
 s_add_u32 s18, s19, 0x801800
 s_add_u32 s19, s19, 0x800000
 buffer_load_dwordx4 v[190:193], v2, s[36:39], s19 offen sc1
 buffer_load_dwordx4 v[194:197], v2, s[36:39], s19 offen offset:1024 sc1
 buffer_load_dwordx2 v[198:199], v2, s[36:39], s18 offen offset:8 sc1
 s_xor_b32 s19, s70, 2
 s_lshl_b32 s19, s19, 15
 s_add_u32 s19, s19, s57
 s_add_u32 s18, s19, 0x801800
 s_add_u32 s19, s19, 0x800800
 buffer_load_dwordx4 v[200:203], v2, s[36:39], s19 offen sc1
 buffer_load_dwordx4 v[204:207], v2, s[36:39], s19 offen offset:1024 sc1
 buffer_load_dwordx2 v[208:209], v2, s[36:39], s18 offen sc1
 s_xor_b32 s19, s70, 3
 s_lshl_b32 s19, s19, 15
 s_add_u32 s19, s19, s57
 s_add_u32 s18, s19, 0x801800
 s_add_u32 s19, s19, 0x801000
 buffer_load_dwordx4 v[210:213], v2, s[36:39], s19 offen sc1
 buffer_load_dwordx4 v[214:217], v2, s[36:39], s19 offen offset:1024 sc1
 buffer_load_dwordx2 v[218:219], v2, s[36:39], s18 offen offset:8 sc1
 s_waitcnt vmcnt(0)
 v_min3_u32 v249, v190, v191, v192
 v_min3_u32 v249, v249, v193, v194
 v_min3_u32 v249, v249, v195, v196
 v_min3_u32 v249, v249, v197, v198
 v_min3_u32 v249, v249, v199, v200
 v_min3_u32 v249, v249, v201, v202
 v_min3_u32 v249, v249, v203, v204
 v_min3_u32 v249, v249, v205, v206
 v_min3_u32 v249, v249, v207, v208
 v_min3_u32 v249, v249, v209, v210
 v_min3_u32 v249, v249, v211, v212
 v_min3_u32 v249, v249, v213, v214
 v_min3_u32 v249, v249, v215, v216
 v_min3_u32 v249, v249, v217, v218
 v_min_u32 v249, v249, v219
 v_cmp_eq_u32 vcc, 0, v249
 s_nop 1
 s_cbranch_vccnz L_slight
 s_branch L_sok
L_fre:
 v_and_b32 v254, 3, v1
 v_lshlrev_b32 v254, 2, v254
 s_mov_b32 s63, 0x100000
L_pl9:
 buffer_load_dword v249, v254, s[36:39], s48 offen sc1
 s_waitcnt vmcnt(0)
 v_cmp_ne_u32 vcc, s59, v249
 s_nop 0
 s_cbranch_vccz L_pd9
 s_sleep 1
 s_sub_u32 s63, s63, 1
 s_cbranch_scc0 L_pl9
L_pd9:
 s_xor_b32 s19, s70, 1
 s_lshl_b32 s19, s19, 15
 s_add_u32 s19, s19, s57
 s_add_u32 s18, s19, 0x1800
 s_add_u32 s19, s19, 0
 buffer_load_dwordx4 v[160:163], v2, s[36:39], s19 offen sc1
 buffer_load_dwordx4 v[164:167], v2, s[36:39], s19 offen offset:1024 sc1
 buffer_load_dwordx2 v[168:169], v2, s[36:39], s18 offen offset:8 sc1
 s_xor_b32 s19, s70, 2
 s_lshl_b32 s19, s19, 15
 s_add_u32 s19, s19, s57
 s_add_u32 s18, s19, 0x1800
 s_add_u32 s19, s19, 0x800
 buffer_load_dwordx4 v[170:173], v2, s[36:39], s19 offen sc1
 buffer_load_dwordx4 v[174:177], v2, s[36:39], s19 offen offset:1024 sc1
 buffer_load_dwordx2 v[178:179], v2, s[36:39], s18 offen sc1
 s_xor_b32 s19, s70, 3
 s_lshl_b32 s19, s19, 15
 s_add_u32 s19, s19, s57
 s_add_u32 s18, s19, 0x1800
 s_add_u32 s19, s19, 0x1000
 buffer_load_dwordx4 v[180:183], v2, s[36:39], s19 offen sc1
 buffer_load_dwordx4 v[184:187], v2, s[36:39], s19 offen offset:1024 sc1
 buffer_load_dwordx2 v[188:189], v2, s[36:39], s18 offen offset:8 sc1
 s_waitcnt vmcnt(0)
 s_branch L_frb
L_non:
 s_mov_b32 s63, 0x100000
L_non1:
 buffer_load_dword v253, off, s[8:11], 0 sc1
 s_waitcnt vmcnt(0)
 v_readfirstlane_b32 s59, v253
 s_nop 0
 s_cmp_lg_u32 s59, 0
 s_cbranch_scc1 L_nond
 s_sub_u32 s63, s63, 1
 s_cbranch_scc0 L_non1
 s_branch L_nond
L_sl4:
 v_and_b32 v254, 31, v1
 v_lshlrev_b32 v254, 2, v254
 s_mov_b32 s63, 0x100000
L_pl5:
 buffer_load_dword v249, v254, s[36:39], s49 offen sc1
 s_waitcnt vmcnt(0)
 v_cmp_ne_u32 vcc, s59, v249
 s_nop 0
 s_cbranch_vccz L_pd5
 s_sleep 1
 s_sub_u32 s63, s63, 1
 s_cbranch_scc0 L_pl5
L_pd5:
 s_branch L_sb4
L_sl6:
 v_and_b32 v254, 63, v1
 v_lshlrev_b32 v254, 2, v254
 s_mov_b32 s63, 0x100000
L_pl7:
 buffer_load_dword v249, v254, s[36:39], s50 offen sc1
 s_waitcnt vmcnt(0)
 v_cmp_ne_u32 vcc, s59, v249
 s_nop 0
 s_cbranch_vccz L_pd7
 s_sleep 1
 s_sub_u32 s63, s63, 1
 s_cbranch_scc0 L_pl7
L_pd7:
 s_branch L_sb6
L_tsl:
 s_mov_b32 s63, 0x100000
L_tsp:
 buffer_load_dwordx2 v[6:7], v10, s[36:39], s47 offen sc1
 s_waitcnt vmcnt(0)
 v_cmp_ne_u32 vcc, s59, v7
 s_nop 0
 s_cbranch_vccz L_tsb
 s_sleep 1
 s_sub_u32 s63, s63, 1
 s_cbranch_scc0 L_tsp
 s_branch L_tsb
L_slO:
 v_and_b32 v254, 7, v1
 v_lshlrev_b32 v254, 2, v254
 s_mov_b32 s63, 0x100000
L_pl8:
 buffer_load_dword v249, v254, s[36:39], s50 offen sc1
 s_waitcnt vmcnt(0)
 v_cmp_ne_u32 vcc, s59, v249
 s_nop 0
 s_cbranch_vccz L_pd8
 s_sleep 1
 s_sub_u32 s63, s63, 1
 s_cbranch_scc0 L_pl8
L_pd8:
 s_branch L_sbO
L_P0:
 ds_read_b64_tr_b16 v[48:49], v14
 ds_read_b64_tr_b16 v[50:51], v14 offset:4608
 ds_read_b64_tr_b16 v[52:53], v14 offset:9216
 ds_read_b64_tr_b16 v[54:55], v14 offset:13824
 ds_read_b64_tr_b16 v[56:57], v14 offset:32
 ds_read_b64_tr_b16 v[58:59], v14 offset:4640
 ds_read_b64_tr_b16 v[60:61], v14 offset:9248
 ds_read_b64_tr_b16 v[62:63], v14 offset:13856
 ds_read_b64_tr_b16 v[64:65], v14 offset:64
 ds_read_b64_tr_b16 v[66:67], v14 offset:4672
 ds_read_b64_tr_b16 v[68:69], v14 offset:9280
 ds_read_b64_tr_b16 v[70:71], v14 offset:13888
 ds_read_b64_tr_b16 v[72:73], v14 offset:96
 ds_read_b64_tr_b16 v[74:75], v14 offset:4704
 ds_read_b64_tr_b16 v[76:77], v14 offset:9312
 ds_read_b64_tr_b16 v[78:79], v14 offset:13920
 ds_read_b64_tr_b16 v[80:81], v15
 ds_read_b64_tr_b16 v[82:83], v15 offset:4608
 ds_read_b64_tr_b16 v[84:85], v15 offset:9216
 ds_read_b64_tr_b16 v[86:87], v15 offset:13824
 s_waitcnt lgkmcnt(15)
 v_mfma_f32_16x16x32_bf16 a[72:75], v[48:51], a[192:195], 0
 s_waitcnt vmcnt(60)
 ds_read_b64_tr_b16 v[88:89], v15 offset:32
 ds_read_b64_tr_b16 v[90:91], v15 offset:4640
 v_mfma_f32_16x16x32_bf16 a[72:75], v[52:55], a[200:203], a[72:75]
 s_add_u32 s55, s58, 0x1800
 buffer_store_dwordx4 v[112:115], v2, s[36:39], s55 offen sc1
 v_mfma_f32_16x16x32_bf16 a[76:79], v[48:51], a[196:199], 0
 s_lshl_b32 s49, s17, 7
 ds_read_b64_tr_b16 v[92:93], v15 offset:9248
 ds_read_b64_tr_b16 v[94:95], v15 offset:13856
 v_mfma_f32_16x16x32_bf16 a[76:79], v[52:55], a[204:207], a[76:79]
 s_waitcnt lgkmcnt(15)
 s_lshl_b32 s62, s16, 2
 v_accvgpr_read_b32 v160, a8
 v_mul_f32 v160, v160, v234
 v_mfma_f32_16x16x32_bf16 a[80:83], v[56:59], a[192:195], 0
 s_add_u32 s49, s49, s62
 ds_read_b64_tr_b16 v[48:49], v15 offset:64
 ds_read_b64_tr_b16 v[50:51], v15 offset:4672
 v_mfma_f32_16x16x32_bf16 a[80:83], v[60:63], a[200:203], a[80:83]
 s_add_u32 s49, s49, 0x300800
 v_accvgpr_read_b32 v161, a9
 v_mul_f32 v161, v161, v234
 v_mfma_f32_16x16x32_bf16 a[84:87], v[56:59], a[196:199], 0
 s_lshl_b32 s50, s17, 7
 ds_read_b64_tr_b16 v[52:53], v15 offset:9280
 ds_read_b64_tr_b16 v[54:55], v15 offset:13888
 v_mfma_f32_16x16x32_bf16 a[84:87], v[60:63], a[204:207], a[84:87]
 s_waitcnt lgkmcnt(15)
 s_lshl_b32 s62, s70, 5
 v_accvgpr_read_b32 v162, a10
 v_mul_f32 v162, v162, v234
 v_mfma_f32_16x16x32_bf16 a[88:91], v[64:67], a[192:195], 0
 s_add_u32 s50, s50, s62
 ds_read_b64_tr_b16 v[56:57], v15 offset:96
 ds_read_b64_tr_b16 v[58:59], v15 offset:4704
 v_mfma_f32_16x16x32_bf16 a[88:91], v[68:71], a[200:203], a[88:91]
 s_add_u32 s50, s50, 0x300800
 v_accvgpr_read_b32 v163, a11
 v_mul_f32 v163, v163, v234
 v_mfma_f32_16x16x32_bf16 a[92:95], v[64:67], a[196:199], 0
 ds_read_b64_tr_b16 v[60:61], v15 offset:9312
 ds_read_b64_tr_b16 v[62:63], v15 offset:13920
 v_mfma_f32_16x16x32_bf16 a[92:95], v[68:71], a[204:207], a[92:95]
 s_waitcnt lgkmcnt(15)
 v_cvt_pk_bf16_f32 v200, v160, v161
 v_cvt_pk_bf16_f32 v201, v162, v163
 v_mfma_f32_16x16x32_bf16 a[96:99], v[72:75], a[192:195], 0
 ds_read_b64_tr_b16 v[64:65], v16
 ds_read_b64_tr_b16 v[66:67], v16 offset:4608
 v_mfma_f32_16x16x32_bf16 a[96:99], v[76:79], a[200:203], a[96:99]
 v_accvgpr_read_b32 v164, a24
 v_mul_f32 v164, v164, v234
 v_mfma_f32_16x16x32_bf16 a[100:103], v[72:75], a[196:199], 0
 ds_read_b64_tr_b16 v[68:69], v16 offset:9216
 ds_read_b64_tr_b16 v[70:71], v16 offset:13824
 v_mfma_f32_16x16x32_bf16 a[100:103], v[76:79], a[204:207], a[100:103]
 s_waitcnt lgkmcnt(15)
 buffer_store_dwordx4 v[116:119], v2, s[36:39], s55 offen offset:1024 sc1
 v_mfma_f32_16x16x32_bf16 a[104:107], v[80:83], a[192:195], 0
 ds_read_b64_tr_b16 v[72:73], v14 offset:18432
 ds_read_b64_tr_b16 v[74:75], v14 offset:23040
 v_mfma_f32_16x16x32_bf16 a[104:107], v[84:87], a[200:203], a[104:107]
 v_accvgpr_read_b32 v165, a25
 v_mul_f32 v165, v165, v234
 v_mfma_f32_16x16x32_bf16 a[108:111], v[80:83], a[196:199], 0
 ds_read_b64_tr_b16 v[76:77], v14 offset:27648
 ds_read_b64_tr_b16 v[78:79], v14 offset:32256
 v_mfma_f32_16x16x32_bf16 a[108:111], v[84:87], a[204:207], a[108:111]
 s_waitcnt lgkmcnt(15)
 v_accvgpr_read_b32 v166, a26
 v_mul_f32 v166, v166, v234
 v_mfma_f32_16x16x32_bf16 a[112:115], v[88:91], a[192:195], 0
 ds_read_b64_tr_b16 v[80:81], v14 offset:18464
 ds_read_b64_tr_b16 v[82:83], v14 offset:23072
 v_mfma_f32_16x16x32_bf16 a[112:115], v[92:95], a[200:203], a[112:115]
 v_accvgpr_read_b32 v167, a27
 v_mul_f32 v167, v167, v234
 v_mfma_f32_16x16x32_bf16 a[116:119], v[88:91], a[196:199], 0
 ds_read_b64_tr_b16 v[84:85], v14 offset:27680
 ds_read_b64_tr_b16 v[86:87], v14 offset:32288
 v_mfma_f32_16x16x32_bf16 a[116:119], v[92:95], a[204:207], a[116:119]
 s_waitcnt lgkmcnt(15)
 v_cvt_pk_bf16_f32 v202, v164, v165
 v_cvt_pk_bf16_f32 v203, v166, v167
 v_mfma_f32_16x16x32_bf16 a[120:123], v[48:51], a[192:195], 0
 ds_read_b64_tr_b16 v[88:89], v14 offset:18496
 ds_read_b64_tr_b16 v[90:91], v14 offset:23104
 v_mfma_f32_16x16x32_bf16 a[120:123], v[52:55], a[200:203], a[120:123]
 v_accvgpr_read_b32 v168, a12
 v_mul_f32 v168, v168, v235
 v_mfma_f32_16x16x32_bf16 a[124:127], v[48:51], a[196:199], 0
 ds_read_b64_tr_b16 v[92:93], v14 offset:27712
 ds_read_b64_tr_b16 v[94:95], v14 offset:32320
 v_mfma_f32_16x16x32_bf16 a[124:127], v[52:55], a[204:207], a[124:127]
 s_waitcnt lgkmcnt(15)
 v_accvgpr_read_b32 v169, a13
 v_mul_f32 v169, v169, v235
 v_mfma_f32_16x16x32_bf16 a[128:131], v[56:59], a[192:195], 0
 ds_read_b64_tr_b16 v[48:49], v14 offset:18528
 ds_read_b64_tr_b16 v[50:51], v14 offset:23136
 v_mfma_f32_16x16x32_bf16 a[128:131], v[60:63], a[200:203], a[128:131]
 buffer_store_dwordx4 v[120:123], v3, s[36:39], s55 offen sc1
 v_mfma_f32_16x16x32_bf16 a[132:135], v[56:59], a[196:199], 0
 ds_read_b64_tr_b16 v[52:53], v14 offset:27744
 ds_read_b64_tr_b16 v[54:55], v14 offset:32352
 v_mfma_f32_16x16x32_bf16 a[132:135], v[60:63], a[204:207], a[132:135]
 s_waitcnt lgkmcnt(15)
 v_accvgpr_read_b32 v170, a14
 v_mul_f32 v170, v170, v235
 v_mfma_f32_16x16x32_bf16 a[136:139], v[64:67], a[192:195], 0
 ds_read_b64_tr_b16 v[56:57], v15 offset:18432
 ds_read_b64_tr_b16 v[58:59], v15 offset:23040
 v_mfma_f32_16x16x32_bf16 a[136:139], v[68:71], a[200:203], a[136:139]
 v_accvgpr_read_b32 v171, a15
 v_mul_f32 v171, v171, v235
 v_mfma_f32_16x16x32_bf16 a[140:143], v[64:67], a[196:199], 0
 ds_read_b64_tr_b16 v[60:61], v15 offset:27648
 ds_read_b64_tr_b16 v[62:63], v15 offset:32256
 v_mfma_f32_16x16x32_bf16 a[140:143], v[68:71], a[204:207], a[140:143]
 s_waitcnt vmcnt(62) lgkmcnt(15)
 v_cvt_pk_bf16_f32 v204, v168, v169
 v_cvt_pk_bf16_f32 v205, v170, v171
 v_mfma_f32_16x16x32_bf16 a[72:75], v[72:75], a[208:211], a[72:75]
 s_waitcnt vmcnt(60)
 ds_read_b64_tr_b16 v[64:65], v15 offset:18464
 ds_read_b64_tr_b16 v[66:67], v15 offset:23072
 v_mfma_f32_16x16x32_bf16 a[72:75], v[76:79], a[216:219], a[72:75]
 v_accvgpr_read_b32 v172, a28
 v_mul_f32 v172, v172, v235
 v_mfma_f32_16x16x32_bf16 a[76:79], v[72:75], a[212:215], a[76:79]
 s_waitcnt vmcnt(59)
 ds_read_b64_tr_b16 v[68:69], v15 offset:27680
 ds_read_b64_tr_b16 v[70:71], v15 offset:32288
 v_mfma_f32_16x16x32_bf16 a[76:79], v[76:79], a[220:223], a[76:79]
 s_waitcnt lgkmcnt(15)
 v_accvgpr_read_b32 v173, a29
 v_mul_f32 v173, v173, v235
 v_mfma_f32_16x16x32_bf16 a[80:83], v[80:83], a[208:211], a[80:83]
 ds_read_b64_tr_b16 v[72:73], v15 offset:18496
 ds_read_b64_tr_b16 v[74:75], v15 offset:23104
 v_mfma_f32_16x16x32_bf16 a[80:83], v[84:87], a[216:219], a[80:83]
 v_accvgpr_read_b32 v174, a30
 v_mul_f32 v174, v174, v235
 v_mfma_f32_16x16x32_bf16 a[84:87], v[80:83], a[212:215], a[84:87]
 ds_read_b64_tr_b16 v[76:77], v15 offset:27712
 ds_read_b64_tr_b16 v[78:79], v15 offset:32320
 v_mfma_f32_16x16x32_bf16 a[84:87], v[84:87], a[220:223], a[84:87]
 s_waitcnt lgkmcnt(15)
 buffer_store_dwordx4 v[124:127], v3, s[36:39], s55 offen offset:1024 sc1
 v_mfma_f32_16x16x32_bf16 a[88:91], v[88:91], a[208:211], a[88:91]
 ds_read_b64_tr_b16 v[80:81], v15 offset:18528
 ds_read_b64_tr_b16 v[82:83], v15 offset:23136
 v_mfma_f32_16x16x32_bf16 a[88:91], v[92:95], a[216:219], a[88:91]
 v_accvgpr_read_b32 v175, a31
 v_mul_f32 v175, v175, v235
 v_mfma_f32_16x16x32_bf16 a[92:95], v[88:91], a[212:215], a[92:95]
 ds_read_b64_tr_b16 v[84:85], v15 offset:27744
 ds_read_b64_tr_b16 v[86:87], v15 offset:32352
 v_mfma_f32_16x16x32_bf16 a[92:95], v[92:95], a[220:223], a[92:95]
 s_waitcnt lgkmcnt(15)
 v_cvt_pk_bf16_f32 v206, v172, v173
 v_cvt_pk_bf16_f32 v207, v174, v175
 v_mfma_f32_16x16x32_bf16 a[96:99], v[48:51], a[208:211], a[96:99]
 ds_read_b64_tr_b16 v[88:89], v16 offset:18432
 ds_read_b64_tr_b16 v[90:91], v16 offset:23040
 v_mfma_f32_16x16x32_bf16 a[96:99], v[52:55], a[216:219], a[96:99]
 v_accvgpr_read_b32 v160, a32
 v_mul_f32 v160, v160, v232
 v_mfma_f32_16x16x32_bf16 a[100:103], v[48:51], a[212:215], a[100:103]
 ds_read_b64_tr_b16 v[92:93], v16 offset:27648
 ds_read_b64_tr_b16 v[94:95], v16 offset:32256
 v_mfma_f32_16x16x32_bf16 a[100:103], v[52:55], a[220:223], a[100:103]
 s_waitcnt lgkmcnt(15)
 v_accvgpr_read_b32 v161, a33
 v_mul_f32 v161, v161, v232
 v_mfma_f32_16x16x32_bf16 a[104:107], v[56:59], a[208:211], a[104:107]
 v_accvgpr_read_b32 v162, a34
 v_mul_f32 v162, v162, v232
 v_mfma_f32_16x16x32_bf16 a[104:107], v[60:63], a[216:219], a[104:107]
 v_accvgpr_read_b32 v163, a35
 v_mul_f32 v163, v163, v232
 v_mfma_f32_16x16x32_bf16 a[108:111], v[56:59], a[212:215], a[108:111]
 v_cvt_pk_bf16_f32 v208, v160, v161
 v_cvt_pk_bf16_f32 v209, v162, v163
 v_mfma_f32_16x16x32_bf16 a[108:111], v[60:63], a[220:223], a[108:111]
 s_waitcnt lgkmcnt(14)
 v_accvgpr_read_b32 v164, a48
 v_mul_f32 v164, v164, v232
 v_mfma_f32_16x16x32_bf16 a[112:115], v[64:67], a[208:211], a[112:115]
 s_waitcnt vmcnt(51) lgkmcnt(12)
 v_accvgpr_read_b32 v165, a49
 v_mul_f32 v165, v165, v232
 v_mfma_f32_16x16x32_bf16 a[112:115], v[68:71], a[216:219], a[112:115]
 s_waitcnt lgkmcnt(0)
 v_accvgpr_read_b32 v166, a50
 v_mul_f32 v166, v166, v232
 v_mfma_f32_16x16x32_bf16 a[116:119], v[64:67], a[212:215], a[116:119]
 s_add_u32 s55, s58, 0
 buffer_store_dwordx4 v[192:195], v2, s[36:39], s55 offen sc1
 v_mfma_f32_16x16x32_bf16 a[116:119], v[68:71], a[220:223], a[116:119]
 s_barrier
 ds_read_b64_tr_b16 v[48:49], v17
 ds_read_b64_tr_b16 v[50:51], v17 offset:4608
 v_mfma_f32_16x16x32_bf16 a[120:123], v[72:75], a[208:211], a[120:123]
 ds_read_b64_tr_b16 v[52:53], v17 offset:9216
 ds_read_b64_tr_b16 v[54:55], v17 offset:13824
 v_mfma_f32_16x16x32_bf16 a[120:123], v[76:79], a[216:219], a[120:123]
 ds_read_b64_tr_b16 v[56:57], v17 offset:32
 ds_read_b64_tr_b16 v[58:59], v17 offset:4640
 v_mfma_f32_16x16x32_bf16 a[124:127], v[72:75], a[212:215], a[124:127]
 ds_read_b64_tr_b16 v[60:61], v17 offset:9248
 ds_read_b64_tr_b16 v[62:63], v17 offset:13856
 v_mfma_f32_16x16x32_bf16 a[124:127], v[76:79], a[220:223], a[124:127]
 ds_read_b64_tr_b16 v[64:65], v17 offset:64
 ds_read_b64_tr_b16 v[66:67], v17 offset:4672
 v_mfma_f32_16x16x32_bf16 a[128:131], v[80:83], a[208:211], a[128:131]
 ds_read_b64_tr_b16 v[68:69], v17 offset:9280
 ds_read_b64_tr_b16 v[70:71], v17 offset:13888
 v_mfma_f32_16x16x32_bf16 a[128:131], v[84:87], a[216:219], a[128:131]
 ds_read_b64_tr_b16 v[72:73], v17 offset:96
 ds_read_b64_tr_b16 v[74:75], v17 offset:4704
 v_mfma_f32_16x16x32_bf16 a[132:135], v[80:83], a[212:215], a[132:135]
 ds_read_b64_tr_b16 v[76:77], v17 offset:9312
 ds_read_b64_tr_b16 v[78:79], v17 offset:13920
 v_mfma_f32_16x16x32_bf16 a[132:135], v[84:87], a[220:223], a[132:135]
 v_accvgpr_read_b32 v167, a51
 v_mul_f32 v167, v167, v232
 v_mfma_f32_16x16x32_bf16 a[136:139], v[88:91], a[208:211], a[136:139]
 ds_read_b64_tr_b16 v[80:81], v18
 ds_read_b64_tr_b16 v[82:83], v18 offset:4608
 v_mfma_f32_16x16x32_bf16 a[136:139], v[92:95], a[216:219], a[136:139]
 v_cvt_pk_bf16_f32 v210, v164, v165
 v_cvt_pk_bf16_f32 v211, v166, v167
 v_mfma_f32_16x16x32_bf16 a[140:143], v[88:91], a[212:215], a[140:143]
 ds_read_b64_tr_b16 v[84:85], v18 offset:9216
 ds_read_b64_tr_b16 v[86:87], v18 offset:13824
 v_mfma_f32_16x16x32_bf16 a[140:143], v[92:95], a[220:223], a[140:143]
 s_waitcnt vmcnt(51) lgkmcnt(15)
 buffer_store_dwordx4 v[196:199], v2, s[36:39], s55 offen offset:1024 sc1
 v_mfma_f32_16x16x32_bf16 a[72:75], v[48:51], a[224:227], a[72:75]
 s_waitcnt vmcnt(49)
 ds_read_b64_tr_b16 v[88:89], v18 offset:32
 ds_read_b64_tr_b16 v[90:91], v18 offset:4640
 v_mfma_f32_16x16x32_bf16 a[72:75], v[52:55], a[232:235], a[72:75]
 s_add_u32 m0, s8, 0
 v_accvgpr_read_b32 v168, a36
 v_mul_f32 v168, v168, v233
 v_mfma_f32_16x16x32_bf16 a[76:79], v[48:51], a[228:231], a[76:79]
 s_add_u32 s40, s52, 0
 buffer_load_dwordx4 v2, s[36:39], s40 offen sc1 lds
 v_mfma_f32_16x16x32_bf16 a[76:79], v[52:55], a[236:239], a[76:79]
 s_waitcnt lgkmcnt(15)
 ds_read_b64_tr_b16 v[92:93], v18 offset:9248
 ds_read_b64_tr_b16 v[94:95], v18 offset:13856
 v_mfma_f32_16x16x32_bf16 a[80:83], v[56:59], a[224:227], a[80:83]
 s_waitcnt lgkmcnt(15)
 ds_read_b64_tr_b16 v[48:49], v18 offset:64
 ds_read_b64_tr_b16 v[50:51], v18 offset:4672
 v_mfma_f32_16x16x32_bf16 a[80:83], v[60:63], a[232:235], a[80:83]
 buffer_load_dwordx4 a[192:195], v4, s[28:31], s53 offen sc1
 v_mfma_f32_16x16x32_bf16 a[84:87], v[56:59], a[228:231], a[84:87]
 ds_read_b64_tr_b16 v[52:53], v18 offset:9280
 ds_read_b64_tr_b16 v[54:55], v18 offset:13888
 v_mfma_f32_16x16x32_bf16 a[84:87], v[60:63], a[236:239], a[84:87]
 s_waitcnt lgkmcnt(15)
 v_accvgpr_read_b32 v169, a37
 v_mul_f32 v169, v169, v233
 v_mfma_f32_16x16x32_bf16 a[88:91], v[64:67], a[224:227], a[88:91]
 ds_read_b64_tr_b16 v[56:57], v18 offset:96
 ds_read_b64_tr_b16 v[58:59], v18 offset:4704
 v_mfma_f32_16x16x32_bf16 a[88:91], v[68:71], a[232:235], a[88:91]
 buffer_load_dwordx4 v2, s[36:39], s40 offen offset:1024 sc1 lds
 v_mfma_f32_16x16x32_bf16 a[92:95], v[64:67], a[228:231], a[92:95]
 ds_read_b64_tr_b16 v[60:61], v18 offset:9312
 ds_read_b64_tr_b16 v[62:63], v18 offset:13920
 v_mfma_f32_16x16x32_bf16 a[92:95], v[68:71], a[236:239], a[92:95]
 s_waitcnt lgkmcnt(15)
 v_accvgpr_read_b32 v170, a38
 v_mul_f32 v170, v170, v233
 v_mfma_f32_16x16x32_bf16 a[96:99], v[72:75], a[224:227], a[96:99]
 ds_read_b64_tr_b16 v[64:65], v19
 ds_read_b64_tr_b16 v[66:67], v19 offset:4608
 v_mfma_f32_16x16x32_bf16 a[96:99], v[76:79], a[232:235], a[96:99]
 buffer_load_dwordx4 a[196:199], v5, s[28:31], s53 offen sc1
 v_mfma_f32_16x16x32_bf16 a[100:103], v[72:75], a[228:231], a[100:103]
 buffer_store_dwordx4 v[200:203], v3, s[36:39], s55 offen sc1
 v_mfma_f32_16x16x32_bf16 a[100:103], v[76:79], a[236:239], a[100:103]
 s_waitcnt lgkmcnt(15)
 ds_read_b64_tr_b16 v[68:69], v19 offset:9216
 ds_read_b64_tr_b16 v[70:71], v19 offset:13824
 v_mfma_f32_16x16x32_bf16 a[104:107], v[80:83], a[224:227], a[104:107]
 s_waitcnt lgkmcnt(15)
 buffer_load_dwordx4 v2, s[36:39], s40 offen offset:2048 sc1 lds
 v_mfma_f32_16x16x32_bf16 a[104:107], v[84:87], a[232:235], a[104:107]
 ds_read_b64_tr_b16 v[72:73], v17 offset:18432
 ds_read_b64_tr_b16 v[74:75], v17 offset:23040
 v_mfma_f32_16x16x32_bf16 a[108:111], v[80:83], a[228:231], a[108:111]
 ds_read_b64_tr_b16 v[76:77], v17 offset:27648
 ds_read_b64_tr_b16 v[78:79], v17 offset:32256
 v_mfma_f32_16x16x32_bf16 a[108:111], v[84:87], a[236:239], a[108:111]
 s_waitcnt lgkmcnt(15)
 v_accvgpr_read_b32 v171, a39
 v_mul_f32 v171, v171, v233
 v_mfma_f32_16x16x32_bf16 a[112:115], v[88:91], a[224:227], a[112:115]
 ds_read_b64_tr_b16 v[80:81], v17 offset:18464
 ds_read_b64_tr_b16 v[82:83], v17 offset:23072
 v_mfma_f32_16x16x32_bf16 a[112:115], v[92:95], a[232:235], a[112:115]
 buffer_load_dwordx4 a[200:203], v4, s[28:31], s53 offen offset:2048 sc1
 v_mfma_f32_16x16x32_bf16 a[116:119], v[88:91], a[228:231], a[116:119]
 ds_read_b64_tr_b16 v[84:85], v17 offset:27680
 ds_read_b64_tr_b16 v[86:87], v17 offset:32288
 v_cvt_pk_bf16_f32 v212, v168, v169
 v_cvt_pk_bf16_f32 v213, v170, v171
 v_accvgpr_read_b32 v172, a52
 v_mul_f32 v172, v172, v233
 v_accvgpr_read_b32 v173, a53
 v_mul_f32 v173, v173, v233
 v_accvgpr_read_b32 v174, a54
 v_mul_f32 v174, v174, v233
 v_accvgpr_read_b32 v175, a55
 v_mul_f32 v175, v175, v233
 v_cvt_pk_bf16_f32 v214, v172, v173
 v_cvt_pk_bf16_f32 v215, v174, v175
 v_mfma_f32_16x16x32_bf16 a[116:119], v[92:95], a[236:239], a[116:119]
 s_waitcnt lgkmcnt(15)
 buffer_load_dwordx4 v2, s[36:39], s40 offen offset:3072 sc1 lds
 v_mfma_f32_16x16x32_bf16 a[120:123], v[48:51], a[224:227], a[120:123]
 ds_read_b64_tr_b16 v[88:89], v17 offset:18496
 ds_read_b64_tr_b16 v[90:91], v17 offset:23104
 v_mfma_f32_16x16x32_bf16 a[120:123], v[52:55], a[232:235], a[120:123]
 v_accvgpr_read_b32 v160, a40
 v_mul_f32 v160, v160, v234
 v_mfma_f32_16x16x32_bf16 a[124:127], v[48:51], a[228:231], a[124:127]
 ds_read_b64_tr_b16 v[92:93], v17 offset:27712
 ds_read_b64_tr_b16 v[94:95], v17 offset:32320
 v_mfma_f32_16x16x32_bf16 a[124:127], v[52:55], a[236:239], a[124:127]
 s_waitcnt lgkmcnt(15)
 buffer_store_dwordx4 v[204:207], v3, s[36:39], s55 offen offset:1024 sc1
 v_mfma_f32_16x16x32_bf16 a[128:131], v[56:59], a[224:227], a[128:131]
 ds_read_b64_tr_b16 v[48:49], v17 offset:18528
 ds_read_b64_tr_b16 v[50:51], v17 offset:23136
 v_mfma_f32_16x16x32_bf16 a[128:131], v[60:63], a[232:235], a[128:131]
 s_add_u32 m0, s8, 0x1000
 buffer_load_dwordx4 a[204:207], v5, s[28:31], s53 offen offset:2048 sc1
 v_mfma_f32_16x16x32_bf16 a[132:135], v[56:59], a[228:231], a[132:135]
 s_add_u32 s40, s52, 0x1000
 buffer_load_dwordx4 v2, s[36:39], s40 offen sc1 lds
 v_mfma_f32_16x16x32_bf16 a[132:135], v[60:63], a[236:239], a[132:135]
 s_waitcnt lgkmcnt(15)
 ds_read_b64_tr_b16 v[52:53], v17 offset:27744
 ds_read_b64_tr_b16 v[54:55], v17 offset:32352
 v_mfma_f32_16x16x32_bf16 a[136:139], v[64:67], a[224:227], a[136:139]
 s_waitcnt lgkmcnt(15)
 ds_read_b64_tr_b16 v[56:57], v18 offset:18432
 ds_read_b64_tr_b16 v[58:59], v18 offset:23040
 v_mfma_f32_16x16x32_bf16 a[136:139], v[68:71], a[232:235], a[136:139]
 v_accvgpr_read_b32 v161, a41
 v_mul_f32 v161, v161, v234
 v_mfma_f32_16x16x32_bf16 a[140:143], v[64:67], a[228:231], a[140:143]
 ds_read_b64_tr_b16 v[60:61], v18 offset:27648
 ds_read_b64_tr_b16 v[62:63], v18 offset:32256
 v_mfma_f32_16x16x32_bf16 a[140:143], v[68:71], a[236:239], a[140:143]
 s_waitcnt vmcnt(57) lgkmcnt(15)
 v_accvgpr_read_b32 v162, a42
 v_mul_f32 v162, v162, v234
 v_mfma_f32_16x16x32_bf16 a[72:75], v[72:75], a[240:243], a[72:75]
 s_add_u32 s53, s53, 0x1000
 ds_read_b64_tr_b16 v[64:65], v18 offset:18464
 ds_read_b64_tr_b16 v[66:67], v18 offset:23072
 v_mfma_f32_16x16x32_bf16 a[72:75], v[76:79], a[248:251], a[72:75]
 buffer_load_dwordx4 v2, s[36:39], s40 offen offset:1024 sc1 lds
 v_mfma_f32_16x16x32_bf16 a[76:79], v[72:75], a[244:247], a[76:79]
 s_waitcnt vmcnt(57)
 buffer_load_dwordx4 a[208:211], v4, s[28:31], s53 offen sc1
 v_mfma_f32_16x16x32_bf16 a[76:79], v[76:79], a[252:255], a[76:79]
 s_waitcnt lgkmcnt(15)
 ds_read_b64_tr_b16 v[68:69], v18 offset:27680
 ds_read_b64_tr_b16 v[70:71], v18 offset:32288
 v_mfma_f32_16x16x32_bf16 a[80:83], v[80:83], a[240:243], a[80:83]
 s_waitcnt lgkmcnt(15)
 ds_read_b64_tr_b16 v[72:73], v18 offset:18496
 ds_read_b64_tr_b16 v[74:75], v18 offset:23104
 v_mfma_f32_16x16x32_bf16 a[80:83], v[84:87], a[248:251], a[80:83]
 s_add_u32 s55, s58, 0x800
 buffer_store_dwordx4 v[208:211], v2, s[36:39], s55 offen sc1
 v_mfma_f32_16x16x32_bf16 a[84:87], v[80:83], a[244:247], a[84:87]
 ds_read_b64_tr_b16 v[76:77], v18 offset:27712
 ds_read_b64_tr_b16 v[78:79], v18 offset:32320
 v_mfma_f32_16x16x32_bf16 a[84:87], v[84:87], a[252:255], a[84:87]
 s_waitcnt lgkmcnt(15)
 buffer_load_dwordx4 v2, s[36:39], s40 offen offset:2048 sc1 lds
 v_mfma_f32_16x16x32_bf16 a[88:91], v[88:91], a[240:243], a[88:91]
 ds_read_b64_tr_b16 v[80:81], v18 offset:18528
 ds_read_b64_tr_b16 v[82:83], v18 offset:23136
 v_accvgpr_read_b32 v163, a43
 v_mul_f32 v163, v163, v234
 v_cvt_pk_bf16_f32 v216, v160, v161
 v_cvt_pk_bf16_f32 v217, v162, v163
 v_accvgpr_read_b32 v164, a56
 v_mul_f32 v164, v164, v234
 v_accvgpr_read_b32 v165, a57
 v_mul_f32 v165, v165, v234
 v_accvgpr_read_b32 v166, a58
 v_mul_f32 v166, v166, v234
 v_accvgpr_read_b32 v167, a59
 v_mul_f32 v167, v167, v234
 v_cvt_pk_bf16_f32 v218, v164, v165
 v_cvt_pk_bf16_f32 v219, v166, v167
 v_mfma_f32_16x16x32_bf16 a[88:91], v[92:95], a[248:251], a[88:91]
 buffer_load_dwordx4 a[212:215], v5, s[28:31], s53 offen sc1
 v_mfma_f32_16x16x32_bf16 a[92:95], v[88:91], a[244:247], a[92:95]
 ds_read_b64_tr_b16 v[84:85], v18 offset:27744
 ds_read_b64_tr_b16 v[86:87], v18 offset:32352
 v_mfma_f32_16x16x32_bf16 a[92:95], v[92:95], a[252:255], a[92:95]
 s_waitcnt lgkmcnt(15)
 v_accvgpr_read_b32 v168, a44
 v_mul_f32 v168, v168, v235
 v_mfma_f32_16x16x32_bf16 a[96:99], v[48:51], a[240:243], a[96:99]
 ds_read_b64_tr_b16 v[88:89], v19 offset:18432
 ds_read_b64_tr_b16 v[90:91], v19 offset:23040
 v_mfma_f32_16x16x32_bf16 a[96:99], v[52:55], a[248:251], a[96:99]
 v_accvgpr_read_b32 v169, a45
 v_mul_f32 v169, v169, v235
 v_mfma_f32_16x16x32_bf16 a[100:103], v[48:51], a[244:247], a[100:103]
 ds_read_b64_tr_b16 v[92:93], v19 offset:27648
 ds_read_b64_tr_b16 v[94:95], v19 offset:32256
 v_mfma_f32_16x16x32_bf16 a[100:103], v[52:55], a[252:255], a[100:103]
 s_waitcnt lgkmcnt(15)
 buffer_load_dwordx4 v2, s[36:39], s40 offen offset:3072 sc1 lds
 v_mfma_f32_16x16x32_bf16 a[104:107], v[56:59], a[240:243], a[104:107]
 buffer_load_dwordx4 a[216:219], v4, s[28:31], s53 offen offset:2048 sc1
 v_mfma_f32_16x16x32_bf16 a[104:107], v[60:63], a[248:251], a[104:107]
 v_accvgpr_read_b32 v170, a46
 v_mul_f32 v170, v170, v235
 v_mfma_f32_16x16x32_bf16 a[108:111], v[56:59], a[244:247], a[108:111]
 v_accvgpr_read_b32 v171, a47
 v_mul_f32 v171, v171, v235
 v_mfma_f32_16x16x32_bf16 a[108:111], v[60:63], a[252:255], a[108:111]
 s_waitcnt vmcnt(62) lgkmcnt(14)
 buffer_store_dwordx4 v[212:215], v2, s[36:39], s55 offen offset:1024 sc1
 v_mfma_f32_16x16x32_bf16 a[112:115], v[64:67], a[240:243], a[112:115]
 s_waitcnt vmcnt(55) lgkmcnt(12)
 v_cvt_pk_bf16_f32 v220, v168, v169
 v_cvt_pk_bf16_f32 v221, v170, v171
 v_mfma_f32_16x16x32_bf16 a[112:115], v[68:71], a[248:251], a[112:115]
 s_waitcnt lgkmcnt(0)
 v_accvgpr_read_b32 v172, a60
 v_mul_f32 v172, v172, v235
 v_mfma_f32_16x16x32_bf16 a[116:119], v[64:67], a[244:247], a[116:119]
 s_add_u32 m0, s8, 0x2000
 v_accvgpr_read_b32 v173, a61
 v_mul_f32 v173, v173, v235
 v_mfma_f32_16x16x32_bf16 a[116:119], v[68:71], a[252:255], a[116:119]
 s_add_u32 s40, s52, 0x2000
 s_barrier
 buffer_load_dwordx4 v2, s[36:39], s40 offen sc1 lds
 v_mfma_f32_16x16x32_bf16 a[120:123], v[72:75], a[240:243], a[120:123]
 ds_read_b64_tr_b16 v[48:49], v20
 ds_read_b64_tr_b16 v[50:51], v20 offset:4608
 v_mfma_f32_16x16x32_bf16 a[120:123], v[76:79], a[248:251], a[120:123]
 ds_read_b64_tr_b16 v[52:53], v20 offset:9216
 ds_read_b64_tr_b16 v[54:55], v20 offset:13824
 v_mfma_f32_16x16x32_bf16 a[124:127], v[72:75], a[244:247], a[124:127]
 buffer_load_dwordx4 a[220:223], v5, s[28:31], s53 offen offset:2048 sc1
 v_mfma_f32_16x16x32_bf16 a[124:127], v[76:79], a[252:255], a[124:127]
 ds_read_b64_tr_b16 v[56:57], v20 offset:32
 ds_read_b64_tr_b16 v[58:59], v20 offset:4640
 v_mfma_f32_16x16x32_bf16 a[128:131], v[80:83], a[240:243], a[128:131]
 s_add_u32 s52, s52, 0x9000
 ds_read_b64_tr_b16 v[60:61], v20 offset:9248
 ds_read_b64_tr_b16 v[62:63], v20 offset:13856
 v_mfma_f32_16x16x32_bf16 a[128:131], v[84:87], a[248:251], a[128:131]
 ds_read_b64_tr_b16 v[64:65], v20 offset:64
 ds_read_b64_tr_b16 v[66:67], v20 offset:4672
 v_mfma_f32_16x16x32_bf16 a[132:135], v[80:83], a[244:247], a[132:135]
 ds_read_b64_tr_b16 v[68:69], v20 offset:9280
 ds_read_b64_tr_b16 v[70:71], v20 offset:13888
 v_accvgpr_read_b32 v174, a62
 v_mul_f32 v174, v174, v235
 v_accvgpr_read_b32 v175, a63
 v_mul_f32 v175, v175, v235
 v_cvt_pk_bf16_f32 v222, v172, v173
 v_cvt_pk_bf16_f32 v223, v174, v175
 v_mfma_f32_16x16x32_bf16 a[132:135], v[84:87], a[252:255], a[132:135]
 ds_read_b64_tr_b16 v[72:73], v20 offset:96
 ds_read_b64_tr_b16 v[74:75], v20 offset:4704
 v_mfma_f32_16x16x32_bf16 a[136:139], v[88:91], a[240:243], a[136:139]
 s_add_u32 s53, s53, 0x1000
 ds_read_b64_tr_b16 v[76:77], v20 offset:9312
 ds_read_b64_tr_b16 v[78:79], v20 offset:13920
 v_mfma_f32_16x16x32_bf16 a[136:139], v[92:95], a[248:251], a[136:139]
 ds_read_b64_tr_b16 v[80:81], v21
 ds_read_b64_tr_b16 v[82:83], v21 offset:4608
 v_mfma_f32_16x16x32_bf16 a[140:143], v[88:91], a[244:247], a[140:143]
 buffer_store_dwordx4 v[216:219], v3, s[36:39], s55 offen sc1
 v_mfma_f32_16x16x32_bf16 a[140:143], v[92:95], a[252:255], a[140:143]
 s_waitcnt vmcnt(57) lgkmcnt(15)
 ds_read_b64_tr_b16 v[84:85], v21 offset:9216
 ds_read_b64_tr_b16 v[86:87], v21 offset:13824
 v_mfma_f32_16x16x32_bf16 a[72:75], v[48:51], a[160:163], a[72:75]
 s_waitcnt vmcnt(54) lgkmcnt(15)
 ds_read_b64_tr_b16 v[88:89], v21 offset:32
 ds_read_b64_tr_b16 v[90:91], v21 offset:4640
 v_mfma_f32_16x16x32_bf16 a[72:75], v[52:55], a[168:171], a[72:75]
 s_add_u32 m0, s9, 0
 v_mfma_f32_16x16x32_bf16 a[76:79], v[48:51], a[164:167], a[76:79]
 s_add_u32 s40, s52, 0
 buffer_load_dwordx4 v2, s[36:39], s40 offen sc1 lds
 v_mfma_f32_16x16x32_bf16 a[76:79], v[52:55], a[172:175], a[76:79]
 s_waitcnt lgkmcnt(15)
 ds_read_b64_tr_b16 v[92:93], v21 offset:9248
 ds_read_b64_tr_b16 v[94:95], v21 offset:13856
 v_mfma_f32_16x16x32_bf16 a[80:83], v[56:59], a[160:163], a[80:83]
 s_waitcnt lgkmcnt(15)
 ds_read_b64_tr_b16 v[48:49], v21 offset:64
 ds_read_b64_tr_b16 v[50:51], v21 offset:4672
 v_mfma_f32_16x16x32_bf16 a[80:83], v[60:63], a[168:171], a[80:83]
 buffer_load_dwordx4 a[224:227], v4, s[28:31], s53 offen sc1
 v_mfma_f32_16x16x32_bf16 a[84:87], v[56:59], a[164:167], a[84:87]
 ds_read_b64_tr_b16 v[52:53], v21 offset:9280
 ds_read_b64_tr_b16 v[54:55], v21 offset:13888
 v_mfma_f32_16x16x32_bf16 a[84:87], v[60:63], a[172:175], a[84:87]
 s_waitcnt lgkmcnt(15)
 v_mfma_f32_16x16x32_bf16 a[88:91], v[64:67], a[160:163], a[88:91]
 ds_read_b64_tr_b16 v[56:57], v21 offset:96
 ds_read_b64_tr_b16 v[58:59], v21 offset:4704
 v_mfma_f32_16x16x32_bf16 a[88:91], v[68:71], a[168:171], a[88:91]
 buffer_load_dwordx4 v2, s[36:39], s40 offen offset:1024 sc1 lds
 v_mfma_f32_16x16x32_bf16 a[92:95], v[64:67], a[164:167], a[92:95]
 ds_read_b64_tr_b16 v[60:61], v21 offset:9312
 ds_read_b64_tr_b16 v[62:63], v21 offset:13920
 v_mfma_f32_16x16x32_bf16 a[92:95], v[68:71], a[172:175], a[92:95]
 s_waitcnt lgkmcnt(15)
 buffer_store_dwordx4 v[220:223], v3, s[36:39], s55 offen offset:1024 sc1
 v_mfma_f32_16x16x32_bf16 a[96:99], v[72:75], a[160:163], a[96:99]
 ds_read_b64_tr_b16 v[64:65], v22
 ds_read_b64_tr_b16 v[66:67], v22 offset:4608
 v_mfma_f32_16x16x32_bf16 a[96:99], v[76:79], a[168:171], a[96:99]
 buffer_load_dwordx4 a[228:231], v5, s[28:31], s53 offen sc1
 v_mfma_f32_16x16x32_bf16 a[100:103], v[72:75], a[164:167], a[100:103]
 ds_read_b64_tr_b16 v[68:69], v22 offset:9216
 ds_read_b64_tr_b16 v[70:71], v22 offset:13824
 v_mfma_f32_16x16x32_bf16 a[100:103], v[76:79], a[172:175], a[100:103]
 s_waitcnt lgkmcnt(15)
 buffer_load_dwordx4 v2, s[36:39], s40 offen offset:2048 sc1 lds
 v_mfma_f32_16x16x32_bf16 a[104:107], v[80:83], a[160:163], a[104:107]
 ds_read_b64_tr_b16 v[72:73], v20 offset:18432
 ds_read_b64_tr_b16 v[74:75], v20 offset:23040
 v_mfma_f32_16x16x32_bf16 a[104:107], v[84:87], a[168:171], a[104:107]
 v_mfma_f32_16x16x32_bf16 a[108:111], v[80:83], a[164:167], a[108:111]
 ds_read_b64_tr_b16 v[76:77], v20 offset:27648
 ds_read_b64_tr_b16 v[78:79], v20 offset:32256
 v_mfma_f32_16x16x32_bf16 a[108:111], v[84:87], a[172:175], a[108:111]
 s_waitcnt lgkmcnt(15)
 v_mfma_f32_16x16x32_bf16 a[112:115], v[88:91], a[160:163], a[112:115]
 ds_read_b64_tr_b16 v[80:81], v20 offset:18464
 ds_read_b64_tr_b16 v[82:83], v20 offset:23072
 v_mfma_f32_16x16x32_bf16 a[112:115], v[92:95], a[168:171], a[112:115]
 buffer_load_dwordx4 a[232:235], v4, s[28:31], s53 offen offset:2048 sc1
 v_mfma_f32_16x16x32_bf16 a[116:119], v[88:91], a[164:167], a[116:119]
 ds_read_b64_tr_b16 v[84:85], v20 offset:27680
 ds_read_b64_tr_b16 v[86:87], v20 offset:32288
 v_mfma_f32_16x16x32_bf16 a[116:119], v[92:95], a[172:175], a[116:119]
 s_waitcnt lgkmcnt(15)
 buffer_load_dwordx4 v2, s[36:39], s40 offen offset:3072 sc1 lds
 v_mfma_f32_16x16x32_bf16 a[120:123], v[48:51], a[160:163], a[120:123]
 ds_read_b64_tr_b16 v[88:89], v20 offset:18496
 ds_read_b64_tr_b16 v[90:91], v20 offset:23104
 v_mfma_f32_16x16x32_bf16 a[120:123], v[52:55], a[168:171], a[120:123]
 v_mfma_f32_16x16x32_bf16 a[124:127], v[48:51], a[164:167], a[124:127]
 ds_read_b64_tr_b16 v[92:93], v20 offset:27712
 ds_read_b64_tr_b16 v[94:95], v20 offset:32320
 v_mfma_f32_16x16x32_bf16 a[124:127], v[52:55], a[172:175], a[124:127]
 s_waitcnt lgkmcnt(15)
 v_mfma_f32_16x16x32_bf16 a[128:131], v[56:59], a[160:163], a[128:131]
 ds_read_b64_tr_b16 v[48:49], v20 offset:18528
 ds_read_b64_tr_b16 v[50:51], v20 offset:23136
 v_mfma_f32_16x16x32_bf16 a[128:131], v[60:63], a[168:171], a[128:131]
 s_add_u32 m0, s9, 0x1000
 buffer_load_dwordx4 a[236:239], v5, s[28:31], s53 offen offset:2048 sc1
 v_mfma_f32_16x16x32_bf16 a[132:135], v[56:59], a[164:167], a[132:135]
 s_add_u32 s40, s52, 0x1000
 s_waitcnt vmcnt(62)
 buffer_load_dwordx4 v2, s[36:39], s40 offen sc1 lds
 v_mfma_f32_16x16x32_bf16 a[132:135], v[60:63], a[172:175], a[132:135]
 s_waitcnt lgkmcnt(15)
 ds_read_b64_tr_b16 v[52:53], v20 offset:27744
 ds_read_b64_tr_b16 v[54:55], v20 offset:32352
 v_mfma_f32_16x16x32_bf16 a[136:139], v[64:67], a[160:163], a[136:139]
 s_waitcnt lgkmcnt(15)
 ds_read_b64_tr_b16 v[56:57], v21 offset:18432
 ds_read_b64_tr_b16 v[58:59], v21 offset:23040
 v_mfma_f32_16x16x32_bf16 a[136:139], v[68:71], a[168:171], a[136:139]
 v_mfma_f32_16x16x32_bf16 a[140:143], v[64:67], a[164:167], a[140:143]
 ds_read_b64_tr_b16 v[60:61], v21 offset:27648
 ds_read_b64_tr_b16 v[62:63], v21 offset:32256
 v_mfma_f32_16x16x32_bf16 a[140:143], v[68:71], a[172:175], a[140:143]
 s_waitcnt vmcnt(61) lgkmcnt(15)
 v_mfma_f32_16x16x32_bf16 a[72:75], v[72:75], a[176:179], a[72:75]
 s_add_u32 s53, s53, 0x1000
 ds_read_b64_tr_b16 v[64:65], v21 offset:18464
 ds_read_b64_tr_b16 v[66:67], v21 offset:23072
 v_mfma_f32_16x16x32_bf16 a[72:75], v[76:79], a[184:187], a[72:75]
 buffer_load_dwordx4 v2, s[36:39], s40 offen offset:1024 sc1 lds
 v_mfma_f32_16x16x32_bf16 a[76:79], v[72:75], a[180:183], a[76:79]
 s_waitcnt vmcnt(61)
 buffer_load_dwordx4 a[240:243], v4, s[28:31], s53 offen sc1
 v_mfma_f32_16x16x32_bf16 a[76:79], v[76:79], a[188:191], a[76:79]
 s_waitcnt lgkmcnt(15)
 ds_read_b64_tr_b16 v[68:69], v21 offset:27680
 ds_read_b64_tr_b16 v[70:71], v21 offset:32288
 v_mfma_f32_16x16x32_bf16 a[80:83], v[80:83], a[176:179], a[80:83]
 s_waitcnt lgkmcnt(15)
 ds_read_b64_tr_b16 v[72:73], v21 offset:18496
 ds_read_b64_tr_b16 v[74:75], v21 offset:23104
 v_mfma_f32_16x16x32_bf16 a[80:83], v[84:87], a[184:187], a[80:83]
 v_mfma_f32_16x16x32_bf16 a[84:87], v[80:83], a[180:183], a[84:87]
 ds_read_b64_tr_b16 v[76:77], v21 offset:27712
 ds_read_b64_tr_b16 v[78:79], v21 offset:32320
 v_mfma_f32_16x16x32_bf16 a[84:87], v[84:87], a[188:191], a[84:87]
 s_waitcnt lgkmcnt(15)
 buffer_load_dwordx4 v2, s[36:39], s40 offen offset:2048 sc1 lds
 v_mfma_f32_16x16x32_bf16 a[88:91], v[88:91], a[176:179], a[88:91]
 ds_read_b64_tr_b16 v[80:81], v21 offset:18528
 ds_read_b64_tr_b16 v[82:83], v21 offset:23136
 v_mfma_f32_16x16x32_bf16 a[88:91], v[92:95], a[184:187], a[88:91]
 s_waitcnt vmcnt(62)
 buffer_load_dwordx4 a[244:247], v5, s[28:31], s53 offen sc1
 v_mfma_f32_16x16x32_bf16 a[92:95], v[88:91], a[180:183], a[92:95]
 ds_read_b64_tr_b16 v[84:85], v21 offset:27744
 ds_read_b64_tr_b16 v[86:87], v21 offset:32352
 v_mfma_f32_16x16x32_bf16 a[92:95], v[92:95], a[188:191], a[92:95]
 s_waitcnt lgkmcnt(15)
 v_mfma_f32_16x16x32_bf16 a[96:99], v[48:51], a[176:179], a[96:99]
 ds_read_b64_tr_b16 v[88:89], v22 offset:18432
 ds_read_b64_tr_b16 v[90:91], v22 offset:23040
 v_mfma_f32_16x16x32_bf16 a[96:99], v[52:55], a[184:187], a[96:99]
 v_mfma_f32_16x16x32_bf16 a[100:103], v[48:51], a[180:183], a[100:103]
 ds_read_b64_tr_b16 v[92:93], v22 offset:27648
 ds_read_b64_tr_b16 v[94:95], v22 offset:32256
 v_mfma_f32_16x16x32_bf16 a[100:103], v[52:55], a[188:191], a[100:103]
 s_waitcnt vmcnt(62) lgkmcnt(15)
 buffer_load_dwordx4 v2, s[36:39], s40 offen offset:3072 sc1 lds
 v_mfma_f32_16x16x32_bf16 a[104:107], v[56:59], a[176:179], a[104:107]
 s_waitcnt vmcnt(62)
 buffer_load_dwordx4 a[248:251], v4, s[28:31], s53 offen offset:2048 sc1
 v_mfma_f32_16x16x32_bf16 a[104:107], v[60:63], a[184:187], a[104:107]
 v_mfma_f32_16x16x32_bf16 a[108:111], v[56:59], a[180:183], a[108:111]
 v_mfma_f32_16x16x32_bf16 a[108:111], v[60:63], a[188:191], a[108:111]
 s_waitcnt vmcnt(12) lgkmcnt(14)
 v_mfma_f32_16x16x32_bf16 a[112:115], v[64:67], a[176:179], a[112:115]
 s_waitcnt lgkmcnt(12)
 v_mfma_f32_16x16x32_bf16 a[112:115], v[68:71], a[184:187], a[112:115]
 s_waitcnt lgkmcnt(0)
 v_mfma_f32_16x16x32_bf16 a[116:119], v[64:67], a[180:183], a[116:119]
 s_add_u32 m0, s9, 0x2000
 v_mfma_f32_16x16x32_bf16 a[116:119], v[68:71], a[188:191], a[116:119]
 s_add_u32 s40, s52, 0x2000
 s_barrier
 buffer_load_dwordx4 v2, s[36:39], s40 offen sc1 lds
 v_mfma_f32_16x16x32_bf16 a[120:123], v[72:75], a[176:179], a[120:123]
 s_cmp_lg_u32 s3, 0
 s_cbranch_scc1 L_sgo0
 s_mov_b64 exec, 1
 buffer_store_dword v253, off, s[36:39], s49 sc1
 s_mov_b64 exec, -1
L_sgo0:
 ds_read_b64_tr_b16 v[48:49], v23
 ds_read_b64_tr_b16 v[50:51], v23 offset:4608
 v_mfma_f32_16x16x32_bf16 a[120:123], v[76:79], a[184:187], a[120:123]
 ds_read_b64_tr_b16 v[52:53], v23 offset:9216
 ds_read_b64_tr_b16 v[54:55], v23 offset:13824
 v_mfma_f32_16x16x32_bf16 a[124:127], v[72:75], a[180:183], a[124:127]
 buffer_load_dwordx4 a[252:255], v5, s[28:31], s53 offen offset:2048 sc1
 v_mfma_f32_16x16x32_bf16 a[124:127], v[76:79], a[188:191], a[124:127]
 ds_read_b64_tr_b16 v[56:57], v23 offset:32
 ds_read_b64_tr_b16 v[58:59], v23 offset:4640
 v_mfma_f32_16x16x32_bf16 a[128:131], v[80:83], a[176:179], a[128:131]
 s_add_u32 s52, s52, 0x9000
 ds_read_b64_tr_b16 v[60:61], v23 offset:9248
 ds_read_b64_tr_b16 v[62:63], v23 offset:13856
 v_mfma_f32_16x16x32_bf16 a[128:131], v[84:87], a[184:187], a[128:131]
 ds_read_b64_tr_b16 v[64:65], v23 offset:64
 ds_read_b64_tr_b16 v[66:67], v23 offset:4672
 v_mfma_f32_16x16x32_bf16 a[132:135], v[80:83], a[180:183], a[132:135]
 ds_read_b64_tr_b16 v[68:69], v23 offset:9280
 ds_read_b64_tr_b16 v[70:71], v23 offset:13888
 v_mfma_f32_16x16x32_bf16 a[132:135], v[84:87], a[188:191], a[132:135]
 ds_read_b64_tr_b16 v[72:73], v23 offset:96
 ds_read_b64_tr_b16 v[74:75], v23 offset:4704
 v_mfma_f32_16x16x32_bf16 a[136:139], v[88:91], a[176:179], a[136:139]
 s_add_u32 s53, s53, 0x1000
 ds_read_b64_tr_b16 v[76:77], v23 offset:9312
 ds_read_b64_tr_b16 v[78:79], v23 offset:13920
 v_mfma_f32_16x16x32_bf16 a[136:139], v[92:95], a[184:187], a[136:139]
 ds_read_b64_tr_b16 v[80:81], v24
 ds_read_b64_tr_b16 v[82:83], v24 offset:4608
 v_mfma_f32_16x16x32_bf16 a[140:143], v[88:91], a[180:183], a[140:143]
 ds_read_b64_tr_b16 v[84:85], v24 offset:9216
 ds_read_b64_tr_b16 v[86:87], v24 offset:13824
 v_mfma_f32_16x16x32_bf16 a[140:143], v[92:95], a[188:191], a[140:143]
 s_branch L_B3
L_P1:
 ds_read_b64_tr_b16 v[48:49], v17
 ds_read_b64_tr_b16 v[50:51], v17 offset:4608
 ds_read_b64_tr_b16 v[52:53], v17 offset:9216
 ds_read_b64_tr_b16 v[54:55], v17 offset:13824
 ds_read_b64_tr_b16 v[56:57], v17 offset:32
 ds_read_b64_tr_b16 v[58:59], v17 offset:4640
 ds_read_b64_tr_b16 v[60:61], v17 offset:9248
 ds_read_b64_tr_b16 v[62:63], v17 offset:13856
 ds_read_b64_tr_b16 v[64:65], v17 offset:64
 ds_read_b64_tr_b16 v[66:67], v17 offset:4672
 ds_read_b64_tr_b16 v[68:69], v17 offset:9280
 ds_read_b64_tr_b16 v[70:71], v17 offset:13888
 ds_read_b64_tr_b16 v[72:73], v17 offset:96
 ds_read_b64_tr_b16 v[74:75], v17 offset:4704
 ds_read_b64_tr_b16 v[76:77], v17 offset:9312
 ds_read_b64_tr_b16 v[78:79], v17 offset:13920
 ds_read_b64_tr_b16 v[80:81], v18
 ds_read_b64_tr_b16 v[82:83], v18 offset:4608
 ds_read_b64_tr_b16 v[84:85], v18 offset:9216
 ds_read_b64_tr_b16 v[86:87], v18 offset:13824
 s_waitcnt vmcnt(46) lgkmcnt(15)
 v_mfma_f32_16x16x32_bf16 a[72:75], v[48:51], a[224:227], 0
 s_waitcnt vmcnt(43)
 ds_read_b64_tr_b16 v[88:89], v18 offset:32
 ds_read_b64_tr_b16 v[90:91], v18 offset:4640
 v_mfma_f32_16x16x32_bf16 a[72:75], v[52:55], a[232:235], a[72:75]
 s_add_u32 s55, s58, 0x1800
 buffer_store_dwordx4 v[112:115], v2, s[36:39], s55 offen sc1
 v_mfma_f32_16x16x32_bf16 a[76:79], v[48:51], a[228:231], 0
 s_lshl_b32 s49, s17, 7
 ds_read_b64_tr_b16 v[92:93], v18 offset:9248
 ds_read_b64_tr_b16 v[94:95], v18 offset:13856
 v_mfma_f32_16x16x32_bf16 a[76:79], v[52:55], a[236:239], a[76:79]
 s_waitcnt lgkmcnt(15)
 s_lshl_b32 s62, s16, 2
 v_accvgpr_read_b32 v160, a8
 v_mul_f32 v160, v160, v234
 v_mfma_f32_16x16x32_bf16 a[80:83], v[56:59], a[224:227], 0
 s_add_u32 s49, s49, s62
 ds_read_b64_tr_b16 v[48:49], v18 offset:64
 ds_read_b64_tr_b16 v[50:51], v18 offset:4672
 v_mfma_f32_16x16x32_bf16 a[80:83], v[60:63], a[232:235], a[80:83]
 s_add_u32 s49, s49, 0x300800
 v_accvgpr_read_b32 v161, a9
 v_mul_f32 v161, v161, v234
 v_mfma_f32_16x16x32_bf16 a[84:87], v[56:59], a[228:231], 0
 s_lshl_b32 s50, s17, 7
 ds_read_b64_tr_b16 v[52:53], v18 offset:9280
 ds_read_b64_tr_b16 v[54:55], v18 offset:13888
 v_mfma_f32_16x16x32_bf16 a[84:87], v[60:63], a[236:239], a[84:87]
 s_waitcnt lgkmcnt(15)
 s_lshl_b32 s62, s70, 5
 v_accvgpr_read_b32 v162, a10
 v_mul_f32 v162, v162, v234
 v_mfma_f32_16x16x32_bf16 a[88:91], v[64:67], a[224:227], 0
 s_add_u32 s50, s50, s62
 ds_read_b64_tr_b16 v[56:57], v18 offset:96
 ds_read_b64_tr_b16 v[58:59], v18 offset:4704
 v_mfma_f32_16x16x32_bf16 a[88:91], v[68:71], a[232:235], a[88:91]
 s_add_u32 s50, s50, 0x300800
 v_accvgpr_read_b32 v163, a11
 v_mul_f32 v163, v163, v234
 v_mfma_f32_16x16x32_bf16 a[92:95], v[64:67], a[228:231], 0
 ds_read_b64_tr_b16 v[60:61], v18 offset:9312
 ds_read_b64_tr_b16 v[62:63], v18 offset:13920
 v_mfma_f32_16x16x32_bf16 a[92:95], v[68:71], a[236:239], a[92:95]
 s_waitcnt lgkmcnt(15)
 v_cvt_pk_bf16_f32 v200, v160, v161
 v_cvt_pk_bf16_f32 v201, v162, v163
 v_mfma_f32_16x16x32_bf16 a[96:99], v[72:75], a[224:227], 0
 ds_read_b64_tr_b16 v[64:65], v19
 ds_read_b64_tr_b16 v[66:67], v19 offset:4608
 v_mfma_f32_16x16x32_bf16 a[96:99], v[76:79], a[232:235], a[96:99]
 v_accvgpr_read_b32 v164, a24
 v_mul_f32 v164, v164, v234
 v_mfma_f32_16x16x32_bf16 a[100:103], v[72:75], a[228:231], 0
 ds_read_b64_tr_b16 v[68:69], v19 offset:9216
 ds_read_b64_tr_b16 v[70:71], v19 offset:13824
 v_mfma_f32_16x16x32_bf16 a[100:103], v[76:79], a[236:239], a[100:103]
 s_waitcnt lgkmcnt(15)
 buffer_store_dwordx4 v[116:119], v2, s[36:39], s55 offen offset:1024 sc1
 v_mfma_f32_16x16x32_bf16 a[104:107], v[80:83], a[224:227], 0
 ds_read_b64_tr_b16 v[72:73], v17 offset:18432
 ds_read_b64_tr_b16 v[74:75], v17 offset:23040
 v_mfma_f32_16x16x32_bf16 a[104:107], v[84:87], a[232:235], a[104:107]
 v_accvgpr_read_b32 v165, a25
 v_mul_f32 v165, v165, v234
 v_mfma_f32_16x16x32_bf16 a[108:111], v[80:83], a[228:231], 0
 ds_read_b64_tr_b16 v[76:77], v17 offset:27648
 ds_read_b64_tr_b16 v[78:79], v17 offset:32256
 v_mfma_f32_16x16x32_bf16 a[108:111], v[84:87], a[236:239], a[108:111]
 s_waitcnt lgkmcnt(15)
 v_accvgpr_read_b32 v166, a26
 v_mul_f32 v166, v166, v234
 v_mfma_f32_16x16x32_bf16 a[112:115], v[88:91], a[224:227], 0
 ds_read_b64_tr_b16 v[80:81], v17 offset:18464
 ds_read_b64_tr_b16 v[82:83], v17 offset:23072
 v_mfma_f32_16x16x32_bf16 a[112:115], v[92:95], a[232:235], a[112:115]
 v_accvgpr_read_b32 v167, a27
 v_mul_f32 v167, v167, v234
 v_mfma_f32_16x16x32_bf16 a[116:119], v[88:91], a[228:231], 0
 ds_read_b64_tr_b16 v[84:85], v17 offset:27680
 ds_read_b64_tr_b16 v[86:87], v17 offset:32288
 v_mfma_f32_16x16x32_bf16 a[116:119], v[92:95], a[236:239], a[116:119]
 s_waitcnt lgkmcnt(15)
 v_cvt_pk_bf16_f32 v202, v164, v165
 v_cvt_pk_bf16_f32 v203, v166, v167
 v_mfma_f32_16x16x32_bf16 a[120:123], v[48:51], a[224:227], 0
 ds_read_b64_tr_b16 v[88:89], v17 offset:18496
 ds_read_b64_tr_b16 v[90:91], v17 offset:23104
 v_mfma_f32_16x16x32_bf16 a[120:123], v[52:55], a[232:235], a[120:123]
 v_accvgpr_read_b32 v168, a12
 v_mul_f32 v168, v168, v235
 v_mfma_f32_16x16x32_bf16 a[124:127], v[48:51], a[228:231], 0
 ds_read_b64_tr_b16 v[92:93], v17 offset:27712
 ds_read_b64_tr_b16 v[94:95], v17 offset:32320
 v_mfma_f32_16x16x32_bf16 a[124:127], v[52:55], a[236:239], a[124:127]
 s_waitcnt lgkmcnt(15)
 v_accvgpr_read_b32 v169, a13
 v_mul_f32 v169, v169, v235
 v_mfma_f32_16x16x32_bf16 a[128:131], v[56:59], a[224:227], 0
 ds_read_b64_tr_b16 v[48:49], v17 offset:18528
 ds_read_b64_tr_b16 v[50:51], v17 offset:23136
 v_mfma_f32_16x16x32_bf16 a[128:131], v[60:63], a[232:235], a[128:131]
 buffer_store_dwordx4 v[120:123], v3, s[36:39], s55 offen sc1
 v_mfma_f32_16x16x32_bf16 a[132:135], v[56:59], a[228:231], 0
 ds_read_b64_tr_b16 v[52:53], v17 offset:27744
 ds_read_b64_tr_b16 v[54:55], v17 offset:32352
 v_mfma_f32_16x16x32_bf16 a[132:135], v[60:63], a[236:239], a[132:135]
 s_waitcnt lgkmcnt(15)
 v_accvgpr_read_b32 v170, a14
 v_mul_f32 v170, v170, v235
 v_mfma_f32_16x16x32_bf16 a[136:139], v[64:67], a[224:227], 0
 ds_read_b64_tr_b16 v[56:57], v18 offset:18432
 ds_read_b64_tr_b16 v[58:59], v18 offset:23040
 v_mfma_f32_16x16x32_bf16 a[136:139], v[68:71], a[232:235], a[136:139]
 v_accvgpr_read_b32 v171, a15
 v_mul_f32 v171, v171, v235
 v_mfma_f32_16x16x32_bf16 a[140:143], v[64:67], a[228:231], 0
 ds_read_b64_tr_b16 v[60:61], v18 offset:27648
 ds_read_b64_tr_b16 v[62:63], v18 offset:32256
 v_mfma_f32_16x16x32_bf16 a[140:143], v[68:71], a[236:239], a[140:143]
 s_waitcnt vmcnt(45) lgkmcnt(15)
 v_cvt_pk_bf16_f32 v204, v168, v169
 v_cvt_pk_bf16_f32 v205, v170, v171
 v_mfma_f32_16x16x32_bf16 a[72:75], v[72:75], a[240:243], a[72:75]
 s_waitcnt vmcnt(43)
 ds_read_b64_tr_b16 v[64:65], v18 offset:18464
 ds_read_b64_tr_b16 v[66:67], v18 offset:23072
 v_mfma_f32_16x16x32_bf16 a[72:75], v[76:79], a[248:251], a[72:75]
 v_accvgpr_read_b32 v172, a28
 v_mul_f32 v172, v172, v235
 v_mfma_f32_16x16x32_bf16 a[76:79], v[72:75], a[244:247], a[76:79]
 s_waitcnt vmcnt(42)
 ds_read_b64_tr_b16 v[68:69], v18 offset:27680
 ds_read_b64_tr_b16 v[70:71], v18 offset:32288
 v_mfma_f32_16x16x32_bf16 a[76:79], v[76:79], a[252:255], a[76:79]
 s_waitcnt lgkmcnt(15)
 v_accvgpr_read_b32 v173, a29
 v_mul_f32 v173, v173, v235
 v_mfma_f32_16x16x32_bf16 a[80:83], v[80:83], a[240:243], a[80:83]
 ds_read_b64_tr_b16 v[72:73], v18 offset:18496
 ds_read_b64_tr_b16 v[74:75], v18 offset:23104
 v_mfma_f32_16x16x32_bf16 a[80:83], v[84:87], a[248:251], a[80:83]
 v_accvgpr_read_b32 v174, a30
 v_mul_f32 v174, v174, v235
 v_mfma_f32_16x16x32_bf16 a[84:87], v[80:83], a[244:247], a[84:87]
 ds_read_b64_tr_b16 v[76:77], v18 offset:27712
 ds_read_b64_tr_b16 v[78:79], v18 offset:32320
 v_mfma_f32_16x16x32_bf16 a[84:87], v[84:87], a[252:255], a[84:87]
 s_waitcnt lgkmcnt(15)
 buffer_store_dwordx4 v[124:127], v3, s[36:39], s55 offen offset:1024 sc1
 v_mfma_f32_16x16x32_bf16 a[88:91], v[88:91], a[240:243], a[88:91]
 ds_read_b64_tr_b16 v[80:81], v18 offset:18528
 ds_read_b64_tr_b16 v[82:83], v18 offset:23136
 v_mfma_f32_16x16x32_bf16 a[88:91], v[92:95], a[248:251], a[88:91]
 v_accvgpr_read_b32 v175, a31
 v_mul_f32 v175, v175, v235
 v_mfma_f32_16x16x32_bf16 a[92:95], v[88:91], a[244:247], a[92:95]
 ds_read_b64_tr_b16 v[84:85], v18 offset:27744
 ds_read_b64_tr_b16 v[86:87], v18 offset:32352
 v_mfma_f32_16x16x32_bf16 a[92:95], v[92:95], a[252:255], a[92:95]
 s_waitcnt lgkmcnt(15)
 v_cvt_pk_bf16_f32 v206, v172, v173
 v_cvt_pk_bf16_f32 v207, v174, v175
 v_mfma_f32_16x16x32_bf16 a[96:99], v[48:51], a[240:243], a[96:99]
 ds_read_b64_tr_b16 v[88:89], v19 offset:18432
 ds_read_b64_tr_b16 v[90:91], v19 offset:23040
 v_mfma_f32_16x16x32_bf16 a[96:99], v[52:55], a[248:251], a[96:99]
 v_accvgpr_read_b32 v160, a32
 v_mul_f32 v160, v160, v232
 v_mfma_f32_16x16x32_bf16 a[100:103], v[48:51], a[244:247], a[100:103]
 ds_read_b64_tr_b16 v[92:93], v19 offset:27648
 ds_read_b64_tr_b16 v[94:95], v19 offset:32256
 v_mfma_f32_16x16x32_bf16 a[100:103], v[52:55], a[252:255], a[100:103]
 s_waitcnt lgkmcnt(15)
 v_accvgpr_read_b32 v161, a33
 v_mul_f32 v161, v161, v232
 v_mfma_f32_16x16x32_bf16 a[104:107], v[56:59], a[240:243], a[104:107]
 v_accvgpr_read_b32 v162, a34
 v_mul_f32 v162, v162, v232
 v_mfma_f32_16x16x32_bf16 a[104:107], v[60:63], a[248:251], a[104:107]
 v_accvgpr_read_b32 v163, a35
 v_mul_f32 v163, v163, v232
 v_mfma_f32_16x16x32_bf16 a[108:111], v[56:59], a[244:247], a[108:111]
 v_cvt_pk_bf16_f32 v208, v160, v161
 v_cvt_pk_bf16_f32 v209, v162, v163
 v_mfma_f32_16x16x32_bf16 a[108:111], v[60:63], a[252:255], a[108:111]
 s_waitcnt lgkmcnt(14)
 v_accvgpr_read_b32 v164, a48
 v_mul_f32 v164, v164, v232
 v_mfma_f32_16x16x32_bf16 a[112:115], v[64:67], a[240:243], a[112:115]
 s_waitcnt lgkmcnt(12)
 v_accvgpr_read_b32 v165, a49
 v_mul_f32 v165, v165, v232
 v_mfma_f32_16x16x32_bf16 a[112:115], v[68:71], a[248:251], a[112:115]
 s_waitcnt lgkmcnt(0)
 v_accvgpr_read_b32 v166, a50
 v_mul_f32 v166, v166, v232
 v_mfma_f32_16x16x32_bf16 a[116:119], v[64:67], a[244:247], a[116:119]
 s_add_u32 s55, s58, 0
 buffer_store_dwordx4 v[192:195], v2, s[36:39], s55 offen sc1
 v_mfma_f32_16x16x32_bf16 a[116:119], v[68:71], a[252:255], a[116:119]
 s_barrier
 ds_read_b64_tr_b16 v[48:49], v20
 ds_read_b64_tr_b16 v[50:51], v20 offset:4608
 v_mfma_f32_16x16x32_bf16 a[120:123], v[72:75], a[240:243], a[120:123]
 ds_read_b64_tr_b16 v[52:53], v20 offset:9216
 ds_read_b64_tr_b16 v[54:55], v20 offset:13824
 v_mfma_f32_16x16x32_bf16 a[120:123], v[76:79], a[248:251], a[120:123]
 ds_read_b64_tr_b16 v[56:57], v20 offset:32
 ds_read_b64_tr_b16 v[58:59], v20 offset:4640
 v_mfma_f32_16x16x32_bf16 a[124:127], v[72:75], a[244:247], a[124:127]
 ds_read_b64_tr_b16 v[60:61], v20 offset:9248
 ds_read_b64_tr_b16 v[62:63], v20 offset:13856
 v_mfma_f32_16x16x32_bf16 a[124:127], v[76:79], a[252:255], a[124:127]
 ds_read_b64_tr_b16 v[64:65], v20 offset:64
 ds_read_b64_tr_b16 v[66:67], v20 offset:4672
 v_mfma_f32_16x16x32_bf16 a[128:131], v[80:83], a[240:243], a[128:131]
 ds_read_b64_tr_b16 v[68:69], v20 offset:9280
 ds_read_b64_tr_b16 v[70:71], v20 offset:13888
 v_mfma_f32_16x16x32_bf16 a[128:131], v[84:87], a[248:251], a[128:131]
 ds_read_b64_tr_b16 v[72:73], v20 offset:96
 ds_read_b64_tr_b16 v[74:75], v20 offset:4704
 v_mfma_f32_16x16x32_bf16 a[132:135], v[80:83], a[244:247], a[132:135]
 ds_read_b64_tr_b16 v[76:77], v20 offset:9312
 ds_read_b64_tr_b16 v[78:79], v20 offset:13920
 v_mfma_f32_16x16x32_bf16 a[132:135], v[84:87], a[252:255], a[132:135]
 v_accvgpr_read_b32 v167, a51
 v_mul_f32 v167, v167, v232
 v_mfma_f32_16x16x32_bf16 a[136:139], v[88:91], a[240:243], a[136:139]
 ds_read_b64_tr_b16 v[80:81], v21
 ds_read_b64_tr_b16 v[82:83], v21 offset:4608
 v_mfma_f32_16x16x32_bf16 a[136:139], v[92:95], a[248:251], a[136:139]
 v_cvt_pk_bf16_f32 v210, v164, v165
 v_cvt_pk_bf16_f32 v211, v166, v167
 v_mfma_f32_16x16x32_bf16 a[140:143], v[88:91], a[244:247], a[140:143]
 ds_read_b64_tr_b16 v[84:85], v21 offset:9216
 ds_read_b64_tr_b16 v[86:87], v21 offset:13824
 v_mfma_f32_16x16x32_bf16 a[140:143], v[92:95], a[252:255], a[140:143]
 s_waitcnt vmcnt(34) lgkmcnt(15)
 buffer_store_dwordx4 v[196:199], v2, s[36:39], s55 offen offset:1024 sc1
 v_mfma_f32_16x16x32_bf16 a[72:75], v[48:51], a[160:163], a[72:75]
 s_waitcnt vmcnt(32)
 ds_read_b64_tr_b16 v[88:89], v21 offset:32
 ds_read_b64_tr_b16 v[90:91], v21 offset:4640
 v_mfma_f32_16x16x32_bf16 a[72:75], v[52:55], a[168:171], a[72:75]
 s_add_u32 m0, s9, 0
 v_accvgpr_read_b32 v168, a36
 v_mul_f32 v168, v168, v233
 v_mfma_f32_16x16x32_bf16 a[76:79], v[48:51], a[164:167], a[76:79]
 s_add_u32 s40, s52, 0
 buffer_load_dwordx4 v2, s[36:39], s40 offen sc1 lds
 v_mfma_f32_16x16x32_bf16 a[76:79], v[52:55], a[172:175], a[76:79]
 s_waitcnt lgkmcnt(15)
 ds_read_b64_tr_b16 v[92:93], v21 offset:9248
 ds_read_b64_tr_b16 v[94:95], v21 offset:13856
 v_mfma_f32_16x16x32_bf16 a[80:83], v[56:59], a[160:163], a[80:83]
 s_waitcnt lgkmcnt(15)
 ds_read_b64_tr_b16 v[48:49], v21 offset:64
 ds_read_b64_tr_b16 v[50:51], v21 offset:4672
 v_mfma_f32_16x16x32_bf16 a[80:83], v[60:63], a[168:171], a[80:83]
 buffer_load_dwordx4 a[224:227], v4, s[28:31], s53 offen sc1
 v_mfma_f32_16x16x32_bf16 a[84:87], v[56:59], a[164:167], a[84:87]
 ds_read_b64_tr_b16 v[52:53], v21 offset:9280
 ds_read_b64_tr_b16 v[54:55], v21 offset:13888
 v_mfma_f32_16x16x32_bf16 a[84:87], v[60:63], a[172:175], a[84:87]
 s_waitcnt lgkmcnt(15)
 v_accvgpr_read_b32 v169, a37
 v_mul_f32 v169, v169, v233
 v_mfma_f32_16x16x32_bf16 a[88:91], v[64:67], a[160:163], a[88:91]
 ds_read_b64_tr_b16 v[56:57], v21 offset:96
 ds_read_b64_tr_b16 v[58:59], v21 offset:4704
 v_mfma_f32_16x16x32_bf16 a[88:91], v[68:71], a[168:171], a[88:91]
 buffer_load_dwordx4 v2, s[36:39], s40 offen offset:1024 sc1 lds
 v_mfma_f32_16x16x32_bf16 a[92:95], v[64:67], a[164:167], a[92:95]
 ds_read_b64_tr_b16 v[60:61], v21 offset:9312
 ds_read_b64_tr_b16 v[62:63], v21 offset:13920
 v_mfma_f32_16x16x32_bf16 a[92:95], v[68:71], a[172:175], a[92:95]
 s_waitcnt lgkmcnt(15)
 v_accvgpr_read_b32 v170, a38
 v_mul_f32 v170, v170, v233
 v_mfma_f32_16x16x32_bf16 a[96:99], v[72:75], a[160:163], a[96:99]
 ds_read_b64_tr_b16 v[64:65], v22
 ds_read_b64_tr_b16 v[66:67], v22 offset:4608
 v_mfma_f32_16x16x32_bf16 a[96:99], v[76:79], a[168:171], a[96:99]
 buffer_load_dwordx4 a[228:231], v5, s[28:31], s53 offen sc1
 v_mfma_f32_16x16x32_bf16 a[100:103], v[72:75], a[164:167], a[100:103]
 buffer_store_dwordx4 v[200:203], v3, s[36:39], s55 offen sc1
 v_mfma_f32_16x16x32_bf16 a[100:103], v[76:79], a[172:175], a[100:103]
 s_waitcnt lgkmcnt(15)
 ds_read_b64_tr_b16 v[68:69], v22 offset:9216
 ds_read_b64_tr_b16 v[70:71], v22 offset:13824
 v_mfma_f32_16x16x32_bf16 a[104:107], v[80:83], a[160:163], a[104:107]
 s_waitcnt lgkmcnt(15)
 buffer_load_dwordx4 v2, s[36:39], s40 offen offset:2048 sc1 lds
 v_mfma_f32_16x16x32_bf16 a[104:107], v[84:87], a[168:171], a[104:107]
 ds_read_b64_tr_b16 v[72:73], v20 offset:18432
 ds_read_b64_tr_b16 v[74:75], v20 offset:23040
 v_mfma_f32_16x16x32_bf16 a[108:111], v[80:83], a[164:167], a[108:111]
 ds_read_b64_tr_b16 v[76:77], v20 offset:27648
 ds_read_b64_tr_b16 v[78:79], v20 offset:32256
 v_mfma_f32_16x16x32_bf16 a[108:111], v[84:87], a[172:175], a[108:111]
 s_waitcnt lgkmcnt(15)
 v_accvgpr_read_b32 v171, a39
 v_mul_f32 v171, v171, v233
 v_mfma_f32_16x16x32_bf16 a[112:115], v[88:91], a[160:163], a[112:115]
 ds_read_b64_tr_b16 v[80:81], v20 offset:18464
 ds_read_b64_tr_b16 v[82:83], v20 offset:23072
 v_mfma_f32_16x16x32_bf16 a[112:115], v[92:95], a[168:171], a[112:115]
 buffer_load_dwordx4 a[232:235], v4, s[28:31], s53 offen offset:2048 sc1
 v_mfma_f32_16x16x32_bf16 a[116:119], v[88:91], a[164:167], a[116:119]
 ds_read_b64_tr_b16 v[84:85], v20 offset:27680
 ds_read_b64_tr_b16 v[86:87], v20 offset:32288
 v_cvt_pk_bf16_f32 v212, v168, v169
 v_cvt_pk_bf16_f32 v213, v170, v171
 v_accvgpr_read_b32 v172, a52
 v_mul_f32 v172, v172, v233
 v_accvgpr_read_b32 v173, a53
 v_mul_f32 v173, v173, v233
 v_accvgpr_read_b32 v174, a54
 v_mul_f32 v174, v174, v233
 v_accvgpr_read_b32 v175, a55
 v_mul_f32 v175, v175, v233
 v_cvt_pk_bf16_f32 v214, v172, v173
 v_cvt_pk_bf16_f32 v215, v174, v175
 v_mfma_f32_16x16x32_bf16 a[116:119], v[92:95], a[172:175], a[116:119]
 s_waitcnt lgkmcnt(15)
 buffer_load_dwordx4 v2, s[36:39], s40 offen offset:3072 sc1 lds
 v_mfma_f32_16x16x32_bf16 a[120:123], v[48:51], a[160:163], a[120:123]
 ds_read_b64_tr_b16 v[88:89], v20 offset:18496
 ds_read_b64_tr_b16 v[90:91], v20 offset:23104
 v_mfma_f32_16x16x32_bf16 a[120:123], v[52:55], a[168:171], a[120:123]
 v_accvgpr_read_b32 v160, a40
 v_mul_f32 v160, v160, v234
 v_mfma_f32_16x16x32_bf16 a[124:127], v[48:51], a[164:167], a[124:127]
 ds_read_b64_tr_b16 v[92:93], v20 offset:27712
 ds_read_b64_tr_b16 v[94:95], v20 offset:32320
 v_mfma_f32_16x16x32_bf16 a[124:127], v[52:55], a[172:175], a[124:127]
 s_waitcnt lgkmcnt(15)
 buffer_store_dwordx4 v[204:207], v3, s[36:39], s55 offen offset:1024 sc1
 v_mfma_f32_16x16x32_bf16 a[128:131], v[56:59], a[160:163], a[128:131]
 ds_read_b64_tr_b16 v[48:49], v20 offset:18528
 ds_read_b64_tr_b16 v[50:51], v20 offset:23136
 v_mfma_f32_16x16x32_bf16 a[128:131], v[60:63], a[168:171], a[128:131]
 s_add_u32 m0, s9, 0x1000
 buffer_load_dwordx4 a[236:239], v5, s[28:31], s53 offen offset:2048 sc1
 v_mfma_f32_16x16x32_bf16 a[132:135], v[56:59], a[164:167], a[132:135]
 s_add_u32 s40, s52, 0x1000
 buffer_load_dwordx4 v2, s[36:39], s40 offen sc1 lds
 v_mfma_f32_16x16x32_bf16 a[132:135], v[60:63], a[172:175], a[132:135]
 s_waitcnt lgkmcnt(15)
 ds_read_b64_tr_b16 v[52:53], v20 offset:27744
 ds_read_b64_tr_b16 v[54:55], v20 offset:32352
 v_mfma_f32_16x16x32_bf16 a[136:139], v[64:67], a[160:163], a[136:139]
 s_waitcnt lgkmcnt(15)
 ds_read_b64_tr_b16 v[56:57], v21 offset:18432
 ds_read_b64_tr_b16 v[58:59], v21 offset:23040
 v_mfma_f32_16x16x32_bf16 a[136:139], v[68:71], a[168:171], a[136:139]
 v_accvgpr_read_b32 v161, a41
 v_mul_f32 v161, v161, v234
 v_mfma_f32_16x16x32_bf16 a[140:143], v[64:67], a[164:167], a[140:143]
 ds_read_b64_tr_b16 v[60:61], v21 offset:27648
 ds_read_b64_tr_b16 v[62:63], v21 offset:32256
 v_mfma_f32_16x16x32_bf16 a[140:143], v[68:71], a[172:175], a[140:143]
 s_waitcnt vmcnt(40) lgkmcnt(15)
 v_accvgpr_read_b32 v162, a42
 v_mul_f32 v162, v162, v234
 v_mfma_f32_16x16x32_bf16 a[72:75], v[72:75], a[176:179], a[72:75]
 s_add_u32 s53, s53, 0x1000
 ds_read_b64_tr_b16 v[64:65], v21 offset:18464
 ds_read_b64_tr_b16 v[66:67], v21 offset:23072
 v_mfma_f32_16x16x32_bf16 a[72:75], v[76:79], a[184:187], a[72:75]
 buffer_load_dwordx4 v2, s[36:39], s40 offen offset:1024 sc1 lds
 v_mfma_f32_16x16x32_bf16 a[76:79], v[72:75], a[180:183], a[76:79]
 s_waitcnt vmcnt(40)
 buffer_load_dwordx4 a[240:243], v4, s[28:31], s53 offen sc1
 v_mfma_f32_16x16x32_bf16 a[76:79], v[76:79], a[188:191], a[76:79]
 s_waitcnt lgkmcnt(15)
 ds_read_b64_tr_b16 v[68:69], v21 offset:27680
 ds_read_b64_tr_b16 v[70:71], v21 offset:32288
 v_mfma_f32_16x16x32_bf16 a[80:83], v[80:83], a[176:179], a[80:83]
 s_waitcnt lgkmcnt(15)
 ds_read_b64_tr_b16 v[72:73], v21 offset:18496
 ds_read_b64_tr_b16 v[74:75], v21 offset:23104
 v_mfma_f32_16x16x32_bf16 a[80:83], v[84:87], a[184:187], a[80:83]
 s_add_u32 s55, s58, 0x800
 buffer_store_dwordx4 v[208:211], v2, s[36:39], s55 offen sc1
 v_mfma_f32_16x16x32_bf16 a[84:87], v[80:83], a[180:183], a[84:87]
 ds_read_b64_tr_b16 v[76:77], v21 offset:27712
 ds_read_b64_tr_b16 v[78:79], v21 offset:32320
 v_mfma_f32_16x16x32_bf16 a[84:87], v[84:87], a[188:191], a[84:87]
 s_waitcnt lgkmcnt(15)
 buffer_load_dwordx4 v2, s[36:39], s40 offen offset:2048 sc1 lds
 v_mfma_f32_16x16x32_bf16 a[88:91], v[88:91], a[176:179], a[88:91]
 ds_read_b64_tr_b16 v[80:81], v21 offset:18528
 ds_read_b64_tr_b16 v[82:83], v21 offset:23136
 v_accvgpr_read_b32 v163, a43
 v_mul_f32 v163, v163, v234
 v_cvt_pk_bf16_f32 v216, v160, v161
 v_cvt_pk_bf16_f32 v217, v162, v163
 v_accvgpr_read_b32 v164, a56
 v_mul_f32 v164, v164, v234
 v_accvgpr_read_b32 v165, a57
 v_mul_f32 v165, v165, v234
 v_accvgpr_read_b32 v166, a58
 v_mul_f32 v166, v166, v234
 v_accvgpr_read_b32 v167, a59
 v_mul_f32 v167, v167, v234
 v_cvt_pk_bf16_f32 v218, v164, v165
 v_cvt_pk_bf16_f32 v219, v166, v167
 v_mfma_f32_16x16x32_bf16 a[88:91], v[92:95], a[184:187], a[88:91]
 buffer_load_dwordx4 a[244:247], v5, s[28:31], s53 offen sc1
 v_mfma_f32_16x16x32_bf16 a[92:95], v[88:91], a[180:183], a[92:95]
 ds_read_b64_tr_b16 v[84:85], v21 offset:27744
 ds_read_b64_tr_b16 v[86:87], v21 offset:32352
 v_mfma_f32_16x16x32_bf16 a[92:95], v[92:95], a[188:191], a[92:95]
 s_waitcnt lgkmcnt(15)
 v_accvgpr_read_b32 v168, a44
 v_mul_f32 v168, v168, v235
 v_mfma_f32_16x16x32_bf16 a[96:99], v[48:51], a[176:179], a[96:99]
 ds_read_b64_tr_b16 v[88:89], v22 offset:18432
 ds_read_b64_tr_b16 v[90:91], v22 offset:23040
 v_mfma_f32_16x16x32_bf16 a[96:99], v[52:55], a[184:187], a[96:99]
 v_accvgpr_read_b32 v169, a45
 v_mul_f32 v169, v169, v235
 v_mfma_f32_16x16x32_bf16 a[100:103], v[48:51], a[180:183], a[100:103]
 ds_read_b64_tr_b16 v[92:93], v22 offset:27648
 ds_read_b64_tr_b16 v[94:95], v22 offset:32256
 v_mfma_f32_16x16x32_bf16 a[100:103], v[52:55], a[188:191], a[100:103]
 s_waitcnt lgkmcnt(15)
 buffer_load_dwordx4 v2, s[36:39], s40 offen offset:3072 sc1 lds
 v_mfma_f32_16x16x32_bf16 a[104:107], v[56:59], a[176:179], a[104:107]
 buffer_load_dwordx4 a[248:251], v4, s[28:31], s53 offen offset:2048 sc1
 v_mfma_f32_16x16x32_bf16 a[104:107], v[60:63], a[184:187], a[104:107]
 v_accvgpr_read_b32 v170, a46
 v_mul_f32 v170, v170, v235
 v_mfma_f32_16x16x32_bf16 a[108:111], v[56:59], a[180:183], a[108:111]
 v_accvgpr_read_b32 v171, a47
 v_mul_f32 v171, v171, v235
 v_mfma_f32_16x16x32_bf16 a[108:111], v[60:63], a[188:191], a[108:111]
 s_waitcnt lgkmcnt(14)
 buffer_store_dwordx4 v[212:215], v2, s[36:39], s55 offen offset:1024 sc1
 v_mfma_f32_16x16x32_bf16 a[112:115], v[64:67], a[176:179], a[112:115]
 s_waitcnt lgkmcnt(12)
 v_cvt_pk_bf16_f32 v220, v168, v169
 v_cvt_pk_bf16_f32 v221, v170, v171
 v_mfma_f32_16x16x32_bf16 a[112:115], v[68:71], a[184:187], a[112:115]
 s_waitcnt lgkmcnt(0)
 v_accvgpr_read_b32 v172, a60
 v_mul_f32 v172, v172, v235
 v_mfma_f32_16x16x32_bf16 a[116:119], v[64:67], a[180:183], a[116:119]
 s_add_u32 m0, s9, 0x2000
 v_accvgpr_read_b32 v173, a61
 v_mul_f32 v173, v173, v235
 v_mfma_f32_16x16x32_bf16 a[116:119], v[68:71], a[188:191], a[116:119]
 s_add_u32 s40, s52, 0x2000
 s_barrier
 buffer_load_dwordx4 v2, s[36:39], s40 offen sc1 lds
 v_mfma_f32_16x16x32_bf16 a[120:123], v[72:75], a[176:179], a[120:123]
 ds_read_b64_tr_b16 v[48:49], v23
 ds_read_b64_tr_b16 v[50:51], v23 offset:4608
 v_mfma_f32_16x16x32_bf16 a[120:123], v[76:79], a[184:187], a[120:123]
 ds_read_b64_tr_b16 v[52:53], v23 offset:9216
 ds_read_b64_tr_b16 v[54:55], v23 offset:13824
 v_mfma_f32_16x16x32_bf16 a[124:127], v[72:75], a[180:183], a[124:127]
 buffer_load_dwordx4 a[252:255], v5, s[28:31], s53 offen offset:2048 sc1
 v_mfma_f32_16x16x32_bf16 a[124:127], v[76:79], a[188:191], a[124:127]
 ds_read_b64_tr_b16 v[56:57], v23 offset:32
 ds_read_b64_tr_b16 v[58:59], v23 offset:4640
 v_mfma_f32_16x16x32_bf16 a[128:131], v[80:83], a[176:179], a[128:131]
 s_add_u32 s52, s52, 0x9000
 ds_read_b64_tr_b16 v[60:61], v23 offset:9248
 ds_read_b64_tr_b16 v[62:63], v23 offset:13856
 v_mfma_f32_16x16x32_bf16 a[128:131], v[84:87], a[184:187], a[128:131]
 ds_read_b64_tr_b16 v[64:65], v23 offset:64
 ds_read_b64_tr_b16 v[66:67], v23 offset:4672
 v_mfma_f32_16x16x32_bf16 a[132:135], v[80:83], a[180:183], a[132:135]
 ds_read_b64_tr_b16 v[68:69], v23 offset:9280
 ds_read_b64_tr_b16 v[70:71], v23 offset:13888
 v_accvgpr_read_b32 v174, a62
 v_mul_f32 v174, v174, v235
 v_accvgpr_read_b32 v175, a63
 v_mul_f32 v175, v175, v235
 v_cvt_pk_bf16_f32 v222, v172, v173
 v_cvt_pk_bf16_f32 v223, v174, v175
 v_mfma_f32_16x16x32_bf16 a[132:135], v[84:87], a[188:191], a[132:135]
 ds_read_b64_tr_b16 v[72:73], v23 offset:96
 ds_read_b64_tr_b16 v[74:75], v23 offset:4704
 v_mfma_f32_16x16x32_bf16 a[136:139], v[88:91], a[176:179], a[136:139]
 s_add_u32 s53, s53, 0x1000
 ds_read_b64_tr_b16 v[76:77], v23 offset:9312
 ds_read_b64_tr_b16 v[78:79], v23 offset:13920
 v_mfma_f32_16x16x32_bf16 a[136:139], v[92:95], a[184:187], a[136:139]
 ds_read_b64_tr_b16 v[80:81], v24
 ds_read_b64_tr_b16 v[82:83], v24 offset:4608
 v_mfma_f32_16x16x32_bf16 a[140:143], v[88:91], a[180:183], a[140:143]
 buffer_store_dwordx4 v[216:219], v3, s[36:39], s55 offen sc1
 v_mfma_f32_16x16x32_bf16 a[140:143], v[92:95], a[188:191], a[140:143]
 s_waitcnt vmcnt(49) lgkmcnt(15)
 ds_read_b64_tr_b16 v[84:85], v24 offset:9216
 ds_read_b64_tr_b16 v[86:87], v24 offset:13824
 v_mfma_f32_16x16x32_bf16 a[72:75], v[48:51], v[128:131], a[72:75]
 s_waitcnt vmcnt(45) lgkmcnt(15)
 ds_read_b64_tr_b16 v[88:89], v24 offset:32
 ds_read_b64_tr_b16 v[90:91], v24 offset:4640
 v_mfma_f32_16x16x32_bf16 a[72:75], v[52:55], v[136:139], a[72:75]
 s_add_u32 m0, s10, 0
 v_mfma_f32_16x16x32_bf16 a[76:79], v[48:51], v[132:135], a[76:79]
 s_add_u32 s40, s52, 0
 buffer_load_dwordx4 v2, s[36:39], s40 offen sc1 lds
 v_mfma_f32_16x16x32_bf16 a[76:79], v[52:55], v[140:143], a[76:79]
 s_waitcnt lgkmcnt(15)
 ds_read_b64_tr_b16 v[92:93], v24 offset:9248
 ds_read_b64_tr_b16 v[94:95], v24 offset:13856
 v_mfma_f32_16x16x32_bf16 a[80:83], v[56:59], v[128:131], a[80:83]
 s_waitcnt lgkmcnt(15)
 ds_read_b64_tr_b16 v[48:49], v24 offset:64
 ds_read_b64_tr_b16 v[50:51], v24 offset:4672
 v_mfma_f32_16x16x32_bf16 a[80:83], v[60:63], v[136:139], a[80:83]
 buffer_load_dwordx4 a[160:163], v4, s[28:31], s53 offen sc1
 v_mfma_f32_16x16x32_bf16 a[84:87], v[56:59], v[132:135], a[84:87]
 ds_read_b64_tr_b16 v[52:53], v24 offset:9280
 ds_read_b64_tr_b16 v[54:55], v24 offset:13888
 v_mfma_f32_16x16x32_bf16 a[84:87], v[60:63], v[140:143], a[84:87]
 s_waitcnt lgkmcnt(15)
 v_mfma_f32_16x16x32_bf16 a[88:91], v[64:67], v[128:131], a[88:91]
 ds_read_b64_tr_b16 v[56:57], v24 offset:96
 ds_read_b64_tr_b16 v[58:59], v24 offset:4704
 v_mfma_f32_16x16x32_bf16 a[88:91], v[68:71], v[136:139], a[88:91]
 buffer_load_dwordx4 v2, s[36:39], s40 offen offset:1024 sc1 lds
 v_mfma_f32_16x16x32_bf16 a[92:95], v[64:67], v[132:135], a[92:95]
 ds_read_b64_tr_b16 v[60:61], v24 offset:9312
 ds_read_b64_tr_b16 v[62:63], v24 offset:13920
 v_mfma_f32_16x16x32_bf16 a[92:95], v[68:71], v[140:143], a[92:95]
 s_waitcnt lgkmcnt(15)
 buffer_store_dwordx4 v[220:223], v3, s[36:39], s55 offen offset:1024 sc1
 v_mfma_f32_16x16x32_bf16 a[96:99], v[72:75], v[128:131], a[96:99]
 ds_read_b64_tr_b16 v[64:65], v25
 ds_read_b64_tr_b16 v[66:67], v25 offset:4608
 v_mfma_f32_16x16x32_bf16 a[96:99], v[76:79], v[136:139], a[96:99]
 buffer_load_dwordx4 a[164:167], v5, s[28:31], s53 offen sc1
 v_mfma_f32_16x16x32_bf16 a[100:103], v[72:75], v[132:135], a[100:103]
 ds_read_b64_tr_b16 v[68:69], v25 offset:9216
 ds_read_b64_tr_b16 v[70:71], v25 offset:13824
 v_mfma_f32_16x16x32_bf16 a[100:103], v[76:79], v[140:143], a[100:103]
 s_waitcnt lgkmcnt(15)
 buffer_load_dwordx4 v2, s[36:39], s40 offen offset:2048 sc1 lds
 v_mfma_f32_16x16x32_bf16 a[104:107], v[80:83], v[128:131], a[104:107]
 ds_read_b64_tr_b16 v[72:73], v23 offset:18432
 ds_read_b64_tr_b16 v[74:75], v23 offset:23040
 v_mfma_f32_16x16x32_bf16 a[104:107], v[84:87], v[136:139], a[104:107]
 v_mfma_f32_16x16x32_bf16 a[108:111], v[80:83], v[132:135], a[108:111]
 ds_read_b64_tr_b16 v[76:77], v23 offset:27648
 ds_read_b64_tr_b16 v[78:79], v23 offset:32256
 v_mfma_f32_16x16x32_bf16 a[108:111], v[84:87], v[140:143], a[108:111]
 s_waitcnt lgkmcnt(15)
 v_mfma_f32_16x16x32_bf16 a[112:115], v[88:91], v[128:131], a[112:115]
 ds_read_b64_tr_b16 v[80:81], v23 offset:18464
 ds_read_b64_tr_b16 v[82:83], v23 offset:23072
 v_mfma_f32_16x16x32_bf16 a[112:115], v[92:95], v[136:139], a[112:115]
 buffer_load_dwordx4 a[168:171], v4, s[28:31], s53 offen offset:2048 sc1
 v_mfma_f32_16x16x32_bf16 a[116:119], v[88:91], v[132:135], a[116:119]
 ds_read_b64_tr_b16 v[84:85], v23 offset:27680
 ds_read_b64_tr_b16 v[86:87], v23 offset:32288
 v_mfma_f32_16x16x32_bf16 a[116:119], v[92:95], v[140:143], a[116:119]
 s_waitcnt lgkmcnt(15)
 buffer_load_dwordx4 v2, s[36:39], s40 offen offset:3072 sc1 lds
 v_mfma_f32_16x16x32_bf16 a[120:123], v[48:51], v[128:131], a[120:123]
 ds_read_b64_tr_b16 v[88:89], v23 offset:18496
 ds_read_b64_tr_b16 v[90:91], v23 offset:23104
 v_mfma_f32_16x16x32_bf16 a[120:123], v[52:55], v[136:139], a[120:123]
 v_mfma_f32_16x16x32_bf16 a[124:127], v[48:51], v[132:135], a[124:127]
 ds_read_b64_tr_b16 v[92:93], v23 offset:27712
 ds_read_b64_tr_b16 v[94:95], v23 offset:32320
 v_mfma_f32_16x16x32_bf16 a[124:127], v[52:55], v[140:143], a[124:127]
 s_waitcnt lgkmcnt(15)
 v_mfma_f32_16x16x32_bf16 a[128:131], v[56:59], v[128:131], a[128:131]
 ds_read_b64_tr_b16 v[48:49], v23 offset:18528
 ds_read_b64_tr_b16 v[50:51], v23 offset:23136
 v_mfma_f32_16x16x32_bf16 a[128:131], v[60:63], v[136:139], a[128:131]
 s_add_u32 m0, s10, 0x1000
 buffer_load_dwordx4 a[172:175], v5, s[28:31], s53 offen offset:2048 sc1
 v_mfma_f32_16x16x32_bf16 a[132:135], v[56:59], v[132:135], a[132:135]
 s_add_u32 s40, s52, 0x1000
 buffer_load_dwordx4 v2, s[36:39], s40 offen sc1 lds
 v_mfma_f32_16x16x32_bf16 a[132:135], v[60:63], v[140:143], a[132:135]
 s_waitcnt lgkmcnt(15)
 ds_read_b64_tr_b16 v[52:53], v23 offset:27744
 ds_read_b64_tr_b16 v[54:55], v23 offset:32352
 v_mfma_f32_16x16x32_bf16 a[136:139], v[64:67], v[128:131], a[136:139]
 s_waitcnt lgkmcnt(15)
 ds_read_b64_tr_b16 v[56:57], v24 offset:18432
 ds_read_b64_tr_b16 v[58:59], v24 offset:23040
 v_mfma_f32_16x16x32_bf16 a[136:139], v[68:71], v[136:139], a[136:139]
 v_mfma_f32_16x16x32_bf16 a[140:143], v[64:67], v[132:135], a[140:143]
 ds_read_b64_tr_b16 v[60:61], v24 offset:27648
 ds_read_b64_tr_b16 v[62:63], v24 offset:32256
 v_mfma_f32_16x16x32_bf16 a[140:143], v[68:71], v[140:143], a[140:143]
 s_waitcnt vmcnt(52) lgkmcnt(15)
 v_mfma_f32_16x16x32_bf16 a[72:75], v[72:75], v[144:147], a[72:75]
 s_add_u32 s53, s53, 0x1000
 ds_read_b64_tr_b16 v[64:65], v24 offset:18464
 ds_read_b64_tr_b16 v[66:67], v24 offset:23072
 v_mfma_f32_16x16x32_bf16 a[72:75], v[76:79], v[152:155], a[72:75]
 buffer_load_dwordx4 v2, s[36:39], s40 offen offset:1024 sc1 lds
 v_mfma_f32_16x16x32_bf16 a[76:79], v[72:75], v[148:151], a[76:79]
 s_waitcnt vmcnt(52)
 buffer_load_dwordx4 a[176:179], v4, s[28:31], s53 offen sc1
 v_mfma_f32_16x16x32_bf16 a[76:79], v[76:79], v[156:159], a[76:79]
 s_waitcnt lgkmcnt(15)
 ds_read_b64_tr_b16 v[68:69], v24 offset:27680
 ds_read_b64_tr_b16 v[70:71], v24 offset:32288
 v_mfma_f32_16x16x32_bf16 a[80:83], v[80:83], v[144:147], a[80:83]
 s_waitcnt lgkmcnt(15)
 ds_read_b64_tr_b16 v[72:73], v24 offset:18496
 ds_read_b64_tr_b16 v[74:75], v24 offset:23104
 v_mfma_f32_16x16x32_bf16 a[80:83], v[84:87], v[152:155], a[80:83]
 v_mfma_f32_16x16x32_bf16 a[84:87], v[80:83], v[148:151], a[84:87]
 ds_read_b64_tr_b16 v[76:77], v24 offset:27712
 ds_read_b64_tr_b16 v[78:79], v24 offset:32320
 v_mfma_f32_16x16x32_bf16 a[84:87], v[84:87], v[156:159], a[84:87]
 s_waitcnt lgkmcnt(15)
 buffer_load_dwordx4 v2, s[36:39], s40 offen offset:2048 sc1 lds
 v_mfma_f32_16x16x32_bf16 a[88:91], v[88:91], v[144:147], a[88:91]
 ds_read_b64_tr_b16 v[80:81], v24 offset:18528
 ds_read_b64_tr_b16 v[82:83], v24 offset:23136
 v_mfma_f32_16x16x32_bf16 a[88:91], v[92:95], v[152:155], a[88:91]
 buffer_load_dwordx4 a[180:183], v5, s[28:31], s53 offen sc1
 v_mfma_f32_16x16x32_bf16 a[92:95], v[88:91], v[148:151], a[92:95]
 ds_read_b64_tr_b16 v[84:85], v24 offset:27744
 ds_read_b64_tr_b16 v[86:87], v24 offset:32352
 v_mfma_f32_16x16x32_bf16 a[92:95], v[92:95], v[156:159], a[92:95]
 s_waitcnt lgkmcnt(15)
 v_mfma_f32_16x16x32_bf16 a[96:99], v[48:51], v[144:147], a[96:99]
 ds_read_b64_tr_b16 v[88:89], v25 offset:18432
 ds_read_b64_tr_b16 v[90:91], v25 offset:23040
 v_mfma_f32_16x16x32_bf16 a[96:99], v[52:55], v[152:155], a[96:99]
 v_mfma_f32_16x16x32_bf16 a[100:103], v[48:51], v[148:151], a[100:103]
 ds_read_b64_tr_b16 v[92:93], v25 offset:27648
 ds_read_b64_tr_b16 v[94:95], v25 offset:32256
 v_mfma_f32_16x16x32_bf16 a[100:103], v[52:55], v[156:159], a[100:103]
 s_waitcnt lgkmcnt(15)
 buffer_load_dwordx4 v2, s[36:39], s40 offen offset:3072 sc1 lds
 v_mfma_f32_16x16x32_bf16 a[104:107], v[56:59], v[144:147], a[104:107]
 buffer_load_dwordx4 a[184:187], v4, s[28:31], s53 offen offset:2048 sc1
 v_mfma_f32_16x16x32_bf16 a[104:107], v[60:63], v[152:155], a[104:107]
 v_mfma_f32_16x16x32_bf16 a[108:111], v[56:59], v[148:151], a[108:111]
 v_mfma_f32_16x16x32_bf16 a[108:111], v[60:63], v[156:159], a[108:111]
 s_waitcnt vmcnt(12) lgkmcnt(14)
 v_mfma_f32_16x16x32_bf16 a[112:115], v[64:67], v[144:147], a[112:115]
 s_waitcnt lgkmcnt(12)
 v_mfma_f32_16x16x32_bf16 a[112:115], v[68:71], v[152:155], a[112:115]
 s_waitcnt lgkmcnt(0)
 v_mfma_f32_16x16x32_bf16 a[116:119], v[64:67], v[148:151], a[116:119]
 s_add_u32 m0, s10, 0x2000
 v_mfma_f32_16x16x32_bf16 a[116:119], v[68:71], v[156:159], a[116:119]
 s_add_u32 s40, s52, 0x2000
 s_barrier
 buffer_load_dwordx4 v2, s[36:39], s40 offen sc1 lds
 v_mfma_f32_16x16x32_bf16 a[120:123], v[72:75], v[144:147], a[120:123]
 s_cmp_lg_u32 s3, 0
 s_cbranch_scc1 L_sgo1
 s_mov_b64 exec, 1
 buffer_store_dword v253, off, s[36:39], s49 sc1
 s_mov_b64 exec, -1
L_sgo1:
 ds_read_b64_tr_b16 v[48:49], v14
 ds_read_b64_tr_b16 v[50:51], v14 offset:4608
 v_mfma_f32_16x16x32_bf16 a[120:123], v[76:79], v[152:155], a[120:123]
 ds_read_b64_tr_b16 v[52:53], v14 offset:9216
 ds_read_b64_tr_b16 v[54:55], v14 offset:13824
 v_mfma_f32_16x16x32_bf16 a[124:127], v[72:75], v[148:151], a[124:127]
 buffer_load_dwordx4 a[188:191], v5, s[28:31], s53 offen offset:2048 sc1
 v_mfma_f32_16x16x32_bf16 a[124:127], v[76:79], v[156:159], a[124:127]
 ds_read_b64_tr_b16 v[56:57], v14 offset:32
 ds_read_b64_tr_b16 v[58:59], v14 offset:4640
 v_mfma_f32_16x16x32_bf16 a[128:131], v[80:83], v[144:147], a[128:131]
 s_add_u32 s52, s52, 0x9000
 ds_read_b64_tr_b16 v[60:61], v14 offset:9248
 ds_read_b64_tr_b16 v[62:63], v14 offset:13856
 v_mfma_f32_16x16x32_bf16 a[128:131], v[84:87], v[152:155], a[128:131]
 ds_read_b64_tr_b16 v[64:65], v14 offset:64
 ds_read_b64_tr_b16 v[66:67], v14 offset:4672
 v_mfma_f32_16x16x32_bf16 a[132:135], v[80:83], v[148:151], a[132:135]
 ds_read_b64_tr_b16 v[68:69], v14 offset:9280
 ds_read_b64_tr_b16 v[70:71], v14 offset:13888
 v_mfma_f32_16x16x32_bf16 a[132:135], v[84:87], v[156:159], a[132:135]
 ds_read_b64_tr_b16 v[72:73], v14 offset:96
 ds_read_b64_tr_b16 v[74:75], v14 offset:4704
 v_mfma_f32_16x16x32_bf16 a[136:139], v[88:91], v[144:147], a[136:139]
 s_add_u32 s53, s53, 0x1000
 ds_read_b64_tr_b16 v[76:77], v14 offset:9312
 ds_read_b64_tr_b16 v[78:79], v14 offset:13920
 v_mfma_f32_16x16x32_bf16 a[136:139], v[92:95], v[152:155], a[136:139]
 ds_read_b64_tr_b16 v[80:81], v15
 ds_read_b64_tr_b16 v[82:83], v15 offset:4608
 v_mfma_f32_16x16x32_bf16 a[140:143], v[88:91], v[148:151], a[140:143]
 ds_read_b64_tr_b16 v[84:85], v15 offset:9216
 ds_read_b64_tr_b16 v[86:87], v15 offset:13824
 v_mfma_f32_16x16x32_bf16 a[140:143], v[92:95], v[156:159], a[140:143]
 s_cmp_eq_u32 s68, 0
 s_cbranch_scc1 L_R
 s_branch L_B0
L_P3:
 ds_read_b64_tr_b16 v[48:49], v23
 ds_read_b64_tr_b16 v[50:51], v23 offset:4608
 ds_read_b64_tr_b16 v[52:53], v23 offset:9216
 ds_read_b64_tr_b16 v[54:55], v23 offset:13824
 ds_read_b64_tr_b16 v[56:57], v23 offset:32
 ds_read_b64_tr_b16 v[58:59], v23 offset:4640
 ds_read_b64_tr_b16 v[60:61], v23 offset:9248
 ds_read_b64_tr_b16 v[62:63], v23 offset:13856
 ds_read_b64_tr_b16 v[64:65], v23 offset:64
 ds_read_b64_tr_b16 v[66:67], v23 offset:4672
 ds_read_b64_tr_b16 v[68:69], v23 offset:9280
 ds_read_b64_tr_b16 v[70:71], v23 offset:13888
 ds_read_b64_tr_b16 v[72:73], v23 offset:96
 ds_read_b64_tr_b16 v[74:75], v23 offset:4704
 ds_read_b64_tr_b16 v[76:77], v23 offset:9312
 ds_read_b64_tr_b16 v[78:79], v23 offset:13920
 ds_read_b64_tr_b16 v[80:81], v24
 ds_read_b64_tr_b16 v[82:83], v24 offset:4608
 ds_read_b64_tr_b16 v[84:85], v24 offset:9216
 ds_read_b64_tr_b16 v[86:87], v24 offset:13824
 s_waitcnt vmcnt(21) lgkmcnt(15)
 v_mfma_f32_16x16x32_bf16 a[72:75], v[48:51], v[128:131], 0
 s_waitcnt vmcnt(17)
 ds_read_b64_tr_b16 v[88:89], v24 offset:32
 ds_read_b64_tr_b16 v[90:91], v24 offset:4640
 v_mfma_f32_16x16x32_bf16 a[72:75], v[52:55], v[136:139], a[72:75]
 s_add_u32 s55, s58, 0x1800
 buffer_store_dwordx4 v[112:115], v2, s[36:39], s55 offen sc1
 v_mfma_f32_16x16x32_bf16 a[76:79], v[48:51], v[132:135], 0
 s_lshl_b32 s49, s17, 7
 ds_read_b64_tr_b16 v[92:93], v24 offset:9248
 ds_read_b64_tr_b16 v[94:95], v24 offset:13856
 v_mfma_f32_16x16x32_bf16 a[76:79], v[52:55], v[140:143], a[76:79]
 s_waitcnt lgkmcnt(15)
 s_lshl_b32 s62, s16, 2
 v_accvgpr_read_b32 v160, a8
 v_mul_f32 v160, v160, v234
 v_mfma_f32_16x16x32_bf16 a[80:83], v[56:59], v[128:131], 0
 s_add_u32 s49, s49, s62
 ds_read_b64_tr_b16 v[48:49], v24 offset:64
 ds_read_b64_tr_b16 v[50:51], v24 offset:4672
 v_mfma_f32_16x16x32_bf16 a[80:83], v[60:63], v[136:139], a[80:83]
 s_add_u32 s49, s49, 0x300800
 v_accvgpr_read_b32 v161, a9
 v_mul_f32 v161, v161, v234
 v_mfma_f32_16x16x32_bf16 a[84:87], v[56:59], v[132:135], 0
 s_lshl_b32 s50, s17, 7
 ds_read_b64_tr_b16 v[52:53], v24 offset:9280
 ds_read_b64_tr_b16 v[54:55], v24 offset:13888
 v_mfma_f32_16x16x32_bf16 a[84:87], v[60:63], v[140:143], a[84:87]
 s_waitcnt lgkmcnt(15)
 s_lshl_b32 s62, s70, 5
 v_accvgpr_read_b32 v162, a10
 v_mul_f32 v162, v162, v234
 v_mfma_f32_16x16x32_bf16 a[88:91], v[64:67], v[128:131], 0
 s_add_u32 s50, s50, s62
 ds_read_b64_tr_b16 v[56:57], v24 offset:96
 ds_read_b64_tr_b16 v[58:59], v24 offset:4704
 v_mfma_f32_16x16x32_bf16 a[88:91], v[68:71], v[136:139], a[88:91]
 s_add_u32 s50, s50, 0x300800
 v_accvgpr_read_b32 v163, a11
 v_mul_f32 v163, v163, v234
 v_mfma_f32_16x16x32_bf16 a[92:95], v[64:67], v[132:135], 0
 ds_read_b64_tr_b16 v[60:61], v24 offset:9312
 ds_read_b64_tr_b16 v[62:63], v24 offset:13920
 v_mfma_f32_16x16x32_bf16 a[92:95], v[68:71], v[140:143], a[92:95]
 s_waitcnt lgkmcnt(15)
 v_cvt_pk_bf16_f32 v200, v160, v161
 v_cvt_pk_bf16_f32 v201, v162, v163
 v_mfma_f32_16x16x32_bf16 a[96:99], v[72:75], v[128:131], 0
 ds_read_b64_tr_b16 v[64:65], v25
 ds_read_b64_tr_b16 v[66:67], v25 offset:4608
 v_mfma_f32_16x16x32_bf16 a[96:99], v[76:79], v[136:139], a[96:99]
 v_accvgpr_read_b32 v164, a24
 v_mul_f32 v164, v164, v234
 v_mfma_f32_16x16x32_bf16 a[100:103], v[72:75], v[132:135], 0
 ds_read_b64_tr_b16 v[68:69], v25 offset:9216
 ds_read_b64_tr_b16 v[70:71], v25 offset:13824
 v_mfma_f32_16x16x32_bf16 a[100:103], v[76:79], v[140:143], a[100:103]
 s_waitcnt lgkmcnt(15)
 buffer_store_dwordx4 v[116:119], v2, s[36:39], s55 offen offset:1024 sc1
 v_mfma_f32_16x16x32_bf16 a[104:107], v[80:83], v[128:131], 0
 ds_read_b64_tr_b16 v[72:73], v23 offset:18432
 ds_read_b64_tr_b16 v[74:75], v23 offset:23040
 v_mfma_f32_16x16x32_bf16 a[104:107], v[84:87], v[136:139], a[104:107]
 v_accvgpr_read_b32 v165, a25
 v_mul_f32 v165, v165, v234
 v_mfma_f32_16x16x32_bf16 a[108:111], v[80:83], v[132:135], 0
 ds_read_b64_tr_b16 v[76:77], v23 offset:27648
 ds_read_b64_tr_b16 v[78:79], v23 offset:32256
 v_mfma_f32_16x16x32_bf16 a[108:111], v[84:87], v[140:143], a[108:111]
 s_waitcnt lgkmcnt(15)
 v_accvgpr_read_b32 v166, a26
 v_mul_f32 v166, v166, v234
 v_mfma_f32_16x16x32_bf16 a[112:115], v[88:91], v[128:131], 0
 ds_read_b64_tr_b16 v[80:81], v23 offset:18464
 ds_read_b64_tr_b16 v[82:83], v23 offset:23072
 v_mfma_f32_16x16x32_bf16 a[112:115], v[92:95], v[136:139], a[112:115]
 v_accvgpr_read_b32 v167, a27
 v_mul_f32 v167, v167, v234
 v_mfma_f32_16x16x32_bf16 a[116:119], v[88:91], v[132:135], 0
 ds_read_b64_tr_b16 v[84:85], v23 offset:27680
 ds_read_b64_tr_b16 v[86:87], v23 offset:32288
 v_mfma_f32_16x16x32_bf16 a[116:119], v[92:95], v[140:143], a[116:119]
 s_waitcnt lgkmcnt(15)
 v_cvt_pk_bf16_f32 v202, v164, v165
 v_cvt_pk_bf16_f32 v203, v166, v167
 v_mfma_f32_16x16x32_bf16 a[120:123], v[48:51], v[128:131], 0
 ds_read_b64_tr_b16 v[88:89], v23 offset:18496
 ds_read_b64_tr_b16 v[90:91], v23 offset:23104
 v_mfma_f32_16x16x32_bf16 a[120:123], v[52:55], v[136:139], a[120:123]
 v_accvgpr_read_b32 v168, a12
 v_mul_f32 v168, v168, v235
 v_mfma_f32_16x16x32_bf16 a[124:127], v[48:51], v[132:135], 0
 ds_read_b64_tr_b16 v[92:93], v23 offset:27712
 ds_read_b64_tr_b16 v[94:95], v23 offset:32320
 v_mfma_f32_16x16x32_bf16 a[124:127], v[52:55], v[140:143], a[124:127]
 s_waitcnt lgkmcnt(15)
 v_accvgpr_read_b32 v169, a13
 v_mul_f32 v169, v169, v235
 v_mfma_f32_16x16x32_bf16 a[128:131], v[56:59], v[128:131], 0
 ds_read_b64_tr_b16 v[48:49], v23 offset:18528
 ds_read_b64_tr_b16 v[50:51], v23 offset:23136
 v_mfma_f32_16x16x32_bf16 a[128:131], v[60:63], v[136:139], a[128:131]
 buffer_store_dwordx4 v[120:123], v3, s[36:39], s55 offen sc1
 v_mfma_f32_16x16x32_bf16 a[132:135], v[56:59], v[132:135], 0
 ds_read_b64_tr_b16 v[52:53], v23 offset:27744
 ds_read_b64_tr_b16 v[54:55], v23 offset:32352
 v_mfma_f32_16x16x32_bf16 a[132:135], v[60:63], v[140:143], a[132:135]
 s_waitcnt lgkmcnt(15)
 v_accvgpr_read_b32 v170, a14
 v_mul_f32 v170, v170, v235
 v_mfma_f32_16x16x32_bf16 a[136:139], v[64:67], v[128:131], 0
 ds_read_b64_tr_b16 v[56:57], v24 offset:18432
 ds_read_b64_tr_b16 v[58:59], v24 offset:23040
 v_mfma_f32_16x16x32_bf16 a[136:139], v[68:71], v[136:139], a[136:139]
 v_accvgpr_read_b32 v171, a15
 v_mul_f32 v171, v171, v235
 v_mfma_f32_16x16x32_bf16 a[140:143], v[64:67], v[132:135], 0
 ds_read_b64_tr_b16 v[60:61], v24 offset:27648
 ds_read_b64_tr_b16 v[62:63], v24 offset:32256
 v_mfma_f32_16x16x32_bf16 a[140:143], v[68:71], v[140:143], a[140:143]
 s_waitcnt vmcnt(19) lgkmcnt(15)
 v_cvt_pk_bf16_f32 v204, v168, v169
 v_cvt_pk_bf16_f32 v205, v170, v171
 v_mfma_f32_16x16x32_bf16 a[72:75], v[72:75], v[144:147], a[72:75]
 s_waitcnt vmcnt(17)
 ds_read_b64_tr_b16 v[64:65], v24 offset:18464
 ds_read_b64_tr_b16 v[66:67], v24 offset:23072
 v_mfma_f32_16x16x32_bf16 a[72:75], v[76:79], v[152:155], a[72:75]
 v_accvgpr_read_b32 v172, a28
 v_mul_f32 v172, v172, v235
 v_mfma_f32_16x16x32_bf16 a[76:79], v[72:75], v[148:151], a[76:79]
 s_waitcnt vmcnt(16)
 ds_read_b64_tr_b16 v[68:69], v24 offset:27680
 ds_read_b64_tr_b16 v[70:71], v24 offset:32288
 v_mfma_f32_16x16x32_bf16 a[76:79], v[76:79], v[156:159], a[76:79]
 s_waitcnt lgkmcnt(15)
 v_accvgpr_read_b32 v173, a29
 v_mul_f32 v173, v173, v235
 v_mfma_f32_16x16x32_bf16 a[80:83], v[80:83], v[144:147], a[80:83]
 ds_read_b64_tr_b16 v[72:73], v24 offset:18496
 ds_read_b64_tr_b16 v[74:75], v24 offset:23104
 v_mfma_f32_16x16x32_bf16 a[80:83], v[84:87], v[152:155], a[80:83]
 v_accvgpr_read_b32 v174, a30
 v_mul_f32 v174, v174, v235
 v_mfma_f32_16x16x32_bf16 a[84:87], v[80:83], v[148:151], a[84:87]
 ds_read_b64_tr_b16 v[76:77], v24 offset:27712
 ds_read_b64_tr_b16 v[78:79], v24 offset:32320
 v_mfma_f32_16x16x32_bf16 a[84:87], v[84:87], v[156:159], a[84:87]
 s_waitcnt lgkmcnt(15)
 buffer_store_dwordx4 v[124:127], v3, s[36:39], s55 offen offset:1024 sc1
 v_mfma_f32_16x16x32_bf16 a[88:91], v[88:91], v[144:147], a[88:91]
 ds_read_b64_tr_b16 v[80:81], v24 offset:18528
 ds_read_b64_tr_b16 v[82:83], v24 offset:23136
 v_mfma_f32_16x16x32_bf16 a[88:91], v[92:95], v[152:155], a[88:91]
 v_accvgpr_read_b32 v175, a31
 v_mul_f32 v175, v175, v235
 v_mfma_f32_16x16x32_bf16 a[92:95], v[88:91], v[148:151], a[92:95]
 ds_read_b64_tr_b16 v[84:85], v24 offset:27744
 ds_read_b64_tr_b16 v[86:87], v24 offset:32352
 v_mfma_f32_16x16x32_bf16 a[92:95], v[92:95], v[156:159], a[92:95]
 s_waitcnt lgkmcnt(15)
 v_cvt_pk_bf16_f32 v206, v172, v173
 v_cvt_pk_bf16_f32 v207, v174, v175
 v_mfma_f32_16x16x32_bf16 a[96:99], v[48:51], v[144:147], a[96:99]
 ds_read_b64_tr_b16 v[88:89], v25 offset:18432
 ds_read_b64_tr_b16 v[90:91], v25 offset:23040
 v_mfma_f32_16x16x32_bf16 a[96:99], v[52:55], v[152:155], a[96:99]
 v_accvgpr_read_b32 v160, a32
 v_mul_f32 v160, v160, v232
 v_mfma_f32_16x16x32_bf16 a[100:103], v[48:51], v[148:151], a[100:103]
 ds_read_b64_tr_b16 v[92:93], v25 offset:27648
 ds_read_b64_tr_b16 v[94:95], v25 offset:32256
 v_mfma_f32_16x16x32_bf16 a[100:103], v[52:55], v[156:159], a[100:103]
 s_waitcnt lgkmcnt(15)
 v_accvgpr_read_b32 v161, a33
 v_mul_f32 v161, v161, v232
 v_mfma_f32_16x16x32_bf16 a[104:107], v[56:59], v[144:147], a[104:107]
 v_accvgpr_read_b32 v162, a34
 v_mul_f32 v162, v162, v232
 v_mfma_f32_16x16x32_bf16 a[104:107], v[60:63], v[152:155], a[104:107]
 v_accvgpr_read_b32 v163, a35
 v_mul_f32 v163, v163, v232
 v_mfma_f32_16x16x32_bf16 a[108:111], v[56:59], v[148:151], a[108:111]
 v_cvt_pk_bf16_f32 v208, v160, v161
 v_cvt_pk_bf16_f32 v209, v162, v163
 v_mfma_f32_16x16x32_bf16 a[108:111], v[60:63], v[156:159], a[108:111]
 s_waitcnt lgkmcnt(14)
 v_accvgpr_read_b32 v164, a48
 v_mul_f32 v164, v164, v232
 v_mfma_f32_16x16x32_bf16 a[112:115], v[64:67], v[144:147], a[112:115]
 s_waitcnt lgkmcnt(12)
 v_accvgpr_read_b32 v165, a49
 v_mul_f32 v165, v165, v232
 v_mfma_f32_16x16x32_bf16 a[112:115], v[68:71], v[152:155], a[112:115]
 s_waitcnt lgkmcnt(0)
 v_accvgpr_read_b32 v166, a50
 v_mul_f32 v166, v166, v232
 v_mfma_f32_16x16x32_bf16 a[116:119], v[64:67], v[148:151], a[116:119]
 s_add_u32 s55, s58, 0
 buffer_store_dwordx4 v[192:195], v2, s[36:39], s55 offen sc1
 v_mfma_f32_16x16x32_bf16 a[116:119], v[68:71], v[156:159], a[116:119]
 s_barrier
 ds_read_b64_tr_b16 v[48:49], v14
 ds_read_b64_tr_b16 v[50:51], v14 offset:4608
 v_mfma_f32_16x16x32_bf16 a[120:123], v[72:75], v[144:147], a[120:123]
 ds_read_b64_tr_b16 v[52:53], v14 offset:9216
 ds_read_b64_tr_b16 v[54:55], v14 offset:13824
 v_mfma_f32_16x16x32_bf16 a[120:123], v[76:79], v[152:155], a[120:123]
 ds_read_b64_tr_b16 v[56:57], v14 offset:32
 ds_read_b64_tr_b16 v[58:59], v14 offset:4640
 v_mfma_f32_16x16x32_bf16 a[124:127], v[72:75], v[148:151], a[124:127]
 ds_read_b64_tr_b16 v[60:61], v14 offset:9248
 ds_read_b64_tr_b16 v[62:63], v14 offset:13856
 v_mfma_f32_16x16x32_bf16 a[124:127], v[76:79], v[156:159], a[124:127]
 ds_read_b64_tr_b16 v[64:65], v14 offset:64
 ds_read_b64_tr_b16 v[66:67], v14 offset:4672
 v_mfma_f32_16x16x32_bf16 a[128:131], v[80:83], v[144:147], a[128:131]
 ds_read_b64_tr_b16 v[68:69], v14 offset:9280
 ds_read_b64_tr_b16 v[70:71], v14 offset:13888
 v_mfma_f32_16x16x32_bf16 a[128:131], v[84:87], v[152:155], a[128:131]
 ds_read_b64_tr_b16 v[72:73], v14 offset:96
 ds_read_b64_tr_b16 v[74:75], v14 offset:4704
 v_mfma_f32_16x16x32_bf16 a[132:135], v[80:83], v[148:151], a[132:135]
 ds_read_b64_tr_b16 v[76:77], v14 offset:9312
 ds_read_b64_tr_b16 v[78:79], v14 offset:13920
 v_mfma_f32_16x16x32_bf16 a[132:135], v[84:87], v[156:159], a[132:135]
 v_accvgpr_read_b32 v167, a51
 v_mul_f32 v167, v167, v232
 v_mfma_f32_16x16x32_bf16 a[136:139], v[88:91], v[144:147], a[136:139]
 ds_read_b64_tr_b16 v[80:81], v15
 ds_read_b64_tr_b16 v[82:83], v15 offset:4608
 v_mfma_f32_16x16x32_bf16 a[136:139], v[92:95], v[152:155], a[136:139]
 v_cvt_pk_bf16_f32 v210, v164, v165
 v_cvt_pk_bf16_f32 v211, v166, v167
 v_mfma_f32_16x16x32_bf16 a[140:143], v[88:91], v[148:151], a[140:143]
 ds_read_b64_tr_b16 v[84:85], v15 offset:9216
 ds_read_b64_tr_b16 v[86:87], v15 offset:13824
 v_mfma_f32_16x16x32_bf16 a[140:143], v[92:95], v[156:159], a[140:143]
 s_waitcnt lgkmcnt(15)
 buffer_store_dwordx4 v[196:199], v2, s[36:39], s55 offen offset:1024 sc1
 v_mfma_f32_16x16x32_bf16 a[72:75], v[48:51], a[192:195], a[72:75]
 ds_read_b64_tr_b16 v[88:89], v15 offset:32
 ds_read_b64_tr_b16 v[90:91], v15 offset:4640
 v_mfma_f32_16x16x32_bf16 a[72:75], v[52:55], a[200:203], a[72:75]
 s_add_u32 m0, s11, 0
 v_accvgpr_read_b32 v168, a36
 v_mul_f32 v168, v168, v233
 v_mfma_f32_16x16x32_bf16 a[76:79], v[48:51], a[196:199], a[76:79]
 s_add_u32 s40, s52, 0
 buffer_load_dwordx4 v2, s[36:39], s40 offen sc1 lds
 v_mfma_f32_16x16x32_bf16 a[76:79], v[52:55], a[204:207], a[76:79]
 s_waitcnt lgkmcnt(15)
 ds_read_b64_tr_b16 v[92:93], v15 offset:9248
 ds_read_b64_tr_b16 v[94:95], v15 offset:13856
 v_mfma_f32_16x16x32_bf16 a[80:83], v[56:59], a[192:195], a[80:83]
 s_waitcnt lgkmcnt(15)
 ds_read_b64_tr_b16 v[48:49], v15 offset:64
 ds_read_b64_tr_b16 v[50:51], v15 offset:4672
 v_mfma_f32_16x16x32_bf16 a[80:83], v[60:63], a[200:203], a[80:83]
 buffer_load_dwordx4 v[128:131], v4, s[28:31], s53 offen sc1
 v_mfma_f32_16x16x32_bf16 a[84:87], v[56:59], a[196:199], a[84:87]
 ds_read_b64_tr_b16 v[52:53], v15 offset:9280
 ds_read_b64_tr_b16 v[54:55], v15 offset:13888
 v_mfma_f32_16x16x32_bf16 a[84:87], v[60:63], a[204:207], a[84:87]
 s_waitcnt lgkmcnt(15)
 v_accvgpr_read_b32 v169, a37
 v_mul_f32 v169, v169, v233
 v_mfma_f32_16x16x32_bf16 a[88:91], v[64:67], a[192:195], a[88:91]
 ds_read_b64_tr_b16 v[56:57], v15 offset:96
 ds_read_b64_tr_b16 v[58:59], v15 offset:4704
 v_mfma_f32_16x16x32_bf16 a[88:91], v[68:71], a[200:203], a[88:91]
 buffer_load_dwordx4 v2, s[36:39], s40 offen offset:1024 sc1 lds
 v_mfma_f32_16x16x32_bf16 a[92:95], v[64:67], a[196:199], a[92:95]
 ds_read_b64_tr_b16 v[60:61], v15 offset:9312
 ds_read_b64_tr_b16 v[62:63], v15 offset:13920
 v_mfma_f32_16x16x32_bf16 a[92:95], v[68:71], a[204:207], a[92:95]
 s_waitcnt lgkmcnt(15)
 v_accvgpr_read_b32 v170, a38
 v_mul_f32 v170, v170, v233
 v_mfma_f32_16x16x32_bf16 a[96:99], v[72:75], a[192:195], a[96:99]
 ds_read_b64_tr_b16 v[64:65], v16
 ds_read_b64_tr_b16 v[66:67], v16 offset:4608
 v_mfma_f32_16x16x32_bf16 a[96:99], v[76:79], a[200:203], a[96:99]
 buffer_load_dwordx4 v[132:135], v5, s[28:31], s53 offen sc1
 v_mfma_f32_16x16x32_bf16 a[100:103], v[72:75], a[196:199], a[100:103]
 buffer_store_dwordx4 v[200:203], v3, s[36:39], s55 offen sc1
 v_mfma_f32_16x16x32_bf16 a[100:103], v[76:79], a[204:207], a[100:103]
 s_waitcnt lgkmcnt(15)
 ds_read_b64_tr_b16 v[68:69], v16 offset:9216
 ds_read_b64_tr_b16 v[70:71], v16 offset:13824
 v_mfma_f32_16x16x32_bf16 a[104:107], v[80:83], a[192:195], a[104:107]
 s_waitcnt lgkmcnt(15)
 buffer_load_dwordx4 v2, s[36:39], s40 offen offset:2048 sc1 lds
 v_mfma_f32_16x16x32_bf16 a[104:107], v[84:87], a[200:203], a[104:107]
 ds_read_b64_tr_b16 v[72:73], v14 offset:18432
 ds_read_b64_tr_b16 v[74:75], v14 offset:23040
 v_mfma_f32_16x16x32_bf16 a[108:111], v[80:83], a[196:199], a[108:111]
 ds_read_b64_tr_b16 v[76:77], v14 offset:27648
 ds_read_b64_tr_b16 v[78:79], v14 offset:32256
 v_mfma_f32_16x16x32_bf16 a[108:111], v[84:87], a[204:207], a[108:111]
 s_waitcnt lgkmcnt(15)
 v_accvgpr_read_b32 v171, a39
 v_mul_f32 v171, v171, v233
 v_mfma_f32_16x16x32_bf16 a[112:115], v[88:91], a[192:195], a[112:115]
 ds_read_b64_tr_b16 v[80:81], v14 offset:18464
 ds_read_b64_tr_b16 v[82:83], v14 offset:23072
 v_mfma_f32_16x16x32_bf16 a[112:115], v[92:95], a[200:203], a[112:115]
 buffer_load_dwordx4 v[136:139], v4, s[28:31], s53 offen offset:2048 sc1
 v_mfma_f32_16x16x32_bf16 a[116:119], v[88:91], a[196:199], a[116:119]
 ds_read_b64_tr_b16 v[84:85], v14 offset:27680
 ds_read_b64_tr_b16 v[86:87], v14 offset:32288
 v_cvt_pk_bf16_f32 v212, v168, v169
 v_cvt_pk_bf16_f32 v213, v170, v171
 v_accvgpr_read_b32 v172, a52
 v_mul_f32 v172, v172, v233
 v_accvgpr_read_b32 v173, a53
 v_mul_f32 v173, v173, v233
 v_accvgpr_read_b32 v174, a54
 v_mul_f32 v174, v174, v233
 v_accvgpr_read_b32 v175, a55
 v_mul_f32 v175, v175, v233
 v_cvt_pk_bf16_f32 v214, v172, v173
 v_cvt_pk_bf16_f32 v215, v174, v175
 v_mfma_f32_16x16x32_bf16 a[116:119], v[92:95], a[204:207], a[116:119]
 s_waitcnt lgkmcnt(15)
 buffer_load_dwordx4 v2, s[36:39], s40 offen offset:3072 sc1 lds
 v_mfma_f32_16x16x32_bf16 a[120:123], v[48:51], a[192:195], a[120:123]
 ds_read_b64_tr_b16 v[88:89], v14 offset:18496
 ds_read_b64_tr_b16 v[90:91], v14 offset:23104
 v_mfma_f32_16x16x32_bf16 a[120:123], v[52:55], a[200:203], a[120:123]
 v_accvgpr_read_b32 v160, a40
 v_mul_f32 v160, v160, v234
 v_mfma_f32_16x16x32_bf16 a[124:127], v[48:51], a[196:199], a[124:127]
 ds_read_b64_tr_b16 v[92:93], v14 offset:27712
 ds_read_b64_tr_b16 v[94:95], v14 offset:32320
 v_mfma_f32_16x16x32_bf16 a[124:127], v[52:55], a[204:207], a[124:127]
 s_waitcnt lgkmcnt(15)
 buffer_store_dwordx4 v[204:207], v3, s[36:39], s55 offen offset:1024 sc1
 v_mfma_f32_16x16x32_bf16 a[128:131], v[56:59], a[192:195], a[128:131]
 ds_read_b64_tr_b16 v[48:49], v14 offset:18528
 ds_read_b64_tr_b16 v[50:51], v14 offset:23136
 v_mfma_f32_16x16x32_bf16 a[128:131], v[60:63], a[200:203], a[128:131]
 s_add_u32 m0, s11, 0x1000
 buffer_load_dwordx4 v[140:143], v5, s[28:31], s53 offen offset:2048 sc1
 v_mfma_f32_16x16x32_bf16 a[132:135], v[56:59], a[196:199], a[132:135]
 s_add_u32 s40, s52, 0x1000
 buffer_load_dwordx4 v2, s[36:39], s40 offen sc1 lds
 v_mfma_f32_16x16x32_bf16 a[132:135], v[60:63], a[204:207], a[132:135]
 s_waitcnt lgkmcnt(15)
 ds_read_b64_tr_b16 v[52:53], v14 offset:27744
 ds_read_b64_tr_b16 v[54:55], v14 offset:32352
 v_mfma_f32_16x16x32_bf16 a[136:139], v[64:67], a[192:195], a[136:139]
 s_waitcnt lgkmcnt(15)
 ds_read_b64_tr_b16 v[56:57], v15 offset:18432
 ds_read_b64_tr_b16 v[58:59], v15 offset:23040
 v_mfma_f32_16x16x32_bf16 a[136:139], v[68:71], a[200:203], a[136:139]
 v_accvgpr_read_b32 v161, a41
 v_mul_f32 v161, v161, v234
 v_mfma_f32_16x16x32_bf16 a[140:143], v[64:67], a[196:199], a[140:143]
 ds_read_b64_tr_b16 v[60:61], v15 offset:27648
 ds_read_b64_tr_b16 v[62:63], v15 offset:32256
 v_mfma_f32_16x16x32_bf16 a[140:143], v[68:71], a[204:207], a[140:143]
 s_waitcnt lgkmcnt(15)
 v_accvgpr_read_b32 v162, a42
 v_mul_f32 v162, v162, v234
 v_mfma_f32_16x16x32_bf16 a[72:75], v[72:75], a[208:211], a[72:75]
 s_add_u32 s53, s53, 0x1000
 ds_read_b64_tr_b16 v[64:65], v15 offset:18464
 ds_read_b64_tr_b16 v[66:67], v15 offset:23072
 v_mfma_f32_16x16x32_bf16 a[72:75], v[76:79], a[216:219], a[72:75]
 buffer_load_dwordx4 v2, s[36:39], s40 offen offset:1024 sc1 lds
 v_mfma_f32_16x16x32_bf16 a[76:79], v[72:75], a[212:215], a[76:79]
 buffer_load_dwordx4 v[144:147], v4, s[28:31], s53 offen sc1
 v_mfma_f32_16x16x32_bf16 a[76:79], v[76:79], a[220:223], a[76:79]
 s_waitcnt lgkmcnt(15)
 ds_read_b64_tr_b16 v[68:69], v15 offset:27680
 ds_read_b64_tr_b16 v[70:71], v15 offset:32288
 v_mfma_f32_16x16x32_bf16 a[80:83], v[80:83], a[208:211], a[80:83]
 s_waitcnt lgkmcnt(15)
 ds_read_b64_tr_b16 v[72:73], v15 offset:18496
 ds_read_b64_tr_b16 v[74:75], v15 offset:23104
 v_mfma_f32_16x16x32_bf16 a[80:83], v[84:87], a[216:219], a[80:83]
 s_add_u32 s55, s58, 0x800
 buffer_store_dwordx4 v[208:211], v2, s[36:39], s55 offen sc1
 v_mfma_f32_16x16x32_bf16 a[84:87], v[80:83], a[212:215], a[84:87]
 ds_read_b64_tr_b16 v[76:77], v15 offset:27712
 ds_read_b64_tr_b16 v[78:79], v15 offset:32320
 v_mfma_f32_16x16x32_bf16 a[84:87], v[84:87], a[220:223], a[84:87]
 s_waitcnt lgkmcnt(15)
 buffer_load_dwordx4 v2, s[36:39], s40 offen offset:2048 sc1 lds
 v_mfma_f32_16x16x32_bf16 a[88:91], v[88:91], a[208:211], a[88:91]
 ds_read_b64_tr_b16 v[80:81], v15 offset:18528
 ds_read_b64_tr_b16 v[82:83], v15 offset:23136
 v_accvgpr_read_b32 v163, a43
 v_mul_f32 v163, v163, v234
 v_cvt_pk_bf16_f32 v216, v160, v161
 v_cvt_pk_bf16_f32 v217, v162, v163
 v_accvgpr_read_b32 v164, a56
 v_mul_f32 v164, v164, v234
 v_accvgpr_read_b32 v165, a57
 v_mul_f32 v165, v165, v234
 v_accvgpr_read_b32 v166, a58
 v_mul_f32 v166, v166, v234
 v_accvgpr_read_b32 v167, a59
 v_mul_f32 v167, v167, v234
 v_cvt_pk_bf16_f32 v218, v164, v165
 v_cvt_pk_bf16_f32 v219, v166, v167
 v_mfma_f32_16x16x32_bf16 a[88:91], v[92:95], a[216:219], a[88:91]
 buffer_load_dwordx4 v[148:151], v5, s[28:31], s53 offen sc1
 v_mfma_f32_16x16x32_bf16 a[92:95], v[88:91], a[212:215], a[92:95]
 ds_read_b64_tr_b16 v[84:85], v15 offset:27744
 ds_read_b64_tr_b16 v[86:87], v15 offset:32352
 v_mfma_f32_16x16x32_bf16 a[92:95], v[92:95], a[220:223], a[92:95]
 s_waitcnt lgkmcnt(15)
 v_accvgpr_read_b32 v168, a44
 v_mul_f32 v168, v168, v235
 v_mfma_f32_16x16x32_bf16 a[96:99], v[48:51], a[208:211], a[96:99]
 ds_read_b64_tr_b16 v[88:89], v16 offset:18432
 ds_read_b64_tr_b16 v[90:91], v16 offset:23040
 v_mfma_f32_16x16x32_bf16 a[96:99], v[52:55], a[216:219], a[96:99]
 v_accvgpr_read_b32 v169, a45
 v_mul_f32 v169, v169, v235
 v_mfma_f32_16x16x32_bf16 a[100:103], v[48:51], a[212:215], a[100:103]
 ds_read_b64_tr_b16 v[92:93], v16 offset:27648
 ds_read_b64_tr_b16 v[94:95], v16 offset:32256
 v_mfma_f32_16x16x32_bf16 a[100:103], v[52:55], a[220:223], a[100:103]
 s_waitcnt lgkmcnt(15)
 buffer_load_dwordx4 v2, s[36:39], s40 offen offset:3072 sc1 lds
 v_mfma_f32_16x16x32_bf16 a[104:107], v[56:59], a[208:211], a[104:107]
 buffer_load_dwordx4 v[152:155], v4, s[28:31], s53 offen offset:2048 sc1
 v_mfma_f32_16x16x32_bf16 a[104:107], v[60:63], a[216:219], a[104:107]
 v_accvgpr_read_b32 v170, a46
 v_mul_f32 v170, v170, v235
 v_mfma_f32_16x16x32_bf16 a[108:111], v[56:59], a[212:215], a[108:111]
 v_accvgpr_read_b32 v171, a47
 v_mul_f32 v171, v171, v235
 v_mfma_f32_16x16x32_bf16 a[108:111], v[60:63], a[220:223], a[108:111]
 s_waitcnt lgkmcnt(14)
 buffer_store_dwordx4 v[212:215], v2, s[36:39], s55 offen offset:1024 sc1
 v_mfma_f32_16x16x32_bf16 a[112:115], v[64:67], a[208:211], a[112:115]
 s_waitcnt lgkmcnt(12)
 v_cvt_pk_bf16_f32 v220, v168, v169
 v_cvt_pk_bf16_f32 v221, v170, v171
 v_mfma_f32_16x16x32_bf16 a[112:115], v[68:71], a[216:219], a[112:115]
 s_waitcnt lgkmcnt(0)
 v_accvgpr_read_b32 v172, a60
 v_mul_f32 v172, v172, v235
 v_mfma_f32_16x16x32_bf16 a[116:119], v[64:67], a[212:215], a[116:119]
 s_add_u32 m0, s11, 0x2000
 v_accvgpr_read_b32 v173, a61
 v_mul_f32 v173, v173, v235
 v_mfma_f32_16x16x32_bf16 a[116:119], v[68:71], a[220:223], a[116:119]
 s_add_u32 s40, s52, 0x2000
 s_barrier
 buffer_load_dwordx4 v2, s[36:39], s40 offen sc1 lds
 v_mfma_f32_16x16x32_bf16 a[120:123], v[72:75], a[208:211], a[120:123]
 ds_read_b64_tr_b16 v[48:49], v17
 ds_read_b64_tr_b16 v[50:51], v17 offset:4608
 v_mfma_f32_16x16x32_bf16 a[120:123], v[76:79], a[216:219], a[120:123]
 ds_read_b64_tr_b16 v[52:53], v17 offset:9216
 ds_read_b64_tr_b16 v[54:55], v17 offset:13824
 v_mfma_f32_16x16x32_bf16 a[124:127], v[72:75], a[212:215], a[124:127]
 buffer_load_dwordx4 v[156:159], v5, s[28:31], s53 offen offset:2048 sc1
 v_mfma_f32_16x16x32_bf16 a[124:127], v[76:79], a[220:223], a[124:127]
 ds_read_b64_tr_b16 v[56:57], v17 offset:32
 ds_read_b64_tr_b16 v[58:59], v17 offset:4640
 v_mfma_f32_16x16x32_bf16 a[128:131], v[80:83], a[208:211], a[128:131]
 s_add_u32 s52, s52, 0x9000
 ds_read_b64_tr_b16 v[60:61], v17 offset:9248
 ds_read_b64_tr_b16 v[62:63], v17 offset:13856
 v_mfma_f32_16x16x32_bf16 a[128:131], v[84:87], a[216:219], a[128:131]
 ds_read_b64_tr_b16 v[64:65], v17 offset:64
 ds_read_b64_tr_b16 v[66:67], v17 offset:4672
 v_mfma_f32_16x16x32_bf16 a[132:135], v[80:83], a[212:215], a[132:135]
 ds_read_b64_tr_b16 v[68:69], v17 offset:9280
 ds_read_b64_tr_b16 v[70:71], v17 offset:13888
 v_accvgpr_read_b32 v174, a62
 v_mul_f32 v174, v174, v235
 v_accvgpr_read_b32 v175, a63
 v_mul_f32 v175, v175, v235
 v_cvt_pk_bf16_f32 v222, v172, v173
 v_cvt_pk_bf16_f32 v223, v174, v175
 v_mfma_f32_16x16x32_bf16 a[132:135], v[84:87], a[220:223], a[132:135]
 ds_read_b64_tr_b16 v[72:73], v17 offset:96
 ds_read_b64_tr_b16 v[74:75], v17 offset:4704
 v_mfma_f32_16x16x32_bf16 a[136:139], v[88:91], a[208:211], a[136:139]
 s_add_u32 s53, s53, 0x1000
 ds_read_b64_tr_b16 v[76:77], v17 offset:9312
 ds_read_b64_tr_b16 v[78:79], v17 offset:13920
 v_mfma_f32_16x16x32_bf16 a[136:139], v[92:95], a[216:219], a[136:139]
 ds_read_b64_tr_b16 v[80:81], v18
 ds_read_b64_tr_b16 v[82:83], v18 offset:4608
 v_mfma_f32_16x16x32_bf16 a[140:143], v[88:91], a[212:215], a[140:143]
 buffer_store_dwordx4 v[216:219], v3, s[36:39], s55 offen sc1
 v_mfma_f32_16x16x32_bf16 a[140:143], v[92:95], a[220:223], a[140:143]
 s_waitcnt lgkmcnt(15)
 ds_read_b64_tr_b16 v[84:85], v18 offset:9216
 ds_read_b64_tr_b16 v[86:87], v18 offset:13824
 v_mfma_f32_16x16x32_bf16 a[72:75], v[48:51], a[224:227], a[72:75]
 s_waitcnt lgkmcnt(15)
 ds_read_b64_tr_b16 v[88:89], v18 offset:32
 ds_read_b64_tr_b16 v[90:91], v18 offset:4640
 v_mfma_f32_16x16x32_bf16 a[72:75], v[52:55], a[232:235], a[72:75]
 s_add_u32 m0, s8, 0
 v_mfma_f32_16x16x32_bf16 a[76:79], v[48:51], a[228:231], a[76:79]
 s_add_u32 s40, s52, 0
 buffer_load_dwordx4 v2, s[36:39], s40 offen sc1 lds
 v_mfma_f32_16x16x32_bf16 a[76:79], v[52:55], a[236:239], a[76:79]
 s_waitcnt lgkmcnt(15)
 ds_read_b64_tr_b16 v[92:93], v18 offset:9248
 ds_read_b64_tr_b16 v[94:95], v18 offset:13856
 v_mfma_f32_16x16x32_bf16 a[80:83], v[56:59], a[224:227], a[80:83]
 s_waitcnt lgkmcnt(15)
 ds_read_b64_tr_b16 v[48:49], v18 offset:64
 ds_read_b64_tr_b16 v[50:51], v18 offset:4672
 v_mfma_f32_16x16x32_bf16 a[80:83], v[60:63], a[232:235], a[80:83]
 buffer_load_dwordx4 a[192:195], v4, s[28:31], s53 offen sc1
 v_mfma_f32_16x16x32_bf16 a[84:87], v[56:59], a[228:231], a[84:87]
 ds_read_b64_tr_b16 v[52:53], v18 offset:9280
 ds_read_b64_tr_b16 v[54:55], v18 offset:13888
 v_mfma_f32_16x16x32_bf16 a[84:87], v[60:63], a[236:239], a[84:87]
 s_waitcnt lgkmcnt(15)
 v_mfma_f32_16x16x32_bf16 a[88:91], v[64:67], a[224:227], a[88:91]
 ds_read_b64_tr_b16 v[56:57], v18 offset:96
 ds_read_b64_tr_b16 v[58:59], v18 offset:4704
 v_mfma_f32_16x16x32_bf16 a[88:91], v[68:71], a[232:235], a[88:91]
 buffer_load_dwordx4 v2, s[36:39], s40 offen offset:1024 sc1 lds
 v_mfma_f32_16x16x32_bf16 a[92:95], v[64:67], a[228:231], a[92:95]
 ds_read_b64_tr_b16 v[60:61], v18 offset:9312
 ds_read_b64_tr_b16 v[62:63], v18 offset:13920
 v_mfma_f32_16x16x32_bf16 a[92:95], v[68:71], a[236:239], a[92:95]
 s_waitcnt lgkmcnt(15)
 buffer_store_dwordx4 v[220:223], v3, s[36:39], s55 offen offset:1024 sc1
 v_mfma_f32_16x16x32_bf16 a[96:99], v[72:75], a[224:227], a[96:99]
 ds_read_b64_tr_b16 v[64:65], v19
 ds_read_b64_tr_b16 v[66:67], v19 offset:4608
 v_mfma_f32_16x16x32_bf16 a[96:99], v[76:79], a[232:235], a[96:99]
 buffer_load_dwordx4 a[196:199], v5, s[28:31], s53 offen sc1
 v_mfma_f32_16x16x32_bf16 a[100:103], v[72:75], a[228:231], a[100:103]
 ds_read_b64_tr_b16 v[68:69], v19 offset:9216
 ds_read_b64_tr_b16 v[70:71], v19 offset:13824
 v_mfma_f32_16x16x32_bf16 a[100:103], v[76:79], a[236:239], a[100:103]
 s_waitcnt lgkmcnt(15)
 buffer_load_dwordx4 v2, s[36:39], s40 offen offset:2048 sc1 lds
 v_mfma_f32_16x16x32_bf16 a[104:107], v[80:83], a[224:227], a[104:107]
 ds_read_b64_tr_b16 v[72:73], v17 offset:18432
 ds_read_b64_tr_b16 v[74:75], v17 offset:23040
 v_mfma_f32_16x16x32_bf16 a[104:107], v[84:87], a[232:235], a[104:107]
 v_mfma_f32_16x16x32_bf16 a[108:111], v[80:83], a[228:231], a[108:111]
 ds_read_b64_tr_b16 v[76:77], v17 offset:27648
 ds_read_b64_tr_b16 v[78:79], v17 offset:32256
 v_mfma_f32_16x16x32_bf16 a[108:111], v[84:87], a[236:239], a[108:111]
 s_waitcnt lgkmcnt(15)
 v_mfma_f32_16x16x32_bf16 a[112:115], v[88:91], a[224:227], a[112:115]
 ds_read_b64_tr_b16 v[80:81], v17 offset:18464
 ds_read_b64_tr_b16 v[82:83], v17 offset:23072
 v_mfma_f32_16x16x32_bf16 a[112:115], v[92:95], a[232:235], a[112:115]
 buffer_load_dwordx4 a[200:203], v4, s[28:31], s53 offen offset:2048 sc1
 v_mfma_f32_16x16x32_bf16 a[116:119], v[88:91], a[228:231], a[116:119]
 ds_read_b64_tr_b16 v[84:85], v17 offset:27680
 ds_read_b64_tr_b16 v[86:87], v17 offset:32288
 v_mfma_f32_16x16x32_bf16 a[116:119], v[92:95], a[236:239], a[116:119]
 s_waitcnt lgkmcnt(15)
 buffer_load_dwordx4 v2, s[36:39], s40 offen offset:3072 sc1 lds
 v_mfma_f32_16x16x32_bf16 a[120:123], v[48:51], a[224:227], a[120:123]
 ds_read_b64_tr_b16 v[88:89], v17 offset:18496
 ds_read_b64_tr_b16 v[90:91], v17 offset:23104
 v_mfma_f32_16x16x32_bf16 a[120:123], v[52:55], a[232:235], a[120:123]
 v_mfma_f32_16x16x32_bf16 a[124:127], v[48:51], a[228:231], a[124:127]
 ds_read_b64_tr_b16 v[92:93], v17 offset:27712
 ds_read_b64_tr_b16 v[94:95], v17 offset:32320
 v_mfma_f32_16x16x32_bf16 a[124:127], v[52:55], a[236:239], a[124:127]
 s_waitcnt lgkmcnt(15)
 v_mfma_f32_16x16x32_bf16 a[128:131], v[56:59], a[224:227], a[128:131]
 ds_read_b64_tr_b16 v[48:49], v17 offset:18528
 ds_read_b64_tr_b16 v[50:51], v17 offset:23136
 v_mfma_f32_16x16x32_bf16 a[128:131], v[60:63], a[232:235], a[128:131]
 s_add_u32 m0, s8, 0x1000
 buffer_load_dwordx4 a[204:207], v5, s[28:31], s53 offen offset:2048 sc1
 v_mfma_f32_16x16x32_bf16 a[132:135], v[56:59], a[228:231], a[132:135]
 s_add_u32 s40, s52, 0x1000
 buffer_load_dwordx4 v2, s[36:39], s40 offen sc1 lds
 v_mfma_f32_16x16x32_bf16 a[132:135], v[60:63], a[236:239], a[132:135]
 s_waitcnt lgkmcnt(15)
 ds_read_b64_tr_b16 v[52:53], v17 offset:27744
 ds_read_b64_tr_b16 v[54:55], v17 offset:32352
 v_mfma_f32_16x16x32_bf16 a[136:139], v[64:67], a[224:227], a[136:139]
 s_waitcnt lgkmcnt(15)
 ds_read_b64_tr_b16 v[56:57], v18 offset:18432
 ds_read_b64_tr_b16 v[58:59], v18 offset:23040
 v_mfma_f32_16x16x32_bf16 a[136:139], v[68:71], a[232:235], a[136:139]
 v_mfma_f32_16x16x32_bf16 a[140:143], v[64:67], a[228:231], a[140:143]
 ds_read_b64_tr_b16 v[60:61], v18 offset:27648
 ds_read_b64_tr_b16 v[62:63], v18 offset:32256
 v_mfma_f32_16x16x32_bf16 a[140:143], v[68:71], a[236:239], a[140:143]
 s_waitcnt lgkmcnt(15)
 v_mfma_f32_16x16x32_bf16 a[72:75], v[72:75], a[240:243], a[72:75]
 s_add_u32 s53, s53, 0x1000
 ds_read_b64_tr_b16 v[64:65], v18 offset:18464
 ds_read_b64_tr_b16 v[66:67], v18 offset:23072
 v_mfma_f32_16x16x32_bf16 a[72:75], v[76:79], a[248:251], a[72:75]
 buffer_load_dwordx4 v2, s[36:39], s40 offen offset:1024 sc1 lds
 v_mfma_f32_16x16x32_bf16 a[76:79], v[72:75], a[244:247], a[76:79]
 buffer_load_dwordx4 a[208:211], v4, s[28:31], s53 offen sc1
 v_mfma_f32_16x16x32_bf16 a[76:79], v[76:79], a[252:255], a[76:79]
 s_waitcnt lgkmcnt(15)
 ds_read_b64_tr_b16 v[68:69], v18 offset:27680
 ds_read_b64_tr_b16 v[70:71], v18 offset:32288
 v_mfma_f32_16x16x32_bf16 a[80:83], v[80:83], a[240:243], a[80:83]
 s_waitcnt lgkmcnt(15)
 ds_read_b64_tr_b16 v[72:73], v18 offset:18496
 ds_read_b64_tr_b16 v[74:75], v18 offset:23104
 v_mfma_f32_16x16x32_bf16 a[80:83], v[84:87], a[248:251], a[80:83]
 v_mfma_f32_16x16x32_bf16 a[84:87], v[80:83], a[244:247], a[84:87]
 ds_read_b64_tr_b16 v[76:77], v18 offset:27712
 ds_read_b64_tr_b16 v[78:79], v18 offset:32320
 v_mfma_f32_16x16x32_bf16 a[84:87], v[84:87], a[252:255], a[84:87]
 s_waitcnt lgkmcnt(15)
 buffer_load_dwordx4 v2, s[36:39], s40 offen offset:2048 sc1 lds
 v_mfma_f32_16x16x32_bf16 a[88:91], v[88:91], a[240:243], a[88:91]
 ds_read_b64_tr_b16 v[80:81], v18 offset:18528
 ds_read_b64_tr_b16 v[82:83], v18 offset:23136
 v_mfma_f32_16x16x32_bf16 a[88:91], v[92:95], a[248:251], a[88:91]
 buffer_load_dwordx4 a[212:215], v5, s[28:31], s53 offen sc1
 v_mfma_f32_16x16x32_bf16 a[92:95], v[88:91], a[244:247], a[92:95]
 ds_read_b64_tr_b16 v[84:85], v18 offset:27744
 ds_read_b64_tr_b16 v[86:87], v18 offset:32352
 v_mfma_f32_16x16x32_bf16 a[92:95], v[92:95], a[252:255], a[92:95]
 s_waitcnt lgkmcnt(15)
 v_mfma_f32_16x16x32_bf16 a[96:99], v[48:51], a[240:243], a[96:99]
 ds_read_b64_tr_b16 v[88:89], v19 offset:18432
 ds_read_b64_tr_b16 v[90:91], v19 offset:23040
 v_mfma_f32_16x16x32_bf16 a[96:99], v[52:55], a[248:251], a[96:99]
 v_mfma_f32_16x16x32_bf16 a[100:103], v[48:51], a[244:247], a[100:103]
 ds_read_b64_tr_b16 v[92:93], v19 offset:27648
 ds_read_b64_tr_b16 v[94:95], v19 offset:32256
 v_mfma_f32_16x16x32_bf16 a[100:103], v[52:55], a[252:255], a[100:103]
 s_waitcnt lgkmcnt(15)
 buffer_load_dwordx4 v2, s[36:39], s40 offen offset:3072 sc1 lds
 v_mfma_f32_16x16x32_bf16 a[104:107], v[56:59], a[240:243], a[104:107]
 buffer_load_dwordx4 a[216:219], v4, s[28:31], s53 offen offset:2048 sc1
 v_mfma_f32_16x16x32_bf16 a[104:107], v[60:63], a[248:251], a[104:107]
 v_mfma_f32_16x16x32_bf16 a[108:111], v[56:59], a[244:247], a[108:111]
 v_mfma_f32_16x16x32_bf16 a[108:111], v[60:63], a[252:255], a[108:111]
 s_waitcnt vmcnt(12) lgkmcnt(14)
 v_mfma_f32_16x16x32_bf16 a[112:115], v[64:67], a[240:243], a[112:115]
 s_waitcnt lgkmcnt(12)
 v_mfma_f32_16x16x32_bf16 a[112:115], v[68:71], a[248:251], a[112:115]
 s_waitcnt lgkmcnt(0)
 v_mfma_f32_16x16x32_bf16 a[116:119], v[64:67], a[244:247], a[116:119]
 s_add_u32 m0, s8, 0x2000
 v_mfma_f32_16x16x32_bf16 a[116:119], v[68:71], a[252:255], a[116:119]
 s_add_u32 s40, s52, 0x2000
 s_barrier
 buffer_load_dwordx4 v2, s[36:39], s40 offen sc1 lds
 v_mfma_f32_16x16x32_bf16 a[120:123], v[72:75], a[240:243], a[120:123]
 s_cmp_lg_u32 s3, 0
 s_cbranch_scc1 L_sgo3
 s_mov_b64 exec, 1
 buffer_store_dword v253, off, s[36:39], s49 sc1
 s_mov_b64 exec, -1
L_sgo3:
 ds_read_b64_tr_b16 v[48:49], v20
 ds_read_b64_tr_b16 v[50:51], v20 offset:4608
 v_mfma_f32_16x16x32_bf16 a[120:123], v[76:79], a[248:251], a[120:123]
 ds_read_b64_tr_b16 v[52:53], v20 offset:9216
 ds_read_b64_tr_b16 v[54:55], v20 offset:13824
 v_mfma_f32_16x16x32_bf16 a[124:127], v[72:75], a[244:247], a[124:127]
 buffer_load_dwordx4 a[220:223], v5, s[28:31], s53 offen offset:2048 sc1
 v_mfma_f32_16x16x32_bf16 a[124:127], v[76:79], a[252:255], a[124:127]
 ds_read_b64_tr_b16 v[56:57], v20 offset:32
 ds_read_b64_tr_b16 v[58:59], v20 offset:4640
 v_mfma_f32_16x16x32_bf16 a[128:131], v[80:83], a[240:243], a[128:131]
 s_add_u32 s52, s52, 0x9000
 ds_read_b64_tr_b16 v[60:61], v20 offset:9248
 ds_read_b64_tr_b16 v[62:63], v20 offset:13856
 v_mfma_f32_16x16x32_bf16 a[128:131], v[84:87], a[248:251], a[128:131]
 ds_read_b64_tr_b16 v[64:65], v20 offset:64
 ds_read_b64_tr_b16 v[66:67], v20 offset:4672
 v_mfma_f32_16x16x32_bf16 a[132:135], v[80:83], a[244:247], a[132:135]
 ds_read_b64_tr_b16 v[68:69], v20 offset:9280
 ds_read_b64_tr_b16 v[70:71], v20 offset:13888
 v_mfma_f32_16x16x32_bf16 a[132:135], v[84:87], a[252:255], a[132:135]
 ds_read_b64_tr_b16 v[72:73], v20 offset:96
 ds_read_b64_tr_b16 v[74:75], v20 offset:4704
 v_mfma_f32_16x16x32_bf16 a[136:139], v[88:91], a[240:243], a[136:139]
 s_add_u32 s53, s53, 0x1000
 ds_read_b64_tr_b16 v[76:77], v20 offset:9312
 ds_read_b64_tr_b16 v[78:79], v20 offset:13920
 v_mfma_f32_16x16x32_bf16 a[136:139], v[92:95], a[248:251], a[136:139]
 ds_read_b64_tr_b16 v[80:81], v21
 ds_read_b64_tr_b16 v[82:83], v21 offset:4608
 v_mfma_f32_16x16x32_bf16 a[140:143], v[88:91], a[244:247], a[140:143]
 ds_read_b64_tr_b16 v[84:85], v21 offset:9216
 ds_read_b64_tr_b16 v[86:87], v21 offset:13824
 v_mfma_f32_16x16x32_bf16 a[140:143], v[92:95], a[252:255], a[140:143]
 s_branch L_B2
L_B0:
 s_waitcnt lgkmcnt(15)
 v_mfma_f32_16x16x32_bf16 a[72:75], v[48:51], a[192:195], a[72:75]
 ds_read_b64_tr_b16 v[88:89], v15 offset:32
 ds_read_b64_tr_b16 v[90:91], v15 offset:4640
 v_mfma_f32_16x16x32_bf16 a[72:75], v[52:55], a[200:203], a[72:75]
 s_add_u32 m0, s11, 0
 v_mfma_f32_16x16x32_bf16 a[76:79], v[48:51], a[196:199], a[76:79]
 s_add_u32 s40, s52, 0
 buffer_load_dwordx4 v2, s[36:39], s40 offen sc1 lds
 v_mfma_f32_16x16x32_bf16 a[76:79], v[52:55], a[204:207], a[76:79]
 s_waitcnt lgkmcnt(15)
 ds_read_b64_tr_b16 v[92:93], v15 offset:9248
 ds_read_b64_tr_b16 v[94:95], v15 offset:13856
 v_mfma_f32_16x16x32_bf16 a[80:83], v[56:59], a[192:195], a[80:83]
 s_waitcnt lgkmcnt(15)
 ds_read_b64_tr_b16 v[48:49], v15 offset:64
 ds_read_b64_tr_b16 v[50:51], v15 offset:4672
 v_mfma_f32_16x16x32_bf16 a[80:83], v[60:63], a[200:203], a[80:83]
 buffer_load_dwordx4 v[128:131], v4, s[28:31], s53 offen sc1
 v_mfma_f32_16x16x32_bf16 a[84:87], v[56:59], a[196:199], a[84:87]
 ds_read_b64_tr_b16 v[52:53], v15 offset:9280
 ds_read_b64_tr_b16 v[54:55], v15 offset:13888
 v_mfma_f32_16x16x32_bf16 a[84:87], v[60:63], a[204:207], a[84:87]
 s_waitcnt lgkmcnt(15)
 v_mfma_f32_16x16x32_bf16 a[88:91], v[64:67], a[192:195], a[88:91]
 ds_read_b64_tr_b16 v[56:57], v15 offset:96
 ds_read_b64_tr_b16 v[58:59], v15 offset:4704
 v_mfma_f32_16x16x32_bf16 a[88:91], v[68:71], a[200:203], a[88:91]
 buffer_load_dwordx4 v2, s[36:39], s40 offen offset:1024 sc1 lds
 v_mfma_f32_16x16x32_bf16 a[92:95], v[64:67], a[196:199], a[92:95]
 ds_read_b64_tr_b16 v[60:61], v15 offset:9312
 ds_read_b64_tr_b16 v[62:63], v15 offset:13920
 v_mfma_f32_16x16x32_bf16 a[92:95], v[68:71], a[204:207], a[92:95]
 s_waitcnt lgkmcnt(15)
 v_mfma_f32_16x16x32_bf16 a[96:99], v[72:75], a[192:195], a[96:99]
 ds_read_b64_tr_b16 v[64:65], v16
 ds_read_b64_tr_b16 v[66:67], v16 offset:4608
 v_mfma_f32_16x16x32_bf16 a[96:99], v[76:79], a[200:203], a[96:99]
 buffer_load_dwordx4 v[132:135], v5, s[28:31], s53 offen sc1
 v_mfma_f32_16x16x32_bf16 a[100:103], v[72:75], a[196:199], a[100:103]
 ds_read_b64_tr_b16 v[68:69], v16 offset:9216
 ds_read_b64_tr_b16 v[70:71], v16 offset:13824
 v_mfma_f32_16x16x32_bf16 a[100:103], v[76:79], a[204:207], a[100:103]
 s_waitcnt lgkmcnt(15)
 buffer_load_dwordx4 v2, s[36:39], s40 offen offset:2048 sc1 lds
 v_mfma_f32_16x16x32_bf16 a[104:107], v[80:83], a[192:195], a[104:107]
 ds_read_b64_tr_b16 v[72:73], v14 offset:18432
 ds_read_b64_tr_b16 v[74:75], v14 offset:23040
 v_mfma_f32_16x16x32_bf16 a[104:107], v[84:87], a[200:203], a[104:107]
 v_mfma_f32_16x16x32_bf16 a[108:111], v[80:83], a[196:199], a[108:111]
 ds_read_b64_tr_b16 v[76:77], v14 offset:27648
 ds_read_b64_tr_b16 v[78:79], v14 offset:32256
 v_mfma_f32_16x16x32_bf16 a[108:111], v[84:87], a[204:207], a[108:111]
 s_waitcnt lgkmcnt(15)
 v_mfma_f32_16x16x32_bf16 a[112:115], v[88:91], a[192:195], a[112:115]
 ds_read_b64_tr_b16 v[80:81], v14 offset:18464
 ds_read_b64_tr_b16 v[82:83], v14 offset:23072
 v_mfma_f32_16x16x32_bf16 a[112:115], v[92:95], a[200:203], a[112:115]
 buffer_load_dwordx4 v[136:139], v4, s[28:31], s53 offen offset:2048 sc1
 v_mfma_f32_16x16x32_bf16 a[116:119], v[88:91], a[196:199], a[116:119]
 ds_read_b64_tr_b16 v[84:85], v14 offset:27680
 ds_read_b64_tr_b16 v[86:87], v14 offset:32288
 v_mfma_f32_16x16x32_bf16 a[116:119], v[92:95], a[204:207], a[116:119]
 s_waitcnt lgkmcnt(15)
 buffer_load_dwordx4 v2, s[36:39], s40 offen offset:3072 sc1 lds
 v_mfma_f32_16x16x32_bf16 a[120:123], v[48:51], a[192:195], a[120:123]
 ds_read_b64_tr_b16 v[88:89], v14 offset:18496
 ds_read_b64_tr_b16 v[90:91], v14 offset:23104
 v_mfma_f32_16x16x32_bf16 a[120:123], v[52:55], a[200:203], a[120:123]
 v_mfma_f32_16x16x32_bf16 a[124:127], v[48:51], a[196:199], a[124:127]
 ds_read_b64_tr_b16 v[92:93], v14 offset:27712
 ds_read_b64_tr_b16 v[94:95], v14 offset:32320
 v_mfma_f32_16x16x32_bf16 a[124:127], v[52:55], a[204:207], a[124:127]
 s_waitcnt lgkmcnt(15)
 v_mfma_f32_16x16x32_bf16 a[128:131], v[56:59], a[192:195], a[128:131]
 ds_read_b64_tr_b16 v[48:49], v14 offset:18528
 ds_read_b64_tr_b16 v[50:51], v14 offset:23136
 v_mfma_f32_16x16x32_bf16 a[128:131], v[60:63], a[200:203], a[128:131]
 s_add_u32 m0, s11, 0x1000
 buffer_load_dwordx4 v[140:143], v5, s[28:31], s53 offen offset:2048 sc1
 v_mfma_f32_16x16x32_bf16 a[132:135], v[56:59], a[196:199], a[132:135]
 s_add_u32 s40, s52, 0x1000
 buffer_load_dwordx4 v2, s[36:39], s40 offen sc1 lds
 v_mfma_f32_16x16x32_bf16 a[132:135], v[60:63], a[204:207], a[132:135]
 s_waitcnt lgkmcnt(15)
 ds_read_b64_tr_b16 v[52:53], v14 offset:27744
 ds_read_b64_tr_b16 v[54:55], v14 offset:32352
 v_mfma_f32_16x16x32_bf16 a[136:139], v[64:67], a[192:195], a[136:139]
 s_waitcnt lgkmcnt(15)
 ds_read_b64_tr_b16 v[56:57], v15 offset:18432
 ds_read_b64_tr_b16 v[58:59], v15 offset:23040
 v_mfma_f32_16x16x32_bf16 a[136:139], v[68:71], a[200:203], a[136:139]
 v_mfma_f32_16x16x32_bf16 a[140:143], v[64:67], a[196:199], a[140:143]
 ds_read_b64_tr_b16 v[60:61], v15 offset:27648
 ds_read_b64_tr_b16 v[62:63], v15 offset:32256
 v_mfma_f32_16x16x32_bf16 a[140:143], v[68:71], a[204:207], a[140:143]
 s_waitcnt lgkmcnt(15)
 v_mfma_f32_16x16x32_bf16 a[72:75], v[72:75], a[208:211], a[72:75]
 s_add_u32 s53, s53, 0x1000
 ds_read_b64_tr_b16 v[64:65], v15 offset:18464
 ds_read_b64_tr_b16 v[66:67], v15 offset:23072
 v_mfma_f32_16x16x32_bf16 a[72:75], v[76:79], a[216:219], a[72:75]
 buffer_load_dwordx4 v2, s[36:39], s40 offen offset:1024 sc1 lds
 v_mfma_f32_16x16x32_bf16 a[76:79], v[72:75], a[212:215], a[76:79]
 s_waitcnt vmcnt(44)
 buffer_load_dwordx4 v[144:147], v4, s[28:31], s53 offen sc1
 v_mfma_f32_16x16x32_bf16 a[76:79], v[76:79], a[220:223], a[76:79]
 s_waitcnt lgkmcnt(15)
 ds_read_b64_tr_b16 v[68:69], v15 offset:27680
 ds_read_b64_tr_b16 v[70:71], v15 offset:32288
 v_mfma_f32_16x16x32_bf16 a[80:83], v[80:83], a[208:211], a[80:83]
 s_waitcnt lgkmcnt(15)
 ds_read_b64_tr_b16 v[72:73], v15 offset:18496
 ds_read_b64_tr_b16 v[74:75], v15 offset:23104
 v_mfma_f32_16x16x32_bf16 a[80:83], v[84:87], a[216:219], a[80:83]
 v_mfma_f32_16x16x32_bf16 a[84:87], v[80:83], a[212:215], a[84:87]
 ds_read_b64_tr_b16 v[76:77], v15 offset:27712
 ds_read_b64_tr_b16 v[78:79], v15 offset:32320
 v_mfma_f32_16x16x32_bf16 a[84:87], v[84:87], a[220:223], a[84:87]
 s_waitcnt lgkmcnt(15)
 buffer_load_dwordx4 v2, s[36:39], s40 offen offset:2048 sc1 lds
 v_mfma_f32_16x16x32_bf16 a[88:91], v[88:91], a[208:211], a[88:91]
 ds_read_b64_tr_b16 v[80:81], v15 offset:18528
 ds_read_b64_tr_b16 v[82:83], v15 offset:23136
 v_mfma_f32_16x16x32_bf16 a[88:91], v[92:95], a[216:219], a[88:91]
 buffer_load_dwordx4 v[148:151], v5, s[28:31], s53 offen sc1
 v_mfma_f32_16x16x32_bf16 a[92:95], v[88:91], a[212:215], a[92:95]
 ds_read_b64_tr_b16 v[84:85], v15 offset:27744
 ds_read_b64_tr_b16 v[86:87], v15 offset:32352
 v_mfma_f32_16x16x32_bf16 a[92:95], v[92:95], a[220:223], a[92:95]
 s_waitcnt lgkmcnt(15)
 v_mfma_f32_16x16x32_bf16 a[96:99], v[48:51], a[208:211], a[96:99]
 ds_read_b64_tr_b16 v[88:89], v16 offset:18432
 ds_read_b64_tr_b16 v[90:91], v16 offset:23040
 v_mfma_f32_16x16x32_bf16 a[96:99], v[52:55], a[216:219], a[96:99]
 v_mfma_f32_16x16x32_bf16 a[100:103], v[48:51], a[212:215], a[100:103]
 ds_read_b64_tr_b16 v[92:93], v16 offset:27648
 ds_read_b64_tr_b16 v[94:95], v16 offset:32256
 v_mfma_f32_16x16x32_bf16 a[100:103], v[52:55], a[220:223], a[100:103]
 s_waitcnt lgkmcnt(15)
 buffer_load_dwordx4 v2, s[36:39], s40 offen offset:3072 sc1 lds
 v_mfma_f32_16x16x32_bf16 a[104:107], v[56:59], a[208:211], a[104:107]
 buffer_load_dwordx4 v[152:155], v4, s[28:31], s53 offen offset:2048 sc1
 v_mfma_f32_16x16x32_bf16 a[104:107], v[60:63], a[216:219], a[104:107]
 v_mfma_f32_16x16x32_bf16 a[108:111], v[56:59], a[212:215], a[108:111]
 v_mfma_f32_16x16x32_bf16 a[108:111], v[60:63], a[220:223], a[108:111]
 s_waitcnt lgkmcnt(14)
 v_mfma_f32_16x16x32_bf16 a[112:115], v[64:67], a[208:211], a[112:115]
 s_waitcnt vmcnt(33) lgkmcnt(12)
 v_mfma_f32_16x16x32_bf16 a[112:115], v[68:71], a[216:219], a[112:115]
 s_waitcnt lgkmcnt(0)
 v_mfma_f32_16x16x32_bf16 a[116:119], v[64:67], a[212:215], a[116:119]
 s_add_u32 m0, s11, 0x2000
 v_mfma_f32_16x16x32_bf16 a[116:119], v[68:71], a[220:223], a[116:119]
 s_add_u32 s40, s52, 0x2000
 s_barrier
 buffer_load_dwordx4 v2, s[36:39], s40 offen sc1 lds
 v_mfma_f32_16x16x32_bf16 a[120:123], v[72:75], a[208:211], a[120:123]
 ds_read_b64_tr_b16 v[48:49], v17
 ds_read_b64_tr_b16 v[50:51], v17 offset:4608
 v_mfma_f32_16x16x32_bf16 a[120:123], v[76:79], a[216:219], a[120:123]
 ds_read_b64_tr_b16 v[52:53], v17 offset:9216
 ds_read_b64_tr_b16 v[54:55], v17 offset:13824
 v_mfma_f32_16x16x32_bf16 a[124:127], v[72:75], a[212:215], a[124:127]
 buffer_load_dwordx4 v[156:159], v5, s[28:31], s53 offen offset:2048 sc1
 v_mfma_f32_16x16x32_bf16 a[124:127], v[76:79], a[220:223], a[124:127]
 ds_read_b64_tr_b16 v[56:57], v17 offset:32
 ds_read_b64_tr_b16 v[58:59], v17 offset:4640
 v_mfma_f32_16x16x32_bf16 a[128:131], v[80:83], a[208:211], a[128:131]
 s_add_u32 s52, s52, 0x9000
 ds_read_b64_tr_b16 v[60:61], v17 offset:9248
 ds_read_b64_tr_b16 v[62:63], v17 offset:13856
 v_mfma_f32_16x16x32_bf16 a[128:131], v[84:87], a[216:219], a[128:131]
 ds_read_b64_tr_b16 v[64:65], v17 offset:64
 ds_read_b64_tr_b16 v[66:67], v17 offset:4672
 v_mfma_f32_16x16x32_bf16 a[132:135], v[80:83], a[212:215], a[132:135]
 ds_read_b64_tr_b16 v[68:69], v17 offset:9280
 ds_read_b64_tr_b16 v[70:71], v17 offset:13888
 v_mfma_f32_16x16x32_bf16 a[132:135], v[84:87], a[220:223], a[132:135]
 ds_read_b64_tr_b16 v[72:73], v17 offset:96
 ds_read_b64_tr_b16 v[74:75], v17 offset:4704
 v_mfma_f32_16x16x32_bf16 a[136:139], v[88:91], a[208:211], a[136:139]
 s_add_u32 s53, s53, 0x1000
 ds_read_b64_tr_b16 v[76:77], v17 offset:9312
 ds_read_b64_tr_b16 v[78:79], v17 offset:13920
 v_mfma_f32_16x16x32_bf16 a[136:139], v[92:95], a[216:219], a[136:139]
 ds_read_b64_tr_b16 v[80:81], v18
 ds_read_b64_tr_b16 v[82:83], v18 offset:4608
 v_mfma_f32_16x16x32_bf16 a[140:143], v[88:91], a[212:215], a[140:143]
 ds_read_b64_tr_b16 v[84:85], v18 offset:9216
 ds_read_b64_tr_b16 v[86:87], v18 offset:13824
 v_mfma_f32_16x16x32_bf16 a[140:143], v[92:95], a[220:223], a[140:143]
 s_branch L_B1
L_rare0:
 s_call_b64 s[60:61], L_rsub0
 v_exp_f32 v224, v96
 v_exp_f32 v225, v97
 v_exp_f32 v226, v98
 v_exp_f32 v227, v99
 v_cvt_pk_bf16_f32 v176, v224, v225
 v_cvt_pk_bf16_f32 v177, v226, v227
 s_nop 1
 s_branch L_back0
L_rare1:
 s_call_b64 s[60:61], L_rsub1
 v_exp_f32 v224, v128
 v_exp_f32 v225, v129
 v_exp_f32 v226, v130
 v_exp_f32 v227, v131
 v_cvt_pk_bf16_f32 v32, v224, v225
 v_cvt_pk_bf16_f32 v33, v226, v227
 s_nop 1
 s_branch L_back1
L_rare2:
 s_call_b64 s[60:61], L_rsub2
 v_exp_f32 v224, v96
 v_exp_f32 v225, v97
 v_exp_f32 v226, v98
 v_exp_f32 v227, v99
 v_cvt_pk_bf16_f32 v48, v224, v225
 v_cvt_pk_bf16_f32 v49, v226, v227
 s_nop 1
 s_branch L_back2
L_rare3:
 s_call_b64 s[60:61], L_rsub3
 v_exp_f32 v224, v128
 v_exp_f32 v225, v129
 v_exp_f32 v226, v130
 v_exp_f32 v227, v131
 v_cvt_pk_bf16_f32 v160, v224, v225
 v_cvt_pk_bf16_f32 v161, v226, v227
 s_nop 1
 s_branch L_back3
L_rare4:
 s_call_b64 s[60:61], L_rsub0
 v_exp_f32 v224, v96
 v_exp_f32 v225, v97
 v_exp_f32 v226, v98
 v_exp_f32 v227, v99
 v_cvt_pk_bf16_f32 v176, v224, v225
 v_cvt_pk_bf16_f32 v177, v226, v227
 s_nop 1
 s_branch L_back4
L_rare5:
 s_call_b64 s[60:61], L_rsub1
 v_exp_f32 v224, v128
 v_exp_f32 v225, v129
 v_exp_f32 v226, v130
 v_exp_f32 v227, v131
 v_cvt_pk_bf16_f32 v32, v224, v225
 v_cvt_pk_bf16_f32 v33, v226, v227
 s_nop 1
 s_branch L_back5
L_rare6:
 s_call_b64 s[60:61], L_rsub2
 v_exp_f32 v224, v96
 v_exp_f32 v225, v97
 v_exp_f32 v226, v98
 v_exp_f32 v227, v99
 v_cvt_pk_bf16_f32 v48, v224, v225
 v_cvt_pk_bf16_f32 v49, v226, v227
 s_nop 1
 s_branch L_back6
L_rare7:
 s_call_b64 s[60:61], L_rsub3
 v_exp_f32 v224, v128
 v_exp_f32 v225, v129
 v_exp_f32 v226, v130
 v_exp_f32 v227, v131
 v_cvt_pk_bf16_f32 v160, v224, v225
 v_cvt_pk_bf16_f32 v161, v226, v227
 s_nop 1
 s_branch L_back7
L_rarep55:
 s_call_b64 s[60:61], L_rsub3
 v_exp_f32 v224, v128
 v_exp_f32 v225, v129
 s_nop 0
 v_cvt_pk_bf16_f32 v160, v224, v225
 v_exp_f32 v226, v130
 s_nop 1
 s_branch L_backp55
L_rarep56:
 s_call_b64 s[60:61], L_rsub0
 v_exp_f32 v224, v96
 v_exp_f32 v225, v97
 v_exp_f32 v226, v98
 v_exp_f32 v227, v99
 v_cvt_pk_bf16_f32 v176, v224, v225
 v_cvt_pk_bf16_f32 v177, v226, v227
 s_nop 1
 s_branch L_backp56
L_rarep57:
 s_call_b64 s[60:61], L_rsub1
 v_exp_f32 v224, v128
 v_exp_f32 v225, v129
 v_exp_f32 v226, v130
 v_cvt_pk_bf16_f32 v32, v224, v225
 v_exp_f32 v227, v131
 s_nop 0
 v_cvt_pk_bf16_f32 v33, v226, v227
 v_exp_f32 v228, v132
 s_nop 1
 s_branch L_backp57
L_rarep58:
 s_call_b64 s[60:61], L_rsub2
 v_exp_f32 v224, v96
 v_exp_f32 v225, v97
 v_exp_f32 v226, v98
 v_exp_f32 v227, v99
 v_cvt_pk_bf16_f32 v48, v224, v225
 v_cvt_pk_bf16_f32 v49, v226, v227
 s_nop 1
 s_branch L_backp58
L_rarep59:
 s_call_b64 s[60:61], L_rsub3
 v_exp_f32 v224, v128
 v_exp_f32 v225, v129
 v_exp_f32 v226, v130
 v_cvt_pk_bf16_f32 v160, v224, v225
 v_exp_f32 v227, v131
 s_nop 0
 v_cvt_pk_bf16_f32 v161, v226, v227
 v_exp_f32 v228, v132
 s_nop 1
 s_branch L_backp59
L_rarep60:
 s_call_b64 s[60:61], L_rsub0
 v_exp_f32 v224, v96
 v_exp_f32 v225, v97
 v_exp_f32 v226, v98
 v_exp_f32 v227, v99
 v_cvt_pk_bf16_f32 v176, v224, v225
 s_nop 1
 s_branch L_backp60
L_rarep61:
 s_call_b64 s[60:61], L_rsub1
 v_exp_f32 v224, v128
 v_exp_f32 v225, v129
 v_exp_f32 v226, v130
 v_exp_f32 v227, v131
 v_cvt_pk_bf16_f32 v32, v224, v225
 s_nop 1
 s_branch L_backp61
L_rarep62:
 s_call_b64 s[60:61], L_rsub2
 v_exp_f32 v224, v96
 v_exp_f32 v225, v97
 v_exp_f32 v226, v98
 v_exp_f32 v227, v99
 v_cvt_pk_bf16_f32 v48, v224, v225
 s_nop 1
 s_branch L_backp62
L_rsub0:
 s_nop 7
 v_max3_f32 v241, v128, v129, v130
 v_max3_f32 v241, v241, v131, v144
 v_max3_f32 v241, v241, v145, v146
 v_max_f32 v241, v241, v147
 v_mov_b32 v240, v241
 s_nop 1
 v_permlane16_swap_b32 v241, v240
 v_max_f32 v241, v241, v240
 v_mov_b32 v240, v241
 s_nop 1
 v_permlane32_swap_b32 v241, v240
 v_max_f32 v241, v241, v240
 v_max_f32 v241, 0, v241
 v_ceil_f32 v241, v241
 v_exp_f32 v245, -v241
 v_sub_f32 v192, v192, v241
 v_sub_f32 v193, v193, v241
 v_sub_f32 v194, v194, v241
 v_sub_f32 v195, v195, v241
 v_mul_f32 v232, v232, v245
 v_sub_f32 v128, v128, v241
 v_sub_f32 v129, v129, v241
 v_sub_f32 v130, v130, v241
 v_sub_f32 v131, v131, v241
 v_sub_f32 v144, v144, v241
 v_sub_f32 v145, v145, v241
 v_sub_f32 v146, v146, v241
 v_sub_f32 v147, v147, v241
 v_sub_f32 v96, v96, v241
 v_sub_f32 v97, v97, v241
 v_sub_f32 v98, v98, v241
 v_sub_f32 v99, v99, v241
 v_sub_f32 v112, v112, v241
 v_sub_f32 v113, v113, v241
 v_sub_f32 v114, v114, v241
 v_sub_f32 v115, v115, v241
 v_lshlrev_b32 v224, 16, v48
 v_and_b32 v225, 0xffff0000, v48
 v_mul_f32 v224, v224, v245
 v_mul_f32 v225, v225, v245
 v_cvt_pk_bf16_f32 v48, v224, v225
 v_lshlrev_b32 v224, 16, v49
 v_and_b32 v225, 0xffff0000, v49
 v_mul_f32 v224, v224, v245
 v_mul_f32 v225, v225, v245
 v_cvt_pk_bf16_f32 v49, v224, v225
 v_lshlrev_b32 v224, 16, v50
 v_and_b32 v225, 0xffff0000, v50
 v_mul_f32 v224, v224, v245
 v_mul_f32 v225, v225, v245
 v_cvt_pk_bf16_f32 v50, v224, v225
 v_lshlrev_b32 v224, 16, v51
 v_and_b32 v225, 0xffff0000, v51
 v_mul_f32 v224, v224, v245
 v_mul_f32 v225, v225, v245
 v_cvt_pk_bf16_f32 v51, v224, v225
 v_max3_f32 v242, v132, v133, v134
 v_max3_f32 v242, v242, v135, v148
 v_max3_f32 v242, v242, v149, v150
 v_max_f32 v242, v242, v151
 v_mov_b32 v240, v242
 s_nop 1
 v_permlane16_swap_b32 v242, v240
 v_max_f32 v242, v242, v240
 v_mov_b32 v240, v242
 s_nop 1
 v_permlane32_swap_b32 v242, v240
 v_max_f32 v242, v242, v240
 v_max_f32 v242, 0, v242
 v_ceil_f32 v242, v242
 v_exp_f32 v246, -v242
 v_sub_f32 v196, v196, v242
 v_sub_f32 v197, v197, v242
 v_sub_f32 v198, v198, v242
 v_sub_f32 v199, v199, v242
 v_mul_f32 v233, v233, v246
 v_sub_f32 v132, v132, v242
 v_sub_f32 v133, v133, v242
 v_sub_f32 v134, v134, v242
 v_sub_f32 v135, v135, v242
 v_sub_f32 v148, v148, v242
 v_sub_f32 v149, v149, v242
 v_sub_f32 v150, v150, v242
 v_sub_f32 v151, v151, v242
 v_sub_f32 v100, v100, v242
 v_sub_f32 v101, v101, v242
 v_sub_f32 v102, v102, v242
 v_sub_f32 v103, v103, v242
 v_sub_f32 v116, v116, v242
 v_sub_f32 v117, v117, v242
 v_sub_f32 v118, v118, v242
 v_sub_f32 v119, v119, v242
 v_lshlrev_b32 v224, 16, v52
 v_and_b32 v225, 0xffff0000, v52
 v_mul_f32 v224, v224, v246
 v_mul_f32 v225, v225, v246
 v_cvt_pk_bf16_f32 v52, v224, v225
 v_lshlrev_b32 v224, 16, v53
 v_and_b32 v225, 0xffff0000, v53
 v_mul_f32 v224, v224, v246
 v_mul_f32 v225, v225, v246
 v_cvt_pk_bf16_f32 v53, v224, v225
 v_lshlrev_b32 v224, 16, v54
 v_and_b32 v225, 0xffff0000, v54
 v_mul_f32 v224, v224, v246
 v_mul_f32 v225, v225, v246
 v_cvt_pk_bf16_f32 v54, v224, v225
 v_lshlrev_b32 v224, 16, v55
 v_and_b32 v225, 0xffff0000, v55
 v_mul_f32 v224, v224, v246
 v_mul_f32 v225, v225, v246
 v_cvt_pk_bf16_f32 v55, v224, v225
 v_max3_f32 v243, v136, v137, v138
 v_max3_f32 v243, v243, v139, v152
 v_max3_f32 v243, v243, v153, v154
 v_max_f32 v243, v243, v155
 v_mov_b32 v240, v243
 s_nop 1
 v_permlane16_swap_b32 v243, v240
 v_max_f32 v243, v243, v240
 v_mov_b32 v240, v243
 s_nop 1
 v_permlane32_swap_b32 v243, v240
 v_max_f32 v243, v243, v240
 v_max_f32 v243, 0, v243
 v_ceil_f32 v243, v243
 v_exp_f32 v247, -v243
 v_sub_f32 v200, v200, v243
 v_sub_f32 v201, v201, v243
 v_sub_f32 v202, v202, v243
 v_sub_f32 v203, v203, v243
 v_mul_f32 v234, v234, v247
 v_sub_f32 v136, v136, v243
 v_sub_f32 v137, v137, v243
 v_sub_f32 v138, v138, v243
 v_sub_f32 v139, v139, v243
 v_sub_f32 v152, v152, v243
 v_sub_f32 v153, v153, v243
 v_sub_f32 v154, v154, v243
 v_sub_f32 v155, v155, v243
 v_sub_f32 v104, v104, v243
 v_sub_f32 v105, v105, v243
 v_sub_f32 v106, v106, v243
 v_sub_f32 v107, v107, v243
 v_sub_f32 v120, v120, v243
 v_sub_f32 v121, v121, v243
 v_sub_f32 v122, v122, v243
 v_sub_f32 v123, v123, v243
 v_lshlrev_b32 v224, 16, v56
 v_and_b32 v225, 0xffff0000, v56
 v_mul_f32 v224, v224, v247
 v_mul_f32 v225, v225, v247
 v_cvt_pk_bf16_f32 v56, v224, v225
 v_lshlrev_b32 v224, 16, v57
 v_and_b32 v225, 0xffff0000, v57
 v_mul_f32 v224, v224, v247
 v_mul_f32 v225, v225, v247
 v_cvt_pk_bf16_f32 v57, v224, v225
 v_lshlrev_b32 v224, 16, v58
 v_and_b32 v225, 0xffff0000, v58
 v_mul_f32 v224, v224, v247
 v_mul_f32 v225, v225, v247
 v_cvt_pk_bf16_f32 v58, v224, v225
 v_lshlrev_b32 v224, 16, v59
 v_and_b32 v225, 0xffff0000, v59
 v_mul_f32 v224, v224, v247
 v_mul_f32 v225, v225, v247
 v_cvt_pk_bf16_f32 v59, v224, v225
 v_max3_f32 v244, v140, v141, v142
 v_max3_f32 v244, v244, v143, v156
 v_max3_f32 v244, v244, v157, v158
 v_max_f32 v244, v244, v159
 v_mov_b32 v240, v244
 s_nop 1
 v_permlane16_swap_b32 v244, v240
 v_max_f32 v244, v244, v240
 v_mov_b32 v240, v244
 s_nop 1
 v_permlane32_swap_b32 v244, v240
 v_max_f32 v244, v244, v240
 v_max_f32 v244, 0, v244
 v_ceil_f32 v244, v244
 v_exp_f32 v248, -v244
 v_sub_f32 v204, v204, v244
 v_sub_f32 v205, v205, v244
 v_sub_f32 v206, v206, v244
 v_sub_f32 v207, v207, v244
 v_mul_f32 v235, v235, v248
 v_sub_f32 v140, v140, v244
 v_sub_f32 v141, v141, v244
 v_sub_f32 v142, v142, v244
 v_sub_f32 v143, v143, v244
 v_sub_f32 v156, v156, v244
 v_sub_f32 v157, v157, v244
 v_sub_f32 v158, v158, v244
 v_sub_f32 v159, v159, v244
 v_sub_f32 v108, v108, v244
 v_sub_f32 v109, v109, v244
 v_sub_f32 v110, v110, v244
 v_sub_f32 v111, v111, v244
 v_sub_f32 v124, v124, v244
 v_sub_f32 v125, v125, v244
 v_sub_f32 v126, v126, v244
 v_sub_f32 v127, v127, v244
 v_lshlrev_b32 v224, 16, v60
 v_and_b32 v225, 0xffff0000, v60
 v_mul_f32 v224, v224, v248
 v_mul_f32 v225, v225, v248
 v_cvt_pk_bf16_f32 v60, v224, v225
 v_lshlrev_b32 v224, 16, v61
 v_and_b32 v225, 0xffff0000, v61
 v_mul_f32 v224, v224, v248
 v_mul_f32 v225, v225, v248
 v_cvt_pk_bf16_f32 v61, v224, v225
 v_lshlrev_b32 v224, 16, v62
 v_and_b32 v225, 0xffff0000, v62
 v_mul_f32 v224, v224, v248
 v_mul_f32 v225, v225, v248
 v_cvt_pk_bf16_f32 v62, v224, v225
 v_lshlrev_b32 v224, 16, v63
 v_and_b32 v225, 0xffff0000, v63
 v_mul_f32 v224, v224, v248
 v_mul_f32 v225, v225, v248
 v_cvt_pk_bf16_f32 v63, v224, v225
 v_exp_f32 v224, v128
 v_exp_f32 v225, v129
 s_nop 0
 v_cvt_pk_bf16_f32 v160, v224, v225
 v_exp_f32 v226, v130
 v_exp_f32 v227, v131
 s_nop 0
 v_cvt_pk_bf16_f32 v161, v226, v227
 v_exp_f32 v228, v132
 v_exp_f32 v229, v133
 s_nop 0
 v_cvt_pk_bf16_f32 v164, v228, v229
 v_exp_f32 v230, v134
 v_exp_f32 v231, v135
 s_nop 0
 v_cvt_pk_bf16_f32 v165, v230, v231
 v_exp_f32 v224, v136
 v_exp_f32 v225, v137
 s_nop 0
 v_cvt_pk_bf16_f32 v168, v224, v225
 v_exp_f32 v226, v138
 v_exp_f32 v227, v139
 s_nop 0
 v_cvt_pk_bf16_f32 v169, v226, v227
 v_exp_f32 v228, v140
 v_exp_f32 v229, v141
 s_nop 0
 v_cvt_pk_bf16_f32 v172, v228, v229
 v_exp_f32 v230, v142
 v_exp_f32 v231, v143
 s_nop 0
 v_cvt_pk_bf16_f32 v173, v230, v231
 v_exp_f32 v224, v144
 v_exp_f32 v225, v145
 s_nop 0
 v_cvt_pk_bf16_f32 v162, v224, v225
 v_exp_f32 v226, v146
 v_exp_f32 v227, v147
 s_nop 0
 v_cvt_pk_bf16_f32 v163, v226, v227
 v_exp_f32 v228, v148
 v_exp_f32 v229, v149
 s_nop 0
 v_cvt_pk_bf16_f32 v166, v228, v229
 v_exp_f32 v230, v150
 v_exp_f32 v231, v151
 s_nop 0
 v_cvt_pk_bf16_f32 v167, v230, v231
 v_exp_f32 v224, v152
 v_exp_f32 v225, v153
 s_nop 0
 v_cvt_pk_bf16_f32 v170, v224, v225
 v_exp_f32 v226, v154
 v_exp_f32 v227, v155
 s_nop 0
 v_cvt_pk_bf16_f32 v171, v226, v227
 v_exp_f32 v228, v156
 v_exp_f32 v229, v157
 s_nop 0
 v_cvt_pk_bf16_f32 v174, v228, v229
 v_exp_f32 v230, v158
 v_exp_f32 v231, v159
 s_nop 0
 v_cvt_pk_bf16_f32 v175, v230, v231
 v_mfma_f32_16x16x32_bf16 v[208:211], v[212:215], v[160:163], 0
 v_mfma_f32_16x16x32_bf16 v[208:211], v[216:219], v[164:167], v[208:211]
 v_mfma_f32_16x16x32_bf16 v[208:211], v[220:223], v[168:171], v[208:211]
 v_mfma_f32_16x16x32_bf16 v[208:211], v[236:239], v[172:175], v[208:211]
 s_branch L_rso
L_rsub1:
 s_nop 7
 v_max3_f32 v241, v96, v97, v98
 v_max3_f32 v241, v241, v99, v112
 v_max3_f32 v241, v241, v113, v114
 v_max_f32 v241, v241, v115
 v_mov_b32 v240, v241
 s_nop 1
 v_permlane16_swap_b32 v241, v240
 v_max_f32 v241, v241, v240
 v_mov_b32 v240, v241
 s_nop 1
 v_permlane32_swap_b32 v241, v240
 v_max_f32 v241, v241, v240
 v_max_f32 v241, 0, v241
 v_ceil_f32 v241, v241
 v_exp_f32 v245, -v241
 v_sub_f32 v192, v192, v241
 v_sub_f32 v193, v193, v241
 v_sub_f32 v194, v194, v241
 v_sub_f32 v195, v195, v241
 v_mul_f32 v232, v232, v245
 v_sub_f32 v96, v96, v241
 v_sub_f32 v97, v97, v241
 v_sub_f32 v98, v98, v241
 v_sub_f32 v99, v99, v241
 v_sub_f32 v112, v112, v241
 v_sub_f32 v113, v113, v241
 v_sub_f32 v114, v114, v241
 v_sub_f32 v115, v115, v241
 v_sub_f32 v128, v128, v241
 v_sub_f32 v129, v129, v241
 v_sub_f32 v130, v130, v241
 v_sub_f32 v131, v131, v241
 v_sub_f32 v144, v144, v241
 v_sub_f32 v145, v145, v241
 v_sub_f32 v146, v146, v241
 v_sub_f32 v147, v147, v241
 v_lshlrev_b32 v224, 16, v160
 v_and_b32 v225, 0xffff0000, v160
 v_mul_f32 v224, v224, v245
 v_mul_f32 v225, v225, v245
 v_cvt_pk_bf16_f32 v160, v224, v225
 v_lshlrev_b32 v224, 16, v161
 v_and_b32 v225, 0xffff0000, v161
 v_mul_f32 v224, v224, v245
 v_mul_f32 v225, v225, v245
 v_cvt_pk_bf16_f32 v161, v224, v225
 v_lshlrev_b32 v224, 16, v162
 v_and_b32 v225, 0xffff0000, v162
 v_mul_f32 v224, v224, v245
 v_mul_f32 v225, v225, v245
 v_cvt_pk_bf16_f32 v162, v224, v225
 v_lshlrev_b32 v224, 16, v163
 v_and_b32 v225, 0xffff0000, v163
 v_mul_f32 v224, v224, v245
 v_mul_f32 v225, v225, v245
 v_cvt_pk_bf16_f32 v163, v224, v225
 v_max3_f32 v242, v100, v101, v102
 v_max3_f32 v242, v242, v103, v116
 v_max3_f32 v242, v242, v117, v118
 v_max_f32 v242, v242, v119
 v_mov_b32 v240, v242
 s_nop 1
 v_permlane16_swap_b32 v242, v240
 v_max_f32 v242, v242, v240
 v_mov_b32 v240, v242
 s_nop 1
 v_permlane32_swap_b32 v242, v240
 v_max_f32 v242, v242, v240
 v_max_f32 v242, 0, v242
 v_ceil_f32 v242, v242
 v_exp_f32 v246, -v242
 v_sub_f32 v196, v196, v242
 v_sub_f32 v197, v197, v242
 v_sub_f32 v198, v198, v242
 v_sub_f32 v199, v199, v242
 v_mul_f32 v233, v233, v246
 v_sub_f32 v100, v100, v242
 v_sub_f32 v101, v101, v242
 v_sub_f32 v102, v102, v242
 v_sub_f32 v103, v103, v242
 v_sub_f32 v116, v116, v242
 v_sub_f32 v117, v117, v242
 v_sub_f32 v118, v118, v242
 v_sub_f32 v119, v119, v242
 v_sub_f32 v132, v132, v242
 v_sub_f32 v133, v133, v242
 v_sub_f32 v134, v134, v242
 v_sub_f32 v135, v135, v242
 v_sub_f32 v148, v148, v242
 v_sub_f32 v149, v149, v242
 v_sub_f32 v150, v150, v242
 v_sub_f32 v151, v151, v242
 v_lshlrev_b32 v224, 16, v164
 v_and_b32 v225, 0xffff0000, v164
 v_mul_f32 v224, v224, v246
 v_mul_f32 v225, v225, v246
 v_cvt_pk_bf16_f32 v164, v224, v225
 v_lshlrev_b32 v224, 16, v165
 v_and_b32 v225, 0xffff0000, v165
 v_mul_f32 v224, v224, v246
 v_mul_f32 v225, v225, v246
 v_cvt_pk_bf16_f32 v165, v224, v225
 v_lshlrev_b32 v224, 16, v166
 v_and_b32 v225, 0xffff0000, v166
 v_mul_f32 v224, v224, v246
 v_mul_f32 v225, v225, v246
 v_cvt_pk_bf16_f32 v166, v224, v225
 v_lshlrev_b32 v224, 16, v167
 v_and_b32 v225, 0xffff0000, v167
 v_mul_f32 v224, v224, v246
 v_mul_f32 v225, v225, v246
 v_cvt_pk_bf16_f32 v167, v224, v225
 v_max3_f32 v243, v104, v105, v106
 v_max3_f32 v243, v243, v107, v120
 v_max3_f32 v243, v243, v121, v122
 v_max_f32 v243, v243, v123
 v_mov_b32 v240, v243
 s_nop 1
 v_permlane16_swap_b32 v243, v240
 v_max_f32 v243, v243, v240
 v_mov_b32 v240, v243
 s_nop 1
 v_permlane32_swap_b32 v243, v240
 v_max_f32 v243, v243, v240
 v_max_f32 v243, 0, v243
 v_ceil_f32 v243, v243
 v_exp_f32 v247, -v243
 v_sub_f32 v200, v200, v243
 v_sub_f32 v201, v201, v243
 v_sub_f32 v202, v202, v243
 v_sub_f32 v203, v203, v243
 v_mul_f32 v234, v234, v247
 v_sub_f32 v104, v104, v243
 v_sub_f32 v105, v105, v243
 v_sub_f32 v106, v106, v243
 v_sub_f32 v107, v107, v243
 v_sub_f32 v120, v120, v243
 v_sub_f32 v121, v121, v243
 v_sub_f32 v122, v122, v243
 v_sub_f32 v123, v123, v243
 v_sub_f32 v136, v136, v243
 v_sub_f32 v137, v137, v243
 v_sub_f32 v138, v138, v243
 v_sub_f32 v139, v139, v243
 v_sub_f32 v152, v152, v243
 v_sub_f32 v153, v153, v243
 v_sub_f32 v154, v154, v243
 v_sub_f32 v155, v155, v243
 v_lshlrev_b32 v224, 16, v168
 v_and_b32 v225, 0xffff0000, v168
 v_mul_f32 v224, v224, v247
 v_mul_f32 v225, v225, v247
 v_cvt_pk_bf16_f32 v168, v224, v225
 v_lshlrev_b32 v224, 16, v169
 v_and_b32 v225, 0xffff0000, v169
 v_mul_f32 v224, v224, v247
 v_mul_f32 v225, v225, v247
 v_cvt_pk_bf16_f32 v169, v224, v225
 v_lshlrev_b32 v224, 16, v170
 v_and_b32 v225, 0xffff0000, v170
 v_mul_f32 v224, v224, v247
 v_mul_f32 v225, v225, v247
 v_cvt_pk_bf16_f32 v170, v224, v225
 v_lshlrev_b32 v224, 16, v171
 v_and_b32 v225, 0xffff0000, v171
 v_mul_f32 v224, v224, v247
 v_mul_f32 v225, v225, v247
 v_cvt_pk_bf16_f32 v171, v224, v225
 v_max3_f32 v244, v108, v109, v110
 v_max3_f32 v244, v244, v111, v124
 v_max3_f32 v244, v244, v125, v126
 v_max_f32 v244, v244, v127
 v_mov_b32 v240, v244
 s_nop 1
 v_permlane16_swap_b32 v244, v240
 v_max_f32 v244, v244, v240
 v_mov_b32 v240, v244
 s_nop 1
 v_permlane32_swap_b32 v244, v240
 v_max_f32 v244, v244, v240
 v_max_f32 v244, 0, v244
 v_ceil_f32 v244, v244
 v_exp_f32 v248, -v244
 v_sub_f32 v204, v204, v244
 v_sub_f32 v205, v205, v244
 v_sub_f32 v206, v206, v244
 v_sub_f32 v207, v207, v244
 v_mul_f32 v235, v235, v248
 v_sub_f32 v108, v108, v244
 v_sub_f32 v109, v109, v244
 v_sub_f32 v110, v110, v244
 v_sub_f32 v111, v111, v244
 v_sub_f32 v124, v124, v244
 v_sub_f32 v125, v125, v244
 v_sub_f32 v126, v126, v244
 v_sub_f32 v127, v127, v244
 v_sub_f32 v140, v140, v244
 v_sub_f32 v141, v141, v244
 v_sub_f32 v142, v142, v244
 v_sub_f32 v143, v143, v244
 v_sub_f32 v156, v156, v244
 v_sub_f32 v157, v157, v244
 v_sub_f32 v158, v158, v244
 v_sub_f32 v159, v159, v244
 v_lshlrev_b32 v224, 16, v172
 v_and_b32 v225, 0xffff0000, v172
 v_mul_f32 v224, v224, v248
 v_mul_f32 v225, v225, v248
 v_cvt_pk_bf16_f32 v172, v224, v225
 v_lshlrev_b32 v224, 16, v173
 v_and_b32 v225, 0xffff0000, v173
 v_mul_f32 v224, v224, v248
 v_mul_f32 v225, v225, v248
 v_cvt_pk_bf16_f32 v173, v224, v225
 v_lshlrev_b32 v224, 16, v174
 v_and_b32 v225, 0xffff0000, v174
 v_mul_f32 v224, v224, v248
 v_mul_f32 v225, v225, v248
 v_cvt_pk_bf16_f32 v174, v224, v225
 v_lshlrev_b32 v224, 16, v175
 v_and_b32 v225, 0xffff0000, v175
 v_mul_f32 v224, v224, v248
 v_mul_f32 v225, v225, v248
 v_cvt_pk_bf16_f32 v175, v224, v225
 v_exp_f32 v224, v96
 v_exp_f32 v225, v97
 s_nop 0
 v_cvt_pk_bf16_f32 v176, v224, v225
 v_exp_f32 v226, v98
 v_exp_f32 v227, v99
 s_nop 0
 v_cvt_pk_bf16_f32 v177, v226, v227
 v_exp_f32 v228, v100
 v_exp_f32 v229, v101
 s_nop 0
 v_cvt_pk_bf16_f32 v180, v228, v229
 v_exp_f32 v230, v102
 v_exp_f32 v231, v103
 s_nop 0
 v_cvt_pk_bf16_f32 v181, v230, v231
 v_exp_f32 v224, v104
 v_exp_f32 v225, v105
 s_nop 0
 v_cvt_pk_bf16_f32 v184, v224, v225
 v_exp_f32 v226, v106
 v_exp_f32 v227, v107
 s_nop 0
 v_cvt_pk_bf16_f32 v185, v226, v227
 v_exp_f32 v228, v108
 v_exp_f32 v229, v109
 s_nop 0
 v_cvt_pk_bf16_f32 v188, v228, v229
 v_exp_f32 v230, v110
 v_exp_f32 v231, v111
 s_nop 0
 v_cvt_pk_bf16_f32 v189, v230, v231
 v_exp_f32 v224, v112
 v_exp_f32 v225, v113
 s_nop 0
 v_cvt_pk_bf16_f32 v178, v224, v225
 v_exp_f32 v226, v114
 v_exp_f32 v227, v115
 s_nop 0
 v_cvt_pk_bf16_f32 v179, v226, v227
 v_exp_f32 v228, v116
 v_exp_f32 v229, v117
 s_nop 0
 v_cvt_pk_bf16_f32 v182, v228, v229
 v_exp_f32 v230, v118
 v_exp_f32 v231, v119
 s_nop 0
 v_cvt_pk_bf16_f32 v183, v230, v231
 v_exp_f32 v224, v120
 v_exp_f32 v225, v121
 s_nop 0
 v_cvt_pk_bf16_f32 v186, v224, v225
 v_exp_f32 v226, v122
 v_exp_f32 v227, v123
 s_nop 0
 v_cvt_pk_bf16_f32 v187, v226, v227
 v_exp_f32 v228, v124
 v_exp_f32 v229, v125
 s_nop 0
 v_cvt_pk_bf16_f32 v190, v228, v229
 v_exp_f32 v230, v126
 v_exp_f32 v231, v127
 s_nop 0
 v_cvt_pk_bf16_f32 v191, v230, v231
 v_mfma_f32_16x16x32_bf16 v[208:211], v[212:215], v[176:179], 0
 v_mfma_f32_16x16x32_bf16 v[208:211], v[216:219], v[180:183], v[208:211]
 v_mfma_f32_16x16x32_bf16 v[208:211], v[220:223], v[184:187], v[208:211]
 v_mfma_f32_16x16x32_bf16 v[208:211], v[236:239], v[188:191], v[208:211]
 s_branch L_rso
L_rsub2:
 s_nop 7
 v_max3_f32 v241, v128, v129, v130
 v_max3_f32 v241, v241, v131, v144
 v_max3_f32 v241, v241, v145, v146
 v_max_f32 v241, v241, v147
 v_mov_b32 v240, v241
 s_nop 1
 v_permlane16_swap_b32 v241, v240
 v_max_f32 v241, v241, v240
 v_mov_b32 v240, v241
 s_nop 1
 v_permlane32_swap_b32 v241, v240
 v_max_f32 v241, v241, v240
 v_max_f32 v241, 0, v241
 v_ceil_f32 v241, v241
 v_exp_f32 v245, -v241
 v_sub_f32 v192, v192, v241
 v_sub_f32 v193, v193, v241
 v_sub_f32 v194, v194, v241
 v_sub_f32 v195, v195, v241
 v_mul_f32 v232, v232, v245
 v_sub_f32 v128, v128, v241
 v_sub_f32 v129, v129, v241
 v_sub_f32 v130, v130, v241
 v_sub_f32 v131, v131, v241
 v_sub_f32 v144, v144, v241
 v_sub_f32 v145, v145, v241
 v_sub_f32 v146, v146, v241
 v_sub_f32 v147, v147, v241
 v_sub_f32 v96, v96, v241
 v_sub_f32 v97, v97, v241
 v_sub_f32 v98, v98, v241
 v_sub_f32 v99, v99, v241
 v_sub_f32 v112, v112, v241
 v_sub_f32 v113, v113, v241
 v_sub_f32 v114, v114, v241
 v_sub_f32 v115, v115, v241
 v_lshlrev_b32 v224, 16, v176
 v_and_b32 v225, 0xffff0000, v176
 v_mul_f32 v224, v224, v245
 v_mul_f32 v225, v225, v245
 v_cvt_pk_bf16_f32 v176, v224, v225
 v_lshlrev_b32 v224, 16, v177
 v_and_b32 v225, 0xffff0000, v177
 v_mul_f32 v224, v224, v245
 v_mul_f32 v225, v225, v245
 v_cvt_pk_bf16_f32 v177, v224, v225
 v_lshlrev_b32 v224, 16, v178
 v_and_b32 v225, 0xffff0000, v178
 v_mul_f32 v224, v224, v245
 v_mul_f32 v225, v225, v245
 v_cvt_pk_bf16_f32 v178, v224, v225
 v_lshlrev_b32 v224, 16, v179
 v_and_b32 v225, 0xffff0000, v179
 v_mul_f32 v224, v224, v245
 v_mul_f32 v225, v225, v245
 v_cvt_pk_bf16_f32 v179, v224, v225
 v_max3_f32 v242, v132, v133, v134
 v_max3_f32 v242, v242, v135, v148
 v_max3_f32 v242, v242, v149, v150
 v_max_f32 v242, v242, v151
 v_mov_b32 v240, v242
 s_nop 1
 v_permlane16_swap_b32 v242, v240
 v_max_f32 v242, v242, v240
 v_mov_b32 v240, v242
 s_nop 1
 v_permlane32_swap_b32 v242, v240
 v_max_f32 v242, v242, v240
 v_max_f32 v242, 0, v242
 v_ceil_f32 v242, v242
 v_exp_f32 v246, -v242
 v_sub_f32 v196, v196, v242
 v_sub_f32 v197, v197, v242
 v_sub_f32 v198, v198, v242
 v_sub_f32 v199, v199, v242
 v_mul_f32 v233, v233, v246
 v_sub_f32 v132, v132, v242
 v_sub_f32 v133, v133, v242
 v_sub_f32 v134, v134, v242
 v_sub_f32 v135, v135, v242
 v_sub_f32 v148, v148, v242
 v_sub_f32 v149, v149, v242
 v_sub_f32 v150, v150, v242
 v_sub_f32 v151, v151, v242
 v_sub_f32 v100, v100, v242
 v_sub_f32 v101, v101, v242
 v_sub_f32 v102, v102, v242
 v_sub_f32 v103, v103, v242
 v_sub_f32 v116, v116, v242
 v_sub_f32 v117, v117, v242
 v_sub_f32 v118, v118, v242
 v_sub_f32 v119, v119, v242
 v_lshlrev_b32 v224, 16, v180
 v_and_b32 v225, 0xffff0000, v180
 v_mul_f32 v224, v224, v246
 v_mul_f32 v225, v225, v246
 v_cvt_pk_bf16_f32 v180, v224, v225
 v_lshlrev_b32 v224, 16, v181
 v_and_b32 v225, 0xffff0000, v181
 v_mul_f32 v224, v224, v246
 v_mul_f32 v225, v225, v246
 v_cvt_pk_bf16_f32 v181, v224, v225
 v_lshlrev_b32 v224, 16, v182
 v_and_b32 v225, 0xffff0000, v182
 v_mul_f32 v224, v224, v246
 v_mul_f32 v225, v225, v246
 v_cvt_pk_bf16_f32 v182, v224, v225
 v_lshlrev_b32 v224, 16, v183
 v_and_b32 v225, 0xffff0000, v183
 v_mul_f32 v224, v224, v246
 v_mul_f32 v225, v225, v246
 v_cvt_pk_bf16_f32 v183, v224, v225
 v_max3_f32 v243, v136, v137, v138
 v_max3_f32 v243, v243, v139, v152
 v_max3_f32 v243, v243, v153, v154
 v_max_f32 v243, v243, v155
 v_mov_b32 v240, v243
 s_nop 1
 v_permlane16_swap_b32 v243, v240
 v_max_f32 v243, v243, v240
 v_mov_b32 v240, v243
 s_nop 1
 v_permlane32_swap_b32 v243, v240
 v_max_f32 v243, v243, v240
 v_max_f32 v243, 0, v243
 v_ceil_f32 v243, v243
 v_exp_f32 v247, -v243
 v_sub_f32 v200, v200, v243
 v_sub_f32 v201, v201, v243
 v_sub_f32 v202, v202, v243
 v_sub_f32 v203, v203, v243
 v_mul_f32 v234, v234, v247
 v_sub_f32 v136, v136, v243
 v_sub_f32 v137, v137, v243
 v_sub_f32 v138, v138, v243
 v_sub_f32 v139, v139, v243
 v_sub_f32 v152, v152, v243
 v_sub_f32 v153, v153, v243
 v_sub_f32 v154, v154, v243
 v_sub_f32 v155, v155, v243
 v_sub_f32 v104, v104, v243
 v_sub_f32 v105, v105, v243
 v_sub_f32 v106, v106, v243
 v_sub_f32 v107, v107, v243
 v_sub_f32 v120, v120, v243
 v_sub_f32 v121, v121, v243
 v_sub_f32 v122, v122, v243
 v_sub_f32 v123, v123, v243
 v_lshlrev_b32 v224, 16, v184
 v_and_b32 v225, 0xffff0000, v184
 v_mul_f32 v224, v224, v247
 v_mul_f32 v225, v225, v247
 v_cvt_pk_bf16_f32 v184, v224, v225
 v_lshlrev_b32 v224, 16, v185
 v_and_b32 v225, 0xffff0000, v185
 v_mul_f32 v224, v224, v247
 v_mul_f32 v225, v225, v247
 v_cvt_pk_bf16_f32 v185, v224, v225
 v_lshlrev_b32 v224, 16, v186
 v_and_b32 v225, 0xffff0000, v186
 v_mul_f32 v224, v224, v247
 v_mul_f32 v225, v225, v247
 v_cvt_pk_bf16_f32 v186, v224, v225
 v_lshlrev_b32 v224, 16, v187
 v_and_b32 v225, 0xffff0000, v187
 v_mul_f32 v224, v224, v247
 v_mul_f32 v225, v225, v247
 v_cvt_pk_bf16_f32 v187, v224, v225
 v_max3_f32 v244, v140, v141, v142
 v_max3_f32 v244, v244, v143, v156
 v_max3_f32 v244, v244, v157, v158
 v_max_f32 v244, v244, v159
 v_mov_b32 v240, v244
 s_nop 1
 v_permlane16_swap_b32 v244, v240
 v_max_f32 v244, v244, v240
 v_mov_b32 v240, v244
 s_nop 1
 v_permlane32_swap_b32 v244, v240
 v_max_f32 v244, v244, v240
 v_max_f32 v244, 0, v244
 v_ceil_f32 v244, v244
 v_exp_f32 v248, -v244
 v_sub_f32 v204, v204, v244
 v_sub_f32 v205, v205, v244
 v_sub_f32 v206, v206, v244
 v_sub_f32 v207, v207, v244
 v_mul_f32 v235, v235, v248
 v_sub_f32 v140, v140, v244
 v_sub_f32 v141, v141, v244
 v_sub_f32 v142, v142, v244
 v_sub_f32 v143, v143, v244
 v_sub_f32 v156, v156, v244
 v_sub_f32 v157, v157, v244
 v_sub_f32 v158, v158, v244
 v_sub_f32 v159, v159, v244
 v_sub_f32 v108, v108, v244
 v_sub_f32 v109, v109, v244
 v_sub_f32 v110, v110, v244
 v_sub_f32 v111, v111, v244
 v_sub_f32 v124, v124, v244
 v_sub_f32 v125, v125, v244
 v_sub_f32 v126, v126, v244
 v_sub_f32 v127, v127, v244
 v_lshlrev_b32 v224, 16, v188
 v_and_b32 v225, 0xffff0000, v188
 v_mul_f32 v224, v224, v248
 v_mul_f32 v225, v225, v248
 v_cvt_pk_bf16_f32 v188, v224, v225
 v_lshlrev_b32 v224, 16, v189
 v_and_b32 v225, 0xffff0000, v189
 v_mul_f32 v224, v224, v248
 v_mul_f32 v225, v225, v248
 v_cvt_pk_bf16_f32 v189, v224, v225
 v_lshlrev_b32 v224, 16, v190
 v_and_b32 v225, 0xffff0000, v190
 v_mul_f32 v224, v224, v248
 v_mul_f32 v225, v225, v248
 v_cvt_pk_bf16_f32 v190, v224, v225
 v_lshlrev_b32 v224, 16, v191
 v_and_b32 v225, 0xffff0000, v191
 v_mul_f32 v224, v224, v248
 v_mul_f32 v225, v225, v248
 v_cvt_pk_bf16_f32 v191, v224, v225
 v_exp_f32 v224, v128
 v_exp_f32 v225, v129
 s_nop 0
 v_cvt_pk_bf16_f32 v32, v224, v225
 v_exp_f32 v226, v130
 v_exp_f32 v227, v131
 s_nop 0
 v_cvt_pk_bf16_f32 v33, v226, v227
 v_exp_f32 v228, v132
 v_exp_f32 v229, v133
 s_nop 0
 v_cvt_pk_bf16_f32 v36, v228, v229
 v_exp_f32 v230, v134
 v_exp_f32 v231, v135
 s_nop 0
 v_cvt_pk_bf16_f32 v37, v230, v231
 v_exp_f32 v224, v136
 v_exp_f32 v225, v137
 s_nop 0
 v_cvt_pk_bf16_f32 v40, v224, v225
 v_exp_f32 v226, v138
 v_exp_f32 v227, v139
 s_nop 0
 v_cvt_pk_bf16_f32 v41, v226, v227
 v_exp_f32 v228, v140
 v_exp_f32 v229, v141
 s_nop 0
 v_cvt_pk_bf16_f32 v44, v228, v229
 v_exp_f32 v230, v142
 v_exp_f32 v231, v143
 s_nop 0
 v_cvt_pk_bf16_f32 v45, v230, v231
 v_exp_f32 v224, v144
 v_exp_f32 v225, v145
 s_nop 0
 v_cvt_pk_bf16_f32 v34, v224, v225
 v_exp_f32 v226, v146
 v_exp_f32 v227, v147
 s_nop 0
 v_cvt_pk_bf16_f32 v35, v226, v227
 v_exp_f32 v228, v148
 v_exp_f32 v229, v149
 s_nop 0
 v_cvt_pk_bf16_f32 v38, v228, v229
 v_exp_f32 v230, v150
 v_exp_f32 v231, v151
 s_nop 0
 v_cvt_pk_bf16_f32 v39, v230, v231
 v_exp_f32 v224, v152
 v_exp_f32 v225, v153
 s_nop 0
 v_cvt_pk_bf16_f32 v42, v224, v225
 v_exp_f32 v226, v154
 v_exp_f32 v227, v155
 s_nop 0
 v_cvt_pk_bf16_f32 v43, v226, v227
 v_exp_f32 v228, v156
 v_exp_f32 v229, v157
 s_nop 0
 v_cvt_pk_bf16_f32 v46, v228, v229
 v_exp_f32 v230, v158
 v_exp_f32 v231, v159
 s_nop 0
 v_cvt_pk_bf16_f32 v47, v230, v231
 v_mfma_f32_16x16x32_bf16 v[208:211], v[212:215], v[32:35], 0
 v_mfma_f32_16x16x32_bf16 v[208:211], v[216:219], v[36:39], v[208:211]
 v_mfma_f32_16x16x32_bf16 v[208:211], v[220:223], v[40:43], v[208:211]
 v_mfma_f32_16x16x32_bf16 v[208:211], v[236:239], v[44:47], v[208:211]
 s_branch L_rso
L_rsub3:
 s_nop 7
 v_max3_f32 v241, v96, v97, v98
 v_max3_f32 v241, v241, v99, v112
 v_max3_f32 v241, v241, v113, v114
 v_max_f32 v241, v241, v115
 v_mov_b32 v240, v241
 s_nop 1
 v_permlane16_swap_b32 v241, v240
 v_max_f32 v241, v241, v240
 v_mov_b32 v240, v241
 s_nop 1
 v_permlane32_swap_b32 v241, v240
 v_max_f32 v241, v241, v240
 v_max_f32 v241, 0, v241
 v_ceil_f32 v241, v241
 v_exp_f32 v245, -v241
 v_sub_f32 v192, v192, v241
 v_sub_f32 v193, v193, v241
 v_sub_f32 v194, v194, v241
 v_sub_f32 v195, v195, v241
 v_mul_f32 v232, v232, v245
 v_sub_f32 v96, v96, v241
 v_sub_f32 v97, v97, v241
 v_sub_f32 v98, v98, v241
 v_sub_f32 v99, v99, v241
 v_sub_f32 v112, v112, v241
 v_sub_f32 v113, v113, v241
 v_sub_f32 v114, v114, v241
 v_sub_f32 v115, v115, v241
 v_sub_f32 v128, v128, v241
 v_sub_f32 v129, v129, v241
 v_sub_f32 v130, v130, v241
 v_sub_f32 v131, v131, v241
 v_sub_f32 v144, v144, v241
 v_sub_f32 v145, v145, v241
 v_sub_f32 v146, v146, v241
 v_sub_f32 v147, v147, v241
 v_lshlrev_b32 v224, 16, v32
 v_and_b32 v225, 0xffff0000, v32
 v_mul_f32 v224, v224, v245
 v_mul_f32 v225, v225, v245
 v_cvt_pk_bf16_f32 v32, v224, v225
 v_lshlrev_b32 v224, 16, v33
 v_and_b32 v225, 0xffff0000, v33
 v_mul_f32 v224, v224, v245
 v_mul_f32 v225, v225, v245
 v_cvt_pk_bf16_f32 v33, v224, v225
 v_lshlrev_b32 v224, 16, v34
 v_and_b32 v225, 0xffff0000, v34
 v_mul_f32 v224, v224, v245
 v_mul_f32 v225, v225, v245
 v_cvt_pk_bf16_f32 v34, v224, v225
 v_lshlrev_b32 v224, 16, v35
 v_and_b32 v225, 0xffff0000, v35
 v_mul_f32 v224, v224, v245
 v_mul_f32 v225, v225, v245
 v_cvt_pk_bf16_f32 v35, v224, v225
 v_max3_f32 v242, v100, v101, v102
 v_max3_f32 v242, v242, v103, v116
 v_max3_f32 v242, v242, v117, v118
 v_max_f32 v242, v242, v119
 v_mov_b32 v240, v242
 s_nop 1
 v_permlane16_swap_b32 v242, v240
 v_max_f32 v242, v242, v240
 v_mov_b32 v240, v242
 s_nop 1
 v_permlane32_swap_b32 v242, v240
 v_max_f32 v242, v242, v240
 v_max_f32 v242, 0, v242
 v_ceil_f32 v242, v242
 v_exp_f32 v246, -v242
 v_sub_f32 v196, v196, v242
 v_sub_f32 v197, v197, v242
 v_sub_f32 v198, v198, v242
 v_sub_f32 v199, v199, v242
 v_mul_f32 v233, v233, v246
 v_sub_f32 v100, v100, v242
 v_sub_f32 v101, v101, v242
 v_sub_f32 v102, v102, v242
 v_sub_f32 v103, v103, v242
 v_sub_f32 v116, v116, v242
 v_sub_f32 v117, v117, v242
 v_sub_f32 v118, v118, v242
 v_sub_f32 v119, v119, v242
 v_sub_f32 v132, v132, v242
 v_sub_f32 v133, v133, v242
 v_sub_f32 v134, v134, v242
 v_sub_f32 v135, v135, v242
 v_sub_f32 v148, v148, v242
 v_sub_f32 v149, v149, v242
 v_sub_f32 v150, v150, v242
 v_sub_f32 v151, v151, v242
 v_lshlrev_b32 v224, 16, v36
 v_and_b32 v225, 0xffff0000, v36
 v_mul_f32 v224, v224, v246
 v_mul_f32 v225, v225, v246
 v_cvt_pk_bf16_f32 v36, v224, v225
 v_lshlrev_b32 v224, 16, v37
 v_and_b32 v225, 0xffff0000, v37
 v_mul_f32 v224, v224, v246
 v_mul_f32 v225, v225, v246
 v_cvt_pk_bf16_f32 v37, v224, v225
 v_lshlrev_b32 v224, 16, v38
 v_and_b32 v225, 0xffff0000, v38
 v_mul_f32 v224, v224, v246
 v_mul_f32 v225, v225, v246
 v_cvt_pk_bf16_f32 v38, v224, v225
 v_lshlrev_b32 v224, 16, v39
 v_and_b32 v225, 0xffff0000, v39
 v_mul_f32 v224, v224, v246
 v_mul_f32 v225, v225, v246
 v_cvt_pk_bf16_f32 v39, v224, v225
 v_max3_f32 v243, v104, v105, v106
 v_max3_f32 v243, v243, v107, v120
 v_max3_f32 v243, v243, v121, v122
 v_max_f32 v243, v243, v123
 v_mov_b32 v240, v243
 s_nop 1
 v_permlane16_swap_b32 v243, v240
 v_max_f32 v243, v243, v240
 v_mov_b32 v240, v243
 s_nop 1
 v_permlane32_swap_b32 v243, v240
 v_max_f32 v243, v243, v240
 v_max_f32 v243, 0, v243
 v_ceil_f32 v243, v243
 v_exp_f32 v247, -v243
 v_sub_f32 v200, v200, v243
 v_sub_f32 v201, v201, v243
 v_sub_f32 v202, v202, v243
 v_sub_f32 v203, v203, v243
 v_mul_f32 v234, v234, v247
 v_sub_f32 v104, v104, v243
 v_sub_f32 v105, v105, v243
 v_sub_f32 v106, v106, v243
 v_sub_f32 v107, v107, v243
 v_sub_f32 v120, v120, v243
 v_sub_f32 v121, v121, v243
 v_sub_f32 v122, v122, v243
 v_sub_f32 v123, v123, v243
 v_sub_f32 v136, v136, v243
 v_sub_f32 v137, v137, v243
 v_sub_f32 v138, v138, v243
 v_sub_f32 v139, v139, v243
 v_sub_f32 v152, v152, v243
 v_sub_f32 v153, v153, v243
 v_sub_f32 v154, v154, v243
 v_sub_f32 v155, v155, v243
 v_lshlrev_b32 v224, 16, v40
 v_and_b32 v225, 0xffff0000, v40
 v_mul_f32 v224, v224, v247
 v_mul_f32 v225, v225, v247
 v_cvt_pk_bf16_f32 v40, v224, v225
 v_lshlrev_b32 v224, 16, v41
 v_and_b32 v225, 0xffff0000, v41
 v_mul_f32 v224, v224, v247
 v_mul_f32 v225, v225, v247
 v_cvt_pk_bf16_f32 v41, v224, v225
 v_lshlrev_b32 v224, 16, v42
 v_and_b32 v225, 0xffff0000, v42
 v_mul_f32 v224, v224, v247
 v_mul_f32 v225, v225, v247
 v_cvt_pk_bf16_f32 v42, v224, v225
 v_lshlrev_b32 v224, 16, v43
 v_and_b32 v225, 0xffff0000, v43
 v_mul_f32 v224, v224, v247
 v_mul_f32 v225, v225, v247
 v_cvt_pk_bf16_f32 v43, v224, v225
 v_max3_f32 v244, v108, v109, v110
 v_max3_f32 v244, v244, v111, v124
 v_max3_f32 v244, v244, v125, v126
 v_max_f32 v244, v244, v127
 v_mov_b32 v240, v244
 s_nop 1
 v_permlane16_swap_b32 v244, v240
 v_max_f32 v244, v244, v240
 v_mov_b32 v240, v244
 s_nop 1
 v_permlane32_swap_b32 v244, v240
 v_max_f32 v244, v244, v240
 v_max_f32 v244, 0, v244
 v_ceil_f32 v244, v244
 v_exp_f32 v248, -v244
 v_sub_f32 v204, v204, v244
 v_sub_f32 v205, v205, v244
 v_sub_f32 v206, v206, v244
 v_sub_f32 v207, v207, v244
 v_mul_f32 v235, v235, v248
 v_sub_f32 v108, v108, v244
 v_sub_f32 v109, v109, v244
 v_sub_f32 v110, v110, v244
 v_sub_f32 v111, v111, v244
 v_sub_f32 v124, v124, v244
 v_sub_f32 v125, v125, v244
 v_sub_f32 v126, v126, v244
 v_sub_f32 v127, v127, v244
 v_sub_f32 v140, v140, v244
 v_sub_f32 v141, v141, v244
 v_sub_f32 v142, v142, v244
 v_sub_f32 v143, v143, v244
 v_sub_f32 v156, v156, v244
 v_sub_f32 v157, v157, v244
 v_sub_f32 v158, v158, v244
 v_sub_f32 v159, v159, v244
 v_lshlrev_b32 v224, 16, v44
 v_and_b32 v225, 0xffff0000, v44
 v_mul_f32 v224, v224, v248
 v_mul_f32 v225, v225, v248
 v_cvt_pk_bf16_f32 v44, v224, v225
 v_lshlrev_b32 v224, 16, v45
 v_and_b32 v225, 0xffff0000, v45
 v_mul_f32 v224, v224, v248
 v_mul_f32 v225, v225, v248
 v_cvt_pk_bf16_f32 v45, v224, v225
 v_lshlrev_b32 v224, 16, v46
 v_and_b32 v225, 0xffff0000, v46
 v_mul_f32 v224, v224, v248
 v_mul_f32 v225, v225, v248
 v_cvt_pk_bf16_f32 v46, v224, v225
 v_lshlrev_b32 v224, 16, v47
 v_and_b32 v225, 0xffff0000, v47
 v_mul_f32 v224, v224, v248
 v_mul_f32 v225, v225, v248
 v_cvt_pk_bf16_f32 v47, v224, v225
 v_exp_f32 v224, v96
 v_exp_f32 v225, v97
 s_nop 0
 v_cvt_pk_bf16_f32 v48, v224, v225
 v_exp_f32 v226, v98
 v_exp_f32 v227, v99
 s_nop 0
 v_cvt_pk_bf16_f32 v49, v226, v227
 v_exp_f32 v228, v100
 v_exp_f32 v229, v101
 s_nop 0
 v_cvt_pk_bf16_f32 v52, v228, v229
 v_exp_f32 v230, v102
 v_exp_f32 v231, v103
 s_nop 0
 v_cvt_pk_bf16_f32 v53, v230, v231
 v_exp_f32 v224, v104
 v_exp_f32 v225, v105
 s_nop 0
 v_cvt_pk_bf16_f32 v56, v224, v225
 v_exp_f32 v226, v106
 v_exp_f32 v227, v107
 s_nop 0
 v_cvt_pk_bf16_f32 v57, v226, v227
 v_exp_f32 v228, v108
 v_exp_f32 v229, v109
 s_nop 0
 v_cvt_pk_bf16_f32 v60, v228, v229
 v_exp_f32 v230, v110
 v_exp_f32 v231, v111
 s_nop 0
 v_cvt_pk_bf16_f32 v61, v230, v231
 v_exp_f32 v224, v112
 v_exp_f32 v225, v113
 s_nop 0
 v_cvt_pk_bf16_f32 v50, v224, v225
 v_exp_f32 v226, v114
 v_exp_f32 v227, v115
 s_nop 0
 v_cvt_pk_bf16_f32 v51, v226, v227
 v_exp_f32 v228, v116
 v_exp_f32 v229, v117
 s_nop 0
 v_cvt_pk_bf16_f32 v54, v228, v229
 v_exp_f32 v230, v118
 v_exp_f32 v231, v119
 s_nop 0
 v_cvt_pk_bf16_f32 v55, v230, v231
 v_exp_f32 v224, v120
 v_exp_f32 v225, v121
 s_nop 0
 v_cvt_pk_bf16_f32 v58, v224, v225
 v_exp_f32 v226, v122
 v_exp_f32 v227, v123
 s_nop 0
 v_cvt_pk_bf16_f32 v59, v226, v227
 v_exp_f32 v228, v124
 v_exp_f32 v229, v125
 s_nop 0
 v_cvt_pk_bf16_f32 v62, v228, v229
 v_exp_f32 v230, v126
 v_exp_f32 v231, v127
 s_nop 0
 v_cvt_pk_bf16_f32 v63, v230, v231
 v_mfma_f32_16x16x32_bf16 v[208:211], v[212:215], v[48:51], 0
 v_mfma_f32_16x16x32_bf16 v[208:211], v[216:219], v[52:55], v[208:211]
 v_mfma_f32_16x16x32_bf16 v[208:211], v[220:223], v[56:59], v[208:211]
 v_mfma_f32_16x16x32_bf16 v[208:211], v[236:239], v[60:63], v[208:211]
 s_branch L_rso
L_rare_last:
 s_call_b64 s[60:61], L_rsubl
 s_branch L_back_last
L_rsubl:
 s_nop 7
 v_max3_f32 v241, v96, v97, v98
 v_max3_f32 v241, v241, v99, v112
 v_max3_f32 v241, v241, v113, v114
 v_max_f32 v241, v241, v115
 v_mov_b32 v240, v241
 s_nop 1
 v_permlane16_swap_b32 v241, v240
 v_max_f32 v241, v241, v240
 v_mov_b32 v240, v241
 s_nop 1
 v_permlane32_swap_b32 v241, v240
 v_max_f32 v241, v241, v240
 v_max_f32 v241, 0, v241
 v_ceil_f32 v241, v241
 v_exp_f32 v245, -v241
 v_sub_f32 v192, v192, v241
 v_sub_f32 v193, v193, v241
 v_sub_f32 v194, v194, v241
 v_sub_f32 v195, v195, v241
 v_mul_f32 v232, v232, v245
 v_sub_f32 v96, v96, v241
 v_sub_f32 v97, v97, v241
 v_sub_f32 v98, v98, v241
 v_sub_f32 v99, v99, v241
 v_sub_f32 v112, v112, v241
 v_sub_f32 v113, v113, v241
 v_sub_f32 v114, v114, v241
 v_sub_f32 v115, v115, v241
 v_lshlrev_b32 v224, 16, v32
 v_and_b32 v225, 0xffff0000, v32
 v_mul_f32 v224, v224, v245
 v_mul_f32 v225, v225, v245
 v_cvt_pk_bf16_f32 v32, v224, v225
 v_lshlrev_b32 v224, 16, v33
 v_and_b32 v225, 0xffff0000, v33
 v_mul_f32 v224, v224, v245
 v_mul_f32 v225, v225, v245
 v_cvt_pk_bf16_f32 v33, v224, v225
 v_lshlrev_b32 v224, 16, v34
 v_and_b32 v225, 0xffff0000, v34
 v_mul_f32 v224, v224, v245
 v_mul_f32 v225, v225, v245
 v_cvt_pk_bf16_f32 v34, v224, v225
 v_lshlrev_b32 v224, 16, v35
 v_and_b32 v225, 0xffff0000, v35
 v_mul_f32 v224, v224, v245
 v_mul_f32 v225, v225, v245
 v_cvt_pk_bf16_f32 v35, v224, v225
 v_max3_f32 v242, v100, v101, v102
 v_max3_f32 v242, v242, v103, v116
 v_max3_f32 v242, v242, v117, v118
 v_max_f32 v242, v242, v119
 v_mov_b32 v240, v242
 s_nop 1
 v_permlane16_swap_b32 v242, v240
 v_max_f32 v242, v242, v240
 v_mov_b32 v240, v242
 s_nop 1
 v_permlane32_swap_b32 v242, v240
 v_max_f32 v242, v242, v240
 v_max_f32 v242, 0, v242
 v_ceil_f32 v242, v242
 v_exp_f32 v246, -v242
 v_sub_f32 v196, v196, v242
 v_sub_f32 v197, v197, v242
 v_sub_f32 v198, v198, v242
 v_sub_f32 v199, v199, v242
 v_mul_f32 v233, v233, v246
 v_sub_f32 v100, v100, v242
 v_sub_f32 v101, v101, v242
 v_sub_f32 v102, v102, v242
 v_sub_f32 v103, v103, v242
 v_sub_f32 v116, v116, v242
 v_sub_f32 v117, v117, v242
 v_sub_f32 v118, v118, v242
 v_sub_f32 v119, v119, v242
 v_lshlrev_b32 v224, 16, v36
 v_and_b32 v225, 0xffff0000, v36
 v_mul_f32 v224, v224, v246
 v_mul_f32 v225, v225, v246
 v_cvt_pk_bf16_f32 v36, v224, v225
 v_lshlrev_b32 v224, 16, v37
 v_and_b32 v225, 0xffff0000, v37
 v_mul_f32 v224, v224, v246
 v_mul_f32 v225, v225, v246
 v_cvt_pk_bf16_f32 v37, v224, v225
 v_lshlrev_b32 v224, 16, v38
 v_and_b32 v225, 0xffff0000, v38
 v_mul_f32 v224, v224, v246
 v_mul_f32 v225, v225, v246
 v_cvt_pk_bf16_f32 v38, v224, v225
 v_lshlrev_b32 v224, 16, v39
 v_and_b32 v225, 0xffff0000, v39
 v_mul_f32 v224, v224, v246
 v_mul_f32 v225, v225, v246
 v_cvt_pk_bf16_f32 v39, v224, v225
 v_max3_f32 v243, v104, v105, v106
 v_max3_f32 v243, v243, v107, v120
 v_max3_f32 v243, v243, v121, v122
 v_max_f32 v243, v243, v123
 v_mov_b32 v240, v243
 s_nop 1
 v_permlane16_swap_b32 v243, v240
 v_max_f32 v243, v243, v240
 v_mov_b32 v240, v243
 s_nop 1
 v_permlane32_swap_b32 v243, v240
 v_max_f32 v243, v243, v240
 v_max_f32 v243, 0, v243
 v_ceil_f32 v243, v243
 v_exp_f32 v247, -v243
 v_sub_f32 v200, v200, v243
 v_sub_f32 v201, v201, v243
 v_sub_f32 v202, v202, v243
 v_sub_f32 v203, v203, v243
 v_mul_f32 v234, v234, v247
 v_sub_f32 v104, v104, v243
 v_sub_f32 v105, v105, v243
 v_sub_f32 v106, v106, v243
 v_sub_f32 v107, v107, v243
 v_sub_f32 v120, v120, v243
 v_sub_f32 v121, v121, v243
 v_sub_f32 v122, v122, v243
 v_sub_f32 v123, v123, v243
 v_lshlrev_b32 v224, 16, v40
 v_and_b32 v225, 0xffff0000, v40
 v_mul_f32 v224, v224, v247
 v_mul_f32 v225, v225, v247
 v_cvt_pk_bf16_f32 v40, v224, v225
 v_lshlrev_b32 v224, 16, v41
 v_and_b32 v225, 0xffff0000, v41
 v_mul_f32 v224, v224, v247
 v_mul_f32 v225, v225, v247
 v_cvt_pk_bf16_f32 v41, v224, v225
 v_lshlrev_b32 v224, 16, v42
 v_and_b32 v225, 0xffff0000, v42
 v_mul_f32 v224, v224, v247
 v_mul_f32 v225, v225, v247
 v_cvt_pk_bf16_f32 v42, v224, v225
 v_lshlrev_b32 v224, 16, v43
 v_and_b32 v225, 0xffff0000, v43
 v_mul_f32 v224, v224, v247
 v_mul_f32 v225, v225, v247
 v_cvt_pk_bf16_f32 v43, v224, v225
 v_max3_f32 v244, v108, v109, v110
 v_max3_f32 v244, v244, v111, v124
 v_max3_f32 v244, v244, v125, v126
 v_max_f32 v244, v244, v127
 v_mov_b32 v240, v244
 s_nop 1
 v_permlane16_swap_b32 v244, v240
 v_max_f32 v244, v244, v240
 v_mov_b32 v240, v244
 s_nop 1
 v_permlane32_swap_b32 v244, v240
 v_max_f32 v244, v244, v240
 v_max_f32 v244, 0, v244
 v_ceil_f32 v244, v244
 v_exp_f32 v248, -v244
 v_sub_f32 v204, v204, v244
 v_sub_f32 v205, v205, v244
 v_sub_f32 v206, v206, v244
 v_sub_f32 v207, v207, v244
 v_mul_f32 v235, v235, v248
 v_sub_f32 v108, v108, v244
 v_sub_f32 v109, v109, v244
 v_sub_f32 v110, v110, v244
 v_sub_f32 v111, v111, v244
 v_sub_f32 v124, v124, v244
 v_sub_f32 v125, v125, v244
 v_sub_f32 v126, v126, v244
 v_sub_f32 v127, v127, v244
 v_lshlrev_b32 v224, 16, v44
 v_and_b32 v225, 0xffff0000, v44
 v_mul_f32 v224, v224, v248
 v_mul_f32 v225, v225, v248
 v_cvt_pk_bf16_f32 v44, v224, v225
 v_lshlrev_b32 v224, 16, v45
 v_and_b32 v225, 0xffff0000, v45
 v_mul_f32 v224, v224, v248
 v_mul_f32 v225, v225, v248
 v_cvt_pk_bf16_f32 v45, v224, v225
 v_lshlrev_b32 v224, 16, v46
 v_and_b32 v225, 0xffff0000, v46
 v_mul_f32 v224, v224, v248
 v_mul_f32 v225, v225, v248
 v_cvt_pk_bf16_f32 v46, v224, v225
 v_lshlrev_b32 v224, 16, v47
 v_and_b32 v225, 0xffff0000, v47
 v_mul_f32 v224, v224, v248
 v_mul_f32 v225, v225, v248
 v_cvt_pk_bf16_f32 v47, v224, v225
 v_exp_f32 v224, v96
 v_exp_f32 v225, v97
 s_nop 0
 v_cvt_pk_bf16_f32 v48, v224, v225
 v_exp_f32 v226, v98
 v_exp_f32 v227, v99
 s_nop 0
 v_cvt_pk_bf16_f32 v49, v226, v227
 v_exp_f32 v228, v100
 v_exp_f32 v229, v101
 s_nop 0
 v_cvt_pk_bf16_f32 v52, v228, v229
 v_exp_f32 v230, v102
 v_exp_f32 v231, v103
 s_nop 0
 v_cvt_pk_bf16_f32 v53, v230, v231
 v_exp_f32 v224, v104
 v_exp_f32 v225, v105
 s_nop 0
 v_cvt_pk_bf16_f32 v56, v224, v225
 v_exp_f32 v226, v106
 v_exp_f32 v227, v107
 s_nop 0
 v_cvt_pk_bf16_f32 v57, v226, v227
 v_exp_f32 v228, v108
 v_exp_f32 v229, v109
 s_nop 0
 v_cvt_pk_bf16_f32 v60, v228, v229
 v_exp_f32 v230, v110
 v_exp_f32 v231, v111
 s_nop 0
 v_cvt_pk_bf16_f32 v61, v230, v231
 v_exp_f32 v224, v112
 v_exp_f32 v225, v113
 s_nop 0
 v_cvt_pk_bf16_f32 v50, v224, v225
 v_exp_f32 v226, v114
 v_exp_f32 v227, v115
 s_nop 0
 v_cvt_pk_bf16_f32 v51, v226, v227
 v_exp_f32 v228, v116
 v_exp_f32 v229, v117
 s_nop 0
 v_cvt_pk_bf16_f32 v54, v228, v229
 v_exp_f32 v230, v118
 v_exp_f32 v231, v119
 s_nop 0
 v_cvt_pk_bf16_f32 v55, v230, v231
 v_exp_f32 v224, v120
 v_exp_f32 v225, v121
 s_nop 0
 v_cvt_pk_bf16_f32 v58, v224, v225
 v_exp_f32 v226, v122
 v_exp_f32 v227, v123
 s_nop 0
 v_cvt_pk_bf16_f32 v59, v226, v227
 v_exp_f32 v228, v124
 v_exp_f32 v229, v125
 s_nop 0
 v_cvt_pk_bf16_f32 v62, v228, v229
 v_exp_f32 v230, v126
 v_exp_f32 v231, v127
 s_nop 0
 v_cvt_pk_bf16_f32 v63, v230, v231
 v_mfma_f32_16x16x32_bf16 v[208:211], v[212:215], v[48:51], 0
 v_mfma_f32_16x16x32_bf16 v[208:211], v[216:219], v[52:55], v[208:211]
 v_mfma_f32_16x16x32_bf16 v[208:211], v[220:223], v[56:59], v[208:211]
 v_mfma_f32_16x16x32_bf16 v[208:211], v[236:239], v[60:63], v[208:211]
 s_branch L_rso
L_rso:
 v_accvgpr_read_b32 v240, a0
 v_mul_f32 v240, v240, v245
 v_accvgpr_write_b32 a0, v240
 v_accvgpr_read_b32 v240, a1
 v_mul_f32 v240, v240, v245
 v_accvgpr_write_b32 a1, v240
 v_accvgpr_read_b32 v240, a2
 v_mul_f32 v240, v240, v245
 v_accvgpr_write_b32 a2, v240
 v_accvgpr_read_b32 v240, a3
 v_mul_f32 v240, v240, v245
 v_accvgpr_write_b32 a3, v240
 v_accvgpr_read_b32 v240, a16
 v_mul_f32 v240, v240, v245
 v_accvgpr_write_b32 a16, v240
 v_accvgpr_read_b32 v240, a17
 v_mul_f32 v240, v240, v245
 v_accvgpr_write_b32 a17, v240
 v_accvgpr_read_b32 v240, a18
 v_mul_f32 v240, v240, v245
 v_accvgpr_write_b32 a18, v240
 v_accvgpr_read_b32 v240, a19
 v_mul_f32 v240, v240, v245
 v_accvgpr_write_b32 a19, v240
 v_accvgpr_read_b32 v240, a32
 v_mul_f32 v240, v240, v245
 v_accvgpr_write_b32 a32, v240
 v_accvgpr_read_b32 v240, a33
 v_mul_f32 v240, v240, v245
 v_accvgpr_write_b32 a33, v240
 v_accvgpr_read_b32 v240, a34
 v_mul_f32 v240, v240, v245
 v_accvgpr_write_b32 a34, v240
 v_accvgpr_read_b32 v240, a35
 v_mul_f32 v240, v240, v245
 v_accvgpr_write_b32 a35, v240
 v_accvgpr_read_b32 v240, a48
 v_mul_f32 v240, v240, v245
 v_accvgpr_write_b32 a48, v240
 v_accvgpr_read_b32 v240, a49
 v_mul_f32 v240, v240, v245
 v_accvgpr_write_b32 a49, v240
 v_accvgpr_read_b32 v240, a50
 v_mul_f32 v240, v240, v245
 v_accvgpr_write_b32 a50, v240
 v_accvgpr_read_b32 v240, a51
 v_mul_f32 v240, v240, v245
 v_accvgpr_write_b32 a51, v240
 v_accvgpr_read_b32 v240, a64
 v_mul_f32 v240, v240, v245
 v_accvgpr_write_b32 a64, v240
 v_accvgpr_read_b32 v240, a65
 v_mul_f32 v240, v240, v245
 v_accvgpr_write_b32 a65, v240
 v_accvgpr_read_b32 v240, a66
 v_mul_f32 v240, v240, v245
 v_accvgpr_write_b32 a66, v240
 v_accvgpr_read_b32 v240, a67
 v_mul_f32 v240, v240, v245
 v_accvgpr_write_b32 a67, v240
 v_accvgpr_read_b32 v240, a80
 v_mul_f32 v240, v240, v245
 v_accvgpr_write_b32 a80, v240
 v_accvgpr_read_b32 v240, a81
 v_mul_f32 v240, v240, v245
 v_accvgpr_write_b32 a81, v240
 v_accvgpr_read_b32 v240, a82
 v_mul_f32 v240, v240, v245
 v_accvgpr_write_b32 a82, v240
 v_accvgpr_read_b32 v240, a83
 v_mul_f32 v240, v240, v245
 v_accvgpr_write_b32 a83, v240
 v_accvgpr_read_b32 v240, a96
 v_mul_f32 v240, v240, v245
 v_accvgpr_write_b32 a96, v240
 v_accvgpr_read_b32 v240, a97
 v_mul_f32 v240, v240, v245
 v_accvgpr_write_b32 a97, v240
 v_accvgpr_read_b32 v240, a98
 v_mul_f32 v240, v240, v245
 v_accvgpr_write_b32 a98, v240
 v_accvgpr_read_b32 v240, a99
 v_mul_f32 v240, v240, v245
 v_accvgpr_write_b32 a99, v240
 v_accvgpr_read_b32 v240, a112
 v_mul_f32 v240, v240, v245
 v_accvgpr_write_b32 a112, v240
 v_accvgpr_read_b32 v240, a113
 v_mul_f32 v240, v240, v245
 v_accvgpr_write_b32 a113, v240
 v_accvgpr_read_b32 v240, a114
 v_mul_f32 v240, v240, v245
 v_accvgpr_write_b32 a114, v240
 v_accvgpr_read_b32 v240, a115
 v_mul_f32 v240, v240, v245
 v_accvgpr_write_b32 a115, v240
 v_accvgpr_read_b32 v240, a4
 v_mul_f32 v240, v240, v246
 v_accvgpr_write_b32 a4, v240
 v_accvgpr_read_b32 v240, a5
 v_mul_f32 v240, v240, v246
 v_accvgpr_write_b32 a5, v240
 v_accvgpr_read_b32 v240, a6
 v_mul_f32 v240, v240, v246
 v_accvgpr_write_b32 a6, v240
 v_accvgpr_read_b32 v240, a7
 v_mul_f32 v240, v240, v246
 v_accvgpr_write_b32 a7, v240
 v_accvgpr_read_b32 v240, a20
 v_mul_f32 v240, v240, v246
 v_accvgpr_write_b32 a20, v240
 v_accvgpr_read_b32 v240, a21
 v_mul_f32 v240, v240, v246
 v_accvgpr_write_b32 a21, v240
 v_accvgpr_read_b32 v240, a22
 v_mul_f32 v240, v240, v246
 v_accvgpr_write_b32 a22, v240
 v_accvgpr_read_b32 v240, a23
 v_mul_f32 v240, v240, v246
 v_accvgpr_write_b32 a23, v240
 v_accvgpr_read_b32 v240, a36
 v_mul_f32 v240, v240, v246
 v_accvgpr_write_b32 a36, v240
 v_accvgpr_read_b32 v240, a37
 v_mul_f32 v240, v240, v246
 v_accvgpr_write_b32 a37, v240
 v_accvgpr_read_b32 v240, a38
 v_mul_f32 v240, v240, v246
 v_accvgpr_write_b32 a38, v240
 v_accvgpr_read_b32 v240, a39
 v_mul_f32 v240, v240, v246
 v_accvgpr_write_b32 a39, v240
 v_accvgpr_read_b32 v240, a52
 v_mul_f32 v240, v240, v246
 v_accvgpr_write_b32 a52, v240
 v_accvgpr_read_b32 v240, a53
 v_mul_f32 v240, v240, v246
 v_accvgpr_write_b32 a53, v240
 v_accvgpr_read_b32 v240, a54
 v_mul_f32 v240, v240, v246
 v_accvgpr_write_b32 a54, v240
 v_accvgpr_read_b32 v240, a55
 v_mul_f32 v240, v240, v246
 v_accvgpr_write_b32 a55, v240
 v_accvgpr_read_b32 v240, a68
 v_mul_f32 v240, v240, v246
 v_accvgpr_write_b32 a68, v240
 v_accvgpr_read_b32 v240, a69
 v_mul_f32 v240, v240, v246
 v_accvgpr_write_b32 a69, v240
 v_accvgpr_read_b32 v240, a70
 v_mul_f32 v240, v240, v246
 v_accvgpr_write_b32 a70, v240
 v_accvgpr_read_b32 v240, a71
 v_mul_f32 v240, v240, v246
 v_accvgpr_write_b32 a71, v240
 v_accvgpr_read_b32 v240, a84
 v_mul_f32 v240, v240, v246
 v_accvgpr_write_b32 a84, v240
 v_accvgpr_read_b32 v240, a85
 v_mul_f32 v240, v240, v246
 v_accvgpr_write_b32 a85, v240
 v_accvgpr_read_b32 v240, a86
 v_mul_f32 v240, v240, v246
 v_accvgpr_write_b32 a86, v240
 v_accvgpr_read_b32 v240, a87
 v_mul_f32 v240, v240, v246
 v_accvgpr_write_b32 a87, v240
 v_accvgpr_read_b32 v240, a100
 v_mul_f32 v240, v240, v246
 v_accvgpr_write_b32 a100, v240
 v_accvgpr_read_b32 v240, a101
 v_mul_f32 v240, v240, v246
 v_accvgpr_write_b32 a101, v240
 v_accvgpr_read_b32 v240, a102
 v_mul_f32 v240, v240, v246
 v_accvgpr_write_b32 a102, v240
 v_accvgpr_read_b32 v240, a103
 v_mul_f32 v240, v240, v246
 v_accvgpr_write_b32 a103, v240
 v_accvgpr_read_b32 v240, a116
 v_mul_f32 v240, v240, v246
 v_accvgpr_write_b32 a116, v240
 v_accvgpr_read_b32 v240, a117
 v_mul_f32 v240, v240, v246
 v_accvgpr_write_b32 a117, v240
 v_accvgpr_read_b32 v240, a118
 v_mul_f32 v240, v240, v246
 v_accvgpr_write_b32 a118, v240
 v_accvgpr_read_b32 v240, a119
 v_mul_f32 v240, v240, v246
 v_accvgpr_write_b32 a119, v240
 v_accvgpr_read_b32 v240, a8
 v_mul_f32 v240, v240, v247
 v_accvgpr_write_b32 a8, v240
 v_accvgpr_read_b32 v240, a9
 v_mul_f32 v240, v240, v247
 v_accvgpr_write_b32 a9, v240
 v_accvgpr_read_b32 v240, a10
 v_mul_f32 v240, v240, v247
 v_accvgpr_write_b32 a10, v240
 v_accvgpr_read_b32 v240, a11
 v_mul_f32 v240, v240, v247
 v_accvgpr_write_b32 a11, v240
 v_accvgpr_read_b32 v240, a24
 v_mul_f32 v240, v240, v247
 v_accvgpr_write_b32 a24, v240
 v_accvgpr_read_b32 v240, a25
 v_mul_f32 v240, v240, v247
 v_accvgpr_write_b32 a25, v240
 v_accvgpr_read_b32 v240, a26
 v_mul_f32 v240, v240, v247
 v_accvgpr_write_b32 a26, v240
 v_accvgpr_read_b32 v240, a27
 v_mul_f32 v240, v240, v247
 v_accvgpr_write_b32 a27, v240
 v_accvgpr_read_b32 v240, a40
 v_mul_f32 v240, v240, v247
 v_accvgpr_write_b32 a40, v240
 v_accvgpr_read_b32 v240, a41
 v_mul_f32 v240, v240, v247
 v_accvgpr_write_b32 a41, v240
 v_accvgpr_read_b32 v240, a42
 v_mul_f32 v240, v240, v247
 v_accvgpr_write_b32 a42, v240
 v_accvgpr_read_b32 v240, a43
 v_mul_f32 v240, v240, v247
 v_accvgpr_write_b32 a43, v240
 v_accvgpr_read_b32 v240, a56
 v_mul_f32 v240, v240, v247
 v_accvgpr_write_b32 a56, v240
 v_accvgpr_read_b32 v240, a57
 v_mul_f32 v240, v240, v247
 v_accvgpr_write_b32 a57, v240
 v_accvgpr_read_b32 v240, a58
 v_mul_f32 v240, v240, v247
 v_accvgpr_write_b32 a58, v240
 v_accvgpr_read_b32 v240, a59
 v_mul_f32 v240, v240, v247
 v_accvgpr_write_b32 a59, v240
 v_accvgpr_read_b32 v240, a72
 v_mul_f32 v240, v240, v247
 v_accvgpr_write_b32 a72, v240
 v_accvgpr_read_b32 v240, a73
 v_mul_f32 v240, v240, v247
 v_accvgpr_write_b32 a73, v240
 v_accvgpr_read_b32 v240, a74
 v_mul_f32 v240, v240, v247
 v_accvgpr_write_b32 a74, v240
 v_accvgpr_read_b32 v240, a75
 v_mul_f32 v240, v240, v247
 v_accvgpr_write_b32 a75, v240
 v_accvgpr_read_b32 v240, a88
 v_mul_f32 v240, v240, v247
 v_accvgpr_write_b32 a88, v240
 v_accvgpr_read_b32 v240, a89
 v_mul_f32 v240, v240, v247
 v_accvgpr_write_b32 a89, v240
 v_accvgpr_read_b32 v240, a90
 v_mul_f32 v240, v240, v247
 v_accvgpr_write_b32 a90, v240
 v_accvgpr_read_b32 v240, a91
 v_mul_f32 v240, v240, v247
 v_accvgpr_write_b32 a91, v240
 v_accvgpr_read_b32 v240, a104
 v_mul_f32 v240, v240, v247
 v_accvgpr_write_b32 a104, v240
 v_accvgpr_read_b32 v240, a105
 v_mul_f32 v240, v240, v247
 v_accvgpr_write_b32 a105, v240
 v_accvgpr_read_b32 v240, a106
 v_mul_f32 v240, v240, v247
 v_accvgpr_write_b32 a106, v240
 v_accvgpr_read_b32 v240, a107
 v_mul_f32 v240, v240, v247
 v_accvgpr_write_b32 a107, v240
 v_accvgpr_read_b32 v240, a120
 v_mul_f32 v240, v240, v247
 v_accvgpr_write_b32 a120, v240
 v_accvgpr_read_b32 v240, a121
 v_mul_f32 v240, v240, v247
 v_accvgpr_write_b32 a121, v240
 v_accvgpr_read_b32 v240, a122
 v_mul_f32 v240, v240, v247
 v_accvgpr_write_b32 a122, v240
 v_accvgpr_read_b32 v240, a123
 v_mul_f32 v240, v240, v247
 v_accvgpr_write_b32 a123, v240
 v_accvgpr_read_b32 v240, a12
 v_mul_f32 v240, v240, v248
 v_accvgpr_write_b32 a12, v240
 v_accvgpr_read_b32 v240, a13
 v_mul_f32 v240, v240, v248
 v_accvgpr_write_b32 a13, v240
 v_accvgpr_read_b32 v240, a14
 v_mul_f32 v240, v240, v248
 v_accvgpr_write_b32 a14, v240
 v_accvgpr_read_b32 v240, a15
 v_mul_f32 v240, v240, v248
 v_accvgpr_write_b32 a15, v240
 v_accvgpr_read_b32 v240, a28
 v_mul_f32 v240, v240, v248
 v_accvgpr_write_b32 a28, v240
 v_accvgpr_read_b32 v240, a29
 v_mul_f32 v240, v240, v248
 v_accvgpr_write_b32 a29, v240
 v_accvgpr_read_b32 v240, a30
 v_mul_f32 v240, v240, v248
 v_accvgpr_write_b32 a30, v240
 v_accvgpr_read_b32 v240, a31
 v_mul_f32 v240, v240, v248
 v_accvgpr_write_b32 a31, v240
 v_accvgpr_read_b32 v240, a44
 v_mul_f32 v240, v240, v248
 v_accvgpr_write_b32 a44, v240
 v_accvgpr_read_b32 v240, a45
 v_mul_f32 v240, v240, v248
 v_accvgpr_write_b32 a45, v240
 v_accvgpr_read_b32 v240, a46
 v_mul_f32 v240, v240, v248
 v_accvgpr_write_b32 a46, v240
 v_accvgpr_read_b32 v240, a47
 v_mul_f32 v240, v240, v248
 v_accvgpr_write_b32 a47, v240
 v_accvgpr_read_b32 v240, a60
 v_mul_f32 v240, v240, v248
 v_accvgpr_write_b32 a60, v240
 v_accvgpr_read_b32 v240, a61
 v_mul_f32 v240, v240, v248
 v_accvgpr_write_b32 a61, v240
 v_accvgpr_read_b32 v240, a62
 v_mul_f32 v240, v240, v248
 v_accvgpr_write_b32 a62, v240
 v_accvgpr_read_b32 v240, a63
 v_mul_f32 v240, v240, v248
 v_accvgpr_write_b32 a63, v240
 v_accvgpr_read_b32 v240, a76
 v_mul_f32 v240, v240, v248
 v_accvgpr_write_b32 a76, v240
 v_accvgpr_read_b32 v240, a77
 v_mul_f32 v240, v240, v248
 v_accvgpr_write_b32 a77, v240
 v_accvgpr_read_b32 v240, a78
 v_mul_f32 v240, v240, v248
 v_accvgpr_write_b32 a78, v240
 v_accvgpr_read_b32 v240, a79
 v_mul_f32 v240, v240, v248
 v_accvgpr_write_b32 a79, v240
 v_accvgpr_read_b32 v240, a92
 v_mul_f32 v240, v240, v248
 v_accvgpr_write_b32 a92, v240
 v_accvgpr_read_b32 v240, a93
 v_mul_f32 v240, v240, v248
 v_accvgpr_write_b32 a93, v240
 v_accvgpr_read_b32 v240, a94
 v_mul_f32 v240, v240, v248
 v_accvgpr_write_b32 a94, v240
 v_accvgpr_read_b32 v240, a95
 v_mul_f32 v240, v240, v248
 v_accvgpr_write_b32 a95, v240
 v_accvgpr_read_b32 v240, a108
 v_mul_f32 v240, v240, v248
 v_accvgpr_write_b32 a108, v240
 v_accvgpr_read_b32 v240, a109
 v_mul_f32 v240, v240, v248
 v_accvgpr_write_b32 a109, v240
 v_accvgpr_read_b32 v240, a110
 v_mul_f32 v240, v240, v248
 v_accvgpr_write_b32 a110, v240
 v_accvgpr_read_b32 v240, a111
 v_mul_f32 v240, v240, v248
 v_accvgpr_write_b32 a111, v240
 v_accvgpr_read_b32 v240, a124
 v_mul_f32 v240, v240, v248
 v_accvgpr_write_b32 a124, v240
 v_accvgpr_read_b32 v240, a125
 v_mul_f32 v240, v240, v248
 v_accvgpr_write_b32 a125, v240
 v_accvgpr_read_b32 v240, a126
 v_mul_f32 v240, v240, v248
 v_accvgpr_write_b32 a126, v240
 v_accvgpr_read_b32 v240, a127
 v_mul_f32 v240, v240, v248
 v_accvgpr_write_b32 a127, v240
 s_nop 7
 s_setpc_b64 s[60:61]
 .fill 64, 4, 0xbf800000
 s_endpgm
 .if (. - L_peel) < 65536
.error "code prefetch window leaves .text"
.endif
.section .rodata,"a"
.p2align 6
.amdhsa_kernel recurrent_scan__mha_block_cached__geglu_ffn__prompt_kernel
  .amdhsa_next_free_vgpr 512
  .amdhsa_next_free_sgpr 102
  .amdhsa_accum_offset 256
  .amdhsa_group_segment_fixed_size 0
  .amdhsa_kernarg_size 96
  .amdhsa_user_sgpr_count 2
  .amdhsa_user_sgpr_kernarg_segment_ptr 1
  .amdhsa_system_sgpr_workgroup_id_x 1
.end_amdhsa_kernel
```
